```python
import torch

def _softmax(x, axis=-1):
    return torch.softmax(x, dim=axis)
def _gelu(x):
    return torch.nn.functional.gelu(x, approximate="tanh")
def _silu(x):
    return torch.nn.functional.silu(x)
def _sigmoid(x):
    return torch.sigmoid(x)
def _layernorm(x, axis=-1, eps=1e-5):
    m = x.mean(dim=axis, keepdim=True)
    v = x.var(dim=axis, keepdim=True, unbiased=False)
    return (x - m) / torch.sqrt(v + eps)
def _scatter_add(tgt, idx, src, axis=0):
    return tgt.clone().index_add_(axis, idx, src)
def _segment_sum(src, seg, n):
    out = torch.zeros((n,) + src.shape[1:], dtype=src.dtype)
    return out.index_add_(0, seg, src)
def _pad(x, pw):
    flat = tuple(v for pair in reversed(pw) for v in pair)
    return torch.nn.functional.pad(x, flat)

kernel_name = 'interleave_layers__sliding_local_dilated__glu_gated_bilinear__prompt'

def setup_inputs():

    _w = (lambda a: (lambda t: t.to(torch.bfloat16) if t.is_floating_point() else t)(torch.as_tensor(a)))
    def _A_setup():
        B, S, D = 1, 2048, 576
        return {
            "x": _w((lambda *s: torch.randn(*s, dtype=torch.bfloat16) * 0.05)(B, S, D)),
            "wqkv": _w((lambda *s: torch.randn(*s, dtype=torch.bfloat16) * 0.05)(D, 3 * D)),
            "wo": _w((lambda *s: torch.randn(*s, dtype=torch.bfloat16) * 0.05)(D, D)),
        }
    _A_in = _A_setup()

    def _B_setup():
        B, S, D, F = 1, 2048, 576, 4608
        return {
            "x": _w((lambda *s: torch.randn(*s, dtype=torch.bfloat16) * 0.05)(B, S, D)),
            "w_gate": _w((lambda *s: torch.randn(*s, dtype=torch.bfloat16) * 0.8)(D, F) * (D ** -0.5)),
            "w_up": _w((lambda *s: torch.randn(*s, dtype=torch.bfloat16) * 0.8)(D, F) * (D ** -0.5)),
            "w_down": _w((lambda *s: torch.randn(*s, dtype=torch.bfloat16) * 0.8)(F, D) * (F ** -0.5)),
        }
    _B_in = _B_setup()

    return {
        "A_x": _A_in["x"],
        "A_wqkv": _A_in["wqkv"],
        "A_wo": _A_in["wo"],
        "B_x": _B_in["x"],
        "B_w_gate": _B_in["w_gate"],
        "B_w_up": _B_in["w_up"],
        "B_w_down": _B_in["w_down"],
    }

def reference(A_x, A_wqkv, A_wo, B_x, B_w_gate, B_w_up, B_w_down):
    def _A_ref(x, wqkv, wo):
        B, S, D = x.shape
        H = 32; Dh = D // H
        W, dil = 8, 2
        qkv = (lambda x, *d: x.permute(*d))((x @ wqkv).reshape(B, S, 3, H, Dh), 2, 0, 3, 1, 4)
        q, k, v = qkv[0], qkv[1], qkv[2]
        scale = Dh ** -0.5
        pos = torch.arange(S)
        off = torch.arange(W) * dil
        idx = pos[:, None] - off[None, :]
        mask = idx >= 0
        idx_c = torch.where(mask, idx, 0).reshape(-1)
        kg = k[:, :, idx_c, :].reshape(B, H, S, W, Dh)
        vg = v[:, :, idx_c, :].reshape(B, H, S, W, Dh)
        logits = torch.einsum("bhsd,bhswd->bhsw", q, kg) * scale
        logits = torch.where(mask[None, None, :, :], logits, -1e9)
        attn = _softmax(logits, axis=-1)
        o = torch.einsum("bhsw,bhswd->bhsd", attn, vg)
        return (lambda x, *d: x.permute(*d))(o, 0, 2, 1, 3).reshape(B, S, D) @ wo

    def _B_ref(x, w_gate, w_up, w_down):
        g = torch.einsum("bsd,df->bsf", x, w_gate)
        u = torch.einsum("bsd,df->bsf", x, w_up)
        h = g * u
        return torch.einsum("bsf,fd->bsd", h, w_down)

    x = A_x
    x = x + _A_ref(_layernorm(x, axis=-1), A_wqkv, A_wo)
    x = x + _B_ref(_layernorm(x, axis=-1), B_w_gate, B_w_up, B_w_down)
    x = x + _A_ref(_layernorm(x, axis=-1), A_wqkv, A_wo)
    x = x + _B_ref(_layernorm(x, axis=-1), B_w_gate, B_w_up, B_w_down)
    return x
```

```asm
; @launch kernel=prep_kernel grid=(256,1,1) block=(256,1,1) lds=73984
; @launch kernel=qkv0_kernel grid=(256,1,1) block=(256,1,1) lds=162816
; @launch kernel=wo0_kernel grid=(256,1,1) block=(256,1,1) lds=110592
; @launch kernel=ffn0_kernel grid=(256,1,1) block=(256,1,1) lds=149504
; @launch kernel=red0_kernel grid=(256,1,1) block=(256,1,1) lds=256
; @launch kernel=qkv1_kernel grid=(256,1,1) block=(256,1,1) lds=162816
; @launch kernel=wo1_kernel grid=(256,1,1) block=(256,1,1) lds=110592
; @launch kernel=ffn1_kernel grid=(256,1,1) block=(256,1,1) lds=149504
; @launch kernel=red1_kernel grid=(256,1,1) block=(256,1,1) lds=256
.amdgcn_target "amdgcn-amd-amdhsa--gfx950"
.text
.globl prep_kernel
.p2align 8
.type prep_kernel,@function
prep_kernel:
    s_cmp_ge_u32 s2, 256
    s_cbranch_scc1 prep_kernel_end
    s_load_dwordx16 s[24:39], s[0:1], 0
    s_load_dwordx4 s[40:43], s[0:1], 64
    v_lshrrev_b32 v1, 6, v0
    s_and_b32 s21, s2, 7
    v_readfirstlane_b32 s20, v1
    s_lshr_b32 s22, s2, 3
    v_and_b32 v1, 63, v0
    v_lshlrev_b32 v2, 4, v1
    s_waitcnt lgkmcnt(0)
    s_mov_b32 s4, s42
    s_mov_b32 s5, s43
    s_mov_b32 s6, 0x10000000
    s_mov_b32 s7, 0x20000
    s_mov_b32 s8, s24
    s_mov_b32 s9, s25
    s_mov_b32 s10, 0x240000
    s_mov_b32 s11, 0x20000
    s_lshl_b32 s46, s2, 10
    s_add_u32 s46, s46, 3932160
    v_lshlrev_b32 v5, 2, v0
    v_mov_b32 v6, 0
    buffer_store_dword v6, v5, s[4:7], s46 offen
    s_lshl_b32 s47, s21, 5
    s_add_u32 s47, s47, s22
    v_and_b32 v5, 7, v1
    v_lshrrev_b32 v6, 3, v1
    s_lshl_b32 s48, s47, 3
    v_add_u32 v3, s48, v5
    v_mul_u32_u24 v3, 1152, v3
    s_mul_i32 s48, s20, 384
    v_lshl_add_u32 v3, v6, 4, v3
    v_add_u32 v3, s48, v3
    s_lshr_b32 s48, s47, 1
    s_mul_i32 s48, s48, 18432
    s_and_b32 s49, s47, 1
    s_lshl_b32 s49, s49, 7
    s_add_u32 s48, s48, s49
    s_mul_i32 s49, s20, 6144
    s_add_u32 s48, s48, s49
    v_lshlrev_b32 v5, 4, v5
    v_lshl_add_u32 v5, v6, 8, v5
    v_add_u32 v4, s48, v5
    buffer_load_dwordx4 v[8:11], v3, s[8:11], 0 offen offset:0
    buffer_load_dwordx4 v[12:15], v3, s[8:11], 0 offen offset:128
    buffer_load_dwordx4 v[16:19], v3, s[8:11], 0 offen offset:256
    s_lshl_b32 s23, s2, 2
    s_add_u32 s23, s23, s20
    s_mul_i32 s94, s20, 18432
    s_add_u32 s94, s94, 256
    s_add_u32 s95, s94, 9216
    s_cmp_ge_u32 s23, 1152
    s_cbranch_scc1 L_ud_2
    s_mul_i32 s56, s23, 1821
    s_lshr_b32 s56, s56, 16
    s_mul_i32 s86, s56, 36
    s_sub_u32 s86, s23, s86
    s_and_b32 s87, s86, 1
    s_lshr_b32 s88, s86, 1
    s_cmp_eq_u32 s87, 0
    s_cselect_b32 s12, s32, s34
    s_cselect_b32 s13, s33, s35
    s_mul_i32 s50, s88, 294912
    s_mul_i32 s89, s56, 288
    s_add_u32 s50, s50, s89
    s_mov_b32 s51, 73728
    s_mov_b32 s52, 36864
    s_mov_b32 s53, 9216
    s_mov_b32 s54, 0
    s_mov_b32 s55, 256
    s_mul_i32 s89, s56, 486
    s_add_u32 s89, s89, s86
    s_lshl_b32 s89, s89, 10
    s_add_u32 s89, s89, 4194304
    s_add_u32 s58, s89, 36864
    s_add_u32 s59, s89, 73728
    s_add_u32 s60, s89, 110592
    s_add_u32 s61, s89, 147456
    s_add_u32 s62, s89, 184320
    s_add_u32 s63, s89, 221184
    s_add_u32 s64, s89, 258048
    s_add_u32 s65, s89, 294912
    s_add_u32 s66, s89, 0
    s_lshl_b32 s89, s56, 1
    s_add_u32 s89, s89, s87
    s_mul_i32 s89, s89, 18
    s_add_u32 s89, s89, s88
    s_mul_i32 s89, s89, 576
    s_add_u32 s57, s89, 2883584
    s_branch L_udone_3
L_ud_2:
    s_sub_u32 s86, s23, 1152
    s_mul_i32 s56, s86, 3641
    s_lshr_b32 s56, s56, 16
    s_mul_i32 s87, s56, 18
    s_sub_u32 s86, s86, s87
    s_mov_b32 s12, s36
    s_mov_b32 s13, s37
    s_mov_b32 s57, 0
    s_mov_b32 s53, 1152
    s_and_b32 s87, s56, 3
    s_and_b32 s88, s87, 1
    s_lshl_b32 s54, s88, 5
    s_cmp_eq_u32 s88, 0
    s_cselect_b32 s55, 256, 0
    s_mov_b32 s91, -165888
    s_cselect_b32 s91, 165888, s91
    s_mov_b32 s51, 9216
    s_mov_b32 s52, 4608
    s_cmp_ge_u32 s86, 4
    s_cbranch_scc1 L_ush_4
    s_mov_b32 s89, s87
    s_lshl_b32 s90, s86, 5
    s_branch L_urows_6
L_ush_4:
    s_cmp_ge_u32 s86, 6
    s_cbranch_scc1 L_urm_5
    s_sub_u32 s89, s86, 4
    s_lshl_b32 s89, s89, 1
    s_xor_b32 s89, s89, s87
    s_mov_b32 s90, 128
    s_mov_b32 s51, 4608
    s_mov_b32 s52, s91
    s_branch L_urows_6
L_urm_5:
    s_sub_u32 s89, s86, 6
    s_mul_i32 s90, s89, 21846
    s_lshr_b32 s90, s90, 16
    s_mul_i32 s91, s90, 3
    s_sub_u32 s89, s89, s91
    s_add_u32 s89, s89, 1
    s_xor_b32 s89, s89, s87
    s_lshl_b32 s90, s90, 5
L_urows_6:
    s_mul_i32 s89, s89, 144
    s_add_u32 s89, s89, s90
    s_lshr_b32 s90, s56, 2
    s_mul_i32 s90, s90, 576
    s_add_u32 s89, s89, s90
    s_mul_i32 s89, s89, 1152
    s_mul_i32 s90, s87, 288
    s_add_u32 s50, s89, s90
    s_mul_i32 s89, s56, 486
    s_add_u32 s89, s89, 324
    s_lshl_b32 s89, s89, 10
    s_add_u32 s89, s89, 4194304
    s_cmp_ge_u32 s86, 3
    s_cbranch_scc1 L_ub_7
    s_sub_u32 s90, s86, 0
    s_mul_i32 s91, s90, 4096
    s_add_u32 s91, s91, 0
    s_add_u32 s58, s91, s89
    s_mul_i32 s91, s90, 4096
    s_add_u32 s91, s91, 1024
    s_add_u32 s59, s91, s89
    s_mul_i32 s91, s90, 4096
    s_add_u32 s91, s91, 2048
    s_add_u32 s60, s91, s89
    s_mul_i32 s91, s90, 4096
    s_add_u32 s91, s91, 3072
    s_add_u32 s61, s91, s89
    s_mul_i32 s91, s90, 5120
    s_add_u32 s91, s91, 12288
    s_add_u32 s62, s91, s89
    s_mul_i32 s91, s90, 5120
    s_add_u32 s91, s91, 13312
    s_add_u32 s63, s91, s89
    s_mul_i32 s91, s90, 5120
    s_add_u32 s91, s91, 14336
    s_add_u32 s64, s91, s89
    s_mul_i32 s91, s90, 5120
    s_add_u32 s91, s91, 15360
    s_add_u32 s65, s91, s89
    s_mul_i32 s91, s90, 5120
    s_add_u32 s91, s91, 16384
    s_add_u32 s66, s91, s89
    s_branch L_udone_3
L_ub_7:
    s_cmp_ge_u32 s86, 9
    s_cbranch_scc1 L_uc_8
    s_sub_u32 s90, s86, 3
    s_mul_i32 s91, s90, 9216
    s_add_u32 s91, s91, 27648
    s_add_u32 s58, s91, s89
    s_mul_i32 s91, s90, 9216
    s_add_u32 s91, s91, 28672
    s_add_u32 s59, s91, s89
    s_mul_i32 s91, s90, 9216
    s_add_u32 s91, s91, 29696
    s_add_u32 s60, s91, s89
    s_mul_i32 s91, s90, 9216
    s_add_u32 s91, s91, 30720
    s_add_u32 s61, s91, s89
    s_mul_i32 s91, s90, 9216
    s_add_u32 s91, s91, 31744
    s_add_u32 s62, s91, s89
    s_mul_i32 s91, s90, 9216
    s_add_u32 s91, s91, 32768
    s_add_u32 s63, s91, s89
    s_mul_i32 s91, s90, 9216
    s_add_u32 s91, s91, 33792
    s_add_u32 s64, s91, s89
    s_mul_i32 s91, s90, 9216
    s_add_u32 s91, s91, 34816
    s_add_u32 s65, s91, s89
    s_mul_i32 s91, s90, 9216
    s_add_u32 s91, s91, 35840
    s_add_u32 s66, s91, s89
    s_branch L_udone_3
L_uc_8:
    s_sub_u32 s90, s86, 9
    s_mul_i32 s91, s90, 2048
    s_add_u32 s91, s91, 82944
    s_add_u32 s58, s91, s89
    s_mul_i32 s91, s90, 2048
    s_add_u32 s91, s91, 83968
    s_add_u32 s59, s91, s89
    s_mul_i32 s91, s90, 2048
    s_add_u32 s91, s91, 101376
    s_add_u32 s60, s91, s89
    s_mul_i32 s91, s90, 2048
    s_add_u32 s91, s91, 102400
    s_add_u32 s61, s91, s89
    s_mul_i32 s91, s90, 2048
    s_add_u32 s91, s91, 119808
    s_add_u32 s62, s91, s89
    s_mul_i32 s91, s90, 2048
    s_add_u32 s91, s91, 120832
    s_add_u32 s63, s91, s89
    s_mul_i32 s91, s90, 2048
    s_add_u32 s91, s91, 138240
    s_add_u32 s64, s91, s89
    s_mul_i32 s91, s90, 2048
    s_add_u32 s91, s91, 139264
    s_add_u32 s65, s91, s89
    s_mul_i32 s91, s90, 1024
    s_add_u32 s91, s91, 156672
    s_add_u32 s66, s91, s89
L_udone_3:
    s_mov_b32 s14, 0x510000
    s_mov_b32 s15, 0x20000
    v_add_u32 v64, 0, v1
    v_mul_u32_u24 v65, 3641, v64
    v_lshrrev_b32 v65, 16, v65
    v_mul_u32_u24 v66, 18, v65
    v_sub_u32 v64, v64, v66
    v_lshlrev_b32 v64, 4, v64
    v_lshrrev_b32 v66, 3, v65
    v_mul_lo_u32 v66, v66, s51
    v_bfe_u32 v67, v65, 2, 1
    v_mul_lo_u32 v67, v67, s52
    v_and_b32 v65, 3, v65
    v_mul_lo_u32 v65, v65, s53
    v_add3_u32 v64, v64, v66, v67
    v_add3_u32 v64, v64, v65, s50
    s_add_u32 m0, s94, 0
    s_nop 0
    buffer_load_dwordx4 v64, s[12:15], 0 offen lds
    v_add_u32 v64, 64, v1
    v_mul_u32_u24 v65, 3641, v64
    v_lshrrev_b32 v65, 16, v65
    v_mul_u32_u24 v66, 18, v65
    v_sub_u32 v64, v64, v66
    v_lshlrev_b32 v64, 4, v64
    v_lshrrev_b32 v66, 3, v65
    v_mul_lo_u32 v66, v66, s51
    v_bfe_u32 v67, v65, 2, 1
    v_mul_lo_u32 v67, v67, s52
    v_and_b32 v65, 3, v65
    v_mul_lo_u32 v65, v65, s53
    v_add3_u32 v64, v64, v66, v67
    v_add3_u32 v64, v64, v65, s50
    s_add_u32 m0, s94, 1024
    s_nop 0
    buffer_load_dwordx4 v64, s[12:15], 0 offen lds
    v_add_u32 v64, 128, v1
    v_mul_u32_u24 v65, 3641, v64
    v_lshrrev_b32 v65, 16, v65
    v_mul_u32_u24 v66, 18, v65
    v_sub_u32 v64, v64, v66
    v_lshlrev_b32 v64, 4, v64
    v_lshrrev_b32 v66, 3, v65
    v_mul_lo_u32 v66, v66, s51
    v_bfe_u32 v67, v65, 2, 1
    v_mul_lo_u32 v67, v67, s52
    v_and_b32 v65, 3, v65
    v_mul_lo_u32 v65, v65, s53
    v_add3_u32 v64, v64, v66, v67
    v_add3_u32 v64, v64, v65, s50
    s_add_u32 m0, s94, 2048
    s_nop 0
    buffer_load_dwordx4 v64, s[12:15], 0 offen lds
    v_add_u32 v64, 192, v1
    v_mul_u32_u24 v65, 3641, v64
    v_lshrrev_b32 v65, 16, v65
    v_mul_u32_u24 v66, 18, v65
    v_sub_u32 v64, v64, v66
    v_lshlrev_b32 v64, 4, v64
    v_lshrrev_b32 v66, 3, v65
    v_mul_lo_u32 v66, v66, s51
    v_bfe_u32 v67, v65, 2, 1
    v_mul_lo_u32 v67, v67, s52
    v_and_b32 v65, 3, v65
    v_mul_lo_u32 v65, v65, s53
    v_add3_u32 v64, v64, v66, v67
    v_add3_u32 v64, v64, v65, s50
    s_add_u32 m0, s94, 3072
    s_nop 0
    buffer_load_dwordx4 v64, s[12:15], 0 offen lds
    v_add_u32 v64, 256, v1
    v_mul_u32_u24 v65, 3641, v64
    v_lshrrev_b32 v65, 16, v65
    v_mul_u32_u24 v66, 18, v65
    v_sub_u32 v64, v64, v66
    v_lshlrev_b32 v64, 4, v64
    v_lshrrev_b32 v66, 3, v65
    v_mul_lo_u32 v66, v66, s51
    v_bfe_u32 v67, v65, 2, 1
    v_mul_lo_u32 v67, v67, s52
    v_and_b32 v65, 3, v65
    v_mul_lo_u32 v65, v65, s53
    v_add3_u32 v64, v64, v66, v67
    v_add3_u32 v64, v64, v65, s50
    s_add_u32 m0, s94, 4096
    s_nop 0
    buffer_load_dwordx4 v64, s[12:15], 0 offen lds
    v_add_u32 v64, 320, v1
    v_mul_u32_u24 v65, 3641, v64
    v_lshrrev_b32 v65, 16, v65
    v_mul_u32_u24 v66, 18, v65
    v_sub_u32 v64, v64, v66
    v_lshlrev_b32 v64, 4, v64
    v_lshrrev_b32 v66, 3, v65
    v_mul_lo_u32 v66, v66, s51
    v_bfe_u32 v67, v65, 2, 1
    v_mul_lo_u32 v67, v67, s52
    v_and_b32 v65, 3, v65
    v_mul_lo_u32 v65, v65, s53
    v_add3_u32 v64, v64, v66, v67
    v_add3_u32 v64, v64, v65, s50
    s_add_u32 m0, s94, 5120
    s_nop 0
    buffer_load_dwordx4 v64, s[12:15], 0 offen lds
    v_add_u32 v64, 384, v1
    v_mul_u32_u24 v65, 3641, v64
    v_lshrrev_b32 v65, 16, v65
    v_mul_u32_u24 v66, 18, v65
    v_sub_u32 v64, v64, v66
    v_lshlrev_b32 v64, 4, v64
    v_lshrrev_b32 v66, 3, v65
    v_mul_lo_u32 v66, v66, s51
    v_bfe_u32 v67, v65, 2, 1
    v_mul_lo_u32 v67, v67, s52
    v_and_b32 v65, 3, v65
    v_mul_lo_u32 v65, v65, s53
    v_add3_u32 v64, v64, v66, v67
    v_add3_u32 v64, v64, v65, s50
    s_add_u32 m0, s94, 6144
    s_nop 0
    buffer_load_dwordx4 v64, s[12:15], 0 offen lds
    v_add_u32 v64, 448, v1
    v_mul_u32_u24 v65, 3641, v64
    v_lshrrev_b32 v65, 16, v65
    v_mul_u32_u24 v66, 18, v65
    v_sub_u32 v64, v64, v66
    v_lshlrev_b32 v64, 4, v64
    v_lshrrev_b32 v66, 3, v65
    v_mul_lo_u32 v66, v66, s51
    v_bfe_u32 v67, v65, 2, 1
    v_mul_lo_u32 v67, v67, s52
    v_and_b32 v65, 3, v65
    v_mul_lo_u32 v65, v65, s53
    v_add3_u32 v64, v64, v66, v67
    v_add3_u32 v64, v64, v65, s50
    s_add_u32 m0, s94, 7168
    s_nop 0
    buffer_load_dwordx4 v64, s[12:15], 0 offen lds
    v_add_u32 v64, 512, v1
    v_mul_u32_u24 v65, 3641, v64
    v_lshrrev_b32 v65, 16, v65
    v_mul_u32_u24 v66, 18, v65
    v_sub_u32 v64, v64, v66
    v_lshlrev_b32 v64, 4, v64
    v_lshrrev_b32 v66, 3, v65
    v_mul_lo_u32 v66, v66, s51
    v_bfe_u32 v67, v65, 2, 1
    v_mul_lo_u32 v67, v67, s52
    v_and_b32 v65, 3, v65
    v_mul_lo_u32 v65, v65, s53
    v_add3_u32 v64, v64, v66, v67
    v_add3_u32 v64, v64, v65, s50
    s_add_u32 m0, s94, 8192
    s_nop 0
    buffer_load_dwordx4 v64, s[12:15], 0 offen lds
    s_add_u32 s96, s23, 1024
    s_cmp_ge_u32 s96, 1728
    s_cbranch_scc1 L_no1_9
    s_cmp_ge_u32 s96, 1152
    s_cbranch_scc1 L_ud_10
    s_mul_i32 s74, s96, 1821
    s_lshr_b32 s74, s74, 16
    s_mul_i32 s86, s74, 36
    s_sub_u32 s86, s96, s86
    s_and_b32 s87, s86, 1
    s_lshr_b32 s88, s86, 1
    s_cmp_eq_u32 s87, 0
    s_cselect_b32 s16, s32, s34
    s_cselect_b32 s17, s33, s35
    s_mul_i32 s68, s88, 294912
    s_mul_i32 s89, s74, 288
    s_add_u32 s68, s68, s89
    s_mov_b32 s69, 73728
    s_mov_b32 s70, 36864
    s_mov_b32 s71, 9216
    s_mov_b32 s72, 0
    s_mov_b32 s73, 256
    s_mul_i32 s89, s74, 486
    s_add_u32 s89, s89, s86
    s_lshl_b32 s89, s89, 10
    s_add_u32 s89, s89, 4194304
    s_add_u32 s76, s89, 36864
    s_add_u32 s77, s89, 73728
    s_add_u32 s78, s89, 110592
    s_add_u32 s79, s89, 147456
    s_add_u32 s80, s89, 184320
    s_add_u32 s81, s89, 221184
    s_add_u32 s82, s89, 258048
    s_add_u32 s83, s89, 294912
    s_add_u32 s84, s89, 0
    s_lshl_b32 s89, s74, 1
    s_add_u32 s89, s89, s87
    s_mul_i32 s89, s89, 18
    s_add_u32 s89, s89, s88
    s_mul_i32 s89, s89, 576
    s_add_u32 s75, s89, 2883584
    s_branch L_udone_11
L_ud_10:
    s_sub_u32 s86, s96, 1152
    s_mul_i32 s74, s86, 3641
    s_lshr_b32 s74, s74, 16
    s_mul_i32 s87, s74, 18
    s_sub_u32 s86, s86, s87
    s_mov_b32 s16, s36
    s_mov_b32 s17, s37
    s_mov_b32 s75, 0
    s_mov_b32 s71, 1152
    s_and_b32 s87, s74, 3
    s_and_b32 s88, s87, 1
    s_lshl_b32 s72, s88, 5
    s_cmp_eq_u32 s88, 0
    s_cselect_b32 s73, 256, 0
    s_mov_b32 s91, -165888
    s_cselect_b32 s91, 165888, s91
    s_mov_b32 s69, 9216
    s_mov_b32 s70, 4608
    s_cmp_ge_u32 s86, 4
    s_cbranch_scc1 L_ush_12
    s_mov_b32 s89, s87
    s_lshl_b32 s90, s86, 5
    s_branch L_urows_14
L_ush_12:
    s_cmp_ge_u32 s86, 6
    s_cbranch_scc1 L_urm_13
    s_sub_u32 s89, s86, 4
    s_lshl_b32 s89, s89, 1
    s_xor_b32 s89, s89, s87
    s_mov_b32 s90, 128
    s_mov_b32 s69, 4608
    s_mov_b32 s70, s91
    s_branch L_urows_14
L_urm_13:
    s_sub_u32 s89, s86, 6
    s_mul_i32 s90, s89, 21846
    s_lshr_b32 s90, s90, 16
    s_mul_i32 s91, s90, 3
    s_sub_u32 s89, s89, s91
    s_add_u32 s89, s89, 1
    s_xor_b32 s89, s89, s87
    s_lshl_b32 s90, s90, 5
L_urows_14:
    s_mul_i32 s89, s89, 144
    s_add_u32 s89, s89, s90
    s_lshr_b32 s90, s74, 2
    s_mul_i32 s90, s90, 576
    s_add_u32 s89, s89, s90
    s_mul_i32 s89, s89, 1152
    s_mul_i32 s90, s87, 288
    s_add_u32 s68, s89, s90
    s_mul_i32 s89, s74, 486
    s_add_u32 s89, s89, 324
    s_lshl_b32 s89, s89, 10
    s_add_u32 s89, s89, 4194304
    s_cmp_ge_u32 s86, 3
    s_cbranch_scc1 L_ub_15
    s_sub_u32 s90, s86, 0
    s_mul_i32 s91, s90, 4096
    s_add_u32 s91, s91, 0
    s_add_u32 s76, s91, s89
    s_mul_i32 s91, s90, 4096
    s_add_u32 s91, s91, 1024
    s_add_u32 s77, s91, s89
    s_mul_i32 s91, s90, 4096
    s_add_u32 s91, s91, 2048
    s_add_u32 s78, s91, s89
    s_mul_i32 s91, s90, 4096
    s_add_u32 s91, s91, 3072
    s_add_u32 s79, s91, s89
    s_mul_i32 s91, s90, 5120
    s_add_u32 s91, s91, 12288
    s_add_u32 s80, s91, s89
    s_mul_i32 s91, s90, 5120
    s_add_u32 s91, s91, 13312
    s_add_u32 s81, s91, s89
    s_mul_i32 s91, s90, 5120
    s_add_u32 s91, s91, 14336
    s_add_u32 s82, s91, s89
    s_mul_i32 s91, s90, 5120
    s_add_u32 s91, s91, 15360
    s_add_u32 s83, s91, s89
    s_mul_i32 s91, s90, 5120
    s_add_u32 s91, s91, 16384
    s_add_u32 s84, s91, s89
    s_branch L_udone_11
L_ub_15:
    s_cmp_ge_u32 s86, 9
    s_cbranch_scc1 L_uc_16
    s_sub_u32 s90, s86, 3
    s_mul_i32 s91, s90, 9216
    s_add_u32 s91, s91, 27648
    s_add_u32 s76, s91, s89
    s_mul_i32 s91, s90, 9216
    s_add_u32 s91, s91, 28672
    s_add_u32 s77, s91, s89
    s_mul_i32 s91, s90, 9216
    s_add_u32 s91, s91, 29696
    s_add_u32 s78, s91, s89
    s_mul_i32 s91, s90, 9216
    s_add_u32 s91, s91, 30720
    s_add_u32 s79, s91, s89
    s_mul_i32 s91, s90, 9216
    s_add_u32 s91, s91, 31744
    s_add_u32 s80, s91, s89
    s_mul_i32 s91, s90, 9216
    s_add_u32 s91, s91, 32768
    s_add_u32 s81, s91, s89
    s_mul_i32 s91, s90, 9216
    s_add_u32 s91, s91, 33792
    s_add_u32 s82, s91, s89
    s_mul_i32 s91, s90, 9216
    s_add_u32 s91, s91, 34816
    s_add_u32 s83, s91, s89
    s_mul_i32 s91, s90, 9216
    s_add_u32 s91, s91, 35840
    s_add_u32 s84, s91, s89
    s_branch L_udone_11
L_uc_16:
    s_sub_u32 s90, s86, 9
    s_mul_i32 s91, s90, 2048
    s_add_u32 s91, s91, 82944
    s_add_u32 s76, s91, s89
    s_mul_i32 s91, s90, 2048
    s_add_u32 s91, s91, 83968
    s_add_u32 s77, s91, s89
    s_mul_i32 s91, s90, 2048
    s_add_u32 s91, s91, 101376
    s_add_u32 s78, s91, s89
    s_mul_i32 s91, s90, 2048
    s_add_u32 s91, s91, 102400
    s_add_u32 s79, s91, s89
    s_mul_i32 s91, s90, 2048
    s_add_u32 s91, s91, 119808
    s_add_u32 s80, s91, s89
    s_mul_i32 s91, s90, 2048
    s_add_u32 s91, s91, 120832
    s_add_u32 s81, s91, s89
    s_mul_i32 s91, s90, 2048
    s_add_u32 s91, s91, 138240
    s_add_u32 s82, s91, s89
    s_mul_i32 s91, s90, 2048
    s_add_u32 s91, s91, 139264
    s_add_u32 s83, s91, s89
    s_mul_i32 s91, s90, 1024
    s_add_u32 s91, s91, 156672
    s_add_u32 s84, s91, s89
L_udone_11:
    s_mov_b32 s18, 0x510000
    s_mov_b32 s19, 0x20000
    v_add_u32 v64, 0, v1
    v_mul_u32_u24 v65, 3641, v64
    v_lshrrev_b32 v65, 16, v65
    v_mul_u32_u24 v66, 18, v65
    v_sub_u32 v64, v64, v66
    v_lshlrev_b32 v64, 4, v64
    v_lshrrev_b32 v66, 3, v65
    v_mul_lo_u32 v66, v66, s69
    v_bfe_u32 v67, v65, 2, 1
    v_mul_lo_u32 v67, v67, s70
    v_and_b32 v65, 3, v65
    v_mul_lo_u32 v65, v65, s71
    v_add3_u32 v64, v64, v66, v67
    v_add3_u32 v64, v64, v65, s68
    s_add_u32 m0, s95, 0
    s_nop 0
    buffer_load_dwordx4 v64, s[16:19], 0 offen lds
    v_add_u32 v64, 64, v1
    v_mul_u32_u24 v65, 3641, v64
    v_lshrrev_b32 v65, 16, v65
    v_mul_u32_u24 v66, 18, v65
    v_sub_u32 v64, v64, v66
    v_lshlrev_b32 v64, 4, v64
    v_lshrrev_b32 v66, 3, v65
    v_mul_lo_u32 v66, v66, s69
    v_bfe_u32 v67, v65, 2, 1
    v_mul_lo_u32 v67, v67, s70
    v_and_b32 v65, 3, v65
    v_mul_lo_u32 v65, v65, s71
    v_add3_u32 v64, v64, v66, v67
    v_add3_u32 v64, v64, v65, s68
    s_add_u32 m0, s95, 1024
    s_nop 0
    buffer_load_dwordx4 v64, s[16:19], 0 offen lds
    v_add_u32 v64, 128, v1
    v_mul_u32_u24 v65, 3641, v64
    v_lshrrev_b32 v65, 16, v65
    v_mul_u32_u24 v66, 18, v65
    v_sub_u32 v64, v64, v66
    v_lshlrev_b32 v64, 4, v64
    v_lshrrev_b32 v66, 3, v65
    v_mul_lo_u32 v66, v66, s69
    v_bfe_u32 v67, v65, 2, 1
    v_mul_lo_u32 v67, v67, s70
    v_and_b32 v65, 3, v65
    v_mul_lo_u32 v65, v65, s71
    v_add3_u32 v64, v64, v66, v67
    v_add3_u32 v64, v64, v65, s68
    s_add_u32 m0, s95, 2048
    s_nop 0
    buffer_load_dwordx4 v64, s[16:19], 0 offen lds
    v_add_u32 v64, 192, v1
    v_mul_u32_u24 v65, 3641, v64
    v_lshrrev_b32 v65, 16, v65
    v_mul_u32_u24 v66, 18, v65
    v_sub_u32 v64, v64, v66
    v_lshlrev_b32 v64, 4, v64
    v_lshrrev_b32 v66, 3, v65
    v_mul_lo_u32 v66, v66, s69
    v_bfe_u32 v67, v65, 2, 1
    v_mul_lo_u32 v67, v67, s70
    v_and_b32 v65, 3, v65
    v_mul_lo_u32 v65, v65, s71
    v_add3_u32 v64, v64, v66, v67
    v_add3_u32 v64, v64, v65, s68
    s_add_u32 m0, s95, 3072
    s_nop 0
    buffer_load_dwordx4 v64, s[16:19], 0 offen lds
    v_add_u32 v64, 256, v1
    v_mul_u32_u24 v65, 3641, v64
    v_lshrrev_b32 v65, 16, v65
    v_mul_u32_u24 v66, 18, v65
    v_sub_u32 v64, v64, v66
    v_lshlrev_b32 v64, 4, v64
    v_lshrrev_b32 v66, 3, v65
    v_mul_lo_u32 v66, v66, s69
    v_bfe_u32 v67, v65, 2, 1
    v_mul_lo_u32 v67, v67, s70
    v_and_b32 v65, 3, v65
    v_mul_lo_u32 v65, v65, s71
    v_add3_u32 v64, v64, v66, v67
    v_add3_u32 v64, v64, v65, s68
    s_add_u32 m0, s95, 4096
    s_nop 0
    buffer_load_dwordx4 v64, s[16:19], 0 offen lds
    v_add_u32 v64, 320, v1
    v_mul_u32_u24 v65, 3641, v64
    v_lshrrev_b32 v65, 16, v65
    v_mul_u32_u24 v66, 18, v65
    v_sub_u32 v64, v64, v66
    v_lshlrev_b32 v64, 4, v64
    v_lshrrev_b32 v66, 3, v65
    v_mul_lo_u32 v66, v66, s69
    v_bfe_u32 v67, v65, 2, 1
    v_mul_lo_u32 v67, v67, s70
    v_and_b32 v65, 3, v65
    v_mul_lo_u32 v65, v65, s71
    v_add3_u32 v64, v64, v66, v67
    v_add3_u32 v64, v64, v65, s68
    s_add_u32 m0, s95, 5120
    s_nop 0
    buffer_load_dwordx4 v64, s[16:19], 0 offen lds
    v_add_u32 v64, 384, v1
    v_mul_u32_u24 v65, 3641, v64
    v_lshrrev_b32 v65, 16, v65
    v_mul_u32_u24 v66, 18, v65
    v_sub_u32 v64, v64, v66
    v_lshlrev_b32 v64, 4, v64
    v_lshrrev_b32 v66, 3, v65
    v_mul_lo_u32 v66, v66, s69
    v_bfe_u32 v67, v65, 2, 1
    v_mul_lo_u32 v67, v67, s70
    v_and_b32 v65, 3, v65
    v_mul_lo_u32 v65, v65, s71
    v_add3_u32 v64, v64, v66, v67
    v_add3_u32 v64, v64, v65, s68
    s_add_u32 m0, s95, 6144
    s_nop 0
    buffer_load_dwordx4 v64, s[16:19], 0 offen lds
    v_add_u32 v64, 448, v1
    v_mul_u32_u24 v65, 3641, v64
    v_lshrrev_b32 v65, 16, v65
    v_mul_u32_u24 v66, 18, v65
    v_sub_u32 v64, v64, v66
    v_lshlrev_b32 v64, 4, v64
    v_lshrrev_b32 v66, 3, v65
    v_mul_lo_u32 v66, v66, s69
    v_bfe_u32 v67, v65, 2, 1
    v_mul_lo_u32 v67, v67, s70
    v_and_b32 v65, 3, v65
    v_mul_lo_u32 v65, v65, s71
    v_add3_u32 v64, v64, v66, v67
    v_add3_u32 v64, v64, v65, s68
    s_add_u32 m0, s95, 7168
    s_nop 0
    buffer_load_dwordx4 v64, s[16:19], 0 offen lds
    v_add_u32 v64, 512, v1
    v_mul_u32_u24 v65, 3641, v64
    v_lshrrev_b32 v65, 16, v65
    v_mul_u32_u24 v66, 18, v65
    v_sub_u32 v64, v64, v66
    v_lshlrev_b32 v64, 4, v64
    v_lshrrev_b32 v66, 3, v65
    v_mul_lo_u32 v66, v66, s69
    v_bfe_u32 v67, v65, 2, 1
    v_mul_lo_u32 v67, v67, s70
    v_and_b32 v65, 3, v65
    v_mul_lo_u32 v65, v65, s71
    v_add3_u32 v64, v64, v66, v67
    v_add3_u32 v64, v64, v65, s68
    s_add_u32 m0, s95, 8192
    s_nop 0
    buffer_load_dwordx4 v64, s[16:19], 0 offen lds
L_no1_9:
    s_waitcnt vmcnt(11)
    v_lshlrev_b32 v20, 16, v8
    v_and_b32 v21, 0xffff0000, v8
    v_lshlrev_b32 v22, 16, v9
    v_and_b32 v23, 0xffff0000, v9
    v_lshlrev_b32 v24, 16, v10
    v_and_b32 v25, 0xffff0000, v10
    v_lshlrev_b32 v26, 16, v11
    v_and_b32 v27, 0xffff0000, v11
    s_waitcnt vmcnt(10)
    v_lshlrev_b32 v28, 16, v12
    v_and_b32 v29, 0xffff0000, v12
    v_lshlrev_b32 v30, 16, v13
    v_and_b32 v31, 0xffff0000, v13
    v_lshlrev_b32 v32, 16, v14
    v_and_b32 v33, 0xffff0000, v14
    v_lshlrev_b32 v34, 16, v15
    v_and_b32 v35, 0xffff0000, v15
    s_waitcnt vmcnt(9)
    v_lshlrev_b32 v36, 16, v16
    v_and_b32 v37, 0xffff0000, v16
    v_lshlrev_b32 v38, 16, v17
    v_and_b32 v39, 0xffff0000, v17
    v_lshlrev_b32 v40, 16, v18
    v_and_b32 v41, 0xffff0000, v18
    v_lshlrev_b32 v42, 16, v19
    v_and_b32 v43, 0xffff0000, v19
    v_add_f32 v44, v20, v21
    v_add_f32 v64, v22, v23
    v_add_f32 v44, v44, v24
    v_add_f32 v64, v64, v25
    v_add_f32 v44, v44, v26
    v_add_f32 v64, v64, v27
    v_add_f32 v44, v44, v28
    v_add_f32 v64, v64, v29
    v_add_f32 v44, v44, v30
    v_add_f32 v64, v64, v31
    v_add_f32 v44, v44, v32
    v_add_f32 v64, v64, v33
    v_add_f32 v44, v44, v34
    v_add_f32 v64, v64, v35
    v_add_f32 v44, v44, v36
    v_add_f32 v64, v64, v37
    v_add_f32 v44, v44, v38
    v_add_f32 v64, v64, v39
    v_add_f32 v44, v44, v40
    v_add_f32 v64, v64, v41
    v_add_f32 v44, v44, v42
    v_add_f32 v64, v64, v43
    v_add_f32 v44, v44, v64
    s_nop 1
    v_add_f32_dpp v44, v44, v44 row_ror:8 row_mask:0xf bank_mask:0xf
    v_mov_b32 v64, v44
    s_nop 1
    v_permlane16_swap_b32 v44, v64
    v_add_f32 v44, v44, v64
    v_mov_b32 v64, v44
    s_nop 1
    v_permlane32_swap_b32 v44, v64
    v_add_f32 v44, v44, v64
    v_mul_f32 v65, 0x3baaaaab, v44
    v_sub_f32 v64, v20, v65
    v_mul_f32 v45, v64, v64
    v_sub_f32 v67, v21, v65
    v_fmac_f32 v45, v67, v67
    v_sub_f32 v66, v22, v65
    v_fmac_f32 v45, v66, v66
    v_sub_f32 v67, v23, v65
    v_fmac_f32 v45, v67, v67
    v_sub_f32 v66, v24, v65
    v_fmac_f32 v45, v66, v66
    v_sub_f32 v67, v25, v65
    v_fmac_f32 v45, v67, v67
    v_sub_f32 v66, v26, v65
    v_fmac_f32 v45, v66, v66
    v_sub_f32 v67, v27, v65
    v_fmac_f32 v45, v67, v67
    v_sub_f32 v66, v28, v65
    v_fmac_f32 v45, v66, v66
    v_sub_f32 v67, v29, v65
    v_fmac_f32 v45, v67, v67
    v_sub_f32 v66, v30, v65
    v_fmac_f32 v45, v66, v66
    v_sub_f32 v67, v31, v65
    v_fmac_f32 v45, v67, v67
    v_sub_f32 v66, v32, v65
    v_fmac_f32 v45, v66, v66
    v_sub_f32 v67, v33, v65
    v_fmac_f32 v45, v67, v67
    v_sub_f32 v66, v34, v65
    v_fmac_f32 v45, v66, v66
    v_sub_f32 v67, v35, v65
    v_fmac_f32 v45, v67, v67
    v_sub_f32 v66, v36, v65
    v_fmac_f32 v45, v66, v66
    v_sub_f32 v67, v37, v65
    v_fmac_f32 v45, v67, v67
    v_sub_f32 v66, v38, v65
    v_fmac_f32 v45, v66, v66
    v_sub_f32 v67, v39, v65
    v_fmac_f32 v45, v67, v67
    v_sub_f32 v66, v40, v65
    v_fmac_f32 v45, v66, v66
    v_sub_f32 v67, v41, v65
    v_fmac_f32 v45, v67, v67
    v_sub_f32 v66, v42, v65
    v_fmac_f32 v45, v66, v66
    v_sub_f32 v67, v43, v65
    v_fmac_f32 v45, v67, v67
    s_nop 1
    v_add_f32_dpp v45, v45, v45 row_ror:8 row_mask:0xf bank_mask:0xf
    v_mov_b32 v64, v45
    s_nop 1
    v_permlane16_swap_b32 v45, v64
    v_add_f32 v45, v45, v64
    v_mov_b32 v64, v45
    s_nop 1
    v_permlane32_swap_b32 v45, v64
    v_add_f32 v45, v45, v64
    v_and_b32 v64, 7, v1
    s_mul_i32 s46, s20, 64
    v_lshl_add_u32 v64, v64, 3, s46
    ds_write_b64 v64, v[44:45] offset:0
    s_waitcnt lgkmcnt(0)
    s_barrier
    v_and_b32 v64, 7, v1
    v_lshlrev_b32 v64, 3, v64
    ds_read_b64 v[44:45], v64 offset:0
    ds_read_b64 v[46:47], v64 offset:64
    ds_read_b64 v[48:49], v64 offset:128
    s_waitcnt lgkmcnt(1)
    v_add_f32 v64, v44, v46
    s_waitcnt lgkmcnt(0)
    v_add_f32 v64, v64, v48
    v_mul_f32 v64, 0x3ae38e39, v64
    v_add_f32 v65, v45, v47
    v_add_f32 v65, v65, v49
    v_mul_f32 v66, 0x3baaaaab, v44
    v_sub_f32 v66, v66, v64
    v_mul_f32 v66, v66, v66
    v_fmac_f32 v65, 0x43400000, v66
    v_mul_f32 v66, 0x3baaaaab, v46
    v_sub_f32 v66, v66, v64
    v_mul_f32 v66, v66, v66
    v_fmac_f32 v65, 0x43400000, v66
    v_mul_f32 v66, 0x3baaaaab, v48
    v_sub_f32 v66, v66, v64
    v_mul_f32 v66, v66, v66
    v_fmac_f32 v65, 0x43400000, v66
    v_mul_f32 v65, 0x3ae38e39, v65
    v_cvt_pk_bf16_f32 v65, v65, v65
    v_lshlrev_b32 v65, 16, v65
    v_add_f32 v65, 0x3727c5ac, v65
    v_cvt_pk_bf16_f32 v65, v65, v65
    v_lshlrev_b32 v65, 16, v65
    v_sqrt_f32 v65, v65
    s_nop 0
    v_cvt_pk_bf16_f32 v65, v65, v65
    v_lshlrev_b32 v65, 16, v65
    v_rcp_f32 v65, v65
    v_cvt_pk_bf16_f32 v64, v64, v64
    v_lshlrev_b32 v64, 16, v64
    v_sub_f32 v20, v20, v64
    v_sub_f32 v21, v21, v64
    v_cvt_pk_bf16_f32 v66, v20, v21
    v_lshlrev_b32 v20, 16, v66
    v_and_b32 v21, 0xffff0000, v66
    v_mul_f32 v20, v20, v65
    v_mul_f32 v21, v21, v65
    v_cvt_pk_bf16_f32 v52, v20, v21
    v_sub_f32 v22, v22, v64
    v_sub_f32 v23, v23, v64
    v_cvt_pk_bf16_f32 v66, v22, v23
    v_lshlrev_b32 v22, 16, v66
    v_and_b32 v23, 0xffff0000, v66
    v_mul_f32 v22, v22, v65
    v_mul_f32 v23, v23, v65
    v_cvt_pk_bf16_f32 v53, v22, v23
    v_sub_f32 v24, v24, v64
    v_sub_f32 v25, v25, v64
    v_cvt_pk_bf16_f32 v66, v24, v25
    v_lshlrev_b32 v24, 16, v66
    v_and_b32 v25, 0xffff0000, v66
    v_mul_f32 v24, v24, v65
    v_mul_f32 v25, v25, v65
    v_cvt_pk_bf16_f32 v54, v24, v25
    v_sub_f32 v26, v26, v64
    v_sub_f32 v27, v27, v64
    v_cvt_pk_bf16_f32 v66, v26, v27
    v_lshlrev_b32 v26, 16, v66
    v_and_b32 v27, 0xffff0000, v66
    v_mul_f32 v26, v26, v65
    v_mul_f32 v27, v27, v65
    v_cvt_pk_bf16_f32 v55, v26, v27
    v_sub_f32 v28, v28, v64
    v_sub_f32 v29, v29, v64
    v_cvt_pk_bf16_f32 v66, v28, v29
    v_lshlrev_b32 v28, 16, v66
    v_and_b32 v29, 0xffff0000, v66
    v_mul_f32 v28, v28, v65
    v_mul_f32 v29, v29, v65
    v_cvt_pk_bf16_f32 v56, v28, v29
    v_sub_f32 v30, v30, v64
    v_sub_f32 v31, v31, v64
    v_cvt_pk_bf16_f32 v66, v30, v31
    v_lshlrev_b32 v30, 16, v66
    v_and_b32 v31, 0xffff0000, v66
    v_mul_f32 v30, v30, v65
    v_mul_f32 v31, v31, v65
    v_cvt_pk_bf16_f32 v57, v30, v31
    v_sub_f32 v32, v32, v64
    v_sub_f32 v33, v33, v64
    v_cvt_pk_bf16_f32 v66, v32, v33
    v_lshlrev_b32 v32, 16, v66
    v_and_b32 v33, 0xffff0000, v66
    v_mul_f32 v32, v32, v65
    v_mul_f32 v33, v33, v65
    v_cvt_pk_bf16_f32 v58, v32, v33
    v_sub_f32 v34, v34, v64
    v_sub_f32 v35, v35, v64
    v_cvt_pk_bf16_f32 v66, v34, v35
    v_lshlrev_b32 v34, 16, v66
    v_and_b32 v35, 0xffff0000, v66
    v_mul_f32 v34, v34, v65
    v_mul_f32 v35, v35, v65
    v_cvt_pk_bf16_f32 v59, v34, v35
    v_sub_f32 v36, v36, v64
    v_sub_f32 v37, v37, v64
    v_cvt_pk_bf16_f32 v66, v36, v37
    v_lshlrev_b32 v36, 16, v66
    v_and_b32 v37, 0xffff0000, v66
    v_mul_f32 v36, v36, v65
    v_mul_f32 v37, v37, v65
    v_cvt_pk_bf16_f32 v60, v36, v37
    v_sub_f32 v38, v38, v64
    v_sub_f32 v39, v39, v64
    v_cvt_pk_bf16_f32 v66, v38, v39
    v_lshlrev_b32 v38, 16, v66
    v_and_b32 v39, 0xffff0000, v66
    v_mul_f32 v38, v38, v65
    v_mul_f32 v39, v39, v65
    v_cvt_pk_bf16_f32 v61, v38, v39
    v_sub_f32 v40, v40, v64
    v_sub_f32 v41, v41, v64
    v_cvt_pk_bf16_f32 v66, v40, v41
    v_lshlrev_b32 v40, 16, v66
    v_and_b32 v41, 0xffff0000, v66
    v_mul_f32 v40, v40, v65
    v_mul_f32 v41, v41, v65
    v_cvt_pk_bf16_f32 v62, v40, v41
    v_sub_f32 v42, v42, v64
    v_sub_f32 v43, v43, v64
    v_cvt_pk_bf16_f32 v66, v42, v43
    v_lshlrev_b32 v42, 16, v66
    v_and_b32 v43, 0xffff0000, v66
    v_mul_f32 v42, v42, v65
    v_mul_f32 v43, v43, v65
    v_cvt_pk_bf16_f32 v63, v42, v43
    s_cmp_eq_u32 s20, 3
    s_cbranch_scc1 L_noln_1
    s_mov_b32 s46, 20971520
    buffer_store_dwordx4 v[52:55], v4, s[4:7], s46 offen offset:0
    buffer_store_dwordx4 v[56:59], v4, s[4:7], s46 offen offset:2048
    s_add_u32 s46, s46, 4096
    buffer_store_dwordx4 v[60:63], v4, s[4:7], s46 offen offset:0
L_noln_1:
    v_lshrrev_b32 v64, 4, v1
    v_bfe_u32 v66, v1, 2, 2
    v_lshl_add_u32 v64, v64, 3, v66
    v_mul_u32_u24 v64, 288, v64
    v_add_u32 v64, s94, v64
    v_and_b32 v66, 3, v1
    v_lshl_add_u32 v65, v66, 3, v64
    v_add_u32 v65, s55, v65
    v_lshl_add_u32 v64, v66, 4, v64
    v_add_u32 v64, s54, v64
    s_waitcnt vmcnt(0)
    ds_read_b64_tr_b16 v[72:73], v64 offset:0
    ds_read_b64_tr_b16 v[74:75], v64 offset:1152
    ds_read_b64_tr_b16 v[76:77], v64 offset:8
    ds_read_b64_tr_b16 v[78:79], v64 offset:1160
    ds_read_b64_tr_b16 v[80:81], v64 offset:64
    ds_read_b64_tr_b16 v[82:83], v64 offset:1216
    ds_read_b64_tr_b16 v[84:85], v64 offset:72
    ds_read_b64_tr_b16 v[86:87], v64 offset:1224
    ds_read_b64_tr_b16 v[88:89], v64 offset:128
    ds_read_b64_tr_b16 v[90:91], v64 offset:1280
    ds_read_b64_tr_b16 v[92:93], v64 offset:136
    ds_read_b64_tr_b16 v[94:95], v64 offset:1288
    ds_read_b64_tr_b16 v[96:97], v64 offset:192
    ds_read_b64_tr_b16 v[98:99], v64 offset:1344
    ds_read_b64_tr_b16 v[100:101], v64 offset:200
    ds_read_b64_tr_b16 v[102:103], v64 offset:1352
    ds_read_b64_tr_b16 v[104:105], v65 offset:0
    ds_read_b64_tr_b16 v[106:107], v65 offset:1152
    s_waitcnt lgkmcnt(15)
    buffer_store_dwordx4 v[72:75], v2, s[4:7], s58 offen
    s_waitcnt lgkmcnt(14)
    buffer_store_dwordx4 v[76:79], v2, s[4:7], s59 offen
    s_waitcnt lgkmcnt(12)
    buffer_store_dwordx4 v[80:83], v2, s[4:7], s60 offen
    s_waitcnt lgkmcnt(10)
    buffer_store_dwordx4 v[84:87], v2, s[4:7], s61 offen
    s_waitcnt lgkmcnt(8)
    buffer_store_dwordx4 v[88:91], v2, s[4:7], s62 offen
    s_waitcnt lgkmcnt(6)
    buffer_store_dwordx4 v[92:95], v2, s[4:7], s63 offen
    s_waitcnt lgkmcnt(4)
    buffer_store_dwordx4 v[96:99], v2, s[4:7], s64 offen
    s_waitcnt lgkmcnt(2)
    buffer_store_dwordx4 v[100:103], v2, s[4:7], s65 offen
    s_waitcnt lgkmcnt(0)
    buffer_store_dwordx4 v[104:107], v2, s[4:7], s66 offen
    s_cmp_eq_u32 s57, 0
    s_cbranch_scc1 L_nocs_17
    v_mov_b32 v68, 0x3f803f80
    v_mov_b32 v69, 0x3f803f80
    v_mov_b32 v70, 0x3f803f80
    v_mov_b32 v71, 0x3f803f80
    s_nop 1
    v_mfma_f32_16x16x32_bf16 v[108:111], v[72:75], v[68:71], 0
    v_mfma_f32_16x16x32_bf16 v[112:115], v[76:79], v[68:71], 0
    v_mfma_f32_16x16x32_bf16 v[116:119], v[80:83], v[68:71], 0
    v_mfma_f32_16x16x32_bf16 v[120:123], v[84:87], v[68:71], 0
    v_mfma_f32_16x16x32_bf16 v[124:127], v[88:91], v[68:71], 0
    v_mfma_f32_16x16x32_bf16 v[128:131], v[92:95], v[68:71], 0
    v_mfma_f32_16x16x32_bf16 v[132:135], v[96:99], v[68:71], 0
    v_mfma_f32_16x16x32_bf16 v[136:139], v[100:103], v[68:71], 0
    v_mfma_f32_16x16x32_bf16 v[140:143], v[104:107], v[68:71], 0
    v_and_b32 v66, 15, v1
    v_cmp_eq_u32 vcc, 0, v66
    s_nop 0
    s_and_saveexec_b64 s[44:45], vcc
    buffer_store_dwordx4 v[108:111], v1, s[4:7], s57 offen offset:64
    buffer_store_dwordx4 v[112:115], v1, s[4:7], s57 offen offset:128
    buffer_store_dwordx4 v[116:119], v1, s[4:7], s57 offen offset:192
    buffer_store_dwordx4 v[120:123], v1, s[4:7], s57 offen offset:256
    buffer_store_dwordx4 v[124:127], v1, s[4:7], s57 offen offset:320
    buffer_store_dwordx4 v[128:131], v1, s[4:7], s57 offen offset:384
    buffer_store_dwordx4 v[132:135], v1, s[4:7], s57 offen offset:448
    buffer_store_dwordx4 v[136:139], v1, s[4:7], s57 offen offset:512
    buffer_store_dwordx4 v[140:143], v1, s[4:7], s57 offen offset:0
    s_mov_b64 exec, s[44:45]
L_nocs_17:
    s_cmp_ge_u32 s96, 1728
    s_cbranch_scc1 L_no2_18
    s_waitcnt vmcnt(0) lgkmcnt(0)
    v_lshrrev_b32 v64, 4, v1
    v_bfe_u32 v66, v1, 2, 2
    v_lshl_add_u32 v64, v64, 3, v66
    v_mul_u32_u24 v64, 288, v64
    v_add_u32 v64, s95, v64
    v_and_b32 v66, 3, v1
    v_lshl_add_u32 v65, v66, 3, v64
    v_add_u32 v65, s73, v65
    v_lshl_add_u32 v64, v66, 4, v64
    v_add_u32 v64, s72, v64
    ds_read_b64_tr_b16 v[72:73], v64 offset:0
    ds_read_b64_tr_b16 v[74:75], v64 offset:1152
    ds_read_b64_tr_b16 v[76:77], v64 offset:8
    ds_read_b64_tr_b16 v[78:79], v64 offset:1160
    ds_read_b64_tr_b16 v[80:81], v64 offset:64
    ds_read_b64_tr_b16 v[82:83], v64 offset:1216
    ds_read_b64_tr_b16 v[84:85], v64 offset:72
    ds_read_b64_tr_b16 v[86:87], v64 offset:1224
    ds_read_b64_tr_b16 v[88:89], v64 offset:128
    ds_read_b64_tr_b16 v[90:91], v64 offset:1280
    ds_read_b64_tr_b16 v[92:93], v64 offset:136
    ds_read_b64_tr_b16 v[94:95], v64 offset:1288
    ds_read_b64_tr_b16 v[96:97], v64 offset:192
    ds_read_b64_tr_b16 v[98:99], v64 offset:1344
    ds_read_b64_tr_b16 v[100:101], v64 offset:200
    ds_read_b64_tr_b16 v[102:103], v64 offset:1352
    ds_read_b64_tr_b16 v[104:105], v65 offset:0
    ds_read_b64_tr_b16 v[106:107], v65 offset:1152
    s_waitcnt lgkmcnt(15)
    buffer_store_dwordx4 v[72:75], v2, s[4:7], s76 offen
    s_waitcnt lgkmcnt(14)
    buffer_store_dwordx4 v[76:79], v2, s[4:7], s77 offen
    s_waitcnt lgkmcnt(12)
    buffer_store_dwordx4 v[80:83], v2, s[4:7], s78 offen
    s_waitcnt lgkmcnt(10)
    buffer_store_dwordx4 v[84:87], v2, s[4:7], s79 offen
    s_waitcnt lgkmcnt(8)
    buffer_store_dwordx4 v[88:91], v2, s[4:7], s80 offen
    s_waitcnt lgkmcnt(6)
    buffer_store_dwordx4 v[92:95], v2, s[4:7], s81 offen
    s_waitcnt lgkmcnt(4)
    buffer_store_dwordx4 v[96:99], v2, s[4:7], s82 offen
    s_waitcnt lgkmcnt(2)
    buffer_store_dwordx4 v[100:103], v2, s[4:7], s83 offen
    s_waitcnt lgkmcnt(0)
    buffer_store_dwordx4 v[104:107], v2, s[4:7], s84 offen
    s_cmp_eq_u32 s75, 0
    s_cbranch_scc1 L_nocs_20
    v_mov_b32 v68, 0x3f803f80
    v_mov_b32 v69, 0x3f803f80
    v_mov_b32 v70, 0x3f803f80
    v_mov_b32 v71, 0x3f803f80
    s_nop 1
    v_mfma_f32_16x16x32_bf16 v[108:111], v[72:75], v[68:71], 0
    v_mfma_f32_16x16x32_bf16 v[112:115], v[76:79], v[68:71], 0
    v_mfma_f32_16x16x32_bf16 v[116:119], v[80:83], v[68:71], 0
    v_mfma_f32_16x16x32_bf16 v[120:123], v[84:87], v[68:71], 0
    v_mfma_f32_16x16x32_bf16 v[124:127], v[88:91], v[68:71], 0
    v_mfma_f32_16x16x32_bf16 v[128:131], v[92:95], v[68:71], 0
    v_mfma_f32_16x16x32_bf16 v[132:135], v[96:99], v[68:71], 0
    v_mfma_f32_16x16x32_bf16 v[136:139], v[100:103], v[68:71], 0
    v_mfma_f32_16x16x32_bf16 v[140:143], v[104:107], v[68:71], 0
    v_and_b32 v66, 15, v1
    v_cmp_eq_u32 vcc, 0, v66
    s_nop 0
    s_and_saveexec_b64 s[44:45], vcc
    buffer_store_dwordx4 v[108:111], v1, s[4:7], s75 offen offset:64
    buffer_store_dwordx4 v[112:115], v1, s[4:7], s75 offen offset:128
    buffer_store_dwordx4 v[116:119], v1, s[4:7], s75 offen offset:192
    buffer_store_dwordx4 v[120:123], v1, s[4:7], s75 offen offset:256
    buffer_store_dwordx4 v[124:127], v1, s[4:7], s75 offen offset:320
    buffer_store_dwordx4 v[128:131], v1, s[4:7], s75 offen offset:384
    buffer_store_dwordx4 v[132:135], v1, s[4:7], s75 offen offset:448
    buffer_store_dwordx4 v[136:139], v1, s[4:7], s75 offen offset:512
    buffer_store_dwordx4 v[140:143], v1, s[4:7], s75 offen offset:0
    s_mov_b64 exec, s[44:45]
L_nocs_20:
L_no2_18:
    s_waitcnt vmcnt(0) lgkmcnt(0)
    s_cmp_lt_u32 s23, 628
    s_cbranch_scc1 prep_kernel_end
    s_sub_u32 s23, s23, 628
    s_cmp_ge_u32 s23, 288
    s_cbranch_scc1 L_wo_21
    s_mul_i32 s86, s23, 3641
    s_lshr_b32 s86, s86, 16
    s_mul_i32 s87, s86, 18
    s_sub_u32 s87, s23, s87
    s_mul_i32 s88, s86, 72
    s_and_b32 s89, s88, 8
    s_and_b32 s88, s88, -16
    s_mul_i32 s90, s87, 110592
    s_add_u32 s88, s88, s90
    s_mov_b32 s90, 27648
    s_mov_b32 s91, 13824
    s_mov_b32 s92, 3456
    s_mul_i32 s93, s23, 7168
    s_mov_b32 s12, s26
    s_mov_b32 s13, s27
    s_mov_b32 s14, 0x1e6000
    s_mov_b32 s15, 0x20000
    v_add_u32 v64, 0, v1
    v_mul_u32_u24 v65, 4370, v64
    v_lshrrev_b32 v65, 16, v65
    v_mul_u32_u24 v66, 15, v65
    v_sub_u32 v64, v64, v66
    v_mul_u32_u24 v66, 13108, v64
    v_lshrrev_b32 v66, 16, v66
    v_mul_u32_u24 v66, 1072, v66
    v_lshl_add_u32 v64, v64, 4, v66
    v_lshrrev_b32 v66, 3, v65
    v_mul_lo_u32 v66, v66, s90
    v_bfe_u32 v67, v65, 2, 1
    v_mul_lo_u32 v67, v67, s91
    v_and_b32 v65, 3, v65
    v_mul_lo_u32 v65, v65, s92
    v_add3_u32 v64, v64, v66, v67
    v_add3_u32 v64, v64, v65, s88
    s_add_u32 m0, s94, 0
    s_nop 0
    buffer_load_dwordx4 v64, s[12:15], 0 offen lds
    v_add_u32 v64, 64, v1
    v_mul_u32_u24 v65, 4370, v64
    v_lshrrev_b32 v65, 16, v65
    v_mul_u32_u24 v66, 15, v65
    v_sub_u32 v64, v64, v66
    v_mul_u32_u24 v66, 13108, v64
    v_lshrrev_b32 v66, 16, v66
    v_mul_u32_u24 v66, 1072, v66
    v_lshl_add_u32 v64, v64, 4, v66
    v_lshrrev_b32 v66, 3, v65
    v_mul_lo_u32 v66, v66, s90
    v_bfe_u32 v67, v65, 2, 1
    v_mul_lo_u32 v67, v67, s91
    v_and_b32 v65, 3, v65
    v_mul_lo_u32 v65, v65, s92
    v_add3_u32 v64, v64, v66, v67
    v_add3_u32 v64, v64, v65, s88
    s_add_u32 m0, s94, 1024
    s_nop 0
    buffer_load_dwordx4 v64, s[12:15], 0 offen lds
    v_add_u32 v64, 128, v1
    v_mul_u32_u24 v65, 4370, v64
    v_lshrrev_b32 v65, 16, v65
    v_mul_u32_u24 v66, 15, v65
    v_sub_u32 v64, v64, v66
    v_mul_u32_u24 v66, 13108, v64
    v_lshrrev_b32 v66, 16, v66
    v_mul_u32_u24 v66, 1072, v66
    v_lshl_add_u32 v64, v64, 4, v66
    v_lshrrev_b32 v66, 3, v65
    v_mul_lo_u32 v66, v66, s90
    v_bfe_u32 v67, v65, 2, 1
    v_mul_lo_u32 v67, v67, s91
    v_and_b32 v65, 3, v65
    v_mul_lo_u32 v65, v65, s92
    v_add3_u32 v64, v64, v66, v67
    v_add3_u32 v64, v64, v65, s88
    s_add_u32 m0, s94, 2048
    s_nop 0
    buffer_load_dwordx4 v64, s[12:15], 0 offen lds
    v_add_u32 v64, 192, v1
    v_mul_u32_u24 v65, 4370, v64
    v_lshrrev_b32 v65, 16, v65
    v_mul_u32_u24 v66, 15, v65
    v_sub_u32 v64, v64, v66
    v_mul_u32_u24 v66, 13108, v64
    v_lshrrev_b32 v66, 16, v66
    v_mul_u32_u24 v66, 1072, v66
    v_lshl_add_u32 v64, v64, 4, v66
    v_lshrrev_b32 v66, 3, v65
    v_mul_lo_u32 v66, v66, s90
    v_bfe_u32 v67, v65, 2, 1
    v_mul_lo_u32 v67, v67, s91
    v_and_b32 v65, 3, v65
    v_mul_lo_u32 v65, v65, s92
    v_add3_u32 v64, v64, v66, v67
    v_add3_u32 v64, v64, v65, s88
    s_add_u32 m0, s94, 3072
    s_nop 0
    buffer_load_dwordx4 v64, s[12:15], 0 offen lds
    v_add_u32 v64, 256, v1
    v_mul_u32_u24 v65, 4370, v64
    v_lshrrev_b32 v65, 16, v65
    v_mul_u32_u24 v66, 15, v65
    v_sub_u32 v64, v64, v66
    v_mul_u32_u24 v66, 13108, v64
    v_lshrrev_b32 v66, 16, v66
    v_mul_u32_u24 v66, 1072, v66
    v_lshl_add_u32 v64, v64, 4, v66
    v_lshrrev_b32 v66, 3, v65
    v_mul_lo_u32 v66, v66, s90
    v_bfe_u32 v67, v65, 2, 1
    v_mul_lo_u32 v67, v67, s91
    v_and_b32 v65, 3, v65
    v_mul_lo_u32 v65, v65, s92
    v_add3_u32 v64, v64, v66, v67
    v_add3_u32 v64, v64, v65, s88
    s_add_u32 m0, s94, 4096
    s_nop 0
    buffer_load_dwordx4 v64, s[12:15], 0 offen lds
    v_add_u32 v64, 320, v1
    v_mul_u32_u24 v65, 4370, v64
    v_lshrrev_b32 v65, 16, v65
    v_mul_u32_u24 v66, 15, v65
    v_sub_u32 v64, v64, v66
    v_mul_u32_u24 v66, 13108, v64
    v_lshrrev_b32 v66, 16, v66
    v_mul_u32_u24 v66, 1072, v66
    v_lshl_add_u32 v64, v64, 4, v66
    v_lshrrev_b32 v66, 3, v65
    v_mul_lo_u32 v66, v66, s90
    v_bfe_u32 v67, v65, 2, 1
    v_mul_lo_u32 v67, v67, s91
    v_and_b32 v65, 3, v65
    v_mul_lo_u32 v65, v65, s92
    v_add3_u32 v64, v64, v66, v67
    v_add3_u32 v64, v64, v65, s88
    s_add_u32 m0, s94, 5120
    s_nop 0
    buffer_load_dwordx4 v64, s[12:15], 0 offen lds
    v_add_u32 v64, 384, v1
    v_mul_u32_u24 v65, 4370, v64
    v_lshrrev_b32 v65, 16, v65
    v_mul_u32_u24 v66, 15, v65
    v_sub_u32 v64, v64, v66
    v_mul_u32_u24 v66, 13108, v64
    v_lshrrev_b32 v66, 16, v66
    v_mul_u32_u24 v66, 1072, v66
    v_lshl_add_u32 v64, v64, 4, v66
    v_lshrrev_b32 v66, 3, v65
    v_mul_lo_u32 v66, v66, s90
    v_bfe_u32 v67, v65, 2, 1
    v_mul_lo_u32 v67, v67, s91
    v_and_b32 v65, 3, v65
    v_mul_lo_u32 v65, v65, s92
    v_add3_u32 v64, v64, v66, v67
    v_add3_u32 v64, v64, v65, s88
    s_add_u32 m0, s94, 6144
    s_nop 0
    buffer_load_dwordx4 v64, s[12:15], 0 offen lds
    v_add_u32 v64, 448, v1
    v_mul_u32_u24 v65, 4370, v64
    v_lshrrev_b32 v65, 16, v65
    v_mul_u32_u24 v66, 15, v65
    v_sub_u32 v64, v64, v66
    v_mul_u32_u24 v66, 13108, v64
    v_lshrrev_b32 v66, 16, v66
    v_mul_u32_u24 v66, 1072, v66
    v_lshl_add_u32 v64, v64, 4, v66
    v_lshrrev_b32 v66, 3, v65
    v_mul_lo_u32 v66, v66, s90
    v_bfe_u32 v67, v65, 2, 1
    v_mul_lo_u32 v67, v67, s91
    v_and_b32 v65, 3, v65
    v_mul_lo_u32 v65, v65, s92
    v_add3_u32 v64, v64, v66, v67
    v_add3_u32 v64, v64, v65, s88
    s_add_u32 m0, s94, 7168
    s_nop 0
    buffer_load_dwordx4 v64, s[12:15], 0 offen lds
    v_lshrrev_b32 v64, 4, v1
    v_bfe_u32 v66, v1, 2, 2
    v_lshl_add_u32 v64, v64, 3, v66
    v_mul_u32_u24 v64, 240, v64
    v_add_u32 v64, s94, v64
    v_and_b32 v66, 3, v1
    v_add_u32 v64, s89, v64
    v_and_b32 v67, 1, v66
    v_mul_u32_u24 v67, 160, v67
    v_lshrrev_b32 v65, 1, v66
    v_mul_u32_u24 v65, 80, v65
    v_add3_u32 v65, v65, v67, v64
    v_cmp_eq_u32 vcc, 3, v66
    s_nop 1
    v_cndmask_b32 v65, v65, v64, vcc
    v_lshl_add_u32 v64, v66, 3, v64
    s_waitcnt vmcnt(0)
    ds_read_b64_tr_b16 v[72:73], v64 offset:0
    ds_read_b64_tr_b16 v[74:75], v64 offset:960
    ds_read_b64_tr_b16 v[76:77], v64 offset:40
    ds_read_b64_tr_b16 v[78:79], v64 offset:1000
    ds_read_b64_tr_b16 v[80:81], v64 offset:80
    ds_read_b64_tr_b16 v[82:83], v64 offset:1040
    ds_read_b64_tr_b16 v[84:85], v64 offset:120
    ds_read_b64_tr_b16 v[86:87], v64 offset:1080
    ds_read_b64_tr_b16 v[88:89], v64 offset:160
    ds_read_b64_tr_b16 v[90:91], v64 offset:1120
    ds_read_b64_tr_b16 v[92:93], v64 offset:200
    ds_read_b64_tr_b16 v[94:95], v64 offset:1160
    ds_read_b64_tr_b16 v[96:97], v65 offset:32
    ds_read_b64_tr_b16 v[98:99], v65 offset:992
    v_and_b32 v66, 15, v1
    v_cmp_gt_u32 vcc, 12, v66
    s_waitcnt lgkmcnt(1)
    s_nop 0
    v_cndmask_b32 v96, 0, v96, vcc
    v_cndmask_b32 v97, 0, v97, vcc
    s_waitcnt lgkmcnt(0)
    v_cndmask_b32 v98, 0, v98, vcc
    v_cndmask_b32 v99, 0, v99, vcc
    s_add_u32 s93, s93, 0
    buffer_store_dwordx4 v[72:75], v2, s[4:7], s93 offen offset:0
    buffer_store_dwordx4 v[76:79], v2, s[4:7], s93 offen offset:1024
    buffer_store_dwordx4 v[80:83], v2, s[4:7], s93 offen offset:2048
    buffer_store_dwordx4 v[84:87], v2, s[4:7], s93 offen offset:3072
    s_add_u32 s93, s93, 4096
    buffer_store_dwordx4 v[88:91], v2, s[4:7], s93 offen offset:0
    buffer_store_dwordx4 v[92:95], v2, s[4:7], s93 offen offset:1024
    buffer_store_dwordx4 v[96:99], v2, s[4:7], s93 offen offset:2048
    s_waitcnt vmcnt(0) lgkmcnt(0)
    s_branch prep_kernel_end
L_wo_21:
    s_sub_u32 s23, s23, 288
    s_mul_i32 s86, s23, 3641
    s_lshr_b32 s86, s86, 16
    s_mul_i32 s87, s86, 18
    s_sub_u32 s87, s23, s87
    s_mul_i32 s88, s87, 41472
    s_sub_u32 s89, s87, 16
    s_mul_i32 s89, s89, 331776
    s_add_u32 s89, s89, 18432
    s_cmp_lt_u32 s87, 16
    s_cselect_b32 s88, s88, s89
    s_mov_b32 s90, 82944
    s_mov_b32 s91, 41472
    s_cselect_b32 s90, 4608, s90
    s_cselect_b32 s91, 23040, s91
    s_mul_i32 s89, s86, 192
    s_add_u32 s88, s88, s89
    s_mov_b32 s92, 1152
    s_mul_i32 s93, s23, 6144
    s_mov_b32 s12, s28
    s_mov_b32 s13, s29
    s_mov_b32 s14, 0xa2000
    s_mov_b32 s15, 0x20000
    v_add_u32 v64, 0, v1
    v_mul_u32_u24 v65, 5462, v64
    v_lshrrev_b32 v65, 16, v65
    v_mul_u32_u24 v66, 12, v65
    v_sub_u32 v64, v64, v66
    v_lshlrev_b32 v64, 4, v64
    v_lshrrev_b32 v66, 3, v65
    v_mul_lo_u32 v66, v66, s90
    v_bfe_u32 v67, v65, 2, 1
    v_mul_lo_u32 v67, v67, s91
    v_and_b32 v65, 3, v65
    v_mul_lo_u32 v65, v65, s92
    v_add3_u32 v64, v64, v66, v67
    v_add3_u32 v64, v64, v65, s88
    s_add_u32 m0, s94, 0
    s_nop 0
    buffer_load_dwordx4 v64, s[12:15], 0 offen lds
    v_add_u32 v64, 64, v1
    v_mul_u32_u24 v65, 5462, v64
    v_lshrrev_b32 v65, 16, v65
    v_mul_u32_u24 v66, 12, v65
    v_sub_u32 v64, v64, v66
    v_lshlrev_b32 v64, 4, v64
    v_lshrrev_b32 v66, 3, v65
    v_mul_lo_u32 v66, v66, s90
    v_bfe_u32 v67, v65, 2, 1
    v_mul_lo_u32 v67, v67, s91
    v_and_b32 v65, 3, v65
    v_mul_lo_u32 v65, v65, s92
    v_add3_u32 v64, v64, v66, v67
    v_add3_u32 v64, v64, v65, s88
    s_add_u32 m0, s94, 1024
    s_nop 0
    buffer_load_dwordx4 v64, s[12:15], 0 offen lds
    v_add_u32 v64, 128, v1
    v_mul_u32_u24 v65, 5462, v64
    v_lshrrev_b32 v65, 16, v65
    v_mul_u32_u24 v66, 12, v65
    v_sub_u32 v64, v64, v66
    v_lshlrev_b32 v64, 4, v64
    v_lshrrev_b32 v66, 3, v65
    v_mul_lo_u32 v66, v66, s90
    v_bfe_u32 v67, v65, 2, 1
    v_mul_lo_u32 v67, v67, s91
    v_and_b32 v65, 3, v65
    v_mul_lo_u32 v65, v65, s92
    v_add3_u32 v64, v64, v66, v67
    v_add3_u32 v64, v64, v65, s88
    s_add_u32 m0, s94, 2048
    s_nop 0
    buffer_load_dwordx4 v64, s[12:15], 0 offen lds
    v_add_u32 v64, 192, v1
    v_mul_u32_u24 v65, 5462, v64
    v_lshrrev_b32 v65, 16, v65
    v_mul_u32_u24 v66, 12, v65
    v_sub_u32 v64, v64, v66
    v_lshlrev_b32 v64, 4, v64
    v_lshrrev_b32 v66, 3, v65
    v_mul_lo_u32 v66, v66, s90
    v_bfe_u32 v67, v65, 2, 1
    v_mul_lo_u32 v67, v67, s91
    v_and_b32 v65, 3, v65
    v_mul_lo_u32 v65, v65, s92
    v_add3_u32 v64, v64, v66, v67
    v_add3_u32 v64, v64, v65, s88
    s_add_u32 m0, s94, 3072
    s_nop 0
    buffer_load_dwordx4 v64, s[12:15], 0 offen lds
    v_add_u32 v64, 256, v1
    v_mul_u32_u24 v65, 5462, v64
    v_lshrrev_b32 v65, 16, v65
    v_mul_u32_u24 v66, 12, v65
    v_sub_u32 v64, v64, v66
    v_lshlrev_b32 v64, 4, v64
    v_lshrrev_b32 v66, 3, v65
    v_mul_lo_u32 v66, v66, s90
    v_bfe_u32 v67, v65, 2, 1
    v_mul_lo_u32 v67, v67, s91
    v_and_b32 v65, 3, v65
    v_mul_lo_u32 v65, v65, s92
    v_add3_u32 v64, v64, v66, v67
    v_add3_u32 v64, v64, v65, s88
    s_add_u32 m0, s94, 4096
    s_nop 0
    buffer_load_dwordx4 v64, s[12:15], 0 offen lds
    v_add_u32 v64, 320, v1
    v_mul_u32_u24 v65, 5462, v64
    v_lshrrev_b32 v65, 16, v65
    v_mul_u32_u24 v66, 12, v65
    v_sub_u32 v64, v64, v66
    v_lshlrev_b32 v64, 4, v64
    v_lshrrev_b32 v66, 3, v65
    v_mul_lo_u32 v66, v66, s90
    v_bfe_u32 v67, v65, 2, 1
    v_mul_lo_u32 v67, v67, s91
    v_and_b32 v65, 3, v65
    v_mul_lo_u32 v65, v65, s92
    v_add3_u32 v64, v64, v66, v67
    v_add3_u32 v64, v64, v65, s88
    s_add_u32 m0, s94, 5120
    s_nop 0
    buffer_load_dwordx4 v64, s[12:15], 0 offen lds
    v_lshrrev_b32 v64, 4, v1
    v_bfe_u32 v66, v1, 2, 2
    v_lshl_add_u32 v64, v64, 3, v66
    v_mul_u32_u24 v64, 192, v64
    v_add_u32 v64, s94, v64
    v_and_b32 v66, 3, v1
    v_lshl_add_u32 v64, v66, 4, v64
    s_waitcnt vmcnt(0)
    ds_read_b64_tr_b16 v[72:73], v64 offset:0
    ds_read_b64_tr_b16 v[74:75], v64 offset:768
    ds_read_b64_tr_b16 v[76:77], v64 offset:8
    ds_read_b64_tr_b16 v[78:79], v64 offset:776
    ds_read_b64_tr_b16 v[80:81], v64 offset:64
    ds_read_b64_tr_b16 v[82:83], v64 offset:832
    ds_read_b64_tr_b16 v[84:85], v64 offset:72
    ds_read_b64_tr_b16 v[86:87], v64 offset:840
    ds_read_b64_tr_b16 v[88:89], v64 offset:128
    ds_read_b64_tr_b16 v[90:91], v64 offset:896
    ds_read_b64_tr_b16 v[92:93], v64 offset:136
    ds_read_b64_tr_b16 v[94:95], v64 offset:904
    s_add_u32 s93, s93, 2097152
    s_waitcnt lgkmcnt(10)
    buffer_store_dwordx4 v[72:75], v2, s[4:7], s93 offen offset:0
    s_waitcnt lgkmcnt(8)
    buffer_store_dwordx4 v[76:79], v2, s[4:7], s93 offen offset:1024
    s_waitcnt lgkmcnt(6)
    buffer_store_dwordx4 v[80:83], v2, s[4:7], s93 offen offset:2048
    s_waitcnt lgkmcnt(4)
    buffer_store_dwordx4 v[84:87], v2, s[4:7], s93 offen offset:3072
    s_add_u32 s93, s93, 4096
    s_waitcnt lgkmcnt(2)
    buffer_store_dwordx4 v[88:91], v2, s[4:7], s93 offen offset:0
    s_waitcnt lgkmcnt(0)
    buffer_store_dwordx4 v[92:95], v2, s[4:7], s93 offen offset:1024
    s_waitcnt vmcnt(0) lgkmcnt(0)
prep_kernel_end:
    s_endpgm
.section .rodata,"a"
.p2align 6
.amdhsa_kernel prep_kernel
  .amdhsa_next_free_vgpr 152
  .amdhsa_next_free_sgpr 102
  .amdhsa_accum_offset 152
  .amdhsa_group_segment_fixed_size 0
  .amdhsa_kernarg_size 80
  .amdhsa_user_sgpr_count 2
  .amdhsa_user_sgpr_kernarg_segment_ptr 1
  .amdhsa_system_sgpr_workgroup_id_x 1
  .amdhsa_float_denorm_mode_32 3
.end_amdhsa_kernel
.text
.globl qkv0_kernel
.p2align 8
.type qkv0_kernel,@function
qkv0_kernel:
    s_cmp_ge_u32 s2, 256
    s_cbranch_scc1 qkv0_kernel_end
    s_load_dwordx16 s[24:39], s[0:1], 0
    s_load_dwordx4 s[40:43], s[0:1], 64
    v_lshrrev_b32 v1, 6, v0
    s_and_b32 s21, s2, 7
    v_readfirstlane_b32 s20, v1
    s_lshr_b32 s22, s2, 3
    v_and_b32 v1, 63, v0
    v_lshlrev_b32 v2, 4, v1
    s_waitcnt lgkmcnt(0)
    s_mov_b32 s4, s42
    s_mov_b32 s5, s43
    s_mov_b32 s6, 0x10000000
    s_mov_b32 s7, 0x20000
    s_lshr_b32 s44, s22, 4
    s_lshl_b32 s52, s21, 1
    s_add_u32 s44, s44, s52
    s_and_b32 s45, s22, 15
    s_lshl_b32 s46, s44, 3
    s_mul_i32 s47, s45, 129024
    s_lshl_b32 s50, s20, 11
    s_add_u32 s47, s47, s50
    s_add_u32 s47, s47, 0
    s_add_u32 s48, s47, 1024
    s_max_u32 s52, s46, 1
    s_sub_u32 s52, s52, 1
    s_mul_i32 s52, s52, 18432
    s_add_u32 s52, s52, 20971520
    s_cmp_eq_u32 s20, 3
    s_cselect_b32 s48, s52, s48
    s_mov_b32 s49, 7168
    s_cselect_b32 s49, 1024, s49
    s_lshl_b32 s52, s20, 1
    s_add_u32 s46, s46, s52
    s_mul_i32 s51, s46, 18432
    s_add_u32 s51, s51, 20971520
    s_mov_b32 m0, s50
    s_nop 0
    buffer_load_dwordx4 v2, s[4:7], s47 offen lds
    s_add_u32 m0, s50, 1024
    s_nop 0
    buffer_load_dwordx4 v2, s[4:7], s48 offen lds
    s_add_u32 s50, s50, 8192
    s_add_u32 s47, s47, 7168
    s_add_u32 s48, s48, s49
    s_add_u32 s52, s51, 0
    buffer_load_dwordx4 a[0:3], v2, s[4:7], s52 offen
    s_add_u32 s52, s51, 18432
    buffer_load_dwordx4 a[72:75], v2, s[4:7], s52 offen
    s_mov_b32 m0, s50
    s_nop 0
    buffer_load_dwordx4 v2, s[4:7], s47 offen lds
    s_add_u32 m0, s50, 1024
    s_nop 0
    buffer_load_dwordx4 v2, s[4:7], s48 offen lds
    s_add_u32 s50, s50, 8192
    s_add_u32 s47, s47, 7168
    s_add_u32 s48, s48, s49
    s_add_u32 s52, s51, 1024
    buffer_load_dwordx4 a[4:7], v2, s[4:7], s52 offen
    s_add_u32 s52, s51, 19456
    buffer_load_dwordx4 a[76:79], v2, s[4:7], s52 offen
    s_mov_b32 m0, s50
    s_nop 0
    buffer_load_dwordx4 v2, s[4:7], s47 offen lds
    s_add_u32 m0, s50, 1024
    s_nop 0
    buffer_load_dwordx4 v2, s[4:7], s48 offen lds
    s_add_u32 s50, s50, 8192
    s_add_u32 s47, s47, 7168
    s_add_u32 s48, s48, s49
    s_add_u32 s52, s51, 2048
    buffer_load_dwordx4 a[8:11], v2, s[4:7], s52 offen
    s_add_u32 s52, s51, 20480
    buffer_load_dwordx4 a[80:83], v2, s[4:7], s52 offen
    s_mov_b32 m0, s50
    s_nop 0
    buffer_load_dwordx4 v2, s[4:7], s47 offen lds
    s_add_u32 m0, s50, 1024
    s_nop 0
    buffer_load_dwordx4 v2, s[4:7], s48 offen lds
    s_add_u32 s50, s50, 8192
    s_add_u32 s47, s47, 7168
    s_add_u32 s48, s48, s49
    s_add_u32 s52, s51, 3072
    buffer_load_dwordx4 a[12:15], v2, s[4:7], s52 offen
    s_add_u32 s52, s51, 21504
    buffer_load_dwordx4 a[84:87], v2, s[4:7], s52 offen
    s_mov_b32 m0, s50
    s_nop 0
    buffer_load_dwordx4 v2, s[4:7], s47 offen lds
    s_add_u32 m0, s50, 1024
    s_nop 0
    buffer_load_dwordx4 v2, s[4:7], s48 offen lds
    s_add_u32 s50, s50, 8192
    s_add_u32 s47, s47, 7168
    s_add_u32 s48, s48, s49
    s_add_u32 s52, s51, 4096
    buffer_load_dwordx4 a[16:19], v2, s[4:7], s52 offen
    s_add_u32 s52, s51, 22528
    buffer_load_dwordx4 a[88:91], v2, s[4:7], s52 offen
    s_mov_b32 m0, s50
    s_nop 0
    buffer_load_dwordx4 v2, s[4:7], s47 offen lds
    s_add_u32 m0, s50, 1024
    s_nop 0
    buffer_load_dwordx4 v2, s[4:7], s48 offen lds
    s_add_u32 s50, s50, 8192
    s_add_u32 s47, s47, 7168
    s_add_u32 s48, s48, s49
    s_add_u32 s52, s51, 5120
    buffer_load_dwordx4 a[20:23], v2, s[4:7], s52 offen
    s_add_u32 s52, s51, 23552
    buffer_load_dwordx4 a[92:95], v2, s[4:7], s52 offen
    s_mov_b32 m0, s50
    s_nop 0
    buffer_load_dwordx4 v2, s[4:7], s47 offen lds
    s_add_u32 m0, s50, 1024
    s_nop 0
    buffer_load_dwordx4 v2, s[4:7], s48 offen lds
    s_add_u32 s50, s50, 8192
    s_add_u32 s47, s47, 7168
    s_add_u32 s48, s48, s49
    s_add_u32 s52, s51, 6144
    buffer_load_dwordx4 a[24:27], v2, s[4:7], s52 offen
    s_add_u32 s52, s51, 24576
    buffer_load_dwordx4 a[96:99], v2, s[4:7], s52 offen
    s_mov_b32 m0, s50
    s_nop 0
    buffer_load_dwordx4 v2, s[4:7], s47 offen lds
    s_add_u32 m0, s50, 1024
    s_nop 0
    buffer_load_dwordx4 v2, s[4:7], s48 offen lds
    s_add_u32 s50, s50, 8192
    s_add_u32 s47, s47, 7168
    s_add_u32 s48, s48, s49
    s_add_u32 s52, s51, 7168
    buffer_load_dwordx4 a[28:31], v2, s[4:7], s52 offen
    s_add_u32 s52, s51, 25600
    buffer_load_dwordx4 a[100:103], v2, s[4:7], s52 offen
    s_mov_b32 m0, s50
    s_nop 0
    buffer_load_dwordx4 v2, s[4:7], s47 offen lds
    s_add_u32 m0, s50, 1024
    s_nop 0
    buffer_load_dwordx4 v2, s[4:7], s48 offen lds
    s_add_u32 s50, s50, 8192
    s_add_u32 s47, s47, 7168
    s_add_u32 s48, s48, s49
    s_add_u32 s52, s51, 8192
    buffer_load_dwordx4 a[32:35], v2, s[4:7], s52 offen
    s_add_u32 s52, s51, 26624
    buffer_load_dwordx4 a[104:107], v2, s[4:7], s52 offen
    s_mov_b32 m0, s50
    s_nop 0
    buffer_load_dwordx4 v2, s[4:7], s47 offen lds
    s_add_u32 m0, s50, 1024
    s_nop 0
    buffer_load_dwordx4 v2, s[4:7], s48 offen lds
    s_add_u32 s50, s50, 8192
    s_add_u32 s47, s47, 7168
    s_add_u32 s48, s48, s49
    s_add_u32 s52, s51, 9216
    buffer_load_dwordx4 a[36:39], v2, s[4:7], s52 offen
    s_add_u32 s52, s51, 27648
    buffer_load_dwordx4 a[108:111], v2, s[4:7], s52 offen
    s_mov_b32 m0, s50
    s_nop 0
    buffer_load_dwordx4 v2, s[4:7], s47 offen lds
    s_add_u32 m0, s50, 1024
    s_nop 0
    buffer_load_dwordx4 v2, s[4:7], s48 offen lds
    s_add_u32 s50, s50, 8192
    s_add_u32 s47, s47, 7168
    s_add_u32 s48, s48, s49
    s_add_u32 s52, s51, 10240
    buffer_load_dwordx4 a[40:43], v2, s[4:7], s52 offen
    s_add_u32 s52, s51, 28672
    buffer_load_dwordx4 a[112:115], v2, s[4:7], s52 offen
    s_mov_b32 m0, s50
    s_nop 0
    buffer_load_dwordx4 v2, s[4:7], s47 offen lds
    s_add_u32 m0, s50, 1024
    s_nop 0
    buffer_load_dwordx4 v2, s[4:7], s48 offen lds
    s_add_u32 s50, s50, 8192
    s_add_u32 s47, s47, 7168
    s_add_u32 s48, s48, s49
    s_add_u32 s52, s51, 11264
    buffer_load_dwordx4 a[44:47], v2, s[4:7], s52 offen
    s_add_u32 s52, s51, 29696
    buffer_load_dwordx4 a[116:119], v2, s[4:7], s52 offen
    s_min_u32 s52, s20, 2
    s_add_u32 s53, s52, 2
    s_add_u32 s54, s52, 4
    s_cmp_ge_u32 s20, 2
    s_cselect_b32 s53, 6, s53
    s_lshl_b32 s53, s53, 10
    s_lshl_b32 s54, s54, 10
    v_mov_b32 v3, v2
    v_add_u32 v4, s53, v2
    v_add_u32 v5, s54, v2
    v_and_b32 v6, 15, v1
    v_lshrrev_b32 v7, 4, v1
    v_lshlrev_b32 v7, 2, v7
    v_sub_u32 v6, v6, v7
    v_mov_b32 v8, 0xf149f2ca
    s_or_b32 s52, s44, s20
    s_cmp_eq_u32 s52, 0
    s_cselect_b64 s[56:57], -1, 0
    v_subrev_u32 v7, 0, v6
    v_and_b32 v9, 0xfffffff1, v7
    v_cmp_eq_u32 vcc, 0, v9
    v_add_u32 v7, 16, v7
    v_and_b32 v9, 0xfffffff1, v7
    v_cndmask_b32_e64 v168, v8, 0, vcc
    v_cmp_eq_u32 vcc, 0, v9
    s_nop 1
    v_cndmask_b32_e64 v172, v8, 0, vcc
    v_cndmask_b32_e64 v176, v172, v8, s[56:57]
    v_subrev_u32 v7, 1, v6
    v_and_b32 v9, 0xfffffff1, v7
    v_cmp_eq_u32 vcc, 0, v9
    v_add_u32 v7, 16, v7
    v_and_b32 v9, 0xfffffff1, v7
    v_cndmask_b32_e64 v169, v8, 0, vcc
    v_cmp_eq_u32 vcc, 0, v9
    s_nop 1
    v_cndmask_b32_e64 v173, v8, 0, vcc
    v_cndmask_b32_e64 v177, v173, v8, s[56:57]
    v_subrev_u32 v7, 2, v6
    v_and_b32 v9, 0xfffffff1, v7
    v_cmp_eq_u32 vcc, 0, v9
    v_add_u32 v7, 16, v7
    v_and_b32 v9, 0xfffffff1, v7
    v_cndmask_b32_e64 v170, v8, 0, vcc
    v_cmp_eq_u32 vcc, 0, v9
    s_nop 1
    v_cndmask_b32_e64 v174, v8, 0, vcc
    v_cndmask_b32_e64 v178, v174, v8, s[56:57]
    v_subrev_u32 v7, 3, v6
    v_and_b32 v9, 0xfffffff1, v7
    v_cmp_eq_u32 vcc, 0, v9
    v_add_u32 v7, 16, v7
    v_and_b32 v9, 0xfffffff1, v7
    v_cndmask_b32_e64 v171, v8, 0, vcc
    v_cmp_eq_u32 vcc, 0, v9
    s_nop 1
    v_cndmask_b32_e64 v175, v8, 0, vcc
    v_cndmask_b32_e64 v179, v175, v8, s[56:57]
    s_waitcnt vmcnt(38)
    s_barrier
    ds_read_b128 v[88:91], v3 offset:0
    ds_read_b128 v[92:95], v3 offset:1024
    ds_read_b128 v[96:99], v3 offset:2048
    ds_read_b128 v[100:103], v3 offset:3072
    ds_read_b128 v[112:115], v3 offset:6144
    ds_read_b128 v[104:107], v3 offset:4096
    ds_read_b128 v[108:111], v3 offset:5120
    ds_read_b128 v[144:147], v3 offset:7168
    ds_read_b128 v[148:151], v4 offset:0
    ds_read_b128 v[152:155], v5 offset:0
    s_mov_b32 m0, s50
    s_nop 0
    buffer_load_dwordx4 v2, s[4:7], s47 offen lds
    s_waitcnt lgkmcnt(9)
    v_mfma_f32_16x16x32_bf16 v[16:19], v[88:91], a[0:3], 0
    ds_read_b128 v[116:119], v3 offset:8192
    s_add_u32 m0, s50, 1024
    v_mfma_f32_16x16x32_bf16 v[48:51], v[88:91], a[72:75], 0
    ds_read_b128 v[120:123], v3 offset:9216
    buffer_load_dwordx4 v2, s[4:7], s48 offen lds
    s_waitcnt lgkmcnt(10)
    v_mfma_f32_16x16x32_bf16 v[20:23], v[92:95], a[0:3], 0
    ds_read_b128 v[124:127], v3 offset:10240
    s_add_u32 s50, s50, 8192
    v_mfma_f32_16x16x32_bf16 v[52:55], v[92:95], a[72:75], 0
    ds_read_b128 v[128:131], v3 offset:11264
    s_add_u32 s47, s47, 7168
    s_waitcnt lgkmcnt(11)
    v_mfma_f32_16x16x32_bf16 v[24:27], v[96:99], a[0:3], 0
    ds_read_b128 v[140:143], v3 offset:14336
    s_add_u32 s48, s48, s49
    v_mfma_f32_16x16x32_bf16 v[56:59], v[96:99], a[72:75], 0
    ds_read_b128 v[132:135], v3 offset:12288
    s_add_u32 s52, s51, 12288
    s_waitcnt lgkmcnt(12)
    v_mfma_f32_16x16x32_bf16 v[28:31], v[100:103], a[0:3], 0
    ds_read_b128 v[136:139], v3 offset:13312
    buffer_load_dwordx4 a[48:51], v2, s[4:7], s52 offen
    v_mfma_f32_16x16x32_bf16 v[60:63], v[100:103], a[72:75], 0
    ds_read_b128 v[156:159], v3 offset:15360
    s_add_u32 s52, s51, 30720
    s_waitcnt lgkmcnt(13)
    v_mfma_f32_16x16x32_bf16 v[32:35], v[112:115], a[0:3], 0
    ds_read_b128 v[160:163], v4 offset:8192
    buffer_load_dwordx4 a[120:123], v2, s[4:7], s52 offen
    v_mfma_f32_16x16x32_bf16 v[64:67], v[112:115], a[72:75], 0
    ds_read_b128 v[164:167], v5 offset:8192
    v_mfma_f32_16x16x32_bf16 v[44:47], a[0:3], v[112:115], 0
    v_mfma_f32_16x16x32_bf16 v[76:79], a[72:75], v[112:115], 0
    s_waitcnt lgkmcnt(14)
    v_mfma_f32_16x16x32_bf16 v[36:39], a[0:3], v[104:107], 0
    v_mfma_f32_16x16x32_bf16 v[68:71], a[72:75], v[104:107], 0
    s_waitcnt lgkmcnt(13)
    v_mfma_f32_16x16x32_bf16 v[40:43], a[0:3], v[108:111], 0
    v_mfma_f32_16x16x32_bf16 v[72:75], a[72:75], v[108:111], 0
    s_waitcnt lgkmcnt(11)
    v_mfma_f32_16x16x32_bf16 v[80:83], v[148:151], v[144:147], 0
    s_waitcnt lgkmcnt(10)
    v_mfma_f32_16x16x32_bf16 v[84:87], v[144:147], v[152:155], 0
    s_mov_b32 m0, s50
    s_nop 0
    buffer_load_dwordx4 v2, s[4:7], s47 offen lds
    s_waitcnt lgkmcnt(9)
    v_mfma_f32_16x16x32_bf16 v[16:19], v[116:119], a[4:7], v[16:19]
    ds_read_b128 v[88:91], v3 offset:16384
    s_add_u32 m0, s50, 1024
    v_mfma_f32_16x16x32_bf16 v[48:51], v[116:119], a[76:79], v[48:51]
    ds_read_b128 v[92:95], v3 offset:17408
    buffer_load_dwordx4 v2, s[4:7], s48 offen lds
    s_waitcnt lgkmcnt(10)
    v_mfma_f32_16x16x32_bf16 v[20:23], v[120:123], a[4:7], v[20:23]
    ds_read_b128 v[96:99], v3 offset:18432
    s_add_u32 s50, s50, 8192
    v_mfma_f32_16x16x32_bf16 v[52:55], v[120:123], a[76:79], v[52:55]
    ds_read_b128 v[100:103], v3 offset:19456
    s_add_u32 s47, s47, 7168
    s_waitcnt lgkmcnt(11)
    v_mfma_f32_16x16x32_bf16 v[24:27], v[124:127], a[4:7], v[24:27]
    ds_read_b128 v[112:115], v3 offset:22528
    s_add_u32 s48, s48, s49
    v_mfma_f32_16x16x32_bf16 v[56:59], v[124:127], a[76:79], v[56:59]
    ds_read_b128 v[104:107], v3 offset:20480
    s_add_u32 s52, s51, 13312
    s_waitcnt lgkmcnt(12)
    v_mfma_f32_16x16x32_bf16 v[28:31], v[128:131], a[4:7], v[28:31]
    ds_read_b128 v[108:111], v3 offset:21504
    buffer_load_dwordx4 a[52:55], v2, s[4:7], s52 offen
    v_mfma_f32_16x16x32_bf16 v[60:63], v[128:131], a[76:79], v[60:63]
    ds_read_b128 v[144:147], v3 offset:23552
    s_add_u32 s52, s51, 31744
    s_waitcnt lgkmcnt(13)
    v_mfma_f32_16x16x32_bf16 v[32:35], v[140:143], a[4:7], v[32:35]
    ds_read_b128 v[148:151], v4 offset:16384
    buffer_load_dwordx4 a[124:127], v2, s[4:7], s52 offen
    v_mfma_f32_16x16x32_bf16 v[64:67], v[140:143], a[76:79], v[64:67]
    ds_read_b128 v[152:155], v5 offset:16384
    v_mfma_f32_16x16x32_bf16 v[44:47], a[4:7], v[140:143], v[44:47]
    v_mfma_f32_16x16x32_bf16 v[76:79], a[76:79], v[140:143], v[76:79]
    s_waitcnt lgkmcnt(14)
    v_mfma_f32_16x16x32_bf16 v[36:39], a[4:7], v[132:135], v[36:39]
    v_mfma_f32_16x16x32_bf16 v[68:71], a[76:79], v[132:135], v[68:71]
    s_waitcnt lgkmcnt(13)
    v_mfma_f32_16x16x32_bf16 v[40:43], a[4:7], v[136:139], v[40:43]
    v_mfma_f32_16x16x32_bf16 v[72:75], a[76:79], v[136:139], v[72:75]
    s_waitcnt lgkmcnt(11)
    v_mfma_f32_16x16x32_bf16 v[80:83], v[160:163], v[156:159], v[80:83]
    s_waitcnt lgkmcnt(10)
    v_mfma_f32_16x16x32_bf16 v[84:87], v[156:159], v[164:167], v[84:87]
    s_mov_b32 m0, s50
    s_nop 0
    buffer_load_dwordx4 v2, s[4:7], s47 offen lds
    s_waitcnt vmcnt(46) lgkmcnt(9)
    v_mfma_f32_16x16x32_bf16 v[16:19], v[88:91], a[8:11], v[16:19]
    s_waitcnt vmcnt(35)
    s_barrier
    v_mfma_f32_16x16x32_bf16 v[48:51], v[88:91], a[80:83], v[48:51]
    ds_read_b128 v[116:119], v3 offset:24576
    ds_read_b128 v[120:123], v3 offset:25600
    s_waitcnt lgkmcnt(10)
    v_mfma_f32_16x16x32_bf16 v[20:23], v[92:95], a[8:11], v[20:23]
    ds_read_b128 v[124:127], v3 offset:26624
    s_add_u32 m0, s50, 1024
    v_mfma_f32_16x16x32_bf16 v[52:55], v[92:95], a[80:83], v[52:55]
    ds_read_b128 v[128:131], v3 offset:27648
    buffer_load_dwordx4 v2, s[4:7], s48 offen lds
    s_waitcnt lgkmcnt(11)
    v_mfma_f32_16x16x32_bf16 v[24:27], v[96:99], a[8:11], v[24:27]
    ds_read_b128 v[140:143], v3 offset:30720
    s_add_u32 s50, s50, 8192
    v_mfma_f32_16x16x32_bf16 v[56:59], v[96:99], a[80:83], v[56:59]
    ds_read_b128 v[132:135], v3 offset:28672
    s_add_u32 s47, s47, 7168
    s_waitcnt lgkmcnt(12)
    v_mfma_f32_16x16x32_bf16 v[28:31], v[100:103], a[8:11], v[28:31]
    ds_read_b128 v[136:139], v3 offset:29696
    s_add_u32 s48, s48, s49
    v_mfma_f32_16x16x32_bf16 v[60:63], v[100:103], a[80:83], v[60:63]
    ds_read_b128 v[156:159], v3 offset:31744
    s_add_u32 s52, s51, 14336
    s_waitcnt lgkmcnt(13)
    v_mfma_f32_16x16x32_bf16 v[32:35], v[112:115], a[8:11], v[32:35]
    ds_read_b128 v[160:163], v4 offset:24576
    buffer_load_dwordx4 a[56:59], v2, s[4:7], s52 offen
    v_mfma_f32_16x16x32_bf16 v[64:67], v[112:115], a[80:83], v[64:67]
    ds_read_b128 v[164:167], v5 offset:24576
    s_add_u32 s52, s51, 32768
    v_mfma_f32_16x16x32_bf16 v[44:47], a[8:11], v[112:115], v[44:47]
    buffer_load_dwordx4 a[128:131], v2, s[4:7], s52 offen
    v_mfma_f32_16x16x32_bf16 v[76:79], a[80:83], v[112:115], v[76:79]
    s_waitcnt lgkmcnt(14)
    v_mfma_f32_16x16x32_bf16 v[36:39], a[8:11], v[104:107], v[36:39]
    v_mfma_f32_16x16x32_bf16 v[68:71], a[80:83], v[104:107], v[68:71]
    s_waitcnt lgkmcnt(13)
    v_mfma_f32_16x16x32_bf16 v[40:43], a[8:11], v[108:111], v[40:43]
    v_mfma_f32_16x16x32_bf16 v[72:75], a[80:83], v[108:111], v[72:75]
    s_waitcnt lgkmcnt(11)
    v_mfma_f32_16x16x32_bf16 v[80:83], v[148:151], v[144:147], v[80:83]
    s_waitcnt lgkmcnt(10)
    v_mfma_f32_16x16x32_bf16 v[84:87], v[144:147], v[152:155], v[84:87]
    s_mov_b32 m0, s50
    s_nop 0
    buffer_load_dwordx4 v2, s[4:7], s47 offen lds
    s_waitcnt lgkmcnt(9)
    v_mfma_f32_16x16x32_bf16 v[16:19], v[116:119], a[12:15], v[16:19]
    ds_read_b128 v[88:91], v3 offset:32768
    s_add_u32 m0, s50, 1024
    v_mfma_f32_16x16x32_bf16 v[48:51], v[116:119], a[84:87], v[48:51]
    ds_read_b128 v[92:95], v3 offset:33792
    buffer_load_dwordx4 v2, s[4:7], s48 offen lds
    s_waitcnt lgkmcnt(10)
    v_mfma_f32_16x16x32_bf16 v[20:23], v[120:123], a[12:15], v[20:23]
    ds_read_b128 v[96:99], v3 offset:34816
    s_add_u32 s50, s50, 8192
    v_mfma_f32_16x16x32_bf16 v[52:55], v[120:123], a[84:87], v[52:55]
    ds_read_b128 v[100:103], v3 offset:35840
    s_add_u32 s47, s47, 7168
    s_waitcnt lgkmcnt(11)
    v_mfma_f32_16x16x32_bf16 v[24:27], v[124:127], a[12:15], v[24:27]
    ds_read_b128 v[112:115], v3 offset:38912
    s_add_u32 s48, s48, s49
    v_mfma_f32_16x16x32_bf16 v[56:59], v[124:127], a[84:87], v[56:59]
    ds_read_b128 v[104:107], v3 offset:36864
    s_add_u32 s52, s51, 15360
    s_waitcnt lgkmcnt(12)
    v_mfma_f32_16x16x32_bf16 v[28:31], v[128:131], a[12:15], v[28:31]
    ds_read_b128 v[108:111], v3 offset:37888
    buffer_load_dwordx4 a[60:63], v2, s[4:7], s52 offen
    v_mfma_f32_16x16x32_bf16 v[60:63], v[128:131], a[84:87], v[60:63]
    ds_read_b128 v[144:147], v3 offset:39936
    s_add_u32 s52, s51, 33792
    s_waitcnt lgkmcnt(13)
    v_mfma_f32_16x16x32_bf16 v[32:35], v[140:143], a[12:15], v[32:35]
    ds_read_b128 v[148:151], v4 offset:32768
    buffer_load_dwordx4 a[132:135], v2, s[4:7], s52 offen
    v_mfma_f32_16x16x32_bf16 v[64:67], v[140:143], a[84:87], v[64:67]
    ds_read_b128 v[152:155], v5 offset:32768
    v_mfma_f32_16x16x32_bf16 v[44:47], a[12:15], v[140:143], v[44:47]
    v_mfma_f32_16x16x32_bf16 v[76:79], a[84:87], v[140:143], v[76:79]
    s_waitcnt lgkmcnt(14)
    v_mfma_f32_16x16x32_bf16 v[36:39], a[12:15], v[132:135], v[36:39]
    v_mfma_f32_16x16x32_bf16 v[68:71], a[84:87], v[132:135], v[68:71]
    s_waitcnt lgkmcnt(13)
    v_mfma_f32_16x16x32_bf16 v[40:43], a[12:15], v[136:139], v[40:43]
    v_mfma_f32_16x16x32_bf16 v[72:75], a[84:87], v[136:139], v[72:75]
    s_waitcnt lgkmcnt(11)
    v_mfma_f32_16x16x32_bf16 v[80:83], v[160:163], v[156:159], v[80:83]
    s_waitcnt lgkmcnt(10)
    v_mfma_f32_16x16x32_bf16 v[84:87], v[156:159], v[164:167], v[84:87]
    s_mov_b32 m0, s50
    s_nop 0
    buffer_load_dwordx4 v2, s[4:7], s47 offen lds
    s_waitcnt lgkmcnt(9)
    v_mfma_f32_16x16x32_bf16 v[16:19], v[88:91], a[16:19], v[16:19]
    ds_read_b128 v[116:119], v3 offset:40960
    s_add_u32 m0, s50, 1024
    v_mfma_f32_16x16x32_bf16 v[48:51], v[88:91], a[88:91], v[48:51]
    ds_read_b128 v[120:123], v3 offset:41984
    buffer_load_dwordx4 v2, s[4:7], s48 offen lds
    s_waitcnt lgkmcnt(10)
    v_mfma_f32_16x16x32_bf16 v[20:23], v[92:95], a[16:19], v[20:23]
    ds_read_b128 v[124:127], v3 offset:43008
    s_add_u32 s50, s50, 8192
    v_mfma_f32_16x16x32_bf16 v[52:55], v[92:95], a[88:91], v[52:55]
    ds_read_b128 v[128:131], v3 offset:44032
    s_add_u32 s47, s47, 7168
    s_waitcnt lgkmcnt(11)
    v_mfma_f32_16x16x32_bf16 v[24:27], v[96:99], a[16:19], v[24:27]
    ds_read_b128 v[140:143], v3 offset:47104
    s_add_u32 s48, s48, s49
    v_mfma_f32_16x16x32_bf16 v[56:59], v[96:99], a[88:91], v[56:59]
    ds_read_b128 v[132:135], v3 offset:45056
    s_add_u32 s52, s51, 16384
    s_waitcnt lgkmcnt(12)
    v_mfma_f32_16x16x32_bf16 v[28:31], v[100:103], a[16:19], v[28:31]
    ds_read_b128 v[136:139], v3 offset:46080
    buffer_load_dwordx4 a[64:67], v2, s[4:7], s52 offen
    v_mfma_f32_16x16x32_bf16 v[60:63], v[100:103], a[88:91], v[60:63]
    ds_read_b128 v[156:159], v3 offset:48128
    s_add_u32 s52, s51, 34816
    s_waitcnt lgkmcnt(13)
    v_mfma_f32_16x16x32_bf16 v[32:35], v[112:115], a[16:19], v[32:35]
    ds_read_b128 v[160:163], v4 offset:40960
    buffer_load_dwordx4 a[136:139], v2, s[4:7], s52 offen
    v_mfma_f32_16x16x32_bf16 v[64:67], v[112:115], a[88:91], v[64:67]
    ds_read_b128 v[164:167], v5 offset:40960
    v_mfma_f32_16x16x32_bf16 v[44:47], a[16:19], v[112:115], v[44:47]
    v_mfma_f32_16x16x32_bf16 v[76:79], a[88:91], v[112:115], v[76:79]
    s_waitcnt lgkmcnt(14)
    v_mfma_f32_16x16x32_bf16 v[36:39], a[16:19], v[104:107], v[36:39]
    v_mfma_f32_16x16x32_bf16 v[68:71], a[88:91], v[104:107], v[68:71]
    s_waitcnt lgkmcnt(13)
    v_mfma_f32_16x16x32_bf16 v[40:43], a[16:19], v[108:111], v[40:43]
    v_mfma_f32_16x16x32_bf16 v[72:75], a[88:91], v[108:111], v[72:75]
    s_waitcnt lgkmcnt(11)
    v_mfma_f32_16x16x32_bf16 v[80:83], v[148:151], v[144:147], v[80:83]
    s_waitcnt lgkmcnt(10)
    v_mfma_f32_16x16x32_bf16 v[84:87], v[144:147], v[152:155], v[84:87]
    s_mov_b32 m0, s50
    s_nop 0
    buffer_load_dwordx4 v2, s[4:7], s47 offen lds
    s_waitcnt vmcnt(46) lgkmcnt(9)
    v_mfma_f32_16x16x32_bf16 v[16:19], v[116:119], a[20:23], v[16:19]
    s_waitcnt vmcnt(35)
    s_barrier
    v_mfma_f32_16x16x32_bf16 v[48:51], v[116:119], a[92:95], v[48:51]
    ds_read_b128 v[88:91], v3 offset:49152
    ds_read_b128 v[92:95], v3 offset:50176
    s_waitcnt lgkmcnt(10)
    v_mfma_f32_16x16x32_bf16 v[20:23], v[120:123], a[20:23], v[20:23]
    ds_read_b128 v[96:99], v3 offset:51200
    s_add_u32 m0, s50, 1024
    v_mfma_f32_16x16x32_bf16 v[52:55], v[120:123], a[92:95], v[52:55]
    ds_read_b128 v[100:103], v3 offset:52224
    buffer_load_dwordx4 v2, s[4:7], s48 offen lds
    s_waitcnt lgkmcnt(11)
    v_mfma_f32_16x16x32_bf16 v[24:27], v[124:127], a[20:23], v[24:27]
    ds_read_b128 v[112:115], v3 offset:55296
    s_add_u32 s50, s50, 8192
    v_mfma_f32_16x16x32_bf16 v[56:59], v[124:127], a[92:95], v[56:59]
    ds_read_b128 v[104:107], v3 offset:53248
    s_add_u32 s47, s47, 7168
    s_waitcnt lgkmcnt(12)
    v_mfma_f32_16x16x32_bf16 v[28:31], v[128:131], a[20:23], v[28:31]
    ds_read_b128 v[108:111], v3 offset:54272
    s_add_u32 s48, s48, s49
    v_mfma_f32_16x16x32_bf16 v[60:63], v[128:131], a[92:95], v[60:63]
    ds_read_b128 v[144:147], v3 offset:56320
    s_add_u32 s52, s51, 17408
    s_waitcnt lgkmcnt(13)
    v_mfma_f32_16x16x32_bf16 v[32:35], v[140:143], a[20:23], v[32:35]
    ds_read_b128 v[148:151], v4 offset:49152
    buffer_load_dwordx4 a[68:71], v2, s[4:7], s52 offen
    v_mfma_f32_16x16x32_bf16 v[64:67], v[140:143], a[92:95], v[64:67]
    ds_read_b128 v[152:155], v5 offset:49152
    s_add_u32 s52, s51, 35840
    v_mfma_f32_16x16x32_bf16 v[44:47], a[20:23], v[140:143], v[44:47]
    buffer_load_dwordx4 a[140:143], v2, s[4:7], s52 offen
    v_mfma_f32_16x16x32_bf16 v[76:79], a[92:95], v[140:143], v[76:79]
    s_waitcnt lgkmcnt(14)
    v_mfma_f32_16x16x32_bf16 v[36:39], a[20:23], v[132:135], v[36:39]
    v_mfma_f32_16x16x32_bf16 v[68:71], a[92:95], v[132:135], v[68:71]
    s_waitcnt lgkmcnt(13)
    v_mfma_f32_16x16x32_bf16 v[40:43], a[20:23], v[136:139], v[40:43]
    v_mfma_f32_16x16x32_bf16 v[72:75], a[92:95], v[136:139], v[72:75]
    s_waitcnt lgkmcnt(11)
    v_mfma_f32_16x16x32_bf16 v[80:83], v[160:163], v[156:159], v[80:83]
    s_waitcnt lgkmcnt(10)
    v_mfma_f32_16x16x32_bf16 v[84:87], v[156:159], v[164:167], v[84:87]
    s_waitcnt lgkmcnt(9)
    v_mfma_f32_16x16x32_bf16 v[16:19], v[88:91], a[24:27], v[16:19]
    ds_read_b128 v[116:119], v3 offset:57344
    v_mfma_f32_16x16x32_bf16 v[48:51], v[88:91], a[96:99], v[48:51]
    ds_read_b128 v[120:123], v3 offset:58368
    s_waitcnt lgkmcnt(10)
    v_mfma_f32_16x16x32_bf16 v[20:23], v[92:95], a[24:27], v[20:23]
    ds_read_b128 v[124:127], v3 offset:59392
    v_mfma_f32_16x16x32_bf16 v[52:55], v[92:95], a[96:99], v[52:55]
    ds_read_b128 v[128:131], v3 offset:60416
    s_waitcnt lgkmcnt(11)
    v_mfma_f32_16x16x32_bf16 v[24:27], v[96:99], a[24:27], v[24:27]
    ds_read_b128 v[140:143], v3 offset:63488
    v_mfma_f32_16x16x32_bf16 v[56:59], v[96:99], a[96:99], v[56:59]
    ds_read_b128 v[132:135], v3 offset:61440
    s_waitcnt lgkmcnt(12)
    v_mfma_f32_16x16x32_bf16 v[28:31], v[100:103], a[24:27], v[28:31]
    ds_read_b128 v[136:139], v3 offset:62464
    v_mfma_f32_16x16x32_bf16 v[60:63], v[100:103], a[96:99], v[60:63]
    ds_read_b128 v[156:159], v3 offset:64512
    s_waitcnt lgkmcnt(13)
    v_mfma_f32_16x16x32_bf16 v[32:35], v[112:115], a[24:27], v[32:35]
    ds_read_b128 v[160:163], v4 offset:57344
    v_mfma_f32_16x16x32_bf16 v[64:67], v[112:115], a[96:99], v[64:67]
    ds_read_b128 v[164:167], v5 offset:57344
    v_mfma_f32_16x16x32_bf16 v[44:47], a[24:27], v[112:115], v[44:47]
    v_mfma_f32_16x16x32_bf16 v[76:79], a[96:99], v[112:115], v[76:79]
    s_waitcnt lgkmcnt(14)
    v_mfma_f32_16x16x32_bf16 v[36:39], a[24:27], v[104:107], v[36:39]
    v_mfma_f32_16x16x32_bf16 v[68:71], a[96:99], v[104:107], v[68:71]
    s_waitcnt lgkmcnt(13)
    v_mfma_f32_16x16x32_bf16 v[40:43], a[24:27], v[108:111], v[40:43]
    v_mfma_f32_16x16x32_bf16 v[72:75], a[96:99], v[108:111], v[72:75]
    s_waitcnt lgkmcnt(11)
    v_mfma_f32_16x16x32_bf16 v[80:83], v[148:151], v[144:147], v[80:83]
    s_waitcnt lgkmcnt(10)
    v_mfma_f32_16x16x32_bf16 v[84:87], v[144:147], v[152:155], v[84:87]
    s_waitcnt lgkmcnt(9)
    v_mfma_f32_16x16x32_bf16 v[16:19], v[116:119], a[28:31], v[16:19]
    v_add_u32 v3, 0x10000, v3
    v_mfma_f32_16x16x32_bf16 v[48:51], v[116:119], a[100:103], v[48:51]
    v_add_u32 v4, 0x10000, v4
    s_waitcnt lgkmcnt(8)
    v_mfma_f32_16x16x32_bf16 v[20:23], v[120:123], a[28:31], v[20:23]
    v_add_u32 v5, 0x10000, v5
    v_mfma_f32_16x16x32_bf16 v[52:55], v[120:123], a[100:103], v[52:55]
    ds_read_b128 v[88:91], v3 offset:0
    s_waitcnt lgkmcnt(8)
    v_mfma_f32_16x16x32_bf16 v[24:27], v[124:127], a[28:31], v[24:27]
    ds_read_b128 v[92:95], v3 offset:1024
    v_mfma_f32_16x16x32_bf16 v[56:59], v[124:127], a[100:103], v[56:59]
    ds_read_b128 v[96:99], v3 offset:2048
    s_waitcnt lgkmcnt(9)
    v_mfma_f32_16x16x32_bf16 v[28:31], v[128:131], a[28:31], v[28:31]
    ds_read_b128 v[100:103], v3 offset:3072
    v_mfma_f32_16x16x32_bf16 v[60:63], v[128:131], a[100:103], v[60:63]
    ds_read_b128 v[112:115], v3 offset:6144
    s_waitcnt lgkmcnt(10)
    v_mfma_f32_16x16x32_bf16 v[32:35], v[140:143], a[28:31], v[32:35]
    ds_read_b128 v[104:107], v3 offset:4096
    v_mfma_f32_16x16x32_bf16 v[64:67], v[140:143], a[100:103], v[64:67]
    ds_read_b128 v[108:111], v3 offset:5120
    v_mfma_f32_16x16x32_bf16 v[44:47], a[28:31], v[140:143], v[44:47]
    ds_read_b128 v[144:147], v3 offset:7168
    v_mfma_f32_16x16x32_bf16 v[76:79], a[100:103], v[140:143], v[76:79]
    ds_read_b128 v[148:151], v4 offset:0
    s_waitcnt lgkmcnt(13)
    v_mfma_f32_16x16x32_bf16 v[36:39], a[28:31], v[132:135], v[36:39]
    ds_read_b128 v[152:155], v5 offset:0
    v_mfma_f32_16x16x32_bf16 v[68:71], a[100:103], v[132:135], v[68:71]
    s_waitcnt lgkmcnt(13)
    v_mfma_f32_16x16x32_bf16 v[40:43], a[28:31], v[136:139], v[40:43]
    v_mfma_f32_16x16x32_bf16 v[72:75], a[100:103], v[136:139], v[72:75]
    s_waitcnt lgkmcnt(11)
    v_mfma_f32_16x16x32_bf16 v[80:83], v[160:163], v[156:159], v[80:83]
    s_waitcnt lgkmcnt(10)
    v_mfma_f32_16x16x32_bf16 v[84:87], v[156:159], v[164:167], v[84:87]
    s_waitcnt vmcnt(37) lgkmcnt(9)
    v_mfma_f32_16x16x32_bf16 v[16:19], v[88:91], a[32:35], v[16:19]
    s_waitcnt vmcnt(26)
    s_barrier
    v_mfma_f32_16x16x32_bf16 v[48:51], v[88:91], a[104:107], v[48:51]
    ds_read_b128 v[116:119], v3 offset:8192
    ds_read_b128 v[120:123], v3 offset:9216
    s_waitcnt lgkmcnt(10)
    v_mfma_f32_16x16x32_bf16 v[20:23], v[92:95], a[32:35], v[20:23]
    ds_read_b128 v[124:127], v3 offset:10240
    v_mfma_f32_16x16x32_bf16 v[52:55], v[92:95], a[104:107], v[52:55]
    ds_read_b128 v[128:131], v3 offset:11264
    s_waitcnt lgkmcnt(11)
    v_mfma_f32_16x16x32_bf16 v[24:27], v[96:99], a[32:35], v[24:27]
    ds_read_b128 v[140:143], v3 offset:14336
    v_mfma_f32_16x16x32_bf16 v[56:59], v[96:99], a[104:107], v[56:59]
    ds_read_b128 v[132:135], v3 offset:12288
    s_waitcnt lgkmcnt(12)
    v_mfma_f32_16x16x32_bf16 v[28:31], v[100:103], a[32:35], v[28:31]
    ds_read_b128 v[136:139], v3 offset:13312
    v_mfma_f32_16x16x32_bf16 v[60:63], v[100:103], a[104:107], v[60:63]
    ds_read_b128 v[156:159], v3 offset:15360
    s_waitcnt lgkmcnt(13)
    v_mfma_f32_16x16x32_bf16 v[32:35], v[112:115], a[32:35], v[32:35]
    ds_read_b128 v[160:163], v4 offset:8192
    v_mfma_f32_16x16x32_bf16 v[64:67], v[112:115], a[104:107], v[64:67]
    ds_read_b128 v[164:167], v5 offset:8192
    v_mfma_f32_16x16x32_bf16 v[44:47], a[32:35], v[112:115], v[44:47]
    v_mfma_f32_16x16x32_bf16 v[76:79], a[104:107], v[112:115], v[76:79]
    s_waitcnt lgkmcnt(14)
    v_mfma_f32_16x16x32_bf16 v[36:39], a[32:35], v[104:107], v[36:39]
    v_mfma_f32_16x16x32_bf16 v[68:71], a[104:107], v[104:107], v[68:71]
    s_waitcnt lgkmcnt(13)
    v_mfma_f32_16x16x32_bf16 v[40:43], a[32:35], v[108:111], v[40:43]
    v_mfma_f32_16x16x32_bf16 v[72:75], a[104:107], v[108:111], v[72:75]
    s_waitcnt lgkmcnt(11)
    v_mfma_f32_16x16x32_bf16 v[80:83], v[148:151], v[144:147], v[80:83]
    s_waitcnt lgkmcnt(10)
    v_mfma_f32_16x16x32_bf16 v[84:87], v[144:147], v[152:155], v[84:87]
    s_waitcnt lgkmcnt(9)
    v_mfma_f32_16x16x32_bf16 v[16:19], v[116:119], a[36:39], v[16:19]
    ds_read_b128 v[88:91], v3 offset:16384
    v_mfma_f32_16x16x32_bf16 v[48:51], v[116:119], a[108:111], v[48:51]
    ds_read_b128 v[92:95], v3 offset:17408
    s_waitcnt lgkmcnt(10)
    v_mfma_f32_16x16x32_bf16 v[20:23], v[120:123], a[36:39], v[20:23]
    ds_read_b128 v[96:99], v3 offset:18432
    v_mfma_f32_16x16x32_bf16 v[52:55], v[120:123], a[108:111], v[52:55]
    ds_read_b128 v[100:103], v3 offset:19456
    s_waitcnt lgkmcnt(11)
    v_mfma_f32_16x16x32_bf16 v[24:27], v[124:127], a[36:39], v[24:27]
    ds_read_b128 v[112:115], v3 offset:22528
    v_mfma_f32_16x16x32_bf16 v[56:59], v[124:127], a[108:111], v[56:59]
    ds_read_b128 v[104:107], v3 offset:20480
    s_waitcnt lgkmcnt(12)
    v_mfma_f32_16x16x32_bf16 v[28:31], v[128:131], a[36:39], v[28:31]
    ds_read_b128 v[108:111], v3 offset:21504
    v_mfma_f32_16x16x32_bf16 v[60:63], v[128:131], a[108:111], v[60:63]
    ds_read_b128 v[144:147], v3 offset:23552
    s_waitcnt lgkmcnt(13)
    v_mfma_f32_16x16x32_bf16 v[32:35], v[140:143], a[36:39], v[32:35]
    ds_read_b128 v[148:151], v4 offset:16384
    v_mfma_f32_16x16x32_bf16 v[64:67], v[140:143], a[108:111], v[64:67]
    ds_read_b128 v[152:155], v5 offset:16384
    v_mfma_f32_16x16x32_bf16 v[44:47], a[36:39], v[140:143], v[44:47]
    v_mfma_f32_16x16x32_bf16 v[76:79], a[108:111], v[140:143], v[76:79]
    s_waitcnt lgkmcnt(14)
    v_mfma_f32_16x16x32_bf16 v[36:39], a[36:39], v[132:135], v[36:39]
    v_mfma_f32_16x16x32_bf16 v[68:71], a[108:111], v[132:135], v[68:71]
    s_waitcnt lgkmcnt(13)
    v_mfma_f32_16x16x32_bf16 v[40:43], a[36:39], v[136:139], v[40:43]
    v_mfma_f32_16x16x32_bf16 v[72:75], a[108:111], v[136:139], v[72:75]
    s_waitcnt lgkmcnt(11)
    v_mfma_f32_16x16x32_bf16 v[80:83], v[160:163], v[156:159], v[80:83]
    s_waitcnt lgkmcnt(10)
    v_mfma_f32_16x16x32_bf16 v[84:87], v[156:159], v[164:167], v[84:87]
    s_waitcnt lgkmcnt(9)
    v_mfma_f32_16x16x32_bf16 v[16:19], v[88:91], a[40:43], v[16:19]
    ds_read_b128 v[116:119], v3 offset:24576
    v_mfma_f32_16x16x32_bf16 v[48:51], v[88:91], a[112:115], v[48:51]
    ds_read_b128 v[120:123], v3 offset:25600
    s_waitcnt lgkmcnt(10)
    v_mfma_f32_16x16x32_bf16 v[20:23], v[92:95], a[40:43], v[20:23]
    ds_read_b128 v[124:127], v3 offset:26624
    v_mfma_f32_16x16x32_bf16 v[52:55], v[92:95], a[112:115], v[52:55]
    ds_read_b128 v[128:131], v3 offset:27648
    s_waitcnt lgkmcnt(11)
    v_mfma_f32_16x16x32_bf16 v[24:27], v[96:99], a[40:43], v[24:27]
    ds_read_b128 v[140:143], v3 offset:30720
    v_mfma_f32_16x16x32_bf16 v[56:59], v[96:99], a[112:115], v[56:59]
    ds_read_b128 v[132:135], v3 offset:28672
    s_waitcnt lgkmcnt(12)
    v_mfma_f32_16x16x32_bf16 v[28:31], v[100:103], a[40:43], v[28:31]
    ds_read_b128 v[136:139], v3 offset:29696
    v_mfma_f32_16x16x32_bf16 v[60:63], v[100:103], a[112:115], v[60:63]
    ds_read_b128 v[156:159], v3 offset:31744
    s_waitcnt lgkmcnt(13)
    v_mfma_f32_16x16x32_bf16 v[32:35], v[112:115], a[40:43], v[32:35]
    ds_read_b128 v[160:163], v4 offset:24576
    v_mfma_f32_16x16x32_bf16 v[64:67], v[112:115], a[112:115], v[64:67]
    ds_read_b128 v[164:167], v5 offset:24576
    v_mfma_f32_16x16x32_bf16 v[44:47], a[40:43], v[112:115], v[44:47]
    v_mfma_f32_16x16x32_bf16 v[76:79], a[112:115], v[112:115], v[76:79]
    s_waitcnt lgkmcnt(14)
    v_mfma_f32_16x16x32_bf16 v[36:39], a[40:43], v[104:107], v[36:39]
    v_mfma_f32_16x16x32_bf16 v[68:71], a[112:115], v[104:107], v[68:71]
    s_waitcnt lgkmcnt(13)
    v_mfma_f32_16x16x32_bf16 v[40:43], a[40:43], v[108:111], v[40:43]
    v_mfma_f32_16x16x32_bf16 v[72:75], a[112:115], v[108:111], v[72:75]
    s_waitcnt lgkmcnt(11)
    v_mfma_f32_16x16x32_bf16 v[80:83], v[148:151], v[144:147], v[80:83]
    s_waitcnt lgkmcnt(10)
    v_mfma_f32_16x16x32_bf16 v[84:87], v[144:147], v[152:155], v[84:87]
    s_waitcnt vmcnt(25) lgkmcnt(9)
    v_mfma_f32_16x16x32_bf16 v[16:19], v[116:119], a[44:47], v[16:19]
    s_waitcnt vmcnt(14)
    s_barrier
    v_mfma_f32_16x16x32_bf16 v[48:51], v[116:119], a[116:119], v[48:51]
    ds_read_b128 v[88:91], v3 offset:32768
    ds_read_b128 v[92:95], v3 offset:33792
    s_waitcnt lgkmcnt(10)
    v_mfma_f32_16x16x32_bf16 v[20:23], v[120:123], a[44:47], v[20:23]
    ds_read_b128 v[96:99], v3 offset:34816
    v_mfma_f32_16x16x32_bf16 v[52:55], v[120:123], a[116:119], v[52:55]
    ds_read_b128 v[100:103], v3 offset:35840
    s_waitcnt lgkmcnt(11)
    v_mfma_f32_16x16x32_bf16 v[24:27], v[124:127], a[44:47], v[24:27]
    ds_read_b128 v[112:115], v3 offset:38912
    v_mfma_f32_16x16x32_bf16 v[56:59], v[124:127], a[116:119], v[56:59]
    ds_read_b128 v[104:107], v3 offset:36864
    s_waitcnt lgkmcnt(12)
    v_mfma_f32_16x16x32_bf16 v[28:31], v[128:131], a[44:47], v[28:31]
    ds_read_b128 v[108:111], v3 offset:37888
    v_mfma_f32_16x16x32_bf16 v[60:63], v[128:131], a[116:119], v[60:63]
    ds_read_b128 v[144:147], v3 offset:39936
    s_waitcnt lgkmcnt(13)
    v_mfma_f32_16x16x32_bf16 v[32:35], v[140:143], a[44:47], v[32:35]
    ds_read_b128 v[148:151], v4 offset:32768
    v_mfma_f32_16x16x32_bf16 v[64:67], v[140:143], a[116:119], v[64:67]
    ds_read_b128 v[152:155], v5 offset:32768
    v_mfma_f32_16x16x32_bf16 v[44:47], a[44:47], v[140:143], v[44:47]
    v_mfma_f32_16x16x32_bf16 v[76:79], a[116:119], v[140:143], v[76:79]
    s_waitcnt lgkmcnt(14)
    v_mfma_f32_16x16x32_bf16 v[36:39], a[44:47], v[132:135], v[36:39]
    v_mfma_f32_16x16x32_bf16 v[68:71], a[116:119], v[132:135], v[68:71]
    s_waitcnt lgkmcnt(13)
    v_mfma_f32_16x16x32_bf16 v[40:43], a[44:47], v[136:139], v[40:43]
    v_mfma_f32_16x16x32_bf16 v[72:75], a[116:119], v[136:139], v[72:75]
    s_waitcnt lgkmcnt(11)
    v_mfma_f32_16x16x32_bf16 v[80:83], v[160:163], v[156:159], v[80:83]
    s_waitcnt lgkmcnt(10)
    v_mfma_f32_16x16x32_bf16 v[84:87], v[156:159], v[164:167], v[84:87]
    s_waitcnt lgkmcnt(9)
    v_mfma_f32_16x16x32_bf16 v[16:19], v[88:91], a[48:51], v[16:19]
    ds_read_b128 v[116:119], v3 offset:40960
    v_mfma_f32_16x16x32_bf16 v[48:51], v[88:91], a[120:123], v[48:51]
    ds_read_b128 v[120:123], v3 offset:41984
    s_waitcnt lgkmcnt(10)
    v_mfma_f32_16x16x32_bf16 v[20:23], v[92:95], a[48:51], v[20:23]
    ds_read_b128 v[124:127], v3 offset:43008
    v_mfma_f32_16x16x32_bf16 v[52:55], v[92:95], a[120:123], v[52:55]
    ds_read_b128 v[128:131], v3 offset:44032
    s_waitcnt lgkmcnt(11)
    v_mfma_f32_16x16x32_bf16 v[24:27], v[96:99], a[48:51], v[24:27]
    ds_read_b128 v[140:143], v3 offset:47104
    v_mfma_f32_16x16x32_bf16 v[56:59], v[96:99], a[120:123], v[56:59]
    ds_read_b128 v[132:135], v3 offset:45056
    s_waitcnt lgkmcnt(12)
    v_mfma_f32_16x16x32_bf16 v[28:31], v[100:103], a[48:51], v[28:31]
    ds_read_b128 v[136:139], v3 offset:46080
    v_mfma_f32_16x16x32_bf16 v[60:63], v[100:103], a[120:123], v[60:63]
    ds_read_b128 v[156:159], v3 offset:48128
    s_waitcnt lgkmcnt(13)
    v_mfma_f32_16x16x32_bf16 v[32:35], v[112:115], a[48:51], v[32:35]
    ds_read_b128 v[160:163], v4 offset:40960
    v_mfma_f32_16x16x32_bf16 v[64:67], v[112:115], a[120:123], v[64:67]
    ds_read_b128 v[164:167], v5 offset:40960
    v_mfma_f32_16x16x32_bf16 v[44:47], a[48:51], v[112:115], v[44:47]
    v_mfma_f32_16x16x32_bf16 v[76:79], a[120:123], v[112:115], v[76:79]
    s_waitcnt lgkmcnt(14)
    v_mfma_f32_16x16x32_bf16 v[36:39], a[48:51], v[104:107], v[36:39]
    v_mfma_f32_16x16x32_bf16 v[68:71], a[120:123], v[104:107], v[68:71]
    s_waitcnt lgkmcnt(13)
    v_mfma_f32_16x16x32_bf16 v[40:43], a[48:51], v[108:111], v[40:43]
    v_mfma_f32_16x16x32_bf16 v[72:75], a[120:123], v[108:111], v[72:75]
    s_waitcnt lgkmcnt(11)
    v_mfma_f32_16x16x32_bf16 v[80:83], v[148:151], v[144:147], v[80:83]
    s_waitcnt lgkmcnt(10)
    v_mfma_f32_16x16x32_bf16 v[84:87], v[144:147], v[152:155], v[84:87]
    s_waitcnt lgkmcnt(9)
    v_mfma_f32_16x16x32_bf16 v[16:19], v[116:119], a[52:55], v[16:19]
    ds_read_b128 v[88:91], v3 offset:49152
    v_mfma_f32_16x16x32_bf16 v[48:51], v[116:119], a[124:127], v[48:51]
    ds_read_b128 v[92:95], v3 offset:50176
    s_waitcnt lgkmcnt(10)
    v_mfma_f32_16x16x32_bf16 v[20:23], v[120:123], a[52:55], v[20:23]
    ds_read_b128 v[96:99], v3 offset:51200
    v_mfma_f32_16x16x32_bf16 v[52:55], v[120:123], a[124:127], v[52:55]
    ds_read_b128 v[100:103], v3 offset:52224
    s_waitcnt lgkmcnt(11)
    v_mfma_f32_16x16x32_bf16 v[24:27], v[124:127], a[52:55], v[24:27]
    ds_read_b128 v[112:115], v3 offset:55296
    v_mfma_f32_16x16x32_bf16 v[56:59], v[124:127], a[124:127], v[56:59]
    ds_read_b128 v[104:107], v3 offset:53248
    s_waitcnt lgkmcnt(12)
    v_mfma_f32_16x16x32_bf16 v[28:31], v[128:131], a[52:55], v[28:31]
    ds_read_b128 v[108:111], v3 offset:54272
    v_mfma_f32_16x16x32_bf16 v[60:63], v[128:131], a[124:127], v[60:63]
    ds_read_b128 v[144:147], v3 offset:56320
    s_waitcnt lgkmcnt(13)
    v_mfma_f32_16x16x32_bf16 v[32:35], v[140:143], a[52:55], v[32:35]
    ds_read_b128 v[148:151], v4 offset:49152
    v_mfma_f32_16x16x32_bf16 v[64:67], v[140:143], a[124:127], v[64:67]
    ds_read_b128 v[152:155], v5 offset:49152
    v_mfma_f32_16x16x32_bf16 v[44:47], a[52:55], v[140:143], v[44:47]
    v_mfma_f32_16x16x32_bf16 v[76:79], a[124:127], v[140:143], v[76:79]
    s_waitcnt lgkmcnt(14)
    v_mfma_f32_16x16x32_bf16 v[36:39], a[52:55], v[132:135], v[36:39]
    v_mfma_f32_16x16x32_bf16 v[68:71], a[124:127], v[132:135], v[68:71]
    s_waitcnt lgkmcnt(13)
    v_mfma_f32_16x16x32_bf16 v[40:43], a[52:55], v[136:139], v[40:43]
    v_mfma_f32_16x16x32_bf16 v[72:75], a[124:127], v[136:139], v[72:75]
    s_waitcnt lgkmcnt(11)
    v_mfma_f32_16x16x32_bf16 v[80:83], v[160:163], v[156:159], v[80:83]
    s_waitcnt lgkmcnt(10)
    v_mfma_f32_16x16x32_bf16 v[84:87], v[156:159], v[164:167], v[84:87]
    s_waitcnt vmcnt(13) lgkmcnt(9)
    v_mfma_f32_16x16x32_bf16 v[16:19], v[88:91], a[56:59], v[16:19]
    s_waitcnt vmcnt(2)
    s_barrier
    v_mfma_f32_16x16x32_bf16 v[48:51], v[88:91], a[128:131], v[48:51]
    ds_read_b128 v[116:119], v3 offset:57344
    ds_read_b128 v[120:123], v3 offset:58368
    s_waitcnt lgkmcnt(10)
    v_mfma_f32_16x16x32_bf16 v[20:23], v[92:95], a[56:59], v[20:23]
    ds_read_b128 v[124:127], v3 offset:59392
    v_mfma_f32_16x16x32_bf16 v[52:55], v[92:95], a[128:131], v[52:55]
    ds_read_b128 v[128:131], v3 offset:60416
    s_waitcnt lgkmcnt(11)
    v_mfma_f32_16x16x32_bf16 v[24:27], v[96:99], a[56:59], v[24:27]
    ds_read_b128 v[140:143], v3 offset:63488
    v_mfma_f32_16x16x32_bf16 v[56:59], v[96:99], a[128:131], v[56:59]
    ds_read_b128 v[132:135], v3 offset:61440
    s_waitcnt lgkmcnt(12)
    v_mfma_f32_16x16x32_bf16 v[28:31], v[100:103], a[56:59], v[28:31]
    ds_read_b128 v[136:139], v3 offset:62464
    v_mfma_f32_16x16x32_bf16 v[60:63], v[100:103], a[128:131], v[60:63]
    ds_read_b128 v[156:159], v3 offset:64512
    s_waitcnt lgkmcnt(13)
    v_mfma_f32_16x16x32_bf16 v[32:35], v[112:115], a[56:59], v[32:35]
    ds_read_b128 v[160:163], v4 offset:57344
    v_mfma_f32_16x16x32_bf16 v[64:67], v[112:115], a[128:131], v[64:67]
    ds_read_b128 v[164:167], v5 offset:57344
    v_mfma_f32_16x16x32_bf16 v[44:47], a[56:59], v[112:115], v[44:47]
    v_mfma_f32_16x16x32_bf16 v[76:79], a[128:131], v[112:115], v[76:79]
    s_waitcnt lgkmcnt(14)
    v_mfma_f32_16x16x32_bf16 v[36:39], a[56:59], v[104:107], v[36:39]
    v_mfma_f32_16x16x32_bf16 v[68:71], a[128:131], v[104:107], v[68:71]
    s_waitcnt lgkmcnt(13)
    v_mfma_f32_16x16x32_bf16 v[40:43], a[56:59], v[108:111], v[40:43]
    v_mfma_f32_16x16x32_bf16 v[72:75], a[128:131], v[108:111], v[72:75]
    s_waitcnt lgkmcnt(11)
    v_mfma_f32_16x16x32_bf16 v[80:83], v[148:151], v[144:147], v[80:83]
    s_waitcnt lgkmcnt(10)
    v_mfma_f32_16x16x32_bf16 v[84:87], v[144:147], v[152:155], v[84:87]
    s_waitcnt lgkmcnt(9)
    v_mfma_f32_16x16x32_bf16 v[16:19], v[116:119], a[60:63], v[16:19]
    v_add_u32 v3, 0x10000, v3
    v_mfma_f32_16x16x32_bf16 v[48:51], v[116:119], a[132:135], v[48:51]
    v_add_u32 v4, 0x10000, v4
    s_waitcnt lgkmcnt(8)
    v_mfma_f32_16x16x32_bf16 v[20:23], v[120:123], a[60:63], v[20:23]
    v_add_u32 v5, 0x10000, v5
    v_mfma_f32_16x16x32_bf16 v[52:55], v[120:123], a[132:135], v[52:55]
    ds_read_b128 v[88:91], v3 offset:0
    s_waitcnt lgkmcnt(8)
    v_mfma_f32_16x16x32_bf16 v[24:27], v[124:127], a[60:63], v[24:27]
    ds_read_b128 v[92:95], v3 offset:1024
    v_mfma_f32_16x16x32_bf16 v[56:59], v[124:127], a[132:135], v[56:59]
    ds_read_b128 v[96:99], v3 offset:2048
    s_waitcnt lgkmcnt(9)
    v_mfma_f32_16x16x32_bf16 v[28:31], v[128:131], a[60:63], v[28:31]
    ds_read_b128 v[100:103], v3 offset:3072
    v_mfma_f32_16x16x32_bf16 v[60:63], v[128:131], a[132:135], v[60:63]
    ds_read_b128 v[112:115], v3 offset:6144
    s_waitcnt lgkmcnt(10)
    v_mfma_f32_16x16x32_bf16 v[32:35], v[140:143], a[60:63], v[32:35]
    ds_read_b128 v[104:107], v3 offset:4096
    v_mfma_f32_16x16x32_bf16 v[64:67], v[140:143], a[132:135], v[64:67]
    ds_read_b128 v[108:111], v3 offset:5120
    v_mfma_f32_16x16x32_bf16 v[44:47], a[60:63], v[140:143], v[44:47]
    ds_read_b128 v[144:147], v3 offset:7168
    v_mfma_f32_16x16x32_bf16 v[76:79], a[132:135], v[140:143], v[76:79]
    ds_read_b128 v[148:151], v4 offset:0
    s_waitcnt lgkmcnt(13)
    v_mfma_f32_16x16x32_bf16 v[36:39], a[60:63], v[132:135], v[36:39]
    ds_read_b128 v[152:155], v5 offset:0
    v_mfma_f32_16x16x32_bf16 v[68:71], a[132:135], v[132:135], v[68:71]
    s_waitcnt lgkmcnt(13)
    v_mfma_f32_16x16x32_bf16 v[40:43], a[60:63], v[136:139], v[40:43]
    v_mfma_f32_16x16x32_bf16 v[72:75], a[132:135], v[136:139], v[72:75]
    s_waitcnt lgkmcnt(11)
    v_mfma_f32_16x16x32_bf16 v[80:83], v[160:163], v[156:159], v[80:83]
    s_waitcnt lgkmcnt(10)
    v_mfma_f32_16x16x32_bf16 v[84:87], v[156:159], v[164:167], v[84:87]
    s_waitcnt lgkmcnt(9)
    v_mfma_f32_16x16x32_bf16 v[16:19], v[88:91], a[64:67], v[16:19]
    ds_read_b128 v[116:119], v3 offset:8192
    v_mfma_f32_16x16x32_bf16 v[48:51], v[88:91], a[136:139], v[48:51]
    ds_read_b128 v[120:123], v3 offset:9216
    s_waitcnt lgkmcnt(10)
    v_mfma_f32_16x16x32_bf16 v[20:23], v[92:95], a[64:67], v[20:23]
    ds_read_b128 v[124:127], v3 offset:10240
    v_mfma_f32_16x16x32_bf16 v[52:55], v[92:95], a[136:139], v[52:55]
    ds_read_b128 v[128:131], v3 offset:11264
    s_waitcnt lgkmcnt(11)
    v_mfma_f32_16x16x32_bf16 v[24:27], v[96:99], a[64:67], v[24:27]
    ds_read_b128 v[140:143], v3 offset:14336
    v_mfma_f32_16x16x32_bf16 v[56:59], v[96:99], a[136:139], v[56:59]
    ds_read_b128 v[132:135], v3 offset:12288
    s_waitcnt lgkmcnt(12)
    v_mfma_f32_16x16x32_bf16 v[28:31], v[100:103], a[64:67], v[28:31]
    ds_read_b128 v[136:139], v3 offset:13312
    v_mfma_f32_16x16x32_bf16 v[60:63], v[100:103], a[136:139], v[60:63]
    ds_read_b128 v[156:159], v3 offset:15360
    s_waitcnt lgkmcnt(13)
    v_mfma_f32_16x16x32_bf16 v[32:35], v[112:115], a[64:67], v[32:35]
    ds_read_b128 v[160:163], v4 offset:8192
    v_mfma_f32_16x16x32_bf16 v[64:67], v[112:115], a[136:139], v[64:67]
    ds_read_b128 v[164:167], v5 offset:8192
    v_mfma_f32_16x16x32_bf16 v[44:47], a[64:67], v[112:115], v[44:47]
    v_mfma_f32_16x16x32_bf16 v[76:79], a[136:139], v[112:115], v[76:79]
    s_waitcnt lgkmcnt(14)
    v_mfma_f32_16x16x32_bf16 v[36:39], a[64:67], v[104:107], v[36:39]
    v_mfma_f32_16x16x32_bf16 v[68:71], a[136:139], v[104:107], v[68:71]
    s_waitcnt lgkmcnt(13)
    v_mfma_f32_16x16x32_bf16 v[40:43], a[64:67], v[108:111], v[40:43]
    v_mfma_f32_16x16x32_bf16 v[72:75], a[136:139], v[108:111], v[72:75]
    s_waitcnt lgkmcnt(11)
    v_mfma_f32_16x16x32_bf16 v[80:83], v[148:151], v[144:147], v[80:83]
    s_waitcnt lgkmcnt(10)
    v_mfma_f32_16x16x32_bf16 v[84:87], v[144:147], v[152:155], v[84:87]
    s_waitcnt vmcnt(1) lgkmcnt(9)
    v_mfma_f32_16x16x32_bf16 v[16:19], v[116:119], a[68:71], v[16:19]
    s_waitcnt vmcnt(0)
    v_mfma_f32_16x16x32_bf16 v[48:51], v[116:119], a[140:143], v[48:51]
    s_waitcnt lgkmcnt(8)
    v_mfma_f32_16x16x32_bf16 v[20:23], v[120:123], a[68:71], v[20:23]
    v_mfma_f32_16x16x32_bf16 v[52:55], v[120:123], a[140:143], v[52:55]
    s_waitcnt lgkmcnt(7)
    v_mfma_f32_16x16x32_bf16 v[24:27], v[124:127], a[68:71], v[24:27]
    v_mfma_f32_16x16x32_bf16 v[56:59], v[124:127], a[140:143], v[56:59]
    s_waitcnt lgkmcnt(6)
    v_mfma_f32_16x16x32_bf16 v[28:31], v[128:131], a[68:71], v[28:31]
    v_mfma_f32_16x16x32_bf16 v[60:63], v[128:131], a[140:143], v[60:63]
    s_waitcnt lgkmcnt(5)
    v_mfma_f32_16x16x32_bf16 v[32:35], v[140:143], a[68:71], v[32:35]
    v_mfma_f32_16x16x32_bf16 v[64:67], v[140:143], a[140:143], v[64:67]
    v_mfma_f32_16x16x32_bf16 v[44:47], a[68:71], v[140:143], v[44:47]
    v_mfma_f32_16x16x32_bf16 v[76:79], a[140:143], v[140:143], v[76:79]
    s_waitcnt lgkmcnt(4)
    v_mfma_f32_16x16x32_bf16 v[36:39], a[68:71], v[132:135], v[36:39]
    v_mfma_f32_16x16x32_bf16 v[68:71], a[140:143], v[132:135], v[68:71]
    s_waitcnt lgkmcnt(3)
    v_mfma_f32_16x16x32_bf16 v[40:43], a[68:71], v[136:139], v[40:43]
    v_mfma_f32_16x16x32_bf16 v[72:75], a[140:143], v[136:139], v[72:75]
    s_waitcnt lgkmcnt(1)
    v_mfma_f32_16x16x32_bf16 v[80:83], v[160:163], v[156:159], v[80:83]
    s_waitcnt lgkmcnt(0)
    v_mfma_f32_16x16x32_bf16 v[84:87], v[156:159], v[164:167], v[84:87]
    v_lshlrev_b32 v6, 3, v1
    v_add_u32 v6, 147456, v6
    s_mul_i32 s52, s20, 3072
    v_add_u32 v7, s52, v6
    v_cvt_pk_bf16_f32 v100, v56, v57
    v_cvt_pk_bf16_f32 v101, v58, v59
    v_cvt_pk_bf16_f32 v104, v60, v61
    v_cvt_pk_bf16_f32 v105, v62, v63
    v_cvt_pk_bf16_f32 v134, v64, v65
    v_cvt_pk_bf16_f32 v137, v66, v67
    v_mov_b32 v102, 0
    v_mov_b32 v103, 0
    v_cvt_pk_bf16_f32 v110, v68, v69
    v_cvt_pk_bf16_f32 v111, v70, v71
    v_cvt_pk_bf16_f32 v116, v72, v73
    v_cvt_pk_bf16_f32 v117, v74, v75
    v_cvt_pk_bf16_f32 v122, v76, v77
    v_cvt_pk_bf16_f32 v123, v78, v79
    v_permlane32_swap_b32 v134, v102
    v_permlane32_swap_b32 v137, v103
    ds_write_b64 v7, v[100:101] offset:3072
    ds_write_b64 v7, v[102:103] offset:3584
    ds_write_b64 v7, v[104:105] offset:4096
    ds_write_b64 v7, v[110:111] offset:4608
    ds_write_b64 v7, v[116:117] offset:5120
    ds_write_b64 v7, v[122:123] offset:5632
    v_cvt_pk_bf16_f32 v140, v80, v81
    v_cvt_pk_bf16_f32 v141, v82, v83
    v_cvt_pk_bf16_f32 v142, v84, v85
    v_cvt_pk_bf16_f32 v143, v86, v87
    s_min_u32 s52, s20, 2
    s_lshl_b32 s53, s52, 1
    s_cmp_ge_u32 s20, 2
    s_cselect_b32 s53, 1, s53
    s_lshl_b32 s53, s53, 9
    s_add_u32 s52, s52, 3
    s_lshl_b32 s52, s52, 9
    v_add_u32 v8, s53, v6
    v_add_u32 v9, s52, v6
    s_cmp_lt_u32 s20, 2
    s_cbranch_scc1 L_noswap_22
    v_mov_b32 v10, 0
    v_mov_b32 v11, 0
    s_nop 1
    v_permlane32_swap_b32 v140, v10
    v_permlane32_swap_b32 v141, v11
    v_mov_b32 v140, v10
    v_mov_b32 v141, v11
L_noswap_22:
    ds_write_b64 v8, v[140:141]
    ds_write_b64 v9, v[142:143]
    v_cvt_pk_bf16_f32 v132, v48, v49
    v_cvt_pk_bf16_f32 v133, v50, v51
    v_cvt_pk_bf16_f32 v138, v52, v53
    v_cvt_pk_bf16_f32 v139, v54, v55
    v_mov_b32 v135, 0
    v_mov_b32 v136, 0
    v_cvt_pk_bf16_f32 v94, v24, v25
    v_cvt_pk_bf16_f32 v95, v26, v27
    v_cvt_pk_bf16_f32 v98, v28, v29
    v_cvt_pk_bf16_f32 v99, v30, v31
    v_cvt_pk_bf16_f32 v126, v32, v33
    v_cvt_pk_bf16_f32 v129, v34, v35
    v_mov_b32 v96, 0
    v_mov_b32 v97, 0
    v_cvt_pk_bf16_f32 v108, v36, v37
    v_cvt_pk_bf16_f32 v109, v38, v39
    v_cvt_pk_bf16_f32 v114, v40, v41
    v_cvt_pk_bf16_f32 v115, v42, v43
    v_cvt_pk_bf16_f32 v120, v44, v45
    v_cvt_pk_bf16_f32 v121, v46, v47
    v_permlane32_swap_b32 v126, v96
    v_permlane32_swap_b32 v129, v97
    v_cvt_pk_bf16_f32 v124, v16, v17
    v_cvt_pk_bf16_f32 v125, v18, v19
    v_cvt_pk_bf16_f32 v130, v20, v21
    v_cvt_pk_bf16_f32 v131, v22, v23
    v_mov_b32 v127, 0
    v_mov_b32 v128, 0
    v_mov_b32 v12, 0x3f803f80
    v_mov_b32 v13, 0x3f803f80
    v_mov_b32 v14, 0x3f803f80
    v_mov_b32 v15, 0x3f803f80
    v_mfma_f32_16x16x32_bf16 v[32:35], v[94:97], v[132:135], v[172:175]
    v_mfma_f32_16x16x32_bf16 v[36:39], v[100:103], v[132:135], v[168:171]
    v_mfma_f32_16x16x32_bf16 v[20:23], v[94:97], v[124:127], v[168:171]
    v_mfma_f32_16x16x32_bf16 v[40:43], v[96:99], v[136:139], v[172:175]
    v_mfma_f32_16x16x32_bf16 v[44:47], v[102:105], v[136:139], v[168:171]
    v_mfma_f32_16x16x32_bf16 v[28:31], v[96:99], v[128:131], v[168:171]
    s_waitcnt lgkmcnt(0)
    s_barrier
    ds_read_b64 v[88:89], v7 offset:0
    ds_read_b64 v[90:91], v7 offset:512
    ds_read_b64 v[92:93], v7 offset:1024
    ds_read_b64 v[106:107], v7 offset:1536
    ds_read_b64 v[112:113], v7 offset:2048
    ds_read_b64 v[118:119], v7 offset:2560
    s_mov_b32 s52, 0x3eae1a93
    s_waitcnt lgkmcnt(4)
    v_mfma_f32_16x16x32_bf16 v[16:19], v[88:91], v[124:127], v[176:179]
    s_waitcnt lgkmcnt(3)
    v_mfma_f32_16x16x32_bf16 v[24:27], v[90:93], v[128:131], v[176:179]
    v_max3_f32 v48, v32, v33, v34
    v_max3_f32 v49, v40, v41, v42
    s_nop 3
    v_max3_f32 v50, v16, v17, v18
    s_nop 0
    v_max3_f32 v51, v24, v25, v26
    v_max3_f32 v48, v48, v35, v36
    v_max3_f32 v49, v49, v43, v44
    v_max3_f32 v50, v50, v19, v20
    v_max3_f32 v51, v51, v27, v28
    v_max3_f32 v48, v48, v37, v38
    v_max3_f32 v49, v49, v45, v46
    v_max3_f32 v50, v50, v21, v22
    v_max3_f32 v51, v51, v29, v30
    v_max_f32 v48, v48, v39
    v_max_f32 v49, v49, v47
    v_max_f32 v50, v50, v23
    v_max_f32 v51, v51, v31
    v_mov_b32 v52, v48
    v_mov_b32 v53, v49
    v_mov_b32 v54, v50
    v_mov_b32 v55, v51
    v_permlane16_swap_b32 v48, v52
    v_permlane16_swap_b32 v49, v53
    v_permlane16_swap_b32 v50, v54
    v_permlane16_swap_b32 v51, v55
    v_max_f32 v48, v48, v52
    v_max_f32 v49, v49, v53
    v_max_f32 v50, v50, v54
    v_max_f32 v51, v51, v55
    v_mov_b32 v52, v48
    v_mov_b32 v53, v49
    v_mov_b32 v54, v50
    v_mov_b32 v55, v51
    v_permlane32_swap_b32 v48, v52
    v_permlane32_swap_b32 v49, v53
    v_permlane32_swap_b32 v50, v54
    v_permlane32_swap_b32 v51, v55
    v_max_f32 v48, v48, v52
    v_max_f32 v49, v49, v53
    v_max_f32 v50, v50, v54
    v_max_f32 v51, v51, v55
    v_mul_f32 v48, s52, v48
    v_mul_f32 v49, s52, v49
    v_mul_f32 v50, s52, v50
    v_mul_f32 v51, s52, v51
    v_fma_f32 v32, v32, s52, -v48
    v_fma_f32 v40, v40, s52, -v49
    v_fma_f32 v16, v16, s52, -v50
    v_fma_f32 v24, v24, s52, -v51
    v_fma_f32 v33, v33, s52, -v48
    v_fma_f32 v41, v41, s52, -v49
    v_fma_f32 v17, v17, s52, -v50
    v_fma_f32 v25, v25, s52, -v51
    v_fma_f32 v34, v34, s52, -v48
    v_fma_f32 v42, v42, s52, -v49
    v_fma_f32 v18, v18, s52, -v50
    v_fma_f32 v26, v26, s52, -v51
    v_fma_f32 v35, v35, s52, -v48
    v_fma_f32 v43, v43, s52, -v49
    v_fma_f32 v19, v19, s52, -v50
    v_fma_f32 v27, v27, s52, -v51
    v_fma_f32 v36, v36, s52, -v48
    v_fma_f32 v44, v44, s52, -v49
    v_fma_f32 v20, v20, s52, -v50
    v_fma_f32 v28, v28, s52, -v51
    v_fma_f32 v37, v37, s52, -v48
    v_fma_f32 v45, v45, s52, -v49
    v_fma_f32 v21, v21, s52, -v50
    v_fma_f32 v29, v29, s52, -v51
    v_fma_f32 v38, v38, s52, -v48
    v_fma_f32 v46, v46, s52, -v49
    v_fma_f32 v22, v22, s52, -v50
    v_fma_f32 v30, v30, s52, -v51
    v_fma_f32 v39, v39, s52, -v48
    v_fma_f32 v47, v47, s52, -v49
    v_fma_f32 v23, v23, s52, -v50
    v_fma_f32 v31, v31, s52, -v51
    v_exp_f32 v32, v32
    v_exp_f32 v40, v40
    v_exp_f32 v16, v16
    v_exp_f32 v24, v24
    v_exp_f32 v33, v33
    v_exp_f32 v41, v41
    v_exp_f32 v17, v17
    v_exp_f32 v25, v25
    v_exp_f32 v34, v34
    v_exp_f32 v42, v42
    v_exp_f32 v18, v18
    v_exp_f32 v26, v26
    v_exp_f32 v35, v35
    v_exp_f32 v43, v43
    v_exp_f32 v19, v19
    v_exp_f32 v27, v27
    v_exp_f32 v36, v36
    v_exp_f32 v44, v44
    v_exp_f32 v20, v20
    v_exp_f32 v28, v28
    v_exp_f32 v37, v37
    v_exp_f32 v45, v45
    v_exp_f32 v21, v21
    v_exp_f32 v29, v29
    v_exp_f32 v38, v38
    v_exp_f32 v46, v46
    v_exp_f32 v22, v22
    v_exp_f32 v30, v30
    v_exp_f32 v39, v39
    v_exp_f32 v47, v47
    v_exp_f32 v23, v23
    v_exp_f32 v31, v31
    v_cvt_pk_bf16_f32 v56, v32, v33
    v_cvt_pk_bf16_f32 v60, v40, v41
    v_cvt_pk_bf16_f32 v64, v16, v17
    v_cvt_pk_bf16_f32 v68, v24, v25
    v_cvt_pk_bf16_f32 v57, v34, v35
    v_cvt_pk_bf16_f32 v61, v42, v43
    v_cvt_pk_bf16_f32 v65, v18, v19
    v_cvt_pk_bf16_f32 v69, v26, v27
    v_cvt_pk_bf16_f32 v58, v36, v37
    v_cvt_pk_bf16_f32 v62, v44, v45
    v_cvt_pk_bf16_f32 v66, v20, v21
    v_cvt_pk_bf16_f32 v70, v28, v29
    v_cvt_pk_bf16_f32 v59, v38, v39
    v_cvt_pk_bf16_f32 v63, v46, v47
    v_cvt_pk_bf16_f32 v67, v22, v23
    v_cvt_pk_bf16_f32 v71, v30, v31
    v_mfma_f32_16x16x32_bf16 v[188:191], v[12:15], v[56:59], 0
    v_mfma_f32_16x16x32_bf16 v[180:183], v[108:111], v[56:59], 0
    v_mfma_f32_16x16x32_bf16 v[184:187], v[120:123], v[56:59], 0
    v_mfma_f32_16x16x32_bf16 v[200:203], v[12:15], v[60:63], 0
    v_mfma_f32_16x16x32_bf16 v[192:195], v[114:117], v[60:63], 0
    v_mfma_f32_16x16x32_bf16 v[196:199], v[120:123], v[60:63], 0
    v_mfma_f32_16x16x32_bf16 v[212:215], v[12:15], v[64:67], 0
    s_waitcnt lgkmcnt(2)
    v_mfma_f32_16x16x32_bf16 v[204:207], v[106:109], v[64:67], 0
    s_waitcnt lgkmcnt(0)
    v_mfma_f32_16x16x32_bf16 v[208:211], v[118:121], v[64:67], 0
    v_mfma_f32_16x16x32_bf16 v[224:227], v[12:15], v[68:71], 0
    v_mfma_f32_16x16x32_bf16 v[216:219], v[112:115], v[68:71], 0
    v_mfma_f32_16x16x32_bf16 v[220:223], v[118:121], v[68:71], 0
    s_lshl_b32 s53, s46, 4
    s_add_u32 s53, s53, s45
    s_lshl_b32 s54, s53, 10
    s_add_u32 s54, s54, 23330816
    s_lshl_b32 s55, s53, 7
    s_add_u32 s55, s55, 25427840
    v_lshlrev_b32 v6, 3, v1
    v_rcp_f32 v188, v188
    v_rcp_f32 v200, v200
    v_rcp_f32 v212, v212
    v_rcp_f32 v224, v224
    v_mul_f32 v180, v180, v188
    v_mul_f32 v181, v181, v188
    v_mul_f32 v182, v182, v188
    v_mul_f32 v183, v183, v188
    v_mul_f32 v184, v184, v188
    v_mul_f32 v185, v185, v188
    v_cvt_pk_bf16_f32 v76, v180, v181
    v_cvt_pk_bf16_f32 v77, v182, v183
    v_cvt_pk_bf16_f32 v82, v184, v185
    v_mul_f32 v192, v192, v200
    v_mul_f32 v193, v193, v200
    v_mul_f32 v194, v194, v200
    v_mul_f32 v195, v195, v200
    v_mul_f32 v198, v198, v200
    v_mul_f32 v199, v199, v200
    v_cvt_pk_bf16_f32 v78, v192, v193
    v_cvt_pk_bf16_f32 v79, v194, v195
    v_cvt_pk_bf16_f32 v83, v198, v199
    s_add_u32 s53, s54, 16384
    buffer_store_dwordx4 v[76:79], v2, s[4:7], s53 offen
    v_mul_f32 v204, v204, v212
    v_mul_f32 v205, v205, v212
    v_mul_f32 v206, v206, v212
    v_mul_f32 v207, v207, v212
    v_mul_f32 v208, v208, v212
    v_mul_f32 v209, v209, v212
    v_cvt_pk_bf16_f32 v72, v204, v205
    v_cvt_pk_bf16_f32 v73, v206, v207
    v_cvt_pk_bf16_f32 v80, v208, v209
    v_mul_f32 v216, v216, v224
    v_mul_f32 v217, v217, v224
    v_mul_f32 v218, v218, v224
    v_mul_f32 v219, v219, v224
    v_mul_f32 v222, v222, v224
    v_mul_f32 v223, v223, v224
    v_cvt_pk_bf16_f32 v74, v216, v217
    v_cvt_pk_bf16_f32 v75, v218, v219
    v_cvt_pk_bf16_f32 v81, v222, v223
    s_add_u32 s53, s54, 0
    buffer_store_dwordx4 v[72:75], v2, s[4:7], s53 offen
    s_mov_b32 exec_lo, 0xffff0000
    s_mov_b32 exec_hi, 0
    buffer_store_dwordx2 v[80:81], v6, s[4:7], s55 offen offset:0
    buffer_store_dwordx2 v[82:83], v6, s[4:7], s55 offen offset:2048
    s_mov_b64 exec, -1
qkv0_kernel_end:
    s_endpgm
.section .rodata,"a"
.p2align 6
.amdhsa_kernel qkv0_kernel
  .amdhsa_next_free_vgpr 400
  .amdhsa_next_free_sgpr 102
  .amdhsa_accum_offset 256
  .amdhsa_group_segment_fixed_size 0
  .amdhsa_kernarg_size 80
  .amdhsa_user_sgpr_count 2
  .amdhsa_user_sgpr_kernarg_segment_ptr 1
  .amdhsa_system_sgpr_workgroup_id_x 1
  .amdhsa_float_denorm_mode_32 3
.end_amdhsa_kernel
.text
.globl wo0_kernel
.p2align 8
.type wo0_kernel,@function
wo0_kernel:
    s_cmp_ge_u32 s2, 256
    s_cbranch_scc1 wo0_kernel_end
    s_load_dwordx16 s[24:39], s[0:1], 0
    s_load_dwordx4 s[40:43], s[0:1], 64
    v_lshrrev_b32 v1, 6, v0
    s_and_b32 s21, s2, 7
    v_readfirstlane_b32 s20, v1
    s_lshr_b32 s22, s2, 3
    v_and_b32 v1, 63, v0
    v_lshlrev_b32 v2, 4, v1
    s_waitcnt lgkmcnt(0)
    s_mov_b32 s4, s42
    s_mov_b32 s5, s43
    s_mov_b32 s6, 0x10000000
    s_mov_b32 s7, 0x20000
    s_cmp_ge_u32 s22, 24
    s_cbranch_scc1 L_cs_23
    s_mul_i32 s44, s22, 10923
    s_lshr_b32 s44, s44, 16
    s_mul_i32 s52, s44, 6
    s_sub_u32 s45, s22, s52
    s_lshl_b32 s52, s21, 2
    s_add_u32 s44, s44, s52
    s_lshl_b32 s46, s44, 2
    s_add_u32 s46, s46, s20
    s_mul_i32 s47, s45, 110592
    s_mul_i32 s48, s20, 3072
    s_add_u32 s47, s47, s48
    s_add_u32 s47, s47, 2097152
    s_lshl_b32 s49, s46, 14
    s_add_u32 s49, s49, 23330816
    s_lshl_b32 s50, s46, 11
    s_add_u32 s50, s50, 25427968
    v_and_b32 v3, 15, v1
    v_lshrrev_b32 v4, 4, v1
    v_lshlrev_b32 v5, 3, v3
    v_lshl_add_u32 v5, v4, 8, v5
    s_lshl_b32 s52, s46, 4
    v_add_u32 v6, s52, v3
    v_lshlrev_b32 v7, 3, v6
    v_mul_u32_u24 v6, 1152, v6
    v_lshl_add_u32 v6, v4, 4, v6
    s_mul_i32 s51, s45, 192
    s_mov_b32 s8, s24
    s_mov_b32 s9, s25
    s_mov_b32 s10, 0x240000
    s_mov_b32 s11, 0x20000
    s_mov_b32 m0, s48
    s_nop 0
    buffer_load_dwordx4 v2, s[4:7], s47 offen offset:0 lds
    buffer_load_dwordx4 v2, s[4:7], s47 offen offset:1024 lds
    buffer_load_dwordx4 v2, s[4:7], s47 offen offset:2048 lds
    s_add_u32 s48, s48, 12288
    s_add_u32 s47, s47, 12288
    buffer_load_dwordx4 v[16:19], v2, s[4:7], s49 offen offset:0
    buffer_load_dwordx4 v[20:23], v2, s[4:7], s49 offen offset:1024
    s_mov_b32 m0, s48
    s_nop 0
    buffer_load_dwordx4 v2, s[4:7], s47 offen offset:0 lds
    buffer_load_dwordx4 v2, s[4:7], s47 offen offset:1024 lds
    buffer_load_dwordx4 v2, s[4:7], s47 offen offset:2048 lds
    s_add_u32 s48, s48, 12288
    s_add_u32 s47, s47, 12288
    buffer_load_dwordx4 v[24:27], v2, s[4:7], s49 offen offset:2048
    buffer_load_dwordx4 v[28:31], v2, s[4:7], s49 offen offset:3072
    s_mov_b32 m0, s48
    s_nop 0
    buffer_load_dwordx4 v2, s[4:7], s47 offen offset:0 lds
    buffer_load_dwordx4 v2, s[4:7], s47 offen offset:1024 lds
    buffer_load_dwordx4 v2, s[4:7], s47 offen offset:2048 lds
    s_add_u32 s48, s48, 12288
    s_add_u32 s47, s47, 12288
    s_add_u32 s49, s49, 4096
    buffer_load_dwordx4 v[32:35], v2, s[4:7], s49 offen offset:0
    buffer_load_dwordx4 v[36:39], v2, s[4:7], s49 offen offset:1024
    s_mov_b32 m0, s48
    s_nop 0
    buffer_load_dwordx4 v2, s[4:7], s47 offen offset:0 lds
    buffer_load_dwordx4 v2, s[4:7], s47 offen offset:1024 lds
    buffer_load_dwordx4 v2, s[4:7], s47 offen offset:2048 lds
    s_add_u32 s48, s48, 12288
    s_add_u32 s47, s47, 12288
    buffer_load_dwordx4 v[40:43], v2, s[4:7], s49 offen offset:2048
    buffer_load_dwordx4 v[44:47], v2, s[4:7], s49 offen offset:3072
    s_mov_b32 m0, s48
    s_nop 0
    buffer_load_dwordx4 v2, s[4:7], s47 offen offset:0 lds
    buffer_load_dwordx4 v2, s[4:7], s47 offen offset:1024 lds
    buffer_load_dwordx4 v2, s[4:7], s47 offen offset:2048 lds
    s_add_u32 s48, s48, 12288
    s_add_u32 s47, s47, 12288
    s_add_u32 s49, s49, 4096
    buffer_load_dwordx4 v[48:51], v2, s[4:7], s49 offen offset:0
    buffer_load_dwordx4 v[52:55], v2, s[4:7], s49 offen offset:1024
    s_mov_b32 m0, s48
    s_nop 0
    buffer_load_dwordx4 v2, s[4:7], s47 offen offset:0 lds
    buffer_load_dwordx4 v2, s[4:7], s47 offen offset:1024 lds
    buffer_load_dwordx4 v2, s[4:7], s47 offen offset:2048 lds
    s_add_u32 s48, s48, 12288
    s_add_u32 s47, s47, 12288
    buffer_load_dwordx4 v[56:59], v2, s[4:7], s49 offen offset:2048
    buffer_load_dwordx4 v[60:63], v2, s[4:7], s49 offen offset:3072
    s_mov_b32 m0, s48
    s_nop 0
    buffer_load_dwordx4 v2, s[4:7], s47 offen offset:0 lds
    buffer_load_dwordx4 v2, s[4:7], s47 offen offset:1024 lds
    buffer_load_dwordx4 v2, s[4:7], s47 offen offset:2048 lds
    s_add_u32 s48, s48, 12288
    s_add_u32 s47, s47, 12288
    s_add_u32 s49, s49, 4096
    buffer_load_dwordx4 v[64:67], v2, s[4:7], s49 offen offset:0
    buffer_load_dwordx4 v[68:71], v2, s[4:7], s49 offen offset:1024
    s_mov_b32 m0, s48
    s_nop 0
    buffer_load_dwordx4 v2, s[4:7], s47 offen offset:0 lds
    buffer_load_dwordx4 v2, s[4:7], s47 offen offset:1024 lds
    buffer_load_dwordx4 v2, s[4:7], s47 offen offset:2048 lds
    s_add_u32 s48, s48, 12288
    s_add_u32 s47, s47, 12288
    buffer_load_dwordx4 v[72:75], v2, s[4:7], s49 offen offset:2048
    buffer_load_dwordx4 v[76:79], v2, s[4:7], s49 offen offset:3072
    s_mov_b32 m0, s48
    s_nop 0
    buffer_load_dwordx4 v2, s[4:7], s47 offen offset:0 lds
    buffer_load_dwordx4 v2, s[4:7], s47 offen offset:1024 lds
    buffer_load_dwordx4 v2, s[4:7], s47 offen offset:2048 lds
    s_add_u32 s48, s48, 12288
    s_add_u32 s47, s47, 12288
    buffer_load_dwordx2 v[80:81], v5, s[4:7], s50 offen offset:0
    buffer_load_dwordx2 v[82:83], v5, s[4:7], s50 offen offset:128
    buffer_load_dwordx2 v[84:85], v5, s[4:7], s50 offen offset:1024
    buffer_load_dwordx2 v[86:87], v5, s[4:7], s50 offen offset:1152
    buffer_load_dwordx4 v[160:163], v6, s[8:11], s51 offen offset:0
    buffer_load_dwordx4 v[164:167], v6, s[8:11], s51 offen offset:64
    buffer_load_dwordx4 v[168:171], v6, s[8:11], s51 offen offset:128
    v_mov_b32 v8, v2
    s_waitcnt vmcnt(37)
    s_barrier
    ds_read_b128 v[112:115], v8 offset:0
    ds_read_b128 v[116:119], v8 offset:1024
    ds_read_b128 v[120:123], v8 offset:2048
    ds_read_b128 v[124:127], v8 offset:3072
    ds_read_b128 v[128:131], v8 offset:4096
    ds_read_b128 v[132:135], v8 offset:5120
    ds_read_b128 v[136:139], v8 offset:6144
    ds_read_b128 v[140:143], v8 offset:7168
    s_waitcnt lgkmcnt(7)
    v_mfma_f32_16x16x32_bf16 v[88:91], v[112:115], v[16:19], 0
    ds_read_b128 v[144:147], v8 offset:8192
    s_waitcnt lgkmcnt(7)
    v_mfma_f32_16x16x32_bf16 v[92:95], v[116:119], v[16:19], 0
    ds_read_b128 v[148:151], v8 offset:9216
    s_waitcnt lgkmcnt(7)
    v_mfma_f32_16x16x32_bf16 v[96:99], v[120:123], v[16:19], 0
    ds_read_b128 v[152:155], v8 offset:10240
    s_waitcnt lgkmcnt(7)
    v_mfma_f32_16x16x32_bf16 v[100:103], v[124:127], v[16:19], 0
    ds_read_b128 v[156:159], v8 offset:11264
    s_waitcnt lgkmcnt(7)
    v_mfma_f32_16x16x32_bf16 v[104:107], v[128:131], v[16:19], 0
    s_waitcnt lgkmcnt(6)
    v_mfma_f32_16x16x32_bf16 v[108:111], v[132:135], v[16:19], 0
    ds_read_b128 v[112:115], v8 offset:12288
    ds_read_b128 v[116:119], v8 offset:13312
    s_waitcnt lgkmcnt(7)
    v_mfma_f32_16x16x32_bf16 v[88:91], v[136:139], v[20:23], v[88:91]
    ds_read_b128 v[120:123], v8 offset:14336
    s_waitcnt lgkmcnt(7)
    v_mfma_f32_16x16x32_bf16 v[92:95], v[140:143], v[20:23], v[92:95]
    ds_read_b128 v[124:127], v8 offset:15360
    s_waitcnt lgkmcnt(7)
    v_mfma_f32_16x16x32_bf16 v[96:99], v[144:147], v[20:23], v[96:99]
    ds_read_b128 v[128:131], v8 offset:16384
    s_waitcnt lgkmcnt(7)
    v_mfma_f32_16x16x32_bf16 v[100:103], v[148:151], v[20:23], v[100:103]
    ds_read_b128 v[132:135], v8 offset:17408
    s_waitcnt lgkmcnt(7)
    v_mfma_f32_16x16x32_bf16 v[104:107], v[152:155], v[20:23], v[104:107]
    s_waitcnt lgkmcnt(6)
    v_mfma_f32_16x16x32_bf16 v[108:111], v[156:159], v[20:23], v[108:111]
    ds_read_b128 v[136:139], v8 offset:18432
    ds_read_b128 v[140:143], v8 offset:19456
    s_waitcnt lgkmcnt(7)
    v_mfma_f32_16x16x32_bf16 v[88:91], v[112:115], v[24:27], v[88:91]
    ds_read_b128 v[144:147], v8 offset:20480
    s_waitcnt lgkmcnt(7)
    v_mfma_f32_16x16x32_bf16 v[92:95], v[116:119], v[24:27], v[92:95]
    ds_read_b128 v[148:151], v8 offset:21504
    s_waitcnt lgkmcnt(7)
    v_mfma_f32_16x16x32_bf16 v[96:99], v[120:123], v[24:27], v[96:99]
    ds_read_b128 v[152:155], v8 offset:22528
    s_waitcnt lgkmcnt(7)
    v_mfma_f32_16x16x32_bf16 v[100:103], v[124:127], v[24:27], v[100:103]
    ds_read_b128 v[156:159], v8 offset:23552
    s_waitcnt lgkmcnt(7)
    v_mfma_f32_16x16x32_bf16 v[104:107], v[128:131], v[24:27], v[104:107]
    s_waitcnt lgkmcnt(6)
    v_mfma_f32_16x16x32_bf16 v[108:111], v[132:135], v[24:27], v[108:111]
    ds_read_b128 v[112:115], v8 offset:24576
    ds_read_b128 v[116:119], v8 offset:25600
    s_waitcnt lgkmcnt(7)
    v_mfma_f32_16x16x32_bf16 v[88:91], v[136:139], v[28:31], v[88:91]
    ds_read_b128 v[120:123], v8 offset:26624
    s_waitcnt lgkmcnt(7)
    v_mfma_f32_16x16x32_bf16 v[92:95], v[140:143], v[28:31], v[92:95]
    ds_read_b128 v[124:127], v8 offset:27648
    s_waitcnt lgkmcnt(7)
    v_mfma_f32_16x16x32_bf16 v[96:99], v[144:147], v[28:31], v[96:99]
    ds_read_b128 v[128:131], v8 offset:28672
    s_waitcnt lgkmcnt(7)
    v_mfma_f32_16x16x32_bf16 v[100:103], v[148:151], v[28:31], v[100:103]
    ds_read_b128 v[132:135], v8 offset:29696
    s_waitcnt lgkmcnt(7)
    v_mfma_f32_16x16x32_bf16 v[104:107], v[152:155], v[28:31], v[104:107]
    s_waitcnt lgkmcnt(6)
    v_mfma_f32_16x16x32_bf16 v[108:111], v[156:159], v[28:31], v[108:111]
    ds_read_b128 v[136:139], v8 offset:30720
    ds_read_b128 v[140:143], v8 offset:31744
    s_waitcnt vmcnt(36) lgkmcnt(7)
    v_mfma_f32_16x16x32_bf16 v[88:91], v[112:115], v[32:35], v[88:91]
    ds_read_b128 v[144:147], v8 offset:32768
    s_waitcnt lgkmcnt(7)
    v_mfma_f32_16x16x32_bf16 v[92:95], v[116:119], v[32:35], v[92:95]
    ds_read_b128 v[148:151], v8 offset:33792
    s_waitcnt lgkmcnt(7)
    v_mfma_f32_16x16x32_bf16 v[96:99], v[120:123], v[32:35], v[96:99]
    ds_read_b128 v[152:155], v8 offset:34816
    s_waitcnt lgkmcnt(7)
    v_mfma_f32_16x16x32_bf16 v[100:103], v[124:127], v[32:35], v[100:103]
    ds_read_b128 v[156:159], v8 offset:35840
    s_waitcnt lgkmcnt(7)
    v_mfma_f32_16x16x32_bf16 v[104:107], v[128:131], v[32:35], v[104:107]
    s_waitcnt lgkmcnt(6)
    v_mfma_f32_16x16x32_bf16 v[108:111], v[132:135], v[32:35], v[108:111]
    s_waitcnt vmcnt(22)
    s_barrier
    s_waitcnt lgkmcnt(5)
    v_mfma_f32_16x16x32_bf16 v[88:91], v[136:139], v[36:39], v[88:91]
    ds_read_b128 v[112:115], v8 offset:36864
    ds_read_b128 v[116:119], v8 offset:37888
    s_waitcnt lgkmcnt(6)
    v_mfma_f32_16x16x32_bf16 v[92:95], v[140:143], v[36:39], v[92:95]
    ds_read_b128 v[120:123], v8 offset:38912
    ds_read_b128 v[124:127], v8 offset:39936
    s_waitcnt lgkmcnt(7)
    v_mfma_f32_16x16x32_bf16 v[96:99], v[144:147], v[36:39], v[96:99]
    ds_read_b128 v[128:131], v8 offset:40960
    s_waitcnt lgkmcnt(7)
    v_mfma_f32_16x16x32_bf16 v[100:103], v[148:151], v[36:39], v[100:103]
    ds_read_b128 v[132:135], v8 offset:41984
    s_waitcnt lgkmcnt(7)
    v_mfma_f32_16x16x32_bf16 v[104:107], v[152:155], v[36:39], v[104:107]
    s_waitcnt lgkmcnt(6)
    v_mfma_f32_16x16x32_bf16 v[108:111], v[156:159], v[36:39], v[108:111]
    ds_read_b128 v[136:139], v8 offset:43008
    ds_read_b128 v[140:143], v8 offset:44032
    s_waitcnt lgkmcnt(7)
    v_mfma_f32_16x16x32_bf16 v[88:91], v[112:115], v[40:43], v[88:91]
    ds_read_b128 v[144:147], v8 offset:45056
    s_waitcnt lgkmcnt(7)
    v_mfma_f32_16x16x32_bf16 v[92:95], v[116:119], v[40:43], v[92:95]
    ds_read_b128 v[148:151], v8 offset:46080
    s_waitcnt lgkmcnt(7)
    v_mfma_f32_16x16x32_bf16 v[96:99], v[120:123], v[40:43], v[96:99]
    ds_read_b128 v[152:155], v8 offset:47104
    s_waitcnt lgkmcnt(7)
    v_mfma_f32_16x16x32_bf16 v[100:103], v[124:127], v[40:43], v[100:103]
    ds_read_b128 v[156:159], v8 offset:48128
    s_waitcnt lgkmcnt(7)
    v_mfma_f32_16x16x32_bf16 v[104:107], v[128:131], v[40:43], v[104:107]
    s_waitcnt lgkmcnt(6)
    v_mfma_f32_16x16x32_bf16 v[108:111], v[132:135], v[40:43], v[108:111]
    ds_read_b128 v[112:115], v8 offset:49152
    ds_read_b128 v[116:119], v8 offset:50176
    s_waitcnt lgkmcnt(7)
    v_mfma_f32_16x16x32_bf16 v[88:91], v[136:139], v[44:47], v[88:91]
    ds_read_b128 v[120:123], v8 offset:51200
    s_waitcnt lgkmcnt(7)
    v_mfma_f32_16x16x32_bf16 v[92:95], v[140:143], v[44:47], v[92:95]
    ds_read_b128 v[124:127], v8 offset:52224
    s_waitcnt lgkmcnt(7)
    v_mfma_f32_16x16x32_bf16 v[96:99], v[144:147], v[44:47], v[96:99]
    ds_read_b128 v[128:131], v8 offset:53248
    s_waitcnt lgkmcnt(7)
    v_mfma_f32_16x16x32_bf16 v[100:103], v[148:151], v[44:47], v[100:103]
    ds_read_b128 v[132:135], v8 offset:54272
    s_waitcnt lgkmcnt(7)
    v_mfma_f32_16x16x32_bf16 v[104:107], v[152:155], v[44:47], v[104:107]
    s_waitcnt lgkmcnt(6)
    v_mfma_f32_16x16x32_bf16 v[108:111], v[156:159], v[44:47], v[108:111]
    ds_read_b128 v[136:139], v8 offset:55296
    ds_read_b128 v[140:143], v8 offset:56320
    s_waitcnt lgkmcnt(7)
    v_mfma_f32_16x16x32_bf16 v[88:91], v[112:115], v[48:51], v[88:91]
    ds_read_b128 v[144:147], v8 offset:57344
    s_waitcnt lgkmcnt(7)
    v_mfma_f32_16x16x32_bf16 v[92:95], v[116:119], v[48:51], v[92:95]
    ds_read_b128 v[148:151], v8 offset:58368
    s_waitcnt lgkmcnt(7)
    v_mfma_f32_16x16x32_bf16 v[96:99], v[120:123], v[48:51], v[96:99]
    ds_read_b128 v[152:155], v8 offset:59392
    s_waitcnt lgkmcnt(7)
    v_mfma_f32_16x16x32_bf16 v[100:103], v[124:127], v[48:51], v[100:103]
    ds_read_b128 v[156:159], v8 offset:60416
    s_waitcnt lgkmcnt(7)
    v_mfma_f32_16x16x32_bf16 v[104:107], v[128:131], v[48:51], v[104:107]
    s_waitcnt lgkmcnt(6)
    v_mfma_f32_16x16x32_bf16 v[108:111], v[132:135], v[48:51], v[108:111]
    v_add_u32 v8, 61440, v8
    ds_read_b128 v[112:115], v8 offset:0
    s_waitcnt lgkmcnt(6)
    v_mfma_f32_16x16x32_bf16 v[88:91], v[136:139], v[52:55], v[88:91]
    ds_read_b128 v[116:119], v8 offset:1024
    s_waitcnt lgkmcnt(6)
    v_mfma_f32_16x16x32_bf16 v[92:95], v[140:143], v[52:55], v[92:95]
    ds_read_b128 v[120:123], v8 offset:2048
    s_waitcnt lgkmcnt(6)
    v_mfma_f32_16x16x32_bf16 v[96:99], v[144:147], v[52:55], v[96:99]
    ds_read_b128 v[124:127], v8 offset:3072
    s_waitcnt lgkmcnt(6)
    v_mfma_f32_16x16x32_bf16 v[100:103], v[148:151], v[52:55], v[100:103]
    ds_read_b128 v[128:131], v8 offset:4096
    s_waitcnt lgkmcnt(6)
    v_mfma_f32_16x16x32_bf16 v[104:107], v[152:155], v[52:55], v[104:107]
    ds_read_b128 v[132:135], v8 offset:5120
    s_waitcnt lgkmcnt(6)
    v_mfma_f32_16x16x32_bf16 v[108:111], v[156:159], v[52:55], v[108:111]
    ds_read_b128 v[136:139], v8 offset:6144
    ds_read_b128 v[140:143], v8 offset:7168
    s_waitcnt vmcnt(21) lgkmcnt(7)
    v_mfma_f32_16x16x32_bf16 v[88:91], v[112:115], v[56:59], v[88:91]
    ds_read_b128 v[144:147], v8 offset:8192
    s_waitcnt lgkmcnt(7)
    v_mfma_f32_16x16x32_bf16 v[92:95], v[116:119], v[56:59], v[92:95]
    ds_read_b128 v[148:151], v8 offset:9216
    s_waitcnt lgkmcnt(7)
    v_mfma_f32_16x16x32_bf16 v[96:99], v[120:123], v[56:59], v[96:99]
    ds_read_b128 v[152:155], v8 offset:10240
    s_waitcnt lgkmcnt(7)
    v_mfma_f32_16x16x32_bf16 v[100:103], v[124:127], v[56:59], v[100:103]
    ds_read_b128 v[156:159], v8 offset:11264
    s_waitcnt lgkmcnt(7)
    v_mfma_f32_16x16x32_bf16 v[104:107], v[128:131], v[56:59], v[104:107]
    s_waitcnt lgkmcnt(6)
    v_mfma_f32_16x16x32_bf16 v[108:111], v[132:135], v[56:59], v[108:111]
    s_waitcnt vmcnt(7)
    s_barrier
    s_waitcnt lgkmcnt(5)
    v_mfma_f32_16x16x32_bf16 v[88:91], v[136:139], v[60:63], v[88:91]
    ds_read_b128 v[112:115], v8 offset:12288
    ds_read_b128 v[116:119], v8 offset:13312
    s_waitcnt lgkmcnt(6)
    v_mfma_f32_16x16x32_bf16 v[92:95], v[140:143], v[60:63], v[92:95]
    ds_read_b128 v[120:123], v8 offset:14336
    ds_read_b128 v[124:127], v8 offset:15360
    s_waitcnt lgkmcnt(7)
    v_mfma_f32_16x16x32_bf16 v[96:99], v[144:147], v[60:63], v[96:99]
    ds_read_b128 v[128:131], v8 offset:16384
    s_waitcnt lgkmcnt(7)
    v_mfma_f32_16x16x32_bf16 v[100:103], v[148:151], v[60:63], v[100:103]
    ds_read_b128 v[132:135], v8 offset:17408
    s_waitcnt lgkmcnt(7)
    v_mfma_f32_16x16x32_bf16 v[104:107], v[152:155], v[60:63], v[104:107]
    s_waitcnt lgkmcnt(6)
    v_mfma_f32_16x16x32_bf16 v[108:111], v[156:159], v[60:63], v[108:111]
    ds_read_b128 v[136:139], v8 offset:18432
    ds_read_b128 v[140:143], v8 offset:19456
    s_waitcnt lgkmcnt(7)
    v_mfma_f32_16x16x32_bf16 v[88:91], v[112:115], v[64:67], v[88:91]
    ds_read_b128 v[144:147], v8 offset:20480
    s_waitcnt lgkmcnt(7)
    v_mfma_f32_16x16x32_bf16 v[92:95], v[116:119], v[64:67], v[92:95]
    ds_read_b128 v[148:151], v8 offset:21504
    s_waitcnt lgkmcnt(7)
    v_mfma_f32_16x16x32_bf16 v[96:99], v[120:123], v[64:67], v[96:99]
    ds_read_b128 v[152:155], v8 offset:22528
    s_waitcnt lgkmcnt(7)
    v_mfma_f32_16x16x32_bf16 v[100:103], v[124:127], v[64:67], v[100:103]
    ds_read_b128 v[156:159], v8 offset:23552
    s_waitcnt lgkmcnt(7)
    v_mfma_f32_16x16x32_bf16 v[104:107], v[128:131], v[64:67], v[104:107]
    s_waitcnt lgkmcnt(6)
    v_mfma_f32_16x16x32_bf16 v[108:111], v[132:135], v[64:67], v[108:111]
    ds_read_b128 v[112:115], v8 offset:24576
    ds_read_b128 v[116:119], v8 offset:25600
    s_waitcnt lgkmcnt(7)
    v_mfma_f32_16x16x32_bf16 v[88:91], v[136:139], v[68:71], v[88:91]
    ds_read_b128 v[120:123], v8 offset:26624
    s_waitcnt lgkmcnt(7)
    v_mfma_f32_16x16x32_bf16 v[92:95], v[140:143], v[68:71], v[92:95]
    ds_read_b128 v[124:127], v8 offset:27648
    s_waitcnt lgkmcnt(7)
    v_mfma_f32_16x16x32_bf16 v[96:99], v[144:147], v[68:71], v[96:99]
    ds_read_b128 v[128:131], v8 offset:28672
    s_waitcnt lgkmcnt(7)
    v_mfma_f32_16x16x32_bf16 v[100:103], v[148:151], v[68:71], v[100:103]
    ds_read_b128 v[132:135], v8 offset:29696
    s_waitcnt lgkmcnt(7)
    v_mfma_f32_16x16x32_bf16 v[104:107], v[152:155], v[68:71], v[104:107]
    s_waitcnt lgkmcnt(6)
    v_mfma_f32_16x16x32_bf16 v[108:111], v[156:159], v[68:71], v[108:111]
    ds_read_b128 v[136:139], v8 offset:30720
    ds_read_b128 v[140:143], v8 offset:31744
    s_waitcnt lgkmcnt(7)
    v_mfma_f32_16x16x32_bf16 v[88:91], v[112:115], v[72:75], v[88:91]
    ds_read_b128 v[144:147], v8 offset:32768
    s_waitcnt lgkmcnt(7)
    v_mfma_f32_16x16x32_bf16 v[92:95], v[116:119], v[72:75], v[92:95]
    ds_read_b128 v[148:151], v8 offset:33792
    s_waitcnt lgkmcnt(7)
    v_mfma_f32_16x16x32_bf16 v[96:99], v[120:123], v[72:75], v[96:99]
    ds_read_b128 v[152:155], v8 offset:34816
    s_waitcnt lgkmcnt(7)
    v_mfma_f32_16x16x32_bf16 v[100:103], v[124:127], v[72:75], v[100:103]
    ds_read_b128 v[156:159], v8 offset:35840
    s_waitcnt lgkmcnt(7)
    v_mfma_f32_16x16x32_bf16 v[104:107], v[128:131], v[72:75], v[104:107]
    s_waitcnt lgkmcnt(6)
    v_mfma_f32_16x16x32_bf16 v[108:111], v[132:135], v[72:75], v[108:111]
    ds_read_b128 v[112:115], v8 offset:36864
    ds_read_b128 v[116:119], v8 offset:37888
    s_waitcnt lgkmcnt(7)
    v_mfma_f32_16x16x32_bf16 v[88:91], v[136:139], v[76:79], v[88:91]
    ds_read_b128 v[120:123], v8 offset:38912
    s_waitcnt lgkmcnt(7)
    v_mfma_f32_16x16x32_bf16 v[92:95], v[140:143], v[76:79], v[92:95]
    ds_read_b128 v[124:127], v8 offset:39936
    s_waitcnt lgkmcnt(7)
    v_mfma_f32_16x16x32_bf16 v[96:99], v[144:147], v[76:79], v[96:99]
    ds_read_b128 v[128:131], v8 offset:40960
    s_waitcnt lgkmcnt(7)
    v_mfma_f32_16x16x32_bf16 v[100:103], v[148:151], v[76:79], v[100:103]
    ds_read_b128 v[132:135], v8 offset:41984
    s_waitcnt lgkmcnt(7)
    v_mfma_f32_16x16x32_bf16 v[104:107], v[152:155], v[76:79], v[104:107]
    s_waitcnt lgkmcnt(6)
    v_mfma_f32_16x16x32_bf16 v[108:111], v[156:159], v[76:79], v[108:111]
    ds_read_b128 v[136:139], v8 offset:43008
    ds_read_b128 v[140:143], v8 offset:44032
    s_waitcnt vmcnt(5) lgkmcnt(7)
    v_mfma_f32_16x16x32_bf16 v[88:91], v[112:115], v[80:83], v[88:91]
    ds_read_b128 v[144:147], v8 offset:45056
    s_waitcnt lgkmcnt(7)
    v_mfma_f32_16x16x32_bf16 v[92:95], v[116:119], v[80:83], v[92:95]
    ds_read_b128 v[148:151], v8 offset:46080
    s_waitcnt lgkmcnt(7)
    v_mfma_f32_16x16x32_bf16 v[96:99], v[120:123], v[80:83], v[96:99]
    ds_read_b128 v[152:155], v8 offset:47104
    s_waitcnt lgkmcnt(7)
    v_mfma_f32_16x16x32_bf16 v[100:103], v[124:127], v[80:83], v[100:103]
    ds_read_b128 v[156:159], v8 offset:48128
    s_waitcnt lgkmcnt(7)
    v_mfma_f32_16x16x32_bf16 v[104:107], v[128:131], v[80:83], v[104:107]
    s_waitcnt lgkmcnt(6)
    v_mfma_f32_16x16x32_bf16 v[108:111], v[132:135], v[80:83], v[108:111]
    s_waitcnt vmcnt(3) lgkmcnt(5)
    v_mfma_f32_16x16x32_bf16 v[88:91], v[136:139], v[84:87], v[88:91]
    s_waitcnt lgkmcnt(4)
    v_mfma_f32_16x16x32_bf16 v[92:95], v[140:143], v[84:87], v[92:95]
    s_waitcnt lgkmcnt(3)
    v_mfma_f32_16x16x32_bf16 v[96:99], v[144:147], v[84:87], v[96:99]
    s_waitcnt lgkmcnt(2)
    v_mfma_f32_16x16x32_bf16 v[100:103], v[148:151], v[84:87], v[100:103]
    s_waitcnt lgkmcnt(1)
    v_mfma_f32_16x16x32_bf16 v[104:107], v[152:155], v[84:87], v[104:107]
    s_waitcnt lgkmcnt(0)
    v_mfma_f32_16x16x32_bf16 v[108:111], v[156:159], v[84:87], v[108:111]
    s_waitcnt vmcnt(2)
    v_lshlrev_b32 v16, 16, v160
    v_and_b32 v17, 0xffff0000, v160
    v_lshlrev_b32 v18, 16, v161
    v_and_b32 v19, 0xffff0000, v161
    v_lshlrev_b32 v20, 16, v162
    v_and_b32 v21, 0xffff0000, v162
    v_lshlrev_b32 v22, 16, v163
    v_and_b32 v23, 0xffff0000, v163
    s_waitcnt vmcnt(1)
    v_lshlrev_b32 v24, 16, v164
    v_and_b32 v25, 0xffff0000, v164
    v_lshlrev_b32 v26, 16, v165
    v_and_b32 v27, 0xffff0000, v165
    v_lshlrev_b32 v28, 16, v166
    v_and_b32 v29, 0xffff0000, v166
    v_lshlrev_b32 v30, 16, v167
    v_and_b32 v31, 0xffff0000, v167
    s_waitcnt vmcnt(0)
    v_lshlrev_b32 v32, 16, v168
    v_and_b32 v33, 0xffff0000, v168
    v_lshlrev_b32 v34, 16, v169
    v_and_b32 v35, 0xffff0000, v169
    v_lshlrev_b32 v36, 16, v170
    v_and_b32 v37, 0xffff0000, v170
    v_lshlrev_b32 v38, 16, v171
    v_and_b32 v39, 0xffff0000, v171
    v_add_f32 v16, v16, v88
    v_add_f32 v17, v17, v89
    v_add_f32 v18, v18, v90
    v_add_f32 v19, v19, v91
    v_add_f32 v20, v20, v92
    v_add_f32 v21, v21, v93
    v_add_f32 v22, v22, v94
    v_add_f32 v23, v23, v95
    v_add_f32 v24, v24, v96
    v_add_f32 v25, v25, v97
    v_add_f32 v26, v26, v98
    v_add_f32 v27, v27, v99
    v_add_f32 v28, v28, v100
    v_add_f32 v29, v29, v101
    v_add_f32 v30, v30, v102
    v_add_f32 v31, v31, v103
    v_add_f32 v32, v32, v104
    v_add_f32 v33, v33, v105
    v_add_f32 v34, v34, v106
    v_add_f32 v35, v35, v107
    v_add_f32 v36, v36, v108
    v_add_f32 v37, v37, v109
    v_add_f32 v38, v38, v110
    v_add_f32 v39, v39, v111
    s_mul_i32 s52, s46, 18
    s_mul_i32 s53, s45, 3
    s_add_u32 s52, s52, s53
    s_lshl_b32 s52, s52, 10
    s_add_u32 s52, s52, 25690112
    v_cvt_pk_bf16_f32 v40, v16, v17
    v_cvt_pk_bf16_f32 v41, v18, v19
    v_cvt_pk_bf16_f32 v42, v20, v21
    v_cvt_pk_bf16_f32 v43, v22, v23
    buffer_store_dwordx4 v[40:43], v2, s[4:7], s52 offen offset:0
    v_cvt_pk_bf16_f32 v44, v24, v25
    v_cvt_pk_bf16_f32 v45, v26, v27
    v_cvt_pk_bf16_f32 v46, v28, v29
    v_cvt_pk_bf16_f32 v47, v30, v31
    buffer_store_dwordx4 v[44:47], v2, s[4:7], s52 offen offset:1024
    v_cvt_pk_bf16_f32 v48, v32, v33
    v_cvt_pk_bf16_f32 v49, v34, v35
    v_cvt_pk_bf16_f32 v50, v36, v37
    v_cvt_pk_bf16_f32 v51, v38, v39
    buffer_store_dwordx4 v[48:51], v2, s[4:7], s52 offen offset:2048
    v_lshlrev_b32 v16, 16, v40
    v_and_b32 v17, 0xffff0000, v40
    v_lshlrev_b32 v18, 16, v41
    v_and_b32 v19, 0xffff0000, v41
    v_lshlrev_b32 v20, 16, v42
    v_and_b32 v21, 0xffff0000, v42
    v_lshlrev_b32 v22, 16, v43
    v_and_b32 v23, 0xffff0000, v43
    v_lshlrev_b32 v24, 16, v44
    v_and_b32 v25, 0xffff0000, v44
    v_lshlrev_b32 v26, 16, v45
    v_and_b32 v27, 0xffff0000, v45
    v_lshlrev_b32 v28, 16, v46
    v_and_b32 v29, 0xffff0000, v46
    v_lshlrev_b32 v30, 16, v47
    v_and_b32 v31, 0xffff0000, v47
    v_lshlrev_b32 v32, 16, v48
    v_and_b32 v33, 0xffff0000, v48
    v_lshlrev_b32 v34, 16, v49
    v_and_b32 v35, 0xffff0000, v49
    v_lshlrev_b32 v36, 16, v50
    v_and_b32 v37, 0xffff0000, v50
    v_lshlrev_b32 v38, 16, v51
    v_and_b32 v39, 0xffff0000, v51
    v_add_f32 v56, v16, v17
    v_add_f32 v58, v18, v19
    v_add_f32 v56, v56, v20
    v_add_f32 v58, v58, v21
    v_add_f32 v56, v56, v22
    v_add_f32 v58, v58, v23
    v_add_f32 v56, v56, v24
    v_add_f32 v58, v58, v25
    v_add_f32 v56, v56, v26
    v_add_f32 v58, v58, v27
    v_add_f32 v56, v56, v28
    v_add_f32 v58, v58, v29
    v_add_f32 v56, v56, v30
    v_add_f32 v58, v58, v31
    v_add_f32 v56, v56, v32
    v_add_f32 v58, v58, v33
    v_add_f32 v56, v56, v34
    v_add_f32 v58, v58, v35
    v_add_f32 v56, v56, v36
    v_add_f32 v58, v58, v37
    v_add_f32 v56, v56, v38
    v_add_f32 v58, v58, v39
    v_add_f32 v56, v56, v58
    v_mov_b32 v58, v56
    s_nop 1
    v_permlane16_swap_b32 v56, v58
    v_add_f32 v56, v56, v58
    v_mov_b32 v58, v56
    s_nop 1
    v_permlane32_swap_b32 v56, v58
    v_add_f32 v56, v56, v58
    v_mul_f32 v59, 0x3c2aaaab, v56
    v_sub_f32 v58, v16, v59
    v_mul_f32 v57, v58, v58
    v_sub_f32 v61, v17, v59
    v_fmac_f32 v57, v61, v61
    v_sub_f32 v60, v18, v59
    v_fmac_f32 v57, v60, v60
    v_sub_f32 v61, v19, v59
    v_fmac_f32 v57, v61, v61
    v_sub_f32 v60, v20, v59
    v_fmac_f32 v57, v60, v60
    v_sub_f32 v61, v21, v59
    v_fmac_f32 v57, v61, v61
    v_sub_f32 v60, v22, v59
    v_fmac_f32 v57, v60, v60
    v_sub_f32 v61, v23, v59
    v_fmac_f32 v57, v61, v61
    v_sub_f32 v60, v24, v59
    v_fmac_f32 v57, v60, v60
    v_sub_f32 v61, v25, v59
    v_fmac_f32 v57, v61, v61
    v_sub_f32 v60, v26, v59
    v_fmac_f32 v57, v60, v60
    v_sub_f32 v61, v27, v59
    v_fmac_f32 v57, v61, v61
    v_sub_f32 v60, v28, v59
    v_fmac_f32 v57, v60, v60
    v_sub_f32 v61, v29, v59
    v_fmac_f32 v57, v61, v61
    v_sub_f32 v60, v30, v59
    v_fmac_f32 v57, v60, v60
    v_sub_f32 v61, v31, v59
    v_fmac_f32 v57, v61, v61
    v_sub_f32 v60, v32, v59
    v_fmac_f32 v57, v60, v60
    v_sub_f32 v61, v33, v59
    v_fmac_f32 v57, v61, v61
    v_sub_f32 v60, v34, v59
    v_fmac_f32 v57, v60, v60
    v_sub_f32 v61, v35, v59
    v_fmac_f32 v57, v61, v61
    v_sub_f32 v60, v36, v59
    v_fmac_f32 v57, v60, v60
    v_sub_f32 v61, v37, v59
    v_fmac_f32 v57, v61, v61
    v_sub_f32 v60, v38, v59
    v_fmac_f32 v57, v60, v60
    v_sub_f32 v61, v39, v59
    v_fmac_f32 v57, v61, v61
    v_mov_b32 v58, v57
    s_nop 1
    v_permlane16_swap_b32 v57, v58
    v_add_f32 v57, v57, v58
    v_mov_b32 v58, v57
    s_nop 1
    v_permlane32_swap_b32 v57, v58
    v_add_f32 v57, v57, v58
    s_lshl_b32 s52, s45, 14
    s_add_u32 s52, s52, 28049408
    s_mov_b32 exec_lo, 0xffff
    s_mov_b32 exec_hi, 0
    buffer_store_dwordx2 v[56:57], v7, s[4:7], s52 offen
    s_mov_b64 exec, -1
    s_waitcnt vmcnt(0) lgkmcnt(0)
    s_branch wo0_kernel_end
L_cs_23:
    s_cmp_lg_u32 s20, 0
    s_cbranch_scc1 wo0_kernel_end
    s_lshl_b32 s23, s21, 3
    s_add_u32 s23, s23, s22
    s_sub_u32 s23, s23, 24
    s_mul_i32 s44, s23, 10368
    s_add_u32 s44, s44, 2883584
    s_lshr_b32 s45, s23, 1
    s_mul_i32 s45, s45, 1152
    s_and_b32 s46, s23, 1
    s_lshl_b32 s46, s46, 6
    s_add_u32 s45, s45, s46
    s_add_u32 s45, s45, 3670016
    v_lshrrev_b32 v3, 2, v1
    v_lshlrev_b32 v3, 7, v3
    v_and_b32 v4, 3, v1
    v_lshl_add_u32 v3, v4, 4, v3
    s_mov_b32 exec_hi, 15
    buffer_load_dwordx4 v[8:11], v2, s[4:7], s44 offen offset:0
    buffer_load_dwordx4 v[12:15], v2, s[4:7], s44 offen offset:576
    buffer_load_dwordx4 v[16:19], v2, s[4:7], s44 offen offset:1152
    buffer_load_dwordx4 v[20:23], v2, s[4:7], s44 offen offset:1728
    buffer_load_dwordx4 v[24:27], v2, s[4:7], s44 offen offset:2304
    buffer_load_dwordx4 v[28:31], v2, s[4:7], s44 offen offset:2880
    s_add_u32 s44, s44, 3456
    buffer_load_dwordx4 v[32:35], v2, s[4:7], s44 offen offset:0
    buffer_load_dwordx4 v[36:39], v2, s[4:7], s44 offen offset:576
    buffer_load_dwordx4 v[40:43], v2, s[4:7], s44 offen offset:1152
    buffer_load_dwordx4 v[44:47], v2, s[4:7], s44 offen offset:1728
    buffer_load_dwordx4 v[48:51], v2, s[4:7], s44 offen offset:2304
    buffer_load_dwordx4 v[52:55], v2, s[4:7], s44 offen offset:2880
    s_add_u32 s44, s44, 3456
    buffer_load_dwordx4 v[56:59], v2, s[4:7], s44 offen offset:0
    buffer_load_dwordx4 v[60:63], v2, s[4:7], s44 offen offset:576
    buffer_load_dwordx4 v[64:67], v2, s[4:7], s44 offen offset:1152
    buffer_load_dwordx4 v[68:71], v2, s[4:7], s44 offen offset:1728
    buffer_load_dwordx4 v[72:75], v2, s[4:7], s44 offen offset:2304
    buffer_load_dwordx4 v[76:79], v2, s[4:7], s44 offen offset:2880
    s_waitcnt vmcnt(16)
    v_add_f32 v8, v8, v12
    v_add_f32 v9, v9, v13
    v_add_f32 v10, v10, v14
    v_add_f32 v11, v11, v15
    s_waitcnt vmcnt(15)
    v_add_f32 v8, v8, v16
    v_add_f32 v9, v9, v17
    v_add_f32 v10, v10, v18
    v_add_f32 v11, v11, v19
    s_waitcnt vmcnt(14)
    v_add_f32 v8, v8, v20
    v_add_f32 v9, v9, v21
    v_add_f32 v10, v10, v22
    v_add_f32 v11, v11, v23
    s_waitcnt vmcnt(13)
    v_add_f32 v8, v8, v24
    v_add_f32 v9, v9, v25
    v_add_f32 v10, v10, v26
    v_add_f32 v11, v11, v27
    s_waitcnt vmcnt(12)
    v_add_f32 v8, v8, v28
    v_add_f32 v9, v9, v29
    v_add_f32 v10, v10, v30
    v_add_f32 v11, v11, v31
    s_waitcnt vmcnt(11)
    v_add_f32 v8, v8, v32
    v_add_f32 v9, v9, v33
    v_add_f32 v10, v10, v34
    v_add_f32 v11, v11, v35
    s_waitcnt vmcnt(10)
    v_add_f32 v8, v8, v36
    v_add_f32 v9, v9, v37
    v_add_f32 v10, v10, v38
    v_add_f32 v11, v11, v39
    s_waitcnt vmcnt(9)
    v_add_f32 v8, v8, v40
    v_add_f32 v9, v9, v41
    v_add_f32 v10, v10, v42
    v_add_f32 v11, v11, v43
    s_waitcnt vmcnt(8)
    v_add_f32 v8, v8, v44
    v_add_f32 v9, v9, v45
    v_add_f32 v10, v10, v46
    v_add_f32 v11, v11, v47
    s_waitcnt vmcnt(7)
    v_add_f32 v8, v8, v48
    v_add_f32 v9, v9, v49
    v_add_f32 v10, v10, v50
    v_add_f32 v11, v11, v51
    s_waitcnt vmcnt(6)
    v_add_f32 v8, v8, v52
    v_add_f32 v9, v9, v53
    v_add_f32 v10, v10, v54
    v_add_f32 v11, v11, v55
    s_waitcnt vmcnt(5)
    v_add_f32 v8, v8, v56
    v_add_f32 v9, v9, v57
    v_add_f32 v10, v10, v58
    v_add_f32 v11, v11, v59
    s_waitcnt vmcnt(4)
    v_add_f32 v8, v8, v60
    v_add_f32 v9, v9, v61
    v_add_f32 v10, v10, v62
    v_add_f32 v11, v11, v63
    s_waitcnt vmcnt(3)
    v_add_f32 v8, v8, v64
    v_add_f32 v9, v9, v65
    v_add_f32 v10, v10, v66
    v_add_f32 v11, v11, v67
    s_waitcnt vmcnt(2)
    v_add_f32 v8, v8, v68
    v_add_f32 v9, v9, v69
    v_add_f32 v10, v10, v70
    v_add_f32 v11, v11, v71
    s_waitcnt vmcnt(1)
    v_add_f32 v8, v8, v72
    v_add_f32 v9, v9, v73
    v_add_f32 v10, v10, v74
    v_add_f32 v11, v11, v75
    s_waitcnt vmcnt(0)
    v_add_f32 v8, v8, v76
    v_add_f32 v9, v9, v77
    v_add_f32 v10, v10, v78
    v_add_f32 v11, v11, v79
    buffer_store_dwordx4 v[8:11], v3, s[4:7], s45 offen
    s_mov_b64 exec, -1
wo0_kernel_end:
    s_endpgm
.section .rodata,"a"
.p2align 6
.amdhsa_kernel wo0_kernel
  .amdhsa_next_free_vgpr 176
  .amdhsa_next_free_sgpr 102
  .amdhsa_accum_offset 176
  .amdhsa_group_segment_fixed_size 0
  .amdhsa_kernarg_size 80
  .amdhsa_user_sgpr_count 2
  .amdhsa_user_sgpr_kernarg_segment_ptr 1
  .amdhsa_system_sgpr_workgroup_id_x 1
  .amdhsa_float_denorm_mode_32 3
.end_amdhsa_kernel
.text
.globl ffn0_kernel
.p2align 8
.type ffn0_kernel,@function
ffn0_kernel:
    s_cmp_ge_u32 s2, 256
    s_cbranch_scc1 ffn0_kernel_end
    s_load_dwordx16 s[24:39], s[0:1], 0
    s_load_dwordx4 s[40:43], s[0:1], 64
    v_lshrrev_b32 v1, 6, v0
    s_and_b32 s21, s2, 7
    v_readfirstlane_b32 s20, v1
    s_lshr_b32 s22, s2, 3
    v_and_b32 v1, 63, v0
    v_lshlrev_b32 v2, 4, v1
    s_waitcnt lgkmcnt(0)
    s_mov_b32 s4, s42
    s_mov_b32 s5, s43
    s_mov_b32 s6, 0x10000000
    s_mov_b32 s7, 0x20000
    s_lshr_b32 s44, s22, 4
    s_and_b32 s60, s21, 6
    s_add_u32 s44, s44, s60
    s_and_b32 s60, s21, 1
    s_lshl_b32 s60, s60, 4
    s_and_b32 s47, s22, 15
    s_add_u32 s47, s47, s60
    s_lshr_b32 s45, s47, 2
    s_and_b32 s46, s47, 3
    s_mul_i32 s48, s47, 497664
    s_add_u32 s48, s48, 4194304
    s_mul_i32 s63, s20, 9
    s_lshr_b32 s63, s63, 1
    s_lshl_b32 s63, s63, 10
    s_add_u32 s62, s48, s63
    s_mul_i32 s49, s20, 9216
    s_add_u32 s48, s48, s49
    s_lshl_b32 s54, s44, 4
    s_lshl_b32 s60, s20, 2
    s_add_u32 s54, s54, s60
    s_mul_i32 s50, s54, 18432
    s_mul_i32 s53, s45, 2359296
    s_add_u32 s53, s53, s50
    s_add_u32 s50, s50, 25690112
    s_lshr_b32 s60, s46, 1
    s_mul_i32 s60, s60, 9216
    s_add_u32 s53, s53, s60
    s_add_u32 s53, s53, 50331648
    v_lshlrev_b32 v3, 3, v1
    v_mov_b32 v4, v2
    s_and_b32 s60, s20, 1
    s_lshl_b32 s60, s60, 10
    s_add_u32 m0, s60, 147456
    s_mul_i32 s61, s47, 1152
    s_add_u32 s61, s61, s60
    s_add_u32 s61, s61, 3670016
    buffer_load_dwordx4 v2, s[4:7], s61 offen lds
    s_add_u32 m0, s49, 0
    s_add_u32 s61, s48, 0
    buffer_load_dwordx4 v2, s[4:7], s61 offen offset:0 lds
    buffer_load_dwordx4 v2, s[4:7], s61 offen offset:1024 lds
    buffer_load_dwordx4 v2, s[4:7], s61 offen offset:2048 lds
    buffer_load_dwordx4 v2, s[4:7], s61 offen offset:3072 lds
    s_add_u32 m0, s49, 4096
    s_add_u32 s61, s48, 4096
    buffer_load_dwordx4 v2, s[4:7], s61 offen offset:0 lds
    buffer_load_dwordx4 v2, s[4:7], s61 offen offset:1024 lds
    buffer_load_dwordx4 v2, s[4:7], s61 offen offset:2048 lds
    buffer_load_dwordx4 v2, s[4:7], s61 offen offset:3072 lds
    s_add_u32 m0, s49, 8192
    s_add_u32 s61, s48, 8192
    buffer_load_dwordx4 v2, s[4:7], s61 offen offset:0 lds
    s_add_u32 m0, s49, 36864
    s_add_u32 s61, s48, 36864
    buffer_load_dwordx4 v2, s[4:7], s61 offen offset:0 lds
    buffer_load_dwordx4 v2, s[4:7], s61 offen offset:1024 lds
    buffer_load_dwordx4 v2, s[4:7], s61 offen offset:2048 lds
    buffer_load_dwordx4 v2, s[4:7], s61 offen offset:3072 lds
    s_add_u32 m0, s49, 40960
    s_add_u32 s61, s48, 40960
    buffer_load_dwordx4 v2, s[4:7], s61 offen offset:0 lds
    buffer_load_dwordx4 v2, s[4:7], s61 offen offset:1024 lds
    buffer_load_dwordx4 v2, s[4:7], s61 offen offset:2048 lds
    buffer_load_dwordx4 v2, s[4:7], s61 offen offset:3072 lds
    s_add_u32 m0, s49, 45056
    s_add_u32 s61, s48, 45056
    buffer_load_dwordx4 v2, s[4:7], s61 offen offset:0 lds
    s_add_u32 s60, s50, 0
    buffer_load_dwordx4 a[0:3], v2, s[4:7], s60 offen offset:0
    buffer_load_dwordx4 a[16:19], v2, s[4:7], s60 offen offset:1024
    buffer_load_dwordx4 a[32:35], v2, s[4:7], s60 offen offset:2048
    buffer_load_dwordx4 a[48:51], v2, s[4:7], s60 offen offset:3072
    s_add_u32 s60, s50, 18432
    buffer_load_dwordx4 a[4:7], v2, s[4:7], s60 offen offset:0
    buffer_load_dwordx4 a[20:23], v2, s[4:7], s60 offen offset:1024
    buffer_load_dwordx4 a[36:39], v2, s[4:7], s60 offen offset:2048
    buffer_load_dwordx4 a[52:55], v2, s[4:7], s60 offen offset:3072
    s_add_u32 s60, s50, 36864
    buffer_load_dwordx4 a[8:11], v2, s[4:7], s60 offen offset:0
    buffer_load_dwordx4 a[24:27], v2, s[4:7], s60 offen offset:1024
    buffer_load_dwordx4 a[40:43], v2, s[4:7], s60 offen offset:2048
    buffer_load_dwordx4 a[56:59], v2, s[4:7], s60 offen offset:3072
    s_add_u32 s60, s50, 55296
    buffer_load_dwordx4 a[12:15], v2, s[4:7], s60 offen offset:0
    buffer_load_dwordx4 a[28:31], v2, s[4:7], s60 offen offset:1024
    buffer_load_dwordx4 a[44:47], v2, s[4:7], s60 offen offset:2048
    buffer_load_dwordx4 a[60:63], v2, s[4:7], s60 offen offset:3072
    s_add_u32 s60, s50, 4096
    buffer_load_dwordx4 a[64:67], v2, s[4:7], s60 offen offset:0
    buffer_load_dwordx4 a[80:83], v2, s[4:7], s60 offen offset:1024
    buffer_load_dwordx4 a[96:99], v2, s[4:7], s60 offen offset:2048
    buffer_load_dwordx4 a[112:115], v2, s[4:7], s60 offen offset:3072
    s_add_u32 s60, s50, 22528
    buffer_load_dwordx4 a[68:71], v2, s[4:7], s60 offen offset:0
    buffer_load_dwordx4 a[84:87], v2, s[4:7], s60 offen offset:1024
    buffer_load_dwordx4 a[100:103], v2, s[4:7], s60 offen offset:2048
    buffer_load_dwordx4 a[116:119], v2, s[4:7], s60 offen offset:3072
    s_add_u32 s60, s50, 40960
    buffer_load_dwordx4 a[72:75], v2, s[4:7], s60 offen offset:0
    buffer_load_dwordx4 a[88:91], v2, s[4:7], s60 offen offset:1024
    buffer_load_dwordx4 a[104:107], v2, s[4:7], s60 offen offset:2048
    buffer_load_dwordx4 a[120:123], v2, s[4:7], s60 offen offset:3072
    s_add_u32 s60, s50, 59392
    buffer_load_dwordx4 a[76:79], v2, s[4:7], s60 offen offset:0
    buffer_load_dwordx4 a[92:95], v2, s[4:7], s60 offen offset:1024
    buffer_load_dwordx4 a[108:111], v2, s[4:7], s60 offen offset:2048
    buffer_load_dwordx4 a[124:127], v2, s[4:7], s60 offen offset:3072
    s_lshl_b32 s60, s44, 5
    s_add_u32 s60, s60, s47
    s_mul_i32 s51, s60, 73728
    s_add_u32 s51, s51, 30670848
    s_xor_b32 s61, s60, 1
    s_mul_i32 s56, s61, 73728
    s_add_u32 s56, s56, 30670848
    s_xor_b32 s61, s60, 2
    s_mul_i32 s57, s61, 73728
    s_add_u32 s57, s57, 30670848
    s_xor_b32 s61, s60, 3
    s_mul_i32 s58, s61, 73728
    s_add_u32 s58, s58, 30670848
    s_lshr_b32 s52, s60, 2
    s_lshl_b32 s52, s52, 2
    s_add_u32 s52, s52, s20
    s_lshl_b32 s52, s52, 7
    s_add_u32 s52, s52, 3932160
    v_lshrrev_b32 v5, 4, v1
    v_lshlrev_b32 v5, 4, v5
    v_add_u32 v5, 147456, v5
    v_and_b32 v6, 15, v1
    s_lshl_b32 s60, s54, 4
    v_add_u32 v6, s60, v6
    v_lshlrev_b32 v6, 3, v6
    s_lshl_b32 s60, s20, 12
    s_add_u32 s51, s51, s60
    s_add_u32 s56, s56, s60
    s_add_u32 s57, s57, s60
    s_add_u32 s58, s58, s60
    s_lshl_b32 s65, s20, 11
    s_sub_u32 s65, 65536, s65
    s_lshl_b32 s67, s46, 2
    s_add_u32 s67, s67, s52
    v_add_u32 v7, 0x10000, v2
    s_waitcnt vmcnt(32)
    s_barrier
    ds_read_b128 v[8:11], v4 offset:0
    ds_read_b128 v[12:15], v4 offset:1024
    ds_read_b128 v[16:19], v4 offset:36864
    ds_read_b128 v[20:23], v4 offset:37888
    s_add_u32 s60, s50, 8192
    buffer_load_dwordx4 a[128:131], v2, s[4:7], s60 offen offset:0
    s_waitcnt vmcnt(32) lgkmcnt(3)
    v_mfma_f32_16x16x32_bf16 v[208:211], v[8:11], a[0:3], 0
    ds_read_b128 v[24:27], v4 offset:2048
    buffer_load_dwordx4 a[144:147], v2, s[4:7], s60 offen offset:1024
    s_waitcnt vmcnt(29)
    v_mfma_f32_16x16x32_bf16 v[212:215], v[8:11], a[4:7], 0
    buffer_load_dwordx4 a[160:163], v2, s[4:7], s60 offen offset:2048
    buffer_load_dwordx4 a[176:179], v2, s[4:7], s60 offen offset:3072
    s_waitcnt vmcnt(27)
    v_mfma_f32_16x16x32_bf16 v[216:219], v[8:11], a[8:11], 0
    s_add_u32 s60, s50, 26624
    buffer_load_dwordx4 a[132:135], v2, s[4:7], s60 offen offset:0
    s_waitcnt vmcnt(24)
    v_mfma_f32_16x16x32_bf16 v[220:223], v[8:11], a[12:15], 0
    buffer_load_dwordx4 a[148:151], v2, s[4:7], s60 offen offset:1024
    buffer_load_dwordx4 a[164:167], v2, s[4:7], s60 offen offset:2048
    s_waitcnt lgkmcnt(3)
    v_mfma_f32_16x16x32_bf16 v[224:227], v[12:15], a[0:3], 0
    ds_read_b128 v[28:31], v4 offset:3072
    buffer_load_dwordx4 a[180:183], v2, s[4:7], s60 offen offset:3072
    v_mfma_f32_16x16x32_bf16 v[228:231], v[12:15], a[4:7], 0
    s_add_u32 s60, s50, 45056
    buffer_load_dwordx4 a[136:139], v2, s[4:7], s60 offen offset:0
    v_mfma_f32_16x16x32_bf16 v[232:235], v[12:15], a[8:11], 0
    buffer_load_dwordx4 a[152:155], v2, s[4:7], s60 offen offset:1024
    buffer_load_dwordx4 a[168:171], v2, s[4:7], s60 offen offset:2048
    v_mfma_f32_16x16x32_bf16 v[236:239], v[12:15], a[12:15], 0
    buffer_load_dwordx4 a[184:187], v2, s[4:7], s60 offen offset:3072
    s_add_u32 s60, s50, 63488
    s_waitcnt lgkmcnt(3)
    v_mfma_f32_16x16x32_bf16 v[64:67], v[16:19], a[0:3], 0
    ds_read_b128 v[8:11], v4 offset:38912
    buffer_load_dwordx4 a[140:143], v2, s[4:7], s60 offen offset:0
    v_mfma_f32_16x16x32_bf16 v[68:71], v[16:19], a[4:7], 0
    buffer_load_dwordx4 a[156:159], v2, s[4:7], s60 offen offset:1024
    buffer_load_dwordx4 a[172:175], v2, s[4:7], s60 offen offset:2048
    v_mfma_f32_16x16x32_bf16 v[72:75], v[16:19], a[8:11], 0
    buffer_load_dwordx4 a[188:191], v2, s[4:7], s60 offen offset:3072
    s_add_u32 s60, s50, 12288
    v_mfma_f32_16x16x32_bf16 v[76:79], v[16:19], a[12:15], 0
    buffer_load_dwordx4 a[192:195], v2, s[4:7], s60 offen offset:0
    buffer_load_dwordx4 a[208:211], v2, s[4:7], s60 offen offset:1024
    s_waitcnt lgkmcnt(3)
    v_mfma_f32_16x16x32_bf16 v[80:83], v[20:23], a[0:3], 0
    ds_read_b128 v[12:15], v4 offset:39936
    buffer_load_dwordx4 a[224:227], v2, s[4:7], s60 offen offset:2048
    v_mfma_f32_16x16x32_bf16 v[84:87], v[20:23], a[4:7], 0
    buffer_load_dwordx4 a[240:243], v2, s[4:7], s60 offen offset:3072
    s_add_u32 s60, s50, 30720
    v_mfma_f32_16x16x32_bf16 v[88:91], v[20:23], a[8:11], 0
    buffer_load_dwordx4 a[196:199], v2, s[4:7], s60 offen offset:0
    buffer_load_dwordx4 a[212:215], v2, s[4:7], s60 offen offset:1024
    v_mfma_f32_16x16x32_bf16 v[92:95], v[20:23], a[12:15], 0
    buffer_load_dwordx4 a[228:231], v2, s[4:7], s60 offen offset:2048
    buffer_load_dwordx4 a[244:247], v2, s[4:7], s60 offen offset:3072
    s_waitcnt lgkmcnt(3)
    v_mfma_f32_16x16x32_bf16 v[208:211], v[24:27], a[16:19], v[208:211]
    ds_read_b128 v[16:19], v4 offset:4096
    s_add_u32 s60, s50, 49152
    v_mfma_f32_16x16x32_bf16 v[212:215], v[24:27], a[20:23], v[212:215]
    buffer_load_dwordx4 a[200:203], v2, s[4:7], s60 offen offset:0
    buffer_load_dwordx4 a[216:219], v2, s[4:7], s60 offen offset:1024
    v_mfma_f32_16x16x32_bf16 v[216:219], v[24:27], a[24:27], v[216:219]
    buffer_load_dwordx4 a[232:235], v2, s[4:7], s60 offen offset:2048
    buffer_load_dwordx4 a[248:251], v2, s[4:7], s60 offen offset:3072
    s_waitcnt vmcnt(46)
    v_mfma_f32_16x16x32_bf16 v[220:223], v[24:27], a[28:31], v[220:223]
    s_add_u32 s60, s50, 67584
    buffer_load_dwordx4 a[204:207], v2, s[4:7], s60 offen offset:0
    s_waitcnt lgkmcnt(3)
    v_mfma_f32_16x16x32_bf16 v[224:227], v[28:31], a[16:19], v[224:227]
    ds_read_b128 v[20:23], v4 offset:5120
    buffer_load_dwordx4 a[220:223], v2, s[4:7], s60 offen offset:1024
    v_mfma_f32_16x16x32_bf16 v[228:231], v[28:31], a[20:23], v[228:231]
    buffer_load_dwordx4 a[236:239], v2, s[4:7], s60 offen offset:2048
    buffer_load_dwordx4 a[252:255], v2, s[4:7], s60 offen offset:3072
    v_mfma_f32_16x16x32_bf16 v[232:235], v[28:31], a[24:27], v[232:235]
    s_add_u32 s60, s50, 16384
    buffer_load_dwordx4 v[32:35], v2, s[4:7], s60 offen offset:0
    v_mfma_f32_16x16x32_bf16 v[236:239], v[28:31], a[28:31], v[236:239]
    buffer_load_dwordx4 v[48:51], v2, s[4:7], s60 offen offset:1024
    s_add_u32 s60, s50, 34816
    s_waitcnt lgkmcnt(3)
    v_mfma_f32_16x16x32_bf16 v[64:67], v[8:11], a[16:19], v[64:67]
    ds_read_b128 v[24:27], v4 offset:40960
    buffer_load_dwordx4 v[36:39], v2, s[4:7], s60 offen offset:0
    v_mfma_f32_16x16x32_bf16 v[68:71], v[8:11], a[20:23], v[68:71]
    buffer_load_dwordx4 v[52:55], v2, s[4:7], s60 offen offset:1024
    s_add_u32 s60, s50, 53248
    v_mfma_f32_16x16x32_bf16 v[72:75], v[8:11], a[24:27], v[72:75]
    buffer_load_dwordx4 v[40:43], v2, s[4:7], s60 offen offset:0
    buffer_load_dwordx4 v[56:59], v2, s[4:7], s60 offen offset:1024
    v_mfma_f32_16x16x32_bf16 v[76:79], v[8:11], a[28:31], v[76:79]
    s_add_u32 s60, s50, 71680
    buffer_load_dwordx4 v[44:47], v2, s[4:7], s60 offen offset:0
    s_waitcnt lgkmcnt(3)
    v_mfma_f32_16x16x32_bf16 v[80:83], v[12:15], a[16:19], v[80:83]
    ds_read_b128 v[28:31], v4 offset:41984
    buffer_load_dwordx4 v[60:63], v2, s[4:7], s60 offen offset:1024
    v_mfma_f32_16x16x32_bf16 v[84:87], v[12:15], a[20:23], v[84:87]
    s_mov_b32 s60, 28049408
    buffer_load_dwordx2 v[96:97], v6, s[4:7], s60 offen offset:0
    v_mfma_f32_16x16x32_bf16 v[88:91], v[12:15], a[24:27], v[88:91]
    buffer_load_dwordx2 v[108:109], v6, s[4:7], s60 offen offset:128
    buffer_load_dwordx2 v[120:121], v6, s[4:7], s60 offen offset:256
    v_mfma_f32_16x16x32_bf16 v[92:95], v[12:15], a[28:31], v[92:95]
    buffer_load_dwordx2 v[156:157], v6, s[4:7], s60 offen offset:384
    s_mov_b32 s60, 28065792
    s_waitcnt lgkmcnt(3)
    v_mfma_f32_16x16x32_bf16 v[208:211], v[16:19], a[32:35], v[208:211]
    ds_read_b128 v[8:11], v4 offset:6144
    buffer_load_dwordx2 v[98:99], v6, s[4:7], s60 offen offset:0
    v_mfma_f32_16x16x32_bf16 v[212:215], v[16:19], a[36:39], v[212:215]
    buffer_load_dwordx2 v[110:111], v6, s[4:7], s60 offen offset:128
    buffer_load_dwordx2 v[122:123], v6, s[4:7], s60 offen offset:256
    v_mfma_f32_16x16x32_bf16 v[216:219], v[16:19], a[40:43], v[216:219]
    buffer_load_dwordx2 v[158:159], v6, s[4:7], s60 offen offset:384
    s_mov_b32 s60, 28082176
    s_waitcnt vmcnt(63)
    v_mfma_f32_16x16x32_bf16 v[220:223], v[16:19], a[44:47], v[220:223]
    buffer_load_dwordx2 v[100:101], v6, s[4:7], s60 offen offset:0
    buffer_load_dwordx2 v[112:113], v6, s[4:7], s60 offen offset:128
    s_waitcnt lgkmcnt(3)
    v_mfma_f32_16x16x32_bf16 v[224:227], v[20:23], a[32:35], v[224:227]
    ds_read_b128 v[12:15], v4 offset:7168
    buffer_load_dwordx2 v[124:125], v6, s[4:7], s60 offen offset:256
    v_mfma_f32_16x16x32_bf16 v[228:231], v[20:23], a[36:39], v[228:231]
    buffer_load_dwordx2 v[160:161], v6, s[4:7], s60 offen offset:384
    s_mov_b32 s60, 28098560
    v_mfma_f32_16x16x32_bf16 v[232:235], v[20:23], a[40:43], v[232:235]
    buffer_load_dwordx2 v[102:103], v6, s[4:7], s60 offen offset:0
    buffer_load_dwordx2 v[114:115], v6, s[4:7], s60 offen offset:128
    v_mfma_f32_16x16x32_bf16 v[236:239], v[20:23], a[44:47], v[236:239]
    buffer_load_dwordx2 v[126:127], v6, s[4:7], s60 offen offset:256
    buffer_load_dwordx2 v[162:163], v6, s[4:7], s60 offen offset:384
    s_waitcnt lgkmcnt(3)
    v_mfma_f32_16x16x32_bf16 v[64:67], v[24:27], a[32:35], v[64:67]
    ds_read_b128 v[16:19], v4 offset:43008
    s_mov_b32 s60, 28114944
    v_mfma_f32_16x16x32_bf16 v[68:71], v[24:27], a[36:39], v[68:71]
    buffer_load_dwordx2 v[104:105], v6, s[4:7], s60 offen offset:0
    buffer_load_dwordx2 v[116:117], v6, s[4:7], s60 offen offset:128
    v_mfma_f32_16x16x32_bf16 v[72:75], v[24:27], a[40:43], v[72:75]
    buffer_load_dwordx2 v[152:153], v6, s[4:7], s60 offen offset:256
    buffer_load_dwordx2 v[164:165], v6, s[4:7], s60 offen offset:384
    v_mfma_f32_16x16x32_bf16 v[76:79], v[24:27], a[44:47], v[76:79]
    s_mov_b32 s60, 28131328
    buffer_load_dwordx2 v[106:107], v6, s[4:7], s60 offen offset:0
    s_waitcnt lgkmcnt(3)
    v_mfma_f32_16x16x32_bf16 v[80:83], v[28:31], a[32:35], v[80:83]
    ds_read_b128 v[20:23], v4 offset:44032
    buffer_load_dwordx2 v[118:119], v6, s[4:7], s60 offen offset:128
    v_mfma_f32_16x16x32_bf16 v[84:87], v[28:31], a[36:39], v[84:87]
    buffer_load_dwordx2 v[154:155], v6, s[4:7], s60 offen offset:256
    buffer_load_dwordx2 v[166:167], v6, s[4:7], s60 offen offset:384
    v_mfma_f32_16x16x32_bf16 v[88:91], v[28:31], a[40:43], v[88:91]
    s_add_u32 m0, s49, 73728
    s_add_u32 s61, s48, 73728
    v_mfma_f32_16x16x32_bf16 v[92:95], v[28:31], a[44:47], v[92:95]
    buffer_load_dwordx4 v2, s[4:7], s61 offen offset:0 lds
    buffer_load_dwordx4 v2, s[4:7], s61 offen offset:1024 lds
    s_waitcnt lgkmcnt(3)
    v_mfma_f32_16x16x32_bf16 v[208:211], v[8:11], a[48:51], v[208:211]
    ds_read_b128 v[24:27], v4 offset:8192
    buffer_load_dwordx4 v2, s[4:7], s61 offen offset:2048 lds
    v_mfma_f32_16x16x32_bf16 v[212:215], v[8:11], a[52:55], v[212:215]
    buffer_load_dwordx4 v2, s[4:7], s61 offen offset:3072 lds
    s_add_u32 m0, s49, 77824
    v_mfma_f32_16x16x32_bf16 v[216:219], v[8:11], a[56:59], v[216:219]
    s_add_u32 s61, s48, 77824
    buffer_load_dwordx4 v2, s[4:7], s61 offen offset:0 lds
    s_waitcnt vmcnt(63)
    v_mfma_f32_16x16x32_bf16 v[220:223], v[8:11], a[60:63], v[220:223]
    buffer_load_dwordx4 v2, s[4:7], s61 offen offset:1024 lds
    buffer_load_dwordx4 v2, s[4:7], s61 offen offset:2048 lds
    s_waitcnt lgkmcnt(3)
    v_mfma_f32_16x16x32_bf16 v[224:227], v[12:15], a[48:51], v[224:227]
    ds_read_b128 v[28:31], v4 offset:9216
    buffer_load_dwordx4 v2, s[4:7], s61 offen offset:3072 lds
    v_mfma_f32_16x16x32_bf16 v[228:231], v[12:15], a[52:55], v[228:231]
    s_add_u32 m0, s49, 81920
    s_add_u32 s61, s48, 81920
    v_mfma_f32_16x16x32_bf16 v[232:235], v[12:15], a[56:59], v[232:235]
    buffer_load_dwordx4 v2, s[4:7], s61 offen offset:0 lds
    s_add_u32 m0, s49, 110592
    v_mfma_f32_16x16x32_bf16 v[236:239], v[12:15], a[60:63], v[236:239]
    s_add_u32 s61, s48, 110592
    buffer_load_dwordx4 v2, s[4:7], s61 offen offset:0 lds
    s_waitcnt lgkmcnt(3)
    v_mfma_f32_16x16x32_bf16 v[64:67], v[16:19], a[48:51], v[64:67]
    ds_read_b128 v[8:11], v4 offset:45056
    buffer_load_dwordx4 v2, s[4:7], s61 offen offset:1024 lds
    v_mfma_f32_16x16x32_bf16 v[68:71], v[16:19], a[52:55], v[68:71]
    buffer_load_dwordx4 v2, s[4:7], s61 offen offset:2048 lds
    buffer_load_dwordx4 v2, s[4:7], s61 offen offset:3072 lds
    v_mfma_f32_16x16x32_bf16 v[72:75], v[16:19], a[56:59], v[72:75]
    s_add_u32 m0, s49, 114688
    s_add_u32 s61, s48, 114688
    v_mfma_f32_16x16x32_bf16 v[76:79], v[16:19], a[60:63], v[76:79]
    buffer_load_dwordx4 v2, s[4:7], s61 offen offset:0 lds
    buffer_load_dwordx4 v2, s[4:7], s61 offen offset:1024 lds
    s_waitcnt lgkmcnt(3)
    v_mfma_f32_16x16x32_bf16 v[80:83], v[20:23], a[48:51], v[80:83]
    ds_read_b128 v[12:15], v4 offset:46080
    buffer_load_dwordx4 v2, s[4:7], s61 offen offset:2048 lds
    v_mfma_f32_16x16x32_bf16 v[84:87], v[20:23], a[52:55], v[84:87]
    buffer_load_dwordx4 v2, s[4:7], s61 offen offset:3072 lds
    s_add_u32 m0, s49, 118784
    v_mfma_f32_16x16x32_bf16 v[88:91], v[20:23], a[56:59], v[88:91]
    s_add_u32 s61, s48, 118784
    buffer_load_dwordx4 v2, s[4:7], s61 offen offset:0 lds
    v_mfma_f32_16x16x32_bf16 v[92:95], v[20:23], a[60:63], v[92:95]
    s_waitcnt vmcnt(63) lgkmcnt(3)
    v_mfma_f32_16x16x32_bf16 v[208:211], v[24:27], a[64:67], v[208:211]
    ds_read_b128 v[16:19], v4 offset:10240
    s_waitcnt vmcnt(63)
    v_mfma_f32_16x16x32_bf16 v[212:215], v[24:27], a[68:71], v[212:215]
    s_waitcnt vmcnt(63)
    v_mfma_f32_16x16x32_bf16 v[216:219], v[24:27], a[72:75], v[216:219]
    s_waitcnt vmcnt(63)
    v_mfma_f32_16x16x32_bf16 v[220:223], v[24:27], a[76:79], v[220:223]
    s_waitcnt lgkmcnt(3)
    v_mfma_f32_16x16x32_bf16 v[224:227], v[28:31], a[64:67], v[224:227]
    ds_read_b128 v[20:23], v4 offset:11264
    v_mfma_f32_16x16x32_bf16 v[228:231], v[28:31], a[68:71], v[228:231]
    v_mfma_f32_16x16x32_bf16 v[232:235], v[28:31], a[72:75], v[232:235]
    v_mfma_f32_16x16x32_bf16 v[236:239], v[28:31], a[76:79], v[236:239]
    s_waitcnt lgkmcnt(3)
    v_mfma_f32_16x16x32_bf16 v[64:67], v[8:11], a[64:67], v[64:67]
    ds_read_b128 v[24:27], v4 offset:47104
    v_mfma_f32_16x16x32_bf16 v[68:71], v[8:11], a[68:71], v[68:71]
    v_mfma_f32_16x16x32_bf16 v[72:75], v[8:11], a[72:75], v[72:75]
    v_mfma_f32_16x16x32_bf16 v[76:79], v[8:11], a[76:79], v[76:79]
    s_waitcnt lgkmcnt(3)
    v_mfma_f32_16x16x32_bf16 v[80:83], v[12:15], a[64:67], v[80:83]
    ds_read_b128 v[28:31], v4 offset:48128
    v_mfma_f32_16x16x32_bf16 v[84:87], v[12:15], a[68:71], v[84:87]
    v_mfma_f32_16x16x32_bf16 v[88:91], v[12:15], a[72:75], v[88:91]
    v_mfma_f32_16x16x32_bf16 v[92:95], v[12:15], a[76:79], v[92:95]
    s_waitcnt lgkmcnt(3)
    v_mfma_f32_16x16x32_bf16 v[208:211], v[16:19], a[80:83], v[208:211]
    ds_read_b128 v[8:11], v4 offset:12288
    v_mfma_f32_16x16x32_bf16 v[212:215], v[16:19], a[84:87], v[212:215]
    v_mfma_f32_16x16x32_bf16 v[216:219], v[16:19], a[88:91], v[216:219]
    s_waitcnt vmcnt(63)
    v_mfma_f32_16x16x32_bf16 v[220:223], v[16:19], a[92:95], v[220:223]
    s_waitcnt lgkmcnt(3)
    v_mfma_f32_16x16x32_bf16 v[224:227], v[20:23], a[80:83], v[224:227]
    ds_read_b128 v[12:15], v4 offset:13312
    v_mfma_f32_16x16x32_bf16 v[228:231], v[20:23], a[84:87], v[228:231]
    v_mfma_f32_16x16x32_bf16 v[232:235], v[20:23], a[88:91], v[232:235]
    v_mfma_f32_16x16x32_bf16 v[236:239], v[20:23], a[92:95], v[236:239]
    s_waitcnt lgkmcnt(3)
    v_mfma_f32_16x16x32_bf16 v[64:67], v[24:27], a[80:83], v[64:67]
    ds_read_b128 v[16:19], v4 offset:49152
    v_mfma_f32_16x16x32_bf16 v[68:71], v[24:27], a[84:87], v[68:71]
    v_mfma_f32_16x16x32_bf16 v[72:75], v[24:27], a[88:91], v[72:75]
    v_mfma_f32_16x16x32_bf16 v[76:79], v[24:27], a[92:95], v[76:79]
    s_waitcnt lgkmcnt(3)
    v_mfma_f32_16x16x32_bf16 v[80:83], v[28:31], a[80:83], v[80:83]
    ds_read_b128 v[20:23], v4 offset:50176
    v_mfma_f32_16x16x32_bf16 v[84:87], v[28:31], a[84:87], v[84:87]
    v_mfma_f32_16x16x32_bf16 v[88:91], v[28:31], a[88:91], v[88:91]
    v_mfma_f32_16x16x32_bf16 v[92:95], v[28:31], a[92:95], v[92:95]
    s_waitcnt lgkmcnt(3)
    v_mfma_f32_16x16x32_bf16 v[208:211], v[8:11], a[96:99], v[208:211]
    ds_read_b128 v[24:27], v4 offset:14336
    v_mfma_f32_16x16x32_bf16 v[212:215], v[8:11], a[100:103], v[212:215]
    v_mfma_f32_16x16x32_bf16 v[216:219], v[8:11], a[104:107], v[216:219]
    s_waitcnt vmcnt(63)
    v_mfma_f32_16x16x32_bf16 v[220:223], v[8:11], a[108:111], v[220:223]
    s_waitcnt lgkmcnt(3)
    v_mfma_f32_16x16x32_bf16 v[224:227], v[12:15], a[96:99], v[224:227]
    ds_read_b128 v[28:31], v4 offset:15360
    v_mfma_f32_16x16x32_bf16 v[228:231], v[12:15], a[100:103], v[228:231]
    v_mfma_f32_16x16x32_bf16 v[232:235], v[12:15], a[104:107], v[232:235]
    v_mfma_f32_16x16x32_bf16 v[236:239], v[12:15], a[108:111], v[236:239]
    s_waitcnt lgkmcnt(3)
    v_mfma_f32_16x16x32_bf16 v[64:67], v[16:19], a[96:99], v[64:67]
    ds_read_b128 v[8:11], v4 offset:51200
    v_mfma_f32_16x16x32_bf16 v[68:71], v[16:19], a[100:103], v[68:71]
    v_mfma_f32_16x16x32_bf16 v[72:75], v[16:19], a[104:107], v[72:75]
    v_mfma_f32_16x16x32_bf16 v[76:79], v[16:19], a[108:111], v[76:79]
    s_waitcnt lgkmcnt(3)
    v_mfma_f32_16x16x32_bf16 v[80:83], v[20:23], a[96:99], v[80:83]
    ds_read_b128 v[12:15], v4 offset:52224
    v_mfma_f32_16x16x32_bf16 v[84:87], v[20:23], a[100:103], v[84:87]
    v_mfma_f32_16x16x32_bf16 v[88:91], v[20:23], a[104:107], v[88:91]
    v_mfma_f32_16x16x32_bf16 v[92:95], v[20:23], a[108:111], v[92:95]
    s_waitcnt lgkmcnt(3)
    v_mfma_f32_16x16x32_bf16 v[208:211], v[24:27], a[112:115], v[208:211]
    ds_read_b128 v[16:19], v4 offset:16384
    v_mfma_f32_16x16x32_bf16 v[212:215], v[24:27], a[116:119], v[212:215]
    v_mfma_f32_16x16x32_bf16 v[216:219], v[24:27], a[120:123], v[216:219]
    s_waitcnt vmcnt(63)
    v_mfma_f32_16x16x32_bf16 v[220:223], v[24:27], a[124:127], v[220:223]
    s_waitcnt lgkmcnt(3)
    v_mfma_f32_16x16x32_bf16 v[224:227], v[28:31], a[112:115], v[224:227]
    ds_read_b128 v[20:23], v4 offset:17408
    v_mfma_f32_16x16x32_bf16 v[228:231], v[28:31], a[116:119], v[228:231]
    v_mfma_f32_16x16x32_bf16 v[232:235], v[28:31], a[120:123], v[232:235]
    v_mfma_f32_16x16x32_bf16 v[236:239], v[28:31], a[124:127], v[236:239]
    s_waitcnt lgkmcnt(3)
    v_mfma_f32_16x16x32_bf16 v[64:67], v[8:11], a[112:115], v[64:67]
    ds_read_b128 v[24:27], v4 offset:53248
    v_mfma_f32_16x16x32_bf16 v[68:71], v[8:11], a[116:119], v[68:71]
    v_mfma_f32_16x16x32_bf16 v[72:75], v[8:11], a[120:123], v[72:75]
    v_mfma_f32_16x16x32_bf16 v[76:79], v[8:11], a[124:127], v[76:79]
    s_waitcnt lgkmcnt(3)
    v_mfma_f32_16x16x32_bf16 v[80:83], v[12:15], a[112:115], v[80:83]
    ds_read_b128 v[28:31], v4 offset:54272
    v_mfma_f32_16x16x32_bf16 v[84:87], v[12:15], a[116:119], v[84:87]
    v_mfma_f32_16x16x32_bf16 v[88:91], v[12:15], a[120:123], v[88:91]
    v_mfma_f32_16x16x32_bf16 v[92:95], v[12:15], a[124:127], v[92:95]
    s_waitcnt vmcnt(63) lgkmcnt(3)
    v_mfma_f32_16x16x32_bf16 v[208:211], v[16:19], a[128:131], v[208:211]
    ds_read_b128 v[8:11], v4 offset:18432
    s_waitcnt vmcnt(63)
    v_mfma_f32_16x16x32_bf16 v[212:215], v[16:19], a[132:135], v[212:215]
    s_waitcnt vmcnt(63)
    v_mfma_f32_16x16x32_bf16 v[216:219], v[16:19], a[136:139], v[216:219]
    s_waitcnt vmcnt(63)
    v_mfma_f32_16x16x32_bf16 v[220:223], v[16:19], a[140:143], v[220:223]
    s_waitcnt lgkmcnt(3)
    v_mfma_f32_16x16x32_bf16 v[224:227], v[20:23], a[128:131], v[224:227]
    ds_read_b128 v[12:15], v4 offset:19456
    v_mfma_f32_16x16x32_bf16 v[228:231], v[20:23], a[132:135], v[228:231]
    v_mfma_f32_16x16x32_bf16 v[232:235], v[20:23], a[136:139], v[232:235]
    v_mfma_f32_16x16x32_bf16 v[236:239], v[20:23], a[140:143], v[236:239]
    s_waitcnt lgkmcnt(3)
    v_mfma_f32_16x16x32_bf16 v[64:67], v[24:27], a[128:131], v[64:67]
    ds_read_b128 v[16:19], v4 offset:55296
    v_mfma_f32_16x16x32_bf16 v[68:71], v[24:27], a[132:135], v[68:71]
    v_mfma_f32_16x16x32_bf16 v[72:75], v[24:27], a[136:139], v[72:75]
    v_mfma_f32_16x16x32_bf16 v[76:79], v[24:27], a[140:143], v[76:79]
    s_waitcnt lgkmcnt(3)
    v_mfma_f32_16x16x32_bf16 v[80:83], v[28:31], a[128:131], v[80:83]
    ds_read_b128 v[20:23], v4 offset:56320
    v_mfma_f32_16x16x32_bf16 v[84:87], v[28:31], a[132:135], v[84:87]
    v_mfma_f32_16x16x32_bf16 v[88:91], v[28:31], a[136:139], v[88:91]
    v_mfma_f32_16x16x32_bf16 v[92:95], v[28:31], a[140:143], v[92:95]
    s_waitcnt lgkmcnt(3)
    v_mfma_f32_16x16x32_bf16 v[208:211], v[8:11], a[144:147], v[208:211]
    ds_read_b128 v[24:27], v4 offset:20480
    v_mfma_f32_16x16x32_bf16 v[212:215], v[8:11], a[148:151], v[212:215]
    v_mfma_f32_16x16x32_bf16 v[216:219], v[8:11], a[152:155], v[216:219]
    s_waitcnt vmcnt(63)
    v_mfma_f32_16x16x32_bf16 v[220:223], v[8:11], a[156:159], v[220:223]
    s_waitcnt lgkmcnt(3)
    v_mfma_f32_16x16x32_bf16 v[224:227], v[12:15], a[144:147], v[224:227]
    ds_read_b128 v[28:31], v4 offset:21504
    v_mfma_f32_16x16x32_bf16 v[228:231], v[12:15], a[148:151], v[228:231]
    v_mfma_f32_16x16x32_bf16 v[232:235], v[12:15], a[152:155], v[232:235]
    v_mfma_f32_16x16x32_bf16 v[236:239], v[12:15], a[156:159], v[236:239]
    s_waitcnt lgkmcnt(3)
    v_mfma_f32_16x16x32_bf16 v[64:67], v[16:19], a[144:147], v[64:67]
    ds_read_b128 v[8:11], v4 offset:57344
    v_mfma_f32_16x16x32_bf16 v[68:71], v[16:19], a[148:151], v[68:71]
    v_mfma_f32_16x16x32_bf16 v[72:75], v[16:19], a[152:155], v[72:75]
    v_mfma_f32_16x16x32_bf16 v[76:79], v[16:19], a[156:159], v[76:79]
    s_waitcnt lgkmcnt(3)
    v_mfma_f32_16x16x32_bf16 v[80:83], v[20:23], a[144:147], v[80:83]
    ds_read_b128 v[12:15], v4 offset:58368
    v_mfma_f32_16x16x32_bf16 v[84:87], v[20:23], a[148:151], v[84:87]
    v_mfma_f32_16x16x32_bf16 v[88:91], v[20:23], a[152:155], v[88:91]
    v_mfma_f32_16x16x32_bf16 v[92:95], v[20:23], a[156:159], v[92:95]
    s_waitcnt lgkmcnt(3)
    v_mfma_f32_16x16x32_bf16 v[208:211], v[24:27], a[160:163], v[208:211]
    ds_read_b128 v[16:19], v4 offset:22528
    v_mfma_f32_16x16x32_bf16 v[212:215], v[24:27], a[164:167], v[212:215]
    v_mfma_f32_16x16x32_bf16 v[216:219], v[24:27], a[168:171], v[216:219]
    s_waitcnt vmcnt(63)
    v_mfma_f32_16x16x32_bf16 v[220:223], v[24:27], a[172:175], v[220:223]
    s_waitcnt lgkmcnt(3)
    v_mfma_f32_16x16x32_bf16 v[224:227], v[28:31], a[160:163], v[224:227]
    ds_read_b128 v[20:23], v4 offset:23552
    v_mfma_f32_16x16x32_bf16 v[228:231], v[28:31], a[164:167], v[228:231]
    v_mfma_f32_16x16x32_bf16 v[232:235], v[28:31], a[168:171], v[232:235]
    v_mfma_f32_16x16x32_bf16 v[236:239], v[28:31], a[172:175], v[236:239]
    s_waitcnt lgkmcnt(3)
    v_mfma_f32_16x16x32_bf16 v[64:67], v[8:11], a[160:163], v[64:67]
    ds_read_b128 v[24:27], v4 offset:59392
    v_mfma_f32_16x16x32_bf16 v[68:71], v[8:11], a[164:167], v[68:71]
    v_mfma_f32_16x16x32_bf16 v[72:75], v[8:11], a[168:171], v[72:75]
    v_mfma_f32_16x16x32_bf16 v[76:79], v[8:11], a[172:175], v[76:79]
    s_waitcnt lgkmcnt(3)
    v_mfma_f32_16x16x32_bf16 v[80:83], v[12:15], a[160:163], v[80:83]
    ds_read_b128 v[28:31], v4 offset:60416
    v_mfma_f32_16x16x32_bf16 v[84:87], v[12:15], a[164:167], v[84:87]
    v_mfma_f32_16x16x32_bf16 v[88:91], v[12:15], a[168:171], v[88:91]
    v_mfma_f32_16x16x32_bf16 v[92:95], v[12:15], a[172:175], v[92:95]
    s_waitcnt lgkmcnt(3)
    v_mfma_f32_16x16x32_bf16 v[208:211], v[16:19], a[176:179], v[208:211]
    ds_read_b128 v[8:11], v4 offset:24576
    v_mfma_f32_16x16x32_bf16 v[212:215], v[16:19], a[180:183], v[212:215]
    v_mfma_f32_16x16x32_bf16 v[216:219], v[16:19], a[184:187], v[216:219]
    s_waitcnt vmcnt(63)
    v_mfma_f32_16x16x32_bf16 v[220:223], v[16:19], a[188:191], v[220:223]
    s_waitcnt lgkmcnt(3)
    v_mfma_f32_16x16x32_bf16 v[224:227], v[20:23], a[176:179], v[224:227]
    ds_read_b128 v[12:15], v4 offset:25600
    v_mfma_f32_16x16x32_bf16 v[228:231], v[20:23], a[180:183], v[228:231]
    v_mfma_f32_16x16x32_bf16 v[232:235], v[20:23], a[184:187], v[232:235]
    v_mfma_f32_16x16x32_bf16 v[236:239], v[20:23], a[188:191], v[236:239]
    s_waitcnt lgkmcnt(3)
    v_mfma_f32_16x16x32_bf16 v[64:67], v[24:27], a[176:179], v[64:67]
    ds_read_b128 v[16:19], v4 offset:61440
    v_mfma_f32_16x16x32_bf16 v[68:71], v[24:27], a[180:183], v[68:71]
    v_mfma_f32_16x16x32_bf16 v[72:75], v[24:27], a[184:187], v[72:75]
    v_mfma_f32_16x16x32_bf16 v[76:79], v[24:27], a[188:191], v[76:79]
    s_waitcnt lgkmcnt(3)
    v_mfma_f32_16x16x32_bf16 v[80:83], v[28:31], a[176:179], v[80:83]
    ds_read_b128 v[20:23], v4 offset:62464
    v_mfma_f32_16x16x32_bf16 v[84:87], v[28:31], a[180:183], v[84:87]
    v_mfma_f32_16x16x32_bf16 v[88:91], v[28:31], a[184:187], v[88:91]
    v_mfma_f32_16x16x32_bf16 v[92:95], v[28:31], a[188:191], v[92:95]
    s_waitcnt vmcnt(63) lgkmcnt(3)
    v_mfma_f32_16x16x32_bf16 v[208:211], v[8:11], a[192:195], v[208:211]
    ds_read_b128 v[24:27], v4 offset:26624
    s_waitcnt vmcnt(61)
    v_mfma_f32_16x16x32_bf16 v[212:215], v[8:11], a[196:199], v[212:215]
    s_waitcnt vmcnt(57)
    v_mfma_f32_16x16x32_bf16 v[216:219], v[8:11], a[200:203], v[216:219]
    s_waitcnt vmcnt(53)
    v_mfma_f32_16x16x32_bf16 v[220:223], v[8:11], a[204:207], v[220:223]
    s_waitcnt lgkmcnt(3)
    v_mfma_f32_16x16x32_bf16 v[224:227], v[12:15], a[192:195], v[224:227]
    ds_read_b128 v[28:31], v4 offset:27648
    v_mfma_f32_16x16x32_bf16 v[228:231], v[12:15], a[196:199], v[228:231]
    s_waitcnt vmcnt(37)
    v_add_f32 v128, v96, v98
    v_add_f32 v132, v97, v99
    v_mfma_f32_16x16x32_bf16 v[232:235], v[12:15], a[200:203], v[232:235]
    s_waitcnt vmcnt(33)
    v_add_f32 v128, v128, v100
    v_add_f32 v132, v132, v101
    v_mfma_f32_16x16x32_bf16 v[236:239], v[12:15], a[204:207], v[236:239]
    s_waitcnt vmcnt(29)
    v_add_f32 v128, v128, v102
    v_add_f32 v132, v132, v103
    s_waitcnt lgkmcnt(3)
    v_mfma_f32_16x16x32_bf16 v[64:67], v[16:19], a[192:195], v[64:67]
    ds_read_b128 v[8:11], v4 offset:63488
    s_waitcnt vmcnt(25)
    v_add_f32 v128, v128, v104
    v_mfma_f32_16x16x32_bf16 v[68:71], v[16:19], a[196:199], v[68:71]
    v_add_f32 v132, v132, v105
    s_waitcnt vmcnt(21)
    v_add_f32 v128, v128, v106
    v_mfma_f32_16x16x32_bf16 v[72:75], v[16:19], a[200:203], v[72:75]
    v_add_f32 v132, v132, v107
    v_mul_f32 v128, 0xbae38e39, v128
    v_mfma_f32_16x16x32_bf16 v[76:79], v[16:19], a[204:207], v[76:79]
    v_fmamk_f32 v169, v96, 0x3c2aaaab, v128
    v_mul_f32 v168, v169, v169
    s_waitcnt lgkmcnt(3)
    v_mfma_f32_16x16x32_bf16 v[80:83], v[20:23], a[192:195], v[80:83]
    ds_read_b128 v[12:15], v4 offset:64512
    v_fmamk_f32 v169, v98, 0x3c2aaaab, v128
    v_mfma_f32_16x16x32_bf16 v[84:87], v[20:23], a[196:199], v[84:87]
    v_fmac_f32 v168, v169, v169
    v_fmamk_f32 v169, v100, 0x3c2aaaab, v128
    v_mfma_f32_16x16x32_bf16 v[88:91], v[20:23], a[200:203], v[88:91]
    v_fmac_f32 v168, v169, v169
    v_fmamk_f32 v169, v102, 0x3c2aaaab, v128
    v_mfma_f32_16x16x32_bf16 v[92:95], v[20:23], a[204:207], v[92:95]
    v_fmac_f32 v168, v169, v169
    v_fmamk_f32 v169, v104, 0x3c2aaaab, v128
    s_waitcnt lgkmcnt(3)
    v_mfma_f32_16x16x32_bf16 v[208:211], v[24:27], a[208:211], v[208:211]
    ds_read_b128 v[16:19], v4 offset:28672
    v_fmac_f32 v168, v169, v169
    v_mfma_f32_16x16x32_bf16 v[212:215], v[24:27], a[212:215], v[212:215]
    v_fmamk_f32 v169, v106, 0x3c2aaaab, v128
    v_fmac_f32 v168, v169, v169
    v_mfma_f32_16x16x32_bf16 v[216:219], v[24:27], a[216:219], v[216:219]
    v_fmac_f32 v132, 0x42c00000, v168
    v_mov_b32 v169, 0x3727c5ac
    v_mfma_f32_16x16x32_bf16 v[220:223], v[24:27], a[220:223], v[220:223]
    v_fmac_f32 v169, 0x3ae38e39, v132
    v_rcp_f32 v132, v169
    s_waitcnt lgkmcnt(3)
    v_mfma_f32_16x16x32_bf16 v[224:227], v[28:31], a[208:211], v[224:227]
    ds_read_b128 v[20:23], v4 offset:29696
    v_add_f32 v129, v108, v110
    v_mfma_f32_16x16x32_bf16 v[228:231], v[28:31], a[212:215], v[228:231]
    v_add_f32 v133, v109, v111
    v_add_f32 v129, v129, v112
    v_mfma_f32_16x16x32_bf16 v[232:235], v[28:31], a[216:219], v[232:235]
    v_add_f32 v133, v133, v113
    v_add_f32 v129, v129, v114
    v_mfma_f32_16x16x32_bf16 v[236:239], v[28:31], a[220:223], v[236:239]
    v_add_f32 v133, v133, v115
    v_add_f32 v129, v129, v116
    s_waitcnt lgkmcnt(3)
    v_mfma_f32_16x16x32_bf16 v[64:67], v[8:11], a[208:211], v[64:67]
    ds_read_b128 v[24:27], v7 offset:0
    v_add_f32 v133, v133, v117
    v_mfma_f32_16x16x32_bf16 v[68:71], v[8:11], a[212:215], v[68:71]
    s_waitcnt vmcnt(20)
    v_add_f32 v129, v129, v118
    v_add_f32 v133, v133, v119
    v_mfma_f32_16x16x32_bf16 v[72:75], v[8:11], a[216:219], v[72:75]
    v_mul_f32 v129, 0xbae38e39, v129
    v_fmamk_f32 v169, v108, 0x3c2aaaab, v129
    v_mfma_f32_16x16x32_bf16 v[76:79], v[8:11], a[220:223], v[76:79]
    v_mul_f32 v168, v169, v169
    v_fmamk_f32 v169, v110, 0x3c2aaaab, v129
    s_waitcnt lgkmcnt(3)
    v_mfma_f32_16x16x32_bf16 v[80:83], v[12:15], a[208:211], v[80:83]
    ds_read_b128 v[28:31], v7 offset:1024
    v_fmac_f32 v168, v169, v169
    v_mfma_f32_16x16x32_bf16 v[84:87], v[12:15], a[212:215], v[84:87]
    v_fmamk_f32 v169, v112, 0x3c2aaaab, v129
    v_fmac_f32 v168, v169, v169
    v_mfma_f32_16x16x32_bf16 v[88:91], v[12:15], a[216:219], v[88:91]
    v_fmamk_f32 v169, v114, 0x3c2aaaab, v129
    v_fmac_f32 v168, v169, v169
    v_mfma_f32_16x16x32_bf16 v[92:95], v[12:15], a[220:223], v[92:95]
    v_fmamk_f32 v169, v116, 0x3c2aaaab, v129
    v_fmac_f32 v168, v169, v169
    s_waitcnt lgkmcnt(3)
    v_mfma_f32_16x16x32_bf16 v[208:211], v[16:19], a[224:227], v[208:211]
    ds_read_b128 v[8:11], v4 offset:30720
    v_fmamk_f32 v169, v118, 0x3c2aaaab, v129
    v_mfma_f32_16x16x32_bf16 v[212:215], v[16:19], a[228:231], v[212:215]
    v_fmac_f32 v168, v169, v169
    v_fmac_f32 v133, 0x42c00000, v168
    v_mfma_f32_16x16x32_bf16 v[216:219], v[16:19], a[232:235], v[216:219]
    v_mov_b32 v169, 0x3727c5ac
    v_fmac_f32 v169, 0x3ae38e39, v133
    v_mfma_f32_16x16x32_bf16 v[220:223], v[16:19], a[236:239], v[220:223]
    v_rcp_f32 v133, v169
    v_add_f32 v130, v120, v122
    s_waitcnt lgkmcnt(3)
    v_mfma_f32_16x16x32_bf16 v[224:227], v[20:23], a[224:227], v[224:227]
    ds_read_b128 v[12:15], v4 offset:31744
    v_add_f32 v134, v121, v123
    v_mfma_f32_16x16x32_bf16 v[228:231], v[20:23], a[228:231], v[228:231]
    v_add_f32 v130, v130, v124
    v_add_f32 v134, v134, v125
    v_mfma_f32_16x16x32_bf16 v[232:235], v[20:23], a[232:235], v[232:235]
    v_add_f32 v130, v130, v126
    v_add_f32 v134, v134, v127
    v_mfma_f32_16x16x32_bf16 v[236:239], v[20:23], a[236:239], v[236:239]
    v_add_f32 v130, v130, v152
    v_add_f32 v134, v134, v153
    s_waitcnt lgkmcnt(3)
    v_mfma_f32_16x16x32_bf16 v[64:67], v[24:27], a[224:227], v[64:67]
    ds_read_b128 v[16:19], v7 offset:2048
    s_waitcnt vmcnt(19)
    v_add_f32 v130, v130, v154
    v_mfma_f32_16x16x32_bf16 v[68:71], v[24:27], a[228:231], v[68:71]
    v_add_f32 v134, v134, v155
    v_mul_f32 v130, 0xbae38e39, v130
    v_mfma_f32_16x16x32_bf16 v[72:75], v[24:27], a[232:235], v[72:75]
    v_fmamk_f32 v169, v120, 0x3c2aaaab, v130
    v_mul_f32 v168, v169, v169
    v_mfma_f32_16x16x32_bf16 v[76:79], v[24:27], a[236:239], v[76:79]
    v_fmamk_f32 v169, v122, 0x3c2aaaab, v130
    v_fmac_f32 v168, v169, v169
    s_waitcnt lgkmcnt(3)
    v_mfma_f32_16x16x32_bf16 v[80:83], v[28:31], a[224:227], v[80:83]
    ds_read_b128 v[20:23], v7 offset:3072
    v_fmamk_f32 v169, v124, 0x3c2aaaab, v130
    v_mfma_f32_16x16x32_bf16 v[84:87], v[28:31], a[228:231], v[84:87]
    v_fmac_f32 v168, v169, v169
    v_fmamk_f32 v169, v126, 0x3c2aaaab, v130
    v_mfma_f32_16x16x32_bf16 v[88:91], v[28:31], a[232:235], v[88:91]
    v_fmac_f32 v168, v169, v169
    v_fmamk_f32 v169, v152, 0x3c2aaaab, v130
    v_mfma_f32_16x16x32_bf16 v[92:95], v[28:31], a[236:239], v[92:95]
    v_fmac_f32 v168, v169, v169
    v_fmamk_f32 v169, v154, 0x3c2aaaab, v130
    s_waitcnt lgkmcnt(3)
    v_mfma_f32_16x16x32_bf16 v[208:211], v[8:11], a[240:243], v[208:211]
    ds_read_b128 v[24:27], v4 offset:32768
    v_fmac_f32 v168, v169, v169
    v_mfma_f32_16x16x32_bf16 v[212:215], v[8:11], a[244:247], v[212:215]
    v_fmac_f32 v134, 0x42c00000, v168
    v_mov_b32 v169, 0x3727c5ac
    v_mfma_f32_16x16x32_bf16 v[216:219], v[8:11], a[248:251], v[216:219]
    v_fmac_f32 v169, 0x3ae38e39, v134
    v_rcp_f32 v134, v169
    v_mfma_f32_16x16x32_bf16 v[220:223], v[8:11], a[252:255], v[220:223]
    v_add_f32 v131, v156, v158
    v_add_f32 v135, v157, v159
    s_waitcnt lgkmcnt(3)
    v_mfma_f32_16x16x32_bf16 v[224:227], v[12:15], a[240:243], v[224:227]
    ds_read_b128 v[28:31], v4 offset:33792
    v_add_f32 v131, v131, v160
    v_mfma_f32_16x16x32_bf16 v[228:231], v[12:15], a[244:247], v[228:231]
    v_add_f32 v135, v135, v161
    v_add_f32 v131, v131, v162
    v_mfma_f32_16x16x32_bf16 v[232:235], v[12:15], a[248:251], v[232:235]
    v_add_f32 v135, v135, v163
    v_add_f32 v131, v131, v164
    v_mfma_f32_16x16x32_bf16 v[236:239], v[12:15], a[252:255], v[236:239]
    v_add_f32 v135, v135, v165
    s_waitcnt vmcnt(18)
    v_add_f32 v131, v131, v166
    s_waitcnt lgkmcnt(3)
    v_mfma_f32_16x16x32_bf16 v[64:67], v[16:19], a[240:243], v[64:67]
    ds_read_b128 v[8:11], v7 offset:4096
    v_add_f32 v135, v135, v167
    v_mfma_f32_16x16x32_bf16 v[68:71], v[16:19], a[244:247], v[68:71]
    v_mul_f32 v131, 0xbae38e39, v131
    v_fmamk_f32 v169, v156, 0x3c2aaaab, v131
    v_mfma_f32_16x16x32_bf16 v[72:75], v[16:19], a[248:251], v[72:75]
    v_mul_f32 v168, v169, v169
    v_fmamk_f32 v169, v158, 0x3c2aaaab, v131
    v_mfma_f32_16x16x32_bf16 v[76:79], v[16:19], a[252:255], v[76:79]
    v_fmac_f32 v168, v169, v169
    v_fmamk_f32 v169, v160, 0x3c2aaaab, v131
    s_waitcnt lgkmcnt(3)
    v_mfma_f32_16x16x32_bf16 v[80:83], v[20:23], a[240:243], v[80:83]
    ds_read_b128 v[12:15], v7 offset:5120
    v_fmac_f32 v168, v169, v169
    v_mfma_f32_16x16x32_bf16 v[84:87], v[20:23], a[244:247], v[84:87]
    v_fmamk_f32 v169, v162, 0x3c2aaaab, v131
    v_fmac_f32 v168, v169, v169
    v_mfma_f32_16x16x32_bf16 v[88:91], v[20:23], a[248:251], v[88:91]
    v_fmamk_f32 v169, v164, 0x3c2aaaab, v131
    v_fmac_f32 v168, v169, v169
    v_mfma_f32_16x16x32_bf16 v[92:95], v[20:23], a[252:255], v[92:95]
    v_fmamk_f32 v169, v166, 0x3c2aaaab, v131
    v_fmac_f32 v168, v169, v169
    s_waitcnt lgkmcnt(3)
    v_mfma_f32_16x16x32_bf16 v[208:211], v[24:27], v[32:35], v[208:211]
    ds_read_b128 v[16:19], v4 offset:34816
    v_fmac_f32 v135, 0x42c00000, v168
    v_mfma_f32_16x16x32_bf16 v[212:215], v[24:27], v[36:39], v[212:215]
    v_mov_b32 v169, 0x3727c5ac
    v_fmac_f32 v169, 0x3ae38e39, v135
    v_mfma_f32_16x16x32_bf16 v[216:219], v[24:27], v[40:43], v[216:219]
    v_rcp_f32 v135, v169
    v_mfma_f32_16x16x32_bf16 v[220:223], v[24:27], v[44:47], v[220:223]
    s_waitcnt lgkmcnt(3)
    v_mfma_f32_16x16x32_bf16 v[224:227], v[28:31], v[32:35], v[224:227]
    ds_read_b128 v[20:23], v4 offset:35840
    v_mfma_f32_16x16x32_bf16 v[228:231], v[28:31], v[36:39], v[228:231]
    v_mfma_f32_16x16x32_bf16 v[232:235], v[28:31], v[40:43], v[232:235]
    v_mfma_f32_16x16x32_bf16 v[236:239], v[28:31], v[44:47], v[236:239]
    s_waitcnt lgkmcnt(3)
    v_mfma_f32_16x16x32_bf16 v[64:67], v[8:11], v[32:35], v[64:67]
    ds_read_b128 v[24:27], v7 offset:6144
    v_mfma_f32_16x16x32_bf16 v[68:71], v[8:11], v[36:39], v[68:71]
    v_mfma_f32_16x16x32_bf16 v[72:75], v[8:11], v[40:43], v[72:75]
    v_mfma_f32_16x16x32_bf16 v[76:79], v[8:11], v[44:47], v[76:79]
    ds_read_b128 v[136:139], v5 offset:0
    ds_read_b128 v[140:143], v5 offset:64
    s_waitcnt lgkmcnt(5)
    v_mfma_f32_16x16x32_bf16 v[80:83], v[12:15], v[32:35], v[80:83]
    ds_read_b128 v[28:31], v7 offset:7168
    ds_read_b128 v[144:147], v5 offset:128
    v_mfma_f32_16x16x32_bf16 v[84:87], v[12:15], v[36:39], v[84:87]
    ds_read_b128 v[148:151], v5 offset:192
    v_mfma_f32_16x16x32_bf16 v[88:91], v[12:15], v[40:43], v[88:91]
    v_mfma_f32_16x16x32_bf16 v[92:95], v[12:15], v[44:47], v[92:95]
    s_waitcnt lgkmcnt(7)
    v_mfma_f32_16x16x32_bf16 v[208:211], v[16:19], v[48:51], v[208:211]
    s_waitcnt vmcnt(9)
    s_waitcnt lgkmcnt(0)
    s_barrier
    v_mfma_f32_16x16x32_bf16 v[212:215], v[16:19], v[52:55], v[212:215]
    v_add_u32 v4, 0x12000, v4
    ds_read_b128 v[8:11], v4 offset:0
    v_mfma_f32_16x16x32_bf16 v[216:219], v[16:19], v[56:59], v[216:219]
    s_add_u32 m0, s49, 0
    s_add_u32 s61, s48, 147456
    v_mfma_f32_16x16x32_bf16 v[220:223], v[16:19], v[60:63], v[220:223]
    buffer_load_dwordx4 v2, s[4:7], s61 offen offset:0 lds
    buffer_load_dwordx4 v2, s[4:7], s61 offen offset:1024 lds
    v_mfma_f32_16x16x32_bf16 v[224:227], v[20:23], v[48:51], v[224:227]
    ds_read_b128 v[12:15], v4 offset:1024
    buffer_load_dwordx4 v2, s[4:7], s61 offen offset:2048 lds
    v_mfma_f32_16x16x32_bf16 v[228:231], v[20:23], v[52:55], v[228:231]
    buffer_load_dwordx4 v2, s[4:7], s61 offen offset:3072 lds
    s_add_u32 m0, s49, 4096
    v_mfma_f32_16x16x32_bf16 v[232:235], v[20:23], v[56:59], v[232:235]
    s_add_u32 s61, s48, 151552
    buffer_load_dwordx4 v2, s[4:7], s61 offen offset:0 lds
    v_mfma_f32_16x16x32_bf16 v[236:239], v[20:23], v[60:63], v[236:239]
    buffer_load_dwordx4 v2, s[4:7], s61 offen offset:1024 lds
    buffer_load_dwordx4 v2, s[4:7], s61 offen offset:2048 lds
    v_mfma_f32_16x16x32_bf16 v[64:67], v[24:27], v[48:51], v[64:67]
    ds_read_b128 v[16:19], v4 offset:2048
    buffer_load_dwordx4 v2, s[4:7], s61 offen offset:3072 lds
    v_mfma_f32_16x16x32_bf16 v[68:71], v[24:27], v[52:55], v[68:71]
    s_add_u32 m0, s49, 8192
    s_add_u32 s61, s48, 155648
    v_mfma_f32_16x16x32_bf16 v[72:75], v[24:27], v[56:59], v[72:75]
    buffer_load_dwordx4 v2, s[4:7], s61 offen offset:0 lds
    s_add_u32 m0, s49, 36864
    v_mfma_f32_16x16x32_bf16 v[76:79], v[24:27], v[60:63], v[76:79]
    s_add_u32 s61, s48, 184320
    buffer_load_dwordx4 v2, s[4:7], s61 offen offset:0 lds
    v_mfma_f32_16x16x32_bf16 v[80:83], v[28:31], v[48:51], v[80:83]
    ds_read_b128 v[20:23], v4 offset:3072
    buffer_load_dwordx4 v2, s[4:7], s61 offen offset:1024 lds
    v_mfma_f32_16x16x32_bf16 v[84:87], v[28:31], v[52:55], v[84:87]
    buffer_load_dwordx4 v2, s[4:7], s61 offen offset:2048 lds
    buffer_load_dwordx4 v2, s[4:7], s61 offen offset:3072 lds
    v_mfma_f32_16x16x32_bf16 v[88:91], v[28:31], v[56:59], v[88:91]
    s_add_u32 m0, s49, 40960
    s_add_u32 s61, s48, 188416
    v_mfma_f32_16x16x32_bf16 v[92:95], v[28:31], v[60:63], v[92:95]
    buffer_load_dwordx4 v2, s[4:7], s61 offen offset:0 lds
    buffer_load_dwordx4 v2, s[4:7], s61 offen offset:1024 lds
    s_waitcnt lgkmcnt(3)
    v_mfma_f32_16x16x32_bf16 v[96:99], v[8:11], a[0:3], 0
    ds_read_b128 v[24:27], v4 offset:4096
    buffer_load_dwordx4 v2, s[4:7], s61 offen offset:2048 lds
    v_mfma_f32_16x16x32_bf16 v[100:103], v[8:11], a[4:7], 0
    buffer_load_dwordx4 v2, s[4:7], s61 offen offset:3072 lds
    s_add_u32 m0, s49, 45056
    v_mfma_f32_16x16x32_bf16 v[104:107], v[8:11], a[8:11], 0
    s_add_u32 s61, s48, 192512
    buffer_load_dwordx4 v2, s[4:7], s61 offen offset:0 lds
    v_mfma_f32_16x16x32_bf16 v[108:111], v[8:11], a[12:15], 0
    s_waitcnt lgkmcnt(3)
    v_mfma_f32_16x16x32_bf16 v[112:115], v[12:15], a[0:3], 0
    ds_read_b128 v[28:31], v4 offset:5120
    v_mfma_f32_16x16x32_bf16 v[116:119], v[12:15], a[4:7], 0
    v_fmac_f32 v64, v144, v128
    v_fmac_f32 v65, v145, v128
    v_mfma_f32_16x16x32_bf16 v[120:123], v[12:15], a[8:11], 0
    v_fmac_f32 v66, v146, v128
    v_fmac_f32 v67, v147, v128
    v_mfma_f32_16x16x32_bf16 v[124:127], v[12:15], a[12:15], 0
    v_fmac_f32 v80, v148, v128
    v_fmac_f32 v81, v149, v128
    s_waitcnt lgkmcnt(3)
    v_mfma_f32_16x16x32_bf16 v[96:99], v[16:19], a[16:19], v[96:99]
    ds_read_b128 v[8:11], v4 offset:6144
    v_fmac_f32 v82, v150, v128
    v_mfma_f32_16x16x32_bf16 v[100:103], v[16:19], a[20:23], v[100:103]
    v_fmac_f32 v83, v151, v128
    v_mul_f32 v64, v64, v132
    v_mfma_f32_16x16x32_bf16 v[104:107], v[16:19], a[24:27], v[104:107]
    v_mul_f32 v65, v65, v132
    v_mul_f32 v66, v66, v132
    v_mfma_f32_16x16x32_bf16 v[108:111], v[16:19], a[28:31], v[108:111]
    v_mul_f32 v67, v67, v132
    v_mul_f32 v64, v64, v80
    s_waitcnt lgkmcnt(3)
    v_mfma_f32_16x16x32_bf16 v[112:115], v[20:23], a[16:19], v[112:115]
    ds_read_b128 v[12:15], v4 offset:7168
    v_mul_f32 v65, v65, v81
    v_mfma_f32_16x16x32_bf16 v[116:119], v[20:23], a[20:23], v[116:119]
    v_mul_f32 v66, v66, v82
    v_mul_f32 v67, v67, v83
    v_mfma_f32_16x16x32_bf16 v[120:123], v[20:23], a[24:27], v[120:123]
    v_cvt_pk_bf16_f32 v176, v64, v65
    v_cvt_pk_bf16_f32 v177, v66, v67
    v_mfma_f32_16x16x32_bf16 v[124:127], v[20:23], a[28:31], v[124:127]
    v_fmac_f32 v68, v144, v129
    v_fmac_f32 v69, v145, v129
    s_waitcnt lgkmcnt(3)
    v_mfma_f32_16x16x32_bf16 v[96:99], v[24:27], a[32:35], v[96:99]
    ds_read_b128 v[16:19], v4 offset:8192
    v_fmac_f32 v70, v146, v129
    v_mfma_f32_16x16x32_bf16 v[100:103], v[24:27], a[36:39], v[100:103]
    v_fmac_f32 v71, v147, v129
    v_fmac_f32 v84, v148, v129
    v_mfma_f32_16x16x32_bf16 v[104:107], v[24:27], a[40:43], v[104:107]
    v_fmac_f32 v85, v149, v129
    v_fmac_f32 v86, v150, v129
    v_mfma_f32_16x16x32_bf16 v[108:111], v[24:27], a[44:47], v[108:111]
    v_fmac_f32 v87, v151, v129
    v_mul_f32 v68, v68, v133
    s_waitcnt lgkmcnt(3)
    v_mfma_f32_16x16x32_bf16 v[112:115], v[28:31], a[32:35], v[112:115]
    ds_read_b128 v[20:23], v4 offset:9216
    v_mul_f32 v69, v69, v133
    v_mfma_f32_16x16x32_bf16 v[116:119], v[28:31], a[36:39], v[116:119]
    v_mul_f32 v70, v70, v133
    v_mul_f32 v71, v71, v133
    v_mfma_f32_16x16x32_bf16 v[120:123], v[28:31], a[40:43], v[120:123]
    v_mul_f32 v68, v68, v84
    v_mul_f32 v69, v69, v85
    v_mfma_f32_16x16x32_bf16 v[124:127], v[28:31], a[44:47], v[124:127]
    v_mul_f32 v70, v70, v86
    v_mul_f32 v71, v71, v87
    s_waitcnt lgkmcnt(3)
    v_mfma_f32_16x16x32_bf16 v[96:99], v[8:11], a[48:51], v[96:99]
    ds_read_b128 v[24:27], v4 offset:10240
    v_cvt_pk_bf16_f32 v180, v68, v69
    v_mfma_f32_16x16x32_bf16 v[100:103], v[8:11], a[52:55], v[100:103]
    v_cvt_pk_bf16_f32 v181, v70, v71
    v_fmac_f32 v72, v144, v130
    v_mfma_f32_16x16x32_bf16 v[104:107], v[8:11], a[56:59], v[104:107]
    v_fmac_f32 v73, v145, v130
    v_fmac_f32 v74, v146, v130
    v_mfma_f32_16x16x32_bf16 v[108:111], v[8:11], a[60:63], v[108:111]
    v_fmac_f32 v75, v147, v130
    v_fmac_f32 v88, v148, v130
    s_waitcnt lgkmcnt(3)
    v_mfma_f32_16x16x32_bf16 v[112:115], v[12:15], a[48:51], v[112:115]
    ds_read_b128 v[28:31], v4 offset:11264
    v_fmac_f32 v89, v149, v130
    v_mfma_f32_16x16x32_bf16 v[116:119], v[12:15], a[52:55], v[116:119]
    v_fmac_f32 v90, v150, v130
    v_fmac_f32 v91, v151, v130
    v_mfma_f32_16x16x32_bf16 v[120:123], v[12:15], a[56:59], v[120:123]
    v_mul_f32 v72, v72, v134
    v_mul_f32 v73, v73, v134
    v_mfma_f32_16x16x32_bf16 v[124:127], v[12:15], a[60:63], v[124:127]
    v_mul_f32 v74, v74, v134
    v_mul_f32 v75, v75, v134
    s_waitcnt lgkmcnt(3)
    v_mfma_f32_16x16x32_bf16 v[96:99], v[16:19], a[64:67], v[96:99]
    ds_read_b128 v[8:11], v4 offset:12288
    v_mul_f32 v72, v72, v88
    v_mfma_f32_16x16x32_bf16 v[100:103], v[16:19], a[68:71], v[100:103]
    v_mul_f32 v73, v73, v89
    v_mul_f32 v74, v74, v90
    v_mfma_f32_16x16x32_bf16 v[104:107], v[16:19], a[72:75], v[104:107]
    v_mul_f32 v75, v75, v91
    v_cvt_pk_bf16_f32 v184, v72, v73
    v_mfma_f32_16x16x32_bf16 v[108:111], v[16:19], a[76:79], v[108:111]
    v_cvt_pk_bf16_f32 v185, v74, v75
    v_fmac_f32 v76, v144, v131
    s_waitcnt lgkmcnt(3)
    v_mfma_f32_16x16x32_bf16 v[112:115], v[20:23], a[64:67], v[112:115]
    ds_read_b128 v[12:15], v4 offset:13312
    v_fmac_f32 v77, v145, v131
    v_mfma_f32_16x16x32_bf16 v[116:119], v[20:23], a[68:71], v[116:119]
    v_fmac_f32 v78, v146, v131
    v_fmac_f32 v79, v147, v131
    v_mfma_f32_16x16x32_bf16 v[120:123], v[20:23], a[72:75], v[120:123]
    v_fmac_f32 v92, v148, v131
    v_fmac_f32 v93, v149, v131
    v_mfma_f32_16x16x32_bf16 v[124:127], v[20:23], a[76:79], v[124:127]
    v_fmac_f32 v94, v150, v131
    v_fmac_f32 v95, v151, v131
    s_waitcnt lgkmcnt(3)
    v_mfma_f32_16x16x32_bf16 v[96:99], v[24:27], a[80:83], v[96:99]
    ds_read_b128 v[16:19], v4 offset:14336
    v_mul_f32 v76, v76, v135
    v_mfma_f32_16x16x32_bf16 v[100:103], v[24:27], a[84:87], v[100:103]
    v_mul_f32 v77, v77, v135
    v_mul_f32 v78, v78, v135
    v_mfma_f32_16x16x32_bf16 v[104:107], v[24:27], a[88:91], v[104:107]
    v_mul_f32 v79, v79, v135
    v_mul_f32 v76, v76, v92
    v_mfma_f32_16x16x32_bf16 v[108:111], v[24:27], a[92:95], v[108:111]
    v_mul_f32 v77, v77, v93
    v_mul_f32 v78, v78, v94
    s_waitcnt lgkmcnt(3)
    v_mfma_f32_16x16x32_bf16 v[112:115], v[28:31], a[80:83], v[112:115]
    ds_read_b128 v[20:23], v4 offset:15360
    v_mul_f32 v79, v79, v95
    v_mfma_f32_16x16x32_bf16 v[116:119], v[28:31], a[84:87], v[116:119]
    v_cvt_pk_bf16_f32 v188, v76, v77
    v_cvt_pk_bf16_f32 v189, v78, v79
    v_mfma_f32_16x16x32_bf16 v[120:123], v[28:31], a[88:91], v[120:123]
    v_fmac_f32 v208, v136, v128
    v_fmac_f32 v209, v137, v128
    v_mfma_f32_16x16x32_bf16 v[124:127], v[28:31], a[92:95], v[124:127]
    v_fmac_f32 v210, v138, v128
    v_fmac_f32 v211, v139, v128
    s_waitcnt lgkmcnt(3)
    v_mfma_f32_16x16x32_bf16 v[96:99], v[8:11], a[96:99], v[96:99]
    ds_read_b128 v[24:27], v4 offset:16384
    v_fmac_f32 v224, v140, v128
    v_mfma_f32_16x16x32_bf16 v[100:103], v[8:11], a[100:103], v[100:103]
    v_fmac_f32 v225, v141, v128
    v_fmac_f32 v226, v142, v128
    v_mfma_f32_16x16x32_bf16 v[104:107], v[8:11], a[104:107], v[104:107]
    v_fmac_f32 v227, v143, v128
    v_mul_f32 v208, v208, v132
    v_mfma_f32_16x16x32_bf16 v[108:111], v[8:11], a[108:111], v[108:111]
    v_mul_f32 v209, v209, v132
    v_mul_f32 v210, v210, v132
    s_waitcnt lgkmcnt(3)
    v_mfma_f32_16x16x32_bf16 v[112:115], v[12:15], a[96:99], v[112:115]
    ds_read_b128 v[28:31], v4 offset:17408
    v_mul_f32 v211, v211, v132
    v_mfma_f32_16x16x32_bf16 v[116:119], v[12:15], a[100:103], v[116:119]
    v_mul_f32 v208, v208, v224
    v_mul_f32 v209, v209, v225
    v_mfma_f32_16x16x32_bf16 v[120:123], v[12:15], a[104:107], v[120:123]
    v_mul_f32 v210, v210, v226
    v_mul_f32 v211, v211, v227
    v_mfma_f32_16x16x32_bf16 v[124:127], v[12:15], a[108:111], v[124:127]
    v_cvt_pk_bf16_f32 v240, v208, v209
    v_cvt_pk_bf16_f32 v241, v210, v211
    s_waitcnt lgkmcnt(3)
    v_mfma_f32_16x16x32_bf16 v[96:99], v[16:19], a[112:115], v[96:99]
    ds_read_b128 v[8:11], v4 offset:18432
    s_add_u32 s66, s51, s65
    v_mfma_f32_16x16x32_bf16 v[100:103], v[16:19], a[116:119], v[100:103]
    buffer_store_dwordx2 v[240:241], v3, s[4:7], s66 offen offset:0 sc1
    v_fmac_f32 v212, v136, v129
    v_mfma_f32_16x16x32_bf16 v[104:107], v[16:19], a[120:123], v[104:107]
    v_fmac_f32 v213, v137, v129
    v_fmac_f32 v214, v138, v129
    v_mfma_f32_16x16x32_bf16 v[108:111], v[16:19], a[124:127], v[108:111]
    v_fmac_f32 v215, v139, v129
    v_fmac_f32 v228, v140, v129
    s_waitcnt lgkmcnt(3)
    v_mfma_f32_16x16x32_bf16 v[112:115], v[20:23], a[112:115], v[112:115]
    ds_read_b128 v[12:15], v4 offset:19456
    v_fmac_f32 v229, v141, v129
    v_mfma_f32_16x16x32_bf16 v[116:119], v[20:23], a[116:119], v[116:119]
    v_fmac_f32 v230, v142, v129
    v_fmac_f32 v231, v143, v129
    v_mfma_f32_16x16x32_bf16 v[120:123], v[20:23], a[120:123], v[120:123]
    v_mul_f32 v212, v212, v133
    v_mul_f32 v213, v213, v133
    v_mfma_f32_16x16x32_bf16 v[124:127], v[20:23], a[124:127], v[124:127]
    v_mul_f32 v214, v214, v133
    v_mul_f32 v215, v215, v133
    s_waitcnt lgkmcnt(3)
    v_mfma_f32_16x16x32_bf16 v[96:99], v[24:27], a[128:131], v[96:99]
    ds_read_b128 v[16:19], v4 offset:20480
    v_mul_f32 v212, v212, v228
    v_mfma_f32_16x16x32_bf16 v[100:103], v[24:27], a[132:135], v[100:103]
    v_mul_f32 v213, v213, v229
    v_mul_f32 v214, v214, v230
    v_mfma_f32_16x16x32_bf16 v[104:107], v[24:27], a[136:139], v[104:107]
    v_mul_f32 v215, v215, v231
    v_cvt_pk_bf16_f32 v244, v212, v213
    v_mfma_f32_16x16x32_bf16 v[108:111], v[24:27], a[140:143], v[108:111]
    v_cvt_pk_bf16_f32 v245, v214, v215
    buffer_store_dwordx2 v[244:245], v3, s[4:7], s66 offen offset:512 sc1
    s_waitcnt lgkmcnt(3)
    v_mfma_f32_16x16x32_bf16 v[112:115], v[28:31], a[128:131], v[112:115]
    ds_read_b128 v[20:23], v4 offset:21504
    v_fmac_f32 v216, v136, v130
    v_mfma_f32_16x16x32_bf16 v[116:119], v[28:31], a[132:135], v[116:119]
    v_fmac_f32 v217, v137, v130
    v_fmac_f32 v218, v138, v130
    v_mfma_f32_16x16x32_bf16 v[120:123], v[28:31], a[136:139], v[120:123]
    v_fmac_f32 v219, v139, v130
    v_fmac_f32 v232, v140, v130
    v_mfma_f32_16x16x32_bf16 v[124:127], v[28:31], a[140:143], v[124:127]
    v_fmac_f32 v233, v141, v130
    v_fmac_f32 v234, v142, v130
    s_waitcnt lgkmcnt(3)
    v_mfma_f32_16x16x32_bf16 v[96:99], v[8:11], a[144:147], v[96:99]
    ds_read_b128 v[24:27], v4 offset:22528
    v_fmac_f32 v235, v143, v130
    v_mfma_f32_16x16x32_bf16 v[100:103], v[8:11], a[148:151], v[100:103]
    v_mul_f32 v216, v216, v134
    v_mul_f32 v217, v217, v134
    v_mfma_f32_16x16x32_bf16 v[104:107], v[8:11], a[152:155], v[104:107]
    v_mul_f32 v218, v218, v134
    v_mul_f32 v219, v219, v134
    v_mfma_f32_16x16x32_bf16 v[108:111], v[8:11], a[156:159], v[108:111]
    v_mul_f32 v216, v216, v232
    v_mul_f32 v217, v217, v233
    s_waitcnt lgkmcnt(3)
    v_mfma_f32_16x16x32_bf16 v[112:115], v[12:15], a[144:147], v[112:115]
    ds_read_b128 v[28:31], v4 offset:23552
    v_mul_f32 v218, v218, v234
    v_mfma_f32_16x16x32_bf16 v[116:119], v[12:15], a[148:151], v[116:119]
    v_mul_f32 v219, v219, v235
    v_cvt_pk_bf16_f32 v248, v216, v217
    v_mfma_f32_16x16x32_bf16 v[120:123], v[12:15], a[152:155], v[120:123]
    v_cvt_pk_bf16_f32 v249, v218, v219
    buffer_store_dwordx2 v[248:249], v3, s[4:7], s66 offen offset:1024 sc1
    v_mfma_f32_16x16x32_bf16 v[124:127], v[12:15], a[156:159], v[124:127]
    v_fmac_f32 v220, v136, v131
    v_fmac_f32 v221, v137, v131
    s_waitcnt lgkmcnt(3)
    v_mfma_f32_16x16x32_bf16 v[96:99], v[16:19], a[160:163], v[96:99]
    ds_read_b128 v[8:11], v4 offset:24576
    v_fmac_f32 v222, v138, v131
    v_mfma_f32_16x16x32_bf16 v[100:103], v[16:19], a[164:167], v[100:103]
    v_fmac_f32 v223, v139, v131
    v_fmac_f32 v236, v140, v131
    v_mfma_f32_16x16x32_bf16 v[104:107], v[16:19], a[168:171], v[104:107]
    v_fmac_f32 v237, v141, v131
    v_fmac_f32 v238, v142, v131
    v_mfma_f32_16x16x32_bf16 v[108:111], v[16:19], a[172:175], v[108:111]
    v_fmac_f32 v239, v143, v131
    v_mul_f32 v220, v220, v135
    s_waitcnt lgkmcnt(3)
    v_mfma_f32_16x16x32_bf16 v[112:115], v[20:23], a[160:163], v[112:115]
    ds_read_b128 v[12:15], v4 offset:25600
    v_mul_f32 v221, v221, v135
    v_mfma_f32_16x16x32_bf16 v[116:119], v[20:23], a[164:167], v[116:119]
    v_mul_f32 v222, v222, v135
    v_mul_f32 v223, v223, v135
    v_mfma_f32_16x16x32_bf16 v[120:123], v[20:23], a[168:171], v[120:123]
    v_mul_f32 v220, v220, v236
    v_mul_f32 v221, v221, v237
    v_mfma_f32_16x16x32_bf16 v[124:127], v[20:23], a[172:175], v[124:127]
    v_mul_f32 v222, v222, v238
    v_mul_f32 v223, v223, v239
    s_waitcnt lgkmcnt(3)
    v_mfma_f32_16x16x32_bf16 v[96:99], v[24:27], a[176:179], v[96:99]
    ds_read_b128 v[16:19], v4 offset:26624
    v_cvt_pk_bf16_f32 v252, v220, v221
    v_mfma_f32_16x16x32_bf16 v[100:103], v[24:27], a[180:183], v[100:103]
    v_cvt_pk_bf16_f32 v253, v222, v223
    buffer_store_dwordx2 v[252:253], v3, s[4:7], s66 offen offset:1536 sc1
    v_mfma_f32_16x16x32_bf16 v[104:107], v[24:27], a[184:187], v[104:107]
    v_mfma_f32_16x16x32_bf16 v[108:111], v[24:27], a[188:191], v[108:111]
    s_waitcnt lgkmcnt(3)
    v_mfma_f32_16x16x32_bf16 v[112:115], v[28:31], a[176:179], v[112:115]
    ds_read_b128 v[20:23], v4 offset:27648
    v_mfma_f32_16x16x32_bf16 v[116:119], v[28:31], a[180:183], v[116:119]
    v_mfma_f32_16x16x32_bf16 v[120:123], v[28:31], a[184:187], v[120:123]
    v_mfma_f32_16x16x32_bf16 v[124:127], v[28:31], a[188:191], v[124:127]
    s_waitcnt lgkmcnt(3)
    v_mfma_f32_16x16x32_bf16 v[96:99], v[8:11], a[192:195], v[96:99]
    ds_read_b128 v[24:27], v4 offset:28672
    v_mfma_f32_16x16x32_bf16 v[100:103], v[8:11], a[196:199], v[100:103]
    v_mfma_f32_16x16x32_bf16 v[104:107], v[8:11], a[200:203], v[104:107]
    v_mfma_f32_16x16x32_bf16 v[108:111], v[8:11], a[204:207], v[108:111]
    s_waitcnt lgkmcnt(3)
    v_mfma_f32_16x16x32_bf16 v[112:115], v[12:15], a[192:195], v[112:115]
    ds_read_b128 v[28:31], v4 offset:29696
    v_mfma_f32_16x16x32_bf16 v[116:119], v[12:15], a[196:199], v[116:119]
    v_mfma_f32_16x16x32_bf16 v[120:123], v[12:15], a[200:203], v[120:123]
    v_mfma_f32_16x16x32_bf16 v[124:127], v[12:15], a[204:207], v[124:127]
    s_waitcnt lgkmcnt(3)
    v_mfma_f32_16x16x32_bf16 v[96:99], v[16:19], a[208:211], v[96:99]
    ds_read_b128 v[8:11], v4 offset:30720
    v_mfma_f32_16x16x32_bf16 v[100:103], v[16:19], a[212:215], v[100:103]
    v_mfma_f32_16x16x32_bf16 v[104:107], v[16:19], a[216:219], v[104:107]
    v_mfma_f32_16x16x32_bf16 v[108:111], v[16:19], a[220:223], v[108:111]
    s_waitcnt lgkmcnt(3)
    v_mfma_f32_16x16x32_bf16 v[112:115], v[20:23], a[208:211], v[112:115]
    ds_read_b128 v[12:15], v4 offset:31744
    v_mfma_f32_16x16x32_bf16 v[116:119], v[20:23], a[212:215], v[116:119]
    v_mfma_f32_16x16x32_bf16 v[120:123], v[20:23], a[216:219], v[120:123]
    v_mfma_f32_16x16x32_bf16 v[124:127], v[20:23], a[220:223], v[124:127]
    s_waitcnt lgkmcnt(3)
    v_mfma_f32_16x16x32_bf16 v[96:99], v[24:27], a[224:227], v[96:99]
    ds_read_b128 v[16:19], v4 offset:32768
    v_mfma_f32_16x16x32_bf16 v[100:103], v[24:27], a[228:231], v[100:103]
    v_mfma_f32_16x16x32_bf16 v[104:107], v[24:27], a[232:235], v[104:107]
    v_mfma_f32_16x16x32_bf16 v[108:111], v[24:27], a[236:239], v[108:111]
    s_waitcnt lgkmcnt(3)
    v_mfma_f32_16x16x32_bf16 v[112:115], v[28:31], a[224:227], v[112:115]
    ds_read_b128 v[20:23], v4 offset:33792
    v_mfma_f32_16x16x32_bf16 v[116:119], v[28:31], a[228:231], v[116:119]
    v_mfma_f32_16x16x32_bf16 v[120:123], v[28:31], a[232:235], v[120:123]
    v_mfma_f32_16x16x32_bf16 v[124:127], v[28:31], a[236:239], v[124:127]
    s_waitcnt lgkmcnt(3)
    v_mfma_f32_16x16x32_bf16 v[96:99], v[8:11], a[240:243], v[96:99]
    ds_read_b128 v[24:27], v4 offset:34816
    v_mfma_f32_16x16x32_bf16 v[100:103], v[8:11], a[244:247], v[100:103]
    v_mfma_f32_16x16x32_bf16 v[104:107], v[8:11], a[248:251], v[104:107]
    v_mfma_f32_16x16x32_bf16 v[108:111], v[8:11], a[252:255], v[108:111]
    ds_read_b128 v[136:139], v5 offset:256
    ds_read_b128 v[140:143], v5 offset:320
    s_waitcnt lgkmcnt(5)
    v_mfma_f32_16x16x32_bf16 v[112:115], v[12:15], a[240:243], v[112:115]
    ds_read_b128 v[28:31], v4 offset:35840
    v_mfma_f32_16x16x32_bf16 v[116:119], v[12:15], a[244:247], v[116:119]
    v_mfma_f32_16x16x32_bf16 v[120:123], v[12:15], a[248:251], v[120:123]
    v_mfma_f32_16x16x32_bf16 v[124:127], v[12:15], a[252:255], v[124:127]
    s_waitcnt lgkmcnt(5)
    v_mfma_f32_16x16x32_bf16 v[96:99], v[16:19], v[32:35], v[96:99]
    s_waitcnt vmcnt(22)
    s_barrier
    v_mfma_f32_16x16x32_bf16 v[100:103], v[16:19], v[36:39], v[100:103]
    v_add_u32 v4, 0x9000, v4
    ds_read_b128 v[8:11], v4 offset:0
    v_mfma_f32_16x16x32_bf16 v[104:107], v[16:19], v[40:43], v[104:107]
    v_mfma_f32_16x16x32_bf16 v[108:111], v[16:19], v[44:47], v[108:111]
    s_waitcnt lgkmcnt(5)
    v_mfma_f32_16x16x32_bf16 v[112:115], v[20:23], v[32:35], v[112:115]
    ds_read_b128 v[12:15], v4 offset:1024
    v_mfma_f32_16x16x32_bf16 v[116:119], v[20:23], v[36:39], v[116:119]
    v_mfma_f32_16x16x32_bf16 v[120:123], v[20:23], v[40:43], v[120:123]
    v_mfma_f32_16x16x32_bf16 v[124:127], v[20:23], v[44:47], v[124:127]
    s_waitcnt lgkmcnt(5)
    v_mfma_f32_16x16x32_bf16 v[96:99], v[24:27], v[48:51], v[96:99]
    ds_read_b128 v[16:19], v4 offset:2048
    v_mfma_f32_16x16x32_bf16 v[100:103], v[24:27], v[52:55], v[100:103]
    v_mfma_f32_16x16x32_bf16 v[104:107], v[24:27], v[56:59], v[104:107]
    v_mfma_f32_16x16x32_bf16 v[108:111], v[24:27], v[60:63], v[108:111]
    s_waitcnt lgkmcnt(3)
    v_mfma_f32_16x16x32_bf16 v[112:115], v[28:31], v[48:51], v[112:115]
    ds_read_b128 v[20:23], v4 offset:3072
    v_mfma_f32_16x16x32_bf16 v[116:119], v[28:31], v[52:55], v[116:119]
    v_mfma_f32_16x16x32_bf16 v[120:123], v[28:31], v[56:59], v[120:123]
    v_mfma_f32_16x16x32_bf16 v[124:127], v[28:31], v[60:63], v[124:127]
    s_waitcnt lgkmcnt(3)
    v_mfma_f32_16x16x32_bf16 v[64:67], v[8:11], a[0:3], 0
    ds_read_b128 v[24:27], v4 offset:4096
    v_mfma_f32_16x16x32_bf16 v[68:71], v[8:11], a[4:7], 0
    v_mfma_f32_16x16x32_bf16 v[72:75], v[8:11], a[8:11], 0
    v_mfma_f32_16x16x32_bf16 v[76:79], v[8:11], a[12:15], 0
    s_waitcnt lgkmcnt(3)
    v_mfma_f32_16x16x32_bf16 v[80:83], v[12:15], a[0:3], 0
    ds_read_b128 v[28:31], v4 offset:5120
    v_mfma_f32_16x16x32_bf16 v[84:87], v[12:15], a[4:7], 0
    v_fmac_f32 v96, v136, v128
    v_fmac_f32 v97, v137, v128
    v_mfma_f32_16x16x32_bf16 v[88:91], v[12:15], a[8:11], 0
    v_fmac_f32 v98, v138, v128
    v_fmac_f32 v99, v139, v128
    v_mfma_f32_16x16x32_bf16 v[92:95], v[12:15], a[12:15], 0
    v_fmac_f32 v112, v140, v128
    v_fmac_f32 v113, v141, v128
    s_waitcnt lgkmcnt(3)
    v_mfma_f32_16x16x32_bf16 v[64:67], v[16:19], a[16:19], v[64:67]
    ds_read_b128 v[8:11], v4 offset:6144
    v_fmac_f32 v114, v142, v128
    v_mfma_f32_16x16x32_bf16 v[68:71], v[16:19], a[20:23], v[68:71]
    v_fmac_f32 v115, v143, v128
    v_mul_f32 v96, v96, v132
    v_mfma_f32_16x16x32_bf16 v[72:75], v[16:19], a[24:27], v[72:75]
    v_mul_f32 v97, v97, v132
    v_mul_f32 v98, v98, v132
    v_mfma_f32_16x16x32_bf16 v[76:79], v[16:19], a[28:31], v[76:79]
    v_mul_f32 v99, v99, v132
    v_mul_f32 v96, v96, v112
    s_waitcnt lgkmcnt(3)
    v_mfma_f32_16x16x32_bf16 v[80:83], v[20:23], a[16:19], v[80:83]
    ds_read_b128 v[12:15], v4 offset:7168
    v_mul_f32 v97, v97, v113
    v_mfma_f32_16x16x32_bf16 v[84:87], v[20:23], a[20:23], v[84:87]
    v_mul_f32 v98, v98, v114
    v_mul_f32 v99, v99, v115
    v_mfma_f32_16x16x32_bf16 v[88:91], v[20:23], a[24:27], v[88:91]
    v_cvt_pk_bf16_f32 v178, v96, v97
    v_cvt_pk_bf16_f32 v179, v98, v99
    v_mfma_f32_16x16x32_bf16 v[92:95], v[20:23], a[28:31], v[92:95]
    s_add_u32 s66, s51, 0
    buffer_store_dwordx4 v[176:179], v2, s[4:7], s66 offen offset:0 sc1
    s_waitcnt lgkmcnt(3)
    v_mfma_f32_16x16x32_bf16 v[64:67], v[24:27], a[32:35], v[64:67]
    ds_read_b128 v[16:19], v4 offset:8192
    v_fmac_f32 v100, v136, v129
    v_mfma_f32_16x16x32_bf16 v[68:71], v[24:27], a[36:39], v[68:71]
    v_fmac_f32 v101, v137, v129
    v_fmac_f32 v102, v138, v129
    v_mfma_f32_16x16x32_bf16 v[72:75], v[24:27], a[40:43], v[72:75]
    v_fmac_f32 v103, v139, v129
    v_fmac_f32 v116, v140, v129
    v_mfma_f32_16x16x32_bf16 v[76:79], v[24:27], a[44:47], v[76:79]
    v_fmac_f32 v117, v141, v129
    v_fmac_f32 v118, v142, v129
    s_waitcnt lgkmcnt(3)
    v_mfma_f32_16x16x32_bf16 v[80:83], v[28:31], a[32:35], v[80:83]
    ds_read_b128 v[20:23], v4 offset:9216
    v_fmac_f32 v119, v143, v129
    v_mfma_f32_16x16x32_bf16 v[84:87], v[28:31], a[36:39], v[84:87]
    v_mul_f32 v100, v100, v133
    v_mul_f32 v101, v101, v133
    v_mfma_f32_16x16x32_bf16 v[88:91], v[28:31], a[40:43], v[88:91]
    v_mul_f32 v102, v102, v133
    v_mul_f32 v103, v103, v133
    v_mfma_f32_16x16x32_bf16 v[92:95], v[28:31], a[44:47], v[92:95]
    v_mul_f32 v100, v100, v116
    v_mul_f32 v101, v101, v117
    s_waitcnt lgkmcnt(3)
    v_mfma_f32_16x16x32_bf16 v[64:67], v[8:11], a[48:51], v[64:67]
    ds_read_b128 v[24:27], v4 offset:10240
    v_mul_f32 v102, v102, v118
    v_mfma_f32_16x16x32_bf16 v[68:71], v[8:11], a[52:55], v[68:71]
    v_mul_f32 v103, v103, v119
    v_cvt_pk_bf16_f32 v182, v100, v101
    v_mfma_f32_16x16x32_bf16 v[72:75], v[8:11], a[56:59], v[72:75]
    v_cvt_pk_bf16_f32 v183, v102, v103
    buffer_store_dwordx4 v[180:183], v2, s[4:7], s66 offen offset:1024 sc1
    v_mfma_f32_16x16x32_bf16 v[76:79], v[8:11], a[60:63], v[76:79]
    v_fmac_f32 v104, v136, v130
    v_fmac_f32 v105, v137, v130
    s_waitcnt lgkmcnt(3)
    v_mfma_f32_16x16x32_bf16 v[80:83], v[12:15], a[48:51], v[80:83]
    ds_read_b128 v[28:31], v4 offset:11264
    v_fmac_f32 v106, v138, v130
    v_mfma_f32_16x16x32_bf16 v[84:87], v[12:15], a[52:55], v[84:87]
    v_fmac_f32 v107, v139, v130
    v_fmac_f32 v120, v140, v130
    v_mfma_f32_16x16x32_bf16 v[88:91], v[12:15], a[56:59], v[88:91]
    v_fmac_f32 v121, v141, v130
    v_fmac_f32 v122, v142, v130
    v_mfma_f32_16x16x32_bf16 v[92:95], v[12:15], a[60:63], v[92:95]
    v_fmac_f32 v123, v143, v130
    v_mul_f32 v104, v104, v134
    s_waitcnt lgkmcnt(3)
    v_mfma_f32_16x16x32_bf16 v[64:67], v[16:19], a[64:67], v[64:67]
    ds_read_b128 v[8:11], v4 offset:12288
    v_mul_f32 v105, v105, v134
    v_mfma_f32_16x16x32_bf16 v[68:71], v[16:19], a[68:71], v[68:71]
    v_mul_f32 v106, v106, v134
    v_mul_f32 v107, v107, v134
    v_mfma_f32_16x16x32_bf16 v[72:75], v[16:19], a[72:75], v[72:75]
    v_mul_f32 v104, v104, v120
    v_mul_f32 v105, v105, v121
    v_mfma_f32_16x16x32_bf16 v[76:79], v[16:19], a[76:79], v[76:79]
    v_mul_f32 v106, v106, v122
    v_mul_f32 v107, v107, v123
    s_waitcnt lgkmcnt(3)
    v_mfma_f32_16x16x32_bf16 v[80:83], v[20:23], a[64:67], v[80:83]
    ds_read_b128 v[12:15], v4 offset:13312
    v_cvt_pk_bf16_f32 v186, v104, v105
    v_mfma_f32_16x16x32_bf16 v[84:87], v[20:23], a[68:71], v[84:87]
    v_cvt_pk_bf16_f32 v187, v106, v107
    buffer_store_dwordx4 v[184:187], v2, s[4:7], s66 offen offset:2048 sc1
    v_mfma_f32_16x16x32_bf16 v[88:91], v[20:23], a[72:75], v[88:91]
    v_fmac_f32 v108, v136, v131
    v_fmac_f32 v109, v137, v131
    v_mfma_f32_16x16x32_bf16 v[92:95], v[20:23], a[76:79], v[92:95]
    v_fmac_f32 v110, v138, v131
    v_fmac_f32 v111, v139, v131
    s_waitcnt lgkmcnt(3)
    v_mfma_f32_16x16x32_bf16 v[64:67], v[24:27], a[80:83], v[64:67]
    ds_read_b128 v[16:19], v4 offset:14336
    v_fmac_f32 v124, v140, v131
    v_mfma_f32_16x16x32_bf16 v[68:71], v[24:27], a[84:87], v[68:71]
    v_fmac_f32 v125, v141, v131
    v_fmac_f32 v126, v142, v131
    v_mfma_f32_16x16x32_bf16 v[72:75], v[24:27], a[88:91], v[72:75]
    v_fmac_f32 v127, v143, v131
    v_mul_f32 v108, v108, v135
    v_mfma_f32_16x16x32_bf16 v[76:79], v[24:27], a[92:95], v[76:79]
    v_mul_f32 v109, v109, v135
    v_mul_f32 v110, v110, v135
    s_waitcnt lgkmcnt(3)
    v_mfma_f32_16x16x32_bf16 v[80:83], v[28:31], a[80:83], v[80:83]
    ds_read_b128 v[20:23], v4 offset:15360
    v_mul_f32 v111, v111, v135
    v_mfma_f32_16x16x32_bf16 v[84:87], v[28:31], a[84:87], v[84:87]
    v_mul_f32 v108, v108, v124
    v_mul_f32 v109, v109, v125
    v_mfma_f32_16x16x32_bf16 v[88:91], v[28:31], a[88:91], v[88:91]
    v_mul_f32 v110, v110, v126
    v_mul_f32 v111, v111, v127
    v_mfma_f32_16x16x32_bf16 v[92:95], v[28:31], a[92:95], v[92:95]
    v_cvt_pk_bf16_f32 v190, v108, v109
    v_cvt_pk_bf16_f32 v191, v110, v111
    s_waitcnt lgkmcnt(3)
    v_mfma_f32_16x16x32_bf16 v[64:67], v[8:11], a[96:99], v[64:67]
    ds_read_b128 v[24:27], v4 offset:16384
    buffer_store_dwordx4 v[188:191], v2, s[4:7], s66 offen offset:3072 sc1
    v_mfma_f32_16x16x32_bf16 v[68:71], v[8:11], a[100:103], v[68:71]
    v_mfma_f32_16x16x32_bf16 v[72:75], v[8:11], a[104:107], v[72:75]
    v_mfma_f32_16x16x32_bf16 v[76:79], v[8:11], a[108:111], v[76:79]
    s_waitcnt lgkmcnt(3)
    v_mfma_f32_16x16x32_bf16 v[80:83], v[12:15], a[96:99], v[80:83]
    ds_read_b128 v[28:31], v4 offset:17408
    v_mfma_f32_16x16x32_bf16 v[84:87], v[12:15], a[100:103], v[84:87]
    v_mfma_f32_16x16x32_bf16 v[88:91], v[12:15], a[104:107], v[88:91]
    v_mfma_f32_16x16x32_bf16 v[92:95], v[12:15], a[108:111], v[92:95]
    s_waitcnt lgkmcnt(3)
    v_mfma_f32_16x16x32_bf16 v[64:67], v[16:19], a[112:115], v[64:67]
    ds_read_b128 v[8:11], v4 offset:18432
    v_mfma_f32_16x16x32_bf16 v[68:71], v[16:19], a[116:119], v[68:71]
    v_mfma_f32_16x16x32_bf16 v[72:75], v[16:19], a[120:123], v[72:75]
    v_mfma_f32_16x16x32_bf16 v[76:79], v[16:19], a[124:127], v[76:79]
    s_waitcnt lgkmcnt(3)
    v_mfma_f32_16x16x32_bf16 v[80:83], v[20:23], a[112:115], v[80:83]
    ds_read_b128 v[12:15], v4 offset:19456
    v_mfma_f32_16x16x32_bf16 v[84:87], v[20:23], a[116:119], v[84:87]
    v_mfma_f32_16x16x32_bf16 v[88:91], v[20:23], a[120:123], v[88:91]
    v_mfma_f32_16x16x32_bf16 v[92:95], v[20:23], a[124:127], v[92:95]
    s_waitcnt lgkmcnt(3)
    v_mfma_f32_16x16x32_bf16 v[64:67], v[24:27], a[128:131], v[64:67]
    ds_read_b128 v[16:19], v4 offset:20480
    v_mfma_f32_16x16x32_bf16 v[68:71], v[24:27], a[132:135], v[68:71]
    v_mfma_f32_16x16x32_bf16 v[72:75], v[24:27], a[136:139], v[72:75]
    v_mfma_f32_16x16x32_bf16 v[76:79], v[24:27], a[140:143], v[76:79]
    s_waitcnt lgkmcnt(3)
    v_mfma_f32_16x16x32_bf16 v[80:83], v[28:31], a[128:131], v[80:83]
    ds_read_b128 v[20:23], v4 offset:21504
    v_mfma_f32_16x16x32_bf16 v[84:87], v[28:31], a[132:135], v[84:87]
    v_mfma_f32_16x16x32_bf16 v[88:91], v[28:31], a[136:139], v[88:91]
    v_mfma_f32_16x16x32_bf16 v[92:95], v[28:31], a[140:143], v[92:95]
    s_waitcnt lgkmcnt(3)
    v_mfma_f32_16x16x32_bf16 v[64:67], v[8:11], a[144:147], v[64:67]
    ds_read_b128 v[24:27], v4 offset:22528
    v_mfma_f32_16x16x32_bf16 v[68:71], v[8:11], a[148:151], v[68:71]
    v_mfma_f32_16x16x32_bf16 v[72:75], v[8:11], a[152:155], v[72:75]
    v_mfma_f32_16x16x32_bf16 v[76:79], v[8:11], a[156:159], v[76:79]
    s_waitcnt lgkmcnt(3)
    v_mfma_f32_16x16x32_bf16 v[80:83], v[12:15], a[144:147], v[80:83]
    ds_read_b128 v[28:31], v4 offset:23552
    v_mfma_f32_16x16x32_bf16 v[84:87], v[12:15], a[148:151], v[84:87]
    v_mfma_f32_16x16x32_bf16 v[88:91], v[12:15], a[152:155], v[88:91]
    v_mfma_f32_16x16x32_bf16 v[92:95], v[12:15], a[156:159], v[92:95]
    s_waitcnt lgkmcnt(3)
    v_mfma_f32_16x16x32_bf16 v[64:67], v[16:19], a[160:163], v[64:67]
    ds_read_b128 v[8:11], v4 offset:24576
    v_mfma_f32_16x16x32_bf16 v[68:71], v[16:19], a[164:167], v[68:71]
    v_mfma_f32_16x16x32_bf16 v[72:75], v[16:19], a[168:171], v[72:75]
    v_mfma_f32_16x16x32_bf16 v[76:79], v[16:19], a[172:175], v[76:79]
    s_waitcnt lgkmcnt(3)
    v_mfma_f32_16x16x32_bf16 v[80:83], v[20:23], a[160:163], v[80:83]
    ds_read_b128 v[12:15], v4 offset:25600
    v_mfma_f32_16x16x32_bf16 v[84:87], v[20:23], a[164:167], v[84:87]
    v_mfma_f32_16x16x32_bf16 v[88:91], v[20:23], a[168:171], v[88:91]
    v_mfma_f32_16x16x32_bf16 v[92:95], v[20:23], a[172:175], v[92:95]
    s_waitcnt lgkmcnt(3)
    v_mfma_f32_16x16x32_bf16 v[64:67], v[24:27], a[176:179], v[64:67]
    ds_read_b128 v[16:19], v4 offset:26624
    v_mfma_f32_16x16x32_bf16 v[68:71], v[24:27], a[180:183], v[68:71]
    v_mfma_f32_16x16x32_bf16 v[72:75], v[24:27], a[184:187], v[72:75]
    v_mfma_f32_16x16x32_bf16 v[76:79], v[24:27], a[188:191], v[76:79]
    s_waitcnt lgkmcnt(3)
    v_mfma_f32_16x16x32_bf16 v[80:83], v[28:31], a[176:179], v[80:83]
    ds_read_b128 v[20:23], v4 offset:27648
    v_mfma_f32_16x16x32_bf16 v[84:87], v[28:31], a[180:183], v[84:87]
    v_mfma_f32_16x16x32_bf16 v[88:91], v[28:31], a[184:187], v[88:91]
    v_mfma_f32_16x16x32_bf16 v[92:95], v[28:31], a[188:191], v[92:95]
    s_waitcnt lgkmcnt(3)
    v_mfma_f32_16x16x32_bf16 v[64:67], v[8:11], a[192:195], v[64:67]
    ds_read_b128 v[24:27], v4 offset:28672
    v_mfma_f32_16x16x32_bf16 v[68:71], v[8:11], a[196:199], v[68:71]
    v_mfma_f32_16x16x32_bf16 v[72:75], v[8:11], a[200:203], v[72:75]
    v_mfma_f32_16x16x32_bf16 v[76:79], v[8:11], a[204:207], v[76:79]
    s_waitcnt lgkmcnt(3)
    v_mfma_f32_16x16x32_bf16 v[80:83], v[12:15], a[192:195], v[80:83]
    ds_read_b128 v[28:31], v4 offset:29696
    v_mfma_f32_16x16x32_bf16 v[84:87], v[12:15], a[196:199], v[84:87]
    v_mfma_f32_16x16x32_bf16 v[88:91], v[12:15], a[200:203], v[88:91]
    v_mfma_f32_16x16x32_bf16 v[92:95], v[12:15], a[204:207], v[92:95]
    s_waitcnt lgkmcnt(3)
    v_mfma_f32_16x16x32_bf16 v[64:67], v[16:19], a[208:211], v[64:67]
    ds_read_b128 v[8:11], v4 offset:30720
    v_mfma_f32_16x16x32_bf16 v[68:71], v[16:19], a[212:215], v[68:71]
    v_mfma_f32_16x16x32_bf16 v[72:75], v[16:19], a[216:219], v[72:75]
    v_mfma_f32_16x16x32_bf16 v[76:79], v[16:19], a[220:223], v[76:79]
    s_waitcnt lgkmcnt(3)
    v_mfma_f32_16x16x32_bf16 v[80:83], v[20:23], a[208:211], v[80:83]
    ds_read_b128 v[12:15], v4 offset:31744
    v_mfma_f32_16x16x32_bf16 v[84:87], v[20:23], a[212:215], v[84:87]
    v_mfma_f32_16x16x32_bf16 v[88:91], v[20:23], a[216:219], v[88:91]
    v_mfma_f32_16x16x32_bf16 v[92:95], v[20:23], a[220:223], v[92:95]
    s_waitcnt lgkmcnt(3)
    v_mfma_f32_16x16x32_bf16 v[64:67], v[24:27], a[224:227], v[64:67]
    ds_read_b128 v[16:19], v4 offset:32768
    v_mfma_f32_16x16x32_bf16 v[68:71], v[24:27], a[228:231], v[68:71]
    v_mfma_f32_16x16x32_bf16 v[72:75], v[24:27], a[232:235], v[72:75]
    v_mfma_f32_16x16x32_bf16 v[76:79], v[24:27], a[236:239], v[76:79]
    s_waitcnt lgkmcnt(3)
    v_mfma_f32_16x16x32_bf16 v[80:83], v[28:31], a[224:227], v[80:83]
    ds_read_b128 v[20:23], v4 offset:33792
    v_mfma_f32_16x16x32_bf16 v[84:87], v[28:31], a[228:231], v[84:87]
    v_mfma_f32_16x16x32_bf16 v[88:91], v[28:31], a[232:235], v[88:91]
    v_mfma_f32_16x16x32_bf16 v[92:95], v[28:31], a[236:239], v[92:95]
    s_waitcnt lgkmcnt(3)
    v_mfma_f32_16x16x32_bf16 v[64:67], v[8:11], a[240:243], v[64:67]
    ds_read_b128 v[24:27], v4 offset:34816
    v_mfma_f32_16x16x32_bf16 v[68:71], v[8:11], a[244:247], v[68:71]
    v_mfma_f32_16x16x32_bf16 v[72:75], v[8:11], a[248:251], v[72:75]
    v_mfma_f32_16x16x32_bf16 v[76:79], v[8:11], a[252:255], v[76:79]
    ds_read_b128 v[144:147], v5 offset:384
    ds_read_b128 v[148:151], v5 offset:448
    s_waitcnt lgkmcnt(5)
    v_mfma_f32_16x16x32_bf16 v[80:83], v[12:15], a[240:243], v[80:83]
    ds_read_b128 v[28:31], v4 offset:35840
    v_mfma_f32_16x16x32_bf16 v[84:87], v[12:15], a[244:247], v[84:87]
    v_mfma_f32_16x16x32_bf16 v[88:91], v[12:15], a[248:251], v[88:91]
    v_mfma_f32_16x16x32_bf16 v[92:95], v[12:15], a[252:255], v[92:95]
    s_waitcnt lgkmcnt(5)
    v_mfma_f32_16x16x32_bf16 v[64:67], v[16:19], v[32:35], v[64:67]
    s_waitcnt vmcnt(17)
    s_barrier
    v_mfma_f32_16x16x32_bf16 v[68:71], v[16:19], v[36:39], v[68:71]
    v_add_u32 v4, 0xfffe5000, v4
    ds_read_b128 v[8:11], v4 offset:0
    v_mfma_f32_16x16x32_bf16 v[72:75], v[16:19], v[40:43], v[72:75]
    s_add_u32 m0, s49, 73728
    s_add_u32 s61, s48, 221184
    v_mfma_f32_16x16x32_bf16 v[76:79], v[16:19], v[44:47], v[76:79]
    buffer_load_dwordx4 v2, s[4:7], s61 offen offset:0 lds
    buffer_load_dwordx4 v2, s[4:7], s61 offen offset:1024 lds
    s_waitcnt lgkmcnt(5)
    v_mfma_f32_16x16x32_bf16 v[80:83], v[20:23], v[32:35], v[80:83]
    ds_read_b128 v[12:15], v4 offset:1024
    buffer_load_dwordx4 v2, s[4:7], s61 offen offset:2048 lds
    v_mfma_f32_16x16x32_bf16 v[84:87], v[20:23], v[36:39], v[84:87]
    buffer_load_dwordx4 v2, s[4:7], s61 offen offset:3072 lds
    s_add_u32 m0, s49, 77824
    v_mfma_f32_16x16x32_bf16 v[88:91], v[20:23], v[40:43], v[88:91]
    s_add_u32 s61, s48, 225280
    buffer_load_dwordx4 v2, s[4:7], s61 offen offset:0 lds
    v_mfma_f32_16x16x32_bf16 v[92:95], v[20:23], v[44:47], v[92:95]
    buffer_load_dwordx4 v2, s[4:7], s61 offen offset:1024 lds
    buffer_load_dwordx4 v2, s[4:7], s61 offen offset:2048 lds
    s_waitcnt lgkmcnt(5)
    v_mfma_f32_16x16x32_bf16 v[64:67], v[24:27], v[48:51], v[64:67]
    ds_read_b128 v[16:19], v4 offset:2048
    buffer_load_dwordx4 v2, s[4:7], s61 offen offset:3072 lds
    v_mfma_f32_16x16x32_bf16 v[68:71], v[24:27], v[52:55], v[68:71]
    s_add_u32 m0, s49, 81920
    s_add_u32 s61, s48, 229376
    v_mfma_f32_16x16x32_bf16 v[72:75], v[24:27], v[56:59], v[72:75]
    buffer_load_dwordx4 v2, s[4:7], s61 offen offset:0 lds
    v_mfma_f32_16x16x32_bf16 v[76:79], v[24:27], v[60:63], v[76:79]
    s_waitcnt lgkmcnt(3)
    v_mfma_f32_16x16x32_bf16 v[80:83], v[28:31], v[48:51], v[80:83]
    ds_read_b128 v[20:23], v4 offset:3072
    v_mfma_f32_16x16x32_bf16 v[84:87], v[28:31], v[52:55], v[84:87]
    v_mfma_f32_16x16x32_bf16 v[88:91], v[28:31], v[56:59], v[88:91]
    v_mfma_f32_16x16x32_bf16 v[92:95], v[28:31], v[60:63], v[92:95]
    s_waitcnt lgkmcnt(3)
    v_mfma_f32_16x16x32_bf16 v[96:99], v[8:11], a[0:3], 0
    ds_read_b128 v[24:27], v4 offset:4096
    v_mfma_f32_16x16x32_bf16 v[100:103], v[8:11], a[4:7], 0
    v_mfma_f32_16x16x32_bf16 v[104:107], v[8:11], a[8:11], 0
    v_mfma_f32_16x16x32_bf16 v[108:111], v[8:11], a[12:15], 0
    s_waitcnt lgkmcnt(3)
    v_mfma_f32_16x16x32_bf16 v[112:115], v[12:15], a[0:3], 0
    ds_read_b128 v[28:31], v4 offset:5120
    v_mfma_f32_16x16x32_bf16 v[116:119], v[12:15], a[4:7], 0
    v_fmac_f32 v64, v144, v128
    v_fmac_f32 v65, v145, v128
    v_mfma_f32_16x16x32_bf16 v[120:123], v[12:15], a[8:11], 0
    v_fmac_f32 v66, v146, v128
    v_fmac_f32 v67, v147, v128
    v_mfma_f32_16x16x32_bf16 v[124:127], v[12:15], a[12:15], 0
    v_fmac_f32 v80, v148, v128
    v_fmac_f32 v81, v149, v128
    s_waitcnt lgkmcnt(3)
    v_mfma_f32_16x16x32_bf16 v[96:99], v[16:19], a[16:19], v[96:99]
    ds_read_b128 v[8:11], v4 offset:6144
    v_fmac_f32 v82, v150, v128
    v_mfma_f32_16x16x32_bf16 v[100:103], v[16:19], a[20:23], v[100:103]
    v_fmac_f32 v83, v151, v128
    v_mul_f32 v64, v64, v132
    v_mfma_f32_16x16x32_bf16 v[104:107], v[16:19], a[24:27], v[104:107]
    v_mul_f32 v65, v65, v132
    v_mul_f32 v66, v66, v132
    v_mfma_f32_16x16x32_bf16 v[108:111], v[16:19], a[28:31], v[108:111]
    v_mul_f32 v67, v67, v132
    v_mul_f32 v64, v64, v80
    s_waitcnt lgkmcnt(3)
    v_mfma_f32_16x16x32_bf16 v[112:115], v[20:23], a[16:19], v[112:115]
    ds_read_b128 v[12:15], v4 offset:7168
    v_mul_f32 v65, v65, v81
    v_mfma_f32_16x16x32_bf16 v[116:119], v[20:23], a[20:23], v[116:119]
    v_mul_f32 v66, v66, v82
    v_mul_f32 v67, v67, v83
    v_mfma_f32_16x16x32_bf16 v[120:123], v[20:23], a[24:27], v[120:123]
    v_cvt_pk_bf16_f32 v192, v64, v65
    v_cvt_pk_bf16_f32 v193, v66, v67
    v_mfma_f32_16x16x32_bf16 v[124:127], v[20:23], a[28:31], v[124:127]
    v_fmac_f32 v68, v144, v129
    v_fmac_f32 v69, v145, v129
    s_waitcnt lgkmcnt(3)
    v_mfma_f32_16x16x32_bf16 v[96:99], v[24:27], a[32:35], v[96:99]
    ds_read_b128 v[16:19], v4 offset:8192
    v_fmac_f32 v70, v146, v129
    v_mfma_f32_16x16x32_bf16 v[100:103], v[24:27], a[36:39], v[100:103]
    v_fmac_f32 v71, v147, v129
    v_fmac_f32 v84, v148, v129
    v_mfma_f32_16x16x32_bf16 v[104:107], v[24:27], a[40:43], v[104:107]
    v_fmac_f32 v85, v149, v129
    v_fmac_f32 v86, v150, v129
    v_mfma_f32_16x16x32_bf16 v[108:111], v[24:27], a[44:47], v[108:111]
    v_fmac_f32 v87, v151, v129
    v_mul_f32 v68, v68, v133
    s_waitcnt lgkmcnt(3)
    v_mfma_f32_16x16x32_bf16 v[112:115], v[28:31], a[32:35], v[112:115]
    ds_read_b128 v[20:23], v4 offset:9216
    v_mul_f32 v69, v69, v133
    v_mfma_f32_16x16x32_bf16 v[116:119], v[28:31], a[36:39], v[116:119]
    v_mul_f32 v70, v70, v133
    v_mul_f32 v71, v71, v133
    v_mfma_f32_16x16x32_bf16 v[120:123], v[28:31], a[40:43], v[120:123]
    v_mul_f32 v68, v68, v84
    v_mul_f32 v69, v69, v85
    v_mfma_f32_16x16x32_bf16 v[124:127], v[28:31], a[44:47], v[124:127]
    v_mul_f32 v70, v70, v86
    v_mul_f32 v71, v71, v87
    s_waitcnt lgkmcnt(3)
    v_mfma_f32_16x16x32_bf16 v[96:99], v[8:11], a[48:51], v[96:99]
    ds_read_b128 v[24:27], v4 offset:10240
    v_cvt_pk_bf16_f32 v196, v68, v69
    v_mfma_f32_16x16x32_bf16 v[100:103], v[8:11], a[52:55], v[100:103]
    v_cvt_pk_bf16_f32 v197, v70, v71
    v_fmac_f32 v72, v144, v130
    v_mfma_f32_16x16x32_bf16 v[104:107], v[8:11], a[56:59], v[104:107]
    v_fmac_f32 v73, v145, v130
    v_fmac_f32 v74, v146, v130
    v_mfma_f32_16x16x32_bf16 v[108:111], v[8:11], a[60:63], v[108:111]
    v_fmac_f32 v75, v147, v130
    v_fmac_f32 v88, v148, v130
    s_waitcnt lgkmcnt(3)
    v_mfma_f32_16x16x32_bf16 v[112:115], v[12:15], a[48:51], v[112:115]
    ds_read_b128 v[28:31], v4 offset:11264
    v_fmac_f32 v89, v149, v130
    v_mfma_f32_16x16x32_bf16 v[116:119], v[12:15], a[52:55], v[116:119]
    v_fmac_f32 v90, v150, v130
    v_fmac_f32 v91, v151, v130
    v_mfma_f32_16x16x32_bf16 v[120:123], v[12:15], a[56:59], v[120:123]
    v_mul_f32 v72, v72, v134
    v_mul_f32 v73, v73, v134
    v_mfma_f32_16x16x32_bf16 v[124:127], v[12:15], a[60:63], v[124:127]
    v_mul_f32 v74, v74, v134
    v_mul_f32 v75, v75, v134
    s_waitcnt lgkmcnt(3)
    v_mfma_f32_16x16x32_bf16 v[96:99], v[16:19], a[64:67], v[96:99]
    ds_read_b128 v[8:11], v4 offset:12288
    v_mul_f32 v72, v72, v88
    v_mfma_f32_16x16x32_bf16 v[100:103], v[16:19], a[68:71], v[100:103]
    v_mul_f32 v73, v73, v89
    v_mul_f32 v74, v74, v90
    v_mfma_f32_16x16x32_bf16 v[104:107], v[16:19], a[72:75], v[104:107]
    v_mul_f32 v75, v75, v91
    v_cvt_pk_bf16_f32 v200, v72, v73
    v_mfma_f32_16x16x32_bf16 v[108:111], v[16:19], a[76:79], v[108:111]
    v_cvt_pk_bf16_f32 v201, v74, v75
    v_fmac_f32 v76, v144, v131
    s_waitcnt lgkmcnt(3)
    v_mfma_f32_16x16x32_bf16 v[112:115], v[20:23], a[64:67], v[112:115]
    ds_read_b128 v[12:15], v4 offset:13312
    v_fmac_f32 v77, v145, v131
    v_mfma_f32_16x16x32_bf16 v[116:119], v[20:23], a[68:71], v[116:119]
    v_fmac_f32 v78, v146, v131
    v_fmac_f32 v79, v147, v131
    v_mfma_f32_16x16x32_bf16 v[120:123], v[20:23], a[72:75], v[120:123]
    v_fmac_f32 v92, v148, v131
    v_fmac_f32 v93, v149, v131
    v_mfma_f32_16x16x32_bf16 v[124:127], v[20:23], a[76:79], v[124:127]
    v_fmac_f32 v94, v150, v131
    v_fmac_f32 v95, v151, v131
    s_waitcnt lgkmcnt(3)
    v_mfma_f32_16x16x32_bf16 v[96:99], v[24:27], a[80:83], v[96:99]
    ds_read_b128 v[16:19], v4 offset:14336
    v_mul_f32 v76, v76, v135
    v_mfma_f32_16x16x32_bf16 v[100:103], v[24:27], a[84:87], v[100:103]
    v_mul_f32 v77, v77, v135
    v_mul_f32 v78, v78, v135
    v_mfma_f32_16x16x32_bf16 v[104:107], v[24:27], a[88:91], v[104:107]
    v_mul_f32 v79, v79, v135
    v_mul_f32 v76, v76, v92
    v_mfma_f32_16x16x32_bf16 v[108:111], v[24:27], a[92:95], v[108:111]
    v_mul_f32 v77, v77, v93
    v_mul_f32 v78, v78, v94
    s_waitcnt lgkmcnt(3)
    v_mfma_f32_16x16x32_bf16 v[112:115], v[28:31], a[80:83], v[112:115]
    ds_read_b128 v[20:23], v4 offset:15360
    v_mul_f32 v79, v79, v95
    v_mfma_f32_16x16x32_bf16 v[116:119], v[28:31], a[84:87], v[116:119]
    v_cvt_pk_bf16_f32 v204, v76, v77
    v_cvt_pk_bf16_f32 v205, v78, v79
    v_mfma_f32_16x16x32_bf16 v[120:123], v[28:31], a[88:91], v[120:123]
    v_mfma_f32_16x16x32_bf16 v[124:127], v[28:31], a[92:95], v[124:127]
    s_waitcnt lgkmcnt(3)
    v_mfma_f32_16x16x32_bf16 v[96:99], v[8:11], a[96:99], v[96:99]
    ds_read_b128 v[24:27], v4 offset:16384
    v_mfma_f32_16x16x32_bf16 v[100:103], v[8:11], a[100:103], v[100:103]
    v_mfma_f32_16x16x32_bf16 v[104:107], v[8:11], a[104:107], v[104:107]
    v_mfma_f32_16x16x32_bf16 v[108:111], v[8:11], a[108:111], v[108:111]
    s_waitcnt lgkmcnt(3)
    v_mfma_f32_16x16x32_bf16 v[112:115], v[12:15], a[96:99], v[112:115]
    ds_read_b128 v[28:31], v4 offset:17408
    v_mfma_f32_16x16x32_bf16 v[116:119], v[12:15], a[100:103], v[116:119]
    v_mfma_f32_16x16x32_bf16 v[120:123], v[12:15], a[104:107], v[120:123]
    v_mfma_f32_16x16x32_bf16 v[124:127], v[12:15], a[108:111], v[124:127]
    s_waitcnt lgkmcnt(3)
    v_mfma_f32_16x16x32_bf16 v[96:99], v[16:19], a[112:115], v[96:99]
    ds_read_b128 v[8:11], v4 offset:18432
    v_mfma_f32_16x16x32_bf16 v[100:103], v[16:19], a[116:119], v[100:103]
    v_mfma_f32_16x16x32_bf16 v[104:107], v[16:19], a[120:123], v[104:107]
    v_mfma_f32_16x16x32_bf16 v[108:111], v[16:19], a[124:127], v[108:111]
    s_waitcnt lgkmcnt(3)
    v_mfma_f32_16x16x32_bf16 v[112:115], v[20:23], a[112:115], v[112:115]
    ds_read_b128 v[12:15], v4 offset:19456
    v_mfma_f32_16x16x32_bf16 v[116:119], v[20:23], a[116:119], v[116:119]
    v_mfma_f32_16x16x32_bf16 v[120:123], v[20:23], a[120:123], v[120:123]
    v_mfma_f32_16x16x32_bf16 v[124:127], v[20:23], a[124:127], v[124:127]
    s_waitcnt lgkmcnt(3)
    v_mfma_f32_16x16x32_bf16 v[96:99], v[24:27], a[128:131], v[96:99]
    ds_read_b128 v[16:19], v4 offset:20480
    v_mfma_f32_16x16x32_bf16 v[100:103], v[24:27], a[132:135], v[100:103]
    v_mfma_f32_16x16x32_bf16 v[104:107], v[24:27], a[136:139], v[104:107]
    v_mfma_f32_16x16x32_bf16 v[108:111], v[24:27], a[140:143], v[108:111]
    s_waitcnt lgkmcnt(3)
    v_mfma_f32_16x16x32_bf16 v[112:115], v[28:31], a[128:131], v[112:115]
    ds_read_b128 v[20:23], v4 offset:21504
    v_mfma_f32_16x16x32_bf16 v[116:119], v[28:31], a[132:135], v[116:119]
    v_mfma_f32_16x16x32_bf16 v[120:123], v[28:31], a[136:139], v[120:123]
    v_mfma_f32_16x16x32_bf16 v[124:127], v[28:31], a[140:143], v[124:127]
    s_waitcnt lgkmcnt(3)
    v_mfma_f32_16x16x32_bf16 v[96:99], v[8:11], a[144:147], v[96:99]
    ds_read_b128 v[24:27], v4 offset:22528
    v_mfma_f32_16x16x32_bf16 v[100:103], v[8:11], a[148:151], v[100:103]
    v_mfma_f32_16x16x32_bf16 v[104:107], v[8:11], a[152:155], v[104:107]
    v_mfma_f32_16x16x32_bf16 v[108:111], v[8:11], a[156:159], v[108:111]
    s_waitcnt lgkmcnt(3)
    v_mfma_f32_16x16x32_bf16 v[112:115], v[12:15], a[144:147], v[112:115]
    ds_read_b128 v[28:31], v4 offset:23552
    v_mfma_f32_16x16x32_bf16 v[116:119], v[12:15], a[148:151], v[116:119]
    v_mfma_f32_16x16x32_bf16 v[120:123], v[12:15], a[152:155], v[120:123]
    v_mfma_f32_16x16x32_bf16 v[124:127], v[12:15], a[156:159], v[124:127]
    s_waitcnt lgkmcnt(3)
    v_mfma_f32_16x16x32_bf16 v[96:99], v[16:19], a[160:163], v[96:99]
    ds_read_b128 v[8:11], v4 offset:24576
    v_mfma_f32_16x16x32_bf16 v[100:103], v[16:19], a[164:167], v[100:103]
    v_mfma_f32_16x16x32_bf16 v[104:107], v[16:19], a[168:171], v[104:107]
    v_mfma_f32_16x16x32_bf16 v[108:111], v[16:19], a[172:175], v[108:111]
    s_waitcnt lgkmcnt(3)
    v_mfma_f32_16x16x32_bf16 v[112:115], v[20:23], a[160:163], v[112:115]
    ds_read_b128 v[12:15], v4 offset:25600
    v_mfma_f32_16x16x32_bf16 v[116:119], v[20:23], a[164:167], v[116:119]
    v_mfma_f32_16x16x32_bf16 v[120:123], v[20:23], a[168:171], v[120:123]
    v_mfma_f32_16x16x32_bf16 v[124:127], v[20:23], a[172:175], v[124:127]
    s_waitcnt lgkmcnt(3)
    v_mfma_f32_16x16x32_bf16 v[96:99], v[24:27], a[176:179], v[96:99]
    ds_read_b128 v[16:19], v4 offset:26624
    v_mfma_f32_16x16x32_bf16 v[100:103], v[24:27], a[180:183], v[100:103]
    v_mfma_f32_16x16x32_bf16 v[104:107], v[24:27], a[184:187], v[104:107]
    v_mfma_f32_16x16x32_bf16 v[108:111], v[24:27], a[188:191], v[108:111]
    s_waitcnt lgkmcnt(3)
    v_mfma_f32_16x16x32_bf16 v[112:115], v[28:31], a[176:179], v[112:115]
    ds_read_b128 v[20:23], v4 offset:27648
    v_mfma_f32_16x16x32_bf16 v[116:119], v[28:31], a[180:183], v[116:119]
    v_mfma_f32_16x16x32_bf16 v[120:123], v[28:31], a[184:187], v[120:123]
    v_mfma_f32_16x16x32_bf16 v[124:127], v[28:31], a[188:191], v[124:127]
    s_waitcnt lgkmcnt(3)
    v_mfma_f32_16x16x32_bf16 v[96:99], v[8:11], a[192:195], v[96:99]
    ds_read_b128 v[24:27], v4 offset:28672
    v_mfma_f32_16x16x32_bf16 v[100:103], v[8:11], a[196:199], v[100:103]
    v_mfma_f32_16x16x32_bf16 v[104:107], v[8:11], a[200:203], v[104:107]
    v_mfma_f32_16x16x32_bf16 v[108:111], v[8:11], a[204:207], v[108:111]
    s_waitcnt lgkmcnt(3)
    v_mfma_f32_16x16x32_bf16 v[112:115], v[12:15], a[192:195], v[112:115]
    ds_read_b128 v[28:31], v4 offset:29696
    v_mfma_f32_16x16x32_bf16 v[116:119], v[12:15], a[196:199], v[116:119]
    v_mfma_f32_16x16x32_bf16 v[120:123], v[12:15], a[200:203], v[120:123]
    v_mfma_f32_16x16x32_bf16 v[124:127], v[12:15], a[204:207], v[124:127]
    s_waitcnt lgkmcnt(3)
    v_mfma_f32_16x16x32_bf16 v[96:99], v[16:19], a[208:211], v[96:99]
    ds_read_b128 v[8:11], v4 offset:30720
    v_mfma_f32_16x16x32_bf16 v[100:103], v[16:19], a[212:215], v[100:103]
    v_mfma_f32_16x16x32_bf16 v[104:107], v[16:19], a[216:219], v[104:107]
    v_mfma_f32_16x16x32_bf16 v[108:111], v[16:19], a[220:223], v[108:111]
    s_waitcnt lgkmcnt(3)
    v_mfma_f32_16x16x32_bf16 v[112:115], v[20:23], a[208:211], v[112:115]
    ds_read_b128 v[12:15], v4 offset:31744
    v_mfma_f32_16x16x32_bf16 v[116:119], v[20:23], a[212:215], v[116:119]
    v_mfma_f32_16x16x32_bf16 v[120:123], v[20:23], a[216:219], v[120:123]
    v_mfma_f32_16x16x32_bf16 v[124:127], v[20:23], a[220:223], v[124:127]
    s_waitcnt lgkmcnt(3)
    v_mfma_f32_16x16x32_bf16 v[96:99], v[24:27], a[224:227], v[96:99]
    ds_read_b128 v[16:19], v4 offset:32768
    v_mfma_f32_16x16x32_bf16 v[100:103], v[24:27], a[228:231], v[100:103]
    v_mfma_f32_16x16x32_bf16 v[104:107], v[24:27], a[232:235], v[104:107]
    v_mfma_f32_16x16x32_bf16 v[108:111], v[24:27], a[236:239], v[108:111]
    s_waitcnt lgkmcnt(3)
    v_mfma_f32_16x16x32_bf16 v[112:115], v[28:31], a[224:227], v[112:115]
    ds_read_b128 v[20:23], v4 offset:33792
    v_mfma_f32_16x16x32_bf16 v[116:119], v[28:31], a[228:231], v[116:119]
    v_mfma_f32_16x16x32_bf16 v[120:123], v[28:31], a[232:235], v[120:123]
    v_mfma_f32_16x16x32_bf16 v[124:127], v[28:31], a[236:239], v[124:127]
    s_waitcnt lgkmcnt(3)
    v_mfma_f32_16x16x32_bf16 v[96:99], v[8:11], a[240:243], v[96:99]
    ds_read_b128 v[24:27], v4 offset:34816
    v_mfma_f32_16x16x32_bf16 v[100:103], v[8:11], a[244:247], v[100:103]
    v_mfma_f32_16x16x32_bf16 v[104:107], v[8:11], a[248:251], v[104:107]
    v_mfma_f32_16x16x32_bf16 v[108:111], v[8:11], a[252:255], v[108:111]
    ds_read_b128 v[136:139], v5 offset:512
    ds_read_b128 v[140:143], v5 offset:576
    s_waitcnt lgkmcnt(5)
    v_mfma_f32_16x16x32_bf16 v[112:115], v[12:15], a[240:243], v[112:115]
    ds_read_b128 v[28:31], v4 offset:35840
    v_mfma_f32_16x16x32_bf16 v[116:119], v[12:15], a[244:247], v[116:119]
    v_mfma_f32_16x16x32_bf16 v[120:123], v[12:15], a[248:251], v[120:123]
    v_mfma_f32_16x16x32_bf16 v[124:127], v[12:15], a[252:255], v[124:127]
    s_waitcnt lgkmcnt(5)
    v_mfma_f32_16x16x32_bf16 v[96:99], v[16:19], v[32:35], v[96:99]
    s_waitcnt vmcnt(17)
    s_barrier
    v_mfma_f32_16x16x32_bf16 v[100:103], v[16:19], v[36:39], v[100:103]
    v_add_u32 v4, 0x9000, v4
    ds_read_b128 v[8:11], v4 offset:0
    v_mfma_f32_16x16x32_bf16 v[104:107], v[16:19], v[40:43], v[104:107]
    s_add_u32 m0, s49, 110592
    s_add_u32 s61, s48, 258048
    v_mfma_f32_16x16x32_bf16 v[108:111], v[16:19], v[44:47], v[108:111]
    buffer_load_dwordx4 v2, s[4:7], s61 offen offset:0 lds
    buffer_load_dwordx4 v2, s[4:7], s61 offen offset:1024 lds
    s_waitcnt lgkmcnt(5)
    v_mfma_f32_16x16x32_bf16 v[112:115], v[20:23], v[32:35], v[112:115]
    ds_read_b128 v[12:15], v4 offset:1024
    buffer_load_dwordx4 v2, s[4:7], s61 offen offset:2048 lds
    v_mfma_f32_16x16x32_bf16 v[116:119], v[20:23], v[36:39], v[116:119]
    buffer_load_dwordx4 v2, s[4:7], s61 offen offset:3072 lds
    s_add_u32 m0, s49, 114688
    v_mfma_f32_16x16x32_bf16 v[120:123], v[20:23], v[40:43], v[120:123]
    s_add_u32 s61, s48, 262144
    buffer_load_dwordx4 v2, s[4:7], s61 offen offset:0 lds
    v_mfma_f32_16x16x32_bf16 v[124:127], v[20:23], v[44:47], v[124:127]
    buffer_load_dwordx4 v2, s[4:7], s61 offen offset:1024 lds
    buffer_load_dwordx4 v2, s[4:7], s61 offen offset:2048 lds
    s_waitcnt lgkmcnt(5)
    v_mfma_f32_16x16x32_bf16 v[96:99], v[24:27], v[48:51], v[96:99]
    ds_read_b128 v[16:19], v4 offset:2048
    buffer_load_dwordx4 v2, s[4:7], s61 offen offset:3072 lds
    v_mfma_f32_16x16x32_bf16 v[100:103], v[24:27], v[52:55], v[100:103]
    s_add_u32 m0, s49, 118784
    s_add_u32 s61, s48, 266240
    v_mfma_f32_16x16x32_bf16 v[104:107], v[24:27], v[56:59], v[104:107]
    buffer_load_dwordx4 v2, s[4:7], s61 offen offset:0 lds
    v_mfma_f32_16x16x32_bf16 v[108:111], v[24:27], v[60:63], v[108:111]
    s_waitcnt lgkmcnt(3)
    v_mfma_f32_16x16x32_bf16 v[112:115], v[28:31], v[48:51], v[112:115]
    ds_read_b128 v[20:23], v4 offset:3072
    v_mfma_f32_16x16x32_bf16 v[116:119], v[28:31], v[52:55], v[116:119]
    v_mfma_f32_16x16x32_bf16 v[120:123], v[28:31], v[56:59], v[120:123]
    v_mfma_f32_16x16x32_bf16 v[124:127], v[28:31], v[60:63], v[124:127]
    s_waitcnt lgkmcnt(3)
    v_mfma_f32_16x16x32_bf16 v[64:67], v[8:11], a[0:3], 0
    ds_read_b128 v[24:27], v4 offset:4096
    v_mfma_f32_16x16x32_bf16 v[68:71], v[8:11], a[4:7], 0
    v_mfma_f32_16x16x32_bf16 v[72:75], v[8:11], a[8:11], 0
    v_mfma_f32_16x16x32_bf16 v[76:79], v[8:11], a[12:15], 0
    s_waitcnt lgkmcnt(3)
    v_mfma_f32_16x16x32_bf16 v[80:83], v[12:15], a[0:3], 0
    ds_read_b128 v[28:31], v4 offset:5120
    v_mfma_f32_16x16x32_bf16 v[84:87], v[12:15], a[4:7], 0
    v_fmac_f32 v96, v136, v128
    v_fmac_f32 v97, v137, v128
    v_mfma_f32_16x16x32_bf16 v[88:91], v[12:15], a[8:11], 0
    v_fmac_f32 v98, v138, v128
    v_fmac_f32 v99, v139, v128
    v_mfma_f32_16x16x32_bf16 v[92:95], v[12:15], a[12:15], 0
    v_fmac_f32 v112, v140, v128
    v_fmac_f32 v113, v141, v128
    s_waitcnt lgkmcnt(3)
    v_mfma_f32_16x16x32_bf16 v[64:67], v[16:19], a[16:19], v[64:67]
    ds_read_b128 v[8:11], v4 offset:6144
    v_fmac_f32 v114, v142, v128
    v_mfma_f32_16x16x32_bf16 v[68:71], v[16:19], a[20:23], v[68:71]
    v_fmac_f32 v115, v143, v128
    v_mul_f32 v96, v96, v132
    v_mfma_f32_16x16x32_bf16 v[72:75], v[16:19], a[24:27], v[72:75]
    v_mul_f32 v97, v97, v132
    v_mul_f32 v98, v98, v132
    v_mfma_f32_16x16x32_bf16 v[76:79], v[16:19], a[28:31], v[76:79]
    v_mul_f32 v99, v99, v132
    v_mul_f32 v96, v96, v112
    s_waitcnt lgkmcnt(3)
    v_mfma_f32_16x16x32_bf16 v[80:83], v[20:23], a[16:19], v[80:83]
    ds_read_b128 v[12:15], v4 offset:7168
    v_mul_f32 v97, v97, v113
    v_mfma_f32_16x16x32_bf16 v[84:87], v[20:23], a[20:23], v[84:87]
    v_mul_f32 v98, v98, v114
    v_mul_f32 v99, v99, v115
    v_mfma_f32_16x16x32_bf16 v[88:91], v[20:23], a[24:27], v[88:91]
    v_cvt_pk_bf16_f32 v194, v96, v97
    v_cvt_pk_bf16_f32 v195, v98, v99
    v_mfma_f32_16x16x32_bf16 v[92:95], v[20:23], a[28:31], v[92:95]
    s_add_u32 s66, s51, 16384
    buffer_store_dwordx4 v[192:195], v2, s[4:7], s66 offen offset:0 sc1
    s_waitcnt lgkmcnt(3)
    v_mfma_f32_16x16x32_bf16 v[64:67], v[24:27], a[32:35], v[64:67]
    ds_read_b128 v[16:19], v4 offset:8192
    v_fmac_f32 v100, v136, v129
    v_mfma_f32_16x16x32_bf16 v[68:71], v[24:27], a[36:39], v[68:71]
    v_fmac_f32 v101, v137, v129
    v_fmac_f32 v102, v138, v129
    v_mfma_f32_16x16x32_bf16 v[72:75], v[24:27], a[40:43], v[72:75]
    v_fmac_f32 v103, v139, v129
    v_fmac_f32 v116, v140, v129
    v_mfma_f32_16x16x32_bf16 v[76:79], v[24:27], a[44:47], v[76:79]
    v_fmac_f32 v117, v141, v129
    v_fmac_f32 v118, v142, v129
    s_waitcnt lgkmcnt(3)
    v_mfma_f32_16x16x32_bf16 v[80:83], v[28:31], a[32:35], v[80:83]
    ds_read_b128 v[20:23], v4 offset:9216
    v_fmac_f32 v119, v143, v129
    v_mfma_f32_16x16x32_bf16 v[84:87], v[28:31], a[36:39], v[84:87]
    v_mul_f32 v100, v100, v133
    v_mul_f32 v101, v101, v133
    v_mfma_f32_16x16x32_bf16 v[88:91], v[28:31], a[40:43], v[88:91]
    v_mul_f32 v102, v102, v133
    v_mul_f32 v103, v103, v133
    v_mfma_f32_16x16x32_bf16 v[92:95], v[28:31], a[44:47], v[92:95]
    v_mul_f32 v100, v100, v116
    v_mul_f32 v101, v101, v117
    s_waitcnt lgkmcnt(3)
    v_mfma_f32_16x16x32_bf16 v[64:67], v[8:11], a[48:51], v[64:67]
    ds_read_b128 v[24:27], v4 offset:10240
    v_mul_f32 v102, v102, v118
    v_mfma_f32_16x16x32_bf16 v[68:71], v[8:11], a[52:55], v[68:71]
    v_mul_f32 v103, v103, v119
    v_cvt_pk_bf16_f32 v198, v100, v101
    v_mfma_f32_16x16x32_bf16 v[72:75], v[8:11], a[56:59], v[72:75]
    v_cvt_pk_bf16_f32 v199, v102, v103
    buffer_store_dwordx4 v[196:199], v2, s[4:7], s66 offen offset:1024 sc1
    v_mfma_f32_16x16x32_bf16 v[76:79], v[8:11], a[60:63], v[76:79]
    v_fmac_f32 v104, v136, v130
    v_fmac_f32 v105, v137, v130
    s_waitcnt lgkmcnt(3)
    v_mfma_f32_16x16x32_bf16 v[80:83], v[12:15], a[48:51], v[80:83]
    ds_read_b128 v[28:31], v4 offset:11264
    v_fmac_f32 v106, v138, v130
    v_mfma_f32_16x16x32_bf16 v[84:87], v[12:15], a[52:55], v[84:87]
    v_fmac_f32 v107, v139, v130
    v_fmac_f32 v120, v140, v130
    v_mfma_f32_16x16x32_bf16 v[88:91], v[12:15], a[56:59], v[88:91]
    v_fmac_f32 v121, v141, v130
    v_fmac_f32 v122, v142, v130
    v_mfma_f32_16x16x32_bf16 v[92:95], v[12:15], a[60:63], v[92:95]
    v_fmac_f32 v123, v143, v130
    v_mul_f32 v104, v104, v134
    s_waitcnt lgkmcnt(3)
    v_mfma_f32_16x16x32_bf16 v[64:67], v[16:19], a[64:67], v[64:67]
    ds_read_b128 v[8:11], v4 offset:12288
    v_mul_f32 v105, v105, v134
    v_mfma_f32_16x16x32_bf16 v[68:71], v[16:19], a[68:71], v[68:71]
    v_mul_f32 v106, v106, v134
    v_mul_f32 v107, v107, v134
    v_mfma_f32_16x16x32_bf16 v[72:75], v[16:19], a[72:75], v[72:75]
    v_mul_f32 v104, v104, v120
    v_mul_f32 v105, v105, v121
    v_mfma_f32_16x16x32_bf16 v[76:79], v[16:19], a[76:79], v[76:79]
    v_mul_f32 v106, v106, v122
    v_mul_f32 v107, v107, v123
    s_waitcnt lgkmcnt(3)
    v_mfma_f32_16x16x32_bf16 v[80:83], v[20:23], a[64:67], v[80:83]
    ds_read_b128 v[12:15], v4 offset:13312
    v_cvt_pk_bf16_f32 v202, v104, v105
    v_mfma_f32_16x16x32_bf16 v[84:87], v[20:23], a[68:71], v[84:87]
    v_cvt_pk_bf16_f32 v203, v106, v107
    buffer_store_dwordx4 v[200:203], v2, s[4:7], s66 offen offset:2048 sc1
    v_mfma_f32_16x16x32_bf16 v[88:91], v[20:23], a[72:75], v[88:91]
    v_fmac_f32 v108, v136, v131
    v_fmac_f32 v109, v137, v131
    v_mfma_f32_16x16x32_bf16 v[92:95], v[20:23], a[76:79], v[92:95]
    v_fmac_f32 v110, v138, v131
    v_fmac_f32 v111, v139, v131
    s_waitcnt lgkmcnt(3)
    v_mfma_f32_16x16x32_bf16 v[64:67], v[24:27], a[80:83], v[64:67]
    ds_read_b128 v[16:19], v4 offset:14336
    v_fmac_f32 v124, v140, v131
    v_mfma_f32_16x16x32_bf16 v[68:71], v[24:27], a[84:87], v[68:71]
    v_fmac_f32 v125, v141, v131
    v_fmac_f32 v126, v142, v131
    v_mfma_f32_16x16x32_bf16 v[72:75], v[24:27], a[88:91], v[72:75]
    v_fmac_f32 v127, v143, v131
    v_mul_f32 v108, v108, v135
    v_mfma_f32_16x16x32_bf16 v[76:79], v[24:27], a[92:95], v[76:79]
    v_mul_f32 v109, v109, v135
    v_mul_f32 v110, v110, v135
    s_waitcnt lgkmcnt(3)
    v_mfma_f32_16x16x32_bf16 v[80:83], v[28:31], a[80:83], v[80:83]
    ds_read_b128 v[20:23], v4 offset:15360
    v_mul_f32 v111, v111, v135
    v_mfma_f32_16x16x32_bf16 v[84:87], v[28:31], a[84:87], v[84:87]
    v_mul_f32 v108, v108, v124
    v_mul_f32 v109, v109, v125
    v_mfma_f32_16x16x32_bf16 v[88:91], v[28:31], a[88:91], v[88:91]
    v_mul_f32 v110, v110, v126
    v_mul_f32 v111, v111, v127
    v_mfma_f32_16x16x32_bf16 v[92:95], v[28:31], a[92:95], v[92:95]
    v_cvt_pk_bf16_f32 v206, v108, v109
    v_cvt_pk_bf16_f32 v207, v110, v111
    s_waitcnt lgkmcnt(3)
    v_mfma_f32_16x16x32_bf16 v[64:67], v[8:11], a[96:99], v[64:67]
    ds_read_b128 v[24:27], v4 offset:16384
    buffer_store_dwordx4 v[204:207], v2, s[4:7], s66 offen offset:3072 sc1
    v_mfma_f32_16x16x32_bf16 v[68:71], v[8:11], a[100:103], v[68:71]
    v_mfma_f32_16x16x32_bf16 v[72:75], v[8:11], a[104:107], v[72:75]
    v_mfma_f32_16x16x32_bf16 v[76:79], v[8:11], a[108:111], v[76:79]
    s_waitcnt lgkmcnt(3)
    v_mfma_f32_16x16x32_bf16 v[80:83], v[12:15], a[96:99], v[80:83]
    ds_read_b128 v[28:31], v4 offset:17408
    v_mfma_f32_16x16x32_bf16 v[84:87], v[12:15], a[100:103], v[84:87]
    v_mfma_f32_16x16x32_bf16 v[88:91], v[12:15], a[104:107], v[88:91]
    v_mfma_f32_16x16x32_bf16 v[92:95], v[12:15], a[108:111], v[92:95]
    s_waitcnt lgkmcnt(3)
    v_mfma_f32_16x16x32_bf16 v[64:67], v[16:19], a[112:115], v[64:67]
    ds_read_b128 v[8:11], v4 offset:18432
    v_mfma_f32_16x16x32_bf16 v[68:71], v[16:19], a[116:119], v[68:71]
    v_mfma_f32_16x16x32_bf16 v[72:75], v[16:19], a[120:123], v[72:75]
    v_mfma_f32_16x16x32_bf16 v[76:79], v[16:19], a[124:127], v[76:79]
    s_waitcnt lgkmcnt(3)
    v_mfma_f32_16x16x32_bf16 v[80:83], v[20:23], a[112:115], v[80:83]
    ds_read_b128 v[12:15], v4 offset:19456
    v_mfma_f32_16x16x32_bf16 v[84:87], v[20:23], a[116:119], v[84:87]
    v_mfma_f32_16x16x32_bf16 v[88:91], v[20:23], a[120:123], v[88:91]
    v_mfma_f32_16x16x32_bf16 v[92:95], v[20:23], a[124:127], v[92:95]
    s_waitcnt lgkmcnt(3)
    v_mfma_f32_16x16x32_bf16 v[64:67], v[24:27], a[128:131], v[64:67]
    ds_read_b128 v[16:19], v4 offset:20480
    v_mfma_f32_16x16x32_bf16 v[68:71], v[24:27], a[132:135], v[68:71]
    v_mfma_f32_16x16x32_bf16 v[72:75], v[24:27], a[136:139], v[72:75]
    v_mfma_f32_16x16x32_bf16 v[76:79], v[24:27], a[140:143], v[76:79]
    s_waitcnt lgkmcnt(3)
    v_mfma_f32_16x16x32_bf16 v[80:83], v[28:31], a[128:131], v[80:83]
    ds_read_b128 v[20:23], v4 offset:21504
    v_mfma_f32_16x16x32_bf16 v[84:87], v[28:31], a[132:135], v[84:87]
    v_mfma_f32_16x16x32_bf16 v[88:91], v[28:31], a[136:139], v[88:91]
    v_mfma_f32_16x16x32_bf16 v[92:95], v[28:31], a[140:143], v[92:95]
    s_waitcnt lgkmcnt(3)
    v_mfma_f32_16x16x32_bf16 v[64:67], v[8:11], a[144:147], v[64:67]
    ds_read_b128 v[24:27], v4 offset:22528
    v_mfma_f32_16x16x32_bf16 v[68:71], v[8:11], a[148:151], v[68:71]
    v_mfma_f32_16x16x32_bf16 v[72:75], v[8:11], a[152:155], v[72:75]
    v_mfma_f32_16x16x32_bf16 v[76:79], v[8:11], a[156:159], v[76:79]
    s_waitcnt lgkmcnt(3)
    v_mfma_f32_16x16x32_bf16 v[80:83], v[12:15], a[144:147], v[80:83]
    ds_read_b128 v[28:31], v4 offset:23552
    v_mfma_f32_16x16x32_bf16 v[84:87], v[12:15], a[148:151], v[84:87]
    v_mfma_f32_16x16x32_bf16 v[88:91], v[12:15], a[152:155], v[88:91]
    v_mfma_f32_16x16x32_bf16 v[92:95], v[12:15], a[156:159], v[92:95]
    s_waitcnt lgkmcnt(3)
    v_mfma_f32_16x16x32_bf16 v[64:67], v[16:19], a[160:163], v[64:67]
    ds_read_b128 v[8:11], v4 offset:24576
    v_mfma_f32_16x16x32_bf16 v[68:71], v[16:19], a[164:167], v[68:71]
    v_mfma_f32_16x16x32_bf16 v[72:75], v[16:19], a[168:171], v[72:75]
    v_mfma_f32_16x16x32_bf16 v[76:79], v[16:19], a[172:175], v[76:79]
    s_waitcnt lgkmcnt(3)
    v_mfma_f32_16x16x32_bf16 v[80:83], v[20:23], a[160:163], v[80:83]
    ds_read_b128 v[12:15], v4 offset:25600
    v_mfma_f32_16x16x32_bf16 v[84:87], v[20:23], a[164:167], v[84:87]
    v_mfma_f32_16x16x32_bf16 v[88:91], v[20:23], a[168:171], v[88:91]
    v_mfma_f32_16x16x32_bf16 v[92:95], v[20:23], a[172:175], v[92:95]
    s_waitcnt lgkmcnt(3)
    v_mfma_f32_16x16x32_bf16 v[64:67], v[24:27], a[176:179], v[64:67]
    ds_read_b128 v[16:19], v4 offset:26624
    v_mfma_f32_16x16x32_bf16 v[68:71], v[24:27], a[180:183], v[68:71]
    v_mfma_f32_16x16x32_bf16 v[72:75], v[24:27], a[184:187], v[72:75]
    v_mfma_f32_16x16x32_bf16 v[76:79], v[24:27], a[188:191], v[76:79]
    s_waitcnt lgkmcnt(3)
    v_mfma_f32_16x16x32_bf16 v[80:83], v[28:31], a[176:179], v[80:83]
    ds_read_b128 v[20:23], v4 offset:27648
    v_mfma_f32_16x16x32_bf16 v[84:87], v[28:31], a[180:183], v[84:87]
    v_mfma_f32_16x16x32_bf16 v[88:91], v[28:31], a[184:187], v[88:91]
    v_mfma_f32_16x16x32_bf16 v[92:95], v[28:31], a[188:191], v[92:95]
    s_waitcnt lgkmcnt(3)
    v_mfma_f32_16x16x32_bf16 v[64:67], v[8:11], a[192:195], v[64:67]
    ds_read_b128 v[24:27], v4 offset:28672
    v_mfma_f32_16x16x32_bf16 v[68:71], v[8:11], a[196:199], v[68:71]
    v_mfma_f32_16x16x32_bf16 v[72:75], v[8:11], a[200:203], v[72:75]
    v_mfma_f32_16x16x32_bf16 v[76:79], v[8:11], a[204:207], v[76:79]
    s_waitcnt lgkmcnt(3)
    v_mfma_f32_16x16x32_bf16 v[80:83], v[12:15], a[192:195], v[80:83]
    ds_read_b128 v[28:31], v4 offset:29696
    v_mfma_f32_16x16x32_bf16 v[84:87], v[12:15], a[196:199], v[84:87]
    v_mfma_f32_16x16x32_bf16 v[88:91], v[12:15], a[200:203], v[88:91]
    v_mfma_f32_16x16x32_bf16 v[92:95], v[12:15], a[204:207], v[92:95]
    s_waitcnt lgkmcnt(3)
    v_mfma_f32_16x16x32_bf16 v[64:67], v[16:19], a[208:211], v[64:67]
    ds_read_b128 v[8:11], v4 offset:30720
    v_mfma_f32_16x16x32_bf16 v[68:71], v[16:19], a[212:215], v[68:71]
    v_mfma_f32_16x16x32_bf16 v[72:75], v[16:19], a[216:219], v[72:75]
    v_mfma_f32_16x16x32_bf16 v[76:79], v[16:19], a[220:223], v[76:79]
    s_waitcnt lgkmcnt(3)
    v_mfma_f32_16x16x32_bf16 v[80:83], v[20:23], a[208:211], v[80:83]
    ds_read_b128 v[12:15], v4 offset:31744
    v_mfma_f32_16x16x32_bf16 v[84:87], v[20:23], a[212:215], v[84:87]
    v_mfma_f32_16x16x32_bf16 v[88:91], v[20:23], a[216:219], v[88:91]
    v_mfma_f32_16x16x32_bf16 v[92:95], v[20:23], a[220:223], v[92:95]
    s_waitcnt lgkmcnt(3)
    v_mfma_f32_16x16x32_bf16 v[64:67], v[24:27], a[224:227], v[64:67]
    ds_read_b128 v[16:19], v4 offset:32768
    v_mfma_f32_16x16x32_bf16 v[68:71], v[24:27], a[228:231], v[68:71]
    v_mfma_f32_16x16x32_bf16 v[72:75], v[24:27], a[232:235], v[72:75]
    v_mfma_f32_16x16x32_bf16 v[76:79], v[24:27], a[236:239], v[76:79]
    s_waitcnt lgkmcnt(3)
    v_mfma_f32_16x16x32_bf16 v[80:83], v[28:31], a[224:227], v[80:83]
    ds_read_b128 v[20:23], v4 offset:33792
    v_mfma_f32_16x16x32_bf16 v[84:87], v[28:31], a[228:231], v[84:87]
    v_mfma_f32_16x16x32_bf16 v[88:91], v[28:31], a[232:235], v[88:91]
    v_mfma_f32_16x16x32_bf16 v[92:95], v[28:31], a[236:239], v[92:95]
    s_waitcnt lgkmcnt(3)
    v_mfma_f32_16x16x32_bf16 v[64:67], v[8:11], a[240:243], v[64:67]
    ds_read_b128 v[24:27], v4 offset:34816
    v_mfma_f32_16x16x32_bf16 v[68:71], v[8:11], a[244:247], v[68:71]
    v_mfma_f32_16x16x32_bf16 v[72:75], v[8:11], a[248:251], v[72:75]
    v_mfma_f32_16x16x32_bf16 v[76:79], v[8:11], a[252:255], v[76:79]
    ds_read_b128 v[144:147], v5 offset:640
    ds_read_b128 v[148:151], v5 offset:704
    s_waitcnt lgkmcnt(5)
    v_mfma_f32_16x16x32_bf16 v[80:83], v[12:15], a[240:243], v[80:83]
    ds_read_b128 v[28:31], v4 offset:35840
    v_mfma_f32_16x16x32_bf16 v[84:87], v[12:15], a[244:247], v[84:87]
    v_mfma_f32_16x16x32_bf16 v[88:91], v[12:15], a[248:251], v[88:91]
    v_mfma_f32_16x16x32_bf16 v[92:95], v[12:15], a[252:255], v[92:95]
    s_waitcnt lgkmcnt(5)
    v_mfma_f32_16x16x32_bf16 v[64:67], v[16:19], v[32:35], v[64:67]
    s_waitcnt vmcnt(13)
    s_barrier
    v_mfma_f32_16x16x32_bf16 v[68:71], v[16:19], v[36:39], v[68:71]
    v_add_u32 v4, 0x9000, v4
    ds_read_b128 v[8:11], v4 offset:0
    v_mfma_f32_16x16x32_bf16 v[72:75], v[16:19], v[40:43], v[72:75]
    s_add_u32 m0, s49, 0
    s_add_u32 s61, s48, 294912
    v_mfma_f32_16x16x32_bf16 v[76:79], v[16:19], v[44:47], v[76:79]
    buffer_load_dwordx4 v2, s[4:7], s61 offen offset:0 lds
    buffer_load_dwordx4 v2, s[4:7], s61 offen offset:1024 lds
    s_waitcnt lgkmcnt(5)
    v_mfma_f32_16x16x32_bf16 v[80:83], v[20:23], v[32:35], v[80:83]
    ds_read_b128 v[12:15], v4 offset:1024
    buffer_load_dwordx4 v2, s[4:7], s61 offen offset:2048 lds
    v_mfma_f32_16x16x32_bf16 v[84:87], v[20:23], v[36:39], v[84:87]
    buffer_load_dwordx4 v2, s[4:7], s61 offen offset:3072 lds
    s_add_u32 m0, s49, 4096
    v_mfma_f32_16x16x32_bf16 v[88:91], v[20:23], v[40:43], v[88:91]
    s_add_u32 s61, s48, 299008
    buffer_load_dwordx4 v2, s[4:7], s61 offen offset:0 lds
    v_mfma_f32_16x16x32_bf16 v[92:95], v[20:23], v[44:47], v[92:95]
    buffer_load_dwordx4 v2, s[4:7], s61 offen offset:1024 lds
    buffer_load_dwordx4 v2, s[4:7], s61 offen offset:2048 lds
    s_waitcnt lgkmcnt(5)
    v_mfma_f32_16x16x32_bf16 v[64:67], v[24:27], v[48:51], v[64:67]
    ds_read_b128 v[16:19], v4 offset:2048
    buffer_load_dwordx4 v2, s[4:7], s61 offen offset:3072 lds
    v_mfma_f32_16x16x32_bf16 v[68:71], v[24:27], v[52:55], v[68:71]
    s_add_u32 m0, s49, 8192
    s_add_u32 s61, s48, 303104
    v_mfma_f32_16x16x32_bf16 v[72:75], v[24:27], v[56:59], v[72:75]
    buffer_load_dwordx4 v2, s[4:7], s61 offen offset:0 lds
    v_mfma_f32_16x16x32_bf16 v[76:79], v[24:27], v[60:63], v[76:79]
    s_waitcnt lgkmcnt(3)
    v_mfma_f32_16x16x32_bf16 v[80:83], v[28:31], v[48:51], v[80:83]
    ds_read_b128 v[20:23], v4 offset:3072
    v_mfma_f32_16x16x32_bf16 v[84:87], v[28:31], v[52:55], v[84:87]
    v_mfma_f32_16x16x32_bf16 v[88:91], v[28:31], v[56:59], v[88:91]
    v_mfma_f32_16x16x32_bf16 v[92:95], v[28:31], v[60:63], v[92:95]
    s_waitcnt lgkmcnt(3)
    v_mfma_f32_16x16x32_bf16 v[96:99], v[8:11], a[0:3], 0
    ds_read_b128 v[24:27], v4 offset:4096
    v_mfma_f32_16x16x32_bf16 v[100:103], v[8:11], a[4:7], 0
    v_mfma_f32_16x16x32_bf16 v[104:107], v[8:11], a[8:11], 0
    v_mfma_f32_16x16x32_bf16 v[108:111], v[8:11], a[12:15], 0
    s_waitcnt lgkmcnt(3)
    v_mfma_f32_16x16x32_bf16 v[112:115], v[12:15], a[0:3], 0
    ds_read_b128 v[28:31], v4 offset:5120
    v_mfma_f32_16x16x32_bf16 v[116:119], v[12:15], a[4:7], 0
    v_fmac_f32 v64, v144, v128
    v_fmac_f32 v65, v145, v128
    v_mfma_f32_16x16x32_bf16 v[120:123], v[12:15], a[8:11], 0
    v_fmac_f32 v66, v146, v128
    v_fmac_f32 v67, v147, v128
    v_mfma_f32_16x16x32_bf16 v[124:127], v[12:15], a[12:15], 0
    v_fmac_f32 v80, v148, v128
    v_fmac_f32 v81, v149, v128
    s_waitcnt lgkmcnt(3)
    v_mfma_f32_16x16x32_bf16 v[96:99], v[16:19], a[16:19], v[96:99]
    ds_read_b128 v[8:11], v4 offset:6144
    v_fmac_f32 v82, v150, v128
    v_mfma_f32_16x16x32_bf16 v[100:103], v[16:19], a[20:23], v[100:103]
    v_fmac_f32 v83, v151, v128
    v_mul_f32 v64, v64, v132
    v_mfma_f32_16x16x32_bf16 v[104:107], v[16:19], a[24:27], v[104:107]
    v_mul_f32 v65, v65, v132
    v_mul_f32 v66, v66, v132
    v_mfma_f32_16x16x32_bf16 v[108:111], v[16:19], a[28:31], v[108:111]
    v_mul_f32 v67, v67, v132
    v_mul_f32 v64, v64, v80
    s_waitcnt lgkmcnt(3)
    v_mfma_f32_16x16x32_bf16 v[112:115], v[20:23], a[16:19], v[112:115]
    ds_read_b128 v[12:15], v4 offset:7168
    v_mul_f32 v65, v65, v81
    v_mfma_f32_16x16x32_bf16 v[116:119], v[20:23], a[20:23], v[116:119]
    v_mul_f32 v66, v66, v82
    v_mul_f32 v67, v67, v83
    v_mfma_f32_16x16x32_bf16 v[120:123], v[20:23], a[24:27], v[120:123]
    v_cvt_pk_bf16_f32 v208, v64, v65
    v_cvt_pk_bf16_f32 v209, v66, v67
    v_mfma_f32_16x16x32_bf16 v[124:127], v[20:23], a[28:31], v[124:127]
    v_fmac_f32 v68, v144, v129
    v_fmac_f32 v69, v145, v129
    s_waitcnt lgkmcnt(3)
    v_mfma_f32_16x16x32_bf16 v[96:99], v[24:27], a[32:35], v[96:99]
    ds_read_b128 v[16:19], v4 offset:8192
    v_fmac_f32 v70, v146, v129
    v_mfma_f32_16x16x32_bf16 v[100:103], v[24:27], a[36:39], v[100:103]
    v_fmac_f32 v71, v147, v129
    v_fmac_f32 v84, v148, v129
    v_mfma_f32_16x16x32_bf16 v[104:107], v[24:27], a[40:43], v[104:107]
    v_fmac_f32 v85, v149, v129
    v_fmac_f32 v86, v150, v129
    v_mfma_f32_16x16x32_bf16 v[108:111], v[24:27], a[44:47], v[108:111]
    v_fmac_f32 v87, v151, v129
    v_mul_f32 v68, v68, v133
    s_waitcnt lgkmcnt(3)
    v_mfma_f32_16x16x32_bf16 v[112:115], v[28:31], a[32:35], v[112:115]
    ds_read_b128 v[20:23], v4 offset:9216
    v_mul_f32 v69, v69, v133
    v_mfma_f32_16x16x32_bf16 v[116:119], v[28:31], a[36:39], v[116:119]
    v_mul_f32 v70, v70, v133
    v_mul_f32 v71, v71, v133
    v_mfma_f32_16x16x32_bf16 v[120:123], v[28:31], a[40:43], v[120:123]
    v_mul_f32 v68, v68, v84
    v_mul_f32 v69, v69, v85
    v_mfma_f32_16x16x32_bf16 v[124:127], v[28:31], a[44:47], v[124:127]
    v_mul_f32 v70, v70, v86
    v_mul_f32 v71, v71, v87
    s_waitcnt lgkmcnt(3)
    v_mfma_f32_16x16x32_bf16 v[96:99], v[8:11], a[48:51], v[96:99]
    ds_read_b128 v[24:27], v4 offset:10240
    v_cvt_pk_bf16_f32 v212, v68, v69
    v_mfma_f32_16x16x32_bf16 v[100:103], v[8:11], a[52:55], v[100:103]
    v_cvt_pk_bf16_f32 v213, v70, v71
    v_fmac_f32 v72, v144, v130
    v_mfma_f32_16x16x32_bf16 v[104:107], v[8:11], a[56:59], v[104:107]
    v_fmac_f32 v73, v145, v130
    v_fmac_f32 v74, v146, v130
    v_mfma_f32_16x16x32_bf16 v[108:111], v[8:11], a[60:63], v[108:111]
    v_fmac_f32 v75, v147, v130
    v_fmac_f32 v88, v148, v130
    s_waitcnt lgkmcnt(3)
    v_mfma_f32_16x16x32_bf16 v[112:115], v[12:15], a[48:51], v[112:115]
    ds_read_b128 v[28:31], v4 offset:11264
    v_fmac_f32 v89, v149, v130
    v_mfma_f32_16x16x32_bf16 v[116:119], v[12:15], a[52:55], v[116:119]
    v_fmac_f32 v90, v150, v130
    v_fmac_f32 v91, v151, v130
    v_mfma_f32_16x16x32_bf16 v[120:123], v[12:15], a[56:59], v[120:123]
    v_mul_f32 v72, v72, v134
    v_mul_f32 v73, v73, v134
    v_mfma_f32_16x16x32_bf16 v[124:127], v[12:15], a[60:63], v[124:127]
    v_mul_f32 v74, v74, v134
    v_mul_f32 v75, v75, v134
    s_waitcnt lgkmcnt(3)
    v_mfma_f32_16x16x32_bf16 v[96:99], v[16:19], a[64:67], v[96:99]
    ds_read_b128 v[8:11], v4 offset:12288
    v_mul_f32 v72, v72, v88
    v_mfma_f32_16x16x32_bf16 v[100:103], v[16:19], a[68:71], v[100:103]
    v_mul_f32 v73, v73, v89
    v_mul_f32 v74, v74, v90
    v_mfma_f32_16x16x32_bf16 v[104:107], v[16:19], a[72:75], v[104:107]
    v_mul_f32 v75, v75, v91
    v_cvt_pk_bf16_f32 v216, v72, v73
    v_mfma_f32_16x16x32_bf16 v[108:111], v[16:19], a[76:79], v[108:111]
    v_cvt_pk_bf16_f32 v217, v74, v75
    v_fmac_f32 v76, v144, v131
    s_waitcnt lgkmcnt(3)
    v_mfma_f32_16x16x32_bf16 v[112:115], v[20:23], a[64:67], v[112:115]
    ds_read_b128 v[12:15], v4 offset:13312
    v_fmac_f32 v77, v145, v131
    v_mfma_f32_16x16x32_bf16 v[116:119], v[20:23], a[68:71], v[116:119]
    v_fmac_f32 v78, v146, v131
    v_fmac_f32 v79, v147, v131
    v_mfma_f32_16x16x32_bf16 v[120:123], v[20:23], a[72:75], v[120:123]
    v_fmac_f32 v92, v148, v131
    v_fmac_f32 v93, v149, v131
    v_mfma_f32_16x16x32_bf16 v[124:127], v[20:23], a[76:79], v[124:127]
    v_fmac_f32 v94, v150, v131
    v_fmac_f32 v95, v151, v131
    s_waitcnt lgkmcnt(3)
    v_mfma_f32_16x16x32_bf16 v[96:99], v[24:27], a[80:83], v[96:99]
    ds_read_b128 v[16:19], v4 offset:14336
    v_mul_f32 v76, v76, v135
    v_mfma_f32_16x16x32_bf16 v[100:103], v[24:27], a[84:87], v[100:103]
    v_mul_f32 v77, v77, v135
    v_mul_f32 v78, v78, v135
    v_mfma_f32_16x16x32_bf16 v[104:107], v[24:27], a[88:91], v[104:107]
    v_mul_f32 v79, v79, v135
    v_mul_f32 v76, v76, v92
    v_mfma_f32_16x16x32_bf16 v[108:111], v[24:27], a[92:95], v[108:111]
    v_mul_f32 v77, v77, v93
    v_mul_f32 v78, v78, v94
    s_waitcnt lgkmcnt(3)
    v_mfma_f32_16x16x32_bf16 v[112:115], v[28:31], a[80:83], v[112:115]
    ds_read_b128 v[20:23], v4 offset:15360
    v_mul_f32 v79, v79, v95
    v_mfma_f32_16x16x32_bf16 v[116:119], v[28:31], a[84:87], v[116:119]
    v_cvt_pk_bf16_f32 v220, v76, v77
    v_cvt_pk_bf16_f32 v221, v78, v79
    v_mfma_f32_16x16x32_bf16 v[120:123], v[28:31], a[88:91], v[120:123]
    v_mfma_f32_16x16x32_bf16 v[124:127], v[28:31], a[92:95], v[124:127]
    s_waitcnt lgkmcnt(3)
    v_mfma_f32_16x16x32_bf16 v[96:99], v[8:11], a[96:99], v[96:99]
    ds_read_b128 v[24:27], v4 offset:16384
    v_mfma_f32_16x16x32_bf16 v[100:103], v[8:11], a[100:103], v[100:103]
    v_mfma_f32_16x16x32_bf16 v[104:107], v[8:11], a[104:107], v[104:107]
    v_mfma_f32_16x16x32_bf16 v[108:111], v[8:11], a[108:111], v[108:111]
    s_waitcnt lgkmcnt(3)
    v_mfma_f32_16x16x32_bf16 v[112:115], v[12:15], a[96:99], v[112:115]
    ds_read_b128 v[28:31], v4 offset:17408
    v_mfma_f32_16x16x32_bf16 v[116:119], v[12:15], a[100:103], v[116:119]
    v_mfma_f32_16x16x32_bf16 v[120:123], v[12:15], a[104:107], v[120:123]
    v_mfma_f32_16x16x32_bf16 v[124:127], v[12:15], a[108:111], v[124:127]
    s_waitcnt lgkmcnt(3)
    v_mfma_f32_16x16x32_bf16 v[96:99], v[16:19], a[112:115], v[96:99]
    ds_read_b128 v[8:11], v4 offset:18432
    v_mfma_f32_16x16x32_bf16 v[100:103], v[16:19], a[116:119], v[100:103]
    v_mfma_f32_16x16x32_bf16 v[104:107], v[16:19], a[120:123], v[104:107]
    v_mfma_f32_16x16x32_bf16 v[108:111], v[16:19], a[124:127], v[108:111]
    s_waitcnt lgkmcnt(3)
    v_mfma_f32_16x16x32_bf16 v[112:115], v[20:23], a[112:115], v[112:115]
    ds_read_b128 v[12:15], v4 offset:19456
    v_mfma_f32_16x16x32_bf16 v[116:119], v[20:23], a[116:119], v[116:119]
    v_mfma_f32_16x16x32_bf16 v[120:123], v[20:23], a[120:123], v[120:123]
    v_mfma_f32_16x16x32_bf16 v[124:127], v[20:23], a[124:127], v[124:127]
    s_waitcnt lgkmcnt(3)
    v_mfma_f32_16x16x32_bf16 v[96:99], v[24:27], a[128:131], v[96:99]
    ds_read_b128 v[16:19], v4 offset:20480
    v_mfma_f32_16x16x32_bf16 v[100:103], v[24:27], a[132:135], v[100:103]
    v_mfma_f32_16x16x32_bf16 v[104:107], v[24:27], a[136:139], v[104:107]
    v_mfma_f32_16x16x32_bf16 v[108:111], v[24:27], a[140:143], v[108:111]
    s_waitcnt lgkmcnt(3)
    v_mfma_f32_16x16x32_bf16 v[112:115], v[28:31], a[128:131], v[112:115]
    ds_read_b128 v[20:23], v4 offset:21504
    v_mfma_f32_16x16x32_bf16 v[116:119], v[28:31], a[132:135], v[116:119]
    v_mfma_f32_16x16x32_bf16 v[120:123], v[28:31], a[136:139], v[120:123]
    v_mfma_f32_16x16x32_bf16 v[124:127], v[28:31], a[140:143], v[124:127]
    s_waitcnt lgkmcnt(3)
    v_mfma_f32_16x16x32_bf16 v[96:99], v[8:11], a[144:147], v[96:99]
    ds_read_b128 v[24:27], v4 offset:22528
    v_mfma_f32_16x16x32_bf16 v[100:103], v[8:11], a[148:151], v[100:103]
    v_mfma_f32_16x16x32_bf16 v[104:107], v[8:11], a[152:155], v[104:107]
    v_mfma_f32_16x16x32_bf16 v[108:111], v[8:11], a[156:159], v[108:111]
    s_waitcnt lgkmcnt(3)
    v_mfma_f32_16x16x32_bf16 v[112:115], v[12:15], a[144:147], v[112:115]
    ds_read_b128 v[28:31], v4 offset:23552
    v_mfma_f32_16x16x32_bf16 v[116:119], v[12:15], a[148:151], v[116:119]
    v_mfma_f32_16x16x32_bf16 v[120:123], v[12:15], a[152:155], v[120:123]
    v_mfma_f32_16x16x32_bf16 v[124:127], v[12:15], a[156:159], v[124:127]
    v_mov_b32 v6, 1
    v_mov_b32 v7, 0
    s_waitcnt lgkmcnt(3)
    v_mfma_f32_16x16x32_bf16 v[96:99], v[16:19], a[160:163], v[96:99]
    ds_read_b128 v[8:11], v4 offset:24576
    s_waitcnt vmcnt(9)
    v_mfma_f32_16x16x32_bf16 v[100:103], v[16:19], a[164:167], v[100:103]
    s_mov_b64 exec, 1
    buffer_store_dword v6, v7, s[4:7], s67 offen sc1
    s_mov_b64 exec, -1
    v_mfma_f32_16x16x32_bf16 v[104:107], v[16:19], a[168:171], v[104:107]
    v_mfma_f32_16x16x32_bf16 v[108:111], v[16:19], a[172:175], v[108:111]
    s_waitcnt lgkmcnt(3)
    v_mfma_f32_16x16x32_bf16 v[112:115], v[20:23], a[160:163], v[112:115]
    ds_read_b128 v[12:15], v4 offset:25600
    v_mfma_f32_16x16x32_bf16 v[116:119], v[20:23], a[164:167], v[116:119]
    v_mfma_f32_16x16x32_bf16 v[120:123], v[20:23], a[168:171], v[120:123]
    v_mfma_f32_16x16x32_bf16 v[124:127], v[20:23], a[172:175], v[124:127]
    s_waitcnt lgkmcnt(3)
    v_mfma_f32_16x16x32_bf16 v[96:99], v[24:27], a[176:179], v[96:99]
    ds_read_b128 v[16:19], v4 offset:26624
    v_mfma_f32_16x16x32_bf16 v[100:103], v[24:27], a[180:183], v[100:103]
    v_mfma_f32_16x16x32_bf16 v[104:107], v[24:27], a[184:187], v[104:107]
    v_mfma_f32_16x16x32_bf16 v[108:111], v[24:27], a[188:191], v[108:111]
    s_waitcnt lgkmcnt(3)
    v_mfma_f32_16x16x32_bf16 v[112:115], v[28:31], a[176:179], v[112:115]
    ds_read_b128 v[20:23], v4 offset:27648
    v_mfma_f32_16x16x32_bf16 v[116:119], v[28:31], a[180:183], v[116:119]
    v_mfma_f32_16x16x32_bf16 v[120:123], v[28:31], a[184:187], v[120:123]
    v_mfma_f32_16x16x32_bf16 v[124:127], v[28:31], a[188:191], v[124:127]
    s_waitcnt lgkmcnt(3)
    v_mfma_f32_16x16x32_bf16 v[96:99], v[8:11], a[192:195], v[96:99]
    ds_read_b128 v[24:27], v4 offset:28672
    v_mfma_f32_16x16x32_bf16 v[100:103], v[8:11], a[196:199], v[100:103]
    v_mfma_f32_16x16x32_bf16 v[104:107], v[8:11], a[200:203], v[104:107]
    v_mfma_f32_16x16x32_bf16 v[108:111], v[8:11], a[204:207], v[108:111]
    s_waitcnt lgkmcnt(3)
    v_mfma_f32_16x16x32_bf16 v[112:115], v[12:15], a[192:195], v[112:115]
    ds_read_b128 v[28:31], v4 offset:29696
    v_mfma_f32_16x16x32_bf16 v[116:119], v[12:15], a[196:199], v[116:119]
    v_mfma_f32_16x16x32_bf16 v[120:123], v[12:15], a[200:203], v[120:123]
    v_mfma_f32_16x16x32_bf16 v[124:127], v[12:15], a[204:207], v[124:127]
    s_waitcnt lgkmcnt(3)
    v_mfma_f32_16x16x32_bf16 v[96:99], v[16:19], a[208:211], v[96:99]
    ds_read_b128 v[8:11], v4 offset:30720
    v_mfma_f32_16x16x32_bf16 v[100:103], v[16:19], a[212:215], v[100:103]
    v_mfma_f32_16x16x32_bf16 v[104:107], v[16:19], a[216:219], v[104:107]
    v_mfma_f32_16x16x32_bf16 v[108:111], v[16:19], a[220:223], v[108:111]
    s_waitcnt lgkmcnt(3)
    v_mfma_f32_16x16x32_bf16 v[112:115], v[20:23], a[208:211], v[112:115]
    ds_read_b128 v[12:15], v4 offset:31744
    v_mfma_f32_16x16x32_bf16 v[116:119], v[20:23], a[212:215], v[116:119]
    v_mfma_f32_16x16x32_bf16 v[120:123], v[20:23], a[216:219], v[120:123]
    v_mfma_f32_16x16x32_bf16 v[124:127], v[20:23], a[220:223], v[124:127]
    s_waitcnt lgkmcnt(3)
    v_mfma_f32_16x16x32_bf16 v[96:99], v[24:27], a[224:227], v[96:99]
    ds_read_b128 v[16:19], v4 offset:32768
    v_mfma_f32_16x16x32_bf16 v[100:103], v[24:27], a[228:231], v[100:103]
    v_mfma_f32_16x16x32_bf16 v[104:107], v[24:27], a[232:235], v[104:107]
    v_mfma_f32_16x16x32_bf16 v[108:111], v[24:27], a[236:239], v[108:111]
    s_waitcnt lgkmcnt(3)
    v_mfma_f32_16x16x32_bf16 v[112:115], v[28:31], a[224:227], v[112:115]
    ds_read_b128 v[20:23], v4 offset:33792
    v_mfma_f32_16x16x32_bf16 v[116:119], v[28:31], a[228:231], v[116:119]
    v_mfma_f32_16x16x32_bf16 v[120:123], v[28:31], a[232:235], v[120:123]
    v_mfma_f32_16x16x32_bf16 v[124:127], v[28:31], a[236:239], v[124:127]
    s_waitcnt lgkmcnt(3)
    v_mfma_f32_16x16x32_bf16 v[96:99], v[8:11], a[240:243], v[96:99]
    ds_read_b128 v[24:27], v4 offset:34816
    v_mfma_f32_16x16x32_bf16 v[100:103], v[8:11], a[244:247], v[100:103]
    v_mfma_f32_16x16x32_bf16 v[104:107], v[8:11], a[248:251], v[104:107]
    v_mfma_f32_16x16x32_bf16 v[108:111], v[8:11], a[252:255], v[108:111]
    ds_read_b128 v[136:139], v5 offset:768
    ds_read_b128 v[140:143], v5 offset:832
    s_waitcnt lgkmcnt(5)
    v_mfma_f32_16x16x32_bf16 v[112:115], v[12:15], a[240:243], v[112:115]
    ds_read_b128 v[28:31], v4 offset:35840
    v_mfma_f32_16x16x32_bf16 v[116:119], v[12:15], a[244:247], v[116:119]
    v_mfma_f32_16x16x32_bf16 v[120:123], v[12:15], a[248:251], v[120:123]
    v_mfma_f32_16x16x32_bf16 v[124:127], v[12:15], a[252:255], v[124:127]
    s_waitcnt lgkmcnt(5)
    v_mfma_f32_16x16x32_bf16 v[96:99], v[16:19], v[32:35], v[96:99]
    s_barrier
    v_mfma_f32_16x16x32_bf16 v[100:103], v[16:19], v[36:39], v[100:103]
    v_add_u32 v4, 0x9000, v4
    ds_read_b128 v[8:11], v4 offset:0
    v_mfma_f32_16x16x32_bf16 v[104:107], v[16:19], v[40:43], v[104:107]
    s_add_u32 m0, s49, 36864
    s_add_u32 s61, s48, 331776
    v_mfma_f32_16x16x32_bf16 v[108:111], v[16:19], v[44:47], v[108:111]
    buffer_load_dwordx4 v2, s[4:7], s61 offen offset:0 lds
    buffer_load_dwordx4 v2, s[4:7], s61 offen offset:1024 lds
    s_waitcnt lgkmcnt(5)
    v_mfma_f32_16x16x32_bf16 v[112:115], v[20:23], v[32:35], v[112:115]
    ds_read_b128 v[12:15], v4 offset:1024
    buffer_load_dwordx4 v2, s[4:7], s61 offen offset:2048 lds
    v_mfma_f32_16x16x32_bf16 v[116:119], v[20:23], v[36:39], v[116:119]
    buffer_load_dwordx4 v2, s[4:7], s61 offen offset:3072 lds
    s_add_u32 m0, s49, 40960
    v_mfma_f32_16x16x32_bf16 v[120:123], v[20:23], v[40:43], v[120:123]
    s_add_u32 s61, s48, 335872
    buffer_load_dwordx4 v2, s[4:7], s61 offen offset:0 lds
    v_mfma_f32_16x16x32_bf16 v[124:127], v[20:23], v[44:47], v[124:127]
    buffer_load_dwordx4 v2, s[4:7], s61 offen offset:1024 lds
    buffer_load_dwordx4 v2, s[4:7], s61 offen offset:2048 lds
    s_waitcnt lgkmcnt(5)
    v_mfma_f32_16x16x32_bf16 v[96:99], v[24:27], v[48:51], v[96:99]
    ds_read_b128 v[16:19], v4 offset:2048
    buffer_load_dwordx4 v2, s[4:7], s61 offen offset:3072 lds
    v_mfma_f32_16x16x32_bf16 v[100:103], v[24:27], v[52:55], v[100:103]
    s_add_u32 m0, s49, 45056
    s_add_u32 s61, s48, 339968
    v_mfma_f32_16x16x32_bf16 v[104:107], v[24:27], v[56:59], v[104:107]
    buffer_load_dwordx4 v2, s[4:7], s61 offen offset:0 lds
    v_mfma_f32_16x16x32_bf16 v[108:111], v[24:27], v[60:63], v[108:111]
    s_waitcnt lgkmcnt(3)
    v_mfma_f32_16x16x32_bf16 v[112:115], v[28:31], v[48:51], v[112:115]
    ds_read_b128 v[20:23], v4 offset:3072
    v_mfma_f32_16x16x32_bf16 v[116:119], v[28:31], v[52:55], v[116:119]
    v_mfma_f32_16x16x32_bf16 v[120:123], v[28:31], v[56:59], v[120:123]
    v_mfma_f32_16x16x32_bf16 v[124:127], v[28:31], v[60:63], v[124:127]
    s_waitcnt lgkmcnt(3)
    v_mfma_f32_16x16x32_bf16 v[64:67], v[8:11], a[0:3], 0
    ds_read_b128 v[24:27], v4 offset:4096
    v_mfma_f32_16x16x32_bf16 v[68:71], v[8:11], a[4:7], 0
    v_mfma_f32_16x16x32_bf16 v[72:75], v[8:11], a[8:11], 0
    v_mfma_f32_16x16x32_bf16 v[76:79], v[8:11], a[12:15], 0
    s_waitcnt lgkmcnt(3)
    v_mfma_f32_16x16x32_bf16 v[80:83], v[12:15], a[0:3], 0
    ds_read_b128 v[28:31], v4 offset:5120
    v_mfma_f32_16x16x32_bf16 v[84:87], v[12:15], a[4:7], 0
    v_fmac_f32 v96, v136, v128
    v_fmac_f32 v97, v137, v128
    v_mfma_f32_16x16x32_bf16 v[88:91], v[12:15], a[8:11], 0
    v_fmac_f32 v98, v138, v128
    v_fmac_f32 v99, v139, v128
    v_mfma_f32_16x16x32_bf16 v[92:95], v[12:15], a[12:15], 0
    v_fmac_f32 v112, v140, v128
    v_fmac_f32 v113, v141, v128
    s_waitcnt lgkmcnt(3)
    v_mfma_f32_16x16x32_bf16 v[64:67], v[16:19], a[16:19], v[64:67]
    ds_read_b128 v[8:11], v4 offset:6144
    v_fmac_f32 v114, v142, v128
    v_mfma_f32_16x16x32_bf16 v[68:71], v[16:19], a[20:23], v[68:71]
    v_fmac_f32 v115, v143, v128
    v_mul_f32 v96, v96, v132
    v_mfma_f32_16x16x32_bf16 v[72:75], v[16:19], a[24:27], v[72:75]
    v_mul_f32 v97, v97, v132
    v_mul_f32 v98, v98, v132
    v_mfma_f32_16x16x32_bf16 v[76:79], v[16:19], a[28:31], v[76:79]
    v_mul_f32 v99, v99, v132
    v_mul_f32 v96, v96, v112
    s_waitcnt lgkmcnt(3)
    v_mfma_f32_16x16x32_bf16 v[80:83], v[20:23], a[16:19], v[80:83]
    ds_read_b128 v[12:15], v4 offset:7168
    v_mul_f32 v97, v97, v113
    v_mfma_f32_16x16x32_bf16 v[84:87], v[20:23], a[20:23], v[84:87]
    v_mul_f32 v98, v98, v114
    v_mul_f32 v99, v99, v115
    v_mfma_f32_16x16x32_bf16 v[88:91], v[20:23], a[24:27], v[88:91]
    v_cvt_pk_bf16_f32 v210, v96, v97
    v_cvt_pk_bf16_f32 v211, v98, v99
    v_mfma_f32_16x16x32_bf16 v[92:95], v[20:23], a[28:31], v[92:95]
    s_add_u32 s66, s51, 32768
    buffer_store_dwordx4 v[208:211], v2, s[4:7], s66 offen offset:0 sc1
    s_waitcnt lgkmcnt(3)
    v_mfma_f32_16x16x32_bf16 v[64:67], v[24:27], a[32:35], v[64:67]
    ds_read_b128 v[16:19], v4 offset:8192
    v_fmac_f32 v100, v136, v129
    v_mfma_f32_16x16x32_bf16 v[68:71], v[24:27], a[36:39], v[68:71]
    v_fmac_f32 v101, v137, v129
    v_fmac_f32 v102, v138, v129
    v_mfma_f32_16x16x32_bf16 v[72:75], v[24:27], a[40:43], v[72:75]
    v_fmac_f32 v103, v139, v129
    v_fmac_f32 v116, v140, v129
    v_mfma_f32_16x16x32_bf16 v[76:79], v[24:27], a[44:47], v[76:79]
    v_fmac_f32 v117, v141, v129
    v_fmac_f32 v118, v142, v129
    s_waitcnt lgkmcnt(3)
    v_mfma_f32_16x16x32_bf16 v[80:83], v[28:31], a[32:35], v[80:83]
    ds_read_b128 v[20:23], v4 offset:9216
    v_fmac_f32 v119, v143, v129
    v_mfma_f32_16x16x32_bf16 v[84:87], v[28:31], a[36:39], v[84:87]
    v_mul_f32 v100, v100, v133
    v_mul_f32 v101, v101, v133
    v_mfma_f32_16x16x32_bf16 v[88:91], v[28:31], a[40:43], v[88:91]
    v_mul_f32 v102, v102, v133
    v_mul_f32 v103, v103, v133
    v_mfma_f32_16x16x32_bf16 v[92:95], v[28:31], a[44:47], v[92:95]
    v_mul_f32 v100, v100, v116
    v_mul_f32 v101, v101, v117
    s_waitcnt lgkmcnt(3)
    v_mfma_f32_16x16x32_bf16 v[64:67], v[8:11], a[48:51], v[64:67]
    ds_read_b128 v[24:27], v4 offset:10240
    v_mul_f32 v102, v102, v118
    v_mfma_f32_16x16x32_bf16 v[68:71], v[8:11], a[52:55], v[68:71]
    v_mul_f32 v103, v103, v119
    v_cvt_pk_bf16_f32 v214, v100, v101
    v_mfma_f32_16x16x32_bf16 v[72:75], v[8:11], a[56:59], v[72:75]
    v_cvt_pk_bf16_f32 v215, v102, v103
    buffer_store_dwordx4 v[212:215], v2, s[4:7], s66 offen offset:1024 sc1
    v_mfma_f32_16x16x32_bf16 v[76:79], v[8:11], a[60:63], v[76:79]
    v_fmac_f32 v104, v136, v130
    v_fmac_f32 v105, v137, v130
    s_waitcnt lgkmcnt(3)
    v_mfma_f32_16x16x32_bf16 v[80:83], v[12:15], a[48:51], v[80:83]
    ds_read_b128 v[28:31], v4 offset:11264
    v_fmac_f32 v106, v138, v130
    v_mfma_f32_16x16x32_bf16 v[84:87], v[12:15], a[52:55], v[84:87]
    v_fmac_f32 v107, v139, v130
    v_fmac_f32 v120, v140, v130
    v_mfma_f32_16x16x32_bf16 v[88:91], v[12:15], a[56:59], v[88:91]
    v_fmac_f32 v121, v141, v130
    v_fmac_f32 v122, v142, v130
    v_mfma_f32_16x16x32_bf16 v[92:95], v[12:15], a[60:63], v[92:95]
    v_fmac_f32 v123, v143, v130
    v_mul_f32 v104, v104, v134
    s_waitcnt lgkmcnt(3)
    v_mfma_f32_16x16x32_bf16 v[64:67], v[16:19], a[64:67], v[64:67]
    ds_read_b128 v[8:11], v4 offset:12288
    v_mul_f32 v105, v105, v134
    v_mfma_f32_16x16x32_bf16 v[68:71], v[16:19], a[68:71], v[68:71]
    v_mul_f32 v106, v106, v134
    v_mul_f32 v107, v107, v134
    v_mfma_f32_16x16x32_bf16 v[72:75], v[16:19], a[72:75], v[72:75]
    v_mul_f32 v104, v104, v120
    v_mul_f32 v105, v105, v121
    v_mfma_f32_16x16x32_bf16 v[76:79], v[16:19], a[76:79], v[76:79]
    v_mul_f32 v106, v106, v122
    v_mul_f32 v107, v107, v123
    s_waitcnt lgkmcnt(3)
    v_mfma_f32_16x16x32_bf16 v[80:83], v[20:23], a[64:67], v[80:83]
    ds_read_b128 v[12:15], v4 offset:13312
    v_cvt_pk_bf16_f32 v218, v104, v105
    v_mfma_f32_16x16x32_bf16 v[84:87], v[20:23], a[68:71], v[84:87]
    v_cvt_pk_bf16_f32 v219, v106, v107
    buffer_store_dwordx4 v[216:219], v2, s[4:7], s66 offen offset:2048 sc1
    v_mfma_f32_16x16x32_bf16 v[88:91], v[20:23], a[72:75], v[88:91]
    v_fmac_f32 v108, v136, v131
    v_fmac_f32 v109, v137, v131
    v_mfma_f32_16x16x32_bf16 v[92:95], v[20:23], a[76:79], v[92:95]
    v_fmac_f32 v110, v138, v131
    v_fmac_f32 v111, v139, v131
    s_waitcnt lgkmcnt(3)
    v_mfma_f32_16x16x32_bf16 v[64:67], v[24:27], a[80:83], v[64:67]
    ds_read_b128 v[16:19], v4 offset:14336
    v_fmac_f32 v124, v140, v131
    v_mfma_f32_16x16x32_bf16 v[68:71], v[24:27], a[84:87], v[68:71]
    v_fmac_f32 v125, v141, v131
    v_fmac_f32 v126, v142, v131
    v_mfma_f32_16x16x32_bf16 v[72:75], v[24:27], a[88:91], v[72:75]
    v_fmac_f32 v127, v143, v131
    v_mul_f32 v108, v108, v135
    v_mfma_f32_16x16x32_bf16 v[76:79], v[24:27], a[92:95], v[76:79]
    v_mul_f32 v109, v109, v135
    v_mul_f32 v110, v110, v135
    s_waitcnt lgkmcnt(3)
    v_mfma_f32_16x16x32_bf16 v[80:83], v[28:31], a[80:83], v[80:83]
    ds_read_b128 v[20:23], v4 offset:15360
    v_mul_f32 v111, v111, v135
    v_mfma_f32_16x16x32_bf16 v[84:87], v[28:31], a[84:87], v[84:87]
    v_mul_f32 v108, v108, v124
    v_mul_f32 v109, v109, v125
    v_mfma_f32_16x16x32_bf16 v[88:91], v[28:31], a[88:91], v[88:91]
    v_mul_f32 v110, v110, v126
    v_mul_f32 v111, v111, v127
    v_mfma_f32_16x16x32_bf16 v[92:95], v[28:31], a[92:95], v[92:95]
    v_cvt_pk_bf16_f32 v222, v108, v109
    v_cvt_pk_bf16_f32 v223, v110, v111
    s_waitcnt lgkmcnt(3)
    v_mfma_f32_16x16x32_bf16 v[64:67], v[8:11], a[96:99], v[64:67]
    ds_read_b128 v[24:27], v4 offset:16384
    buffer_store_dwordx4 v[220:223], v2, s[4:7], s66 offen offset:3072 sc1
    v_mfma_f32_16x16x32_bf16 v[68:71], v[8:11], a[100:103], v[68:71]
    v_mfma_f32_16x16x32_bf16 v[72:75], v[8:11], a[104:107], v[72:75]
    v_mfma_f32_16x16x32_bf16 v[76:79], v[8:11], a[108:111], v[76:79]
    s_waitcnt lgkmcnt(3)
    v_mfma_f32_16x16x32_bf16 v[80:83], v[12:15], a[96:99], v[80:83]
    ds_read_b128 v[28:31], v4 offset:17408
    v_mfma_f32_16x16x32_bf16 v[84:87], v[12:15], a[100:103], v[84:87]
    v_mfma_f32_16x16x32_bf16 v[88:91], v[12:15], a[104:107], v[88:91]
    v_mfma_f32_16x16x32_bf16 v[92:95], v[12:15], a[108:111], v[92:95]
    s_waitcnt lgkmcnt(3)
    v_mfma_f32_16x16x32_bf16 v[64:67], v[16:19], a[112:115], v[64:67]
    ds_read_b128 v[8:11], v4 offset:18432
    v_mfma_f32_16x16x32_bf16 v[68:71], v[16:19], a[116:119], v[68:71]
    v_mfma_f32_16x16x32_bf16 v[72:75], v[16:19], a[120:123], v[72:75]
    v_mfma_f32_16x16x32_bf16 v[76:79], v[16:19], a[124:127], v[76:79]
    s_waitcnt lgkmcnt(3)
    v_mfma_f32_16x16x32_bf16 v[80:83], v[20:23], a[112:115], v[80:83]
    ds_read_b128 v[12:15], v4 offset:19456
    v_mfma_f32_16x16x32_bf16 v[84:87], v[20:23], a[116:119], v[84:87]
    v_mfma_f32_16x16x32_bf16 v[88:91], v[20:23], a[120:123], v[88:91]
    v_mfma_f32_16x16x32_bf16 v[92:95], v[20:23], a[124:127], v[92:95]
    s_waitcnt lgkmcnt(3)
    v_mfma_f32_16x16x32_bf16 v[64:67], v[24:27], a[128:131], v[64:67]
    ds_read_b128 v[16:19], v4 offset:20480
    v_mfma_f32_16x16x32_bf16 v[68:71], v[24:27], a[132:135], v[68:71]
    v_mfma_f32_16x16x32_bf16 v[72:75], v[24:27], a[136:139], v[72:75]
    v_mfma_f32_16x16x32_bf16 v[76:79], v[24:27], a[140:143], v[76:79]
    s_waitcnt lgkmcnt(3)
    v_mfma_f32_16x16x32_bf16 v[80:83], v[28:31], a[128:131], v[80:83]
    ds_read_b128 v[20:23], v4 offset:21504
    v_mfma_f32_16x16x32_bf16 v[84:87], v[28:31], a[132:135], v[84:87]
    v_mfma_f32_16x16x32_bf16 v[88:91], v[28:31], a[136:139], v[88:91]
    v_mfma_f32_16x16x32_bf16 v[92:95], v[28:31], a[140:143], v[92:95]
    s_waitcnt lgkmcnt(3)
    v_mfma_f32_16x16x32_bf16 v[64:67], v[8:11], a[144:147], v[64:67]
    ds_read_b128 v[24:27], v4 offset:22528
    v_mfma_f32_16x16x32_bf16 v[68:71], v[8:11], a[148:151], v[68:71]
    v_mfma_f32_16x16x32_bf16 v[72:75], v[8:11], a[152:155], v[72:75]
    v_mfma_f32_16x16x32_bf16 v[76:79], v[8:11], a[156:159], v[76:79]
    s_waitcnt lgkmcnt(3)
    v_mfma_f32_16x16x32_bf16 v[80:83], v[12:15], a[144:147], v[80:83]
    ds_read_b128 v[28:31], v4 offset:23552
    v_mfma_f32_16x16x32_bf16 v[84:87], v[12:15], a[148:151], v[84:87]
    v_mfma_f32_16x16x32_bf16 v[88:91], v[12:15], a[152:155], v[88:91]
    v_mfma_f32_16x16x32_bf16 v[92:95], v[12:15], a[156:159], v[92:95]
    s_waitcnt lgkmcnt(3)
    v_mfma_f32_16x16x32_bf16 v[64:67], v[16:19], a[160:163], v[64:67]
    ds_read_b128 v[8:11], v4 offset:24576
    v_mfma_f32_16x16x32_bf16 v[68:71], v[16:19], a[164:167], v[68:71]
    v_and_b32 v7, 3, v1
    v_mfma_f32_16x16x32_bf16 v[72:75], v[16:19], a[168:171], v[72:75]
    v_lshlrev_b32 v7, 2, v7
    v_mfma_f32_16x16x32_bf16 v[76:79], v[16:19], a[172:175], v[76:79]
    buffer_load_dword v6, v7, s[4:7], s52 offen sc1
    s_waitcnt lgkmcnt(3)
    v_mfma_f32_16x16x32_bf16 v[80:83], v[20:23], a[160:163], v[80:83]
    ds_read_b128 v[12:15], v4 offset:25600
    v_mfma_f32_16x16x32_bf16 v[84:87], v[20:23], a[164:167], v[84:87]
    v_mfma_f32_16x16x32_bf16 v[88:91], v[20:23], a[168:171], v[88:91]
    v_mfma_f32_16x16x32_bf16 v[92:95], v[20:23], a[172:175], v[92:95]
    s_waitcnt lgkmcnt(3)
    v_mfma_f32_16x16x32_bf16 v[64:67], v[24:27], a[176:179], v[64:67]
    ds_read_b128 v[16:19], v4 offset:26624
    v_mfma_f32_16x16x32_bf16 v[68:71], v[24:27], a[180:183], v[68:71]
    v_mfma_f32_16x16x32_bf16 v[72:75], v[24:27], a[184:187], v[72:75]
    v_mfma_f32_16x16x32_bf16 v[76:79], v[24:27], a[188:191], v[76:79]
    s_waitcnt lgkmcnt(3)
    v_mfma_f32_16x16x32_bf16 v[80:83], v[28:31], a[176:179], v[80:83]
    ds_read_b128 v[20:23], v4 offset:27648
    v_mfma_f32_16x16x32_bf16 v[84:87], v[28:31], a[180:183], v[84:87]
    v_mfma_f32_16x16x32_bf16 v[88:91], v[28:31], a[184:187], v[88:91]
    v_mfma_f32_16x16x32_bf16 v[92:95], v[28:31], a[188:191], v[92:95]
    s_waitcnt lgkmcnt(3)
    v_mfma_f32_16x16x32_bf16 v[64:67], v[8:11], a[192:195], v[64:67]
    ds_read_b128 v[24:27], v4 offset:28672
    v_mfma_f32_16x16x32_bf16 v[68:71], v[8:11], a[196:199], v[68:71]
    v_mfma_f32_16x16x32_bf16 v[72:75], v[8:11], a[200:203], v[72:75]
    v_mfma_f32_16x16x32_bf16 v[76:79], v[8:11], a[204:207], v[76:79]
    s_waitcnt lgkmcnt(3)
    v_mfma_f32_16x16x32_bf16 v[80:83], v[12:15], a[192:195], v[80:83]
    ds_read_b128 v[28:31], v4 offset:29696
    v_mfma_f32_16x16x32_bf16 v[84:87], v[12:15], a[196:199], v[84:87]
    v_mfma_f32_16x16x32_bf16 v[88:91], v[12:15], a[200:203], v[88:91]
    v_mfma_f32_16x16x32_bf16 v[92:95], v[12:15], a[204:207], v[92:95]
    s_waitcnt lgkmcnt(3)
    v_mfma_f32_16x16x32_bf16 v[64:67], v[16:19], a[208:211], v[64:67]
    ds_read_b128 v[8:11], v4 offset:30720
    v_mfma_f32_16x16x32_bf16 v[68:71], v[16:19], a[212:215], v[68:71]
    v_mfma_f32_16x16x32_bf16 v[72:75], v[16:19], a[216:219], v[72:75]
    v_mfma_f32_16x16x32_bf16 v[76:79], v[16:19], a[220:223], v[76:79]
    s_waitcnt lgkmcnt(3)
    v_mfma_f32_16x16x32_bf16 v[80:83], v[20:23], a[208:211], v[80:83]
    ds_read_b128 v[12:15], v4 offset:31744
    v_mfma_f32_16x16x32_bf16 v[84:87], v[20:23], a[212:215], v[84:87]
    v_mfma_f32_16x16x32_bf16 v[88:91], v[20:23], a[216:219], v[88:91]
    v_mfma_f32_16x16x32_bf16 v[92:95], v[20:23], a[220:223], v[92:95]
    s_waitcnt lgkmcnt(3)
    v_mfma_f32_16x16x32_bf16 v[64:67], v[24:27], a[224:227], v[64:67]
    ds_read_b128 v[16:19], v4 offset:32768
    v_mfma_f32_16x16x32_bf16 v[68:71], v[24:27], a[228:231], v[68:71]
    v_mfma_f32_16x16x32_bf16 v[72:75], v[24:27], a[232:235], v[72:75]
    v_mfma_f32_16x16x32_bf16 v[76:79], v[24:27], a[236:239], v[76:79]
    s_waitcnt lgkmcnt(3)
    v_mfma_f32_16x16x32_bf16 v[80:83], v[28:31], a[224:227], v[80:83]
    ds_read_b128 v[20:23], v4 offset:33792
    v_mfma_f32_16x16x32_bf16 v[84:87], v[28:31], a[228:231], v[84:87]
    v_mfma_f32_16x16x32_bf16 v[88:91], v[28:31], a[232:235], v[88:91]
    v_mfma_f32_16x16x32_bf16 v[92:95], v[28:31], a[236:239], v[92:95]
    s_waitcnt lgkmcnt(3)
    v_mfma_f32_16x16x32_bf16 v[64:67], v[8:11], a[240:243], v[64:67]
    ds_read_b128 v[24:27], v4 offset:34816
    v_mfma_f32_16x16x32_bf16 v[68:71], v[8:11], a[244:247], v[68:71]
    v_mfma_f32_16x16x32_bf16 v[72:75], v[8:11], a[248:251], v[72:75]
    v_mfma_f32_16x16x32_bf16 v[76:79], v[8:11], a[252:255], v[76:79]
    ds_read_b128 v[144:147], v5 offset:896
    ds_read_b128 v[148:151], v5 offset:960
    s_waitcnt lgkmcnt(5)
    v_mfma_f32_16x16x32_bf16 v[80:83], v[12:15], a[240:243], v[80:83]
    ds_read_b128 v[28:31], v4 offset:35840
    v_mfma_f32_16x16x32_bf16 v[84:87], v[12:15], a[244:247], v[84:87]
    v_mfma_f32_16x16x32_bf16 v[88:91], v[12:15], a[248:251], v[88:91]
    v_mfma_f32_16x16x32_bf16 v[92:95], v[12:15], a[252:255], v[92:95]
    s_waitcnt lgkmcnt(5)
    v_mfma_f32_16x16x32_bf16 v[64:67], v[16:19], v[32:35], v[64:67]
    s_waitcnt vmcnt(15)
    s_barrier
    v_mfma_f32_16x16x32_bf16 v[68:71], v[16:19], v[36:39], v[68:71]
    v_add_u32 v4, 0xfffe5000, v4
    ds_read_b128 v[8:11], v4 offset:0
    v_mfma_f32_16x16x32_bf16 v[72:75], v[16:19], v[40:43], v[72:75]
    s_add_u32 m0, s49, 73728
    s_add_u32 s61, s48, 368640
    v_mfma_f32_16x16x32_bf16 v[76:79], v[16:19], v[44:47], v[76:79]
    buffer_load_dwordx4 v2, s[4:7], s61 offen offset:0 lds
    buffer_load_dwordx4 v2, s[4:7], s61 offen offset:1024 lds
    s_waitcnt lgkmcnt(5)
    v_mfma_f32_16x16x32_bf16 v[80:83], v[20:23], v[32:35], v[80:83]
    ds_read_b128 v[12:15], v4 offset:1024
    buffer_load_dwordx4 v2, s[4:7], s61 offen offset:2048 lds
    v_mfma_f32_16x16x32_bf16 v[84:87], v[20:23], v[36:39], v[84:87]
    buffer_load_dwordx4 v2, s[4:7], s61 offen offset:3072 lds
    s_add_u32 m0, s49, 77824
    v_mfma_f32_16x16x32_bf16 v[88:91], v[20:23], v[40:43], v[88:91]
    s_add_u32 s61, s48, 372736
    buffer_load_dwordx4 v2, s[4:7], s61 offen offset:0 lds
    v_mfma_f32_16x16x32_bf16 v[92:95], v[20:23], v[44:47], v[92:95]
    buffer_load_dwordx4 v2, s[4:7], s61 offen offset:1024 lds
    buffer_load_dwordx4 v2, s[4:7], s61 offen offset:2048 lds
    s_waitcnt lgkmcnt(5)
    v_mfma_f32_16x16x32_bf16 v[64:67], v[24:27], v[48:51], v[64:67]
    ds_read_b128 v[16:19], v4 offset:2048
    buffer_load_dwordx4 v2, s[4:7], s61 offen offset:3072 lds
    v_mfma_f32_16x16x32_bf16 v[68:71], v[24:27], v[52:55], v[68:71]
    s_add_u32 m0, s49, 81920
    s_add_u32 s61, s48, 376832
    v_mfma_f32_16x16x32_bf16 v[72:75], v[24:27], v[56:59], v[72:75]
    buffer_load_dwordx4 v2, s[4:7], s61 offen offset:0 lds
    v_mfma_f32_16x16x32_bf16 v[76:79], v[24:27], v[60:63], v[76:79]
    s_waitcnt vmcnt(9)
    v_cmp_le_u32 vcc, 1, v6
    s_nop 0
    s_cmp_eq_u64 vcc, exec
    s_cbranch_scc0 L_pa_slow_24
L_pa_back_25:
    s_waitcnt lgkmcnt(3)
    v_mfma_f32_16x16x32_bf16 v[80:83], v[28:31], v[48:51], v[80:83]
    ds_read_b128 v[20:23], v4 offset:3072
    v_mfma_f32_16x16x32_bf16 v[84:87], v[28:31], v[52:55], v[84:87]
    v_mfma_f32_16x16x32_bf16 v[88:91], v[28:31], v[56:59], v[88:91]
    v_mfma_f32_16x16x32_bf16 v[92:95], v[28:31], v[60:63], v[92:95]
    s_add_u32 s60, s56, s65
    buffer_load_dwordx2 v[242:243], v3, s[4:7], s60 offen offset:0 sc1
    s_waitcnt lgkmcnt(3)
    v_mfma_f32_16x16x32_bf16 v[96:99], v[8:11], a[0:3], 0
    ds_read_b128 v[24:27], v4 offset:4096
    buffer_load_dwordx2 v[246:247], v3, s[4:7], s60 offen offset:512 sc1
    v_mfma_f32_16x16x32_bf16 v[100:103], v[8:11], a[4:7], 0
    buffer_load_dwordx2 v[250:251], v3, s[4:7], s60 offen offset:1024 sc1
    buffer_load_dwordx2 v[254:255], v3, s[4:7], s60 offen offset:1536 sc1
    v_mfma_f32_16x16x32_bf16 v[104:107], v[8:11], a[8:11], 0
    v_mfma_f32_16x16x32_bf16 v[108:111], v[8:11], a[12:15], 0
    s_waitcnt lgkmcnt(3)
    v_mfma_f32_16x16x32_bf16 v[112:115], v[12:15], a[0:3], 0
    ds_read_b128 v[28:31], v4 offset:5120
    v_mfma_f32_16x16x32_bf16 v[116:119], v[12:15], a[4:7], 0
    v_fmac_f32 v64, v144, v128
    v_fmac_f32 v65, v145, v128
    v_mfma_f32_16x16x32_bf16 v[120:123], v[12:15], a[8:11], 0
    v_fmac_f32 v66, v146, v128
    v_fmac_f32 v67, v147, v128
    v_mfma_f32_16x16x32_bf16 v[124:127], v[12:15], a[12:15], 0
    s_add_u32 s60, s57, s65
    buffer_load_dwordx2 a[0:1], v3, s[4:7], s60 offen offset:0 sc1
    s_waitcnt lgkmcnt(3)
    v_mfma_f32_16x16x32_bf16 v[96:99], v[16:19], a[16:19], v[96:99]
    ds_read_b128 v[8:11], v4 offset:6144
    buffer_load_dwordx2 a[4:5], v3, s[4:7], s60 offen offset:512 sc1
    v_mfma_f32_16x16x32_bf16 v[100:103], v[16:19], a[20:23], v[100:103]
    buffer_load_dwordx2 a[8:9], v3, s[4:7], s60 offen offset:1024 sc1
    buffer_load_dwordx2 a[12:13], v3, s[4:7], s60 offen offset:1536 sc1
    v_mfma_f32_16x16x32_bf16 v[104:107], v[16:19], a[24:27], v[104:107]
    s_add_u32 s60, s58, s65
    buffer_load_dwordx2 a[2:3], v3, s[4:7], s60 offen offset:0 sc1
    v_mfma_f32_16x16x32_bf16 v[108:111], v[16:19], a[28:31], v[108:111]
    buffer_load_dwordx2 a[6:7], v3, s[4:7], s60 offen offset:512 sc1
    buffer_load_dwordx2 a[10:11], v3, s[4:7], s60 offen offset:1024 sc1
    s_waitcnt lgkmcnt(3)
    v_mfma_f32_16x16x32_bf16 v[112:115], v[20:23], a[16:19], v[112:115]
    ds_read_b128 v[12:15], v4 offset:7168
    buffer_load_dwordx2 a[14:15], v3, s[4:7], s60 offen offset:1536 sc1
    v_mfma_f32_16x16x32_bf16 v[116:119], v[20:23], a[20:23], v[116:119]
    v_fmac_f32 v80, v148, v128
    v_fmac_f32 v81, v149, v128
    v_mfma_f32_16x16x32_bf16 v[120:123], v[20:23], a[24:27], v[120:123]
    v_fmac_f32 v82, v150, v128
    v_fmac_f32 v83, v151, v128
    v_mfma_f32_16x16x32_bf16 v[124:127], v[20:23], a[28:31], v[124:127]
    s_add_u32 s60, s56, 0
    buffer_load_dwordx4 a[16:19], v2, s[4:7], s60 offen offset:0 sc1
    s_waitcnt lgkmcnt(3)
    v_mfma_f32_16x16x32_bf16 v[96:99], v[24:27], a[32:35], v[96:99]
    ds_read_b128 v[16:19], v4 offset:8192
    buffer_load_dwordx4 a[20:23], v2, s[4:7], s60 offen offset:1024 sc1
    v_mfma_f32_16x16x32_bf16 v[100:103], v[24:27], a[36:39], v[100:103]
    buffer_load_dwordx4 a[24:27], v2, s[4:7], s60 offen offset:2048 sc1
    buffer_load_dwordx4 a[28:31], v2, s[4:7], s60 offen offset:3072 sc1
    v_mfma_f32_16x16x32_bf16 v[104:107], v[24:27], a[40:43], v[104:107]
    v_mul_f32 v64, v64, v132
    v_mul_f32 v65, v65, v132
    v_mfma_f32_16x16x32_bf16 v[108:111], v[24:27], a[44:47], v[108:111]
    v_mul_f32 v66, v66, v132
    v_mul_f32 v67, v67, v132
    s_waitcnt lgkmcnt(3)
    v_mfma_f32_16x16x32_bf16 v[112:115], v[28:31], a[32:35], v[112:115]
    ds_read_b128 v[20:23], v4 offset:9216
    v_mul_f32 v64, v64, v80
    v_mfma_f32_16x16x32_bf16 v[116:119], v[28:31], a[36:39], v[116:119]
    v_mul_f32 v65, v65, v81
    v_mul_f32 v66, v66, v82
    v_mfma_f32_16x16x32_bf16 v[120:123], v[28:31], a[40:43], v[120:123]
    v_mul_f32 v67, v67, v83
    v_cvt_pk_bf16_f32 v224, v64, v65
    v_mfma_f32_16x16x32_bf16 v[124:127], v[28:31], a[44:47], v[124:127]
    v_cvt_pk_bf16_f32 v225, v66, v67
    v_fmac_f32 v68, v144, v129
    s_waitcnt lgkmcnt(3)
    v_mfma_f32_16x16x32_bf16 v[96:99], v[8:11], a[48:51], v[96:99]
    ds_read_b128 v[24:27], v4 offset:10240
    v_fmac_f32 v69, v145, v129
    v_mfma_f32_16x16x32_bf16 v[100:103], v[8:11], a[52:55], v[100:103]
    v_fmac_f32 v70, v146, v129
    v_fmac_f32 v71, v147, v129
    v_mfma_f32_16x16x32_bf16 v[104:107], v[8:11], a[56:59], v[104:107]
    v_fmac_f32 v84, v148, v129
    v_fmac_f32 v85, v149, v129
    v_mfma_f32_16x16x32_bf16 v[108:111], v[8:11], a[60:63], v[108:111]
    v_fmac_f32 v86, v150, v129
    v_fmac_f32 v87, v151, v129
    s_waitcnt lgkmcnt(3)
    v_mfma_f32_16x16x32_bf16 v[112:115], v[12:15], a[48:51], v[112:115]
    ds_read_b128 v[28:31], v4 offset:11264
    v_mul_f32 v68, v68, v133
    v_mfma_f32_16x16x32_bf16 v[116:119], v[12:15], a[52:55], v[116:119]
    v_mul_f32 v69, v69, v133
    v_mul_f32 v70, v70, v133
    v_mfma_f32_16x16x32_bf16 v[120:123], v[12:15], a[56:59], v[120:123]
    v_mul_f32 v71, v71, v133
    v_mul_f32 v68, v68, v84
    v_mfma_f32_16x16x32_bf16 v[124:127], v[12:15], a[60:63], v[124:127]
    s_add_u32 s60, s57, 0
    buffer_load_dwordx4 a[32:35], v2, s[4:7], s60 offen offset:0 sc1
    s_waitcnt lgkmcnt(3)
    v_mfma_f32_16x16x32_bf16 v[96:99], v[16:19], a[64:67], v[96:99]
    ds_read_b128 v[8:11], v4 offset:12288
    buffer_load_dwordx4 a[36:39], v2, s[4:7], s60 offen offset:1024 sc1
    v_mfma_f32_16x16x32_bf16 v[100:103], v[16:19], a[68:71], v[100:103]
    buffer_load_dwordx4 a[40:43], v2, s[4:7], s60 offen offset:2048 sc1
    buffer_load_dwordx4 a[44:47], v2, s[4:7], s60 offen offset:3072 sc1
    v_mfma_f32_16x16x32_bf16 v[104:107], v[16:19], a[72:75], v[104:107]
    v_mul_f32 v69, v69, v85
    v_mul_f32 v70, v70, v86
    v_mfma_f32_16x16x32_bf16 v[108:111], v[16:19], a[76:79], v[108:111]
    v_mul_f32 v71, v71, v87
    v_cvt_pk_bf16_f32 v228, v68, v69
    s_waitcnt lgkmcnt(3)
    v_mfma_f32_16x16x32_bf16 v[112:115], v[20:23], a[64:67], v[112:115]
    ds_read_b128 v[12:15], v4 offset:13312
    v_cvt_pk_bf16_f32 v229, v70, v71
    v_mfma_f32_16x16x32_bf16 v[116:119], v[20:23], a[68:71], v[116:119]
    v_fmac_f32 v72, v144, v130
    v_fmac_f32 v73, v145, v130
    v_mfma_f32_16x16x32_bf16 v[120:123], v[20:23], a[72:75], v[120:123]
    v_fmac_f32 v74, v146, v130
    v_fmac_f32 v75, v147, v130
    v_mfma_f32_16x16x32_bf16 v[124:127], v[20:23], a[76:79], v[124:127]
    v_fmac_f32 v88, v148, v130
    v_fmac_f32 v89, v149, v130
    s_waitcnt lgkmcnt(3)
    v_mfma_f32_16x16x32_bf16 v[96:99], v[24:27], a[80:83], v[96:99]
    ds_read_b128 v[16:19], v4 offset:14336
    v_fmac_f32 v90, v150, v130
    v_mfma_f32_16x16x32_bf16 v[100:103], v[24:27], a[84:87], v[100:103]
    v_fmac_f32 v91, v151, v130
    v_mul_f32 v72, v72, v134
    v_mfma_f32_16x16x32_bf16 v[104:107], v[24:27], a[88:91], v[104:107]
    v_mul_f32 v73, v73, v134
    v_mul_f32 v74, v74, v134
    v_mfma_f32_16x16x32_bf16 v[108:111], v[24:27], a[92:95], v[108:111]
    v_mul_f32 v75, v75, v134
    v_mul_f32 v72, v72, v88
    s_waitcnt lgkmcnt(3)
    v_mfma_f32_16x16x32_bf16 v[112:115], v[28:31], a[80:83], v[112:115]
    ds_read_b128 v[20:23], v4 offset:15360
    v_mul_f32 v73, v73, v89
    v_mfma_f32_16x16x32_bf16 v[116:119], v[28:31], a[84:87], v[116:119]
    v_mul_f32 v74, v74, v90
    v_mul_f32 v75, v75, v91
    v_mfma_f32_16x16x32_bf16 v[120:123], v[28:31], a[88:91], v[120:123]
    v_cvt_pk_bf16_f32 v232, v72, v73
    v_cvt_pk_bf16_f32 v233, v74, v75
    v_mfma_f32_16x16x32_bf16 v[124:127], v[28:31], a[92:95], v[124:127]
    s_add_u32 s60, s58, 0
    buffer_load_dwordx4 a[48:51], v2, s[4:7], s60 offen offset:0 sc1
    s_waitcnt lgkmcnt(3)
    v_mfma_f32_16x16x32_bf16 v[96:99], v[8:11], a[96:99], v[96:99]
    ds_read_b128 v[24:27], v4 offset:16384
    buffer_load_dwordx4 a[52:55], v2, s[4:7], s60 offen offset:1024 sc1
    v_mfma_f32_16x16x32_bf16 v[100:103], v[8:11], a[100:103], v[100:103]
    buffer_load_dwordx4 a[56:59], v2, s[4:7], s60 offen offset:2048 sc1
    buffer_load_dwordx4 a[60:63], v2, s[4:7], s60 offen offset:3072 sc1
    v_mfma_f32_16x16x32_bf16 v[104:107], v[8:11], a[104:107], v[104:107]
    v_fmac_f32 v76, v144, v131
    v_fmac_f32 v77, v145, v131
    v_mfma_f32_16x16x32_bf16 v[108:111], v[8:11], a[108:111], v[108:111]
    v_fmac_f32 v78, v146, v131
    v_fmac_f32 v79, v147, v131
    s_waitcnt lgkmcnt(3)
    v_mfma_f32_16x16x32_bf16 v[112:115], v[12:15], a[96:99], v[112:115]
    ds_read_b128 v[28:31], v4 offset:17408
    v_fmac_f32 v92, v148, v131
    v_mfma_f32_16x16x32_bf16 v[116:119], v[12:15], a[100:103], v[116:119]
    v_fmac_f32 v93, v149, v131
    v_fmac_f32 v94, v150, v131
    v_mfma_f32_16x16x32_bf16 v[120:123], v[12:15], a[104:107], v[120:123]
    v_fmac_f32 v95, v151, v131
    v_mul_f32 v76, v76, v135
    v_mfma_f32_16x16x32_bf16 v[124:127], v[12:15], a[108:111], v[124:127]
    v_mul_f32 v77, v77, v135
    v_mul_f32 v78, v78, v135
    s_waitcnt lgkmcnt(3)
    v_mfma_f32_16x16x32_bf16 v[96:99], v[16:19], a[112:115], v[96:99]
    ds_read_b128 v[8:11], v4 offset:18432
    v_mul_f32 v79, v79, v135
    v_mfma_f32_16x16x32_bf16 v[100:103], v[16:19], a[116:119], v[100:103]
    v_mul_f32 v76, v76, v92
    v_mul_f32 v77, v77, v93
    v_mfma_f32_16x16x32_bf16 v[104:107], v[16:19], a[120:123], v[104:107]
    v_mul_f32 v78, v78, v94
    v_mul_f32 v79, v79, v95
    v_mfma_f32_16x16x32_bf16 v[108:111], v[16:19], a[124:127], v[108:111]
    v_cvt_pk_bf16_f32 v236, v76, v77
    v_cvt_pk_bf16_f32 v237, v78, v79
    s_waitcnt lgkmcnt(3)
    v_mfma_f32_16x16x32_bf16 v[112:115], v[20:23], a[112:115], v[112:115]
    ds_read_b128 v[12:15], v4 offset:19456
    v_mfma_f32_16x16x32_bf16 v[116:119], v[20:23], a[116:119], v[116:119]
    v_mfma_f32_16x16x32_bf16 v[120:123], v[20:23], a[120:123], v[120:123]
    v_mfma_f32_16x16x32_bf16 v[124:127], v[20:23], a[124:127], v[124:127]
    s_add_u32 s60, s56, 16384
    buffer_load_dwordx4 a[64:67], v2, s[4:7], s60 offen offset:0 sc1
    s_waitcnt lgkmcnt(3)
    v_mfma_f32_16x16x32_bf16 v[96:99], v[24:27], a[128:131], v[96:99]
    ds_read_b128 v[16:19], v4 offset:20480
    buffer_load_dwordx4 a[68:71], v2, s[4:7], s60 offen offset:1024 sc1
    v_mfma_f32_16x16x32_bf16 v[100:103], v[24:27], a[132:135], v[100:103]
    buffer_load_dwordx4 a[72:75], v2, s[4:7], s60 offen offset:2048 sc1
    buffer_load_dwordx4 a[76:79], v2, s[4:7], s60 offen offset:3072 sc1
    v_mfma_f32_16x16x32_bf16 v[104:107], v[24:27], a[136:139], v[104:107]
    v_mfma_f32_16x16x32_bf16 v[108:111], v[24:27], a[140:143], v[108:111]
    s_waitcnt lgkmcnt(3)
    v_mfma_f32_16x16x32_bf16 v[112:115], v[28:31], a[128:131], v[112:115]
    ds_read_b128 v[20:23], v4 offset:21504
    v_mfma_f32_16x16x32_bf16 v[116:119], v[28:31], a[132:135], v[116:119]
    v_mfma_f32_16x16x32_bf16 v[120:123], v[28:31], a[136:139], v[120:123]
    v_mfma_f32_16x16x32_bf16 v[124:127], v[28:31], a[140:143], v[124:127]
    s_waitcnt lgkmcnt(3)
    v_mfma_f32_16x16x32_bf16 v[96:99], v[8:11], a[144:147], v[96:99]
    ds_read_b128 v[24:27], v4 offset:22528
    v_mfma_f32_16x16x32_bf16 v[100:103], v[8:11], a[148:151], v[100:103]
    v_mfma_f32_16x16x32_bf16 v[104:107], v[8:11], a[152:155], v[104:107]
    v_mfma_f32_16x16x32_bf16 v[108:111], v[8:11], a[156:159], v[108:111]
    s_waitcnt lgkmcnt(3)
    v_mfma_f32_16x16x32_bf16 v[112:115], v[12:15], a[144:147], v[112:115]
    ds_read_b128 v[28:31], v4 offset:23552
    v_mfma_f32_16x16x32_bf16 v[116:119], v[12:15], a[148:151], v[116:119]
    v_mfma_f32_16x16x32_bf16 v[120:123], v[12:15], a[152:155], v[120:123]
    v_mfma_f32_16x16x32_bf16 v[124:127], v[12:15], a[156:159], v[124:127]
    s_add_u32 s60, s57, 16384
    buffer_load_dwordx4 a[80:83], v2, s[4:7], s60 offen offset:0 sc1
    s_waitcnt lgkmcnt(3)
    v_mfma_f32_16x16x32_bf16 v[96:99], v[16:19], a[160:163], v[96:99]
    ds_read_b128 v[8:11], v4 offset:24576
    buffer_load_dwordx4 a[84:87], v2, s[4:7], s60 offen offset:1024 sc1
    v_mfma_f32_16x16x32_bf16 v[100:103], v[16:19], a[164:167], v[100:103]
    buffer_load_dwordx4 a[88:91], v2, s[4:7], s60 offen offset:2048 sc1
    buffer_load_dwordx4 a[92:95], v2, s[4:7], s60 offen offset:3072 sc1
    v_mfma_f32_16x16x32_bf16 v[104:107], v[16:19], a[168:171], v[104:107]
    v_mfma_f32_16x16x32_bf16 v[108:111], v[16:19], a[172:175], v[108:111]
    s_waitcnt lgkmcnt(3)
    v_mfma_f32_16x16x32_bf16 v[112:115], v[20:23], a[160:163], v[112:115]
    ds_read_b128 v[12:15], v4 offset:25600
    v_mfma_f32_16x16x32_bf16 v[116:119], v[20:23], a[164:167], v[116:119]
    v_mfma_f32_16x16x32_bf16 v[120:123], v[20:23], a[168:171], v[120:123]
    v_mfma_f32_16x16x32_bf16 v[124:127], v[20:23], a[172:175], v[124:127]
    s_waitcnt lgkmcnt(3)
    v_mfma_f32_16x16x32_bf16 v[96:99], v[24:27], a[176:179], v[96:99]
    ds_read_b128 v[16:19], v4 offset:26624
    v_mfma_f32_16x16x32_bf16 v[100:103], v[24:27], a[180:183], v[100:103]
    v_mfma_f32_16x16x32_bf16 v[104:107], v[24:27], a[184:187], v[104:107]
    v_mfma_f32_16x16x32_bf16 v[108:111], v[24:27], a[188:191], v[108:111]
    s_waitcnt lgkmcnt(3)
    v_mfma_f32_16x16x32_bf16 v[112:115], v[28:31], a[176:179], v[112:115]
    ds_read_b128 v[20:23], v4 offset:27648
    v_mfma_f32_16x16x32_bf16 v[116:119], v[28:31], a[180:183], v[116:119]
    v_mfma_f32_16x16x32_bf16 v[120:123], v[28:31], a[184:187], v[120:123]
    v_mfma_f32_16x16x32_bf16 v[124:127], v[28:31], a[188:191], v[124:127]
    s_add_u32 s60, s58, 16384
    buffer_load_dwordx4 a[96:99], v2, s[4:7], s60 offen offset:0 sc1
    s_waitcnt lgkmcnt(3)
    v_mfma_f32_16x16x32_bf16 v[96:99], v[8:11], a[192:195], v[96:99]
    ds_read_b128 v[24:27], v4 offset:28672
    buffer_load_dwordx4 a[100:103], v2, s[4:7], s60 offen offset:1024 sc1
    v_mfma_f32_16x16x32_bf16 v[100:103], v[8:11], a[196:199], v[100:103]
    buffer_load_dwordx4 a[104:107], v2, s[4:7], s60 offen offset:2048 sc1
    buffer_load_dwordx4 a[108:111], v2, s[4:7], s60 offen offset:3072 sc1
    v_mfma_f32_16x16x32_bf16 v[104:107], v[8:11], a[200:203], v[104:107]
    v_mfma_f32_16x16x32_bf16 v[108:111], v[8:11], a[204:207], v[108:111]
    s_waitcnt lgkmcnt(3)
    v_mfma_f32_16x16x32_bf16 v[112:115], v[12:15], a[192:195], v[112:115]
    ds_read_b128 v[28:31], v4 offset:29696
    v_mfma_f32_16x16x32_bf16 v[116:119], v[12:15], a[196:199], v[116:119]
    v_mfma_f32_16x16x32_bf16 v[120:123], v[12:15], a[200:203], v[120:123]
    v_mfma_f32_16x16x32_bf16 v[124:127], v[12:15], a[204:207], v[124:127]
    s_waitcnt lgkmcnt(3)
    v_mfma_f32_16x16x32_bf16 v[96:99], v[16:19], a[208:211], v[96:99]
    ds_read_b128 v[8:11], v4 offset:30720
    v_mfma_f32_16x16x32_bf16 v[100:103], v[16:19], a[212:215], v[100:103]
    v_mfma_f32_16x16x32_bf16 v[104:107], v[16:19], a[216:219], v[104:107]
    v_mfma_f32_16x16x32_bf16 v[108:111], v[16:19], a[220:223], v[108:111]
    s_waitcnt lgkmcnt(3)
    v_mfma_f32_16x16x32_bf16 v[112:115], v[20:23], a[208:211], v[112:115]
    ds_read_b128 v[12:15], v4 offset:31744
    v_mfma_f32_16x16x32_bf16 v[116:119], v[20:23], a[212:215], v[116:119]
    v_mfma_f32_16x16x32_bf16 v[120:123], v[20:23], a[216:219], v[120:123]
    v_mfma_f32_16x16x32_bf16 v[124:127], v[20:23], a[220:223], v[124:127]
    s_waitcnt lgkmcnt(3)
    v_mfma_f32_16x16x32_bf16 v[96:99], v[24:27], a[224:227], v[96:99]
    ds_read_b128 v[16:19], v4 offset:32768
    v_mfma_f32_16x16x32_bf16 v[100:103], v[24:27], a[228:231], v[100:103]
    v_mfma_f32_16x16x32_bf16 v[104:107], v[24:27], a[232:235], v[104:107]
    v_mfma_f32_16x16x32_bf16 v[108:111], v[24:27], a[236:239], v[108:111]
    s_waitcnt lgkmcnt(3)
    v_mfma_f32_16x16x32_bf16 v[112:115], v[28:31], a[224:227], v[112:115]
    ds_read_b128 v[20:23], v4 offset:33792
    v_mfma_f32_16x16x32_bf16 v[116:119], v[28:31], a[228:231], v[116:119]
    v_mfma_f32_16x16x32_bf16 v[120:123], v[28:31], a[232:235], v[120:123]
    v_mfma_f32_16x16x32_bf16 v[124:127], v[28:31], a[236:239], v[124:127]
    s_waitcnt lgkmcnt(3)
    v_mfma_f32_16x16x32_bf16 v[96:99], v[8:11], a[240:243], v[96:99]
    ds_read_b128 v[24:27], v4 offset:34816
    v_mfma_f32_16x16x32_bf16 v[100:103], v[8:11], a[244:247], v[100:103]
    v_mfma_f32_16x16x32_bf16 v[104:107], v[8:11], a[248:251], v[104:107]
    v_mfma_f32_16x16x32_bf16 v[108:111], v[8:11], a[252:255], v[108:111]
    ds_read_b128 v[136:139], v5 offset:1024
    ds_read_b128 v[140:143], v5 offset:1088
    s_waitcnt lgkmcnt(5)
    v_mfma_f32_16x16x32_bf16 v[112:115], v[12:15], a[240:243], v[112:115]
    ds_read_b128 v[28:31], v4 offset:35840
    v_mfma_f32_16x16x32_bf16 v[116:119], v[12:15], a[244:247], v[116:119]
    v_mfma_f32_16x16x32_bf16 v[120:123], v[12:15], a[248:251], v[120:123]
    v_mfma_f32_16x16x32_bf16 v[124:127], v[12:15], a[252:255], v[124:127]
    s_waitcnt lgkmcnt(5)
    v_mfma_f32_16x16x32_bf16 v[96:99], v[16:19], v[32:35], v[96:99]
    s_barrier
    v_mfma_f32_16x16x32_bf16 v[100:103], v[16:19], v[36:39], v[100:103]
    v_add_u32 v4, 0x9000, v4
    ds_read_b128 v[8:11], v4 offset:0
    v_mfma_f32_16x16x32_bf16 v[104:107], v[16:19], v[40:43], v[104:107]
    s_add_u32 m0, s49, 110592
    s_add_u32 s61, s48, 405504
    v_mfma_f32_16x16x32_bf16 v[108:111], v[16:19], v[44:47], v[108:111]
    buffer_load_dwordx4 v2, s[4:7], s61 offen offset:0 lds
    buffer_load_dwordx4 v2, s[4:7], s61 offen offset:1024 lds
    s_waitcnt lgkmcnt(5)
    v_mfma_f32_16x16x32_bf16 v[112:115], v[20:23], v[32:35], v[112:115]
    ds_read_b128 v[12:15], v4 offset:1024
    buffer_load_dwordx4 v2, s[4:7], s61 offen offset:2048 lds
    v_mfma_f32_16x16x32_bf16 v[116:119], v[20:23], v[36:39], v[116:119]
    buffer_load_dwordx4 v2, s[4:7], s61 offen offset:3072 lds
    s_add_u32 m0, s49, 114688
    v_mfma_f32_16x16x32_bf16 v[120:123], v[20:23], v[40:43], v[120:123]
    s_add_u32 s61, s48, 409600
    buffer_load_dwordx4 v2, s[4:7], s61 offen offset:0 lds
    v_mfma_f32_16x16x32_bf16 v[124:127], v[20:23], v[44:47], v[124:127]
    buffer_load_dwordx4 v2, s[4:7], s61 offen offset:1024 lds
    buffer_load_dwordx4 v2, s[4:7], s61 offen offset:2048 lds
    s_waitcnt lgkmcnt(5)
    v_mfma_f32_16x16x32_bf16 v[96:99], v[24:27], v[48:51], v[96:99]
    ds_read_b128 v[16:19], v4 offset:2048
    buffer_load_dwordx4 v2, s[4:7], s61 offen offset:3072 lds
    v_mfma_f32_16x16x32_bf16 v[100:103], v[24:27], v[52:55], v[100:103]
    s_add_u32 m0, s49, 118784
    s_add_u32 s61, s48, 413696
    v_mfma_f32_16x16x32_bf16 v[104:107], v[24:27], v[56:59], v[104:107]
    buffer_load_dwordx4 v2, s[4:7], s61 offen offset:0 lds
    v_mfma_f32_16x16x32_bf16 v[108:111], v[24:27], v[60:63], v[108:111]
    s_waitcnt lgkmcnt(3)
    v_mfma_f32_16x16x32_bf16 v[112:115], v[28:31], v[48:51], v[112:115]
    ds_read_b128 v[20:23], v4 offset:3072
    v_mfma_f32_16x16x32_bf16 v[116:119], v[28:31], v[52:55], v[116:119]
    v_mfma_f32_16x16x32_bf16 v[120:123], v[28:31], v[56:59], v[120:123]
    v_mfma_f32_16x16x32_bf16 v[124:127], v[28:31], v[60:63], v[124:127]
    s_waitcnt lgkmcnt(3)
    v_mfma_f32_16x16x32_bf16 v[32:35], v[8:11], v[176:179], 0
    ds_read_b128 v[24:27], v4 offset:4096
    v_mfma_f32_16x16x32_bf16 v[40:43], v[8:11], v[180:183], 0
    v_mfma_f32_16x16x32_bf16 v[48:51], v[8:11], v[184:187], 0
    v_mfma_f32_16x16x32_bf16 v[56:59], v[8:11], v[188:191], 0
    s_waitcnt lgkmcnt(3)
    v_mfma_f32_16x16x32_bf16 v[36:39], v[12:15], v[176:179], 0
    ds_read_b128 v[28:31], v4 offset:5120
    v_mfma_f32_16x16x32_bf16 v[44:47], v[12:15], v[180:183], 0
    v_fmac_f32 v96, v136, v128
    v_fmac_f32 v97, v137, v128
    v_mfma_f32_16x16x32_bf16 v[52:55], v[12:15], v[184:187], 0
    v_fmac_f32 v98, v138, v128
    v_fmac_f32 v99, v139, v128
    v_mfma_f32_16x16x32_bf16 v[60:63], v[12:15], v[188:191], 0
    v_fmac_f32 v112, v140, v128
    v_fmac_f32 v113, v141, v128
    s_waitcnt lgkmcnt(3)
    v_mfma_f32_16x16x32_bf16 v[64:67], v[16:19], v[176:179], 0
    ds_read_b128 v[8:11], v4 offset:6144
    v_fmac_f32 v114, v142, v128
    v_mfma_f32_16x16x32_bf16 v[72:75], v[16:19], v[180:183], 0
    v_fmac_f32 v115, v143, v128
    v_mul_f32 v96, v96, v132
    v_mfma_f32_16x16x32_bf16 v[80:83], v[16:19], v[184:187], 0
    v_mul_f32 v97, v97, v132
    v_mul_f32 v98, v98, v132
    v_mfma_f32_16x16x32_bf16 v[88:91], v[16:19], v[188:191], 0
    v_mul_f32 v99, v99, v132
    v_mul_f32 v96, v96, v112
    s_waitcnt lgkmcnt(3)
    v_mfma_f32_16x16x32_bf16 v[68:71], v[20:23], v[176:179], 0
    ds_read_b128 v[12:15], v4 offset:7168
    v_mul_f32 v97, v97, v113
    v_mfma_f32_16x16x32_bf16 v[76:79], v[20:23], v[180:183], 0
    v_mul_f32 v98, v98, v114
    v_mul_f32 v99, v99, v115
    v_mfma_f32_16x16x32_bf16 v[84:87], v[20:23], v[184:187], 0
    v_cvt_pk_bf16_f32 v226, v96, v97
    v_cvt_pk_bf16_f32 v227, v98, v99
    v_mfma_f32_16x16x32_bf16 v[92:95], v[20:23], v[188:191], 0
    s_add_u32 s66, s51, 49152
    buffer_store_dwordx4 v[224:227], v2, s[4:7], s66 offen offset:0 sc1
    s_waitcnt lgkmcnt(3)
    v_mfma_f32_16x16x32_bf16 v[32:35], v[24:27], v[192:195], v[32:35]
    ds_read_b128 v[16:19], v4 offset:8192
    v_fmac_f32 v100, v136, v129
    v_mfma_f32_16x16x32_bf16 v[40:43], v[24:27], v[196:199], v[40:43]
    v_fmac_f32 v101, v137, v129
    v_fmac_f32 v102, v138, v129
    v_mfma_f32_16x16x32_bf16 v[48:51], v[24:27], v[200:203], v[48:51]
    v_fmac_f32 v103, v139, v129
    v_fmac_f32 v116, v140, v129
    v_mfma_f32_16x16x32_bf16 v[56:59], v[24:27], v[204:207], v[56:59]
    v_fmac_f32 v117, v141, v129
    v_fmac_f32 v118, v142, v129
    s_waitcnt lgkmcnt(3)
    v_mfma_f32_16x16x32_bf16 v[36:39], v[28:31], v[192:195], v[36:39]
    ds_read_b128 v[20:23], v4 offset:9216
    v_fmac_f32 v119, v143, v129
    v_mfma_f32_16x16x32_bf16 v[44:47], v[28:31], v[196:199], v[44:47]
    v_mul_f32 v100, v100, v133
    v_mul_f32 v101, v101, v133
    v_mfma_f32_16x16x32_bf16 v[52:55], v[28:31], v[200:203], v[52:55]
    v_mul_f32 v102, v102, v133
    v_mul_f32 v103, v103, v133
    v_mfma_f32_16x16x32_bf16 v[60:63], v[28:31], v[204:207], v[60:63]
    v_mul_f32 v100, v100, v116
    v_mul_f32 v101, v101, v117
    s_waitcnt lgkmcnt(3)
    v_mfma_f32_16x16x32_bf16 v[64:67], v[8:11], v[192:195], v[64:67]
    ds_read_b128 v[24:27], v4 offset:10240
    v_mul_f32 v102, v102, v118
    v_mfma_f32_16x16x32_bf16 v[72:75], v[8:11], v[196:199], v[72:75]
    v_mul_f32 v103, v103, v119
    v_cvt_pk_bf16_f32 v230, v100, v101
    v_mfma_f32_16x16x32_bf16 v[80:83], v[8:11], v[200:203], v[80:83]
    v_cvt_pk_bf16_f32 v231, v102, v103
    buffer_store_dwordx4 v[228:231], v2, s[4:7], s66 offen offset:1024 sc1
    v_mfma_f32_16x16x32_bf16 v[88:91], v[8:11], v[204:207], v[88:91]
    v_fmac_f32 v104, v136, v130
    v_fmac_f32 v105, v137, v130
    s_waitcnt lgkmcnt(3)
    v_mfma_f32_16x16x32_bf16 v[68:71], v[12:15], v[192:195], v[68:71]
    ds_read_b128 v[28:31], v4 offset:11264
    v_fmac_f32 v106, v138, v130
    v_mfma_f32_16x16x32_bf16 v[76:79], v[12:15], v[196:199], v[76:79]
    v_fmac_f32 v107, v139, v130
    v_fmac_f32 v120, v140, v130
    v_mfma_f32_16x16x32_bf16 v[84:87], v[12:15], v[200:203], v[84:87]
    v_fmac_f32 v121, v141, v130
    v_fmac_f32 v122, v142, v130
    v_mfma_f32_16x16x32_bf16 v[92:95], v[12:15], v[204:207], v[92:95]
    v_fmac_f32 v123, v143, v130
    v_mul_f32 v104, v104, v134
    s_waitcnt lgkmcnt(3)
    v_mfma_f32_16x16x32_bf16 v[32:35], v[16:19], v[208:211], v[32:35]
    ds_read_b128 v[8:11], v4 offset:12288
    v_mul_f32 v105, v105, v134
    v_mfma_f32_16x16x32_bf16 v[40:43], v[16:19], v[212:215], v[40:43]
    v_mul_f32 v106, v106, v134
    v_mul_f32 v107, v107, v134
    v_mfma_f32_16x16x32_bf16 v[48:51], v[16:19], v[216:219], v[48:51]
    v_mul_f32 v104, v104, v120
    v_mul_f32 v105, v105, v121
    v_mfma_f32_16x16x32_bf16 v[56:59], v[16:19], v[220:223], v[56:59]
    v_mul_f32 v106, v106, v122
    v_mul_f32 v107, v107, v123
    s_waitcnt lgkmcnt(3)
    v_mfma_f32_16x16x32_bf16 v[36:39], v[20:23], v[208:211], v[36:39]
    ds_read_b128 v[12:15], v4 offset:13312
    v_cvt_pk_bf16_f32 v234, v104, v105
    v_mfma_f32_16x16x32_bf16 v[44:47], v[20:23], v[212:215], v[44:47]
    v_cvt_pk_bf16_f32 v235, v106, v107
    buffer_store_dwordx4 v[232:235], v2, s[4:7], s66 offen offset:2048 sc1
    v_mfma_f32_16x16x32_bf16 v[52:55], v[20:23], v[216:219], v[52:55]
    v_fmac_f32 v108, v136, v131
    v_fmac_f32 v109, v137, v131
    v_mfma_f32_16x16x32_bf16 v[60:63], v[20:23], v[220:223], v[60:63]
    v_fmac_f32 v110, v138, v131
    v_fmac_f32 v111, v139, v131
    s_waitcnt lgkmcnt(3)
    v_mfma_f32_16x16x32_bf16 v[64:67], v[24:27], v[208:211], v[64:67]
    ds_read_b128 v[16:19], v4 offset:14336
    v_fmac_f32 v124, v140, v131
    v_mfma_f32_16x16x32_bf16 v[72:75], v[24:27], v[212:215], v[72:75]
    v_fmac_f32 v125, v141, v131
    v_fmac_f32 v126, v142, v131
    v_mfma_f32_16x16x32_bf16 v[80:83], v[24:27], v[216:219], v[80:83]
    v_fmac_f32 v127, v143, v131
    v_mul_f32 v108, v108, v135
    v_mfma_f32_16x16x32_bf16 v[88:91], v[24:27], v[220:223], v[88:91]
    v_mul_f32 v109, v109, v135
    v_mul_f32 v110, v110, v135
    s_waitcnt lgkmcnt(3)
    v_mfma_f32_16x16x32_bf16 v[68:71], v[28:31], v[208:211], v[68:71]
    ds_read_b128 v[20:23], v4 offset:15360
    v_mul_f32 v111, v111, v135
    v_mfma_f32_16x16x32_bf16 v[76:79], v[28:31], v[212:215], v[76:79]
    v_mul_f32 v108, v108, v124
    v_mul_f32 v109, v109, v125
    v_mfma_f32_16x16x32_bf16 v[84:87], v[28:31], v[216:219], v[84:87]
    v_mul_f32 v110, v110, v126
    v_mul_f32 v111, v111, v127
    v_mfma_f32_16x16x32_bf16 v[92:95], v[28:31], v[220:223], v[92:95]
    v_cvt_pk_bf16_f32 v238, v108, v109
    v_cvt_pk_bf16_f32 v239, v110, v111
    buffer_store_dwordx4 v[236:239], v2, s[4:7], s66 offen offset:3072 sc1
    s_waitcnt lgkmcnt(3)
    v_mfma_f32_16x16x32_bf16 v[96:99], v[8:11], v[176:179], 0
    ds_read_b128 v[24:27], v4 offset:16384
    v_mfma_f32_16x16x32_bf16 v[104:107], v[8:11], v[180:183], 0
    v_mfma_f32_16x16x32_bf16 v[112:115], v[8:11], v[184:187], 0
    v_mfma_f32_16x16x32_bf16 v[120:123], v[8:11], v[188:191], 0
    s_waitcnt lgkmcnt(3)
    v_mfma_f32_16x16x32_bf16 v[100:103], v[12:15], v[176:179], 0
    ds_read_b128 v[28:31], v4 offset:17408
    v_mfma_f32_16x16x32_bf16 v[108:111], v[12:15], v[180:183], 0
    v_mfma_f32_16x16x32_bf16 v[116:119], v[12:15], v[184:187], 0
    v_mfma_f32_16x16x32_bf16 v[124:127], v[12:15], v[188:191], 0
    s_waitcnt lgkmcnt(3)
    v_mfma_f32_16x16x32_bf16 v[128:131], v[16:19], v[176:179], 0
    ds_read_b128 v[8:11], v4 offset:18432
    v_mfma_f32_16x16x32_bf16 v[136:139], v[16:19], v[180:183], 0
    v_mfma_f32_16x16x32_bf16 v[144:147], v[16:19], v[184:187], 0
    v_mfma_f32_16x16x32_bf16 v[152:155], v[16:19], v[188:191], 0
    s_waitcnt lgkmcnt(3)
    v_mfma_f32_16x16x32_bf16 v[132:135], v[20:23], v[176:179], 0
    ds_read_b128 v[12:15], v4 offset:19456
    v_mfma_f32_16x16x32_bf16 v[140:143], v[20:23], v[180:183], 0
    v_mfma_f32_16x16x32_bf16 v[148:151], v[20:23], v[184:187], 0
    v_mfma_f32_16x16x32_bf16 v[156:159], v[20:23], v[188:191], 0
    s_waitcnt lgkmcnt(3)
    v_mfma_f32_16x16x32_bf16 v[160:163], v[24:27], v[176:179], 0
    ds_read_b128 v[16:19], v4 offset:20480
    v_mfma_f32_16x16x32_bf16 v[164:167], v[24:27], v[180:183], 0
    v_mfma_f32_16x16x32_bf16 v[168:171], v[24:27], v[184:187], 0
    v_mfma_f32_16x16x32_bf16 v[172:175], v[24:27], v[188:191], 0
    s_waitcnt lgkmcnt(3)
    v_mfma_f32_16x16x32_bf16 v[96:99], v[28:31], v[192:195], v[96:99]
    ds_read_b128 v[20:23], v4 offset:21504
    v_mfma_f32_16x16x32_bf16 v[104:107], v[28:31], v[196:199], v[104:107]
    v_mfma_f32_16x16x32_bf16 v[112:115], v[28:31], v[200:203], v[112:115]
    v_mfma_f32_16x16x32_bf16 v[120:123], v[28:31], v[204:207], v[120:123]
    s_waitcnt lgkmcnt(3)
    v_mfma_f32_16x16x32_bf16 v[100:103], v[8:11], v[192:195], v[100:103]
    ds_read_b128 v[24:27], v4 offset:22528
    v_mfma_f32_16x16x32_bf16 v[108:111], v[8:11], v[196:199], v[108:111]
    v_mfma_f32_16x16x32_bf16 v[116:119], v[8:11], v[200:203], v[116:119]
    v_mfma_f32_16x16x32_bf16 v[124:127], v[8:11], v[204:207], v[124:127]
    s_waitcnt lgkmcnt(3)
    v_mfma_f32_16x16x32_bf16 v[128:131], v[12:15], v[192:195], v[128:131]
    ds_read_b128 v[28:31], v4 offset:23552
    v_mfma_f32_16x16x32_bf16 v[136:139], v[12:15], v[196:199], v[136:139]
    v_mfma_f32_16x16x32_bf16 v[144:147], v[12:15], v[200:203], v[144:147]
    v_mfma_f32_16x16x32_bf16 v[152:155], v[12:15], v[204:207], v[152:155]
    s_waitcnt lgkmcnt(3)
    v_mfma_f32_16x16x32_bf16 v[132:135], v[16:19], v[192:195], v[132:135]
    ds_read_b128 v[8:11], v4 offset:24576
    v_mfma_f32_16x16x32_bf16 v[140:143], v[16:19], v[196:199], v[140:143]
    v_mfma_f32_16x16x32_bf16 v[148:151], v[16:19], v[200:203], v[148:151]
    v_mfma_f32_16x16x32_bf16 v[156:159], v[16:19], v[204:207], v[156:159]
    s_waitcnt lgkmcnt(3)
    v_mfma_f32_16x16x32_bf16 v[160:163], v[20:23], v[192:195], v[160:163]
    ds_read_b128 v[12:15], v4 offset:25600
    v_mfma_f32_16x16x32_bf16 v[164:167], v[20:23], v[196:199], v[164:167]
    v_mfma_f32_16x16x32_bf16 v[168:171], v[20:23], v[200:203], v[168:171]
    v_mfma_f32_16x16x32_bf16 v[172:175], v[20:23], v[204:207], v[172:175]
    s_waitcnt lgkmcnt(3)
    v_mfma_f32_16x16x32_bf16 v[96:99], v[24:27], v[208:211], v[96:99]
    ds_read_b128 v[16:19], v4 offset:26624
    v_mfma_f32_16x16x32_bf16 v[104:107], v[24:27], v[212:215], v[104:107]
    v_mfma_f32_16x16x32_bf16 v[112:115], v[24:27], v[216:219], v[112:115]
    v_mfma_f32_16x16x32_bf16 v[120:123], v[24:27], v[220:223], v[120:123]
    s_waitcnt lgkmcnt(3)
    v_mfma_f32_16x16x32_bf16 v[100:103], v[28:31], v[208:211], v[100:103]
    ds_read_b128 v[20:23], v4 offset:27648
    v_mfma_f32_16x16x32_bf16 v[108:111], v[28:31], v[212:215], v[108:111]
    v_mfma_f32_16x16x32_bf16 v[116:119], v[28:31], v[216:219], v[116:119]
    v_mfma_f32_16x16x32_bf16 v[124:127], v[28:31], v[220:223], v[124:127]
    s_waitcnt lgkmcnt(3)
    v_mfma_f32_16x16x32_bf16 v[128:131], v[8:11], v[208:211], v[128:131]
    ds_read_b128 v[24:27], v4 offset:28672
    v_mfma_f32_16x16x32_bf16 v[136:139], v[8:11], v[212:215], v[136:139]
    v_mfma_f32_16x16x32_bf16 v[144:147], v[8:11], v[216:219], v[144:147]
    v_mfma_f32_16x16x32_bf16 v[152:155], v[8:11], v[220:223], v[152:155]
    s_waitcnt lgkmcnt(3)
    v_mfma_f32_16x16x32_bf16 v[132:135], v[12:15], v[208:211], v[132:135]
    ds_read_b128 v[28:31], v4 offset:29696
    v_mfma_f32_16x16x32_bf16 v[140:143], v[12:15], v[212:215], v[140:143]
    v_mfma_f32_16x16x32_bf16 v[148:151], v[12:15], v[216:219], v[148:151]
    v_mfma_f32_16x16x32_bf16 v[156:159], v[12:15], v[220:223], v[156:159]
    s_waitcnt lgkmcnt(3)
    v_mfma_f32_16x16x32_bf16 v[160:163], v[16:19], v[208:211], v[160:163]
    ds_read_b128 v[8:11], v4 offset:30720
    v_mfma_f32_16x16x32_bf16 v[164:167], v[16:19], v[212:215], v[164:167]
    v_mfma_f32_16x16x32_bf16 v[168:171], v[16:19], v[216:219], v[168:171]
    v_mfma_f32_16x16x32_bf16 v[172:175], v[16:19], v[220:223], v[172:175]
    s_waitcnt lgkmcnt(3)
    v_mfma_f32_16x16x32_bf16 v[32:35], v[20:23], v[224:227], v[32:35]
    ds_read_b128 v[12:15], v4 offset:31744
    v_mfma_f32_16x16x32_bf16 v[40:43], v[20:23], v[228:231], v[40:43]
    v_mfma_f32_16x16x32_bf16 v[48:51], v[20:23], v[232:235], v[48:51]
    v_mfma_f32_16x16x32_bf16 v[56:59], v[20:23], v[236:239], v[56:59]
    s_waitcnt lgkmcnt(3)
    v_mfma_f32_16x16x32_bf16 v[36:39], v[24:27], v[224:227], v[36:39]
    ds_read_b128 v[16:19], v4 offset:32768
    v_mfma_f32_16x16x32_bf16 v[44:47], v[24:27], v[228:231], v[44:47]
    v_mfma_f32_16x16x32_bf16 v[52:55], v[24:27], v[232:235], v[52:55]
    v_mfma_f32_16x16x32_bf16 v[60:63], v[24:27], v[236:239], v[60:63]
    s_waitcnt lgkmcnt(3)
    v_mfma_f32_16x16x32_bf16 v[64:67], v[28:31], v[224:227], v[64:67]
    ds_read_b128 v[20:23], v4 offset:33792
    v_mfma_f32_16x16x32_bf16 v[72:75], v[28:31], v[228:231], v[72:75]
    v_mov_b32 v6, 2
    v_mov_b32 v7, 0
    v_mfma_f32_16x16x32_bf16 v[80:83], v[28:31], v[232:235], v[80:83]
    s_waitcnt vmcnt(0)
    v_mfma_f32_16x16x32_bf16 v[88:91], v[28:31], v[236:239], v[88:91]
    s_mov_b64 exec, 1
    buffer_store_dword v6, v7, s[4:7], s67 offen sc1
    s_mov_b64 exec, -1
    s_waitcnt lgkmcnt(3)
    v_mfma_f32_16x16x32_bf16 v[68:71], v[8:11], v[224:227], v[68:71]
    ds_read_b128 v[24:27], v4 offset:34816
    v_mfma_f32_16x16x32_bf16 v[76:79], v[8:11], v[228:231], v[76:79]
    v_mfma_f32_16x16x32_bf16 v[84:87], v[8:11], v[232:235], v[84:87]
    v_mfma_f32_16x16x32_bf16 v[92:95], v[8:11], v[236:239], v[92:95]
    s_waitcnt lgkmcnt(3)
    v_mfma_f32_16x16x32_bf16 v[96:99], v[12:15], v[224:227], v[96:99]
    ds_read_b128 v[28:31], v4 offset:35840
    v_mfma_f32_16x16x32_bf16 v[104:107], v[12:15], v[228:231], v[104:107]
    v_mfma_f32_16x16x32_bf16 v[112:115], v[12:15], v[232:235], v[112:115]
    v_mfma_f32_16x16x32_bf16 v[120:123], v[12:15], v[236:239], v[120:123]
    s_waitcnt lgkmcnt(3)
    v_mfma_f32_16x16x32_bf16 v[100:103], v[16:19], v[224:227], v[100:103]
    s_barrier
    v_mfma_f32_16x16x32_bf16 v[108:111], v[16:19], v[228:231], v[108:111]
    v_add_u32 v4, 0x9000, v4
    ds_read_b128 v[8:11], v4 offset:0
    v_mfma_f32_16x16x32_bf16 v[116:119], v[16:19], v[232:235], v[116:119]
    s_add_u32 m0, s49, 0
    s_add_u32 s61, s48, 442368
    v_mfma_f32_16x16x32_bf16 v[124:127], v[16:19], v[236:239], v[124:127]
    buffer_load_dwordx4 v2, s[4:7], s61 offen offset:0 lds
    buffer_load_dwordx4 v2, s[4:7], s61 offen offset:1024 lds
    s_waitcnt lgkmcnt(3)
    v_mfma_f32_16x16x32_bf16 v[128:131], v[20:23], v[224:227], v[128:131]
    ds_read_b128 v[12:15], v4 offset:1024
    buffer_load_dwordx4 v2, s[4:7], s61 offen offset:2048 lds
    v_mfma_f32_16x16x32_bf16 v[136:139], v[20:23], v[228:231], v[136:139]
    buffer_load_dwordx4 v2, s[4:7], s61 offen offset:3072 lds
    s_add_u32 m0, s49, 4096
    v_mfma_f32_16x16x32_bf16 v[144:147], v[20:23], v[232:235], v[144:147]
    s_add_u32 s61, s48, 446464
    buffer_load_dwordx4 v2, s[4:7], s61 offen offset:0 lds
    v_mfma_f32_16x16x32_bf16 v[152:155], v[20:23], v[236:239], v[152:155]
    buffer_load_dwordx4 v2, s[4:7], s61 offen offset:1024 lds
    buffer_load_dwordx4 v2, s[4:7], s61 offen offset:2048 lds
    s_waitcnt lgkmcnt(3)
    v_mfma_f32_16x16x32_bf16 v[132:135], v[24:27], v[224:227], v[132:135]
    ds_read_b128 v[16:19], v4 offset:2048
    buffer_load_dwordx4 v2, s[4:7], s61 offen offset:3072 lds
    v_mfma_f32_16x16x32_bf16 v[140:143], v[24:27], v[228:231], v[140:143]
    s_add_u32 m0, s49, 8192
    s_add_u32 s61, s48, 450560
    v_mfma_f32_16x16x32_bf16 v[148:151], v[24:27], v[232:235], v[148:151]
    buffer_load_dwordx4 v2, s[4:7], s61 offen offset:0 lds
    v_mfma_f32_16x16x32_bf16 v[156:159], v[24:27], v[236:239], v[156:159]
    s_waitcnt lgkmcnt(3)
    v_mfma_f32_16x16x32_bf16 v[160:163], v[28:31], v[224:227], v[160:163]
    ds_read_b128 v[20:23], v4 offset:3072
    v_mfma_f32_16x16x32_bf16 v[164:167], v[28:31], v[228:231], v[164:167]
    v_mfma_f32_16x16x32_bf16 v[168:171], v[28:31], v[232:235], v[168:171]
    v_mfma_f32_16x16x32_bf16 v[172:175], v[28:31], v[236:239], v[172:175]
    s_waitcnt lgkmcnt(3)
    v_mfma_f32_16x16x32_bf16 v[32:35], v[8:11], v[240:243], v[32:35]
    ds_read_b128 v[24:27], v4 offset:4096
    v_mfma_f32_16x16x32_bf16 v[40:43], v[8:11], v[244:247], v[40:43]
    v_mfma_f32_16x16x32_bf16 v[48:51], v[8:11], v[248:251], v[48:51]
    v_mfma_f32_16x16x32_bf16 v[56:59], v[8:11], v[252:255], v[56:59]
    s_waitcnt lgkmcnt(3)
    v_mfma_f32_16x16x32_bf16 v[36:39], v[12:15], v[240:243], v[36:39]
    ds_read_b128 v[28:31], v4 offset:5120
    v_mfma_f32_16x16x32_bf16 v[44:47], v[12:15], v[244:247], v[44:47]
    v_mfma_f32_16x16x32_bf16 v[52:55], v[12:15], v[248:251], v[52:55]
    v_mfma_f32_16x16x32_bf16 v[60:63], v[12:15], v[252:255], v[60:63]
    s_waitcnt lgkmcnt(3)
    v_mfma_f32_16x16x32_bf16 v[64:67], v[16:19], v[240:243], v[64:67]
    ds_read_b128 v[8:11], v4 offset:6144
    v_mfma_f32_16x16x32_bf16 v[72:75], v[16:19], v[244:247], v[72:75]
    v_mfma_f32_16x16x32_bf16 v[80:83], v[16:19], v[248:251], v[80:83]
    v_mfma_f32_16x16x32_bf16 v[88:91], v[16:19], v[252:255], v[88:91]
    s_waitcnt lgkmcnt(3)
    v_mfma_f32_16x16x32_bf16 v[68:71], v[20:23], v[240:243], v[68:71]
    ds_read_b128 v[12:15], v4 offset:7168
    v_mfma_f32_16x16x32_bf16 v[76:79], v[20:23], v[244:247], v[76:79]
    v_mfma_f32_16x16x32_bf16 v[84:87], v[20:23], v[248:251], v[84:87]
    v_mfma_f32_16x16x32_bf16 v[92:95], v[20:23], v[252:255], v[92:95]
    s_waitcnt lgkmcnt(3)
    v_mfma_f32_16x16x32_bf16 v[96:99], v[24:27], v[240:243], v[96:99]
    ds_read_b128 v[16:19], v4 offset:8192
    v_mfma_f32_16x16x32_bf16 v[104:107], v[24:27], v[244:247], v[104:107]
    v_mfma_f32_16x16x32_bf16 v[112:115], v[24:27], v[248:251], v[112:115]
    v_mfma_f32_16x16x32_bf16 v[120:123], v[24:27], v[252:255], v[120:123]
    s_waitcnt lgkmcnt(3)
    v_mfma_f32_16x16x32_bf16 v[100:103], v[28:31], v[240:243], v[100:103]
    ds_read_b128 v[20:23], v4 offset:9216
    v_mfma_f32_16x16x32_bf16 v[108:111], v[28:31], v[244:247], v[108:111]
    v_mfma_f32_16x16x32_bf16 v[116:119], v[28:31], v[248:251], v[116:119]
    v_mfma_f32_16x16x32_bf16 v[124:127], v[28:31], v[252:255], v[124:127]
    s_waitcnt lgkmcnt(3)
    v_mfma_f32_16x16x32_bf16 v[128:131], v[8:11], v[240:243], v[128:131]
    ds_read_b128 v[24:27], v4 offset:10240
    v_mfma_f32_16x16x32_bf16 v[136:139], v[8:11], v[244:247], v[136:139]
    v_mfma_f32_16x16x32_bf16 v[144:147], v[8:11], v[248:251], v[144:147]
    v_mfma_f32_16x16x32_bf16 v[152:155], v[8:11], v[252:255], v[152:155]
    s_waitcnt lgkmcnt(3)
    v_mfma_f32_16x16x32_bf16 v[132:135], v[12:15], v[240:243], v[132:135]
    ds_read_b128 v[28:31], v4 offset:11264
    v_mfma_f32_16x16x32_bf16 v[140:143], v[12:15], v[244:247], v[140:143]
    v_mfma_f32_16x16x32_bf16 v[148:151], v[12:15], v[248:251], v[148:151]
    v_mfma_f32_16x16x32_bf16 v[156:159], v[12:15], v[252:255], v[156:159]
    s_waitcnt lgkmcnt(3)
    v_mfma_f32_16x16x32_bf16 v[160:163], v[16:19], v[240:243], v[160:163]
    ds_read_b128 v[8:11], v4 offset:12288
    v_mfma_f32_16x16x32_bf16 v[164:167], v[16:19], v[244:247], v[164:167]
    v_mfma_f32_16x16x32_bf16 v[168:171], v[16:19], v[248:251], v[168:171]
    v_mfma_f32_16x16x32_bf16 v[172:175], v[16:19], v[252:255], v[172:175]
    s_waitcnt lgkmcnt(3)
    v_mfma_f32_16x16x32_bf16 v[32:35], v[20:23], a[0:3], v[32:35]
    ds_read_b128 v[12:15], v4 offset:13312
    v_mfma_f32_16x16x32_bf16 v[40:43], v[20:23], a[4:7], v[40:43]
    v_mfma_f32_16x16x32_bf16 v[48:51], v[20:23], a[8:11], v[48:51]
    v_mfma_f32_16x16x32_bf16 v[56:59], v[20:23], a[12:15], v[56:59]
    v_and_b32 v7, 3, v1
    s_waitcnt lgkmcnt(3)
    v_mfma_f32_16x16x32_bf16 v[36:39], v[24:27], a[0:3], v[36:39]
    ds_read_b128 v[16:19], v4 offset:14336
    v_lshlrev_b32 v7, 2, v7
    v_mfma_f32_16x16x32_bf16 v[44:47], v[24:27], a[4:7], v[44:47]
    buffer_load_dword v6, v7, s[4:7], s52 offen sc1
    v_mfma_f32_16x16x32_bf16 v[52:55], v[24:27], a[8:11], v[52:55]
    v_mfma_f32_16x16x32_bf16 v[60:63], v[24:27], a[12:15], v[60:63]
    s_waitcnt lgkmcnt(3)
    v_mfma_f32_16x16x32_bf16 v[64:67], v[28:31], a[0:3], v[64:67]
    ds_read_b128 v[20:23], v4 offset:15360
    v_mfma_f32_16x16x32_bf16 v[72:75], v[28:31], a[4:7], v[72:75]
    v_mfma_f32_16x16x32_bf16 v[80:83], v[28:31], a[8:11], v[80:83]
    v_mfma_f32_16x16x32_bf16 v[88:91], v[28:31], a[12:15], v[88:91]
    s_waitcnt lgkmcnt(3)
    v_mfma_f32_16x16x32_bf16 v[68:71], v[8:11], a[0:3], v[68:71]
    ds_read_b128 v[24:27], v4 offset:16384
    v_mfma_f32_16x16x32_bf16 v[76:79], v[8:11], a[4:7], v[76:79]
    v_mfma_f32_16x16x32_bf16 v[84:87], v[8:11], a[8:11], v[84:87]
    v_mfma_f32_16x16x32_bf16 v[92:95], v[8:11], a[12:15], v[92:95]
    s_waitcnt lgkmcnt(3)
    v_mfma_f32_16x16x32_bf16 v[96:99], v[12:15], a[0:3], v[96:99]
    ds_read_b128 v[28:31], v4 offset:17408
    v_mfma_f32_16x16x32_bf16 v[104:107], v[12:15], a[4:7], v[104:107]
    v_mfma_f32_16x16x32_bf16 v[112:115], v[12:15], a[8:11], v[112:115]
    v_mfma_f32_16x16x32_bf16 v[120:123], v[12:15], a[12:15], v[120:123]
    s_waitcnt lgkmcnt(3)
    v_mfma_f32_16x16x32_bf16 v[100:103], v[16:19], a[0:3], v[100:103]
    ds_read_b128 v[8:11], v4 offset:18432
    v_mfma_f32_16x16x32_bf16 v[108:111], v[16:19], a[4:7], v[108:111]
    v_mfma_f32_16x16x32_bf16 v[116:119], v[16:19], a[8:11], v[116:119]
    v_mfma_f32_16x16x32_bf16 v[124:127], v[16:19], a[12:15], v[124:127]
    s_waitcnt lgkmcnt(3)
    v_mfma_f32_16x16x32_bf16 v[128:131], v[20:23], a[0:3], v[128:131]
    ds_read_b128 v[12:15], v4 offset:19456
    v_mfma_f32_16x16x32_bf16 v[136:139], v[20:23], a[4:7], v[136:139]
    v_mfma_f32_16x16x32_bf16 v[144:147], v[20:23], a[8:11], v[144:147]
    v_mfma_f32_16x16x32_bf16 v[152:155], v[20:23], a[12:15], v[152:155]
    s_waitcnt lgkmcnt(3)
    v_mfma_f32_16x16x32_bf16 v[132:135], v[24:27], a[0:3], v[132:135]
    ds_read_b128 v[16:19], v4 offset:20480
    v_mfma_f32_16x16x32_bf16 v[140:143], v[24:27], a[4:7], v[140:143]
    v_mfma_f32_16x16x32_bf16 v[148:151], v[24:27], a[8:11], v[148:151]
    v_mfma_f32_16x16x32_bf16 v[156:159], v[24:27], a[12:15], v[156:159]
    s_waitcnt lgkmcnt(3)
    v_mfma_f32_16x16x32_bf16 v[160:163], v[28:31], a[0:3], v[160:163]
    ds_read_b128 v[20:23], v4 offset:21504
    v_mfma_f32_16x16x32_bf16 v[164:167], v[28:31], a[4:7], v[164:167]
    v_mfma_f32_16x16x32_bf16 v[168:171], v[28:31], a[8:11], v[168:171]
    v_mfma_f32_16x16x32_bf16 v[172:175], v[28:31], a[12:15], v[172:175]
    s_waitcnt vmcnt(0)
    v_cmp_le_u32 vcc, 2, v6
    s_nop 0
    s_cmp_eq_u64 vcc, exec
    s_cbranch_scc0 L_pb_slow_26
L_pb_back_27:
    s_waitcnt lgkmcnt(3)
    v_mfma_f32_16x16x32_bf16 v[32:35], v[8:11], a[16:19], v[32:35]
    ds_read_b128 v[24:27], v4 offset:22528
    s_add_u32 s60, s56, 32768
    v_mfma_f32_16x16x32_bf16 v[40:43], v[8:11], a[20:23], v[40:43]
    buffer_load_dwordx4 a[112:115], v2, s[4:7], s60 offen offset:0 sc1
    buffer_load_dwordx4 a[116:119], v2, s[4:7], s60 offen offset:1024 sc1
    v_mfma_f32_16x16x32_bf16 v[48:51], v[8:11], a[24:27], v[48:51]
    buffer_load_dwordx4 a[120:123], v2, s[4:7], s60 offen offset:2048 sc1
    buffer_load_dwordx4 a[124:127], v2, s[4:7], s60 offen offset:3072 sc1
    v_mfma_f32_16x16x32_bf16 v[56:59], v[8:11], a[28:31], v[56:59]
    s_and_b32 s68, s46, 1
    s_mul_i32 s69, s68, 5120
    s_waitcnt lgkmcnt(3)
    v_mfma_f32_16x16x32_bf16 v[36:39], v[12:15], a[16:19], v[36:39]
    ds_read_b128 v[28:31], v4 offset:23552
    s_add_u32 s69, s69, s53
    v_mfma_f32_16x16x32_bf16 v[44:47], v[12:15], a[20:23], v[44:47]
    s_lshl_b32 s68, s68, 9
    s_add_u32 s68, s68, s53
    v_mfma_f32_16x16x32_bf16 v[52:55], v[12:15], a[24:27], v[52:55]
    s_add_u32 s60, s57, 32768
    buffer_load_dwordx4 a[128:131], v2, s[4:7], s60 offen offset:0 sc1
    v_mfma_f32_16x16x32_bf16 v[60:63], v[12:15], a[28:31], v[60:63]
    buffer_load_dwordx4 a[132:135], v2, s[4:7], s60 offen offset:1024 sc1
    buffer_load_dwordx4 a[136:139], v2, s[4:7], s60 offen offset:2048 sc1
    s_waitcnt lgkmcnt(3)
    v_mfma_f32_16x16x32_bf16 v[64:67], v[16:19], a[16:19], v[64:67]
    ds_read_b128 v[8:11], v4 offset:24576
    buffer_load_dwordx4 a[140:143], v2, s[4:7], s60 offen offset:3072 sc1
    v_mfma_f32_16x16x32_bf16 v[72:75], v[16:19], a[20:23], v[72:75]
    v_and_b32 v0, 15, v1
    v_lshlrev_b32 v0, 5, v0
    v_mfma_f32_16x16x32_bf16 v[80:83], v[16:19], a[24:27], v[80:83]
    v_lshrrev_b32 v5, 4, v1
    v_lshl_add_u32 v0, v5, 3, v0
    v_mfma_f32_16x16x32_bf16 v[88:91], v[16:19], a[28:31], v[88:91]
    s_waitcnt lgkmcnt(3)
    v_mfma_f32_16x16x32_bf16 v[68:71], v[20:23], a[16:19], v[68:71]
    ds_read_b128 v[12:15], v4 offset:25600
    s_add_u32 s60, s58, 32768
    v_mfma_f32_16x16x32_bf16 v[76:79], v[20:23], a[20:23], v[76:79]
    buffer_load_dwordx4 a[144:147], v2, s[4:7], s60 offen offset:0 sc1
    buffer_load_dwordx4 a[148:151], v2, s[4:7], s60 offen offset:1024 sc1
    v_mfma_f32_16x16x32_bf16 v[84:87], v[20:23], a[24:27], v[84:87]
    buffer_load_dwordx4 a[152:155], v2, s[4:7], s60 offen offset:2048 sc1
    buffer_load_dwordx4 a[156:159], v2, s[4:7], s60 offen offset:3072 sc1
    v_mfma_f32_16x16x32_bf16 v[92:95], v[20:23], a[28:31], v[92:95]
    s_waitcnt lgkmcnt(3)
    v_mfma_f32_16x16x32_bf16 v[96:99], v[24:27], a[16:19], v[96:99]
    ds_read_b128 v[16:19], v4 offset:26624
    v_mfma_f32_16x16x32_bf16 v[104:107], v[24:27], a[20:23], v[104:107]
    v_mfma_f32_16x16x32_bf16 v[112:115], v[24:27], a[24:27], v[112:115]
    s_add_u32 s60, s56, 49152
    buffer_load_dwordx4 a[160:163], v2, s[4:7], s60 offen offset:0 sc1
    v_mfma_f32_16x16x32_bf16 v[120:123], v[24:27], a[28:31], v[120:123]
    buffer_load_dwordx4 a[164:167], v2, s[4:7], s60 offen offset:1024 sc1
    buffer_load_dwordx4 a[168:171], v2, s[4:7], s60 offen offset:2048 sc1
    s_waitcnt lgkmcnt(3)
    v_mfma_f32_16x16x32_bf16 v[100:103], v[28:31], a[16:19], v[100:103]
    ds_read_b128 v[20:23], v4 offset:27648
    buffer_load_dwordx4 a[172:175], v2, s[4:7], s60 offen offset:3072 sc1
    v_mfma_f32_16x16x32_bf16 v[108:111], v[28:31], a[20:23], v[108:111]
    v_mfma_f32_16x16x32_bf16 v[116:119], v[28:31], a[24:27], v[116:119]
    v_mfma_f32_16x16x32_bf16 v[124:127], v[28:31], a[28:31], v[124:127]
    s_waitcnt lgkmcnt(3)
    v_mfma_f32_16x16x32_bf16 v[128:131], v[8:11], a[16:19], v[128:131]
    ds_read_b128 v[24:27], v4 offset:28672
    s_add_u32 s60, s57, 49152
    v_mfma_f32_16x16x32_bf16 v[136:139], v[8:11], a[20:23], v[136:139]
    buffer_load_dwordx4 a[176:179], v2, s[4:7], s60 offen offset:0 sc1
    buffer_load_dwordx4 a[180:183], v2, s[4:7], s60 offen offset:1024 sc1
    v_mfma_f32_16x16x32_bf16 v[144:147], v[8:11], a[24:27], v[144:147]
    buffer_load_dwordx4 a[184:187], v2, s[4:7], s60 offen offset:2048 sc1
    buffer_load_dwordx4 a[188:191], v2, s[4:7], s60 offen offset:3072 sc1
    v_mfma_f32_16x16x32_bf16 v[152:155], v[8:11], a[28:31], v[152:155]
    s_waitcnt lgkmcnt(3)
    v_mfma_f32_16x16x32_bf16 v[132:135], v[12:15], a[16:19], v[132:135]
    ds_read_b128 v[28:31], v4 offset:29696
    v_mfma_f32_16x16x32_bf16 v[140:143], v[12:15], a[20:23], v[140:143]
    v_mfma_f32_16x16x32_bf16 v[148:151], v[12:15], a[24:27], v[148:151]
    s_add_u32 s60, s58, 49152
    buffer_load_dwordx4 a[192:195], v2, s[4:7], s60 offen offset:0 sc1
    v_mfma_f32_16x16x32_bf16 v[156:159], v[12:15], a[28:31], v[156:159]
    buffer_load_dwordx4 a[196:199], v2, s[4:7], s60 offen offset:1024 sc1
    buffer_load_dwordx4 a[200:203], v2, s[4:7], s60 offen offset:2048 sc1
    s_waitcnt lgkmcnt(3)
    v_mfma_f32_16x16x32_bf16 v[160:163], v[16:19], a[16:19], v[160:163]
    ds_read_b128 v[8:11], v4 offset:30720
    buffer_load_dwordx4 a[204:207], v2, s[4:7], s60 offen offset:3072 sc1
    v_mfma_f32_16x16x32_bf16 v[164:167], v[16:19], a[20:23], v[164:167]
    v_mfma_f32_16x16x32_bf16 v[168:171], v[16:19], a[24:27], v[168:171]
    v_mfma_f32_16x16x32_bf16 v[172:175], v[16:19], a[28:31], v[172:175]
    s_waitcnt lgkmcnt(3)
    v_mfma_f32_16x16x32_bf16 v[32:35], v[20:23], a[32:35], v[32:35]
    ds_read_b128 v[12:15], v4 offset:31744
    v_mfma_f32_16x16x32_bf16 v[40:43], v[20:23], a[36:39], v[40:43]
    v_mfma_f32_16x16x32_bf16 v[48:51], v[20:23], a[40:43], v[48:51]
    v_mfma_f32_16x16x32_bf16 v[56:59], v[20:23], a[44:47], v[56:59]
    s_waitcnt lgkmcnt(3)
    v_mfma_f32_16x16x32_bf16 v[36:39], v[24:27], a[32:35], v[36:39]
    ds_read_b128 v[16:19], v4 offset:32768
    v_mfma_f32_16x16x32_bf16 v[44:47], v[24:27], a[36:39], v[44:47]
    v_mfma_f32_16x16x32_bf16 v[52:55], v[24:27], a[40:43], v[52:55]
    v_mfma_f32_16x16x32_bf16 v[60:63], v[24:27], a[44:47], v[60:63]
    s_waitcnt lgkmcnt(3)
    v_mfma_f32_16x16x32_bf16 v[64:67], v[28:31], a[32:35], v[64:67]
    ds_read_b128 v[20:23], v4 offset:33792
    v_mfma_f32_16x16x32_bf16 v[72:75], v[28:31], a[36:39], v[72:75]
    v_mfma_f32_16x16x32_bf16 v[80:83], v[28:31], a[40:43], v[80:83]
    v_mfma_f32_16x16x32_bf16 v[88:91], v[28:31], a[44:47], v[88:91]
    s_waitcnt lgkmcnt(3)
    v_mfma_f32_16x16x32_bf16 v[68:71], v[8:11], a[32:35], v[68:71]
    ds_read_b128 v[24:27], v4 offset:34816
    v_mfma_f32_16x16x32_bf16 v[76:79], v[8:11], a[36:39], v[76:79]
    v_mfma_f32_16x16x32_bf16 v[84:87], v[8:11], a[40:43], v[84:87]
    v_mfma_f32_16x16x32_bf16 v[92:95], v[8:11], a[44:47], v[92:95]
    s_waitcnt lgkmcnt(3)
    v_mfma_f32_16x16x32_bf16 v[96:99], v[12:15], a[32:35], v[96:99]
    ds_read_b128 v[28:31], v4 offset:35840
    v_mfma_f32_16x16x32_bf16 v[104:107], v[12:15], a[36:39], v[104:107]
    v_mfma_f32_16x16x32_bf16 v[112:115], v[12:15], a[40:43], v[112:115]
    v_mfma_f32_16x16x32_bf16 v[120:123], v[12:15], a[44:47], v[120:123]
    s_waitcnt lgkmcnt(3)
    v_mfma_f32_16x16x32_bf16 v[100:103], v[16:19], a[32:35], v[100:103]
    s_barrier
    v_mfma_f32_16x16x32_bf16 v[108:111], v[16:19], a[36:39], v[108:111]
    v_add_u32 v4, 0x9000, v4
    ds_read_b128 v[8:11], v4 offset:0
    v_mfma_f32_16x16x32_bf16 v[116:119], v[16:19], a[40:43], v[116:119]
    s_add_u32 m0, s63, 36864
    s_add_u32 s61, s62, 479232
    v_mfma_f32_16x16x32_bf16 v[124:127], v[16:19], a[44:47], v[124:127]
    buffer_load_dwordx4 v2, s[4:7], s61 offen offset:0 lds
    buffer_load_dwordx4 v2, s[4:7], s61 offen offset:1024 lds
    s_waitcnt lgkmcnt(3)
    v_mfma_f32_16x16x32_bf16 v[128:131], v[20:23], a[32:35], v[128:131]
    ds_read_b128 v[12:15], v4 offset:1024
    buffer_load_dwordx4 v2, s[4:7], s61 offen offset:2048 lds
    v_mfma_f32_16x16x32_bf16 v[136:139], v[20:23], a[36:39], v[136:139]
    buffer_load_dwordx4 v2, s[4:7], s61 offen offset:3072 lds
    s_add_u32 m0, s63, 40960
    v_mfma_f32_16x16x32_bf16 v[144:147], v[20:23], a[40:43], v[144:147]
    s_add_u32 s61, s62, 483328
    buffer_load_dwordx4 v2, s[4:7], s61 offen offset:0 lds
    v_mfma_f32_16x16x32_bf16 v[152:155], v[20:23], a[44:47], v[152:155]
    s_waitcnt lgkmcnt(3)
    v_mfma_f32_16x16x32_bf16 v[132:135], v[24:27], a[32:35], v[132:135]
    ds_read_b128 v[16:19], v4 offset:2048
    v_mfma_f32_16x16x32_bf16 v[140:143], v[24:27], a[36:39], v[140:143]
    v_mfma_f32_16x16x32_bf16 v[148:151], v[24:27], a[40:43], v[148:151]
    v_mfma_f32_16x16x32_bf16 v[156:159], v[24:27], a[44:47], v[156:159]
    s_waitcnt lgkmcnt(3)
    v_mfma_f32_16x16x32_bf16 v[160:163], v[28:31], a[32:35], v[160:163]
    ds_read_b128 v[20:23], v4 offset:3072
    v_mfma_f32_16x16x32_bf16 v[164:167], v[28:31], a[36:39], v[164:167]
    v_mfma_f32_16x16x32_bf16 v[168:171], v[28:31], a[40:43], v[168:171]
    v_mfma_f32_16x16x32_bf16 v[172:175], v[28:31], a[44:47], v[172:175]
    s_waitcnt lgkmcnt(3)
    v_mfma_f32_16x16x32_bf16 v[32:35], v[8:11], a[48:51], v[32:35]
    ds_read_b128 v[24:27], v4 offset:4096
    v_mfma_f32_16x16x32_bf16 v[40:43], v[8:11], a[52:55], v[40:43]
    v_mfma_f32_16x16x32_bf16 v[48:51], v[8:11], a[56:59], v[48:51]
    v_mfma_f32_16x16x32_bf16 v[56:59], v[8:11], a[60:63], v[56:59]
    s_waitcnt lgkmcnt(3)
    v_mfma_f32_16x16x32_bf16 v[36:39], v[12:15], a[48:51], v[36:39]
    ds_read_b128 v[28:31], v4 offset:5120
    v_mfma_f32_16x16x32_bf16 v[44:47], v[12:15], a[52:55], v[44:47]
    v_mfma_f32_16x16x32_bf16 v[52:55], v[12:15], a[56:59], v[52:55]
    v_mfma_f32_16x16x32_bf16 v[60:63], v[12:15], a[60:63], v[60:63]
    s_waitcnt lgkmcnt(3)
    v_mfma_f32_16x16x32_bf16 v[64:67], v[16:19], a[48:51], v[64:67]
    ds_read_b128 v[8:11], v4 offset:6144
    v_mfma_f32_16x16x32_bf16 v[72:75], v[16:19], a[52:55], v[72:75]
    v_mfma_f32_16x16x32_bf16 v[80:83], v[16:19], a[56:59], v[80:83]
    v_mfma_f32_16x16x32_bf16 v[88:91], v[16:19], a[60:63], v[88:91]
    s_waitcnt lgkmcnt(3)
    v_mfma_f32_16x16x32_bf16 v[68:71], v[20:23], a[48:51], v[68:71]
    ds_read_b128 v[12:15], v4 offset:7168
    v_mfma_f32_16x16x32_bf16 v[76:79], v[20:23], a[52:55], v[76:79]
    v_mfma_f32_16x16x32_bf16 v[84:87], v[20:23], a[56:59], v[84:87]
    v_mfma_f32_16x16x32_bf16 v[92:95], v[20:23], a[60:63], v[92:95]
    s_waitcnt lgkmcnt(3)
    v_mfma_f32_16x16x32_bf16 v[96:99], v[24:27], a[48:51], v[96:99]
    ds_read_b128 v[16:19], v4 offset:8192
    v_mfma_f32_16x16x32_bf16 v[104:107], v[24:27], a[52:55], v[104:107]
    v_mfma_f32_16x16x32_bf16 v[112:115], v[24:27], a[56:59], v[112:115]
    v_mfma_f32_16x16x32_bf16 v[120:123], v[24:27], a[60:63], v[120:123]
    s_waitcnt lgkmcnt(3)
    v_mfma_f32_16x16x32_bf16 v[100:103], v[28:31], a[48:51], v[100:103]
    ds_read_b128 v[20:23], v4 offset:9216
    v_mfma_f32_16x16x32_bf16 v[108:111], v[28:31], a[52:55], v[108:111]
    v_mfma_f32_16x16x32_bf16 v[116:119], v[28:31], a[56:59], v[116:119]
    v_mfma_f32_16x16x32_bf16 v[124:127], v[28:31], a[60:63], v[124:127]
    s_waitcnt lgkmcnt(3)
    v_mfma_f32_16x16x32_bf16 v[128:131], v[8:11], a[48:51], v[128:131]
    ds_read_b128 v[24:27], v4 offset:10240
    v_mfma_f32_16x16x32_bf16 v[136:139], v[8:11], a[52:55], v[136:139]
    v_mfma_f32_16x16x32_bf16 v[144:147], v[8:11], a[56:59], v[144:147]
    v_mfma_f32_16x16x32_bf16 v[152:155], v[8:11], a[60:63], v[152:155]
    s_waitcnt lgkmcnt(3)
    v_mfma_f32_16x16x32_bf16 v[132:135], v[12:15], a[48:51], v[132:135]
    ds_read_b128 v[28:31], v4 offset:11264
    v_mfma_f32_16x16x32_bf16 v[140:143], v[12:15], a[52:55], v[140:143]
    v_mfma_f32_16x16x32_bf16 v[148:151], v[12:15], a[56:59], v[148:151]
    v_mfma_f32_16x16x32_bf16 v[156:159], v[12:15], a[60:63], v[156:159]
    s_waitcnt lgkmcnt(3)
    v_mfma_f32_16x16x32_bf16 v[160:163], v[16:19], a[48:51], v[160:163]
    ds_read_b128 v[8:11], v4 offset:12288
    v_mfma_f32_16x16x32_bf16 v[164:167], v[16:19], a[52:55], v[164:167]
    v_mfma_f32_16x16x32_bf16 v[168:171], v[16:19], a[56:59], v[168:171]
    v_mfma_f32_16x16x32_bf16 v[172:175], v[16:19], a[60:63], v[172:175]
    s_waitcnt lgkmcnt(3)
    v_mfma_f32_16x16x32_bf16 v[32:35], v[20:23], a[64:67], v[32:35]
    ds_read_b128 v[12:15], v4 offset:13312
    v_mfma_f32_16x16x32_bf16 v[40:43], v[20:23], a[68:71], v[40:43]
    v_mfma_f32_16x16x32_bf16 v[48:51], v[20:23], a[72:75], v[48:51]
    v_mfma_f32_16x16x32_bf16 v[56:59], v[20:23], a[76:79], v[56:59]
    s_waitcnt lgkmcnt(3)
    v_mfma_f32_16x16x32_bf16 v[36:39], v[24:27], a[64:67], v[36:39]
    ds_read_b128 v[16:19], v4 offset:14336
    v_mfma_f32_16x16x32_bf16 v[44:47], v[24:27], a[68:71], v[44:47]
    v_mfma_f32_16x16x32_bf16 v[52:55], v[24:27], a[72:75], v[52:55]
    v_mfma_f32_16x16x32_bf16 v[60:63], v[24:27], a[76:79], v[60:63]
    s_waitcnt lgkmcnt(3)
    v_mfma_f32_16x16x32_bf16 v[32:35], v[28:31], a[80:83], v[32:35]
    ds_read_b128 v[20:23], v4 offset:15360
    v_mfma_f32_16x16x32_bf16 v[40:43], v[28:31], a[84:87], v[40:43]
    v_mfma_f32_16x16x32_bf16 v[48:51], v[28:31], a[88:91], v[48:51]
    v_mfma_f32_16x16x32_bf16 v[56:59], v[28:31], a[92:95], v[56:59]
    s_waitcnt lgkmcnt(3)
    v_mfma_f32_16x16x32_bf16 v[36:39], v[8:11], a[80:83], v[36:39]
    ds_read_b128 v[24:27], v4 offset:16384
    v_mfma_f32_16x16x32_bf16 v[44:47], v[8:11], a[84:87], v[44:47]
    v_mfma_f32_16x16x32_bf16 v[52:55], v[8:11], a[88:91], v[52:55]
    v_mfma_f32_16x16x32_bf16 v[60:63], v[8:11], a[92:95], v[60:63]
    s_waitcnt lgkmcnt(3)
    v_mfma_f32_16x16x32_bf16 v[32:35], v[12:15], a[96:99], v[32:35]
    ds_read_b128 v[28:31], v4 offset:17408
    v_mfma_f32_16x16x32_bf16 v[40:43], v[12:15], a[100:103], v[40:43]
    v_mfma_f32_16x16x32_bf16 v[48:51], v[12:15], a[104:107], v[48:51]
    v_mfma_f32_16x16x32_bf16 v[56:59], v[12:15], a[108:111], v[56:59]
    s_waitcnt lgkmcnt(3)
    v_mfma_f32_16x16x32_bf16 v[36:39], v[16:19], a[96:99], v[36:39]
    ds_read_b128 v[8:11], v4 offset:18432
    v_mfma_f32_16x16x32_bf16 v[44:47], v[16:19], a[100:103], v[44:47]
    v_mfma_f32_16x16x32_bf16 v[52:55], v[16:19], a[104:107], v[52:55]
    v_mfma_f32_16x16x32_bf16 v[60:63], v[16:19], a[108:111], v[60:63]
    s_waitcnt vmcnt(28) lgkmcnt(3)
    v_mfma_f32_16x16x32_bf16 v[32:35], v[20:23], a[112:115], v[32:35]
    ds_read_b128 v[12:15], v4 offset:19456
    s_waitcnt vmcnt(27)
    v_mfma_f32_16x16x32_bf16 v[40:43], v[20:23], a[116:119], v[40:43]
    s_waitcnt vmcnt(26)
    v_mfma_f32_16x16x32_bf16 v[48:51], v[20:23], a[120:123], v[48:51]
    s_waitcnt vmcnt(25)
    v_mfma_f32_16x16x32_bf16 v[56:59], v[20:23], a[124:127], v[56:59]
    s_waitcnt lgkmcnt(3)
    v_mfma_f32_16x16x32_bf16 v[36:39], v[24:27], a[112:115], v[36:39]
    ds_read_b128 v[16:19], v4 offset:20480
    v_mfma_f32_16x16x32_bf16 v[44:47], v[24:27], a[116:119], v[44:47]
    v_mfma_f32_16x16x32_bf16 v[52:55], v[24:27], a[120:123], v[52:55]
    v_mfma_f32_16x16x32_bf16 v[60:63], v[24:27], a[124:127], v[60:63]
    s_waitcnt vmcnt(24) lgkmcnt(3)
    v_mfma_f32_16x16x32_bf16 v[32:35], v[28:31], a[128:131], v[32:35]
    ds_read_b128 v[20:23], v4 offset:21504
    s_waitcnt vmcnt(23)
    v_mfma_f32_16x16x32_bf16 v[40:43], v[28:31], a[132:135], v[40:43]
    s_waitcnt vmcnt(22)
    v_mfma_f32_16x16x32_bf16 v[48:51], v[28:31], a[136:139], v[48:51]
    s_waitcnt vmcnt(21)
    v_mfma_f32_16x16x32_bf16 v[56:59], v[28:31], a[140:143], v[56:59]
    s_waitcnt lgkmcnt(3)
    v_mfma_f32_16x16x32_bf16 v[36:39], v[8:11], a[128:131], v[36:39]
    ds_read_b128 v[24:27], v4 offset:22528
    v_mfma_f32_16x16x32_bf16 v[44:47], v[8:11], a[132:135], v[44:47]
    v_mfma_f32_16x16x32_bf16 v[52:55], v[8:11], a[136:139], v[52:55]
    v_mfma_f32_16x16x32_bf16 v[60:63], v[8:11], a[140:143], v[60:63]
    s_waitcnt vmcnt(20) lgkmcnt(3)
    v_mfma_f32_16x16x32_bf16 v[32:35], v[12:15], a[144:147], v[32:35]
    ds_read_b128 v[28:31], v4 offset:23552
    s_waitcnt vmcnt(19)
    v_mfma_f32_16x16x32_bf16 v[40:43], v[12:15], a[148:151], v[40:43]
    s_waitcnt vmcnt(18)
    v_mfma_f32_16x16x32_bf16 v[48:51], v[12:15], a[152:155], v[48:51]
    s_waitcnt vmcnt(17)
    v_mfma_f32_16x16x32_bf16 v[56:59], v[12:15], a[156:159], v[56:59]
    s_waitcnt lgkmcnt(3)
    v_mfma_f32_16x16x32_bf16 v[36:39], v[16:19], a[144:147], v[36:39]
    ds_read_b128 v[8:11], v4 offset:24576
    v_mfma_f32_16x16x32_bf16 v[44:47], v[16:19], a[148:151], v[44:47]
    v_mfma_f32_16x16x32_bf16 v[52:55], v[16:19], a[152:155], v[52:55]
    v_mfma_f32_16x16x32_bf16 v[60:63], v[16:19], a[156:159], v[60:63]
    s_waitcnt vmcnt(16) lgkmcnt(3)
    v_mfma_f32_16x16x32_bf16 v[32:35], v[20:23], a[160:163], v[32:35]
    ds_read_b128 v[12:15], v4 offset:25600
    s_waitcnt vmcnt(15)
    v_mfma_f32_16x16x32_bf16 v[40:43], v[20:23], a[164:167], v[40:43]
    s_waitcnt vmcnt(14)
    v_mfma_f32_16x16x32_bf16 v[48:51], v[20:23], a[168:171], v[48:51]
    s_waitcnt vmcnt(13)
    v_mfma_f32_16x16x32_bf16 v[56:59], v[20:23], a[172:175], v[56:59]
    s_waitcnt lgkmcnt(3)
    v_mfma_f32_16x16x32_bf16 v[36:39], v[24:27], a[160:163], v[36:39]
    ds_read_b128 v[16:19], v4 offset:26624
    v_mfma_f32_16x16x32_bf16 v[44:47], v[24:27], a[164:167], v[44:47]
    v_mfma_f32_16x16x32_bf16 v[52:55], v[24:27], a[168:171], v[52:55]
    v_mfma_f32_16x16x32_bf16 v[60:63], v[24:27], a[172:175], v[60:63]
    s_waitcnt vmcnt(12) lgkmcnt(3)
    v_mfma_f32_16x16x32_bf16 v[32:35], v[28:31], a[176:179], v[32:35]
    ds_read_b128 v[20:23], v4 offset:27648
    s_waitcnt vmcnt(11)
    v_mfma_f32_16x16x32_bf16 v[40:43], v[28:31], a[180:183], v[40:43]
    s_waitcnt vmcnt(10)
    v_mfma_f32_16x16x32_bf16 v[48:51], v[28:31], a[184:187], v[48:51]
    s_waitcnt vmcnt(9)
    v_mfma_f32_16x16x32_bf16 v[56:59], v[28:31], a[188:191], v[56:59]
    s_waitcnt lgkmcnt(3)
    v_mfma_f32_16x16x32_bf16 v[36:39], v[8:11], a[176:179], v[36:39]
    ds_read_b128 v[24:27], v4 offset:28672
    v_mfma_f32_16x16x32_bf16 v[44:47], v[8:11], a[180:183], v[44:47]
    v_mfma_f32_16x16x32_bf16 v[52:55], v[8:11], a[184:187], v[52:55]
    v_mfma_f32_16x16x32_bf16 v[60:63], v[8:11], a[188:191], v[60:63]
    s_waitcnt vmcnt(8) lgkmcnt(3)
    v_mfma_f32_16x16x32_bf16 v[32:35], v[12:15], a[192:195], v[32:35]
    ds_read_b128 v[28:31], v4 offset:29696
    s_waitcnt vmcnt(7)
    v_mfma_f32_16x16x32_bf16 v[40:43], v[12:15], a[196:199], v[40:43]
    s_waitcnt vmcnt(6)
    v_mfma_f32_16x16x32_bf16 v[48:51], v[12:15], a[200:203], v[48:51]
    s_waitcnt vmcnt(5)
    v_mfma_f32_16x16x32_bf16 v[56:59], v[12:15], a[204:207], v[56:59]
    s_waitcnt lgkmcnt(3)
    v_mfma_f32_16x16x32_bf16 v[36:39], v[16:19], a[192:195], v[36:39]
    ds_read_b128 v[8:11], v4 offset:30720
    v_mfma_f32_16x16x32_bf16 v[44:47], v[16:19], a[196:199], v[44:47]
    v_mfma_f32_16x16x32_bf16 v[52:55], v[16:19], a[200:203], v[52:55]
    v_mfma_f32_16x16x32_bf16 v[60:63], v[16:19], a[204:207], v[60:63]
    s_waitcnt lgkmcnt(3)
    v_mfma_f32_16x16x32_bf16 v[64:67], v[20:23], a[64:67], v[64:67]
    ds_read_b128 v[12:15], v4 offset:31744
    v_mfma_f32_16x16x32_bf16 v[72:75], v[20:23], a[68:71], v[72:75]
    v_mfma_f32_16x16x32_bf16 v[80:83], v[20:23], a[72:75], v[80:83]
    v_mfma_f32_16x16x32_bf16 v[88:91], v[20:23], a[76:79], v[88:91]
    v_cvt_pk_bf16_f32 v32, v32, v33
    v_cvt_pk_bf16_f32 v33, v34, v35
    s_waitcnt lgkmcnt(3)
    v_mfma_f32_16x16x32_bf16 v[68:71], v[24:27], a[64:67], v[68:71]
    ds_read_b128 v[16:19], v4 offset:32768
    v_cvt_pk_bf16_f32 v34, v36, v37
    v_mfma_f32_16x16x32_bf16 v[76:79], v[24:27], a[68:71], v[76:79]
    v_cvt_pk_bf16_f32 v35, v38, v39
    s_add_u32 s70, s69, 0
    v_mfma_f32_16x16x32_bf16 v[84:87], v[24:27], a[72:75], v[84:87]
    buffer_store_dwordx4 v[32:35], v2, s[4:7], s70 offen sc1
    v_cvt_pk_bf16_f32 v40, v40, v41
    v_mfma_f32_16x16x32_bf16 v[92:95], v[24:27], a[76:79], v[92:95]
    v_cvt_pk_bf16_f32 v41, v42, v43
    v_cvt_pk_bf16_f32 v42, v44, v45
    s_waitcnt lgkmcnt(3)
    v_mfma_f32_16x16x32_bf16 v[64:67], v[28:31], a[80:83], v[64:67]
    ds_read_b128 v[20:23], v4 offset:33792
    v_cvt_pk_bf16_f32 v43, v46, v47
    v_mfma_f32_16x16x32_bf16 v[72:75], v[28:31], a[84:87], v[72:75]
    s_add_u32 s70, s69, 18432
    buffer_store_dwordx4 v[40:43], v2, s[4:7], s70 offen sc1
    v_mfma_f32_16x16x32_bf16 v[80:83], v[28:31], a[88:91], v[80:83]
    v_cvt_pk_bf16_f32 v48, v48, v49
    v_cvt_pk_bf16_f32 v49, v50, v51
    v_mfma_f32_16x16x32_bf16 v[88:91], v[28:31], a[92:95], v[88:91]
    v_cvt_pk_bf16_f32 v50, v52, v53
    v_cvt_pk_bf16_f32 v51, v54, v55
    s_waitcnt lgkmcnt(3)
    v_mfma_f32_16x16x32_bf16 v[68:71], v[8:11], a[80:83], v[68:71]
    ds_read_b128 v[24:27], v4 offset:34816
    s_add_u32 s70, s69, 36864
    v_mfma_f32_16x16x32_bf16 v[76:79], v[8:11], a[84:87], v[76:79]
    buffer_store_dwordx4 v[48:51], v2, s[4:7], s70 offen sc1
    v_cvt_pk_bf16_f32 v56, v56, v57
    v_mfma_f32_16x16x32_bf16 v[84:87], v[8:11], a[88:91], v[84:87]
    v_cvt_pk_bf16_f32 v57, v58, v59
    v_cvt_pk_bf16_f32 v58, v60, v61
    v_mfma_f32_16x16x32_bf16 v[92:95], v[8:11], a[92:95], v[92:95]
    v_cvt_pk_bf16_f32 v59, v62, v63
    s_add_u32 s70, s69, 55296
    s_waitcnt lgkmcnt(3)
    v_mfma_f32_16x16x32_bf16 v[64:67], v[12:15], a[96:99], v[64:67]
    ds_read_b128 v[28:31], v4 offset:35840
    buffer_store_dwordx4 v[56:59], v2, s[4:7], s70 offen sc1
    v_mfma_f32_16x16x32_bf16 v[72:75], v[12:15], a[100:103], v[72:75]
    v_mfma_f32_16x16x32_bf16 v[80:83], v[12:15], a[104:107], v[80:83]
    v_mfma_f32_16x16x32_bf16 v[88:91], v[12:15], a[108:111], v[88:91]
    s_waitcnt lgkmcnt(3)
    v_mfma_f32_16x16x32_bf16 v[68:71], v[16:19], a[96:99], v[68:71]
    s_barrier
    v_mfma_f32_16x16x32_bf16 v[76:79], v[16:19], a[100:103], v[76:79]
    v_add_u32 v4, 0xfffe5000, v4
    ds_read_b128 v[8:11], v4 offset:0
    v_mfma_f32_16x16x32_bf16 v[84:87], v[16:19], a[104:107], v[84:87]
    v_mfma_f32_16x16x32_bf16 v[92:95], v[16:19], a[108:111], v[92:95]
    s_waitcnt lgkmcnt(3)
    v_mfma_f32_16x16x32_bf16 v[64:67], v[20:23], a[112:115], v[64:67]
    ds_read_b128 v[12:15], v4 offset:1024
    v_mfma_f32_16x16x32_bf16 v[72:75], v[20:23], a[116:119], v[72:75]
    v_mfma_f32_16x16x32_bf16 v[80:83], v[20:23], a[120:123], v[80:83]
    v_mfma_f32_16x16x32_bf16 v[88:91], v[20:23], a[124:127], v[88:91]
    s_waitcnt lgkmcnt(3)
    v_mfma_f32_16x16x32_bf16 v[68:71], v[24:27], a[112:115], v[68:71]
    ds_read_b128 v[16:19], v4 offset:2048
    v_mfma_f32_16x16x32_bf16 v[76:79], v[24:27], a[116:119], v[76:79]
    v_mfma_f32_16x16x32_bf16 v[84:87], v[24:27], a[120:123], v[84:87]
    v_mfma_f32_16x16x32_bf16 v[92:95], v[24:27], a[124:127], v[92:95]
    s_waitcnt lgkmcnt(3)
    v_mfma_f32_16x16x32_bf16 v[64:67], v[28:31], a[128:131], v[64:67]
    ds_read_b128 v[20:23], v4 offset:3072
    v_mfma_f32_16x16x32_bf16 v[72:75], v[28:31], a[132:135], v[72:75]
    v_mfma_f32_16x16x32_bf16 v[80:83], v[28:31], a[136:139], v[80:83]
    v_mfma_f32_16x16x32_bf16 v[88:91], v[28:31], a[140:143], v[88:91]
    s_waitcnt lgkmcnt(3)
    v_mfma_f32_16x16x32_bf16 v[68:71], v[8:11], a[128:131], v[68:71]
    ds_read_b128 v[24:27], v4 offset:4096
    v_mfma_f32_16x16x32_bf16 v[76:79], v[8:11], a[132:135], v[76:79]
    v_mfma_f32_16x16x32_bf16 v[84:87], v[8:11], a[136:139], v[84:87]
    v_mfma_f32_16x16x32_bf16 v[92:95], v[8:11], a[140:143], v[92:95]
    s_waitcnt lgkmcnt(3)
    v_mfma_f32_16x16x32_bf16 v[64:67], v[12:15], a[144:147], v[64:67]
    ds_read_b128 v[28:31], v4 offset:5120
    v_mfma_f32_16x16x32_bf16 v[72:75], v[12:15], a[148:151], v[72:75]
    v_mfma_f32_16x16x32_bf16 v[80:83], v[12:15], a[152:155], v[80:83]
    v_mfma_f32_16x16x32_bf16 v[88:91], v[12:15], a[156:159], v[88:91]
    s_waitcnt lgkmcnt(3)
    v_mfma_f32_16x16x32_bf16 v[68:71], v[16:19], a[144:147], v[68:71]
    ds_read_b128 v[8:11], v4 offset:6144
    v_mfma_f32_16x16x32_bf16 v[76:79], v[16:19], a[148:151], v[76:79]
    v_mfma_f32_16x16x32_bf16 v[84:87], v[16:19], a[152:155], v[84:87]
    v_mfma_f32_16x16x32_bf16 v[92:95], v[16:19], a[156:159], v[92:95]
    s_waitcnt lgkmcnt(3)
    v_mfma_f32_16x16x32_bf16 v[64:67], v[20:23], a[160:163], v[64:67]
    ds_read_b128 v[12:15], v4 offset:7168
    v_mfma_f32_16x16x32_bf16 v[72:75], v[20:23], a[164:167], v[72:75]
    v_mfma_f32_16x16x32_bf16 v[80:83], v[20:23], a[168:171], v[80:83]
    v_mfma_f32_16x16x32_bf16 v[88:91], v[20:23], a[172:175], v[88:91]
    s_waitcnt lgkmcnt(3)
    v_mfma_f32_16x16x32_bf16 v[68:71], v[24:27], a[160:163], v[68:71]
    ds_read_b128 v[16:19], v4 offset:8192
    v_mfma_f32_16x16x32_bf16 v[76:79], v[24:27], a[164:167], v[76:79]
    v_mfma_f32_16x16x32_bf16 v[84:87], v[24:27], a[168:171], v[84:87]
    v_mfma_f32_16x16x32_bf16 v[92:95], v[24:27], a[172:175], v[92:95]
    s_waitcnt lgkmcnt(3)
    v_mfma_f32_16x16x32_bf16 v[64:67], v[28:31], a[176:179], v[64:67]
    ds_read_b128 v[20:23], v4 offset:9216
    v_mfma_f32_16x16x32_bf16 v[72:75], v[28:31], a[180:183], v[72:75]
    v_mfma_f32_16x16x32_bf16 v[80:83], v[28:31], a[184:187], v[80:83]
    v_mfma_f32_16x16x32_bf16 v[88:91], v[28:31], a[188:191], v[88:91]
    s_waitcnt lgkmcnt(3)
    v_mfma_f32_16x16x32_bf16 v[68:71], v[8:11], a[176:179], v[68:71]
    ds_read_b128 v[24:27], v4 offset:10240
    v_mfma_f32_16x16x32_bf16 v[76:79], v[8:11], a[180:183], v[76:79]
    v_mfma_f32_16x16x32_bf16 v[84:87], v[8:11], a[184:187], v[84:87]
    v_mfma_f32_16x16x32_bf16 v[92:95], v[8:11], a[188:191], v[92:95]
    s_waitcnt lgkmcnt(3)
    v_mfma_f32_16x16x32_bf16 v[64:67], v[12:15], a[192:195], v[64:67]
    ds_read_b128 v[28:31], v4 offset:11264
    v_mfma_f32_16x16x32_bf16 v[72:75], v[12:15], a[196:199], v[72:75]
    v_mfma_f32_16x16x32_bf16 v[80:83], v[12:15], a[200:203], v[80:83]
    v_mfma_f32_16x16x32_bf16 v[88:91], v[12:15], a[204:207], v[88:91]
    s_waitcnt lgkmcnt(3)
    v_mfma_f32_16x16x32_bf16 v[68:71], v[16:19], a[192:195], v[68:71]
    ds_read_b128 v[8:11], v4 offset:12288
    v_mfma_f32_16x16x32_bf16 v[76:79], v[16:19], a[196:199], v[76:79]
    v_mfma_f32_16x16x32_bf16 v[84:87], v[16:19], a[200:203], v[84:87]
    v_mfma_f32_16x16x32_bf16 v[92:95], v[16:19], a[204:207], v[92:95]
    s_waitcnt lgkmcnt(3)
    v_mfma_f32_16x16x32_bf16 v[96:99], v[20:23], a[64:67], v[96:99]
    ds_read_b128 v[12:15], v4 offset:13312
    v_mfma_f32_16x16x32_bf16 v[104:107], v[20:23], a[68:71], v[104:107]
    v_mfma_f32_16x16x32_bf16 v[112:115], v[20:23], a[72:75], v[112:115]
    v_mfma_f32_16x16x32_bf16 v[120:123], v[20:23], a[76:79], v[120:123]
    v_cvt_pk_bf16_f32 v64, v64, v65
    v_cvt_pk_bf16_f32 v65, v66, v67
    s_waitcnt lgkmcnt(3)
    v_mfma_f32_16x16x32_bf16 v[100:103], v[24:27], a[64:67], v[100:103]
    ds_read_b128 v[16:19], v4 offset:14336
    v_cvt_pk_bf16_f32 v66, v68, v69
    v_mfma_f32_16x16x32_bf16 v[108:111], v[24:27], a[68:71], v[108:111]
    v_cvt_pk_bf16_f32 v67, v70, v71
    s_add_u32 s70, s69, 1024
    v_mfma_f32_16x16x32_bf16 v[116:119], v[24:27], a[72:75], v[116:119]
    buffer_store_dwordx4 v[64:67], v2, s[4:7], s70 offen sc1
    v_cvt_pk_bf16_f32 v72, v72, v73
    v_mfma_f32_16x16x32_bf16 v[124:127], v[24:27], a[76:79], v[124:127]
    v_cvt_pk_bf16_f32 v73, v74, v75
    v_cvt_pk_bf16_f32 v74, v76, v77
    s_waitcnt lgkmcnt(3)
    v_mfma_f32_16x16x32_bf16 v[96:99], v[28:31], a[80:83], v[96:99]
    ds_read_b128 v[20:23], v4 offset:15360
    v_cvt_pk_bf16_f32 v75, v78, v79
    v_mfma_f32_16x16x32_bf16 v[104:107], v[28:31], a[84:87], v[104:107]
    s_add_u32 s70, s69, 19456
    buffer_store_dwordx4 v[72:75], v2, s[4:7], s70 offen sc1
    v_mfma_f32_16x16x32_bf16 v[112:115], v[28:31], a[88:91], v[112:115]
    v_cvt_pk_bf16_f32 v80, v80, v81
    v_cvt_pk_bf16_f32 v81, v82, v83
    v_mfma_f32_16x16x32_bf16 v[120:123], v[28:31], a[92:95], v[120:123]
    v_cvt_pk_bf16_f32 v82, v84, v85
    v_cvt_pk_bf16_f32 v83, v86, v87
    s_waitcnt lgkmcnt(3)
    v_mfma_f32_16x16x32_bf16 v[100:103], v[8:11], a[80:83], v[100:103]
    ds_read_b128 v[24:27], v4 offset:16384
    s_add_u32 s70, s69, 37888
    v_mfma_f32_16x16x32_bf16 v[108:111], v[8:11], a[84:87], v[108:111]
    buffer_store_dwordx4 v[80:83], v2, s[4:7], s70 offen sc1
    v_cvt_pk_bf16_f32 v88, v88, v89
    v_mfma_f32_16x16x32_bf16 v[116:119], v[8:11], a[88:91], v[116:119]
    v_cvt_pk_bf16_f32 v89, v90, v91
    v_cvt_pk_bf16_f32 v90, v92, v93
    v_mfma_f32_16x16x32_bf16 v[124:127], v[8:11], a[92:95], v[124:127]
    v_cvt_pk_bf16_f32 v91, v94, v95
    s_add_u32 s70, s69, 56320
    s_waitcnt lgkmcnt(3)
    v_mfma_f32_16x16x32_bf16 v[96:99], v[12:15], a[96:99], v[96:99]
    ds_read_b128 v[28:31], v4 offset:17408
    buffer_store_dwordx4 v[88:91], v2, s[4:7], s70 offen sc1
    v_mfma_f32_16x16x32_bf16 v[104:107], v[12:15], a[100:103], v[104:107]
    v_mfma_f32_16x16x32_bf16 v[112:115], v[12:15], a[104:107], v[112:115]
    v_mfma_f32_16x16x32_bf16 v[120:123], v[12:15], a[108:111], v[120:123]
    s_waitcnt lgkmcnt(3)
    v_mfma_f32_16x16x32_bf16 v[100:103], v[16:19], a[96:99], v[100:103]
    ds_read_b128 v[8:11], v4 offset:18432
    v_mfma_f32_16x16x32_bf16 v[108:111], v[16:19], a[100:103], v[108:111]
    v_mfma_f32_16x16x32_bf16 v[116:119], v[16:19], a[104:107], v[116:119]
    v_mfma_f32_16x16x32_bf16 v[124:127], v[16:19], a[108:111], v[124:127]
    s_waitcnt lgkmcnt(3)
    v_mfma_f32_16x16x32_bf16 v[96:99], v[20:23], a[112:115], v[96:99]
    ds_read_b128 v[12:15], v4 offset:19456
    v_mfma_f32_16x16x32_bf16 v[104:107], v[20:23], a[116:119], v[104:107]
    v_mfma_f32_16x16x32_bf16 v[112:115], v[20:23], a[120:123], v[112:115]
    v_mfma_f32_16x16x32_bf16 v[120:123], v[20:23], a[124:127], v[120:123]
    s_waitcnt lgkmcnt(3)
    v_mfma_f32_16x16x32_bf16 v[100:103], v[24:27], a[112:115], v[100:103]
    ds_read_b128 v[16:19], v4 offset:20480
    v_mfma_f32_16x16x32_bf16 v[108:111], v[24:27], a[116:119], v[108:111]
    v_mfma_f32_16x16x32_bf16 v[116:119], v[24:27], a[120:123], v[116:119]
    v_mfma_f32_16x16x32_bf16 v[124:127], v[24:27], a[124:127], v[124:127]
    s_waitcnt lgkmcnt(3)
    v_mfma_f32_16x16x32_bf16 v[96:99], v[28:31], a[128:131], v[96:99]
    ds_read_b128 v[20:23], v4 offset:21504
    v_mfma_f32_16x16x32_bf16 v[104:107], v[28:31], a[132:135], v[104:107]
    v_mfma_f32_16x16x32_bf16 v[112:115], v[28:31], a[136:139], v[112:115]
    v_mfma_f32_16x16x32_bf16 v[120:123], v[28:31], a[140:143], v[120:123]
    s_waitcnt lgkmcnt(3)
    v_mfma_f32_16x16x32_bf16 v[100:103], v[8:11], a[128:131], v[100:103]
    ds_read_b128 v[24:27], v4 offset:22528
    v_mfma_f32_16x16x32_bf16 v[108:111], v[8:11], a[132:135], v[108:111]
    v_mfma_f32_16x16x32_bf16 v[116:119], v[8:11], a[136:139], v[116:119]
    v_mfma_f32_16x16x32_bf16 v[124:127], v[8:11], a[140:143], v[124:127]
    s_waitcnt lgkmcnt(3)
    v_mfma_f32_16x16x32_bf16 v[96:99], v[12:15], a[144:147], v[96:99]
    ds_read_b128 v[28:31], v4 offset:23552
    v_mfma_f32_16x16x32_bf16 v[104:107], v[12:15], a[148:151], v[104:107]
    v_mfma_f32_16x16x32_bf16 v[112:115], v[12:15], a[152:155], v[112:115]
    v_mfma_f32_16x16x32_bf16 v[120:123], v[12:15], a[156:159], v[120:123]
    s_waitcnt lgkmcnt(3)
    v_mfma_f32_16x16x32_bf16 v[100:103], v[16:19], a[144:147], v[100:103]
    ds_read_b128 v[8:11], v4 offset:24576
    v_mfma_f32_16x16x32_bf16 v[108:111], v[16:19], a[148:151], v[108:111]
    v_mfma_f32_16x16x32_bf16 v[116:119], v[16:19], a[152:155], v[116:119]
    v_mfma_f32_16x16x32_bf16 v[124:127], v[16:19], a[156:159], v[124:127]
    s_waitcnt lgkmcnt(3)
    v_mfma_f32_16x16x32_bf16 v[96:99], v[20:23], a[160:163], v[96:99]
    ds_read_b128 v[12:15], v4 offset:25600
    v_mfma_f32_16x16x32_bf16 v[104:107], v[20:23], a[164:167], v[104:107]
    v_mfma_f32_16x16x32_bf16 v[112:115], v[20:23], a[168:171], v[112:115]
    v_mfma_f32_16x16x32_bf16 v[120:123], v[20:23], a[172:175], v[120:123]
    s_waitcnt lgkmcnt(3)
    v_mfma_f32_16x16x32_bf16 v[100:103], v[24:27], a[160:163], v[100:103]
    ds_read_b128 v[16:19], v4 offset:26624
    v_mfma_f32_16x16x32_bf16 v[108:111], v[24:27], a[164:167], v[108:111]
    v_mfma_f32_16x16x32_bf16 v[116:119], v[24:27], a[168:171], v[116:119]
    v_mfma_f32_16x16x32_bf16 v[124:127], v[24:27], a[172:175], v[124:127]
    s_waitcnt lgkmcnt(3)
    v_mfma_f32_16x16x32_bf16 v[96:99], v[28:31], a[176:179], v[96:99]
    ds_read_b128 v[20:23], v4 offset:27648
    v_mfma_f32_16x16x32_bf16 v[104:107], v[28:31], a[180:183], v[104:107]
    v_mfma_f32_16x16x32_bf16 v[112:115], v[28:31], a[184:187], v[112:115]
    v_mfma_f32_16x16x32_bf16 v[120:123], v[28:31], a[188:191], v[120:123]
    s_waitcnt lgkmcnt(3)
    v_mfma_f32_16x16x32_bf16 v[100:103], v[8:11], a[176:179], v[100:103]
    ds_read_b128 v[24:27], v4 offset:28672
    v_mfma_f32_16x16x32_bf16 v[108:111], v[8:11], a[180:183], v[108:111]
    v_mfma_f32_16x16x32_bf16 v[116:119], v[8:11], a[184:187], v[116:119]
    v_mfma_f32_16x16x32_bf16 v[124:127], v[8:11], a[188:191], v[124:127]
    s_waitcnt lgkmcnt(3)
    v_mfma_f32_16x16x32_bf16 v[96:99], v[12:15], a[192:195], v[96:99]
    ds_read_b128 v[28:31], v4 offset:29696
    v_mfma_f32_16x16x32_bf16 v[104:107], v[12:15], a[196:199], v[104:107]
    v_mfma_f32_16x16x32_bf16 v[112:115], v[12:15], a[200:203], v[112:115]
    v_mfma_f32_16x16x32_bf16 v[120:123], v[12:15], a[204:207], v[120:123]
    s_waitcnt lgkmcnt(3)
    v_mfma_f32_16x16x32_bf16 v[100:103], v[16:19], a[192:195], v[100:103]
    ds_read_b128 v[8:11], v4 offset:30720
    v_mfma_f32_16x16x32_bf16 v[108:111], v[16:19], a[196:199], v[108:111]
    v_mfma_f32_16x16x32_bf16 v[116:119], v[16:19], a[200:203], v[116:119]
    v_mfma_f32_16x16x32_bf16 v[124:127], v[16:19], a[204:207], v[124:127]
    s_waitcnt lgkmcnt(3)
    v_mfma_f32_16x16x32_bf16 v[128:131], v[20:23], a[64:67], v[128:131]
    ds_read_b128 v[12:15], v4 offset:31744
    v_mfma_f32_16x16x32_bf16 v[136:139], v[20:23], a[68:71], v[136:139]
    v_mfma_f32_16x16x32_bf16 v[144:147], v[20:23], a[72:75], v[144:147]
    v_mfma_f32_16x16x32_bf16 v[152:155], v[20:23], a[76:79], v[152:155]
    v_cvt_pk_bf16_f32 v96, v96, v97
    v_cvt_pk_bf16_f32 v97, v98, v99
    s_waitcnt lgkmcnt(3)
    v_mfma_f32_16x16x32_bf16 v[132:135], v[24:27], a[64:67], v[132:135]
    ds_read_b128 v[16:19], v4 offset:32768
    v_cvt_pk_bf16_f32 v98, v100, v101
    v_mfma_f32_16x16x32_bf16 v[140:143], v[24:27], a[68:71], v[140:143]
    v_cvt_pk_bf16_f32 v99, v102, v103
    s_add_u32 s70, s69, 2048
    v_mfma_f32_16x16x32_bf16 v[148:151], v[24:27], a[72:75], v[148:151]
    buffer_store_dwordx4 v[96:99], v2, s[4:7], s70 offen sc1
    v_cvt_pk_bf16_f32 v104, v104, v105
    v_mfma_f32_16x16x32_bf16 v[156:159], v[24:27], a[76:79], v[156:159]
    v_cvt_pk_bf16_f32 v105, v106, v107
    v_cvt_pk_bf16_f32 v106, v108, v109
    s_waitcnt lgkmcnt(3)
    v_mfma_f32_16x16x32_bf16 v[128:131], v[28:31], a[80:83], v[128:131]
    ds_read_b128 v[20:23], v4 offset:33792
    v_cvt_pk_bf16_f32 v107, v110, v111
    v_mfma_f32_16x16x32_bf16 v[136:139], v[28:31], a[84:87], v[136:139]
    s_add_u32 s70, s69, 20480
    buffer_store_dwordx4 v[104:107], v2, s[4:7], s70 offen sc1
    v_mfma_f32_16x16x32_bf16 v[144:147], v[28:31], a[88:91], v[144:147]
    v_cvt_pk_bf16_f32 v112, v112, v113
    v_cvt_pk_bf16_f32 v113, v114, v115
    v_mfma_f32_16x16x32_bf16 v[152:155], v[28:31], a[92:95], v[152:155]
    v_cvt_pk_bf16_f32 v114, v116, v117
    v_cvt_pk_bf16_f32 v115, v118, v119
    s_waitcnt lgkmcnt(3)
    v_mfma_f32_16x16x32_bf16 v[132:135], v[8:11], a[80:83], v[132:135]
    ds_read_b128 v[24:27], v4 offset:34816
    s_add_u32 s70, s69, 38912
    v_mfma_f32_16x16x32_bf16 v[140:143], v[8:11], a[84:87], v[140:143]
    buffer_store_dwordx4 v[112:115], v2, s[4:7], s70 offen sc1
    v_cvt_pk_bf16_f32 v120, v120, v121
    v_mfma_f32_16x16x32_bf16 v[148:151], v[8:11], a[88:91], v[148:151]
    v_cvt_pk_bf16_f32 v121, v122, v123
    v_cvt_pk_bf16_f32 v122, v124, v125
    v_mfma_f32_16x16x32_bf16 v[156:159], v[8:11], a[92:95], v[156:159]
    v_cvt_pk_bf16_f32 v123, v126, v127
    s_add_u32 s70, s69, 57344
    s_waitcnt lgkmcnt(3)
    v_mfma_f32_16x16x32_bf16 v[128:131], v[12:15], a[96:99], v[128:131]
    ds_read_b128 v[28:31], v4 offset:35840
    buffer_store_dwordx4 v[120:123], v2, s[4:7], s70 offen sc1
    v_mfma_f32_16x16x32_bf16 v[136:139], v[12:15], a[100:103], v[136:139]
    v_mfma_f32_16x16x32_bf16 v[144:147], v[12:15], a[104:107], v[144:147]
    v_mfma_f32_16x16x32_bf16 v[152:155], v[12:15], a[108:111], v[152:155]
    s_waitcnt lgkmcnt(3)
    v_mfma_f32_16x16x32_bf16 v[132:135], v[16:19], a[96:99], v[132:135]
    s_waitcnt vmcnt(12)
    s_barrier
    v_mfma_f32_16x16x32_bf16 v[140:143], v[16:19], a[100:103], v[140:143]
    v_add_u32 v4, 0x9000, v4
    ds_read_b128 v[8:11], v4 offset:0
    v_mfma_f32_16x16x32_bf16 v[148:151], v[16:19], a[104:107], v[148:151]
    v_mfma_f32_16x16x32_bf16 v[156:159], v[16:19], a[108:111], v[156:159]
    s_waitcnt lgkmcnt(3)
    v_mfma_f32_16x16x32_bf16 v[128:131], v[20:23], a[112:115], v[128:131]
    ds_read_b128 v[12:15], v4 offset:1024
    v_mfma_f32_16x16x32_bf16 v[136:139], v[20:23], a[116:119], v[136:139]
    v_mfma_f32_16x16x32_bf16 v[144:147], v[20:23], a[120:123], v[144:147]
    v_mfma_f32_16x16x32_bf16 v[152:155], v[20:23], a[124:127], v[152:155]
    s_waitcnt lgkmcnt(3)
    v_mfma_f32_16x16x32_bf16 v[132:135], v[24:27], a[112:115], v[132:135]
    ds_read_b128 v[16:19], v4 offset:2048
    v_mfma_f32_16x16x32_bf16 v[140:143], v[24:27], a[116:119], v[140:143]
    v_mfma_f32_16x16x32_bf16 v[148:151], v[24:27], a[120:123], v[148:151]
    v_mfma_f32_16x16x32_bf16 v[156:159], v[24:27], a[124:127], v[156:159]
    s_waitcnt lgkmcnt(3)
    v_mfma_f32_16x16x32_bf16 v[128:131], v[28:31], a[128:131], v[128:131]
    ds_read_b128 v[20:23], v4 offset:3072
    v_mfma_f32_16x16x32_bf16 v[136:139], v[28:31], a[132:135], v[136:139]
    v_mfma_f32_16x16x32_bf16 v[144:147], v[28:31], a[136:139], v[144:147]
    v_mfma_f32_16x16x32_bf16 v[152:155], v[28:31], a[140:143], v[152:155]
    s_waitcnt lgkmcnt(3)
    v_mfma_f32_16x16x32_bf16 v[132:135], v[8:11], a[128:131], v[132:135]
    ds_read_b128 v[24:27], v4 offset:4096
    v_mfma_f32_16x16x32_bf16 v[140:143], v[8:11], a[132:135], v[140:143]
    v_mfma_f32_16x16x32_bf16 v[148:151], v[8:11], a[136:139], v[148:151]
    v_mfma_f32_16x16x32_bf16 v[156:159], v[8:11], a[140:143], v[156:159]
    s_waitcnt lgkmcnt(3)
    v_mfma_f32_16x16x32_bf16 v[128:131], v[12:15], a[144:147], v[128:131]
    ds_read_b128 v[28:31], v4 offset:5120
    v_mfma_f32_16x16x32_bf16 v[136:139], v[12:15], a[148:151], v[136:139]
    v_mfma_f32_16x16x32_bf16 v[144:147], v[12:15], a[152:155], v[144:147]
    v_mfma_f32_16x16x32_bf16 v[152:155], v[12:15], a[156:159], v[152:155]
    s_waitcnt lgkmcnt(3)
    v_mfma_f32_16x16x32_bf16 v[132:135], v[16:19], a[144:147], v[132:135]
    ds_read_b128 v[8:11], v4 offset:6144
    v_mfma_f32_16x16x32_bf16 v[140:143], v[16:19], a[148:151], v[140:143]
    v_mfma_f32_16x16x32_bf16 v[148:151], v[16:19], a[152:155], v[148:151]
    v_mfma_f32_16x16x32_bf16 v[156:159], v[16:19], a[156:159], v[156:159]
    s_waitcnt lgkmcnt(3)
    v_mfma_f32_16x16x32_bf16 v[128:131], v[20:23], a[160:163], v[128:131]
    ds_read_b128 v[12:15], v4 offset:7168
    v_mfma_f32_16x16x32_bf16 v[136:139], v[20:23], a[164:167], v[136:139]
    v_mfma_f32_16x16x32_bf16 v[144:147], v[20:23], a[168:171], v[144:147]
    v_mfma_f32_16x16x32_bf16 v[152:155], v[20:23], a[172:175], v[152:155]
    s_waitcnt lgkmcnt(3)
    v_mfma_f32_16x16x32_bf16 v[132:135], v[24:27], a[160:163], v[132:135]
    ds_read_b128 v[16:19], v4 offset:8192
    v_mfma_f32_16x16x32_bf16 v[140:143], v[24:27], a[164:167], v[140:143]
    v_mfma_f32_16x16x32_bf16 v[148:151], v[24:27], a[168:171], v[148:151]
    v_mfma_f32_16x16x32_bf16 v[156:159], v[24:27], a[172:175], v[156:159]
    s_waitcnt lgkmcnt(3)
    v_mfma_f32_16x16x32_bf16 v[128:131], v[28:31], a[176:179], v[128:131]
    ds_read_b128 v[20:23], v4 offset:9216
    v_mfma_f32_16x16x32_bf16 v[136:139], v[28:31], a[180:183], v[136:139]
    v_mfma_f32_16x16x32_bf16 v[144:147], v[28:31], a[184:187], v[144:147]
    v_mfma_f32_16x16x32_bf16 v[152:155], v[28:31], a[188:191], v[152:155]
    s_waitcnt lgkmcnt(3)
    v_mfma_f32_16x16x32_bf16 v[132:135], v[8:11], a[176:179], v[132:135]
    ds_read_b128 v[24:27], v4 offset:10240
    v_mfma_f32_16x16x32_bf16 v[140:143], v[8:11], a[180:183], v[140:143]
    v_mfma_f32_16x16x32_bf16 v[148:151], v[8:11], a[184:187], v[148:151]
    v_mfma_f32_16x16x32_bf16 v[156:159], v[8:11], a[188:191], v[156:159]
    s_waitcnt lgkmcnt(3)
    v_mfma_f32_16x16x32_bf16 v[128:131], v[12:15], a[192:195], v[128:131]
    ds_read_b128 v[28:31], v4 offset:11264
    v_mfma_f32_16x16x32_bf16 v[136:139], v[12:15], a[196:199], v[136:139]
    v_mfma_f32_16x16x32_bf16 v[144:147], v[12:15], a[200:203], v[144:147]
    v_mfma_f32_16x16x32_bf16 v[152:155], v[12:15], a[204:207], v[152:155]
    s_waitcnt lgkmcnt(3)
    v_mfma_f32_16x16x32_bf16 v[132:135], v[16:19], a[192:195], v[132:135]
    ds_read_b128 v[8:11], v4 offset:12288
    v_mfma_f32_16x16x32_bf16 v[140:143], v[16:19], a[196:199], v[140:143]
    v_mfma_f32_16x16x32_bf16 v[148:151], v[16:19], a[200:203], v[148:151]
    v_mfma_f32_16x16x32_bf16 v[156:159], v[16:19], a[204:207], v[156:159]
    s_waitcnt lgkmcnt(3)
    v_mfma_f32_16x16x32_bf16 v[160:163], v[20:23], a[64:67], v[160:163]
    ds_read_b128 v[12:15], v4 offset:13312
    v_mfma_f32_16x16x32_bf16 v[164:167], v[20:23], a[68:71], v[164:167]
    v_mfma_f32_16x16x32_bf16 v[168:171], v[20:23], a[72:75], v[168:171]
    v_mfma_f32_16x16x32_bf16 v[172:175], v[20:23], a[76:79], v[172:175]
    v_cvt_pk_bf16_f32 v128, v128, v129
    v_cvt_pk_bf16_f32 v129, v130, v131
    s_waitcnt lgkmcnt(3)
    v_mfma_f32_16x16x32_bf16 v[160:163], v[24:27], a[80:83], v[160:163]
    ds_read_b128 v[16:19], v4 offset:14336
    v_cvt_pk_bf16_f32 v130, v132, v133
    v_mfma_f32_16x16x32_bf16 v[164:167], v[24:27], a[84:87], v[164:167]
    v_cvt_pk_bf16_f32 v131, v134, v135
    s_add_u32 s70, s69, 3072
    v_mfma_f32_16x16x32_bf16 v[168:171], v[24:27], a[88:91], v[168:171]
    buffer_store_dwordx4 v[128:131], v2, s[4:7], s70 offen sc1
    v_cvt_pk_bf16_f32 v136, v136, v137
    v_mfma_f32_16x16x32_bf16 v[172:175], v[24:27], a[92:95], v[172:175]
    v_cvt_pk_bf16_f32 v137, v138, v139
    v_cvt_pk_bf16_f32 v138, v140, v141
    s_waitcnt lgkmcnt(3)
    v_mfma_f32_16x16x32_bf16 v[160:163], v[28:31], a[96:99], v[160:163]
    ds_read_b128 v[20:23], v4 offset:15360
    v_cvt_pk_bf16_f32 v139, v142, v143
    v_mfma_f32_16x16x32_bf16 v[164:167], v[28:31], a[100:103], v[164:167]
    s_add_u32 s70, s69, 21504
    buffer_store_dwordx4 v[136:139], v2, s[4:7], s70 offen sc1
    v_mfma_f32_16x16x32_bf16 v[168:171], v[28:31], a[104:107], v[168:171]
    v_cvt_pk_bf16_f32 v144, v144, v145
    v_cvt_pk_bf16_f32 v145, v146, v147
    v_mfma_f32_16x16x32_bf16 v[172:175], v[28:31], a[108:111], v[172:175]
    v_cvt_pk_bf16_f32 v146, v148, v149
    v_cvt_pk_bf16_f32 v147, v150, v151
    s_waitcnt lgkmcnt(3)
    v_mfma_f32_16x16x32_bf16 v[160:163], v[8:11], a[112:115], v[160:163]
    ds_read_b128 v[24:27], v4 offset:16384
    s_add_u32 s70, s69, 39936
    v_mfma_f32_16x16x32_bf16 v[164:167], v[8:11], a[116:119], v[164:167]
    buffer_store_dwordx4 v[144:147], v2, s[4:7], s70 offen sc1
    v_cvt_pk_bf16_f32 v152, v152, v153
    v_mfma_f32_16x16x32_bf16 v[168:171], v[8:11], a[120:123], v[168:171]
    v_cvt_pk_bf16_f32 v153, v154, v155
    v_cvt_pk_bf16_f32 v154, v156, v157
    v_mfma_f32_16x16x32_bf16 v[172:175], v[8:11], a[124:127], v[172:175]
    v_cvt_pk_bf16_f32 v155, v158, v159
    s_add_u32 s70, s69, 58368
    s_waitcnt lgkmcnt(3)
    v_mfma_f32_16x16x32_bf16 v[160:163], v[12:15], a[128:131], v[160:163]
    ds_read_b128 v[28:31], v4 offset:17408
    buffer_store_dwordx4 v[152:155], v2, s[4:7], s70 offen sc1
    v_mfma_f32_16x16x32_bf16 v[164:167], v[12:15], a[132:135], v[164:167]
    v_mfma_f32_16x16x32_bf16 v[168:171], v[12:15], a[136:139], v[168:171]
    v_mfma_f32_16x16x32_bf16 v[172:175], v[12:15], a[140:143], v[172:175]
    s_waitcnt lgkmcnt(3)
    v_mfma_f32_16x16x32_bf16 v[160:163], v[16:19], a[144:147], v[160:163]
    v_mfma_f32_16x16x32_bf16 v[164:167], v[16:19], a[148:151], v[164:167]
    v_mfma_f32_16x16x32_bf16 v[168:171], v[16:19], a[152:155], v[168:171]
    v_mfma_f32_16x16x32_bf16 v[172:175], v[16:19], a[156:159], v[172:175]
    s_waitcnt lgkmcnt(2)
    v_mfma_f32_16x16x32_bf16 v[160:163], v[20:23], a[160:163], v[160:163]
    v_mfma_f32_16x16x32_bf16 v[164:167], v[20:23], a[164:167], v[164:167]
    v_mfma_f32_16x16x32_bf16 v[168:171], v[20:23], a[168:171], v[168:171]
    v_mfma_f32_16x16x32_bf16 v[172:175], v[20:23], a[172:175], v[172:175]
    s_waitcnt lgkmcnt(1)
    v_mfma_f32_16x16x32_bf16 v[160:163], v[24:27], a[176:179], v[160:163]
    v_mfma_f32_16x16x32_bf16 v[164:167], v[24:27], a[180:183], v[164:167]
    v_mfma_f32_16x16x32_bf16 v[168:171], v[24:27], a[184:187], v[168:171]
    v_mfma_f32_16x16x32_bf16 v[172:175], v[24:27], a[188:191], v[172:175]
    s_waitcnt lgkmcnt(0)
    v_mfma_f32_16x16x32_bf16 v[160:163], v[28:31], a[192:195], v[160:163]
    v_mfma_f32_16x16x32_bf16 v[164:167], v[28:31], a[196:199], v[164:167]
    v_mfma_f32_16x16x32_bf16 v[168:171], v[28:31], a[200:203], v[168:171]
    v_mfma_f32_16x16x32_bf16 v[172:175], v[28:31], a[204:207], v[172:175]
    s_nop 4
    v_cvt_pk_bf16_f32 v160, v160, v161
    v_cvt_pk_bf16_f32 v161, v162, v163
    s_add_u32 s70, s68, 4096
    buffer_store_dwordx2 v[160:161], v0, s[4:7], s70 offen sc1
    v_cvt_pk_bf16_f32 v164, v164, v165
    v_cvt_pk_bf16_f32 v165, v166, v167
    s_add_u32 s70, s68, 22528
    buffer_store_dwordx2 v[164:165], v0, s[4:7], s70 offen sc1
    v_cvt_pk_bf16_f32 v168, v168, v169
    v_cvt_pk_bf16_f32 v169, v170, v171
    s_add_u32 s70, s68, 40960
    buffer_store_dwordx2 v[168:169], v0, s[4:7], s70 offen sc1
    v_cvt_pk_bf16_f32 v172, v172, v173
    v_cvt_pk_bf16_f32 v173, v174, v175
    s_add_u32 s70, s68, 59392
    buffer_store_dwordx2 v[172:173], v0, s[4:7], s70 offen sc1
ffn0_kernel_end:
    s_endpgm
L_pa_slow_24:
    s_mov_b32 s64, 0x40000
L_spin_28:
    buffer_load_dword v6, v7, s[4:7], s52 offen sc1
    s_waitcnt vmcnt(0)
    v_cmp_le_u32 vcc, 1, v6
    s_sub_u32 s64, s64, 1
    s_cbranch_scc1 L_pa_back_25
    s_cmp_eq_u64 vcc, exec
    s_cbranch_scc1 L_pa_back_25
    s_branch L_spin_28
L_pb_slow_26:
    s_mov_b32 s64, 0x40000
L_spin_29:
    buffer_load_dword v6, v7, s[4:7], s52 offen sc1
    s_waitcnt vmcnt(0)
    v_cmp_le_u32 vcc, 2, v6
    s_sub_u32 s64, s64, 1
    s_cbranch_scc1 L_pb_back_27
    s_cmp_eq_u64 vcc, exec
    s_cbranch_scc1 L_pb_back_27
    s_branch L_spin_29
.section .rodata,"a"
.p2align 6
.amdhsa_kernel ffn0_kernel
  .amdhsa_next_free_vgpr 512
  .amdhsa_next_free_sgpr 102
  .amdhsa_accum_offset 256
  .amdhsa_group_segment_fixed_size 0
  .amdhsa_kernarg_size 80
  .amdhsa_user_sgpr_count 2
  .amdhsa_user_sgpr_kernarg_segment_ptr 1
  .amdhsa_system_sgpr_workgroup_id_x 1
  .amdhsa_float_denorm_mode_32 3
.end_amdhsa_kernel
.text
.globl red0_kernel
.p2align 8
.type red0_kernel,@function
red0_kernel:
    s_cmp_ge_u32 s2, 256
    s_cbranch_scc1 red0_kernel_end
    s_load_dwordx16 s[24:39], s[0:1], 0
    s_load_dwordx4 s[40:43], s[0:1], 64
    v_lshrrev_b32 v1, 6, v0
    s_and_b32 s21, s2, 7
    v_readfirstlane_b32 s20, v1
    s_lshr_b32 s22, s2, 3
    v_and_b32 v1, 63, v0
    v_lshlrev_b32 v2, 4, v1
    s_waitcnt lgkmcnt(0)
    s_mov_b32 s4, s42
    s_mov_b32 s5, s43
    s_mov_b32 s6, 0x10000000
    s_mov_b32 s7, 0x20000
    s_lshl_b32 s47, s21, 5
    s_add_u32 s47, s47, s22
    v_and_b32 v8, 7, v1
    v_lshrrev_b32 v9, 3, v1
    s_lshl_b32 s48, s47, 3
    v_add_u32 v3, s48, v8
    v_mul_u32_u24 v3, 1152, v3
    s_mul_i32 s48, s20, 384
    v_lshl_add_u32 v3, v9, 4, v3
    v_add_u32 v3, s48, v3
    s_lshr_b32 s48, s47, 1
    s_mul_i32 s48, s48, 18432
    s_and_b32 s49, s47, 1
    s_lshl_b32 s49, s49, 7
    s_add_u32 s48, s48, s49
    s_mul_i32 s49, s20, 6144
    s_add_u32 s48, s48, s49
    v_lshlrev_b32 v8, 4, v8
    v_lshl_add_u32 v8, v9, 8, v8
    v_add_u32 v4, s48, v8
    v_lshrrev_b32 v8, 3, v1
    v_and_b32 v9, 7, v1
    s_and_b32 s48, s47, 1
    s_lshl_b32 s48, s48, 3
    v_add_u32 v9, s48, v9
    v_lshlrev_b32 v9, 4, v9
    v_bfe_u32 v10, v8, 1, 1
    v_and_b32 v11, 1, v8
    v_lshl_add_u32 v9, v11, 4, v9
    v_lshl_add_u32 v9, v10, 9, v9
    v_and_b32 v10, 3, v8
    v_lshlrev_b32 v10, 8, v10
    v_sub_u32 v9, v9, v10
    s_mul_i32 s48, s20, 6
    v_lshrrev_b32 v8, 2, v8
    v_add_u32 v8, s48, v8
    v_add_u32 v10, 0, v8
    v_cmp_eq_u32 vcc, 4, v10
    v_cmp_eq_u32 s[56:57], 13, v10
    s_nop 0
    s_or_b64 vcc, vcc, s[56:57]
    v_cndmask_b32 v10, 0, v9, vcc
    v_add3_u32 v5, v4, v10, 0
    v_add_u32 v5, 0, v5
    v_add_u32 v10, 2, v8
    v_cmp_eq_u32 vcc, 4, v10
    v_cmp_eq_u32 s[56:57], 13, v10
    s_nop 0
    s_or_b64 vcc, vcc, s[56:57]
    v_cndmask_b32 v10, 0, v9, vcc
    v_add3_u32 v6, v4, v10, 0
    v_add_u32 v6, 2048, v6
    v_add_u32 v10, 4, v8
    v_cmp_eq_u32 vcc, 4, v10
    v_cmp_eq_u32 s[56:57], 13, v10
    s_nop 0
    s_or_b64 vcc, vcc, s[56:57]
    v_cndmask_b32 v10, 0, v9, vcc
    v_add3_u32 v7, v4, v10, 0
    v_add_u32 v7, 4096, v7
    s_cmp_eq_u32 s20, 3
    s_cbranch_scc1 L_w3a_30
    s_mov_b32 s48, 25690112
    buffer_load_dwordx4 v[16:19], v4, s[4:7], s48 offen offset:0
    buffer_load_dwordx4 v[52:55], v4, s[4:7], s48 offen offset:2048
    s_add_u32 s48, s48, 4096
    buffer_load_dwordx4 v[88:91], v4, s[4:7], s48 offen offset:0
    s_mov_b32 s48, 50331648
    buffer_load_dwordx4 v[20:23], v5, s[4:7], s48 offen
    buffer_load_dwordx4 v[56:59], v6, s[4:7], s48 offen
    buffer_load_dwordx4 v[92:95], v7, s[4:7], s48 offen
    s_mov_b32 s48, 52690944
    buffer_load_dwordx4 v[24:27], v5, s[4:7], s48 offen
    buffer_load_dwordx4 v[60:63], v6, s[4:7], s48 offen
    buffer_load_dwordx4 v[96:99], v7, s[4:7], s48 offen
    s_mov_b32 s48, 55050240
    buffer_load_dwordx4 v[28:31], v5, s[4:7], s48 offen
    buffer_load_dwordx4 v[64:67], v6, s[4:7], s48 offen
    buffer_load_dwordx4 v[100:103], v7, s[4:7], s48 offen
    s_mov_b32 s48, 57409536
    buffer_load_dwordx4 v[32:35], v5, s[4:7], s48 offen
    buffer_load_dwordx4 v[68:71], v6, s[4:7], s48 offen
    buffer_load_dwordx4 v[104:107], v7, s[4:7], s48 offen
    s_mov_b32 s48, 59768832
    buffer_load_dwordx4 v[36:39], v5, s[4:7], s48 offen
    buffer_load_dwordx4 v[72:75], v6, s[4:7], s48 offen
    buffer_load_dwordx4 v[108:111], v7, s[4:7], s48 offen
    s_mov_b32 s48, 62128128
    buffer_load_dwordx4 v[40:43], v5, s[4:7], s48 offen
    buffer_load_dwordx4 v[76:79], v6, s[4:7], s48 offen
    buffer_load_dwordx4 v[112:115], v7, s[4:7], s48 offen
    s_mov_b32 s48, 64487424
    buffer_load_dwordx4 v[44:47], v5, s[4:7], s48 offen
    buffer_load_dwordx4 v[80:83], v6, s[4:7], s48 offen
    buffer_load_dwordx4 v[116:119], v7, s[4:7], s48 offen
    s_mov_b32 s48, 66846720
    buffer_load_dwordx4 v[48:51], v5, s[4:7], s48 offen
    buffer_load_dwordx4 v[84:87], v6, s[4:7], s48 offen
    buffer_load_dwordx4 v[120:123], v7, s[4:7], s48 offen
    s_waitcnt vmcnt(26)
    v_lshlrev_b32 v128, 16, v16
    v_and_b32 v129, 0xffff0000, v16
    v_lshlrev_b32 v130, 16, v17
    v_and_b32 v131, 0xffff0000, v17
    v_lshlrev_b32 v132, 16, v18
    v_and_b32 v133, 0xffff0000, v18
    v_lshlrev_b32 v134, 16, v19
    v_and_b32 v135, 0xffff0000, v19
    s_waitcnt vmcnt(25)
    v_lshlrev_b32 v136, 16, v52
    v_and_b32 v137, 0xffff0000, v52
    v_lshlrev_b32 v138, 16, v53
    v_and_b32 v139, 0xffff0000, v53
    v_lshlrev_b32 v140, 16, v54
    v_and_b32 v141, 0xffff0000, v54
    v_lshlrev_b32 v142, 16, v55
    v_and_b32 v143, 0xffff0000, v55
    s_waitcnt vmcnt(24)
    v_lshlrev_b32 v144, 16, v88
    v_and_b32 v145, 0xffff0000, v88
    v_lshlrev_b32 v146, 16, v89
    v_and_b32 v147, 0xffff0000, v89
    v_lshlrev_b32 v148, 16, v90
    v_and_b32 v149, 0xffff0000, v90
    v_lshlrev_b32 v150, 16, v91
    v_and_b32 v151, 0xffff0000, v91
    s_waitcnt vmcnt(23)
    v_lshlrev_b32 v8, 16, v20
    v_and_b32 v9, 0xffff0000, v20
    v_add_f32 v128, v128, v8
    v_add_f32 v129, v129, v9
    v_lshlrev_b32 v10, 16, v21
    v_and_b32 v11, 0xffff0000, v21
    v_add_f32 v130, v130, v10
    v_add_f32 v131, v131, v11
    v_lshlrev_b32 v8, 16, v22
    v_and_b32 v9, 0xffff0000, v22
    v_add_f32 v132, v132, v8
    v_add_f32 v133, v133, v9
    v_lshlrev_b32 v10, 16, v23
    v_and_b32 v11, 0xffff0000, v23
    v_add_f32 v134, v134, v10
    v_add_f32 v135, v135, v11
    s_waitcnt vmcnt(22)
    v_lshlrev_b32 v8, 16, v56
    v_and_b32 v9, 0xffff0000, v56
    v_add_f32 v136, v136, v8
    v_add_f32 v137, v137, v9
    v_lshlrev_b32 v10, 16, v57
    v_and_b32 v11, 0xffff0000, v57
    v_add_f32 v138, v138, v10
    v_add_f32 v139, v139, v11
    v_lshlrev_b32 v8, 16, v58
    v_and_b32 v9, 0xffff0000, v58
    v_add_f32 v140, v140, v8
    v_add_f32 v141, v141, v9
    v_lshlrev_b32 v10, 16, v59
    v_and_b32 v11, 0xffff0000, v59
    v_add_f32 v142, v142, v10
    v_add_f32 v143, v143, v11
    s_waitcnt vmcnt(21)
    v_lshlrev_b32 v8, 16, v92
    v_and_b32 v9, 0xffff0000, v92
    v_add_f32 v144, v144, v8
    v_add_f32 v145, v145, v9
    v_lshlrev_b32 v10, 16, v93
    v_and_b32 v11, 0xffff0000, v93
    v_add_f32 v146, v146, v10
    v_add_f32 v147, v147, v11
    v_lshlrev_b32 v8, 16, v94
    v_and_b32 v9, 0xffff0000, v94
    v_add_f32 v148, v148, v8
    v_add_f32 v149, v149, v9
    v_lshlrev_b32 v10, 16, v95
    v_and_b32 v11, 0xffff0000, v95
    v_add_f32 v150, v150, v10
    v_add_f32 v151, v151, v11
    s_waitcnt vmcnt(20)
    v_lshlrev_b32 v8, 16, v24
    v_and_b32 v9, 0xffff0000, v24
    v_add_f32 v128, v128, v8
    v_add_f32 v129, v129, v9
    v_lshlrev_b32 v10, 16, v25
    v_and_b32 v11, 0xffff0000, v25
    v_add_f32 v130, v130, v10
    v_add_f32 v131, v131, v11
    v_lshlrev_b32 v8, 16, v26
    v_and_b32 v9, 0xffff0000, v26
    v_add_f32 v132, v132, v8
    v_add_f32 v133, v133, v9
    v_lshlrev_b32 v10, 16, v27
    v_and_b32 v11, 0xffff0000, v27
    v_add_f32 v134, v134, v10
    v_add_f32 v135, v135, v11
    s_waitcnt vmcnt(19)
    v_lshlrev_b32 v8, 16, v60
    v_and_b32 v9, 0xffff0000, v60
    v_add_f32 v136, v136, v8
    v_add_f32 v137, v137, v9
    v_lshlrev_b32 v10, 16, v61
    v_and_b32 v11, 0xffff0000, v61
    v_add_f32 v138, v138, v10
    v_add_f32 v139, v139, v11
    v_lshlrev_b32 v8, 16, v62
    v_and_b32 v9, 0xffff0000, v62
    v_add_f32 v140, v140, v8
    v_add_f32 v141, v141, v9
    v_lshlrev_b32 v10, 16, v63
    v_and_b32 v11, 0xffff0000, v63
    v_add_f32 v142, v142, v10
    v_add_f32 v143, v143, v11
    s_waitcnt vmcnt(18)
    v_lshlrev_b32 v8, 16, v96
    v_and_b32 v9, 0xffff0000, v96
    v_add_f32 v144, v144, v8
    v_add_f32 v145, v145, v9
    v_lshlrev_b32 v10, 16, v97
    v_and_b32 v11, 0xffff0000, v97
    v_add_f32 v146, v146, v10
    v_add_f32 v147, v147, v11
    v_lshlrev_b32 v8, 16, v98
    v_and_b32 v9, 0xffff0000, v98
    v_add_f32 v148, v148, v8
    v_add_f32 v149, v149, v9
    v_lshlrev_b32 v10, 16, v99
    v_and_b32 v11, 0xffff0000, v99
    v_add_f32 v150, v150, v10
    v_add_f32 v151, v151, v11
    s_waitcnt vmcnt(17)
    v_lshlrev_b32 v8, 16, v28
    v_and_b32 v9, 0xffff0000, v28
    v_add_f32 v128, v128, v8
    v_add_f32 v129, v129, v9
    v_lshlrev_b32 v10, 16, v29
    v_and_b32 v11, 0xffff0000, v29
    v_add_f32 v130, v130, v10
    v_add_f32 v131, v131, v11
    v_lshlrev_b32 v8, 16, v30
    v_and_b32 v9, 0xffff0000, v30
    v_add_f32 v132, v132, v8
    v_add_f32 v133, v133, v9
    v_lshlrev_b32 v10, 16, v31
    v_and_b32 v11, 0xffff0000, v31
    v_add_f32 v134, v134, v10
    v_add_f32 v135, v135, v11
    s_waitcnt vmcnt(16)
    v_lshlrev_b32 v8, 16, v64
    v_and_b32 v9, 0xffff0000, v64
    v_add_f32 v136, v136, v8
    v_add_f32 v137, v137, v9
    v_lshlrev_b32 v10, 16, v65
    v_and_b32 v11, 0xffff0000, v65
    v_add_f32 v138, v138, v10
    v_add_f32 v139, v139, v11
    v_lshlrev_b32 v8, 16, v66
    v_and_b32 v9, 0xffff0000, v66
    v_add_f32 v140, v140, v8
    v_add_f32 v141, v141, v9
    v_lshlrev_b32 v10, 16, v67
    v_and_b32 v11, 0xffff0000, v67
    v_add_f32 v142, v142, v10
    v_add_f32 v143, v143, v11
    s_waitcnt vmcnt(15)
    v_lshlrev_b32 v8, 16, v100
    v_and_b32 v9, 0xffff0000, v100
    v_add_f32 v144, v144, v8
    v_add_f32 v145, v145, v9
    v_lshlrev_b32 v10, 16, v101
    v_and_b32 v11, 0xffff0000, v101
    v_add_f32 v146, v146, v10
    v_add_f32 v147, v147, v11
    v_lshlrev_b32 v8, 16, v102
    v_and_b32 v9, 0xffff0000, v102
    v_add_f32 v148, v148, v8
    v_add_f32 v149, v149, v9
    v_lshlrev_b32 v10, 16, v103
    v_and_b32 v11, 0xffff0000, v103
    v_add_f32 v150, v150, v10
    v_add_f32 v151, v151, v11
    s_waitcnt vmcnt(14)
    v_lshlrev_b32 v8, 16, v32
    v_and_b32 v9, 0xffff0000, v32
    v_add_f32 v128, v128, v8
    v_add_f32 v129, v129, v9
    v_lshlrev_b32 v10, 16, v33
    v_and_b32 v11, 0xffff0000, v33
    v_add_f32 v130, v130, v10
    v_add_f32 v131, v131, v11
    v_lshlrev_b32 v8, 16, v34
    v_and_b32 v9, 0xffff0000, v34
    v_add_f32 v132, v132, v8
    v_add_f32 v133, v133, v9
    v_lshlrev_b32 v10, 16, v35
    v_and_b32 v11, 0xffff0000, v35
    v_add_f32 v134, v134, v10
    v_add_f32 v135, v135, v11
    s_waitcnt vmcnt(13)
    v_lshlrev_b32 v8, 16, v68
    v_and_b32 v9, 0xffff0000, v68
    v_add_f32 v136, v136, v8
    v_add_f32 v137, v137, v9
    v_lshlrev_b32 v10, 16, v69
    v_and_b32 v11, 0xffff0000, v69
    v_add_f32 v138, v138, v10
    v_add_f32 v139, v139, v11
    v_lshlrev_b32 v8, 16, v70
    v_and_b32 v9, 0xffff0000, v70
    v_add_f32 v140, v140, v8
    v_add_f32 v141, v141, v9
    v_lshlrev_b32 v10, 16, v71
    v_and_b32 v11, 0xffff0000, v71
    v_add_f32 v142, v142, v10
    v_add_f32 v143, v143, v11
    s_waitcnt vmcnt(12)
    v_lshlrev_b32 v8, 16, v104
    v_and_b32 v9, 0xffff0000, v104
    v_add_f32 v144, v144, v8
    v_add_f32 v145, v145, v9
    v_lshlrev_b32 v10, 16, v105
    v_and_b32 v11, 0xffff0000, v105
    v_add_f32 v146, v146, v10
    v_add_f32 v147, v147, v11
    v_lshlrev_b32 v8, 16, v106
    v_and_b32 v9, 0xffff0000, v106
    v_add_f32 v148, v148, v8
    v_add_f32 v149, v149, v9
    v_lshlrev_b32 v10, 16, v107
    v_and_b32 v11, 0xffff0000, v107
    v_add_f32 v150, v150, v10
    v_add_f32 v151, v151, v11
    s_waitcnt vmcnt(11)
    v_lshlrev_b32 v8, 16, v36
    v_and_b32 v9, 0xffff0000, v36
    v_add_f32 v128, v128, v8
    v_add_f32 v129, v129, v9
    v_lshlrev_b32 v10, 16, v37
    v_and_b32 v11, 0xffff0000, v37
    v_add_f32 v130, v130, v10
    v_add_f32 v131, v131, v11
    v_lshlrev_b32 v8, 16, v38
    v_and_b32 v9, 0xffff0000, v38
    v_add_f32 v132, v132, v8
    v_add_f32 v133, v133, v9
    v_lshlrev_b32 v10, 16, v39
    v_and_b32 v11, 0xffff0000, v39
    v_add_f32 v134, v134, v10
    v_add_f32 v135, v135, v11
    s_waitcnt vmcnt(10)
    v_lshlrev_b32 v8, 16, v72
    v_and_b32 v9, 0xffff0000, v72
    v_add_f32 v136, v136, v8
    v_add_f32 v137, v137, v9
    v_lshlrev_b32 v10, 16, v73
    v_and_b32 v11, 0xffff0000, v73
    v_add_f32 v138, v138, v10
    v_add_f32 v139, v139, v11
    v_lshlrev_b32 v8, 16, v74
    v_and_b32 v9, 0xffff0000, v74
    v_add_f32 v140, v140, v8
    v_add_f32 v141, v141, v9
    v_lshlrev_b32 v10, 16, v75
    v_and_b32 v11, 0xffff0000, v75
    v_add_f32 v142, v142, v10
    v_add_f32 v143, v143, v11
    s_waitcnt vmcnt(9)
    v_lshlrev_b32 v8, 16, v108
    v_and_b32 v9, 0xffff0000, v108
    v_add_f32 v144, v144, v8
    v_add_f32 v145, v145, v9
    v_lshlrev_b32 v10, 16, v109
    v_and_b32 v11, 0xffff0000, v109
    v_add_f32 v146, v146, v10
    v_add_f32 v147, v147, v11
    v_lshlrev_b32 v8, 16, v110
    v_and_b32 v9, 0xffff0000, v110
    v_add_f32 v148, v148, v8
    v_add_f32 v149, v149, v9
    v_lshlrev_b32 v10, 16, v111
    v_and_b32 v11, 0xffff0000, v111
    v_add_f32 v150, v150, v10
    v_add_f32 v151, v151, v11
    s_waitcnt vmcnt(8)
    v_lshlrev_b32 v8, 16, v40
    v_and_b32 v9, 0xffff0000, v40
    v_add_f32 v128, v128, v8
    v_add_f32 v129, v129, v9
    v_lshlrev_b32 v10, 16, v41
    v_and_b32 v11, 0xffff0000, v41
    v_add_f32 v130, v130, v10
    v_add_f32 v131, v131, v11
    v_lshlrev_b32 v8, 16, v42
    v_and_b32 v9, 0xffff0000, v42
    v_add_f32 v132, v132, v8
    v_add_f32 v133, v133, v9
    v_lshlrev_b32 v10, 16, v43
    v_and_b32 v11, 0xffff0000, v43
    v_add_f32 v134, v134, v10
    v_add_f32 v135, v135, v11
    s_waitcnt vmcnt(7)
    v_lshlrev_b32 v8, 16, v76
    v_and_b32 v9, 0xffff0000, v76
    v_add_f32 v136, v136, v8
    v_add_f32 v137, v137, v9
    v_lshlrev_b32 v10, 16, v77
    v_and_b32 v11, 0xffff0000, v77
    v_add_f32 v138, v138, v10
    v_add_f32 v139, v139, v11
    v_lshlrev_b32 v8, 16, v78
    v_and_b32 v9, 0xffff0000, v78
    v_add_f32 v140, v140, v8
    v_add_f32 v141, v141, v9
    v_lshlrev_b32 v10, 16, v79
    v_and_b32 v11, 0xffff0000, v79
    v_add_f32 v142, v142, v10
    v_add_f32 v143, v143, v11
    s_waitcnt vmcnt(6)
    v_lshlrev_b32 v8, 16, v112
    v_and_b32 v9, 0xffff0000, v112
    v_add_f32 v144, v144, v8
    v_add_f32 v145, v145, v9
    v_lshlrev_b32 v10, 16, v113
    v_and_b32 v11, 0xffff0000, v113
    v_add_f32 v146, v146, v10
    v_add_f32 v147, v147, v11
    v_lshlrev_b32 v8, 16, v114
    v_and_b32 v9, 0xffff0000, v114
    v_add_f32 v148, v148, v8
    v_add_f32 v149, v149, v9
    v_lshlrev_b32 v10, 16, v115
    v_and_b32 v11, 0xffff0000, v115
    v_add_f32 v150, v150, v10
    v_add_f32 v151, v151, v11
    s_waitcnt vmcnt(5)
    v_lshlrev_b32 v8, 16, v44
    v_and_b32 v9, 0xffff0000, v44
    v_add_f32 v128, v128, v8
    v_add_f32 v129, v129, v9
    v_lshlrev_b32 v10, 16, v45
    v_and_b32 v11, 0xffff0000, v45
    v_add_f32 v130, v130, v10
    v_add_f32 v131, v131, v11
    v_lshlrev_b32 v8, 16, v46
    v_and_b32 v9, 0xffff0000, v46
    v_add_f32 v132, v132, v8
    v_add_f32 v133, v133, v9
    v_lshlrev_b32 v10, 16, v47
    v_and_b32 v11, 0xffff0000, v47
    v_add_f32 v134, v134, v10
    v_add_f32 v135, v135, v11
    s_waitcnt vmcnt(4)
    v_lshlrev_b32 v8, 16, v80
    v_and_b32 v9, 0xffff0000, v80
    v_add_f32 v136, v136, v8
    v_add_f32 v137, v137, v9
    v_lshlrev_b32 v10, 16, v81
    v_and_b32 v11, 0xffff0000, v81
    v_add_f32 v138, v138, v10
    v_add_f32 v139, v139, v11
    v_lshlrev_b32 v8, 16, v82
    v_and_b32 v9, 0xffff0000, v82
    v_add_f32 v140, v140, v8
    v_add_f32 v141, v141, v9
    v_lshlrev_b32 v10, 16, v83
    v_and_b32 v11, 0xffff0000, v83
    v_add_f32 v142, v142, v10
    v_add_f32 v143, v143, v11
    s_waitcnt vmcnt(3)
    v_lshlrev_b32 v8, 16, v116
    v_and_b32 v9, 0xffff0000, v116
    v_add_f32 v144, v144, v8
    v_add_f32 v145, v145, v9
    v_lshlrev_b32 v10, 16, v117
    v_and_b32 v11, 0xffff0000, v117
    v_add_f32 v146, v146, v10
    v_add_f32 v147, v147, v11
    v_lshlrev_b32 v8, 16, v118
    v_and_b32 v9, 0xffff0000, v118
    v_add_f32 v148, v148, v8
    v_add_f32 v149, v149, v9
    v_lshlrev_b32 v10, 16, v119
    v_and_b32 v11, 0xffff0000, v119
    v_add_f32 v150, v150, v10
    v_add_f32 v151, v151, v11
    s_waitcnt vmcnt(2)
    v_lshlrev_b32 v8, 16, v48
    v_and_b32 v9, 0xffff0000, v48
    v_add_f32 v128, v128, v8
    v_add_f32 v129, v129, v9
    v_lshlrev_b32 v10, 16, v49
    v_and_b32 v11, 0xffff0000, v49
    v_add_f32 v130, v130, v10
    v_add_f32 v131, v131, v11
    v_lshlrev_b32 v8, 16, v50
    v_and_b32 v9, 0xffff0000, v50
    v_add_f32 v132, v132, v8
    v_add_f32 v133, v133, v9
    v_lshlrev_b32 v10, 16, v51
    v_and_b32 v11, 0xffff0000, v51
    v_add_f32 v134, v134, v10
    v_add_f32 v135, v135, v11
    s_waitcnt vmcnt(1)
    v_lshlrev_b32 v8, 16, v84
    v_and_b32 v9, 0xffff0000, v84
    v_add_f32 v136, v136, v8
    v_add_f32 v137, v137, v9
    v_lshlrev_b32 v10, 16, v85
    v_and_b32 v11, 0xffff0000, v85
    v_add_f32 v138, v138, v10
    v_add_f32 v139, v139, v11
    v_lshlrev_b32 v8, 16, v86
    v_and_b32 v9, 0xffff0000, v86
    v_add_f32 v140, v140, v8
    v_add_f32 v141, v141, v9
    v_lshlrev_b32 v10, 16, v87
    v_and_b32 v11, 0xffff0000, v87
    v_add_f32 v142, v142, v10
    v_add_f32 v143, v143, v11
    s_waitcnt vmcnt(0)
    v_lshlrev_b32 v8, 16, v120
    v_and_b32 v9, 0xffff0000, v120
    v_add_f32 v144, v144, v8
    v_add_f32 v145, v145, v9
    v_lshlrev_b32 v10, 16, v121
    v_and_b32 v11, 0xffff0000, v121
    v_add_f32 v146, v146, v10
    v_add_f32 v147, v147, v11
    v_lshlrev_b32 v8, 16, v122
    v_and_b32 v9, 0xffff0000, v122
    v_add_f32 v148, v148, v8
    v_add_f32 v149, v149, v9
    v_lshlrev_b32 v10, 16, v123
    v_and_b32 v11, 0xffff0000, v123
    v_add_f32 v150, v150, v10
    v_add_f32 v151, v151, v11
    s_add_u32 s16, s42, 28311552
    s_addc_u32 s17, s43, 0
    s_mov_b32 s18, 0x240000
    s_mov_b32 s19, 0x20000
    v_cvt_pk_bf16_f32 v160, v128, v129
    v_cvt_pk_bf16_f32 v161, v130, v131
    v_cvt_pk_bf16_f32 v162, v132, v133
    v_cvt_pk_bf16_f32 v163, v134, v135
    buffer_store_dwordx4 v[160:163], v3, s[16:19], 0 offen offset:0
    v_cvt_pk_bf16_f32 v164, v136, v137
    v_cvt_pk_bf16_f32 v165, v138, v139
    v_cvt_pk_bf16_f32 v166, v140, v141
    v_cvt_pk_bf16_f32 v167, v142, v143
    buffer_store_dwordx4 v[164:167], v3, s[16:19], 0 offen offset:128
    v_cvt_pk_bf16_f32 v168, v144, v145
    v_cvt_pk_bf16_f32 v169, v146, v147
    v_cvt_pk_bf16_f32 v170, v148, v149
    v_cvt_pk_bf16_f32 v171, v150, v151
    buffer_store_dwordx4 v[168:171], v3, s[16:19], 0 offen offset:256
    v_lshlrev_b32 v128, 16, v160
    v_and_b32 v129, 0xffff0000, v160
    v_lshlrev_b32 v130, 16, v161
    v_and_b32 v131, 0xffff0000, v161
    v_lshlrev_b32 v132, 16, v162
    v_and_b32 v133, 0xffff0000, v162
    v_lshlrev_b32 v134, 16, v163
    v_and_b32 v135, 0xffff0000, v163
    v_lshlrev_b32 v136, 16, v164
    v_and_b32 v137, 0xffff0000, v164
    v_lshlrev_b32 v138, 16, v165
    v_and_b32 v139, 0xffff0000, v165
    v_lshlrev_b32 v140, 16, v166
    v_and_b32 v141, 0xffff0000, v166
    v_lshlrev_b32 v142, 16, v167
    v_and_b32 v143, 0xffff0000, v167
    v_lshlrev_b32 v144, 16, v168
    v_and_b32 v145, 0xffff0000, v168
    v_lshlrev_b32 v146, 16, v169
    v_and_b32 v147, 0xffff0000, v169
    v_lshlrev_b32 v148, 16, v170
    v_and_b32 v149, 0xffff0000, v170
    v_lshlrev_b32 v150, 16, v171
    v_and_b32 v151, 0xffff0000, v171
    v_add_f32 v152, v128, v129
    v_add_f32 v8, v130, v131
    v_add_f32 v152, v152, v132
    v_add_f32 v8, v8, v133
    v_add_f32 v152, v152, v134
    v_add_f32 v8, v8, v135
    v_add_f32 v152, v152, v136
    v_add_f32 v8, v8, v137
    v_add_f32 v152, v152, v138
    v_add_f32 v8, v8, v139
    v_add_f32 v152, v152, v140
    v_add_f32 v8, v8, v141
    v_add_f32 v152, v152, v142
    v_add_f32 v8, v8, v143
    v_add_f32 v152, v152, v144
    v_add_f32 v8, v8, v145
    v_add_f32 v152, v152, v146
    v_add_f32 v8, v8, v147
    v_add_f32 v152, v152, v148
    v_add_f32 v8, v8, v149
    v_add_f32 v152, v152, v150
    v_add_f32 v8, v8, v151
    v_add_f32 v152, v152, v8
    s_nop 1
    v_add_f32_dpp v152, v152, v152 row_ror:8 row_mask:0xf bank_mask:0xf
    v_mov_b32 v8, v152
    s_nop 1
    v_permlane16_swap_b32 v152, v8
    v_add_f32 v152, v152, v8
    v_mov_b32 v8, v152
    s_nop 1
    v_permlane32_swap_b32 v152, v8
    v_add_f32 v152, v152, v8
    v_mul_f32 v9, 0x3baaaaab, v152
    v_sub_f32 v8, v128, v9
    v_mul_f32 v153, v8, v8
    v_sub_f32 v11, v129, v9
    v_fmac_f32 v153, v11, v11
    v_sub_f32 v10, v130, v9
    v_fmac_f32 v153, v10, v10
    v_sub_f32 v11, v131, v9
    v_fmac_f32 v153, v11, v11
    v_sub_f32 v10, v132, v9
    v_fmac_f32 v153, v10, v10
    v_sub_f32 v11, v133, v9
    v_fmac_f32 v153, v11, v11
    v_sub_f32 v10, v134, v9
    v_fmac_f32 v153, v10, v10
    v_sub_f32 v11, v135, v9
    v_fmac_f32 v153, v11, v11
    v_sub_f32 v10, v136, v9
    v_fmac_f32 v153, v10, v10
    v_sub_f32 v11, v137, v9
    v_fmac_f32 v153, v11, v11
    v_sub_f32 v10, v138, v9
    v_fmac_f32 v153, v10, v10
    v_sub_f32 v11, v139, v9
    v_fmac_f32 v153, v11, v11
    v_sub_f32 v10, v140, v9
    v_fmac_f32 v153, v10, v10
    v_sub_f32 v11, v141, v9
    v_fmac_f32 v153, v11, v11
    v_sub_f32 v10, v142, v9
    v_fmac_f32 v153, v10, v10
    v_sub_f32 v11, v143, v9
    v_fmac_f32 v153, v11, v11
    v_sub_f32 v10, v144, v9
    v_fmac_f32 v153, v10, v10
    v_sub_f32 v11, v145, v9
    v_fmac_f32 v153, v11, v11
    v_sub_f32 v10, v146, v9
    v_fmac_f32 v153, v10, v10
    v_sub_f32 v11, v147, v9
    v_fmac_f32 v153, v11, v11
    v_sub_f32 v10, v148, v9
    v_fmac_f32 v153, v10, v10
    v_sub_f32 v11, v149, v9
    v_fmac_f32 v153, v11, v11
    v_sub_f32 v10, v150, v9
    v_fmac_f32 v153, v10, v10
    v_sub_f32 v11, v151, v9
    v_fmac_f32 v153, v11, v11
    s_nop 1
    v_add_f32_dpp v153, v153, v153 row_ror:8 row_mask:0xf bank_mask:0xf
    v_mov_b32 v8, v153
    s_nop 1
    v_permlane16_swap_b32 v153, v8
    v_add_f32 v153, v153, v8
    v_mov_b32 v8, v153
    s_nop 1
    v_permlane32_swap_b32 v153, v8
    v_add_f32 v153, v153, v8
    v_and_b32 v8, 7, v1
    s_mul_i32 s46, s20, 64
    v_lshl_add_u32 v8, v8, 3, s46
    ds_write_b64 v8, v[152:153] offset:0
    s_waitcnt lgkmcnt(0)
L_w3a_30:
    s_barrier
    s_cmp_eq_u32 s20, 3
    s_cbranch_scc1 L_w3b_31
    v_and_b32 v8, 7, v1
    v_lshlrev_b32 v8, 3, v8
    ds_read_b64 v[152:153], v8 offset:0
    ds_read_b64 v[154:155], v8 offset:64
    ds_read_b64 v[156:157], v8 offset:128
    s_waitcnt lgkmcnt(1)
    v_add_f32 v8, v152, v154
    s_waitcnt lgkmcnt(0)
    v_add_f32 v8, v8, v156
    v_mul_f32 v8, 0x3ae38e39, v8
    v_add_f32 v9, v153, v155
    v_add_f32 v9, v9, v157
    v_mul_f32 v10, 0x3baaaaab, v152
    v_sub_f32 v10, v10, v8
    v_mul_f32 v10, v10, v10
    v_fmac_f32 v9, 0x43400000, v10
    v_mul_f32 v10, 0x3baaaaab, v154
    v_sub_f32 v10, v10, v8
    v_mul_f32 v10, v10, v10
    v_fmac_f32 v9, 0x43400000, v10
    v_mul_f32 v10, 0x3baaaaab, v156
    v_sub_f32 v10, v10, v8
    v_mul_f32 v10, v10, v10
    v_fmac_f32 v9, 0x43400000, v10
    v_mul_f32 v9, 0x3ae38e39, v9
    v_cvt_pk_bf16_f32 v9, v9, v9
    v_lshlrev_b32 v9, 16, v9
    v_add_f32 v9, 0x3727c5ac, v9
    v_cvt_pk_bf16_f32 v9, v9, v9
    v_lshlrev_b32 v9, 16, v9
    v_sqrt_f32 v9, v9
    s_nop 0
    v_cvt_pk_bf16_f32 v9, v9, v9
    v_lshlrev_b32 v9, 16, v9
    v_rcp_f32 v9, v9
    v_cvt_pk_bf16_f32 v8, v8, v8
    v_lshlrev_b32 v8, 16, v8
    v_sub_f32 v128, v128, v8
    v_sub_f32 v129, v129, v8
    v_cvt_pk_bf16_f32 v10, v128, v129
    v_lshlrev_b32 v128, 16, v10
    v_and_b32 v129, 0xffff0000, v10
    v_mul_f32 v128, v128, v9
    v_mul_f32 v129, v129, v9
    v_cvt_pk_bf16_f32 v16, v128, v129
    v_sub_f32 v130, v130, v8
    v_sub_f32 v131, v131, v8
    v_cvt_pk_bf16_f32 v10, v130, v131
    v_lshlrev_b32 v130, 16, v10
    v_and_b32 v131, 0xffff0000, v10
    v_mul_f32 v130, v130, v9
    v_mul_f32 v131, v131, v9
    v_cvt_pk_bf16_f32 v17, v130, v131
    v_sub_f32 v132, v132, v8
    v_sub_f32 v133, v133, v8
    v_cvt_pk_bf16_f32 v10, v132, v133
    v_lshlrev_b32 v132, 16, v10
    v_and_b32 v133, 0xffff0000, v10
    v_mul_f32 v132, v132, v9
    v_mul_f32 v133, v133, v9
    v_cvt_pk_bf16_f32 v18, v132, v133
    v_sub_f32 v134, v134, v8
    v_sub_f32 v135, v135, v8
    v_cvt_pk_bf16_f32 v10, v134, v135
    v_lshlrev_b32 v134, 16, v10
    v_and_b32 v135, 0xffff0000, v10
    v_mul_f32 v134, v134, v9
    v_mul_f32 v135, v135, v9
    v_cvt_pk_bf16_f32 v19, v134, v135
    v_sub_f32 v136, v136, v8
    v_sub_f32 v137, v137, v8
    v_cvt_pk_bf16_f32 v10, v136, v137
    v_lshlrev_b32 v136, 16, v10
    v_and_b32 v137, 0xffff0000, v10
    v_mul_f32 v136, v136, v9
    v_mul_f32 v137, v137, v9
    v_cvt_pk_bf16_f32 v20, v136, v137
    v_sub_f32 v138, v138, v8
    v_sub_f32 v139, v139, v8
    v_cvt_pk_bf16_f32 v10, v138, v139
    v_lshlrev_b32 v138, 16, v10
    v_and_b32 v139, 0xffff0000, v10
    v_mul_f32 v138, v138, v9
    v_mul_f32 v139, v139, v9
    v_cvt_pk_bf16_f32 v21, v138, v139
    v_sub_f32 v140, v140, v8
    v_sub_f32 v141, v141, v8
    v_cvt_pk_bf16_f32 v10, v140, v141
    v_lshlrev_b32 v140, 16, v10
    v_and_b32 v141, 0xffff0000, v10
    v_mul_f32 v140, v140, v9
    v_mul_f32 v141, v141, v9
    v_cvt_pk_bf16_f32 v22, v140, v141
    v_sub_f32 v142, v142, v8
    v_sub_f32 v143, v143, v8
    v_cvt_pk_bf16_f32 v10, v142, v143
    v_lshlrev_b32 v142, 16, v10
    v_and_b32 v143, 0xffff0000, v10
    v_mul_f32 v142, v142, v9
    v_mul_f32 v143, v143, v9
    v_cvt_pk_bf16_f32 v23, v142, v143
    v_sub_f32 v144, v144, v8
    v_sub_f32 v145, v145, v8
    v_cvt_pk_bf16_f32 v10, v144, v145
    v_lshlrev_b32 v144, 16, v10
    v_and_b32 v145, 0xffff0000, v10
    v_mul_f32 v144, v144, v9
    v_mul_f32 v145, v145, v9
    v_cvt_pk_bf16_f32 v24, v144, v145
    v_sub_f32 v146, v146, v8
    v_sub_f32 v147, v147, v8
    v_cvt_pk_bf16_f32 v10, v146, v147
    v_lshlrev_b32 v146, 16, v10
    v_and_b32 v147, 0xffff0000, v10
    v_mul_f32 v146, v146, v9
    v_mul_f32 v147, v147, v9
    v_cvt_pk_bf16_f32 v25, v146, v147
    v_sub_f32 v148, v148, v8
    v_sub_f32 v149, v149, v8
    v_cvt_pk_bf16_f32 v10, v148, v149
    v_lshlrev_b32 v148, 16, v10
    v_and_b32 v149, 0xffff0000, v10
    v_mul_f32 v148, v148, v9
    v_mul_f32 v149, v149, v9
    v_cvt_pk_bf16_f32 v26, v148, v149
    v_sub_f32 v150, v150, v8
    v_sub_f32 v151, v151, v8
    v_cvt_pk_bf16_f32 v10, v150, v151
    v_lshlrev_b32 v150, 16, v10
    v_and_b32 v151, 0xffff0000, v10
    v_mul_f32 v150, v150, v9
    v_mul_f32 v151, v151, v9
    v_cvt_pk_bf16_f32 v27, v150, v151
    s_mov_b32 s46, 71303168
    buffer_store_dwordx4 v[16:19], v4, s[4:7], s46 offen offset:0
    buffer_store_dwordx4 v[20:23], v4, s[4:7], s46 offen offset:2048
    s_add_u32 s46, s46, 4096
    buffer_store_dwordx4 v[24:27], v4, s[4:7], s46 offen offset:0
L_w3b_31:
red0_kernel_end:
    s_endpgm
.section .rodata,"a"
.p2align 6
.amdhsa_kernel red0_kernel
  .amdhsa_next_free_vgpr 176
  .amdhsa_next_free_sgpr 102
  .amdhsa_accum_offset 176
  .amdhsa_group_segment_fixed_size 0
  .amdhsa_kernarg_size 80
  .amdhsa_user_sgpr_count 2
  .amdhsa_user_sgpr_kernarg_segment_ptr 1
  .amdhsa_system_sgpr_workgroup_id_x 1
  .amdhsa_float_denorm_mode_32 3
.end_amdhsa_kernel
.text
.globl qkv1_kernel
.p2align 8
.type qkv1_kernel,@function
qkv1_kernel:
    s_cmp_ge_u32 s2, 256
    s_cbranch_scc1 qkv1_kernel_end
    s_load_dwordx16 s[24:39], s[0:1], 0
    s_load_dwordx4 s[40:43], s[0:1], 64
    v_lshrrev_b32 v1, 6, v0
    s_and_b32 s21, s2, 7
    v_readfirstlane_b32 s20, v1
    s_lshr_b32 s22, s2, 3
    v_and_b32 v1, 63, v0
    v_lshlrev_b32 v2, 4, v1
    s_waitcnt lgkmcnt(0)
    s_mov_b32 s4, s42
    s_mov_b32 s5, s43
    s_mov_b32 s6, 0x10000000
    s_mov_b32 s7, 0x20000
    s_lshr_b32 s44, s22, 4
    s_lshl_b32 s52, s21, 1
    s_add_u32 s44, s44, s52
    s_and_b32 s45, s22, 15
    s_lshl_b32 s46, s44, 3
    s_mul_i32 s47, s45, 129024
    s_lshl_b32 s50, s20, 11
    s_add_u32 s47, s47, s50
    s_add_u32 s47, s47, 0
    s_add_u32 s48, s47, 1024
    s_max_u32 s52, s46, 1
    s_sub_u32 s52, s52, 1
    s_mul_i32 s52, s52, 18432
    s_add_u32 s52, s52, 71303168
    s_cmp_eq_u32 s20, 3
    s_cselect_b32 s48, s52, s48
    s_mov_b32 s49, 7168
    s_cselect_b32 s49, 1024, s49
    s_lshl_b32 s52, s20, 1
    s_add_u32 s46, s46, s52
    s_mul_i32 s51, s46, 18432
    s_add_u32 s51, s51, 71303168
    s_mov_b32 m0, s50
    s_nop 0
    buffer_load_dwordx4 v2, s[4:7], s47 offen lds
    s_add_u32 m0, s50, 1024
    s_nop 0
    buffer_load_dwordx4 v2, s[4:7], s48 offen lds
    s_add_u32 s50, s50, 8192
    s_add_u32 s47, s47, 7168
    s_add_u32 s48, s48, s49
    s_add_u32 s52, s51, 0
    buffer_load_dwordx4 a[0:3], v2, s[4:7], s52 offen
    s_add_u32 s52, s51, 18432
    buffer_load_dwordx4 a[72:75], v2, s[4:7], s52 offen
    s_mov_b32 m0, s50
    s_nop 0
    buffer_load_dwordx4 v2, s[4:7], s47 offen lds
    s_add_u32 m0, s50, 1024
    s_nop 0
    buffer_load_dwordx4 v2, s[4:7], s48 offen lds
    s_add_u32 s50, s50, 8192
    s_add_u32 s47, s47, 7168
    s_add_u32 s48, s48, s49
    s_add_u32 s52, s51, 1024
    buffer_load_dwordx4 a[4:7], v2, s[4:7], s52 offen
    s_add_u32 s52, s51, 19456
    buffer_load_dwordx4 a[76:79], v2, s[4:7], s52 offen
    s_mov_b32 m0, s50
    s_nop 0
    buffer_load_dwordx4 v2, s[4:7], s47 offen lds
    s_add_u32 m0, s50, 1024
    s_nop 0
    buffer_load_dwordx4 v2, s[4:7], s48 offen lds
    s_add_u32 s50, s50, 8192
    s_add_u32 s47, s47, 7168
    s_add_u32 s48, s48, s49
    s_add_u32 s52, s51, 2048
    buffer_load_dwordx4 a[8:11], v2, s[4:7], s52 offen
    s_add_u32 s52, s51, 20480
    buffer_load_dwordx4 a[80:83], v2, s[4:7], s52 offen
    s_mov_b32 m0, s50
    s_nop 0
    buffer_load_dwordx4 v2, s[4:7], s47 offen lds
    s_add_u32 m0, s50, 1024
    s_nop 0
    buffer_load_dwordx4 v2, s[4:7], s48 offen lds
    s_add_u32 s50, s50, 8192
    s_add_u32 s47, s47, 7168
    s_add_u32 s48, s48, s49
    s_add_u32 s52, s51, 3072
    buffer_load_dwordx4 a[12:15], v2, s[4:7], s52 offen
    s_add_u32 s52, s51, 21504
    buffer_load_dwordx4 a[84:87], v2, s[4:7], s52 offen
    s_mov_b32 m0, s50
    s_nop 0
    buffer_load_dwordx4 v2, s[4:7], s47 offen lds
    s_add_u32 m0, s50, 1024
    s_nop 0
    buffer_load_dwordx4 v2, s[4:7], s48 offen lds
    s_add_u32 s50, s50, 8192
    s_add_u32 s47, s47, 7168
    s_add_u32 s48, s48, s49
    s_add_u32 s52, s51, 4096
    buffer_load_dwordx4 a[16:19], v2, s[4:7], s52 offen
    s_add_u32 s52, s51, 22528
    buffer_load_dwordx4 a[88:91], v2, s[4:7], s52 offen
    s_mov_b32 m0, s50
    s_nop 0
    buffer_load_dwordx4 v2, s[4:7], s47 offen lds
    s_add_u32 m0, s50, 1024
    s_nop 0
    buffer_load_dwordx4 v2, s[4:7], s48 offen lds
    s_add_u32 s50, s50, 8192
    s_add_u32 s47, s47, 7168
    s_add_u32 s48, s48, s49
    s_add_u32 s52, s51, 5120
    buffer_load_dwordx4 a[20:23], v2, s[4:7], s52 offen
    s_add_u32 s52, s51, 23552
    buffer_load_dwordx4 a[92:95], v2, s[4:7], s52 offen
    s_mov_b32 m0, s50
    s_nop 0
    buffer_load_dwordx4 v2, s[4:7], s47 offen lds
    s_add_u32 m0, s50, 1024
    s_nop 0
    buffer_load_dwordx4 v2, s[4:7], s48 offen lds
    s_add_u32 s50, s50, 8192
    s_add_u32 s47, s47, 7168
    s_add_u32 s48, s48, s49
    s_add_u32 s52, s51, 6144
    buffer_load_dwordx4 a[24:27], v2, s[4:7], s52 offen
    s_add_u32 s52, s51, 24576
    buffer_load_dwordx4 a[96:99], v2, s[4:7], s52 offen
    s_mov_b32 m0, s50
    s_nop 0
    buffer_load_dwordx4 v2, s[4:7], s47 offen lds
    s_add_u32 m0, s50, 1024
    s_nop 0
    buffer_load_dwordx4 v2, s[4:7], s48 offen lds
    s_add_u32 s50, s50, 8192
    s_add_u32 s47, s47, 7168
    s_add_u32 s48, s48, s49
    s_add_u32 s52, s51, 7168
    buffer_load_dwordx4 a[28:31], v2, s[4:7], s52 offen
    s_add_u32 s52, s51, 25600
    buffer_load_dwordx4 a[100:103], v2, s[4:7], s52 offen
    s_mov_b32 m0, s50
    s_nop 0
    buffer_load_dwordx4 v2, s[4:7], s47 offen lds
    s_add_u32 m0, s50, 1024
    s_nop 0
    buffer_load_dwordx4 v2, s[4:7], s48 offen lds
    s_add_u32 s50, s50, 8192
    s_add_u32 s47, s47, 7168
    s_add_u32 s48, s48, s49
    s_add_u32 s52, s51, 8192
    buffer_load_dwordx4 a[32:35], v2, s[4:7], s52 offen
    s_add_u32 s52, s51, 26624
    buffer_load_dwordx4 a[104:107], v2, s[4:7], s52 offen
    s_mov_b32 m0, s50
    s_nop 0
    buffer_load_dwordx4 v2, s[4:7], s47 offen lds
    s_add_u32 m0, s50, 1024
    s_nop 0
    buffer_load_dwordx4 v2, s[4:7], s48 offen lds
    s_add_u32 s50, s50, 8192
    s_add_u32 s47, s47, 7168
    s_add_u32 s48, s48, s49
    s_add_u32 s52, s51, 9216
    buffer_load_dwordx4 a[36:39], v2, s[4:7], s52 offen
    s_add_u32 s52, s51, 27648
    buffer_load_dwordx4 a[108:111], v2, s[4:7], s52 offen
    s_mov_b32 m0, s50
    s_nop 0
    buffer_load_dwordx4 v2, s[4:7], s47 offen lds
    s_add_u32 m0, s50, 1024
    s_nop 0
    buffer_load_dwordx4 v2, s[4:7], s48 offen lds
    s_add_u32 s50, s50, 8192
    s_add_u32 s47, s47, 7168
    s_add_u32 s48, s48, s49
    s_add_u32 s52, s51, 10240
    buffer_load_dwordx4 a[40:43], v2, s[4:7], s52 offen
    s_add_u32 s52, s51, 28672
    buffer_load_dwordx4 a[112:115], v2, s[4:7], s52 offen
    s_mov_b32 m0, s50
    s_nop 0
    buffer_load_dwordx4 v2, s[4:7], s47 offen lds
    s_add_u32 m0, s50, 1024
    s_nop 0
    buffer_load_dwordx4 v2, s[4:7], s48 offen lds
    s_add_u32 s50, s50, 8192
    s_add_u32 s47, s47, 7168
    s_add_u32 s48, s48, s49
    s_add_u32 s52, s51, 11264
    buffer_load_dwordx4 a[44:47], v2, s[4:7], s52 offen
    s_add_u32 s52, s51, 29696
    buffer_load_dwordx4 a[116:119], v2, s[4:7], s52 offen
    s_min_u32 s52, s20, 2
    s_add_u32 s53, s52, 2
    s_add_u32 s54, s52, 4
    s_cmp_ge_u32 s20, 2
    s_cselect_b32 s53, 6, s53
    s_lshl_b32 s53, s53, 10
    s_lshl_b32 s54, s54, 10
    v_mov_b32 v3, v2
    v_add_u32 v4, s53, v2
    v_add_u32 v5, s54, v2
    v_and_b32 v6, 15, v1
    v_lshrrev_b32 v7, 4, v1
    v_lshlrev_b32 v7, 2, v7
    v_sub_u32 v6, v6, v7
    v_mov_b32 v8, 0xf149f2ca
    s_or_b32 s52, s44, s20
    s_cmp_eq_u32 s52, 0
    s_cselect_b64 s[56:57], -1, 0
    v_subrev_u32 v7, 0, v6
    v_and_b32 v9, 0xfffffff1, v7
    v_cmp_eq_u32 vcc, 0, v9
    v_add_u32 v7, 16, v7
    v_and_b32 v9, 0xfffffff1, v7
    v_cndmask_b32_e64 v168, v8, 0, vcc
    v_cmp_eq_u32 vcc, 0, v9
    s_nop 1
    v_cndmask_b32_e64 v172, v8, 0, vcc
    v_cndmask_b32_e64 v176, v172, v8, s[56:57]
    v_subrev_u32 v7, 1, v6
    v_and_b32 v9, 0xfffffff1, v7
    v_cmp_eq_u32 vcc, 0, v9
    v_add_u32 v7, 16, v7
    v_and_b32 v9, 0xfffffff1, v7
    v_cndmask_b32_e64 v169, v8, 0, vcc
    v_cmp_eq_u32 vcc, 0, v9
    s_nop 1
    v_cndmask_b32_e64 v173, v8, 0, vcc
    v_cndmask_b32_e64 v177, v173, v8, s[56:57]
    v_subrev_u32 v7, 2, v6
    v_and_b32 v9, 0xfffffff1, v7
    v_cmp_eq_u32 vcc, 0, v9
    v_add_u32 v7, 16, v7
    v_and_b32 v9, 0xfffffff1, v7
    v_cndmask_b32_e64 v170, v8, 0, vcc
    v_cmp_eq_u32 vcc, 0, v9
    s_nop 1
    v_cndmask_b32_e64 v174, v8, 0, vcc
    v_cndmask_b32_e64 v178, v174, v8, s[56:57]
    v_subrev_u32 v7, 3, v6
    v_and_b32 v9, 0xfffffff1, v7
    v_cmp_eq_u32 vcc, 0, v9
    v_add_u32 v7, 16, v7
    v_and_b32 v9, 0xfffffff1, v7
    v_cndmask_b32_e64 v171, v8, 0, vcc
    v_cmp_eq_u32 vcc, 0, v9
    s_nop 1
    v_cndmask_b32_e64 v175, v8, 0, vcc
    v_cndmask_b32_e64 v179, v175, v8, s[56:57]
    s_waitcnt vmcnt(38)
    s_barrier
    ds_read_b128 v[88:91], v3 offset:0
    ds_read_b128 v[92:95], v3 offset:1024
    ds_read_b128 v[96:99], v3 offset:2048
    ds_read_b128 v[100:103], v3 offset:3072
    ds_read_b128 v[112:115], v3 offset:6144
    ds_read_b128 v[104:107], v3 offset:4096
    ds_read_b128 v[108:111], v3 offset:5120
    ds_read_b128 v[144:147], v3 offset:7168
    ds_read_b128 v[148:151], v4 offset:0
    ds_read_b128 v[152:155], v5 offset:0
    s_mov_b32 m0, s50
    s_nop 0
    buffer_load_dwordx4 v2, s[4:7], s47 offen lds
    s_waitcnt lgkmcnt(9)
    v_mfma_f32_16x16x32_bf16 v[16:19], v[88:91], a[0:3], 0
    ds_read_b128 v[116:119], v3 offset:8192
    s_add_u32 m0, s50, 1024
    v_mfma_f32_16x16x32_bf16 v[48:51], v[88:91], a[72:75], 0
    ds_read_b128 v[120:123], v3 offset:9216
    buffer_load_dwordx4 v2, s[4:7], s48 offen lds
    s_waitcnt lgkmcnt(10)
    v_mfma_f32_16x16x32_bf16 v[20:23], v[92:95], a[0:3], 0
    ds_read_b128 v[124:127], v3 offset:10240
    s_add_u32 s50, s50, 8192
    v_mfma_f32_16x16x32_bf16 v[52:55], v[92:95], a[72:75], 0
    ds_read_b128 v[128:131], v3 offset:11264
    s_add_u32 s47, s47, 7168
    s_waitcnt lgkmcnt(11)
    v_mfma_f32_16x16x32_bf16 v[24:27], v[96:99], a[0:3], 0
    ds_read_b128 v[140:143], v3 offset:14336
    s_add_u32 s48, s48, s49
    v_mfma_f32_16x16x32_bf16 v[56:59], v[96:99], a[72:75], 0
    ds_read_b128 v[132:135], v3 offset:12288
    s_add_u32 s52, s51, 12288
    s_waitcnt lgkmcnt(12)
    v_mfma_f32_16x16x32_bf16 v[28:31], v[100:103], a[0:3], 0
    ds_read_b128 v[136:139], v3 offset:13312
    buffer_load_dwordx4 a[48:51], v2, s[4:7], s52 offen
    v_mfma_f32_16x16x32_bf16 v[60:63], v[100:103], a[72:75], 0
    ds_read_b128 v[156:159], v3 offset:15360
    s_add_u32 s52, s51, 30720
    s_waitcnt lgkmcnt(13)
    v_mfma_f32_16x16x32_bf16 v[32:35], v[112:115], a[0:3], 0
    ds_read_b128 v[160:163], v4 offset:8192
    buffer_load_dwordx4 a[120:123], v2, s[4:7], s52 offen
    v_mfma_f32_16x16x32_bf16 v[64:67], v[112:115], a[72:75], 0
    ds_read_b128 v[164:167], v5 offset:8192
    v_mfma_f32_16x16x32_bf16 v[44:47], a[0:3], v[112:115], 0
    v_mfma_f32_16x16x32_bf16 v[76:79], a[72:75], v[112:115], 0
    s_waitcnt lgkmcnt(14)
    v_mfma_f32_16x16x32_bf16 v[36:39], a[0:3], v[104:107], 0
    v_mfma_f32_16x16x32_bf16 v[68:71], a[72:75], v[104:107], 0
    s_waitcnt lgkmcnt(13)
    v_mfma_f32_16x16x32_bf16 v[40:43], a[0:3], v[108:111], 0
    v_mfma_f32_16x16x32_bf16 v[72:75], a[72:75], v[108:111], 0
    s_waitcnt lgkmcnt(11)
    v_mfma_f32_16x16x32_bf16 v[80:83], v[148:151], v[144:147], 0
    s_waitcnt lgkmcnt(10)
    v_mfma_f32_16x16x32_bf16 v[84:87], v[144:147], v[152:155], 0
    s_mov_b32 m0, s50
    s_nop 0
    buffer_load_dwordx4 v2, s[4:7], s47 offen lds
    s_waitcnt lgkmcnt(9)
    v_mfma_f32_16x16x32_bf16 v[16:19], v[116:119], a[4:7], v[16:19]
    ds_read_b128 v[88:91], v3 offset:16384
    s_add_u32 m0, s50, 1024
    v_mfma_f32_16x16x32_bf16 v[48:51], v[116:119], a[76:79], v[48:51]
    ds_read_b128 v[92:95], v3 offset:17408
    buffer_load_dwordx4 v2, s[4:7], s48 offen lds
    s_waitcnt lgkmcnt(10)
    v_mfma_f32_16x16x32_bf16 v[20:23], v[120:123], a[4:7], v[20:23]
    ds_read_b128 v[96:99], v3 offset:18432
    s_add_u32 s50, s50, 8192
    v_mfma_f32_16x16x32_bf16 v[52:55], v[120:123], a[76:79], v[52:55]
    ds_read_b128 v[100:103], v3 offset:19456
    s_add_u32 s47, s47, 7168
    s_waitcnt lgkmcnt(11)
    v_mfma_f32_16x16x32_bf16 v[24:27], v[124:127], a[4:7], v[24:27]
    ds_read_b128 v[112:115], v3 offset:22528
    s_add_u32 s48, s48, s49
    v_mfma_f32_16x16x32_bf16 v[56:59], v[124:127], a[76:79], v[56:59]
    ds_read_b128 v[104:107], v3 offset:20480
    s_add_u32 s52, s51, 13312
    s_waitcnt lgkmcnt(12)
    v_mfma_f32_16x16x32_bf16 v[28:31], v[128:131], a[4:7], v[28:31]
    ds_read_b128 v[108:111], v3 offset:21504
    buffer_load_dwordx4 a[52:55], v2, s[4:7], s52 offen
    v_mfma_f32_16x16x32_bf16 v[60:63], v[128:131], a[76:79], v[60:63]
    ds_read_b128 v[144:147], v3 offset:23552
    s_add_u32 s52, s51, 31744
    s_waitcnt lgkmcnt(13)
    v_mfma_f32_16x16x32_bf16 v[32:35], v[140:143], a[4:7], v[32:35]
    ds_read_b128 v[148:151], v4 offset:16384
    buffer_load_dwordx4 a[124:127], v2, s[4:7], s52 offen
    v_mfma_f32_16x16x32_bf16 v[64:67], v[140:143], a[76:79], v[64:67]
    ds_read_b128 v[152:155], v5 offset:16384
    v_mfma_f32_16x16x32_bf16 v[44:47], a[4:7], v[140:143], v[44:47]
    v_mfma_f32_16x16x32_bf16 v[76:79], a[76:79], v[140:143], v[76:79]
    s_waitcnt lgkmcnt(14)
    v_mfma_f32_16x16x32_bf16 v[36:39], a[4:7], v[132:135], v[36:39]
    v_mfma_f32_16x16x32_bf16 v[68:71], a[76:79], v[132:135], v[68:71]
    s_waitcnt lgkmcnt(13)
    v_mfma_f32_16x16x32_bf16 v[40:43], a[4:7], v[136:139], v[40:43]
    v_mfma_f32_16x16x32_bf16 v[72:75], a[76:79], v[136:139], v[72:75]
    s_waitcnt lgkmcnt(11)
    v_mfma_f32_16x16x32_bf16 v[80:83], v[160:163], v[156:159], v[80:83]
    s_waitcnt lgkmcnt(10)
    v_mfma_f32_16x16x32_bf16 v[84:87], v[156:159], v[164:167], v[84:87]
    s_mov_b32 m0, s50
    s_nop 0
    buffer_load_dwordx4 v2, s[4:7], s47 offen lds
    s_waitcnt vmcnt(46) lgkmcnt(9)
    v_mfma_f32_16x16x32_bf16 v[16:19], v[88:91], a[8:11], v[16:19]
    s_waitcnt vmcnt(35)
    s_barrier
    v_mfma_f32_16x16x32_bf16 v[48:51], v[88:91], a[80:83], v[48:51]
    ds_read_b128 v[116:119], v3 offset:24576
    ds_read_b128 v[120:123], v3 offset:25600
    s_waitcnt lgkmcnt(10)
    v_mfma_f32_16x16x32_bf16 v[20:23], v[92:95], a[8:11], v[20:23]
    ds_read_b128 v[124:127], v3 offset:26624
    s_add_u32 m0, s50, 1024
    v_mfma_f32_16x16x32_bf16 v[52:55], v[92:95], a[80:83], v[52:55]
    ds_read_b128 v[128:131], v3 offset:27648
    buffer_load_dwordx4 v2, s[4:7], s48 offen lds
    s_waitcnt lgkmcnt(11)
    v_mfma_f32_16x16x32_bf16 v[24:27], v[96:99], a[8:11], v[24:27]
    ds_read_b128 v[140:143], v3 offset:30720
    s_add_u32 s50, s50, 8192
    v_mfma_f32_16x16x32_bf16 v[56:59], v[96:99], a[80:83], v[56:59]
    ds_read_b128 v[132:135], v3 offset:28672
    s_add_u32 s47, s47, 7168
    s_waitcnt lgkmcnt(12)
    v_mfma_f32_16x16x32_bf16 v[28:31], v[100:103], a[8:11], v[28:31]
    ds_read_b128 v[136:139], v3 offset:29696
    s_add_u32 s48, s48, s49
    v_mfma_f32_16x16x32_bf16 v[60:63], v[100:103], a[80:83], v[60:63]
    ds_read_b128 v[156:159], v3 offset:31744
    s_add_u32 s52, s51, 14336
    s_waitcnt lgkmcnt(13)
    v_mfma_f32_16x16x32_bf16 v[32:35], v[112:115], a[8:11], v[32:35]
    ds_read_b128 v[160:163], v4 offset:24576
    buffer_load_dwordx4 a[56:59], v2, s[4:7], s52 offen
    v_mfma_f32_16x16x32_bf16 v[64:67], v[112:115], a[80:83], v[64:67]
    ds_read_b128 v[164:167], v5 offset:24576
    s_add_u32 s52, s51, 32768
    v_mfma_f32_16x16x32_bf16 v[44:47], a[8:11], v[112:115], v[44:47]
    buffer_load_dwordx4 a[128:131], v2, s[4:7], s52 offen
    v_mfma_f32_16x16x32_bf16 v[76:79], a[80:83], v[112:115], v[76:79]
    s_waitcnt lgkmcnt(14)
    v_mfma_f32_16x16x32_bf16 v[36:39], a[8:11], v[104:107], v[36:39]
    v_mfma_f32_16x16x32_bf16 v[68:71], a[80:83], v[104:107], v[68:71]
    s_waitcnt lgkmcnt(13)
    v_mfma_f32_16x16x32_bf16 v[40:43], a[8:11], v[108:111], v[40:43]
    v_mfma_f32_16x16x32_bf16 v[72:75], a[80:83], v[108:111], v[72:75]
    s_waitcnt lgkmcnt(11)
    v_mfma_f32_16x16x32_bf16 v[80:83], v[148:151], v[144:147], v[80:83]
    s_waitcnt lgkmcnt(10)
    v_mfma_f32_16x16x32_bf16 v[84:87], v[144:147], v[152:155], v[84:87]
    s_mov_b32 m0, s50
    s_nop 0
    buffer_load_dwordx4 v2, s[4:7], s47 offen lds
    s_waitcnt lgkmcnt(9)
    v_mfma_f32_16x16x32_bf16 v[16:19], v[116:119], a[12:15], v[16:19]
    ds_read_b128 v[88:91], v3 offset:32768
    s_add_u32 m0, s50, 1024
    v_mfma_f32_16x16x32_bf16 v[48:51], v[116:119], a[84:87], v[48:51]
    ds_read_b128 v[92:95], v3 offset:33792
    buffer_load_dwordx4 v2, s[4:7], s48 offen lds
    s_waitcnt lgkmcnt(10)
    v_mfma_f32_16x16x32_bf16 v[20:23], v[120:123], a[12:15], v[20:23]
    ds_read_b128 v[96:99], v3 offset:34816
    s_add_u32 s50, s50, 8192
    v_mfma_f32_16x16x32_bf16 v[52:55], v[120:123], a[84:87], v[52:55]
    ds_read_b128 v[100:103], v3 offset:35840
    s_add_u32 s47, s47, 7168
    s_waitcnt lgkmcnt(11)
    v_mfma_f32_16x16x32_bf16 v[24:27], v[124:127], a[12:15], v[24:27]
    ds_read_b128 v[112:115], v3 offset:38912
    s_add_u32 s48, s48, s49
    v_mfma_f32_16x16x32_bf16 v[56:59], v[124:127], a[84:87], v[56:59]
    ds_read_b128 v[104:107], v3 offset:36864
    s_add_u32 s52, s51, 15360
    s_waitcnt lgkmcnt(12)
    v_mfma_f32_16x16x32_bf16 v[28:31], v[128:131], a[12:15], v[28:31]
    ds_read_b128 v[108:111], v3 offset:37888
    buffer_load_dwordx4 a[60:63], v2, s[4:7], s52 offen
    v_mfma_f32_16x16x32_bf16 v[60:63], v[128:131], a[84:87], v[60:63]
    ds_read_b128 v[144:147], v3 offset:39936
    s_add_u32 s52, s51, 33792
    s_waitcnt lgkmcnt(13)
    v_mfma_f32_16x16x32_bf16 v[32:35], v[140:143], a[12:15], v[32:35]
    ds_read_b128 v[148:151], v4 offset:32768
    buffer_load_dwordx4 a[132:135], v2, s[4:7], s52 offen
    v_mfma_f32_16x16x32_bf16 v[64:67], v[140:143], a[84:87], v[64:67]
    ds_read_b128 v[152:155], v5 offset:32768
    v_mfma_f32_16x16x32_bf16 v[44:47], a[12:15], v[140:143], v[44:47]
    v_mfma_f32_16x16x32_bf16 v[76:79], a[84:87], v[140:143], v[76:79]
    s_waitcnt lgkmcnt(14)
    v_mfma_f32_16x16x32_bf16 v[36:39], a[12:15], v[132:135], v[36:39]
    v_mfma_f32_16x16x32_bf16 v[68:71], a[84:87], v[132:135], v[68:71]
    s_waitcnt lgkmcnt(13)
    v_mfma_f32_16x16x32_bf16 v[40:43], a[12:15], v[136:139], v[40:43]
    v_mfma_f32_16x16x32_bf16 v[72:75], a[84:87], v[136:139], v[72:75]
    s_waitcnt lgkmcnt(11)
    v_mfma_f32_16x16x32_bf16 v[80:83], v[160:163], v[156:159], v[80:83]
    s_waitcnt lgkmcnt(10)
    v_mfma_f32_16x16x32_bf16 v[84:87], v[156:159], v[164:167], v[84:87]
    s_mov_b32 m0, s50
    s_nop 0
    buffer_load_dwordx4 v2, s[4:7], s47 offen lds
    s_waitcnt lgkmcnt(9)
    v_mfma_f32_16x16x32_bf16 v[16:19], v[88:91], a[16:19], v[16:19]
    ds_read_b128 v[116:119], v3 offset:40960
    s_add_u32 m0, s50, 1024
    v_mfma_f32_16x16x32_bf16 v[48:51], v[88:91], a[88:91], v[48:51]
    ds_read_b128 v[120:123], v3 offset:41984
    buffer_load_dwordx4 v2, s[4:7], s48 offen lds
    s_waitcnt lgkmcnt(10)
    v_mfma_f32_16x16x32_bf16 v[20:23], v[92:95], a[16:19], v[20:23]
    ds_read_b128 v[124:127], v3 offset:43008
    s_add_u32 s50, s50, 8192
    v_mfma_f32_16x16x32_bf16 v[52:55], v[92:95], a[88:91], v[52:55]
    ds_read_b128 v[128:131], v3 offset:44032
    s_add_u32 s47, s47, 7168
    s_waitcnt lgkmcnt(11)
    v_mfma_f32_16x16x32_bf16 v[24:27], v[96:99], a[16:19], v[24:27]
    ds_read_b128 v[140:143], v3 offset:47104
    s_add_u32 s48, s48, s49
    v_mfma_f32_16x16x32_bf16 v[56:59], v[96:99], a[88:91], v[56:59]
    ds_read_b128 v[132:135], v3 offset:45056
    s_add_u32 s52, s51, 16384
    s_waitcnt lgkmcnt(12)
    v_mfma_f32_16x16x32_bf16 v[28:31], v[100:103], a[16:19], v[28:31]
    ds_read_b128 v[136:139], v3 offset:46080
    buffer_load_dwordx4 a[64:67], v2, s[4:7], s52 offen
    v_mfma_f32_16x16x32_bf16 v[60:63], v[100:103], a[88:91], v[60:63]
    ds_read_b128 v[156:159], v3 offset:48128
    s_add_u32 s52, s51, 34816
    s_waitcnt lgkmcnt(13)
    v_mfma_f32_16x16x32_bf16 v[32:35], v[112:115], a[16:19], v[32:35]
    ds_read_b128 v[160:163], v4 offset:40960
    buffer_load_dwordx4 a[136:139], v2, s[4:7], s52 offen
    v_mfma_f32_16x16x32_bf16 v[64:67], v[112:115], a[88:91], v[64:67]
    ds_read_b128 v[164:167], v5 offset:40960
    v_mfma_f32_16x16x32_bf16 v[44:47], a[16:19], v[112:115], v[44:47]
    v_mfma_f32_16x16x32_bf16 v[76:79], a[88:91], v[112:115], v[76:79]
    s_waitcnt lgkmcnt(14)
    v_mfma_f32_16x16x32_bf16 v[36:39], a[16:19], v[104:107], v[36:39]
    v_mfma_f32_16x16x32_bf16 v[68:71], a[88:91], v[104:107], v[68:71]
    s_waitcnt lgkmcnt(13)
    v_mfma_f32_16x16x32_bf16 v[40:43], a[16:19], v[108:111], v[40:43]
    v_mfma_f32_16x16x32_bf16 v[72:75], a[88:91], v[108:111], v[72:75]
    s_waitcnt lgkmcnt(11)
    v_mfma_f32_16x16x32_bf16 v[80:83], v[148:151], v[144:147], v[80:83]
    s_waitcnt lgkmcnt(10)
    v_mfma_f32_16x16x32_bf16 v[84:87], v[144:147], v[152:155], v[84:87]
    s_mov_b32 m0, s50
    s_nop 0
    buffer_load_dwordx4 v2, s[4:7], s47 offen lds
    s_waitcnt vmcnt(46) lgkmcnt(9)
    v_mfma_f32_16x16x32_bf16 v[16:19], v[116:119], a[20:23], v[16:19]
    s_waitcnt vmcnt(35)
    s_barrier
    v_mfma_f32_16x16x32_bf16 v[48:51], v[116:119], a[92:95], v[48:51]
    ds_read_b128 v[88:91], v3 offset:49152
    ds_read_b128 v[92:95], v3 offset:50176
    s_waitcnt lgkmcnt(10)
    v_mfma_f32_16x16x32_bf16 v[20:23], v[120:123], a[20:23], v[20:23]
    ds_read_b128 v[96:99], v3 offset:51200
    s_add_u32 m0, s50, 1024
    v_mfma_f32_16x16x32_bf16 v[52:55], v[120:123], a[92:95], v[52:55]
    ds_read_b128 v[100:103], v3 offset:52224
    buffer_load_dwordx4 v2, s[4:7], s48 offen lds
    s_waitcnt lgkmcnt(11)
    v_mfma_f32_16x16x32_bf16 v[24:27], v[124:127], a[20:23], v[24:27]
    ds_read_b128 v[112:115], v3 offset:55296
    s_add_u32 s50, s50, 8192
    v_mfma_f32_16x16x32_bf16 v[56:59], v[124:127], a[92:95], v[56:59]
    ds_read_b128 v[104:107], v3 offset:53248
    s_add_u32 s47, s47, 7168
    s_waitcnt lgkmcnt(12)
    v_mfma_f32_16x16x32_bf16 v[28:31], v[128:131], a[20:23], v[28:31]
    ds_read_b128 v[108:111], v3 offset:54272
    s_add_u32 s48, s48, s49
    v_mfma_f32_16x16x32_bf16 v[60:63], v[128:131], a[92:95], v[60:63]
    ds_read_b128 v[144:147], v3 offset:56320
    s_add_u32 s52, s51, 17408
    s_waitcnt lgkmcnt(13)
    v_mfma_f32_16x16x32_bf16 v[32:35], v[140:143], a[20:23], v[32:35]
    ds_read_b128 v[148:151], v4 offset:49152
    buffer_load_dwordx4 a[68:71], v2, s[4:7], s52 offen
    v_mfma_f32_16x16x32_bf16 v[64:67], v[140:143], a[92:95], v[64:67]
    ds_read_b128 v[152:155], v5 offset:49152
    s_add_u32 s52, s51, 35840
    v_mfma_f32_16x16x32_bf16 v[44:47], a[20:23], v[140:143], v[44:47]
    buffer_load_dwordx4 a[140:143], v2, s[4:7], s52 offen
    v_mfma_f32_16x16x32_bf16 v[76:79], a[92:95], v[140:143], v[76:79]
    s_waitcnt lgkmcnt(14)
    v_mfma_f32_16x16x32_bf16 v[36:39], a[20:23], v[132:135], v[36:39]
    v_mfma_f32_16x16x32_bf16 v[68:71], a[92:95], v[132:135], v[68:71]
    s_waitcnt lgkmcnt(13)
    v_mfma_f32_16x16x32_bf16 v[40:43], a[20:23], v[136:139], v[40:43]
    v_mfma_f32_16x16x32_bf16 v[72:75], a[92:95], v[136:139], v[72:75]
    s_waitcnt lgkmcnt(11)
    v_mfma_f32_16x16x32_bf16 v[80:83], v[160:163], v[156:159], v[80:83]
    s_waitcnt lgkmcnt(10)
    v_mfma_f32_16x16x32_bf16 v[84:87], v[156:159], v[164:167], v[84:87]
    s_waitcnt lgkmcnt(9)
    v_mfma_f32_16x16x32_bf16 v[16:19], v[88:91], a[24:27], v[16:19]
    ds_read_b128 v[116:119], v3 offset:57344
    v_mfma_f32_16x16x32_bf16 v[48:51], v[88:91], a[96:99], v[48:51]
    ds_read_b128 v[120:123], v3 offset:58368
    s_waitcnt lgkmcnt(10)
    v_mfma_f32_16x16x32_bf16 v[20:23], v[92:95], a[24:27], v[20:23]
    ds_read_b128 v[124:127], v3 offset:59392
    v_mfma_f32_16x16x32_bf16 v[52:55], v[92:95], a[96:99], v[52:55]
    ds_read_b128 v[128:131], v3 offset:60416
    s_waitcnt lgkmcnt(11)
    v_mfma_f32_16x16x32_bf16 v[24:27], v[96:99], a[24:27], v[24:27]
    ds_read_b128 v[140:143], v3 offset:63488
    v_mfma_f32_16x16x32_bf16 v[56:59], v[96:99], a[96:99], v[56:59]
    ds_read_b128 v[132:135], v3 offset:61440
    s_waitcnt lgkmcnt(12)
    v_mfma_f32_16x16x32_bf16 v[28:31], v[100:103], a[24:27], v[28:31]
    ds_read_b128 v[136:139], v3 offset:62464
    v_mfma_f32_16x16x32_bf16 v[60:63], v[100:103], a[96:99], v[60:63]
    ds_read_b128 v[156:159], v3 offset:64512
    s_waitcnt lgkmcnt(13)
    v_mfma_f32_16x16x32_bf16 v[32:35], v[112:115], a[24:27], v[32:35]
    ds_read_b128 v[160:163], v4 offset:57344
    v_mfma_f32_16x16x32_bf16 v[64:67], v[112:115], a[96:99], v[64:67]
    ds_read_b128 v[164:167], v5 offset:57344
    v_mfma_f32_16x16x32_bf16 v[44:47], a[24:27], v[112:115], v[44:47]
    v_mfma_f32_16x16x32_bf16 v[76:79], a[96:99], v[112:115], v[76:79]
    s_waitcnt lgkmcnt(14)
    v_mfma_f32_16x16x32_bf16 v[36:39], a[24:27], v[104:107], v[36:39]
    v_mfma_f32_16x16x32_bf16 v[68:71], a[96:99], v[104:107], v[68:71]
    s_waitcnt lgkmcnt(13)
    v_mfma_f32_16x16x32_bf16 v[40:43], a[24:27], v[108:111], v[40:43]
    v_mfma_f32_16x16x32_bf16 v[72:75], a[96:99], v[108:111], v[72:75]
    s_waitcnt lgkmcnt(11)
    v_mfma_f32_16x16x32_bf16 v[80:83], v[148:151], v[144:147], v[80:83]
    s_waitcnt lgkmcnt(10)
    v_mfma_f32_16x16x32_bf16 v[84:87], v[144:147], v[152:155], v[84:87]
    s_waitcnt lgkmcnt(9)
    v_mfma_f32_16x16x32_bf16 v[16:19], v[116:119], a[28:31], v[16:19]
    v_add_u32 v3, 0x10000, v3
    v_mfma_f32_16x16x32_bf16 v[48:51], v[116:119], a[100:103], v[48:51]
    v_add_u32 v4, 0x10000, v4
    s_waitcnt lgkmcnt(8)
    v_mfma_f32_16x16x32_bf16 v[20:23], v[120:123], a[28:31], v[20:23]
    v_add_u32 v5, 0x10000, v5
    v_mfma_f32_16x16x32_bf16 v[52:55], v[120:123], a[100:103], v[52:55]
    ds_read_b128 v[88:91], v3 offset:0
    s_waitcnt lgkmcnt(8)
    v_mfma_f32_16x16x32_bf16 v[24:27], v[124:127], a[28:31], v[24:27]
    ds_read_b128 v[92:95], v3 offset:1024
    v_mfma_f32_16x16x32_bf16 v[56:59], v[124:127], a[100:103], v[56:59]
    ds_read_b128 v[96:99], v3 offset:2048
    s_waitcnt lgkmcnt(9)
    v_mfma_f32_16x16x32_bf16 v[28:31], v[128:131], a[28:31], v[28:31]
    ds_read_b128 v[100:103], v3 offset:3072
    v_mfma_f32_16x16x32_bf16 v[60:63], v[128:131], a[100:103], v[60:63]
    ds_read_b128 v[112:115], v3 offset:6144
    s_waitcnt lgkmcnt(10)
    v_mfma_f32_16x16x32_bf16 v[32:35], v[140:143], a[28:31], v[32:35]
    ds_read_b128 v[104:107], v3 offset:4096
    v_mfma_f32_16x16x32_bf16 v[64:67], v[140:143], a[100:103], v[64:67]
    ds_read_b128 v[108:111], v3 offset:5120
    v_mfma_f32_16x16x32_bf16 v[44:47], a[28:31], v[140:143], v[44:47]
    ds_read_b128 v[144:147], v3 offset:7168
    v_mfma_f32_16x16x32_bf16 v[76:79], a[100:103], v[140:143], v[76:79]
    ds_read_b128 v[148:151], v4 offset:0
    s_waitcnt lgkmcnt(13)
    v_mfma_f32_16x16x32_bf16 v[36:39], a[28:31], v[132:135], v[36:39]
    ds_read_b128 v[152:155], v5 offset:0
    v_mfma_f32_16x16x32_bf16 v[68:71], a[100:103], v[132:135], v[68:71]
    s_waitcnt lgkmcnt(13)
    v_mfma_f32_16x16x32_bf16 v[40:43], a[28:31], v[136:139], v[40:43]
    v_mfma_f32_16x16x32_bf16 v[72:75], a[100:103], v[136:139], v[72:75]
    s_waitcnt lgkmcnt(11)
    v_mfma_f32_16x16x32_bf16 v[80:83], v[160:163], v[156:159], v[80:83]
    s_waitcnt lgkmcnt(10)
    v_mfma_f32_16x16x32_bf16 v[84:87], v[156:159], v[164:167], v[84:87]
    s_waitcnt vmcnt(37) lgkmcnt(9)
    v_mfma_f32_16x16x32_bf16 v[16:19], v[88:91], a[32:35], v[16:19]
    s_waitcnt vmcnt(26)
    s_barrier
    v_mfma_f32_16x16x32_bf16 v[48:51], v[88:91], a[104:107], v[48:51]
    ds_read_b128 v[116:119], v3 offset:8192
    ds_read_b128 v[120:123], v3 offset:9216
    s_waitcnt lgkmcnt(10)
    v_mfma_f32_16x16x32_bf16 v[20:23], v[92:95], a[32:35], v[20:23]
    ds_read_b128 v[124:127], v3 offset:10240
    v_mfma_f32_16x16x32_bf16 v[52:55], v[92:95], a[104:107], v[52:55]
    ds_read_b128 v[128:131], v3 offset:11264
    s_waitcnt lgkmcnt(11)
    v_mfma_f32_16x16x32_bf16 v[24:27], v[96:99], a[32:35], v[24:27]
    ds_read_b128 v[140:143], v3 offset:14336
    v_mfma_f32_16x16x32_bf16 v[56:59], v[96:99], a[104:107], v[56:59]
    ds_read_b128 v[132:135], v3 offset:12288
    s_waitcnt lgkmcnt(12)
    v_mfma_f32_16x16x32_bf16 v[28:31], v[100:103], a[32:35], v[28:31]
    ds_read_b128 v[136:139], v3 offset:13312
    v_mfma_f32_16x16x32_bf16 v[60:63], v[100:103], a[104:107], v[60:63]
    ds_read_b128 v[156:159], v3 offset:15360
    s_waitcnt lgkmcnt(13)
    v_mfma_f32_16x16x32_bf16 v[32:35], v[112:115], a[32:35], v[32:35]
    ds_read_b128 v[160:163], v4 offset:8192
    v_mfma_f32_16x16x32_bf16 v[64:67], v[112:115], a[104:107], v[64:67]
    ds_read_b128 v[164:167], v5 offset:8192
    v_mfma_f32_16x16x32_bf16 v[44:47], a[32:35], v[112:115], v[44:47]
    v_mfma_f32_16x16x32_bf16 v[76:79], a[104:107], v[112:115], v[76:79]
    s_waitcnt lgkmcnt(14)
    v_mfma_f32_16x16x32_bf16 v[36:39], a[32:35], v[104:107], v[36:39]
    v_mfma_f32_16x16x32_bf16 v[68:71], a[104:107], v[104:107], v[68:71]
    s_waitcnt lgkmcnt(13)
    v_mfma_f32_16x16x32_bf16 v[40:43], a[32:35], v[108:111], v[40:43]
    v_mfma_f32_16x16x32_bf16 v[72:75], a[104:107], v[108:111], v[72:75]
    s_waitcnt lgkmcnt(11)
    v_mfma_f32_16x16x32_bf16 v[80:83], v[148:151], v[144:147], v[80:83]
    s_waitcnt lgkmcnt(10)
    v_mfma_f32_16x16x32_bf16 v[84:87], v[144:147], v[152:155], v[84:87]
    s_waitcnt lgkmcnt(9)
    v_mfma_f32_16x16x32_bf16 v[16:19], v[116:119], a[36:39], v[16:19]
    ds_read_b128 v[88:91], v3 offset:16384
    v_mfma_f32_16x16x32_bf16 v[48:51], v[116:119], a[108:111], v[48:51]
    ds_read_b128 v[92:95], v3 offset:17408
    s_waitcnt lgkmcnt(10)
    v_mfma_f32_16x16x32_bf16 v[20:23], v[120:123], a[36:39], v[20:23]
    ds_read_b128 v[96:99], v3 offset:18432
    v_mfma_f32_16x16x32_bf16 v[52:55], v[120:123], a[108:111], v[52:55]
    ds_read_b128 v[100:103], v3 offset:19456
    s_waitcnt lgkmcnt(11)
    v_mfma_f32_16x16x32_bf16 v[24:27], v[124:127], a[36:39], v[24:27]
    ds_read_b128 v[112:115], v3 offset:22528
    v_mfma_f32_16x16x32_bf16 v[56:59], v[124:127], a[108:111], v[56:59]
    ds_read_b128 v[104:107], v3 offset:20480
    s_waitcnt lgkmcnt(12)
    v_mfma_f32_16x16x32_bf16 v[28:31], v[128:131], a[36:39], v[28:31]
    ds_read_b128 v[108:111], v3 offset:21504
    v_mfma_f32_16x16x32_bf16 v[60:63], v[128:131], a[108:111], v[60:63]
    ds_read_b128 v[144:147], v3 offset:23552
    s_waitcnt lgkmcnt(13)
    v_mfma_f32_16x16x32_bf16 v[32:35], v[140:143], a[36:39], v[32:35]
    ds_read_b128 v[148:151], v4 offset:16384
    v_mfma_f32_16x16x32_bf16 v[64:67], v[140:143], a[108:111], v[64:67]
    ds_read_b128 v[152:155], v5 offset:16384
    v_mfma_f32_16x16x32_bf16 v[44:47], a[36:39], v[140:143], v[44:47]
    v_mfma_f32_16x16x32_bf16 v[76:79], a[108:111], v[140:143], v[76:79]
    s_waitcnt lgkmcnt(14)
    v_mfma_f32_16x16x32_bf16 v[36:39], a[36:39], v[132:135], v[36:39]
    v_mfma_f32_16x16x32_bf16 v[68:71], a[108:111], v[132:135], v[68:71]
    s_waitcnt lgkmcnt(13)
    v_mfma_f32_16x16x32_bf16 v[40:43], a[36:39], v[136:139], v[40:43]
    v_mfma_f32_16x16x32_bf16 v[72:75], a[108:111], v[136:139], v[72:75]
    s_waitcnt lgkmcnt(11)
    v_mfma_f32_16x16x32_bf16 v[80:83], v[160:163], v[156:159], v[80:83]
    s_waitcnt lgkmcnt(10)
    v_mfma_f32_16x16x32_bf16 v[84:87], v[156:159], v[164:167], v[84:87]
    s_waitcnt lgkmcnt(9)
    v_mfma_f32_16x16x32_bf16 v[16:19], v[88:91], a[40:43], v[16:19]
    ds_read_b128 v[116:119], v3 offset:24576
    v_mfma_f32_16x16x32_bf16 v[48:51], v[88:91], a[112:115], v[48:51]
    ds_read_b128 v[120:123], v3 offset:25600
    s_waitcnt lgkmcnt(10)
    v_mfma_f32_16x16x32_bf16 v[20:23], v[92:95], a[40:43], v[20:23]
    ds_read_b128 v[124:127], v3 offset:26624
    v_mfma_f32_16x16x32_bf16 v[52:55], v[92:95], a[112:115], v[52:55]
    ds_read_b128 v[128:131], v3 offset:27648
    s_waitcnt lgkmcnt(11)
    v_mfma_f32_16x16x32_bf16 v[24:27], v[96:99], a[40:43], v[24:27]
    ds_read_b128 v[140:143], v3 offset:30720
    v_mfma_f32_16x16x32_bf16 v[56:59], v[96:99], a[112:115], v[56:59]
    ds_read_b128 v[132:135], v3 offset:28672
    s_waitcnt lgkmcnt(12)
    v_mfma_f32_16x16x32_bf16 v[28:31], v[100:103], a[40:43], v[28:31]
    ds_read_b128 v[136:139], v3 offset:29696
    v_mfma_f32_16x16x32_bf16 v[60:63], v[100:103], a[112:115], v[60:63]
    ds_read_b128 v[156:159], v3 offset:31744
    s_waitcnt lgkmcnt(13)
    v_mfma_f32_16x16x32_bf16 v[32:35], v[112:115], a[40:43], v[32:35]
    ds_read_b128 v[160:163], v4 offset:24576
    v_mfma_f32_16x16x32_bf16 v[64:67], v[112:115], a[112:115], v[64:67]
    ds_read_b128 v[164:167], v5 offset:24576
    v_mfma_f32_16x16x32_bf16 v[44:47], a[40:43], v[112:115], v[44:47]
    v_mfma_f32_16x16x32_bf16 v[76:79], a[112:115], v[112:115], v[76:79]
    s_waitcnt lgkmcnt(14)
    v_mfma_f32_16x16x32_bf16 v[36:39], a[40:43], v[104:107], v[36:39]
    v_mfma_f32_16x16x32_bf16 v[68:71], a[112:115], v[104:107], v[68:71]
    s_waitcnt lgkmcnt(13)
    v_mfma_f32_16x16x32_bf16 v[40:43], a[40:43], v[108:111], v[40:43]
    v_mfma_f32_16x16x32_bf16 v[72:75], a[112:115], v[108:111], v[72:75]
    s_waitcnt lgkmcnt(11)
    v_mfma_f32_16x16x32_bf16 v[80:83], v[148:151], v[144:147], v[80:83]
    s_waitcnt lgkmcnt(10)
    v_mfma_f32_16x16x32_bf16 v[84:87], v[144:147], v[152:155], v[84:87]
    s_waitcnt vmcnt(25) lgkmcnt(9)
    v_mfma_f32_16x16x32_bf16 v[16:19], v[116:119], a[44:47], v[16:19]
    s_waitcnt vmcnt(14)
    s_barrier
    v_mfma_f32_16x16x32_bf16 v[48:51], v[116:119], a[116:119], v[48:51]
    ds_read_b128 v[88:91], v3 offset:32768
    ds_read_b128 v[92:95], v3 offset:33792
    s_waitcnt lgkmcnt(10)
    v_mfma_f32_16x16x32_bf16 v[20:23], v[120:123], a[44:47], v[20:23]
    ds_read_b128 v[96:99], v3 offset:34816
    v_mfma_f32_16x16x32_bf16 v[52:55], v[120:123], a[116:119], v[52:55]
    ds_read_b128 v[100:103], v3 offset:35840
    s_waitcnt lgkmcnt(11)
    v_mfma_f32_16x16x32_bf16 v[24:27], v[124:127], a[44:47], v[24:27]
    ds_read_b128 v[112:115], v3 offset:38912
    v_mfma_f32_16x16x32_bf16 v[56:59], v[124:127], a[116:119], v[56:59]
    ds_read_b128 v[104:107], v3 offset:36864
    s_waitcnt lgkmcnt(12)
    v_mfma_f32_16x16x32_bf16 v[28:31], v[128:131], a[44:47], v[28:31]
    ds_read_b128 v[108:111], v3 offset:37888
    v_mfma_f32_16x16x32_bf16 v[60:63], v[128:131], a[116:119], v[60:63]
    ds_read_b128 v[144:147], v3 offset:39936
    s_waitcnt lgkmcnt(13)
    v_mfma_f32_16x16x32_bf16 v[32:35], v[140:143], a[44:47], v[32:35]
    ds_read_b128 v[148:151], v4 offset:32768
    v_mfma_f32_16x16x32_bf16 v[64:67], v[140:143], a[116:119], v[64:67]
    ds_read_b128 v[152:155], v5 offset:32768
    v_mfma_f32_16x16x32_bf16 v[44:47], a[44:47], v[140:143], v[44:47]
    v_mfma_f32_16x16x32_bf16 v[76:79], a[116:119], v[140:143], v[76:79]
    s_waitcnt lgkmcnt(14)
    v_mfma_f32_16x16x32_bf16 v[36:39], a[44:47], v[132:135], v[36:39]
    v_mfma_f32_16x16x32_bf16 v[68:71], a[116:119], v[132:135], v[68:71]
    s_waitcnt lgkmcnt(13)
    v_mfma_f32_16x16x32_bf16 v[40:43], a[44:47], v[136:139], v[40:43]
    v_mfma_f32_16x16x32_bf16 v[72:75], a[116:119], v[136:139], v[72:75]
    s_waitcnt lgkmcnt(11)
    v_mfma_f32_16x16x32_bf16 v[80:83], v[160:163], v[156:159], v[80:83]
    s_waitcnt lgkmcnt(10)
    v_mfma_f32_16x16x32_bf16 v[84:87], v[156:159], v[164:167], v[84:87]
    s_waitcnt lgkmcnt(9)
    v_mfma_f32_16x16x32_bf16 v[16:19], v[88:91], a[48:51], v[16:19]
    ds_read_b128 v[116:119], v3 offset:40960
    v_mfma_f32_16x16x32_bf16 v[48:51], v[88:91], a[120:123], v[48:51]
    ds_read_b128 v[120:123], v3 offset:41984
    s_waitcnt lgkmcnt(10)
    v_mfma_f32_16x16x32_bf16 v[20:23], v[92:95], a[48:51], v[20:23]
    ds_read_b128 v[124:127], v3 offset:43008
    v_mfma_f32_16x16x32_bf16 v[52:55], v[92:95], a[120:123], v[52:55]
    ds_read_b128 v[128:131], v3 offset:44032
    s_waitcnt lgkmcnt(11)
    v_mfma_f32_16x16x32_bf16 v[24:27], v[96:99], a[48:51], v[24:27]
    ds_read_b128 v[140:143], v3 offset:47104
    v_mfma_f32_16x16x32_bf16 v[56:59], v[96:99], a[120:123], v[56:59]
    ds_read_b128 v[132:135], v3 offset:45056
    s_waitcnt lgkmcnt(12)
    v_mfma_f32_16x16x32_bf16 v[28:31], v[100:103], a[48:51], v[28:31]
    ds_read_b128 v[136:139], v3 offset:46080
    v_mfma_f32_16x16x32_bf16 v[60:63], v[100:103], a[120:123], v[60:63]
    ds_read_b128 v[156:159], v3 offset:48128
    s_waitcnt lgkmcnt(13)
    v_mfma_f32_16x16x32_bf16 v[32:35], v[112:115], a[48:51], v[32:35]
    ds_read_b128 v[160:163], v4 offset:40960
    v_mfma_f32_16x16x32_bf16 v[64:67], v[112:115], a[120:123], v[64:67]
    ds_read_b128 v[164:167], v5 offset:40960
    v_mfma_f32_16x16x32_bf16 v[44:47], a[48:51], v[112:115], v[44:47]
    v_mfma_f32_16x16x32_bf16 v[76:79], a[120:123], v[112:115], v[76:79]
    s_waitcnt lgkmcnt(14)
    v_mfma_f32_16x16x32_bf16 v[36:39], a[48:51], v[104:107], v[36:39]
    v_mfma_f32_16x16x32_bf16 v[68:71], a[120:123], v[104:107], v[68:71]
    s_waitcnt lgkmcnt(13)
    v_mfma_f32_16x16x32_bf16 v[40:43], a[48:51], v[108:111], v[40:43]
    v_mfma_f32_16x16x32_bf16 v[72:75], a[120:123], v[108:111], v[72:75]
    s_waitcnt lgkmcnt(11)
    v_mfma_f32_16x16x32_bf16 v[80:83], v[148:151], v[144:147], v[80:83]
    s_waitcnt lgkmcnt(10)
    v_mfma_f32_16x16x32_bf16 v[84:87], v[144:147], v[152:155], v[84:87]
    s_waitcnt lgkmcnt(9)
    v_mfma_f32_16x16x32_bf16 v[16:19], v[116:119], a[52:55], v[16:19]
    ds_read_b128 v[88:91], v3 offset:49152
    v_mfma_f32_16x16x32_bf16 v[48:51], v[116:119], a[124:127], v[48:51]
    ds_read_b128 v[92:95], v3 offset:50176
    s_waitcnt lgkmcnt(10)
    v_mfma_f32_16x16x32_bf16 v[20:23], v[120:123], a[52:55], v[20:23]
    ds_read_b128 v[96:99], v3 offset:51200
    v_mfma_f32_16x16x32_bf16 v[52:55], v[120:123], a[124:127], v[52:55]
    ds_read_b128 v[100:103], v3 offset:52224
    s_waitcnt lgkmcnt(11)
    v_mfma_f32_16x16x32_bf16 v[24:27], v[124:127], a[52:55], v[24:27]
    ds_read_b128 v[112:115], v3 offset:55296
    v_mfma_f32_16x16x32_bf16 v[56:59], v[124:127], a[124:127], v[56:59]
    ds_read_b128 v[104:107], v3 offset:53248
    s_waitcnt lgkmcnt(12)
    v_mfma_f32_16x16x32_bf16 v[28:31], v[128:131], a[52:55], v[28:31]
    ds_read_b128 v[108:111], v3 offset:54272
    v_mfma_f32_16x16x32_bf16 v[60:63], v[128:131], a[124:127], v[60:63]
    ds_read_b128 v[144:147], v3 offset:56320
    s_waitcnt lgkmcnt(13)
    v_mfma_f32_16x16x32_bf16 v[32:35], v[140:143], a[52:55], v[32:35]
    ds_read_b128 v[148:151], v4 offset:49152
    v_mfma_f32_16x16x32_bf16 v[64:67], v[140:143], a[124:127], v[64:67]
    ds_read_b128 v[152:155], v5 offset:49152
    v_mfma_f32_16x16x32_bf16 v[44:47], a[52:55], v[140:143], v[44:47]
    v_mfma_f32_16x16x32_bf16 v[76:79], a[124:127], v[140:143], v[76:79]
    s_waitcnt lgkmcnt(14)
    v_mfma_f32_16x16x32_bf16 v[36:39], a[52:55], v[132:135], v[36:39]
    v_mfma_f32_16x16x32_bf16 v[68:71], a[124:127], v[132:135], v[68:71]
    s_waitcnt lgkmcnt(13)
    v_mfma_f32_16x16x32_bf16 v[40:43], a[52:55], v[136:139], v[40:43]
    v_mfma_f32_16x16x32_bf16 v[72:75], a[124:127], v[136:139], v[72:75]
    s_waitcnt lgkmcnt(11)
    v_mfma_f32_16x16x32_bf16 v[80:83], v[160:163], v[156:159], v[80:83]
    s_waitcnt lgkmcnt(10)
    v_mfma_f32_16x16x32_bf16 v[84:87], v[156:159], v[164:167], v[84:87]
    s_waitcnt vmcnt(13) lgkmcnt(9)
    v_mfma_f32_16x16x32_bf16 v[16:19], v[88:91], a[56:59], v[16:19]
    s_waitcnt vmcnt(2)
    s_barrier
    v_mfma_f32_16x16x32_bf16 v[48:51], v[88:91], a[128:131], v[48:51]
    ds_read_b128 v[116:119], v3 offset:57344
    ds_read_b128 v[120:123], v3 offset:58368
    s_waitcnt lgkmcnt(10)
    v_mfma_f32_16x16x32_bf16 v[20:23], v[92:95], a[56:59], v[20:23]
    ds_read_b128 v[124:127], v3 offset:59392
    v_mfma_f32_16x16x32_bf16 v[52:55], v[92:95], a[128:131], v[52:55]
    ds_read_b128 v[128:131], v3 offset:60416
    s_waitcnt lgkmcnt(11)
    v_mfma_f32_16x16x32_bf16 v[24:27], v[96:99], a[56:59], v[24:27]
    ds_read_b128 v[140:143], v3 offset:63488
    v_mfma_f32_16x16x32_bf16 v[56:59], v[96:99], a[128:131], v[56:59]
    ds_read_b128 v[132:135], v3 offset:61440
    s_waitcnt lgkmcnt(12)
    v_mfma_f32_16x16x32_bf16 v[28:31], v[100:103], a[56:59], v[28:31]
    ds_read_b128 v[136:139], v3 offset:62464
    v_mfma_f32_16x16x32_bf16 v[60:63], v[100:103], a[128:131], v[60:63]
    ds_read_b128 v[156:159], v3 offset:64512
    s_waitcnt lgkmcnt(13)
    v_mfma_f32_16x16x32_bf16 v[32:35], v[112:115], a[56:59], v[32:35]
    ds_read_b128 v[160:163], v4 offset:57344
    v_mfma_f32_16x16x32_bf16 v[64:67], v[112:115], a[128:131], v[64:67]
    ds_read_b128 v[164:167], v5 offset:57344
    v_mfma_f32_16x16x32_bf16 v[44:47], a[56:59], v[112:115], v[44:47]
    v_mfma_f32_16x16x32_bf16 v[76:79], a[128:131], v[112:115], v[76:79]
    s_waitcnt lgkmcnt(14)
    v_mfma_f32_16x16x32_bf16 v[36:39], a[56:59], v[104:107], v[36:39]
    v_mfma_f32_16x16x32_bf16 v[68:71], a[128:131], v[104:107], v[68:71]
    s_waitcnt lgkmcnt(13)
    v_mfma_f32_16x16x32_bf16 v[40:43], a[56:59], v[108:111], v[40:43]
    v_mfma_f32_16x16x32_bf16 v[72:75], a[128:131], v[108:111], v[72:75]
    s_waitcnt lgkmcnt(11)
    v_mfma_f32_16x16x32_bf16 v[80:83], v[148:151], v[144:147], v[80:83]
    s_waitcnt lgkmcnt(10)
    v_mfma_f32_16x16x32_bf16 v[84:87], v[144:147], v[152:155], v[84:87]
    s_waitcnt lgkmcnt(9)
    v_mfma_f32_16x16x32_bf16 v[16:19], v[116:119], a[60:63], v[16:19]
    v_add_u32 v3, 0x10000, v3
    v_mfma_f32_16x16x32_bf16 v[48:51], v[116:119], a[132:135], v[48:51]
    v_add_u32 v4, 0x10000, v4
    s_waitcnt lgkmcnt(8)
    v_mfma_f32_16x16x32_bf16 v[20:23], v[120:123], a[60:63], v[20:23]
    v_add_u32 v5, 0x10000, v5
    v_mfma_f32_16x16x32_bf16 v[52:55], v[120:123], a[132:135], v[52:55]
    ds_read_b128 v[88:91], v3 offset:0
    s_waitcnt lgkmcnt(8)
    v_mfma_f32_16x16x32_bf16 v[24:27], v[124:127], a[60:63], v[24:27]
    ds_read_b128 v[92:95], v3 offset:1024
    v_mfma_f32_16x16x32_bf16 v[56:59], v[124:127], a[132:135], v[56:59]
    ds_read_b128 v[96:99], v3 offset:2048
    s_waitcnt lgkmcnt(9)
    v_mfma_f32_16x16x32_bf16 v[28:31], v[128:131], a[60:63], v[28:31]
    ds_read_b128 v[100:103], v3 offset:3072
    v_mfma_f32_16x16x32_bf16 v[60:63], v[128:131], a[132:135], v[60:63]
    ds_read_b128 v[112:115], v3 offset:6144
    s_waitcnt lgkmcnt(10)
    v_mfma_f32_16x16x32_bf16 v[32:35], v[140:143], a[60:63], v[32:35]
    ds_read_b128 v[104:107], v3 offset:4096
    v_mfma_f32_16x16x32_bf16 v[64:67], v[140:143], a[132:135], v[64:67]
    ds_read_b128 v[108:111], v3 offset:5120
    v_mfma_f32_16x16x32_bf16 v[44:47], a[60:63], v[140:143], v[44:47]
    ds_read_b128 v[144:147], v3 offset:7168
    v_mfma_f32_16x16x32_bf16 v[76:79], a[132:135], v[140:143], v[76:79]
    ds_read_b128 v[148:151], v4 offset:0
    s_waitcnt lgkmcnt(13)
    v_mfma_f32_16x16x32_bf16 v[36:39], a[60:63], v[132:135], v[36:39]
    ds_read_b128 v[152:155], v5 offset:0
    v_mfma_f32_16x16x32_bf16 v[68:71], a[132:135], v[132:135], v[68:71]
    s_waitcnt lgkmcnt(13)
    v_mfma_f32_16x16x32_bf16 v[40:43], a[60:63], v[136:139], v[40:43]
    v_mfma_f32_16x16x32_bf16 v[72:75], a[132:135], v[136:139], v[72:75]
    s_waitcnt lgkmcnt(11)
    v_mfma_f32_16x16x32_bf16 v[80:83], v[160:163], v[156:159], v[80:83]
    s_waitcnt lgkmcnt(10)
    v_mfma_f32_16x16x32_bf16 v[84:87], v[156:159], v[164:167], v[84:87]
    s_waitcnt lgkmcnt(9)
    v_mfma_f32_16x16x32_bf16 v[16:19], v[88:91], a[64:67], v[16:19]
    ds_read_b128 v[116:119], v3 offset:8192
    v_mfma_f32_16x16x32_bf16 v[48:51], v[88:91], a[136:139], v[48:51]
    ds_read_b128 v[120:123], v3 offset:9216
    s_waitcnt lgkmcnt(10)
    v_mfma_f32_16x16x32_bf16 v[20:23], v[92:95], a[64:67], v[20:23]
    ds_read_b128 v[124:127], v3 offset:10240
    v_mfma_f32_16x16x32_bf16 v[52:55], v[92:95], a[136:139], v[52:55]
    ds_read_b128 v[128:131], v3 offset:11264
    s_waitcnt lgkmcnt(11)
    v_mfma_f32_16x16x32_bf16 v[24:27], v[96:99], a[64:67], v[24:27]
    ds_read_b128 v[140:143], v3 offset:14336
    v_mfma_f32_16x16x32_bf16 v[56:59], v[96:99], a[136:139], v[56:59]
    ds_read_b128 v[132:135], v3 offset:12288
    s_waitcnt lgkmcnt(12)
    v_mfma_f32_16x16x32_bf16 v[28:31], v[100:103], a[64:67], v[28:31]
    ds_read_b128 v[136:139], v3 offset:13312
    v_mfma_f32_16x16x32_bf16 v[60:63], v[100:103], a[136:139], v[60:63]
    ds_read_b128 v[156:159], v3 offset:15360
    s_waitcnt lgkmcnt(13)
    v_mfma_f32_16x16x32_bf16 v[32:35], v[112:115], a[64:67], v[32:35]
    ds_read_b128 v[160:163], v4 offset:8192
    v_mfma_f32_16x16x32_bf16 v[64:67], v[112:115], a[136:139], v[64:67]
    ds_read_b128 v[164:167], v5 offset:8192
    v_mfma_f32_16x16x32_bf16 v[44:47], a[64:67], v[112:115], v[44:47]
    v_mfma_f32_16x16x32_bf16 v[76:79], a[136:139], v[112:115], v[76:79]
    s_waitcnt lgkmcnt(14)
    v_mfma_f32_16x16x32_bf16 v[36:39], a[64:67], v[104:107], v[36:39]
    v_mfma_f32_16x16x32_bf16 v[68:71], a[136:139], v[104:107], v[68:71]
    s_waitcnt lgkmcnt(13)
    v_mfma_f32_16x16x32_bf16 v[40:43], a[64:67], v[108:111], v[40:43]
    v_mfma_f32_16x16x32_bf16 v[72:75], a[136:139], v[108:111], v[72:75]
    s_waitcnt lgkmcnt(11)
    v_mfma_f32_16x16x32_bf16 v[80:83], v[148:151], v[144:147], v[80:83]
    s_waitcnt lgkmcnt(10)
    v_mfma_f32_16x16x32_bf16 v[84:87], v[144:147], v[152:155], v[84:87]
    s_waitcnt vmcnt(1) lgkmcnt(9)
    v_mfma_f32_16x16x32_bf16 v[16:19], v[116:119], a[68:71], v[16:19]
    s_waitcnt vmcnt(0)
    v_mfma_f32_16x16x32_bf16 v[48:51], v[116:119], a[140:143], v[48:51]
    s_waitcnt lgkmcnt(8)
    v_mfma_f32_16x16x32_bf16 v[20:23], v[120:123], a[68:71], v[20:23]
    v_mfma_f32_16x16x32_bf16 v[52:55], v[120:123], a[140:143], v[52:55]
    s_waitcnt lgkmcnt(7)
    v_mfma_f32_16x16x32_bf16 v[24:27], v[124:127], a[68:71], v[24:27]
    v_mfma_f32_16x16x32_bf16 v[56:59], v[124:127], a[140:143], v[56:59]
    s_waitcnt lgkmcnt(6)
    v_mfma_f32_16x16x32_bf16 v[28:31], v[128:131], a[68:71], v[28:31]
    v_mfma_f32_16x16x32_bf16 v[60:63], v[128:131], a[140:143], v[60:63]
    s_waitcnt lgkmcnt(5)
    v_mfma_f32_16x16x32_bf16 v[32:35], v[140:143], a[68:71], v[32:35]
    v_mfma_f32_16x16x32_bf16 v[64:67], v[140:143], a[140:143], v[64:67]
    v_mfma_f32_16x16x32_bf16 v[44:47], a[68:71], v[140:143], v[44:47]
    v_mfma_f32_16x16x32_bf16 v[76:79], a[140:143], v[140:143], v[76:79]
    s_waitcnt lgkmcnt(4)
    v_mfma_f32_16x16x32_bf16 v[36:39], a[68:71], v[132:135], v[36:39]
    v_mfma_f32_16x16x32_bf16 v[68:71], a[140:143], v[132:135], v[68:71]
    s_waitcnt lgkmcnt(3)
    v_mfma_f32_16x16x32_bf16 v[40:43], a[68:71], v[136:139], v[40:43]
    v_mfma_f32_16x16x32_bf16 v[72:75], a[140:143], v[136:139], v[72:75]
    s_waitcnt lgkmcnt(1)
    v_mfma_f32_16x16x32_bf16 v[80:83], v[160:163], v[156:159], v[80:83]
    s_waitcnt lgkmcnt(0)
    v_mfma_f32_16x16x32_bf16 v[84:87], v[156:159], v[164:167], v[84:87]
    v_lshlrev_b32 v6, 3, v1
    v_add_u32 v6, 147456, v6
    s_mul_i32 s52, s20, 3072
    v_add_u32 v7, s52, v6
    v_cvt_pk_bf16_f32 v100, v56, v57
    v_cvt_pk_bf16_f32 v101, v58, v59
    v_cvt_pk_bf16_f32 v104, v60, v61
    v_cvt_pk_bf16_f32 v105, v62, v63
    v_cvt_pk_bf16_f32 v134, v64, v65
    v_cvt_pk_bf16_f32 v137, v66, v67
    v_mov_b32 v102, 0
    v_mov_b32 v103, 0
    v_cvt_pk_bf16_f32 v110, v68, v69
    v_cvt_pk_bf16_f32 v111, v70, v71
    v_cvt_pk_bf16_f32 v116, v72, v73
    v_cvt_pk_bf16_f32 v117, v74, v75
    v_cvt_pk_bf16_f32 v122, v76, v77
    v_cvt_pk_bf16_f32 v123, v78, v79
    v_permlane32_swap_b32 v134, v102
    v_permlane32_swap_b32 v137, v103
    ds_write_b64 v7, v[100:101] offset:3072
    ds_write_b64 v7, v[102:103] offset:3584
    ds_write_b64 v7, v[104:105] offset:4096
    ds_write_b64 v7, v[110:111] offset:4608
    ds_write_b64 v7, v[116:117] offset:5120
    ds_write_b64 v7, v[122:123] offset:5632
    v_cvt_pk_bf16_f32 v140, v80, v81
    v_cvt_pk_bf16_f32 v141, v82, v83
    v_cvt_pk_bf16_f32 v142, v84, v85
    v_cvt_pk_bf16_f32 v143, v86, v87
    s_min_u32 s52, s20, 2
    s_lshl_b32 s53, s52, 1
    s_cmp_ge_u32 s20, 2
    s_cselect_b32 s53, 1, s53
    s_lshl_b32 s53, s53, 9
    s_add_u32 s52, s52, 3
    s_lshl_b32 s52, s52, 9
    v_add_u32 v8, s53, v6
    v_add_u32 v9, s52, v6
    s_cmp_lt_u32 s20, 2
    s_cbranch_scc1 L_noswap_32
    v_mov_b32 v10, 0
    v_mov_b32 v11, 0
    s_nop 1
    v_permlane32_swap_b32 v140, v10
    v_permlane32_swap_b32 v141, v11
    v_mov_b32 v140, v10
    v_mov_b32 v141, v11
L_noswap_32:
    ds_write_b64 v8, v[140:141]
    ds_write_b64 v9, v[142:143]
    v_cvt_pk_bf16_f32 v132, v48, v49
    v_cvt_pk_bf16_f32 v133, v50, v51
    v_cvt_pk_bf16_f32 v138, v52, v53
    v_cvt_pk_bf16_f32 v139, v54, v55
    v_mov_b32 v135, 0
    v_mov_b32 v136, 0
    v_cvt_pk_bf16_f32 v94, v24, v25
    v_cvt_pk_bf16_f32 v95, v26, v27
    v_cvt_pk_bf16_f32 v98, v28, v29
    v_cvt_pk_bf16_f32 v99, v30, v31
    v_cvt_pk_bf16_f32 v126, v32, v33
    v_cvt_pk_bf16_f32 v129, v34, v35
    v_mov_b32 v96, 0
    v_mov_b32 v97, 0
    v_cvt_pk_bf16_f32 v108, v36, v37
    v_cvt_pk_bf16_f32 v109, v38, v39
    v_cvt_pk_bf16_f32 v114, v40, v41
    v_cvt_pk_bf16_f32 v115, v42, v43
    v_cvt_pk_bf16_f32 v120, v44, v45
    v_cvt_pk_bf16_f32 v121, v46, v47
    v_permlane32_swap_b32 v126, v96
    v_permlane32_swap_b32 v129, v97
    v_cvt_pk_bf16_f32 v124, v16, v17
    v_cvt_pk_bf16_f32 v125, v18, v19
    v_cvt_pk_bf16_f32 v130, v20, v21
    v_cvt_pk_bf16_f32 v131, v22, v23
    v_mov_b32 v127, 0
    v_mov_b32 v128, 0
    v_mov_b32 v12, 0x3f803f80
    v_mov_b32 v13, 0x3f803f80
    v_mov_b32 v14, 0x3f803f80
    v_mov_b32 v15, 0x3f803f80
    v_mfma_f32_16x16x32_bf16 v[32:35], v[94:97], v[132:135], v[172:175]
    v_mfma_f32_16x16x32_bf16 v[36:39], v[100:103], v[132:135], v[168:171]
    v_mfma_f32_16x16x32_bf16 v[20:23], v[94:97], v[124:127], v[168:171]
    v_mfma_f32_16x16x32_bf16 v[40:43], v[96:99], v[136:139], v[172:175]
    v_mfma_f32_16x16x32_bf16 v[44:47], v[102:105], v[136:139], v[168:171]
    v_mfma_f32_16x16x32_bf16 v[28:31], v[96:99], v[128:131], v[168:171]
    s_waitcnt lgkmcnt(0)
    s_barrier
    ds_read_b64 v[88:89], v7 offset:0
    ds_read_b64 v[90:91], v7 offset:512
    ds_read_b64 v[92:93], v7 offset:1024
    ds_read_b64 v[106:107], v7 offset:1536
    ds_read_b64 v[112:113], v7 offset:2048
    ds_read_b64 v[118:119], v7 offset:2560
    s_mov_b32 s52, 0x3eae1a93
    s_waitcnt lgkmcnt(4)
    v_mfma_f32_16x16x32_bf16 v[16:19], v[88:91], v[124:127], v[176:179]
    s_waitcnt lgkmcnt(3)
    v_mfma_f32_16x16x32_bf16 v[24:27], v[90:93], v[128:131], v[176:179]
    v_max3_f32 v48, v32, v33, v34
    v_max3_f32 v49, v40, v41, v42
    s_nop 3
    v_max3_f32 v50, v16, v17, v18
    s_nop 0
    v_max3_f32 v51, v24, v25, v26
    v_max3_f32 v48, v48, v35, v36
    v_max3_f32 v49, v49, v43, v44
    v_max3_f32 v50, v50, v19, v20
    v_max3_f32 v51, v51, v27, v28
    v_max3_f32 v48, v48, v37, v38
    v_max3_f32 v49, v49, v45, v46
    v_max3_f32 v50, v50, v21, v22
    v_max3_f32 v51, v51, v29, v30
    v_max_f32 v48, v48, v39
    v_max_f32 v49, v49, v47
    v_max_f32 v50, v50, v23
    v_max_f32 v51, v51, v31
    v_mov_b32 v52, v48
    v_mov_b32 v53, v49
    v_mov_b32 v54, v50
    v_mov_b32 v55, v51
    v_permlane16_swap_b32 v48, v52
    v_permlane16_swap_b32 v49, v53
    v_permlane16_swap_b32 v50, v54
    v_permlane16_swap_b32 v51, v55
    v_max_f32 v48, v48, v52
    v_max_f32 v49, v49, v53
    v_max_f32 v50, v50, v54
    v_max_f32 v51, v51, v55
    v_mov_b32 v52, v48
    v_mov_b32 v53, v49
    v_mov_b32 v54, v50
    v_mov_b32 v55, v51
    v_permlane32_swap_b32 v48, v52
    v_permlane32_swap_b32 v49, v53
    v_permlane32_swap_b32 v50, v54
    v_permlane32_swap_b32 v51, v55
    v_max_f32 v48, v48, v52
    v_max_f32 v49, v49, v53
    v_max_f32 v50, v50, v54
    v_max_f32 v51, v51, v55
    v_mul_f32 v48, s52, v48
    v_mul_f32 v49, s52, v49
    v_mul_f32 v50, s52, v50
    v_mul_f32 v51, s52, v51
    v_fma_f32 v32, v32, s52, -v48
    v_fma_f32 v40, v40, s52, -v49
    v_fma_f32 v16, v16, s52, -v50
    v_fma_f32 v24, v24, s52, -v51
    v_fma_f32 v33, v33, s52, -v48
    v_fma_f32 v41, v41, s52, -v49
    v_fma_f32 v17, v17, s52, -v50
    v_fma_f32 v25, v25, s52, -v51
    v_fma_f32 v34, v34, s52, -v48
    v_fma_f32 v42, v42, s52, -v49
    v_fma_f32 v18, v18, s52, -v50
    v_fma_f32 v26, v26, s52, -v51
    v_fma_f32 v35, v35, s52, -v48
    v_fma_f32 v43, v43, s52, -v49
    v_fma_f32 v19, v19, s52, -v50
    v_fma_f32 v27, v27, s52, -v51
    v_fma_f32 v36, v36, s52, -v48
    v_fma_f32 v44, v44, s52, -v49
    v_fma_f32 v20, v20, s52, -v50
    v_fma_f32 v28, v28, s52, -v51
    v_fma_f32 v37, v37, s52, -v48
    v_fma_f32 v45, v45, s52, -v49
    v_fma_f32 v21, v21, s52, -v50
    v_fma_f32 v29, v29, s52, -v51
    v_fma_f32 v38, v38, s52, -v48
    v_fma_f32 v46, v46, s52, -v49
    v_fma_f32 v22, v22, s52, -v50
    v_fma_f32 v30, v30, s52, -v51
    v_fma_f32 v39, v39, s52, -v48
    v_fma_f32 v47, v47, s52, -v49
    v_fma_f32 v23, v23, s52, -v50
    v_fma_f32 v31, v31, s52, -v51
    v_exp_f32 v32, v32
    v_exp_f32 v40, v40
    v_exp_f32 v16, v16
    v_exp_f32 v24, v24
    v_exp_f32 v33, v33
    v_exp_f32 v41, v41
    v_exp_f32 v17, v17
    v_exp_f32 v25, v25
    v_exp_f32 v34, v34
    v_exp_f32 v42, v42
    v_exp_f32 v18, v18
    v_exp_f32 v26, v26
    v_exp_f32 v35, v35
    v_exp_f32 v43, v43
    v_exp_f32 v19, v19
    v_exp_f32 v27, v27
    v_exp_f32 v36, v36
    v_exp_f32 v44, v44
    v_exp_f32 v20, v20
    v_exp_f32 v28, v28
    v_exp_f32 v37, v37
    v_exp_f32 v45, v45
    v_exp_f32 v21, v21
    v_exp_f32 v29, v29
    v_exp_f32 v38, v38
    v_exp_f32 v46, v46
    v_exp_f32 v22, v22
    v_exp_f32 v30, v30
    v_exp_f32 v39, v39
    v_exp_f32 v47, v47
    v_exp_f32 v23, v23
    v_exp_f32 v31, v31
    v_cvt_pk_bf16_f32 v56, v32, v33
    v_cvt_pk_bf16_f32 v60, v40, v41
    v_cvt_pk_bf16_f32 v64, v16, v17
    v_cvt_pk_bf16_f32 v68, v24, v25
    v_cvt_pk_bf16_f32 v57, v34, v35
    v_cvt_pk_bf16_f32 v61, v42, v43
    v_cvt_pk_bf16_f32 v65, v18, v19
    v_cvt_pk_bf16_f32 v69, v26, v27
    v_cvt_pk_bf16_f32 v58, v36, v37
    v_cvt_pk_bf16_f32 v62, v44, v45
    v_cvt_pk_bf16_f32 v66, v20, v21
    v_cvt_pk_bf16_f32 v70, v28, v29
    v_cvt_pk_bf16_f32 v59, v38, v39
    v_cvt_pk_bf16_f32 v63, v46, v47
    v_cvt_pk_bf16_f32 v67, v22, v23
    v_cvt_pk_bf16_f32 v71, v30, v31
    v_mfma_f32_16x16x32_bf16 v[188:191], v[12:15], v[56:59], 0
    v_mfma_f32_16x16x32_bf16 v[180:183], v[108:111], v[56:59], 0
    v_mfma_f32_16x16x32_bf16 v[184:187], v[120:123], v[56:59], 0
    v_mfma_f32_16x16x32_bf16 v[200:203], v[12:15], v[60:63], 0
    v_mfma_f32_16x16x32_bf16 v[192:195], v[114:117], v[60:63], 0
    v_mfma_f32_16x16x32_bf16 v[196:199], v[120:123], v[60:63], 0
    v_mfma_f32_16x16x32_bf16 v[212:215], v[12:15], v[64:67], 0
    s_waitcnt lgkmcnt(2)
    v_mfma_f32_16x16x32_bf16 v[204:207], v[106:109], v[64:67], 0
    s_waitcnt lgkmcnt(0)
    v_mfma_f32_16x16x32_bf16 v[208:211], v[118:121], v[64:67], 0
    v_mfma_f32_16x16x32_bf16 v[224:227], v[12:15], v[68:71], 0
    v_mfma_f32_16x16x32_bf16 v[216:219], v[112:115], v[68:71], 0
    v_mfma_f32_16x16x32_bf16 v[220:223], v[118:121], v[68:71], 0
    s_lshl_b32 s53, s46, 4
    s_add_u32 s53, s53, s45
    s_lshl_b32 s54, s53, 10
    s_add_u32 s54, s54, 73662464
    s_lshl_b32 s55, s53, 7
    s_add_u32 s55, s55, 75759488
    v_lshlrev_b32 v6, 3, v1
    v_rcp_f32 v188, v188
    v_rcp_f32 v200, v200
    v_rcp_f32 v212, v212
    v_rcp_f32 v224, v224
    v_mul_f32 v180, v180, v188
    v_mul_f32 v181, v181, v188
    v_mul_f32 v182, v182, v188
    v_mul_f32 v183, v183, v188
    v_mul_f32 v184, v184, v188
    v_mul_f32 v185, v185, v188
    v_cvt_pk_bf16_f32 v76, v180, v181
    v_cvt_pk_bf16_f32 v77, v182, v183
    v_cvt_pk_bf16_f32 v82, v184, v185
    v_mul_f32 v192, v192, v200
    v_mul_f32 v193, v193, v200
    v_mul_f32 v194, v194, v200
    v_mul_f32 v195, v195, v200
    v_mul_f32 v198, v198, v200
    v_mul_f32 v199, v199, v200
    v_cvt_pk_bf16_f32 v78, v192, v193
    v_cvt_pk_bf16_f32 v79, v194, v195
    v_cvt_pk_bf16_f32 v83, v198, v199
    s_add_u32 s53, s54, 16384
    buffer_store_dwordx4 v[76:79], v2, s[4:7], s53 offen
    v_mul_f32 v204, v204, v212
    v_mul_f32 v205, v205, v212
    v_mul_f32 v206, v206, v212
    v_mul_f32 v207, v207, v212
    v_mul_f32 v208, v208, v212
    v_mul_f32 v209, v209, v212
    v_cvt_pk_bf16_f32 v72, v204, v205
    v_cvt_pk_bf16_f32 v73, v206, v207
    v_cvt_pk_bf16_f32 v80, v208, v209
    v_mul_f32 v216, v216, v224
    v_mul_f32 v217, v217, v224
    v_mul_f32 v218, v218, v224
    v_mul_f32 v219, v219, v224
    v_mul_f32 v222, v222, v224
    v_mul_f32 v223, v223, v224
    v_cvt_pk_bf16_f32 v74, v216, v217
    v_cvt_pk_bf16_f32 v75, v218, v219
    v_cvt_pk_bf16_f32 v81, v222, v223
    s_add_u32 s53, s54, 0
    buffer_store_dwordx4 v[72:75], v2, s[4:7], s53 offen
    s_mov_b32 exec_lo, 0xffff0000
    s_mov_b32 exec_hi, 0
    buffer_store_dwordx2 v[80:81], v6, s[4:7], s55 offen offset:0
    buffer_store_dwordx2 v[82:83], v6, s[4:7], s55 offen offset:2048
    s_mov_b64 exec, -1
qkv1_kernel_end:
    s_endpgm
.section .rodata,"a"
.p2align 6
.amdhsa_kernel qkv1_kernel
  .amdhsa_next_free_vgpr 400
  .amdhsa_next_free_sgpr 102
  .amdhsa_accum_offset 256
  .amdhsa_group_segment_fixed_size 0
  .amdhsa_kernarg_size 80
  .amdhsa_user_sgpr_count 2
  .amdhsa_user_sgpr_kernarg_segment_ptr 1
  .amdhsa_system_sgpr_workgroup_id_x 1
  .amdhsa_float_denorm_mode_32 3
.end_amdhsa_kernel
.text
.globl wo1_kernel
.p2align 8
.type wo1_kernel,@function
wo1_kernel:
    s_cmp_ge_u32 s2, 256
    s_cbranch_scc1 wo1_kernel_end
    s_load_dwordx16 s[24:39], s[0:1], 0
    s_load_dwordx4 s[40:43], s[0:1], 64
    v_lshrrev_b32 v1, 6, v0
    s_and_b32 s21, s2, 7
    v_readfirstlane_b32 s20, v1
    s_lshr_b32 s22, s2, 3
    v_and_b32 v1, 63, v0
    v_lshlrev_b32 v2, 4, v1
    s_waitcnt lgkmcnt(0)
    s_mov_b32 s4, s42
    s_mov_b32 s5, s43
    s_mov_b32 s6, 0x10000000
    s_mov_b32 s7, 0x20000
    s_cmp_ge_u32 s22, 24
    s_cbranch_scc1 wo1_kernel_end
    s_mul_i32 s44, s22, 10923
    s_lshr_b32 s44, s44, 16
    s_mul_i32 s52, s44, 6
    s_sub_u32 s45, s22, s52
    s_lshl_b32 s52, s21, 2
    s_add_u32 s44, s44, s52
    s_lshl_b32 s46, s44, 2
    s_add_u32 s46, s46, s20
    s_mul_i32 s47, s45, 110592
    s_mul_i32 s48, s20, 3072
    s_add_u32 s47, s47, s48
    s_add_u32 s47, s47, 2097152
    s_lshl_b32 s49, s46, 14
    s_add_u32 s49, s49, 73662464
    s_lshl_b32 s50, s46, 11
    s_add_u32 s50, s50, 75759616
    v_and_b32 v3, 15, v1
    v_lshrrev_b32 v4, 4, v1
    v_lshlrev_b32 v5, 3, v3
    v_lshl_add_u32 v5, v4, 8, v5
    s_lshl_b32 s52, s46, 4
    v_add_u32 v6, s52, v3
    v_lshlrev_b32 v7, 3, v6
    v_mul_u32_u24 v6, 1152, v6
    v_lshl_add_u32 v6, v4, 4, v6
    s_mul_i32 s51, s45, 192
    s_add_u32 s8, s42, 28311552
    s_addc_u32 s9, s43, 0
    s_mov_b32 s10, 0x240000
    s_mov_b32 s11, 0x20000
    s_mov_b32 m0, s48
    s_nop 0
    buffer_load_dwordx4 v2, s[4:7], s47 offen offset:0 lds
    buffer_load_dwordx4 v2, s[4:7], s47 offen offset:1024 lds
    buffer_load_dwordx4 v2, s[4:7], s47 offen offset:2048 lds
    s_add_u32 s48, s48, 12288
    s_add_u32 s47, s47, 12288
    buffer_load_dwordx4 v[16:19], v2, s[4:7], s49 offen offset:0
    buffer_load_dwordx4 v[20:23], v2, s[4:7], s49 offen offset:1024
    s_mov_b32 m0, s48
    s_nop 0
    buffer_load_dwordx4 v2, s[4:7], s47 offen offset:0 lds
    buffer_load_dwordx4 v2, s[4:7], s47 offen offset:1024 lds
    buffer_load_dwordx4 v2, s[4:7], s47 offen offset:2048 lds
    s_add_u32 s48, s48, 12288
    s_add_u32 s47, s47, 12288
    buffer_load_dwordx4 v[24:27], v2, s[4:7], s49 offen offset:2048
    buffer_load_dwordx4 v[28:31], v2, s[4:7], s49 offen offset:3072
    s_mov_b32 m0, s48
    s_nop 0
    buffer_load_dwordx4 v2, s[4:7], s47 offen offset:0 lds
    buffer_load_dwordx4 v2, s[4:7], s47 offen offset:1024 lds
    buffer_load_dwordx4 v2, s[4:7], s47 offen offset:2048 lds
    s_add_u32 s48, s48, 12288
    s_add_u32 s47, s47, 12288
    s_add_u32 s49, s49, 4096
    buffer_load_dwordx4 v[32:35], v2, s[4:7], s49 offen offset:0
    buffer_load_dwordx4 v[36:39], v2, s[4:7], s49 offen offset:1024
    s_mov_b32 m0, s48
    s_nop 0
    buffer_load_dwordx4 v2, s[4:7], s47 offen offset:0 lds
    buffer_load_dwordx4 v2, s[4:7], s47 offen offset:1024 lds
    buffer_load_dwordx4 v2, s[4:7], s47 offen offset:2048 lds
    s_add_u32 s48, s48, 12288
    s_add_u32 s47, s47, 12288
    buffer_load_dwordx4 v[40:43], v2, s[4:7], s49 offen offset:2048
    buffer_load_dwordx4 v[44:47], v2, s[4:7], s49 offen offset:3072
    s_mov_b32 m0, s48
    s_nop 0
    buffer_load_dwordx4 v2, s[4:7], s47 offen offset:0 lds
    buffer_load_dwordx4 v2, s[4:7], s47 offen offset:1024 lds
    buffer_load_dwordx4 v2, s[4:7], s47 offen offset:2048 lds
    s_add_u32 s48, s48, 12288
    s_add_u32 s47, s47, 12288
    s_add_u32 s49, s49, 4096
    buffer_load_dwordx4 v[48:51], v2, s[4:7], s49 offen offset:0
    buffer_load_dwordx4 v[52:55], v2, s[4:7], s49 offen offset:1024
    s_mov_b32 m0, s48
    s_nop 0
    buffer_load_dwordx4 v2, s[4:7], s47 offen offset:0 lds
    buffer_load_dwordx4 v2, s[4:7], s47 offen offset:1024 lds
    buffer_load_dwordx4 v2, s[4:7], s47 offen offset:2048 lds
    s_add_u32 s48, s48, 12288
    s_add_u32 s47, s47, 12288
    buffer_load_dwordx4 v[56:59], v2, s[4:7], s49 offen offset:2048
    buffer_load_dwordx4 v[60:63], v2, s[4:7], s49 offen offset:3072
    s_mov_b32 m0, s48
    s_nop 0
    buffer_load_dwordx4 v2, s[4:7], s47 offen offset:0 lds
    buffer_load_dwordx4 v2, s[4:7], s47 offen offset:1024 lds
    buffer_load_dwordx4 v2, s[4:7], s47 offen offset:2048 lds
    s_add_u32 s48, s48, 12288
    s_add_u32 s47, s47, 12288
    s_add_u32 s49, s49, 4096
    buffer_load_dwordx4 v[64:67], v2, s[4:7], s49 offen offset:0
    buffer_load_dwordx4 v[68:71], v2, s[4:7], s49 offen offset:1024
    s_mov_b32 m0, s48
    s_nop 0
    buffer_load_dwordx4 v2, s[4:7], s47 offen offset:0 lds
    buffer_load_dwordx4 v2, s[4:7], s47 offen offset:1024 lds
    buffer_load_dwordx4 v2, s[4:7], s47 offen offset:2048 lds
    s_add_u32 s48, s48, 12288
    s_add_u32 s47, s47, 12288
    buffer_load_dwordx4 v[72:75], v2, s[4:7], s49 offen offset:2048
    buffer_load_dwordx4 v[76:79], v2, s[4:7], s49 offen offset:3072
    s_mov_b32 m0, s48
    s_nop 0
    buffer_load_dwordx4 v2, s[4:7], s47 offen offset:0 lds
    buffer_load_dwordx4 v2, s[4:7], s47 offen offset:1024 lds
    buffer_load_dwordx4 v2, s[4:7], s47 offen offset:2048 lds
    s_add_u32 s48, s48, 12288
    s_add_u32 s47, s47, 12288
    buffer_load_dwordx2 v[80:81], v5, s[4:7], s50 offen offset:0
    buffer_load_dwordx2 v[82:83], v5, s[4:7], s50 offen offset:128
    buffer_load_dwordx2 v[84:85], v5, s[4:7], s50 offen offset:1024
    buffer_load_dwordx2 v[86:87], v5, s[4:7], s50 offen offset:1152
    buffer_load_dwordx4 v[160:163], v6, s[8:11], s51 offen offset:0
    buffer_load_dwordx4 v[164:167], v6, s[8:11], s51 offen offset:64
    buffer_load_dwordx4 v[168:171], v6, s[8:11], s51 offen offset:128
    v_mov_b32 v8, v2
    s_waitcnt vmcnt(37)
    s_barrier
    ds_read_b128 v[112:115], v8 offset:0
    ds_read_b128 v[116:119], v8 offset:1024
    ds_read_b128 v[120:123], v8 offset:2048
    ds_read_b128 v[124:127], v8 offset:3072
    ds_read_b128 v[128:131], v8 offset:4096
    ds_read_b128 v[132:135], v8 offset:5120
    ds_read_b128 v[136:139], v8 offset:6144
    ds_read_b128 v[140:143], v8 offset:7168
    s_waitcnt lgkmcnt(7)
    v_mfma_f32_16x16x32_bf16 v[88:91], v[112:115], v[16:19], 0
    ds_read_b128 v[144:147], v8 offset:8192
    s_waitcnt lgkmcnt(7)
    v_mfma_f32_16x16x32_bf16 v[92:95], v[116:119], v[16:19], 0
    ds_read_b128 v[148:151], v8 offset:9216
    s_waitcnt lgkmcnt(7)
    v_mfma_f32_16x16x32_bf16 v[96:99], v[120:123], v[16:19], 0
    ds_read_b128 v[152:155], v8 offset:10240
    s_waitcnt lgkmcnt(7)
    v_mfma_f32_16x16x32_bf16 v[100:103], v[124:127], v[16:19], 0
    ds_read_b128 v[156:159], v8 offset:11264
    s_waitcnt lgkmcnt(7)
    v_mfma_f32_16x16x32_bf16 v[104:107], v[128:131], v[16:19], 0
    s_waitcnt lgkmcnt(6)
    v_mfma_f32_16x16x32_bf16 v[108:111], v[132:135], v[16:19], 0
    ds_read_b128 v[112:115], v8 offset:12288
    ds_read_b128 v[116:119], v8 offset:13312
    s_waitcnt lgkmcnt(7)
    v_mfma_f32_16x16x32_bf16 v[88:91], v[136:139], v[20:23], v[88:91]
    ds_read_b128 v[120:123], v8 offset:14336
    s_waitcnt lgkmcnt(7)
    v_mfma_f32_16x16x32_bf16 v[92:95], v[140:143], v[20:23], v[92:95]
    ds_read_b128 v[124:127], v8 offset:15360
    s_waitcnt lgkmcnt(7)
    v_mfma_f32_16x16x32_bf16 v[96:99], v[144:147], v[20:23], v[96:99]
    ds_read_b128 v[128:131], v8 offset:16384
    s_waitcnt lgkmcnt(7)
    v_mfma_f32_16x16x32_bf16 v[100:103], v[148:151], v[20:23], v[100:103]
    ds_read_b128 v[132:135], v8 offset:17408
    s_waitcnt lgkmcnt(7)
    v_mfma_f32_16x16x32_bf16 v[104:107], v[152:155], v[20:23], v[104:107]
    s_waitcnt lgkmcnt(6)
    v_mfma_f32_16x16x32_bf16 v[108:111], v[156:159], v[20:23], v[108:111]
    ds_read_b128 v[136:139], v8 offset:18432
    ds_read_b128 v[140:143], v8 offset:19456
    s_waitcnt lgkmcnt(7)
    v_mfma_f32_16x16x32_bf16 v[88:91], v[112:115], v[24:27], v[88:91]
    ds_read_b128 v[144:147], v8 offset:20480
    s_waitcnt lgkmcnt(7)
    v_mfma_f32_16x16x32_bf16 v[92:95], v[116:119], v[24:27], v[92:95]
    ds_read_b128 v[148:151], v8 offset:21504
    s_waitcnt lgkmcnt(7)
    v_mfma_f32_16x16x32_bf16 v[96:99], v[120:123], v[24:27], v[96:99]
    ds_read_b128 v[152:155], v8 offset:22528
    s_waitcnt lgkmcnt(7)
    v_mfma_f32_16x16x32_bf16 v[100:103], v[124:127], v[24:27], v[100:103]
    ds_read_b128 v[156:159], v8 offset:23552
    s_waitcnt lgkmcnt(7)
    v_mfma_f32_16x16x32_bf16 v[104:107], v[128:131], v[24:27], v[104:107]
    s_waitcnt lgkmcnt(6)
    v_mfma_f32_16x16x32_bf16 v[108:111], v[132:135], v[24:27], v[108:111]
    ds_read_b128 v[112:115], v8 offset:24576
    ds_read_b128 v[116:119], v8 offset:25600
    s_waitcnt lgkmcnt(7)
    v_mfma_f32_16x16x32_bf16 v[88:91], v[136:139], v[28:31], v[88:91]
    ds_read_b128 v[120:123], v8 offset:26624
    s_waitcnt lgkmcnt(7)
    v_mfma_f32_16x16x32_bf16 v[92:95], v[140:143], v[28:31], v[92:95]
    ds_read_b128 v[124:127], v8 offset:27648
    s_waitcnt lgkmcnt(7)
    v_mfma_f32_16x16x32_bf16 v[96:99], v[144:147], v[28:31], v[96:99]
    ds_read_b128 v[128:131], v8 offset:28672
    s_waitcnt lgkmcnt(7)
    v_mfma_f32_16x16x32_bf16 v[100:103], v[148:151], v[28:31], v[100:103]
    ds_read_b128 v[132:135], v8 offset:29696
    s_waitcnt lgkmcnt(7)
    v_mfma_f32_16x16x32_bf16 v[104:107], v[152:155], v[28:31], v[104:107]
    s_waitcnt lgkmcnt(6)
    v_mfma_f32_16x16x32_bf16 v[108:111], v[156:159], v[28:31], v[108:111]
    ds_read_b128 v[136:139], v8 offset:30720
    ds_read_b128 v[140:143], v8 offset:31744
    s_waitcnt vmcnt(36) lgkmcnt(7)
    v_mfma_f32_16x16x32_bf16 v[88:91], v[112:115], v[32:35], v[88:91]
    ds_read_b128 v[144:147], v8 offset:32768
    s_waitcnt lgkmcnt(7)
    v_mfma_f32_16x16x32_bf16 v[92:95], v[116:119], v[32:35], v[92:95]
    ds_read_b128 v[148:151], v8 offset:33792
    s_waitcnt lgkmcnt(7)
    v_mfma_f32_16x16x32_bf16 v[96:99], v[120:123], v[32:35], v[96:99]
    ds_read_b128 v[152:155], v8 offset:34816
    s_waitcnt lgkmcnt(7)
    v_mfma_f32_16x16x32_bf16 v[100:103], v[124:127], v[32:35], v[100:103]
    ds_read_b128 v[156:159], v8 offset:35840
    s_waitcnt lgkmcnt(7)
    v_mfma_f32_16x16x32_bf16 v[104:107], v[128:131], v[32:35], v[104:107]
    s_waitcnt lgkmcnt(6)
    v_mfma_f32_16x16x32_bf16 v[108:111], v[132:135], v[32:35], v[108:111]
    s_waitcnt vmcnt(22)
    s_barrier
    s_waitcnt lgkmcnt(5)
    v_mfma_f32_16x16x32_bf16 v[88:91], v[136:139], v[36:39], v[88:91]
    ds_read_b128 v[112:115], v8 offset:36864
    ds_read_b128 v[116:119], v8 offset:37888
    s_waitcnt lgkmcnt(6)
    v_mfma_f32_16x16x32_bf16 v[92:95], v[140:143], v[36:39], v[92:95]
    ds_read_b128 v[120:123], v8 offset:38912
    ds_read_b128 v[124:127], v8 offset:39936
    s_waitcnt lgkmcnt(7)
    v_mfma_f32_16x16x32_bf16 v[96:99], v[144:147], v[36:39], v[96:99]
    ds_read_b128 v[128:131], v8 offset:40960
    s_waitcnt lgkmcnt(7)
    v_mfma_f32_16x16x32_bf16 v[100:103], v[148:151], v[36:39], v[100:103]
    ds_read_b128 v[132:135], v8 offset:41984
    s_waitcnt lgkmcnt(7)
    v_mfma_f32_16x16x32_bf16 v[104:107], v[152:155], v[36:39], v[104:107]
    s_waitcnt lgkmcnt(6)
    v_mfma_f32_16x16x32_bf16 v[108:111], v[156:159], v[36:39], v[108:111]
    ds_read_b128 v[136:139], v8 offset:43008
    ds_read_b128 v[140:143], v8 offset:44032
    s_waitcnt lgkmcnt(7)
    v_mfma_f32_16x16x32_bf16 v[88:91], v[112:115], v[40:43], v[88:91]
    ds_read_b128 v[144:147], v8 offset:45056
    s_waitcnt lgkmcnt(7)
    v_mfma_f32_16x16x32_bf16 v[92:95], v[116:119], v[40:43], v[92:95]
    ds_read_b128 v[148:151], v8 offset:46080
    s_waitcnt lgkmcnt(7)
    v_mfma_f32_16x16x32_bf16 v[96:99], v[120:123], v[40:43], v[96:99]
    ds_read_b128 v[152:155], v8 offset:47104
    s_waitcnt lgkmcnt(7)
    v_mfma_f32_16x16x32_bf16 v[100:103], v[124:127], v[40:43], v[100:103]
    ds_read_b128 v[156:159], v8 offset:48128
    s_waitcnt lgkmcnt(7)
    v_mfma_f32_16x16x32_bf16 v[104:107], v[128:131], v[40:43], v[104:107]
    s_waitcnt lgkmcnt(6)
    v_mfma_f32_16x16x32_bf16 v[108:111], v[132:135], v[40:43], v[108:111]
    ds_read_b128 v[112:115], v8 offset:49152
    ds_read_b128 v[116:119], v8 offset:50176
    s_waitcnt lgkmcnt(7)
    v_mfma_f32_16x16x32_bf16 v[88:91], v[136:139], v[44:47], v[88:91]
    ds_read_b128 v[120:123], v8 offset:51200
    s_waitcnt lgkmcnt(7)
    v_mfma_f32_16x16x32_bf16 v[92:95], v[140:143], v[44:47], v[92:95]
    ds_read_b128 v[124:127], v8 offset:52224
    s_waitcnt lgkmcnt(7)
    v_mfma_f32_16x16x32_bf16 v[96:99], v[144:147], v[44:47], v[96:99]
    ds_read_b128 v[128:131], v8 offset:53248
    s_waitcnt lgkmcnt(7)
    v_mfma_f32_16x16x32_bf16 v[100:103], v[148:151], v[44:47], v[100:103]
    ds_read_b128 v[132:135], v8 offset:54272
    s_waitcnt lgkmcnt(7)
    v_mfma_f32_16x16x32_bf16 v[104:107], v[152:155], v[44:47], v[104:107]
    s_waitcnt lgkmcnt(6)
    v_mfma_f32_16x16x32_bf16 v[108:111], v[156:159], v[44:47], v[108:111]
    ds_read_b128 v[136:139], v8 offset:55296
    ds_read_b128 v[140:143], v8 offset:56320
    s_waitcnt lgkmcnt(7)
    v_mfma_f32_16x16x32_bf16 v[88:91], v[112:115], v[48:51], v[88:91]
    ds_read_b128 v[144:147], v8 offset:57344
    s_waitcnt lgkmcnt(7)
    v_mfma_f32_16x16x32_bf16 v[92:95], v[116:119], v[48:51], v[92:95]
    ds_read_b128 v[148:151], v8 offset:58368
    s_waitcnt lgkmcnt(7)
    v_mfma_f32_16x16x32_bf16 v[96:99], v[120:123], v[48:51], v[96:99]
    ds_read_b128 v[152:155], v8 offset:59392
    s_waitcnt lgkmcnt(7)
    v_mfma_f32_16x16x32_bf16 v[100:103], v[124:127], v[48:51], v[100:103]
    ds_read_b128 v[156:159], v8 offset:60416
    s_waitcnt lgkmcnt(7)
    v_mfma_f32_16x16x32_bf16 v[104:107], v[128:131], v[48:51], v[104:107]
    s_waitcnt lgkmcnt(6)
    v_mfma_f32_16x16x32_bf16 v[108:111], v[132:135], v[48:51], v[108:111]
    v_add_u32 v8, 61440, v8
    ds_read_b128 v[112:115], v8 offset:0
    s_waitcnt lgkmcnt(6)
    v_mfma_f32_16x16x32_bf16 v[88:91], v[136:139], v[52:55], v[88:91]
    ds_read_b128 v[116:119], v8 offset:1024
    s_waitcnt lgkmcnt(6)
    v_mfma_f32_16x16x32_bf16 v[92:95], v[140:143], v[52:55], v[92:95]
    ds_read_b128 v[120:123], v8 offset:2048
    s_waitcnt lgkmcnt(6)
    v_mfma_f32_16x16x32_bf16 v[96:99], v[144:147], v[52:55], v[96:99]
    ds_read_b128 v[124:127], v8 offset:3072
    s_waitcnt lgkmcnt(6)
    v_mfma_f32_16x16x32_bf16 v[100:103], v[148:151], v[52:55], v[100:103]
    ds_read_b128 v[128:131], v8 offset:4096
    s_waitcnt lgkmcnt(6)
    v_mfma_f32_16x16x32_bf16 v[104:107], v[152:155], v[52:55], v[104:107]
    ds_read_b128 v[132:135], v8 offset:5120
    s_waitcnt lgkmcnt(6)
    v_mfma_f32_16x16x32_bf16 v[108:111], v[156:159], v[52:55], v[108:111]
    ds_read_b128 v[136:139], v8 offset:6144
    ds_read_b128 v[140:143], v8 offset:7168
    s_waitcnt vmcnt(21) lgkmcnt(7)
    v_mfma_f32_16x16x32_bf16 v[88:91], v[112:115], v[56:59], v[88:91]
    ds_read_b128 v[144:147], v8 offset:8192
    s_waitcnt lgkmcnt(7)
    v_mfma_f32_16x16x32_bf16 v[92:95], v[116:119], v[56:59], v[92:95]
    ds_read_b128 v[148:151], v8 offset:9216
    s_waitcnt lgkmcnt(7)
    v_mfma_f32_16x16x32_bf16 v[96:99], v[120:123], v[56:59], v[96:99]
    ds_read_b128 v[152:155], v8 offset:10240
    s_waitcnt lgkmcnt(7)
    v_mfma_f32_16x16x32_bf16 v[100:103], v[124:127], v[56:59], v[100:103]
    ds_read_b128 v[156:159], v8 offset:11264
    s_waitcnt lgkmcnt(7)
    v_mfma_f32_16x16x32_bf16 v[104:107], v[128:131], v[56:59], v[104:107]
    s_waitcnt lgkmcnt(6)
    v_mfma_f32_16x16x32_bf16 v[108:111], v[132:135], v[56:59], v[108:111]
    s_waitcnt vmcnt(7)
    s_barrier
    s_waitcnt lgkmcnt(5)
    v_mfma_f32_16x16x32_bf16 v[88:91], v[136:139], v[60:63], v[88:91]
    ds_read_b128 v[112:115], v8 offset:12288
    ds_read_b128 v[116:119], v8 offset:13312
    s_waitcnt lgkmcnt(6)
    v_mfma_f32_16x16x32_bf16 v[92:95], v[140:143], v[60:63], v[92:95]
    ds_read_b128 v[120:123], v8 offset:14336
    ds_read_b128 v[124:127], v8 offset:15360
    s_waitcnt lgkmcnt(7)
    v_mfma_f32_16x16x32_bf16 v[96:99], v[144:147], v[60:63], v[96:99]
    ds_read_b128 v[128:131], v8 offset:16384
    s_waitcnt lgkmcnt(7)
    v_mfma_f32_16x16x32_bf16 v[100:103], v[148:151], v[60:63], v[100:103]
    ds_read_b128 v[132:135], v8 offset:17408
    s_waitcnt lgkmcnt(7)
    v_mfma_f32_16x16x32_bf16 v[104:107], v[152:155], v[60:63], v[104:107]
    s_waitcnt lgkmcnt(6)
    v_mfma_f32_16x16x32_bf16 v[108:111], v[156:159], v[60:63], v[108:111]
    ds_read_b128 v[136:139], v8 offset:18432
    ds_read_b128 v[140:143], v8 offset:19456
    s_waitcnt lgkmcnt(7)
    v_mfma_f32_16x16x32_bf16 v[88:91], v[112:115], v[64:67], v[88:91]
    ds_read_b128 v[144:147], v8 offset:20480
    s_waitcnt lgkmcnt(7)
    v_mfma_f32_16x16x32_bf16 v[92:95], v[116:119], v[64:67], v[92:95]
    ds_read_b128 v[148:151], v8 offset:21504
    s_waitcnt lgkmcnt(7)
    v_mfma_f32_16x16x32_bf16 v[96:99], v[120:123], v[64:67], v[96:99]
    ds_read_b128 v[152:155], v8 offset:22528
    s_waitcnt lgkmcnt(7)
    v_mfma_f32_16x16x32_bf16 v[100:103], v[124:127], v[64:67], v[100:103]
    ds_read_b128 v[156:159], v8 offset:23552
    s_waitcnt lgkmcnt(7)
    v_mfma_f32_16x16x32_bf16 v[104:107], v[128:131], v[64:67], v[104:107]
    s_waitcnt lgkmcnt(6)
    v_mfma_f32_16x16x32_bf16 v[108:111], v[132:135], v[64:67], v[108:111]
    ds_read_b128 v[112:115], v8 offset:24576
    ds_read_b128 v[116:119], v8 offset:25600
    s_waitcnt lgkmcnt(7)
    v_mfma_f32_16x16x32_bf16 v[88:91], v[136:139], v[68:71], v[88:91]
    ds_read_b128 v[120:123], v8 offset:26624
    s_waitcnt lgkmcnt(7)
    v_mfma_f32_16x16x32_bf16 v[92:95], v[140:143], v[68:71], v[92:95]
    ds_read_b128 v[124:127], v8 offset:27648
    s_waitcnt lgkmcnt(7)
    v_mfma_f32_16x16x32_bf16 v[96:99], v[144:147], v[68:71], v[96:99]
    ds_read_b128 v[128:131], v8 offset:28672
    s_waitcnt lgkmcnt(7)
    v_mfma_f32_16x16x32_bf16 v[100:103], v[148:151], v[68:71], v[100:103]
    ds_read_b128 v[132:135], v8 offset:29696
    s_waitcnt lgkmcnt(7)
    v_mfma_f32_16x16x32_bf16 v[104:107], v[152:155], v[68:71], v[104:107]
    s_waitcnt lgkmcnt(6)
    v_mfma_f32_16x16x32_bf16 v[108:111], v[156:159], v[68:71], v[108:111]
    ds_read_b128 v[136:139], v8 offset:30720
    ds_read_b128 v[140:143], v8 offset:31744
    s_waitcnt lgkmcnt(7)
    v_mfma_f32_16x16x32_bf16 v[88:91], v[112:115], v[72:75], v[88:91]
    ds_read_b128 v[144:147], v8 offset:32768
    s_waitcnt lgkmcnt(7)
    v_mfma_f32_16x16x32_bf16 v[92:95], v[116:119], v[72:75], v[92:95]
    ds_read_b128 v[148:151], v8 offset:33792
    s_waitcnt lgkmcnt(7)
    v_mfma_f32_16x16x32_bf16 v[96:99], v[120:123], v[72:75], v[96:99]
    ds_read_b128 v[152:155], v8 offset:34816
    s_waitcnt lgkmcnt(7)
    v_mfma_f32_16x16x32_bf16 v[100:103], v[124:127], v[72:75], v[100:103]
    ds_read_b128 v[156:159], v8 offset:35840
    s_waitcnt lgkmcnt(7)
    v_mfma_f32_16x16x32_bf16 v[104:107], v[128:131], v[72:75], v[104:107]
    s_waitcnt lgkmcnt(6)
    v_mfma_f32_16x16x32_bf16 v[108:111], v[132:135], v[72:75], v[108:111]
    ds_read_b128 v[112:115], v8 offset:36864
    ds_read_b128 v[116:119], v8 offset:37888
    s_waitcnt lgkmcnt(7)
    v_mfma_f32_16x16x32_bf16 v[88:91], v[136:139], v[76:79], v[88:91]
    ds_read_b128 v[120:123], v8 offset:38912
    s_waitcnt lgkmcnt(7)
    v_mfma_f32_16x16x32_bf16 v[92:95], v[140:143], v[76:79], v[92:95]
    ds_read_b128 v[124:127], v8 offset:39936
    s_waitcnt lgkmcnt(7)
    v_mfma_f32_16x16x32_bf16 v[96:99], v[144:147], v[76:79], v[96:99]
    ds_read_b128 v[128:131], v8 offset:40960
    s_waitcnt lgkmcnt(7)
    v_mfma_f32_16x16x32_bf16 v[100:103], v[148:151], v[76:79], v[100:103]
    ds_read_b128 v[132:135], v8 offset:41984
    s_waitcnt lgkmcnt(7)
    v_mfma_f32_16x16x32_bf16 v[104:107], v[152:155], v[76:79], v[104:107]
    s_waitcnt lgkmcnt(6)
    v_mfma_f32_16x16x32_bf16 v[108:111], v[156:159], v[76:79], v[108:111]
    ds_read_b128 v[136:139], v8 offset:43008
    ds_read_b128 v[140:143], v8 offset:44032
    s_waitcnt vmcnt(5) lgkmcnt(7)
    v_mfma_f32_16x16x32_bf16 v[88:91], v[112:115], v[80:83], v[88:91]
    ds_read_b128 v[144:147], v8 offset:45056
    s_waitcnt lgkmcnt(7)
    v_mfma_f32_16x16x32_bf16 v[92:95], v[116:119], v[80:83], v[92:95]
    ds_read_b128 v[148:151], v8 offset:46080
    s_waitcnt lgkmcnt(7)
    v_mfma_f32_16x16x32_bf16 v[96:99], v[120:123], v[80:83], v[96:99]
    ds_read_b128 v[152:155], v8 offset:47104
    s_waitcnt lgkmcnt(7)
    v_mfma_f32_16x16x32_bf16 v[100:103], v[124:127], v[80:83], v[100:103]
    ds_read_b128 v[156:159], v8 offset:48128
    s_waitcnt lgkmcnt(7)
    v_mfma_f32_16x16x32_bf16 v[104:107], v[128:131], v[80:83], v[104:107]
    s_waitcnt lgkmcnt(6)
    v_mfma_f32_16x16x32_bf16 v[108:111], v[132:135], v[80:83], v[108:111]
    s_waitcnt vmcnt(3) lgkmcnt(5)
    v_mfma_f32_16x16x32_bf16 v[88:91], v[136:139], v[84:87], v[88:91]
    s_waitcnt lgkmcnt(4)
    v_mfma_f32_16x16x32_bf16 v[92:95], v[140:143], v[84:87], v[92:95]
    s_waitcnt lgkmcnt(3)
    v_mfma_f32_16x16x32_bf16 v[96:99], v[144:147], v[84:87], v[96:99]
    s_waitcnt lgkmcnt(2)
    v_mfma_f32_16x16x32_bf16 v[100:103], v[148:151], v[84:87], v[100:103]
    s_waitcnt lgkmcnt(1)
    v_mfma_f32_16x16x32_bf16 v[104:107], v[152:155], v[84:87], v[104:107]
    s_waitcnt lgkmcnt(0)
    v_mfma_f32_16x16x32_bf16 v[108:111], v[156:159], v[84:87], v[108:111]
    s_waitcnt vmcnt(2)
    v_lshlrev_b32 v16, 16, v160
    v_and_b32 v17, 0xffff0000, v160
    v_lshlrev_b32 v18, 16, v161
    v_and_b32 v19, 0xffff0000, v161
    v_lshlrev_b32 v20, 16, v162
    v_and_b32 v21, 0xffff0000, v162
    v_lshlrev_b32 v22, 16, v163
    v_and_b32 v23, 0xffff0000, v163
    s_waitcnt vmcnt(1)
    v_lshlrev_b32 v24, 16, v164
    v_and_b32 v25, 0xffff0000, v164
    v_lshlrev_b32 v26, 16, v165
    v_and_b32 v27, 0xffff0000, v165
    v_lshlrev_b32 v28, 16, v166
    v_and_b32 v29, 0xffff0000, v166
    v_lshlrev_b32 v30, 16, v167
    v_and_b32 v31, 0xffff0000, v167
    s_waitcnt vmcnt(0)
    v_lshlrev_b32 v32, 16, v168
    v_and_b32 v33, 0xffff0000, v168
    v_lshlrev_b32 v34, 16, v169
    v_and_b32 v35, 0xffff0000, v169
    v_lshlrev_b32 v36, 16, v170
    v_and_b32 v37, 0xffff0000, v170
    v_lshlrev_b32 v38, 16, v171
    v_and_b32 v39, 0xffff0000, v171
    v_add_f32 v16, v16, v88
    v_add_f32 v17, v17, v89
    v_add_f32 v18, v18, v90
    v_add_f32 v19, v19, v91
    v_add_f32 v20, v20, v92
    v_add_f32 v21, v21, v93
    v_add_f32 v22, v22, v94
    v_add_f32 v23, v23, v95
    v_add_f32 v24, v24, v96
    v_add_f32 v25, v25, v97
    v_add_f32 v26, v26, v98
    v_add_f32 v27, v27, v99
    v_add_f32 v28, v28, v100
    v_add_f32 v29, v29, v101
    v_add_f32 v30, v30, v102
    v_add_f32 v31, v31, v103
    v_add_f32 v32, v32, v104
    v_add_f32 v33, v33, v105
    v_add_f32 v34, v34, v106
    v_add_f32 v35, v35, v107
    v_add_f32 v36, v36, v108
    v_add_f32 v37, v37, v109
    v_add_f32 v38, v38, v110
    v_add_f32 v39, v39, v111
    s_mul_i32 s52, s46, 18
    s_mul_i32 s53, s45, 3
    s_add_u32 s52, s52, s53
    s_lshl_b32 s52, s52, 10
    s_add_u32 s52, s52, 76021760
    v_cvt_pk_bf16_f32 v40, v16, v17
    v_cvt_pk_bf16_f32 v41, v18, v19
    v_cvt_pk_bf16_f32 v42, v20, v21
    v_cvt_pk_bf16_f32 v43, v22, v23
    buffer_store_dwordx4 v[40:43], v2, s[4:7], s52 offen offset:0
    v_cvt_pk_bf16_f32 v44, v24, v25
    v_cvt_pk_bf16_f32 v45, v26, v27
    v_cvt_pk_bf16_f32 v46, v28, v29
    v_cvt_pk_bf16_f32 v47, v30, v31
    buffer_store_dwordx4 v[44:47], v2, s[4:7], s52 offen offset:1024
    v_cvt_pk_bf16_f32 v48, v32, v33
    v_cvt_pk_bf16_f32 v49, v34, v35
    v_cvt_pk_bf16_f32 v50, v36, v37
    v_cvt_pk_bf16_f32 v51, v38, v39
    buffer_store_dwordx4 v[48:51], v2, s[4:7], s52 offen offset:2048
    v_lshlrev_b32 v16, 16, v40
    v_and_b32 v17, 0xffff0000, v40
    v_lshlrev_b32 v18, 16, v41
    v_and_b32 v19, 0xffff0000, v41
    v_lshlrev_b32 v20, 16, v42
    v_and_b32 v21, 0xffff0000, v42
    v_lshlrev_b32 v22, 16, v43
    v_and_b32 v23, 0xffff0000, v43
    v_lshlrev_b32 v24, 16, v44
    v_and_b32 v25, 0xffff0000, v44
    v_lshlrev_b32 v26, 16, v45
    v_and_b32 v27, 0xffff0000, v45
    v_lshlrev_b32 v28, 16, v46
    v_and_b32 v29, 0xffff0000, v46
    v_lshlrev_b32 v30, 16, v47
    v_and_b32 v31, 0xffff0000, v47
    v_lshlrev_b32 v32, 16, v48
    v_and_b32 v33, 0xffff0000, v48
    v_lshlrev_b32 v34, 16, v49
    v_and_b32 v35, 0xffff0000, v49
    v_lshlrev_b32 v36, 16, v50
    v_and_b32 v37, 0xffff0000, v50
    v_lshlrev_b32 v38, 16, v51
    v_and_b32 v39, 0xffff0000, v51
    v_add_f32 v56, v16, v17
    v_add_f32 v58, v18, v19
    v_add_f32 v56, v56, v20
    v_add_f32 v58, v58, v21
    v_add_f32 v56, v56, v22
    v_add_f32 v58, v58, v23
    v_add_f32 v56, v56, v24
    v_add_f32 v58, v58, v25
    v_add_f32 v56, v56, v26
    v_add_f32 v58, v58, v27
    v_add_f32 v56, v56, v28
    v_add_f32 v58, v58, v29
    v_add_f32 v56, v56, v30
    v_add_f32 v58, v58, v31
    v_add_f32 v56, v56, v32
    v_add_f32 v58, v58, v33
    v_add_f32 v56, v56, v34
    v_add_f32 v58, v58, v35
    v_add_f32 v56, v56, v36
    v_add_f32 v58, v58, v37
    v_add_f32 v56, v56, v38
    v_add_f32 v58, v58, v39
    v_add_f32 v56, v56, v58
    v_mov_b32 v58, v56
    s_nop 1
    v_permlane16_swap_b32 v56, v58
    v_add_f32 v56, v56, v58
    v_mov_b32 v58, v56
    s_nop 1
    v_permlane32_swap_b32 v56, v58
    v_add_f32 v56, v56, v58
    v_mul_f32 v59, 0x3c2aaaab, v56
    v_sub_f32 v58, v16, v59
    v_mul_f32 v57, v58, v58
    v_sub_f32 v61, v17, v59
    v_fmac_f32 v57, v61, v61
    v_sub_f32 v60, v18, v59
    v_fmac_f32 v57, v60, v60
    v_sub_f32 v61, v19, v59
    v_fmac_f32 v57, v61, v61
    v_sub_f32 v60, v20, v59
    v_fmac_f32 v57, v60, v60
    v_sub_f32 v61, v21, v59
    v_fmac_f32 v57, v61, v61
    v_sub_f32 v60, v22, v59
    v_fmac_f32 v57, v60, v60
    v_sub_f32 v61, v23, v59
    v_fmac_f32 v57, v61, v61
    v_sub_f32 v60, v24, v59
    v_fmac_f32 v57, v60, v60
    v_sub_f32 v61, v25, v59
    v_fmac_f32 v57, v61, v61
    v_sub_f32 v60, v26, v59
    v_fmac_f32 v57, v60, v60
    v_sub_f32 v61, v27, v59
    v_fmac_f32 v57, v61, v61
    v_sub_f32 v60, v28, v59
    v_fmac_f32 v57, v60, v60
    v_sub_f32 v61, v29, v59
    v_fmac_f32 v57, v61, v61
    v_sub_f32 v60, v30, v59
    v_fmac_f32 v57, v60, v60
    v_sub_f32 v61, v31, v59
    v_fmac_f32 v57, v61, v61
    v_sub_f32 v60, v32, v59
    v_fmac_f32 v57, v60, v60
    v_sub_f32 v61, v33, v59
    v_fmac_f32 v57, v61, v61
    v_sub_f32 v60, v34, v59
    v_fmac_f32 v57, v60, v60
    v_sub_f32 v61, v35, v59
    v_fmac_f32 v57, v61, v61
    v_sub_f32 v60, v36, v59
    v_fmac_f32 v57, v60, v60
    v_sub_f32 v61, v37, v59
    v_fmac_f32 v57, v61, v61
    v_sub_f32 v60, v38, v59
    v_fmac_f32 v57, v60, v60
    v_sub_f32 v61, v39, v59
    v_fmac_f32 v57, v61, v61
    v_mov_b32 v58, v57
    s_nop 1
    v_permlane16_swap_b32 v57, v58
    v_add_f32 v57, v57, v58
    v_mov_b32 v58, v57
    s_nop 1
    v_permlane32_swap_b32 v57, v58
    v_add_f32 v57, v57, v58
    s_lshl_b32 s52, s45, 14
    s_add_u32 s52, s52, 78381056
    s_mov_b32 exec_lo, 0xffff
    s_mov_b32 exec_hi, 0
    buffer_store_dwordx2 v[56:57], v7, s[4:7], s52 offen
    s_mov_b64 exec, -1
wo1_kernel_end:
    s_endpgm
.section .rodata,"a"
.p2align 6
.amdhsa_kernel wo1_kernel
  .amdhsa_next_free_vgpr 176
  .amdhsa_next_free_sgpr 102
  .amdhsa_accum_offset 176
  .amdhsa_group_segment_fixed_size 0
  .amdhsa_kernarg_size 80
  .amdhsa_user_sgpr_count 2
  .amdhsa_user_sgpr_kernarg_segment_ptr 1
  .amdhsa_system_sgpr_workgroup_id_x 1
  .amdhsa_float_denorm_mode_32 3
.end_amdhsa_kernel
.text
.globl ffn1_kernel
.p2align 8
.type ffn1_kernel,@function
ffn1_kernel:
    s_cmp_ge_u32 s2, 256
    s_cbranch_scc1 ffn1_kernel_end
    s_load_dwordx16 s[24:39], s[0:1], 0
    s_load_dwordx4 s[40:43], s[0:1], 64
    v_lshrrev_b32 v1, 6, v0
    s_and_b32 s21, s2, 7
    v_readfirstlane_b32 s20, v1
    s_lshr_b32 s22, s2, 3
    v_and_b32 v1, 63, v0
    v_lshlrev_b32 v2, 4, v1
    s_waitcnt lgkmcnt(0)
    s_mov_b32 s4, s42
    s_mov_b32 s5, s43
    s_mov_b32 s6, 0x10000000
    s_mov_b32 s7, 0x20000
    s_lshr_b32 s44, s22, 4
    s_and_b32 s60, s21, 6
    s_add_u32 s44, s44, s60
    s_and_b32 s60, s21, 1
    s_lshl_b32 s60, s60, 4
    s_and_b32 s47, s22, 15
    s_add_u32 s47, s47, s60
    s_lshr_b32 s45, s47, 2
    s_and_b32 s46, s47, 3
    s_mul_i32 s48, s47, 497664
    s_add_u32 s48, s48, 4194304
    s_mul_i32 s63, s20, 9
    s_lshr_b32 s63, s63, 1
    s_lshl_b32 s63, s63, 10
    s_add_u32 s62, s48, s63
    s_mul_i32 s49, s20, 9216
    s_add_u32 s48, s48, s49
    s_lshl_b32 s54, s44, 4
    s_lshl_b32 s60, s20, 2
    s_add_u32 s54, s54, s60
    s_mul_i32 s50, s54, 18432
    s_mul_i32 s53, s45, 2359296
    s_add_u32 s53, s53, s50
    s_add_u32 s50, s50, 76021760
    s_lshr_b32 s60, s46, 1
    s_mul_i32 s60, s60, 9216
    s_add_u32 s53, s53, s60
    s_add_u32 s53, s53, 100663296
    v_lshlrev_b32 v3, 3, v1
    v_mov_b32 v4, v2
    s_and_b32 s60, s20, 1
    s_lshl_b32 s60, s60, 10
    s_add_u32 m0, s60, 147456
    s_mul_i32 s61, s47, 1152
    s_add_u32 s61, s61, s60
    s_add_u32 s61, s61, 3670016
    buffer_load_dwordx4 v2, s[4:7], s61 offen lds
    s_add_u32 m0, s49, 0
    s_add_u32 s61, s48, 0
    buffer_load_dwordx4 v2, s[4:7], s61 offen offset:0 lds
    buffer_load_dwordx4 v2, s[4:7], s61 offen offset:1024 lds
    buffer_load_dwordx4 v2, s[4:7], s61 offen offset:2048 lds
    buffer_load_dwordx4 v2, s[4:7], s61 offen offset:3072 lds
    s_add_u32 m0, s49, 4096
    s_add_u32 s61, s48, 4096
    buffer_load_dwordx4 v2, s[4:7], s61 offen offset:0 lds
    buffer_load_dwordx4 v2, s[4:7], s61 offen offset:1024 lds
    buffer_load_dwordx4 v2, s[4:7], s61 offen offset:2048 lds
    buffer_load_dwordx4 v2, s[4:7], s61 offen offset:3072 lds
    s_add_u32 m0, s49, 8192
    s_add_u32 s61, s48, 8192
    buffer_load_dwordx4 v2, s[4:7], s61 offen offset:0 lds
    s_add_u32 m0, s49, 36864
    s_add_u32 s61, s48, 36864
    buffer_load_dwordx4 v2, s[4:7], s61 offen offset:0 lds
    buffer_load_dwordx4 v2, s[4:7], s61 offen offset:1024 lds
    buffer_load_dwordx4 v2, s[4:7], s61 offen offset:2048 lds
    buffer_load_dwordx4 v2, s[4:7], s61 offen offset:3072 lds
    s_add_u32 m0, s49, 40960
    s_add_u32 s61, s48, 40960
    buffer_load_dwordx4 v2, s[4:7], s61 offen offset:0 lds
    buffer_load_dwordx4 v2, s[4:7], s61 offen offset:1024 lds
    buffer_load_dwordx4 v2, s[4:7], s61 offen offset:2048 lds
    buffer_load_dwordx4 v2, s[4:7], s61 offen offset:3072 lds
    s_add_u32 m0, s49, 45056
    s_add_u32 s61, s48, 45056
    buffer_load_dwordx4 v2, s[4:7], s61 offen offset:0 lds
    s_add_u32 s60, s50, 0
    buffer_load_dwordx4 a[0:3], v2, s[4:7], s60 offen offset:0
    buffer_load_dwordx4 a[16:19], v2, s[4:7], s60 offen offset:1024
    buffer_load_dwordx4 a[32:35], v2, s[4:7], s60 offen offset:2048
    buffer_load_dwordx4 a[48:51], v2, s[4:7], s60 offen offset:3072
    s_add_u32 s60, s50, 18432
    buffer_load_dwordx4 a[4:7], v2, s[4:7], s60 offen offset:0
    buffer_load_dwordx4 a[20:23], v2, s[4:7], s60 offen offset:1024
    buffer_load_dwordx4 a[36:39], v2, s[4:7], s60 offen offset:2048
    buffer_load_dwordx4 a[52:55], v2, s[4:7], s60 offen offset:3072
    s_add_u32 s60, s50, 36864
    buffer_load_dwordx4 a[8:11], v2, s[4:7], s60 offen offset:0
    buffer_load_dwordx4 a[24:27], v2, s[4:7], s60 offen offset:1024
    buffer_load_dwordx4 a[40:43], v2, s[4:7], s60 offen offset:2048
    buffer_load_dwordx4 a[56:59], v2, s[4:7], s60 offen offset:3072
    s_add_u32 s60, s50, 55296
    buffer_load_dwordx4 a[12:15], v2, s[4:7], s60 offen offset:0
    buffer_load_dwordx4 a[28:31], v2, s[4:7], s60 offen offset:1024
    buffer_load_dwordx4 a[44:47], v2, s[4:7], s60 offen offset:2048
    buffer_load_dwordx4 a[60:63], v2, s[4:7], s60 offen offset:3072
    s_add_u32 s60, s50, 4096
    buffer_load_dwordx4 a[64:67], v2, s[4:7], s60 offen offset:0
    buffer_load_dwordx4 a[80:83], v2, s[4:7], s60 offen offset:1024
    buffer_load_dwordx4 a[96:99], v2, s[4:7], s60 offen offset:2048
    buffer_load_dwordx4 a[112:115], v2, s[4:7], s60 offen offset:3072
    s_add_u32 s60, s50, 22528
    buffer_load_dwordx4 a[68:71], v2, s[4:7], s60 offen offset:0
    buffer_load_dwordx4 a[84:87], v2, s[4:7], s60 offen offset:1024
    buffer_load_dwordx4 a[100:103], v2, s[4:7], s60 offen offset:2048
    buffer_load_dwordx4 a[116:119], v2, s[4:7], s60 offen offset:3072
    s_add_u32 s60, s50, 40960
    buffer_load_dwordx4 a[72:75], v2, s[4:7], s60 offen offset:0
    buffer_load_dwordx4 a[88:91], v2, s[4:7], s60 offen offset:1024
    buffer_load_dwordx4 a[104:107], v2, s[4:7], s60 offen offset:2048
    buffer_load_dwordx4 a[120:123], v2, s[4:7], s60 offen offset:3072
    s_add_u32 s60, s50, 59392
    buffer_load_dwordx4 a[76:79], v2, s[4:7], s60 offen offset:0
    buffer_load_dwordx4 a[92:95], v2, s[4:7], s60 offen offset:1024
    buffer_load_dwordx4 a[108:111], v2, s[4:7], s60 offen offset:2048
    buffer_load_dwordx4 a[124:127], v2, s[4:7], s60 offen offset:3072
    s_lshl_b32 s60, s44, 5
    s_add_u32 s60, s60, s47
    s_mul_i32 s51, s60, 73728
    s_add_u32 s51, s51, 81002496
    s_xor_b32 s61, s60, 1
    s_mul_i32 s56, s61, 73728
    s_add_u32 s56, s56, 81002496
    s_xor_b32 s61, s60, 2
    s_mul_i32 s57, s61, 73728
    s_add_u32 s57, s57, 81002496
    s_xor_b32 s61, s60, 3
    s_mul_i32 s58, s61, 73728
    s_add_u32 s58, s58, 81002496
    s_lshr_b32 s52, s60, 2
    s_lshl_b32 s52, s52, 2
    s_add_u32 s52, s52, s20
    s_lshl_b32 s52, s52, 7
    s_add_u32 s52, s52, 3997696
    v_lshrrev_b32 v5, 4, v1
    v_lshlrev_b32 v5, 4, v5
    v_add_u32 v5, 147456, v5
    v_and_b32 v6, 15, v1
    s_lshl_b32 s60, s54, 4
    v_add_u32 v6, s60, v6
    v_lshlrev_b32 v6, 3, v6
    s_lshl_b32 s60, s20, 12
    s_add_u32 s51, s51, s60
    s_add_u32 s56, s56, s60
    s_add_u32 s57, s57, s60
    s_add_u32 s58, s58, s60
    s_lshl_b32 s65, s20, 11
    s_sub_u32 s65, 65536, s65
    s_lshl_b32 s67, s46, 2
    s_add_u32 s67, s67, s52
    v_add_u32 v7, 0x10000, v2
    s_waitcnt vmcnt(32)
    s_barrier
    ds_read_b128 v[8:11], v4 offset:0
    ds_read_b128 v[12:15], v4 offset:1024
    ds_read_b128 v[16:19], v4 offset:36864
    ds_read_b128 v[20:23], v4 offset:37888
    s_add_u32 s60, s50, 8192
    buffer_load_dwordx4 a[128:131], v2, s[4:7], s60 offen offset:0
    s_waitcnt vmcnt(32) lgkmcnt(3)
    v_mfma_f32_16x16x32_bf16 v[208:211], v[8:11], a[0:3], 0
    ds_read_b128 v[24:27], v4 offset:2048
    buffer_load_dwordx4 a[144:147], v2, s[4:7], s60 offen offset:1024
    s_waitcnt vmcnt(29)
    v_mfma_f32_16x16x32_bf16 v[212:215], v[8:11], a[4:7], 0
    buffer_load_dwordx4 a[160:163], v2, s[4:7], s60 offen offset:2048
    buffer_load_dwordx4 a[176:179], v2, s[4:7], s60 offen offset:3072
    s_waitcnt vmcnt(27)
    v_mfma_f32_16x16x32_bf16 v[216:219], v[8:11], a[8:11], 0
    s_add_u32 s60, s50, 26624
    buffer_load_dwordx4 a[132:135], v2, s[4:7], s60 offen offset:0
    s_waitcnt vmcnt(24)
    v_mfma_f32_16x16x32_bf16 v[220:223], v[8:11], a[12:15], 0
    buffer_load_dwordx4 a[148:151], v2, s[4:7], s60 offen offset:1024
    buffer_load_dwordx4 a[164:167], v2, s[4:7], s60 offen offset:2048
    s_waitcnt lgkmcnt(3)
    v_mfma_f32_16x16x32_bf16 v[224:227], v[12:15], a[0:3], 0
    ds_read_b128 v[28:31], v4 offset:3072
    buffer_load_dwordx4 a[180:183], v2, s[4:7], s60 offen offset:3072
    v_mfma_f32_16x16x32_bf16 v[228:231], v[12:15], a[4:7], 0
    s_add_u32 s60, s50, 45056
    buffer_load_dwordx4 a[136:139], v2, s[4:7], s60 offen offset:0
    v_mfma_f32_16x16x32_bf16 v[232:235], v[12:15], a[8:11], 0
    buffer_load_dwordx4 a[152:155], v2, s[4:7], s60 offen offset:1024
    buffer_load_dwordx4 a[168:171], v2, s[4:7], s60 offen offset:2048
    v_mfma_f32_16x16x32_bf16 v[236:239], v[12:15], a[12:15], 0
    buffer_load_dwordx4 a[184:187], v2, s[4:7], s60 offen offset:3072
    s_add_u32 s60, s50, 63488
    s_waitcnt lgkmcnt(3)
    v_mfma_f32_16x16x32_bf16 v[64:67], v[16:19], a[0:3], 0
    ds_read_b128 v[8:11], v4 offset:38912
    buffer_load_dwordx4 a[140:143], v2, s[4:7], s60 offen offset:0
    v_mfma_f32_16x16x32_bf16 v[68:71], v[16:19], a[4:7], 0
    buffer_load_dwordx4 a[156:159], v2, s[4:7], s60 offen offset:1024
    buffer_load_dwordx4 a[172:175], v2, s[4:7], s60 offen offset:2048
    v_mfma_f32_16x16x32_bf16 v[72:75], v[16:19], a[8:11], 0
    buffer_load_dwordx4 a[188:191], v2, s[4:7], s60 offen offset:3072
    s_add_u32 s60, s50, 12288
    v_mfma_f32_16x16x32_bf16 v[76:79], v[16:19], a[12:15], 0
    buffer_load_dwordx4 a[192:195], v2, s[4:7], s60 offen offset:0
    buffer_load_dwordx4 a[208:211], v2, s[4:7], s60 offen offset:1024
    s_waitcnt lgkmcnt(3)
    v_mfma_f32_16x16x32_bf16 v[80:83], v[20:23], a[0:3], 0
    ds_read_b128 v[12:15], v4 offset:39936
    buffer_load_dwordx4 a[224:227], v2, s[4:7], s60 offen offset:2048
    v_mfma_f32_16x16x32_bf16 v[84:87], v[20:23], a[4:7], 0
    buffer_load_dwordx4 a[240:243], v2, s[4:7], s60 offen offset:3072
    s_add_u32 s60, s50, 30720
    v_mfma_f32_16x16x32_bf16 v[88:91], v[20:23], a[8:11], 0
    buffer_load_dwordx4 a[196:199], v2, s[4:7], s60 offen offset:0
    buffer_load_dwordx4 a[212:215], v2, s[4:7], s60 offen offset:1024
    v_mfma_f32_16x16x32_bf16 v[92:95], v[20:23], a[12:15], 0
    buffer_load_dwordx4 a[228:231], v2, s[4:7], s60 offen offset:2048
    buffer_load_dwordx4 a[244:247], v2, s[4:7], s60 offen offset:3072
    s_waitcnt lgkmcnt(3)
    v_mfma_f32_16x16x32_bf16 v[208:211], v[24:27], a[16:19], v[208:211]
    ds_read_b128 v[16:19], v4 offset:4096
    s_add_u32 s60, s50, 49152
    v_mfma_f32_16x16x32_bf16 v[212:215], v[24:27], a[20:23], v[212:215]
    buffer_load_dwordx4 a[200:203], v2, s[4:7], s60 offen offset:0
    buffer_load_dwordx4 a[216:219], v2, s[4:7], s60 offen offset:1024
    v_mfma_f32_16x16x32_bf16 v[216:219], v[24:27], a[24:27], v[216:219]
    buffer_load_dwordx4 a[232:235], v2, s[4:7], s60 offen offset:2048
    buffer_load_dwordx4 a[248:251], v2, s[4:7], s60 offen offset:3072
    s_waitcnt vmcnt(46)
    v_mfma_f32_16x16x32_bf16 v[220:223], v[24:27], a[28:31], v[220:223]
    s_add_u32 s60, s50, 67584
    buffer_load_dwordx4 a[204:207], v2, s[4:7], s60 offen offset:0
    s_waitcnt lgkmcnt(3)
    v_mfma_f32_16x16x32_bf16 v[224:227], v[28:31], a[16:19], v[224:227]
    ds_read_b128 v[20:23], v4 offset:5120
    buffer_load_dwordx4 a[220:223], v2, s[4:7], s60 offen offset:1024
    v_mfma_f32_16x16x32_bf16 v[228:231], v[28:31], a[20:23], v[228:231]
    buffer_load_dwordx4 a[236:239], v2, s[4:7], s60 offen offset:2048
    buffer_load_dwordx4 a[252:255], v2, s[4:7], s60 offen offset:3072
    v_mfma_f32_16x16x32_bf16 v[232:235], v[28:31], a[24:27], v[232:235]
    s_add_u32 s60, s50, 16384
    buffer_load_dwordx4 v[32:35], v2, s[4:7], s60 offen offset:0
    v_mfma_f32_16x16x32_bf16 v[236:239], v[28:31], a[28:31], v[236:239]
    buffer_load_dwordx4 v[48:51], v2, s[4:7], s60 offen offset:1024
    s_add_u32 s60, s50, 34816
    s_waitcnt lgkmcnt(3)
    v_mfma_f32_16x16x32_bf16 v[64:67], v[8:11], a[16:19], v[64:67]
    ds_read_b128 v[24:27], v4 offset:40960
    buffer_load_dwordx4 v[36:39], v2, s[4:7], s60 offen offset:0
    v_mfma_f32_16x16x32_bf16 v[68:71], v[8:11], a[20:23], v[68:71]
    buffer_load_dwordx4 v[52:55], v2, s[4:7], s60 offen offset:1024
    s_add_u32 s60, s50, 53248
    v_mfma_f32_16x16x32_bf16 v[72:75], v[8:11], a[24:27], v[72:75]
    buffer_load_dwordx4 v[40:43], v2, s[4:7], s60 offen offset:0
    buffer_load_dwordx4 v[56:59], v2, s[4:7], s60 offen offset:1024
    v_mfma_f32_16x16x32_bf16 v[76:79], v[8:11], a[28:31], v[76:79]
    s_add_u32 s60, s50, 71680
    buffer_load_dwordx4 v[44:47], v2, s[4:7], s60 offen offset:0
    s_waitcnt lgkmcnt(3)
    v_mfma_f32_16x16x32_bf16 v[80:83], v[12:15], a[16:19], v[80:83]
    ds_read_b128 v[28:31], v4 offset:41984
    buffer_load_dwordx4 v[60:63], v2, s[4:7], s60 offen offset:1024
    v_mfma_f32_16x16x32_bf16 v[84:87], v[12:15], a[20:23], v[84:87]
    s_mov_b32 s60, 78381056
    buffer_load_dwordx2 v[96:97], v6, s[4:7], s60 offen offset:0
    v_mfma_f32_16x16x32_bf16 v[88:91], v[12:15], a[24:27], v[88:91]
    buffer_load_dwordx2 v[108:109], v6, s[4:7], s60 offen offset:128
    buffer_load_dwordx2 v[120:121], v6, s[4:7], s60 offen offset:256
    v_mfma_f32_16x16x32_bf16 v[92:95], v[12:15], a[28:31], v[92:95]
    buffer_load_dwordx2 v[156:157], v6, s[4:7], s60 offen offset:384
    s_mov_b32 s60, 78397440
    s_waitcnt lgkmcnt(3)
    v_mfma_f32_16x16x32_bf16 v[208:211], v[16:19], a[32:35], v[208:211]
    ds_read_b128 v[8:11], v4 offset:6144
    buffer_load_dwordx2 v[98:99], v6, s[4:7], s60 offen offset:0
    v_mfma_f32_16x16x32_bf16 v[212:215], v[16:19], a[36:39], v[212:215]
    buffer_load_dwordx2 v[110:111], v6, s[4:7], s60 offen offset:128
    buffer_load_dwordx2 v[122:123], v6, s[4:7], s60 offen offset:256
    v_mfma_f32_16x16x32_bf16 v[216:219], v[16:19], a[40:43], v[216:219]
    buffer_load_dwordx2 v[158:159], v6, s[4:7], s60 offen offset:384
    s_mov_b32 s60, 78413824
    s_waitcnt vmcnt(63)
    v_mfma_f32_16x16x32_bf16 v[220:223], v[16:19], a[44:47], v[220:223]
    buffer_load_dwordx2 v[100:101], v6, s[4:7], s60 offen offset:0
    buffer_load_dwordx2 v[112:113], v6, s[4:7], s60 offen offset:128
    s_waitcnt lgkmcnt(3)
    v_mfma_f32_16x16x32_bf16 v[224:227], v[20:23], a[32:35], v[224:227]
    ds_read_b128 v[12:15], v4 offset:7168
    buffer_load_dwordx2 v[124:125], v6, s[4:7], s60 offen offset:256
    v_mfma_f32_16x16x32_bf16 v[228:231], v[20:23], a[36:39], v[228:231]
    buffer_load_dwordx2 v[160:161], v6, s[4:7], s60 offen offset:384
    s_mov_b32 s60, 78430208
    v_mfma_f32_16x16x32_bf16 v[232:235], v[20:23], a[40:43], v[232:235]
    buffer_load_dwordx2 v[102:103], v6, s[4:7], s60 offen offset:0
    buffer_load_dwordx2 v[114:115], v6, s[4:7], s60 offen offset:128
    v_mfma_f32_16x16x32_bf16 v[236:239], v[20:23], a[44:47], v[236:239]
    buffer_load_dwordx2 v[126:127], v6, s[4:7], s60 offen offset:256
    buffer_load_dwordx2 v[162:163], v6, s[4:7], s60 offen offset:384
    s_waitcnt lgkmcnt(3)
    v_mfma_f32_16x16x32_bf16 v[64:67], v[24:27], a[32:35], v[64:67]
    ds_read_b128 v[16:19], v4 offset:43008
    s_mov_b32 s60, 78446592
    v_mfma_f32_16x16x32_bf16 v[68:71], v[24:27], a[36:39], v[68:71]
    buffer_load_dwordx2 v[104:105], v6, s[4:7], s60 offen offset:0
    buffer_load_dwordx2 v[116:117], v6, s[4:7], s60 offen offset:128
    v_mfma_f32_16x16x32_bf16 v[72:75], v[24:27], a[40:43], v[72:75]
    buffer_load_dwordx2 v[152:153], v6, s[4:7], s60 offen offset:256
    buffer_load_dwordx2 v[164:165], v6, s[4:7], s60 offen offset:384
    v_mfma_f32_16x16x32_bf16 v[76:79], v[24:27], a[44:47], v[76:79]
    s_mov_b32 s60, 78462976
    buffer_load_dwordx2 v[106:107], v6, s[4:7], s60 offen offset:0
    s_waitcnt lgkmcnt(3)
    v_mfma_f32_16x16x32_bf16 v[80:83], v[28:31], a[32:35], v[80:83]
    ds_read_b128 v[20:23], v4 offset:44032
    buffer_load_dwordx2 v[118:119], v6, s[4:7], s60 offen offset:128
    v_mfma_f32_16x16x32_bf16 v[84:87], v[28:31], a[36:39], v[84:87]
    buffer_load_dwordx2 v[154:155], v6, s[4:7], s60 offen offset:256
    buffer_load_dwordx2 v[166:167], v6, s[4:7], s60 offen offset:384
    v_mfma_f32_16x16x32_bf16 v[88:91], v[28:31], a[40:43], v[88:91]
    s_add_u32 m0, s49, 73728
    s_add_u32 s61, s48, 73728
    v_mfma_f32_16x16x32_bf16 v[92:95], v[28:31], a[44:47], v[92:95]
    buffer_load_dwordx4 v2, s[4:7], s61 offen offset:0 lds
    buffer_load_dwordx4 v2, s[4:7], s61 offen offset:1024 lds
    s_waitcnt lgkmcnt(3)
    v_mfma_f32_16x16x32_bf16 v[208:211], v[8:11], a[48:51], v[208:211]
    ds_read_b128 v[24:27], v4 offset:8192
    buffer_load_dwordx4 v2, s[4:7], s61 offen offset:2048 lds
    v_mfma_f32_16x16x32_bf16 v[212:215], v[8:11], a[52:55], v[212:215]
    buffer_load_dwordx4 v2, s[4:7], s61 offen offset:3072 lds
    s_add_u32 m0, s49, 77824
    v_mfma_f32_16x16x32_bf16 v[216:219], v[8:11], a[56:59], v[216:219]
    s_add_u32 s61, s48, 77824
    buffer_load_dwordx4 v2, s[4:7], s61 offen offset:0 lds
    s_waitcnt vmcnt(63)
    v_mfma_f32_16x16x32_bf16 v[220:223], v[8:11], a[60:63], v[220:223]
    buffer_load_dwordx4 v2, s[4:7], s61 offen offset:1024 lds
    buffer_load_dwordx4 v2, s[4:7], s61 offen offset:2048 lds
    s_waitcnt lgkmcnt(3)
    v_mfma_f32_16x16x32_bf16 v[224:227], v[12:15], a[48:51], v[224:227]
    ds_read_b128 v[28:31], v4 offset:9216
    buffer_load_dwordx4 v2, s[4:7], s61 offen offset:3072 lds
    v_mfma_f32_16x16x32_bf16 v[228:231], v[12:15], a[52:55], v[228:231]
    s_add_u32 m0, s49, 81920
    s_add_u32 s61, s48, 81920
    v_mfma_f32_16x16x32_bf16 v[232:235], v[12:15], a[56:59], v[232:235]
    buffer_load_dwordx4 v2, s[4:7], s61 offen offset:0 lds
    s_add_u32 m0, s49, 110592
    v_mfma_f32_16x16x32_bf16 v[236:239], v[12:15], a[60:63], v[236:239]
    s_add_u32 s61, s48, 110592
    buffer_load_dwordx4 v2, s[4:7], s61 offen offset:0 lds
    s_waitcnt lgkmcnt(3)
    v_mfma_f32_16x16x32_bf16 v[64:67], v[16:19], a[48:51], v[64:67]
    ds_read_b128 v[8:11], v4 offset:45056
    buffer_load_dwordx4 v2, s[4:7], s61 offen offset:1024 lds
    v_mfma_f32_16x16x32_bf16 v[68:71], v[16:19], a[52:55], v[68:71]
    buffer_load_dwordx4 v2, s[4:7], s61 offen offset:2048 lds
    buffer_load_dwordx4 v2, s[4:7], s61 offen offset:3072 lds
    v_mfma_f32_16x16x32_bf16 v[72:75], v[16:19], a[56:59], v[72:75]
    s_add_u32 m0, s49, 114688
    s_add_u32 s61, s48, 114688
    v_mfma_f32_16x16x32_bf16 v[76:79], v[16:19], a[60:63], v[76:79]
    buffer_load_dwordx4 v2, s[4:7], s61 offen offset:0 lds
    buffer_load_dwordx4 v2, s[4:7], s61 offen offset:1024 lds
    s_waitcnt lgkmcnt(3)
    v_mfma_f32_16x16x32_bf16 v[80:83], v[20:23], a[48:51], v[80:83]
    ds_read_b128 v[12:15], v4 offset:46080
    buffer_load_dwordx4 v2, s[4:7], s61 offen offset:2048 lds
    v_mfma_f32_16x16x32_bf16 v[84:87], v[20:23], a[52:55], v[84:87]
    buffer_load_dwordx4 v2, s[4:7], s61 offen offset:3072 lds
    s_add_u32 m0, s49, 118784
    v_mfma_f32_16x16x32_bf16 v[88:91], v[20:23], a[56:59], v[88:91]
    s_add_u32 s61, s48, 118784
    buffer_load_dwordx4 v2, s[4:7], s61 offen offset:0 lds
    v_mfma_f32_16x16x32_bf16 v[92:95], v[20:23], a[60:63], v[92:95]
    s_waitcnt vmcnt(63) lgkmcnt(3)
    v_mfma_f32_16x16x32_bf16 v[208:211], v[24:27], a[64:67], v[208:211]
    ds_read_b128 v[16:19], v4 offset:10240
    s_waitcnt vmcnt(63)
    v_mfma_f32_16x16x32_bf16 v[212:215], v[24:27], a[68:71], v[212:215]
    s_waitcnt vmcnt(63)
    v_mfma_f32_16x16x32_bf16 v[216:219], v[24:27], a[72:75], v[216:219]
    s_waitcnt vmcnt(63)
    v_mfma_f32_16x16x32_bf16 v[220:223], v[24:27], a[76:79], v[220:223]
    s_waitcnt lgkmcnt(3)
    v_mfma_f32_16x16x32_bf16 v[224:227], v[28:31], a[64:67], v[224:227]
    ds_read_b128 v[20:23], v4 offset:11264
    v_mfma_f32_16x16x32_bf16 v[228:231], v[28:31], a[68:71], v[228:231]
    v_mfma_f32_16x16x32_bf16 v[232:235], v[28:31], a[72:75], v[232:235]
    v_mfma_f32_16x16x32_bf16 v[236:239], v[28:31], a[76:79], v[236:239]
    s_waitcnt lgkmcnt(3)
    v_mfma_f32_16x16x32_bf16 v[64:67], v[8:11], a[64:67], v[64:67]
    ds_read_b128 v[24:27], v4 offset:47104
    v_mfma_f32_16x16x32_bf16 v[68:71], v[8:11], a[68:71], v[68:71]
    v_mfma_f32_16x16x32_bf16 v[72:75], v[8:11], a[72:75], v[72:75]
    v_mfma_f32_16x16x32_bf16 v[76:79], v[8:11], a[76:79], v[76:79]
    s_waitcnt lgkmcnt(3)
    v_mfma_f32_16x16x32_bf16 v[80:83], v[12:15], a[64:67], v[80:83]
    ds_read_b128 v[28:31], v4 offset:48128
    v_mfma_f32_16x16x32_bf16 v[84:87], v[12:15], a[68:71], v[84:87]
    v_mfma_f32_16x16x32_bf16 v[88:91], v[12:15], a[72:75], v[88:91]
    v_mfma_f32_16x16x32_bf16 v[92:95], v[12:15], a[76:79], v[92:95]
    s_waitcnt lgkmcnt(3)
    v_mfma_f32_16x16x32_bf16 v[208:211], v[16:19], a[80:83], v[208:211]
    ds_read_b128 v[8:11], v4 offset:12288
    v_mfma_f32_16x16x32_bf16 v[212:215], v[16:19], a[84:87], v[212:215]
    v_mfma_f32_16x16x32_bf16 v[216:219], v[16:19], a[88:91], v[216:219]
    s_waitcnt vmcnt(63)
    v_mfma_f32_16x16x32_bf16 v[220:223], v[16:19], a[92:95], v[220:223]
    s_waitcnt lgkmcnt(3)
    v_mfma_f32_16x16x32_bf16 v[224:227], v[20:23], a[80:83], v[224:227]
    ds_read_b128 v[12:15], v4 offset:13312
    v_mfma_f32_16x16x32_bf16 v[228:231], v[20:23], a[84:87], v[228:231]
    v_mfma_f32_16x16x32_bf16 v[232:235], v[20:23], a[88:91], v[232:235]
    v_mfma_f32_16x16x32_bf16 v[236:239], v[20:23], a[92:95], v[236:239]
    s_waitcnt lgkmcnt(3)
    v_mfma_f32_16x16x32_bf16 v[64:67], v[24:27], a[80:83], v[64:67]
    ds_read_b128 v[16:19], v4 offset:49152
    v_mfma_f32_16x16x32_bf16 v[68:71], v[24:27], a[84:87], v[68:71]
    v_mfma_f32_16x16x32_bf16 v[72:75], v[24:27], a[88:91], v[72:75]
    v_mfma_f32_16x16x32_bf16 v[76:79], v[24:27], a[92:95], v[76:79]
    s_waitcnt lgkmcnt(3)
    v_mfma_f32_16x16x32_bf16 v[80:83], v[28:31], a[80:83], v[80:83]
    ds_read_b128 v[20:23], v4 offset:50176
    v_mfma_f32_16x16x32_bf16 v[84:87], v[28:31], a[84:87], v[84:87]
    v_mfma_f32_16x16x32_bf16 v[88:91], v[28:31], a[88:91], v[88:91]
    v_mfma_f32_16x16x32_bf16 v[92:95], v[28:31], a[92:95], v[92:95]
    s_waitcnt lgkmcnt(3)
    v_mfma_f32_16x16x32_bf16 v[208:211], v[8:11], a[96:99], v[208:211]
    ds_read_b128 v[24:27], v4 offset:14336
    v_mfma_f32_16x16x32_bf16 v[212:215], v[8:11], a[100:103], v[212:215]
    v_mfma_f32_16x16x32_bf16 v[216:219], v[8:11], a[104:107], v[216:219]
    s_waitcnt vmcnt(63)
    v_mfma_f32_16x16x32_bf16 v[220:223], v[8:11], a[108:111], v[220:223]
    s_waitcnt lgkmcnt(3)
    v_mfma_f32_16x16x32_bf16 v[224:227], v[12:15], a[96:99], v[224:227]
    ds_read_b128 v[28:31], v4 offset:15360
    v_mfma_f32_16x16x32_bf16 v[228:231], v[12:15], a[100:103], v[228:231]
    v_mfma_f32_16x16x32_bf16 v[232:235], v[12:15], a[104:107], v[232:235]
    v_mfma_f32_16x16x32_bf16 v[236:239], v[12:15], a[108:111], v[236:239]
    s_waitcnt lgkmcnt(3)
    v_mfma_f32_16x16x32_bf16 v[64:67], v[16:19], a[96:99], v[64:67]
    ds_read_b128 v[8:11], v4 offset:51200
    v_mfma_f32_16x16x32_bf16 v[68:71], v[16:19], a[100:103], v[68:71]
    v_mfma_f32_16x16x32_bf16 v[72:75], v[16:19], a[104:107], v[72:75]
    v_mfma_f32_16x16x32_bf16 v[76:79], v[16:19], a[108:111], v[76:79]
    s_waitcnt lgkmcnt(3)
    v_mfma_f32_16x16x32_bf16 v[80:83], v[20:23], a[96:99], v[80:83]
    ds_read_b128 v[12:15], v4 offset:52224
    v_mfma_f32_16x16x32_bf16 v[84:87], v[20:23], a[100:103], v[84:87]
    v_mfma_f32_16x16x32_bf16 v[88:91], v[20:23], a[104:107], v[88:91]
    v_mfma_f32_16x16x32_bf16 v[92:95], v[20:23], a[108:111], v[92:95]
    s_waitcnt lgkmcnt(3)
    v_mfma_f32_16x16x32_bf16 v[208:211], v[24:27], a[112:115], v[208:211]
    ds_read_b128 v[16:19], v4 offset:16384
    v_mfma_f32_16x16x32_bf16 v[212:215], v[24:27], a[116:119], v[212:215]
    v_mfma_f32_16x16x32_bf16 v[216:219], v[24:27], a[120:123], v[216:219]
    s_waitcnt vmcnt(63)
    v_mfma_f32_16x16x32_bf16 v[220:223], v[24:27], a[124:127], v[220:223]
    s_waitcnt lgkmcnt(3)
    v_mfma_f32_16x16x32_bf16 v[224:227], v[28:31], a[112:115], v[224:227]
    ds_read_b128 v[20:23], v4 offset:17408
    v_mfma_f32_16x16x32_bf16 v[228:231], v[28:31], a[116:119], v[228:231]
    v_mfma_f32_16x16x32_bf16 v[232:235], v[28:31], a[120:123], v[232:235]
    v_mfma_f32_16x16x32_bf16 v[236:239], v[28:31], a[124:127], v[236:239]
    s_waitcnt lgkmcnt(3)
    v_mfma_f32_16x16x32_bf16 v[64:67], v[8:11], a[112:115], v[64:67]
    ds_read_b128 v[24:27], v4 offset:53248
    v_mfma_f32_16x16x32_bf16 v[68:71], v[8:11], a[116:119], v[68:71]
    v_mfma_f32_16x16x32_bf16 v[72:75], v[8:11], a[120:123], v[72:75]
    v_mfma_f32_16x16x32_bf16 v[76:79], v[8:11], a[124:127], v[76:79]
    s_waitcnt lgkmcnt(3)
    v_mfma_f32_16x16x32_bf16 v[80:83], v[12:15], a[112:115], v[80:83]
    ds_read_b128 v[28:31], v4 offset:54272
    v_mfma_f32_16x16x32_bf16 v[84:87], v[12:15], a[116:119], v[84:87]
    v_mfma_f32_16x16x32_bf16 v[88:91], v[12:15], a[120:123], v[88:91]
    v_mfma_f32_16x16x32_bf16 v[92:95], v[12:15], a[124:127], v[92:95]
    s_waitcnt vmcnt(63) lgkmcnt(3)
    v_mfma_f32_16x16x32_bf16 v[208:211], v[16:19], a[128:131], v[208:211]
    ds_read_b128 v[8:11], v4 offset:18432
    s_waitcnt vmcnt(63)
    v_mfma_f32_16x16x32_bf16 v[212:215], v[16:19], a[132:135], v[212:215]
    s_waitcnt vmcnt(63)
    v_mfma_f32_16x16x32_bf16 v[216:219], v[16:19], a[136:139], v[216:219]
    s_waitcnt vmcnt(63)
    v_mfma_f32_16x16x32_bf16 v[220:223], v[16:19], a[140:143], v[220:223]
    s_waitcnt lgkmcnt(3)
    v_mfma_f32_16x16x32_bf16 v[224:227], v[20:23], a[128:131], v[224:227]
    ds_read_b128 v[12:15], v4 offset:19456
    v_mfma_f32_16x16x32_bf16 v[228:231], v[20:23], a[132:135], v[228:231]
    v_mfma_f32_16x16x32_bf16 v[232:235], v[20:23], a[136:139], v[232:235]
    v_mfma_f32_16x16x32_bf16 v[236:239], v[20:23], a[140:143], v[236:239]
    s_waitcnt lgkmcnt(3)
    v_mfma_f32_16x16x32_bf16 v[64:67], v[24:27], a[128:131], v[64:67]
    ds_read_b128 v[16:19], v4 offset:55296
    v_mfma_f32_16x16x32_bf16 v[68:71], v[24:27], a[132:135], v[68:71]
    v_mfma_f32_16x16x32_bf16 v[72:75], v[24:27], a[136:139], v[72:75]
    v_mfma_f32_16x16x32_bf16 v[76:79], v[24:27], a[140:143], v[76:79]
    s_waitcnt lgkmcnt(3)
    v_mfma_f32_16x16x32_bf16 v[80:83], v[28:31], a[128:131], v[80:83]
    ds_read_b128 v[20:23], v4 offset:56320
    v_mfma_f32_16x16x32_bf16 v[84:87], v[28:31], a[132:135], v[84:87]
    v_mfma_f32_16x16x32_bf16 v[88:91], v[28:31], a[136:139], v[88:91]
    v_mfma_f32_16x16x32_bf16 v[92:95], v[28:31], a[140:143], v[92:95]
    s_waitcnt lgkmcnt(3)
    v_mfma_f32_16x16x32_bf16 v[208:211], v[8:11], a[144:147], v[208:211]
    ds_read_b128 v[24:27], v4 offset:20480
    v_mfma_f32_16x16x32_bf16 v[212:215], v[8:11], a[148:151], v[212:215]
    v_mfma_f32_16x16x32_bf16 v[216:219], v[8:11], a[152:155], v[216:219]
    s_waitcnt vmcnt(63)
    v_mfma_f32_16x16x32_bf16 v[220:223], v[8:11], a[156:159], v[220:223]
    s_waitcnt lgkmcnt(3)
    v_mfma_f32_16x16x32_bf16 v[224:227], v[12:15], a[144:147], v[224:227]
    ds_read_b128 v[28:31], v4 offset:21504
    v_mfma_f32_16x16x32_bf16 v[228:231], v[12:15], a[148:151], v[228:231]
    v_mfma_f32_16x16x32_bf16 v[232:235], v[12:15], a[152:155], v[232:235]
    v_mfma_f32_16x16x32_bf16 v[236:239], v[12:15], a[156:159], v[236:239]
    s_waitcnt lgkmcnt(3)
    v_mfma_f32_16x16x32_bf16 v[64:67], v[16:19], a[144:147], v[64:67]
    ds_read_b128 v[8:11], v4 offset:57344
    v_mfma_f32_16x16x32_bf16 v[68:71], v[16:19], a[148:151], v[68:71]
    v_mfma_f32_16x16x32_bf16 v[72:75], v[16:19], a[152:155], v[72:75]
    v_mfma_f32_16x16x32_bf16 v[76:79], v[16:19], a[156:159], v[76:79]
    s_waitcnt lgkmcnt(3)
    v_mfma_f32_16x16x32_bf16 v[80:83], v[20:23], a[144:147], v[80:83]
    ds_read_b128 v[12:15], v4 offset:58368
    v_mfma_f32_16x16x32_bf16 v[84:87], v[20:23], a[148:151], v[84:87]
    v_mfma_f32_16x16x32_bf16 v[88:91], v[20:23], a[152:155], v[88:91]
    v_mfma_f32_16x16x32_bf16 v[92:95], v[20:23], a[156:159], v[92:95]
    s_waitcnt lgkmcnt(3)
    v_mfma_f32_16x16x32_bf16 v[208:211], v[24:27], a[160:163], v[208:211]
    ds_read_b128 v[16:19], v4 offset:22528
    v_mfma_f32_16x16x32_bf16 v[212:215], v[24:27], a[164:167], v[212:215]
    v_mfma_f32_16x16x32_bf16 v[216:219], v[24:27], a[168:171], v[216:219]
    s_waitcnt vmcnt(63)
    v_mfma_f32_16x16x32_bf16 v[220:223], v[24:27], a[172:175], v[220:223]
    s_waitcnt lgkmcnt(3)
    v_mfma_f32_16x16x32_bf16 v[224:227], v[28:31], a[160:163], v[224:227]
    ds_read_b128 v[20:23], v4 offset:23552
    v_mfma_f32_16x16x32_bf16 v[228:231], v[28:31], a[164:167], v[228:231]
    v_mfma_f32_16x16x32_bf16 v[232:235], v[28:31], a[168:171], v[232:235]
    v_mfma_f32_16x16x32_bf16 v[236:239], v[28:31], a[172:175], v[236:239]
    s_waitcnt lgkmcnt(3)
    v_mfma_f32_16x16x32_bf16 v[64:67], v[8:11], a[160:163], v[64:67]
    ds_read_b128 v[24:27], v4 offset:59392
    v_mfma_f32_16x16x32_bf16 v[68:71], v[8:11], a[164:167], v[68:71]
    v_mfma_f32_16x16x32_bf16 v[72:75], v[8:11], a[168:171], v[72:75]
    v_mfma_f32_16x16x32_bf16 v[76:79], v[8:11], a[172:175], v[76:79]
    s_waitcnt lgkmcnt(3)
    v_mfma_f32_16x16x32_bf16 v[80:83], v[12:15], a[160:163], v[80:83]
    ds_read_b128 v[28:31], v4 offset:60416
    v_mfma_f32_16x16x32_bf16 v[84:87], v[12:15], a[164:167], v[84:87]
    v_mfma_f32_16x16x32_bf16 v[88:91], v[12:15], a[168:171], v[88:91]
    v_mfma_f32_16x16x32_bf16 v[92:95], v[12:15], a[172:175], v[92:95]
    s_waitcnt lgkmcnt(3)
    v_mfma_f32_16x16x32_bf16 v[208:211], v[16:19], a[176:179], v[208:211]
    ds_read_b128 v[8:11], v4 offset:24576
    v_mfma_f32_16x16x32_bf16 v[212:215], v[16:19], a[180:183], v[212:215]
    v_mfma_f32_16x16x32_bf16 v[216:219], v[16:19], a[184:187], v[216:219]
    s_waitcnt vmcnt(63)
    v_mfma_f32_16x16x32_bf16 v[220:223], v[16:19], a[188:191], v[220:223]
    s_waitcnt lgkmcnt(3)
    v_mfma_f32_16x16x32_bf16 v[224:227], v[20:23], a[176:179], v[224:227]
    ds_read_b128 v[12:15], v4 offset:25600
    v_mfma_f32_16x16x32_bf16 v[228:231], v[20:23], a[180:183], v[228:231]
    v_mfma_f32_16x16x32_bf16 v[232:235], v[20:23], a[184:187], v[232:235]
    v_mfma_f32_16x16x32_bf16 v[236:239], v[20:23], a[188:191], v[236:239]
    s_waitcnt lgkmcnt(3)
    v_mfma_f32_16x16x32_bf16 v[64:67], v[24:27], a[176:179], v[64:67]
    ds_read_b128 v[16:19], v4 offset:61440
    v_mfma_f32_16x16x32_bf16 v[68:71], v[24:27], a[180:183], v[68:71]
    v_mfma_f32_16x16x32_bf16 v[72:75], v[24:27], a[184:187], v[72:75]
    v_mfma_f32_16x16x32_bf16 v[76:79], v[24:27], a[188:191], v[76:79]
    s_waitcnt lgkmcnt(3)
    v_mfma_f32_16x16x32_bf16 v[80:83], v[28:31], a[176:179], v[80:83]
    ds_read_b128 v[20:23], v4 offset:62464
    v_mfma_f32_16x16x32_bf16 v[84:87], v[28:31], a[180:183], v[84:87]
    v_mfma_f32_16x16x32_bf16 v[88:91], v[28:31], a[184:187], v[88:91]
    v_mfma_f32_16x16x32_bf16 v[92:95], v[28:31], a[188:191], v[92:95]
    s_waitcnt vmcnt(63) lgkmcnt(3)
    v_mfma_f32_16x16x32_bf16 v[208:211], v[8:11], a[192:195], v[208:211]
    ds_read_b128 v[24:27], v4 offset:26624
    s_waitcnt vmcnt(61)
    v_mfma_f32_16x16x32_bf16 v[212:215], v[8:11], a[196:199], v[212:215]
    s_waitcnt vmcnt(57)
    v_mfma_f32_16x16x32_bf16 v[216:219], v[8:11], a[200:203], v[216:219]
    s_waitcnt vmcnt(53)
    v_mfma_f32_16x16x32_bf16 v[220:223], v[8:11], a[204:207], v[220:223]
    s_waitcnt lgkmcnt(3)
    v_mfma_f32_16x16x32_bf16 v[224:227], v[12:15], a[192:195], v[224:227]
    ds_read_b128 v[28:31], v4 offset:27648
    v_mfma_f32_16x16x32_bf16 v[228:231], v[12:15], a[196:199], v[228:231]
    s_waitcnt vmcnt(37)
    v_add_f32 v128, v96, v98
    v_add_f32 v132, v97, v99
    v_mfma_f32_16x16x32_bf16 v[232:235], v[12:15], a[200:203], v[232:235]
    s_waitcnt vmcnt(33)
    v_add_f32 v128, v128, v100
    v_add_f32 v132, v132, v101
    v_mfma_f32_16x16x32_bf16 v[236:239], v[12:15], a[204:207], v[236:239]
    s_waitcnt vmcnt(29)
    v_add_f32 v128, v128, v102
    v_add_f32 v132, v132, v103
    s_waitcnt lgkmcnt(3)
    v_mfma_f32_16x16x32_bf16 v[64:67], v[16:19], a[192:195], v[64:67]
    ds_read_b128 v[8:11], v4 offset:63488
    s_waitcnt vmcnt(25)
    v_add_f32 v128, v128, v104
    v_mfma_f32_16x16x32_bf16 v[68:71], v[16:19], a[196:199], v[68:71]
    v_add_f32 v132, v132, v105
    s_waitcnt vmcnt(21)
    v_add_f32 v128, v128, v106
    v_mfma_f32_16x16x32_bf16 v[72:75], v[16:19], a[200:203], v[72:75]
    v_add_f32 v132, v132, v107
    v_mul_f32 v128, 0xbae38e39, v128
    v_mfma_f32_16x16x32_bf16 v[76:79], v[16:19], a[204:207], v[76:79]
    v_fmamk_f32 v169, v96, 0x3c2aaaab, v128
    v_mul_f32 v168, v169, v169
    s_waitcnt lgkmcnt(3)
    v_mfma_f32_16x16x32_bf16 v[80:83], v[20:23], a[192:195], v[80:83]
    ds_read_b128 v[12:15], v4 offset:64512
    v_fmamk_f32 v169, v98, 0x3c2aaaab, v128
    v_mfma_f32_16x16x32_bf16 v[84:87], v[20:23], a[196:199], v[84:87]
    v_fmac_f32 v168, v169, v169
    v_fmamk_f32 v169, v100, 0x3c2aaaab, v128
    v_mfma_f32_16x16x32_bf16 v[88:91], v[20:23], a[200:203], v[88:91]
    v_fmac_f32 v168, v169, v169
    v_fmamk_f32 v169, v102, 0x3c2aaaab, v128
    v_mfma_f32_16x16x32_bf16 v[92:95], v[20:23], a[204:207], v[92:95]
    v_fmac_f32 v168, v169, v169
    v_fmamk_f32 v169, v104, 0x3c2aaaab, v128
    s_waitcnt lgkmcnt(3)
    v_mfma_f32_16x16x32_bf16 v[208:211], v[24:27], a[208:211], v[208:211]
    ds_read_b128 v[16:19], v4 offset:28672
    v_fmac_f32 v168, v169, v169
    v_mfma_f32_16x16x32_bf16 v[212:215], v[24:27], a[212:215], v[212:215]
    v_fmamk_f32 v169, v106, 0x3c2aaaab, v128
    v_fmac_f32 v168, v169, v169
    v_mfma_f32_16x16x32_bf16 v[216:219], v[24:27], a[216:219], v[216:219]
    v_fmac_f32 v132, 0x42c00000, v168
    v_mov_b32 v169, 0x3727c5ac
    v_mfma_f32_16x16x32_bf16 v[220:223], v[24:27], a[220:223], v[220:223]
    v_fmac_f32 v169, 0x3ae38e39, v132
    v_rcp_f32 v132, v169
    s_waitcnt lgkmcnt(3)
    v_mfma_f32_16x16x32_bf16 v[224:227], v[28:31], a[208:211], v[224:227]
    ds_read_b128 v[20:23], v4 offset:29696
    v_add_f32 v129, v108, v110
    v_mfma_f32_16x16x32_bf16 v[228:231], v[28:31], a[212:215], v[228:231]
    v_add_f32 v133, v109, v111
    v_add_f32 v129, v129, v112
    v_mfma_f32_16x16x32_bf16 v[232:235], v[28:31], a[216:219], v[232:235]
    v_add_f32 v133, v133, v113
    v_add_f32 v129, v129, v114
    v_mfma_f32_16x16x32_bf16 v[236:239], v[28:31], a[220:223], v[236:239]
    v_add_f32 v133, v133, v115
    v_add_f32 v129, v129, v116
    s_waitcnt lgkmcnt(3)
    v_mfma_f32_16x16x32_bf16 v[64:67], v[8:11], a[208:211], v[64:67]
    ds_read_b128 v[24:27], v7 offset:0
    v_add_f32 v133, v133, v117
    v_mfma_f32_16x16x32_bf16 v[68:71], v[8:11], a[212:215], v[68:71]
    s_waitcnt vmcnt(20)
    v_add_f32 v129, v129, v118
    v_add_f32 v133, v133, v119
    v_mfma_f32_16x16x32_bf16 v[72:75], v[8:11], a[216:219], v[72:75]
    v_mul_f32 v129, 0xbae38e39, v129
    v_fmamk_f32 v169, v108, 0x3c2aaaab, v129
    v_mfma_f32_16x16x32_bf16 v[76:79], v[8:11], a[220:223], v[76:79]
    v_mul_f32 v168, v169, v169
    v_fmamk_f32 v169, v110, 0x3c2aaaab, v129
    s_waitcnt lgkmcnt(3)
    v_mfma_f32_16x16x32_bf16 v[80:83], v[12:15], a[208:211], v[80:83]
    ds_read_b128 v[28:31], v7 offset:1024
    v_fmac_f32 v168, v169, v169
    v_mfma_f32_16x16x32_bf16 v[84:87], v[12:15], a[212:215], v[84:87]
    v_fmamk_f32 v169, v112, 0x3c2aaaab, v129
    v_fmac_f32 v168, v169, v169
    v_mfma_f32_16x16x32_bf16 v[88:91], v[12:15], a[216:219], v[88:91]
    v_fmamk_f32 v169, v114, 0x3c2aaaab, v129
    v_fmac_f32 v168, v169, v169
    v_mfma_f32_16x16x32_bf16 v[92:95], v[12:15], a[220:223], v[92:95]
    v_fmamk_f32 v169, v116, 0x3c2aaaab, v129
    v_fmac_f32 v168, v169, v169
    s_waitcnt lgkmcnt(3)
    v_mfma_f32_16x16x32_bf16 v[208:211], v[16:19], a[224:227], v[208:211]
    ds_read_b128 v[8:11], v4 offset:30720
    v_fmamk_f32 v169, v118, 0x3c2aaaab, v129
    v_mfma_f32_16x16x32_bf16 v[212:215], v[16:19], a[228:231], v[212:215]
    v_fmac_f32 v168, v169, v169
    v_fmac_f32 v133, 0x42c00000, v168
    v_mfma_f32_16x16x32_bf16 v[216:219], v[16:19], a[232:235], v[216:219]
    v_mov_b32 v169, 0x3727c5ac
    v_fmac_f32 v169, 0x3ae38e39, v133
    v_mfma_f32_16x16x32_bf16 v[220:223], v[16:19], a[236:239], v[220:223]
    v_rcp_f32 v133, v169
    v_add_f32 v130, v120, v122
    s_waitcnt lgkmcnt(3)
    v_mfma_f32_16x16x32_bf16 v[224:227], v[20:23], a[224:227], v[224:227]
    ds_read_b128 v[12:15], v4 offset:31744
    v_add_f32 v134, v121, v123
    v_mfma_f32_16x16x32_bf16 v[228:231], v[20:23], a[228:231], v[228:231]
    v_add_f32 v130, v130, v124
    v_add_f32 v134, v134, v125
    v_mfma_f32_16x16x32_bf16 v[232:235], v[20:23], a[232:235], v[232:235]
    v_add_f32 v130, v130, v126
    v_add_f32 v134, v134, v127
    v_mfma_f32_16x16x32_bf16 v[236:239], v[20:23], a[236:239], v[236:239]
    v_add_f32 v130, v130, v152
    v_add_f32 v134, v134, v153
    s_waitcnt lgkmcnt(3)
    v_mfma_f32_16x16x32_bf16 v[64:67], v[24:27], a[224:227], v[64:67]
    ds_read_b128 v[16:19], v7 offset:2048
    s_waitcnt vmcnt(19)
    v_add_f32 v130, v130, v154
    v_mfma_f32_16x16x32_bf16 v[68:71], v[24:27], a[228:231], v[68:71]
    v_add_f32 v134, v134, v155
    v_mul_f32 v130, 0xbae38e39, v130
    v_mfma_f32_16x16x32_bf16 v[72:75], v[24:27], a[232:235], v[72:75]
    v_fmamk_f32 v169, v120, 0x3c2aaaab, v130
    v_mul_f32 v168, v169, v169
    v_mfma_f32_16x16x32_bf16 v[76:79], v[24:27], a[236:239], v[76:79]
    v_fmamk_f32 v169, v122, 0x3c2aaaab, v130
    v_fmac_f32 v168, v169, v169
    s_waitcnt lgkmcnt(3)
    v_mfma_f32_16x16x32_bf16 v[80:83], v[28:31], a[224:227], v[80:83]
    ds_read_b128 v[20:23], v7 offset:3072
    v_fmamk_f32 v169, v124, 0x3c2aaaab, v130
    v_mfma_f32_16x16x32_bf16 v[84:87], v[28:31], a[228:231], v[84:87]
    v_fmac_f32 v168, v169, v169
    v_fmamk_f32 v169, v126, 0x3c2aaaab, v130
    v_mfma_f32_16x16x32_bf16 v[88:91], v[28:31], a[232:235], v[88:91]
    v_fmac_f32 v168, v169, v169
    v_fmamk_f32 v169, v152, 0x3c2aaaab, v130
    v_mfma_f32_16x16x32_bf16 v[92:95], v[28:31], a[236:239], v[92:95]
    v_fmac_f32 v168, v169, v169
    v_fmamk_f32 v169, v154, 0x3c2aaaab, v130
    s_waitcnt lgkmcnt(3)
    v_mfma_f32_16x16x32_bf16 v[208:211], v[8:11], a[240:243], v[208:211]
    ds_read_b128 v[24:27], v4 offset:32768
    v_fmac_f32 v168, v169, v169
    v_mfma_f32_16x16x32_bf16 v[212:215], v[8:11], a[244:247], v[212:215]
    v_fmac_f32 v134, 0x42c00000, v168
    v_mov_b32 v169, 0x3727c5ac
    v_mfma_f32_16x16x32_bf16 v[216:219], v[8:11], a[248:251], v[216:219]
    v_fmac_f32 v169, 0x3ae38e39, v134
    v_rcp_f32 v134, v169
    v_mfma_f32_16x16x32_bf16 v[220:223], v[8:11], a[252:255], v[220:223]
    v_add_f32 v131, v156, v158
    v_add_f32 v135, v157, v159
    s_waitcnt lgkmcnt(3)
    v_mfma_f32_16x16x32_bf16 v[224:227], v[12:15], a[240:243], v[224:227]
    ds_read_b128 v[28:31], v4 offset:33792
    v_add_f32 v131, v131, v160
    v_mfma_f32_16x16x32_bf16 v[228:231], v[12:15], a[244:247], v[228:231]
    v_add_f32 v135, v135, v161
    v_add_f32 v131, v131, v162
    v_mfma_f32_16x16x32_bf16 v[232:235], v[12:15], a[248:251], v[232:235]
    v_add_f32 v135, v135, v163
    v_add_f32 v131, v131, v164
    v_mfma_f32_16x16x32_bf16 v[236:239], v[12:15], a[252:255], v[236:239]
    v_add_f32 v135, v135, v165
    s_waitcnt vmcnt(18)
    v_add_f32 v131, v131, v166
    s_waitcnt lgkmcnt(3)
    v_mfma_f32_16x16x32_bf16 v[64:67], v[16:19], a[240:243], v[64:67]
    ds_read_b128 v[8:11], v7 offset:4096
    v_add_f32 v135, v135, v167
    v_mfma_f32_16x16x32_bf16 v[68:71], v[16:19], a[244:247], v[68:71]
    v_mul_f32 v131, 0xbae38e39, v131
    v_fmamk_f32 v169, v156, 0x3c2aaaab, v131
    v_mfma_f32_16x16x32_bf16 v[72:75], v[16:19], a[248:251], v[72:75]
    v_mul_f32 v168, v169, v169
    v_fmamk_f32 v169, v158, 0x3c2aaaab, v131
    v_mfma_f32_16x16x32_bf16 v[76:79], v[16:19], a[252:255], v[76:79]
    v_fmac_f32 v168, v169, v169
    v_fmamk_f32 v169, v160, 0x3c2aaaab, v131
    s_waitcnt lgkmcnt(3)
    v_mfma_f32_16x16x32_bf16 v[80:83], v[20:23], a[240:243], v[80:83]
    ds_read_b128 v[12:15], v7 offset:5120
    v_fmac_f32 v168, v169, v169
    v_mfma_f32_16x16x32_bf16 v[84:87], v[20:23], a[244:247], v[84:87]
    v_fmamk_f32 v169, v162, 0x3c2aaaab, v131
    v_fmac_f32 v168, v169, v169
    v_mfma_f32_16x16x32_bf16 v[88:91], v[20:23], a[248:251], v[88:91]
    v_fmamk_f32 v169, v164, 0x3c2aaaab, v131
    v_fmac_f32 v168, v169, v169
    v_mfma_f32_16x16x32_bf16 v[92:95], v[20:23], a[252:255], v[92:95]
    v_fmamk_f32 v169, v166, 0x3c2aaaab, v131
    v_fmac_f32 v168, v169, v169
    s_waitcnt lgkmcnt(3)
    v_mfma_f32_16x16x32_bf16 v[208:211], v[24:27], v[32:35], v[208:211]
    ds_read_b128 v[16:19], v4 offset:34816
    v_fmac_f32 v135, 0x42c00000, v168
    v_mfma_f32_16x16x32_bf16 v[212:215], v[24:27], v[36:39], v[212:215]
    v_mov_b32 v169, 0x3727c5ac
    v_fmac_f32 v169, 0x3ae38e39, v135
    v_mfma_f32_16x16x32_bf16 v[216:219], v[24:27], v[40:43], v[216:219]
    v_rcp_f32 v135, v169
    v_mfma_f32_16x16x32_bf16 v[220:223], v[24:27], v[44:47], v[220:223]
    s_waitcnt lgkmcnt(3)
    v_mfma_f32_16x16x32_bf16 v[224:227], v[28:31], v[32:35], v[224:227]
    ds_read_b128 v[20:23], v4 offset:35840
    v_mfma_f32_16x16x32_bf16 v[228:231], v[28:31], v[36:39], v[228:231]
    v_mfma_f32_16x16x32_bf16 v[232:235], v[28:31], v[40:43], v[232:235]
    v_mfma_f32_16x16x32_bf16 v[236:239], v[28:31], v[44:47], v[236:239]
    s_waitcnt lgkmcnt(3)
    v_mfma_f32_16x16x32_bf16 v[64:67], v[8:11], v[32:35], v[64:67]
    ds_read_b128 v[24:27], v7 offset:6144
    v_mfma_f32_16x16x32_bf16 v[68:71], v[8:11], v[36:39], v[68:71]
    v_mfma_f32_16x16x32_bf16 v[72:75], v[8:11], v[40:43], v[72:75]
    v_mfma_f32_16x16x32_bf16 v[76:79], v[8:11], v[44:47], v[76:79]
    ds_read_b128 v[136:139], v5 offset:0
    ds_read_b128 v[140:143], v5 offset:64
    s_waitcnt lgkmcnt(5)
    v_mfma_f32_16x16x32_bf16 v[80:83], v[12:15], v[32:35], v[80:83]
    ds_read_b128 v[28:31], v7 offset:7168
    ds_read_b128 v[144:147], v5 offset:128
    v_mfma_f32_16x16x32_bf16 v[84:87], v[12:15], v[36:39], v[84:87]
    ds_read_b128 v[148:151], v5 offset:192
    v_mfma_f32_16x16x32_bf16 v[88:91], v[12:15], v[40:43], v[88:91]
    v_mfma_f32_16x16x32_bf16 v[92:95], v[12:15], v[44:47], v[92:95]
    s_waitcnt lgkmcnt(7)
    v_mfma_f32_16x16x32_bf16 v[208:211], v[16:19], v[48:51], v[208:211]
    s_waitcnt vmcnt(9)
    s_waitcnt lgkmcnt(0)
    s_barrier
    v_mfma_f32_16x16x32_bf16 v[212:215], v[16:19], v[52:55], v[212:215]
    v_add_u32 v4, 0x12000, v4
    ds_read_b128 v[8:11], v4 offset:0
    v_mfma_f32_16x16x32_bf16 v[216:219], v[16:19], v[56:59], v[216:219]
    s_add_u32 m0, s49, 0
    s_add_u32 s61, s48, 147456
    v_mfma_f32_16x16x32_bf16 v[220:223], v[16:19], v[60:63], v[220:223]
    buffer_load_dwordx4 v2, s[4:7], s61 offen offset:0 lds
    buffer_load_dwordx4 v2, s[4:7], s61 offen offset:1024 lds
    v_mfma_f32_16x16x32_bf16 v[224:227], v[20:23], v[48:51], v[224:227]
    ds_read_b128 v[12:15], v4 offset:1024
    buffer_load_dwordx4 v2, s[4:7], s61 offen offset:2048 lds
    v_mfma_f32_16x16x32_bf16 v[228:231], v[20:23], v[52:55], v[228:231]
    buffer_load_dwordx4 v2, s[4:7], s61 offen offset:3072 lds
    s_add_u32 m0, s49, 4096
    v_mfma_f32_16x16x32_bf16 v[232:235], v[20:23], v[56:59], v[232:235]
    s_add_u32 s61, s48, 151552
    buffer_load_dwordx4 v2, s[4:7], s61 offen offset:0 lds
    v_mfma_f32_16x16x32_bf16 v[236:239], v[20:23], v[60:63], v[236:239]
    buffer_load_dwordx4 v2, s[4:7], s61 offen offset:1024 lds
    buffer_load_dwordx4 v2, s[4:7], s61 offen offset:2048 lds
    v_mfma_f32_16x16x32_bf16 v[64:67], v[24:27], v[48:51], v[64:67]
    ds_read_b128 v[16:19], v4 offset:2048
    buffer_load_dwordx4 v2, s[4:7], s61 offen offset:3072 lds
    v_mfma_f32_16x16x32_bf16 v[68:71], v[24:27], v[52:55], v[68:71]
    s_add_u32 m0, s49, 8192
    s_add_u32 s61, s48, 155648
    v_mfma_f32_16x16x32_bf16 v[72:75], v[24:27], v[56:59], v[72:75]
    buffer_load_dwordx4 v2, s[4:7], s61 offen offset:0 lds
    s_add_u32 m0, s49, 36864
    v_mfma_f32_16x16x32_bf16 v[76:79], v[24:27], v[60:63], v[76:79]
    s_add_u32 s61, s48, 184320
    buffer_load_dwordx4 v2, s[4:7], s61 offen offset:0 lds
    v_mfma_f32_16x16x32_bf16 v[80:83], v[28:31], v[48:51], v[80:83]
    ds_read_b128 v[20:23], v4 offset:3072
    buffer_load_dwordx4 v2, s[4:7], s61 offen offset:1024 lds
    v_mfma_f32_16x16x32_bf16 v[84:87], v[28:31], v[52:55], v[84:87]
    buffer_load_dwordx4 v2, s[4:7], s61 offen offset:2048 lds
    buffer_load_dwordx4 v2, s[4:7], s61 offen offset:3072 lds
    v_mfma_f32_16x16x32_bf16 v[88:91], v[28:31], v[56:59], v[88:91]
    s_add_u32 m0, s49, 40960
    s_add_u32 s61, s48, 188416
    v_mfma_f32_16x16x32_bf16 v[92:95], v[28:31], v[60:63], v[92:95]
    buffer_load_dwordx4 v2, s[4:7], s61 offen offset:0 lds
    buffer_load_dwordx4 v2, s[4:7], s61 offen offset:1024 lds
    s_waitcnt lgkmcnt(3)
    v_mfma_f32_16x16x32_bf16 v[96:99], v[8:11], a[0:3], 0
    ds_read_b128 v[24:27], v4 offset:4096
    buffer_load_dwordx4 v2, s[4:7], s61 offen offset:2048 lds
    v_mfma_f32_16x16x32_bf16 v[100:103], v[8:11], a[4:7], 0
    buffer_load_dwordx4 v2, s[4:7], s61 offen offset:3072 lds
    s_add_u32 m0, s49, 45056
    v_mfma_f32_16x16x32_bf16 v[104:107], v[8:11], a[8:11], 0
    s_add_u32 s61, s48, 192512
    buffer_load_dwordx4 v2, s[4:7], s61 offen offset:0 lds
    v_mfma_f32_16x16x32_bf16 v[108:111], v[8:11], a[12:15], 0
    s_waitcnt lgkmcnt(3)
    v_mfma_f32_16x16x32_bf16 v[112:115], v[12:15], a[0:3], 0
    ds_read_b128 v[28:31], v4 offset:5120
    v_mfma_f32_16x16x32_bf16 v[116:119], v[12:15], a[4:7], 0
    v_fmac_f32 v64, v144, v128
    v_fmac_f32 v65, v145, v128
    v_mfma_f32_16x16x32_bf16 v[120:123], v[12:15], a[8:11], 0
    v_fmac_f32 v66, v146, v128
    v_fmac_f32 v67, v147, v128
    v_mfma_f32_16x16x32_bf16 v[124:127], v[12:15], a[12:15], 0
    v_fmac_f32 v80, v148, v128
    v_fmac_f32 v81, v149, v128
    s_waitcnt lgkmcnt(3)
    v_mfma_f32_16x16x32_bf16 v[96:99], v[16:19], a[16:19], v[96:99]
    ds_read_b128 v[8:11], v4 offset:6144
    v_fmac_f32 v82, v150, v128
    v_mfma_f32_16x16x32_bf16 v[100:103], v[16:19], a[20:23], v[100:103]
    v_fmac_f32 v83, v151, v128
    v_mul_f32 v64, v64, v132
    v_mfma_f32_16x16x32_bf16 v[104:107], v[16:19], a[24:27], v[104:107]
    v_mul_f32 v65, v65, v132
    v_mul_f32 v66, v66, v132
    v_mfma_f32_16x16x32_bf16 v[108:111], v[16:19], a[28:31], v[108:111]
    v_mul_f32 v67, v67, v132
    v_mul_f32 v64, v64, v80
    s_waitcnt lgkmcnt(3)
    v_mfma_f32_16x16x32_bf16 v[112:115], v[20:23], a[16:19], v[112:115]
    ds_read_b128 v[12:15], v4 offset:7168
    v_mul_f32 v65, v65, v81
    v_mfma_f32_16x16x32_bf16 v[116:119], v[20:23], a[20:23], v[116:119]
    v_mul_f32 v66, v66, v82
    v_mul_f32 v67, v67, v83
    v_mfma_f32_16x16x32_bf16 v[120:123], v[20:23], a[24:27], v[120:123]
    v_cvt_pk_bf16_f32 v176, v64, v65
    v_cvt_pk_bf16_f32 v177, v66, v67
    v_mfma_f32_16x16x32_bf16 v[124:127], v[20:23], a[28:31], v[124:127]
    v_fmac_f32 v68, v144, v129
    v_fmac_f32 v69, v145, v129
    s_waitcnt lgkmcnt(3)
    v_mfma_f32_16x16x32_bf16 v[96:99], v[24:27], a[32:35], v[96:99]
    ds_read_b128 v[16:19], v4 offset:8192
    v_fmac_f32 v70, v146, v129
    v_mfma_f32_16x16x32_bf16 v[100:103], v[24:27], a[36:39], v[100:103]
    v_fmac_f32 v71, v147, v129
    v_fmac_f32 v84, v148, v129
    v_mfma_f32_16x16x32_bf16 v[104:107], v[24:27], a[40:43], v[104:107]
    v_fmac_f32 v85, v149, v129
    v_fmac_f32 v86, v150, v129
    v_mfma_f32_16x16x32_bf16 v[108:111], v[24:27], a[44:47], v[108:111]
    v_fmac_f32 v87, v151, v129
    v_mul_f32 v68, v68, v133
    s_waitcnt lgkmcnt(3)
    v_mfma_f32_16x16x32_bf16 v[112:115], v[28:31], a[32:35], v[112:115]
    ds_read_b128 v[20:23], v4 offset:9216
    v_mul_f32 v69, v69, v133
    v_mfma_f32_16x16x32_bf16 v[116:119], v[28:31], a[36:39], v[116:119]
    v_mul_f32 v70, v70, v133
    v_mul_f32 v71, v71, v133
    v_mfma_f32_16x16x32_bf16 v[120:123], v[28:31], a[40:43], v[120:123]
    v_mul_f32 v68, v68, v84
    v_mul_f32 v69, v69, v85
    v_mfma_f32_16x16x32_bf16 v[124:127], v[28:31], a[44:47], v[124:127]
    v_mul_f32 v70, v70, v86
    v_mul_f32 v71, v71, v87
    s_waitcnt lgkmcnt(3)
    v_mfma_f32_16x16x32_bf16 v[96:99], v[8:11], a[48:51], v[96:99]
    ds_read_b128 v[24:27], v4 offset:10240
    v_cvt_pk_bf16_f32 v180, v68, v69
    v_mfma_f32_16x16x32_bf16 v[100:103], v[8:11], a[52:55], v[100:103]
    v_cvt_pk_bf16_f32 v181, v70, v71
    v_fmac_f32 v72, v144, v130
    v_mfma_f32_16x16x32_bf16 v[104:107], v[8:11], a[56:59], v[104:107]
    v_fmac_f32 v73, v145, v130
    v_fmac_f32 v74, v146, v130
    v_mfma_f32_16x16x32_bf16 v[108:111], v[8:11], a[60:63], v[108:111]
    v_fmac_f32 v75, v147, v130
    v_fmac_f32 v88, v148, v130
    s_waitcnt lgkmcnt(3)
    v_mfma_f32_16x16x32_bf16 v[112:115], v[12:15], a[48:51], v[112:115]
    ds_read_b128 v[28:31], v4 offset:11264
    v_fmac_f32 v89, v149, v130
    v_mfma_f32_16x16x32_bf16 v[116:119], v[12:15], a[52:55], v[116:119]
    v_fmac_f32 v90, v150, v130
    v_fmac_f32 v91, v151, v130
    v_mfma_f32_16x16x32_bf16 v[120:123], v[12:15], a[56:59], v[120:123]
    v_mul_f32 v72, v72, v134
    v_mul_f32 v73, v73, v134
    v_mfma_f32_16x16x32_bf16 v[124:127], v[12:15], a[60:63], v[124:127]
    v_mul_f32 v74, v74, v134
    v_mul_f32 v75, v75, v134
    s_waitcnt lgkmcnt(3)
    v_mfma_f32_16x16x32_bf16 v[96:99], v[16:19], a[64:67], v[96:99]
    ds_read_b128 v[8:11], v4 offset:12288
    v_mul_f32 v72, v72, v88
    v_mfma_f32_16x16x32_bf16 v[100:103], v[16:19], a[68:71], v[100:103]
    v_mul_f32 v73, v73, v89
    v_mul_f32 v74, v74, v90
    v_mfma_f32_16x16x32_bf16 v[104:107], v[16:19], a[72:75], v[104:107]
    v_mul_f32 v75, v75, v91
    v_cvt_pk_bf16_f32 v184, v72, v73
    v_mfma_f32_16x16x32_bf16 v[108:111], v[16:19], a[76:79], v[108:111]
    v_cvt_pk_bf16_f32 v185, v74, v75
    v_fmac_f32 v76, v144, v131
    s_waitcnt lgkmcnt(3)
    v_mfma_f32_16x16x32_bf16 v[112:115], v[20:23], a[64:67], v[112:115]
    ds_read_b128 v[12:15], v4 offset:13312
    v_fmac_f32 v77, v145, v131
    v_mfma_f32_16x16x32_bf16 v[116:119], v[20:23], a[68:71], v[116:119]
    v_fmac_f32 v78, v146, v131
    v_fmac_f32 v79, v147, v131
    v_mfma_f32_16x16x32_bf16 v[120:123], v[20:23], a[72:75], v[120:123]
    v_fmac_f32 v92, v148, v131
    v_fmac_f32 v93, v149, v131
    v_mfma_f32_16x16x32_bf16 v[124:127], v[20:23], a[76:79], v[124:127]
    v_fmac_f32 v94, v150, v131
    v_fmac_f32 v95, v151, v131
    s_waitcnt lgkmcnt(3)
    v_mfma_f32_16x16x32_bf16 v[96:99], v[24:27], a[80:83], v[96:99]
    ds_read_b128 v[16:19], v4 offset:14336
    v_mul_f32 v76, v76, v135
    v_mfma_f32_16x16x32_bf16 v[100:103], v[24:27], a[84:87], v[100:103]
    v_mul_f32 v77, v77, v135
    v_mul_f32 v78, v78, v135
    v_mfma_f32_16x16x32_bf16 v[104:107], v[24:27], a[88:91], v[104:107]
    v_mul_f32 v79, v79, v135
    v_mul_f32 v76, v76, v92
    v_mfma_f32_16x16x32_bf16 v[108:111], v[24:27], a[92:95], v[108:111]
    v_mul_f32 v77, v77, v93
    v_mul_f32 v78, v78, v94
    s_waitcnt lgkmcnt(3)
    v_mfma_f32_16x16x32_bf16 v[112:115], v[28:31], a[80:83], v[112:115]
    ds_read_b128 v[20:23], v4 offset:15360
    v_mul_f32 v79, v79, v95
    v_mfma_f32_16x16x32_bf16 v[116:119], v[28:31], a[84:87], v[116:119]
    v_cvt_pk_bf16_f32 v188, v76, v77
    v_cvt_pk_bf16_f32 v189, v78, v79
    v_mfma_f32_16x16x32_bf16 v[120:123], v[28:31], a[88:91], v[120:123]
    v_fmac_f32 v208, v136, v128
    v_fmac_f32 v209, v137, v128
    v_mfma_f32_16x16x32_bf16 v[124:127], v[28:31], a[92:95], v[124:127]
    v_fmac_f32 v210, v138, v128
    v_fmac_f32 v211, v139, v128
    s_waitcnt lgkmcnt(3)
    v_mfma_f32_16x16x32_bf16 v[96:99], v[8:11], a[96:99], v[96:99]
    ds_read_b128 v[24:27], v4 offset:16384
    v_fmac_f32 v224, v140, v128
    v_mfma_f32_16x16x32_bf16 v[100:103], v[8:11], a[100:103], v[100:103]
    v_fmac_f32 v225, v141, v128
    v_fmac_f32 v226, v142, v128
    v_mfma_f32_16x16x32_bf16 v[104:107], v[8:11], a[104:107], v[104:107]
    v_fmac_f32 v227, v143, v128
    v_mul_f32 v208, v208, v132
    v_mfma_f32_16x16x32_bf16 v[108:111], v[8:11], a[108:111], v[108:111]
    v_mul_f32 v209, v209, v132
    v_mul_f32 v210, v210, v132
    s_waitcnt lgkmcnt(3)
    v_mfma_f32_16x16x32_bf16 v[112:115], v[12:15], a[96:99], v[112:115]
    ds_read_b128 v[28:31], v4 offset:17408
    v_mul_f32 v211, v211, v132
    v_mfma_f32_16x16x32_bf16 v[116:119], v[12:15], a[100:103], v[116:119]
    v_mul_f32 v208, v208, v224
    v_mul_f32 v209, v209, v225
    v_mfma_f32_16x16x32_bf16 v[120:123], v[12:15], a[104:107], v[120:123]
    v_mul_f32 v210, v210, v226
    v_mul_f32 v211, v211, v227
    v_mfma_f32_16x16x32_bf16 v[124:127], v[12:15], a[108:111], v[124:127]
    v_cvt_pk_bf16_f32 v240, v208, v209
    v_cvt_pk_bf16_f32 v241, v210, v211
    s_waitcnt lgkmcnt(3)
    v_mfma_f32_16x16x32_bf16 v[96:99], v[16:19], a[112:115], v[96:99]
    ds_read_b128 v[8:11], v4 offset:18432
    s_add_u32 s66, s51, s65
    v_mfma_f32_16x16x32_bf16 v[100:103], v[16:19], a[116:119], v[100:103]
    buffer_store_dwordx2 v[240:241], v3, s[4:7], s66 offen offset:0 sc1
    v_fmac_f32 v212, v136, v129
    v_mfma_f32_16x16x32_bf16 v[104:107], v[16:19], a[120:123], v[104:107]
    v_fmac_f32 v213, v137, v129
    v_fmac_f32 v214, v138, v129
    v_mfma_f32_16x16x32_bf16 v[108:111], v[16:19], a[124:127], v[108:111]
    v_fmac_f32 v215, v139, v129
    v_fmac_f32 v228, v140, v129
    s_waitcnt lgkmcnt(3)
    v_mfma_f32_16x16x32_bf16 v[112:115], v[20:23], a[112:115], v[112:115]
    ds_read_b128 v[12:15], v4 offset:19456
    v_fmac_f32 v229, v141, v129
    v_mfma_f32_16x16x32_bf16 v[116:119], v[20:23], a[116:119], v[116:119]
    v_fmac_f32 v230, v142, v129
    v_fmac_f32 v231, v143, v129
    v_mfma_f32_16x16x32_bf16 v[120:123], v[20:23], a[120:123], v[120:123]
    v_mul_f32 v212, v212, v133
    v_mul_f32 v213, v213, v133
    v_mfma_f32_16x16x32_bf16 v[124:127], v[20:23], a[124:127], v[124:127]
    v_mul_f32 v214, v214, v133
    v_mul_f32 v215, v215, v133
    s_waitcnt lgkmcnt(3)
    v_mfma_f32_16x16x32_bf16 v[96:99], v[24:27], a[128:131], v[96:99]
    ds_read_b128 v[16:19], v4 offset:20480
    v_mul_f32 v212, v212, v228
    v_mfma_f32_16x16x32_bf16 v[100:103], v[24:27], a[132:135], v[100:103]
    v_mul_f32 v213, v213, v229
    v_mul_f32 v214, v214, v230
    v_mfma_f32_16x16x32_bf16 v[104:107], v[24:27], a[136:139], v[104:107]
    v_mul_f32 v215, v215, v231
    v_cvt_pk_bf16_f32 v244, v212, v213
    v_mfma_f32_16x16x32_bf16 v[108:111], v[24:27], a[140:143], v[108:111]
    v_cvt_pk_bf16_f32 v245, v214, v215
    buffer_store_dwordx2 v[244:245], v3, s[4:7], s66 offen offset:512 sc1
    s_waitcnt lgkmcnt(3)
    v_mfma_f32_16x16x32_bf16 v[112:115], v[28:31], a[128:131], v[112:115]
    ds_read_b128 v[20:23], v4 offset:21504
    v_fmac_f32 v216, v136, v130
    v_mfma_f32_16x16x32_bf16 v[116:119], v[28:31], a[132:135], v[116:119]
    v_fmac_f32 v217, v137, v130
    v_fmac_f32 v218, v138, v130
    v_mfma_f32_16x16x32_bf16 v[120:123], v[28:31], a[136:139], v[120:123]
    v_fmac_f32 v219, v139, v130
    v_fmac_f32 v232, v140, v130
    v_mfma_f32_16x16x32_bf16 v[124:127], v[28:31], a[140:143], v[124:127]
    v_fmac_f32 v233, v141, v130
    v_fmac_f32 v234, v142, v130
    s_waitcnt lgkmcnt(3)
    v_mfma_f32_16x16x32_bf16 v[96:99], v[8:11], a[144:147], v[96:99]
    ds_read_b128 v[24:27], v4 offset:22528
    v_fmac_f32 v235, v143, v130
    v_mfma_f32_16x16x32_bf16 v[100:103], v[8:11], a[148:151], v[100:103]
    v_mul_f32 v216, v216, v134
    v_mul_f32 v217, v217, v134
    v_mfma_f32_16x16x32_bf16 v[104:107], v[8:11], a[152:155], v[104:107]
    v_mul_f32 v218, v218, v134
    v_mul_f32 v219, v219, v134
    v_mfma_f32_16x16x32_bf16 v[108:111], v[8:11], a[156:159], v[108:111]
    v_mul_f32 v216, v216, v232
    v_mul_f32 v217, v217, v233
    s_waitcnt lgkmcnt(3)
    v_mfma_f32_16x16x32_bf16 v[112:115], v[12:15], a[144:147], v[112:115]
    ds_read_b128 v[28:31], v4 offset:23552
    v_mul_f32 v218, v218, v234
    v_mfma_f32_16x16x32_bf16 v[116:119], v[12:15], a[148:151], v[116:119]
    v_mul_f32 v219, v219, v235
    v_cvt_pk_bf16_f32 v248, v216, v217
    v_mfma_f32_16x16x32_bf16 v[120:123], v[12:15], a[152:155], v[120:123]
    v_cvt_pk_bf16_f32 v249, v218, v219
    buffer_store_dwordx2 v[248:249], v3, s[4:7], s66 offen offset:1024 sc1
    v_mfma_f32_16x16x32_bf16 v[124:127], v[12:15], a[156:159], v[124:127]
    v_fmac_f32 v220, v136, v131
    v_fmac_f32 v221, v137, v131
    s_waitcnt lgkmcnt(3)
    v_mfma_f32_16x16x32_bf16 v[96:99], v[16:19], a[160:163], v[96:99]
    ds_read_b128 v[8:11], v4 offset:24576
    v_fmac_f32 v222, v138, v131
    v_mfma_f32_16x16x32_bf16 v[100:103], v[16:19], a[164:167], v[100:103]
    v_fmac_f32 v223, v139, v131
    v_fmac_f32 v236, v140, v131
    v_mfma_f32_16x16x32_bf16 v[104:107], v[16:19], a[168:171], v[104:107]
    v_fmac_f32 v237, v141, v131
    v_fmac_f32 v238, v142, v131
    v_mfma_f32_16x16x32_bf16 v[108:111], v[16:19], a[172:175], v[108:111]
    v_fmac_f32 v239, v143, v131
    v_mul_f32 v220, v220, v135
    s_waitcnt lgkmcnt(3)
    v_mfma_f32_16x16x32_bf16 v[112:115], v[20:23], a[160:163], v[112:115]
    ds_read_b128 v[12:15], v4 offset:25600
    v_mul_f32 v221, v221, v135
    v_mfma_f32_16x16x32_bf16 v[116:119], v[20:23], a[164:167], v[116:119]
    v_mul_f32 v222, v222, v135
    v_mul_f32 v223, v223, v135
    v_mfma_f32_16x16x32_bf16 v[120:123], v[20:23], a[168:171], v[120:123]
    v_mul_f32 v220, v220, v236
    v_mul_f32 v221, v221, v237
    v_mfma_f32_16x16x32_bf16 v[124:127], v[20:23], a[172:175], v[124:127]
    v_mul_f32 v222, v222, v238
    v_mul_f32 v223, v223, v239
    s_waitcnt lgkmcnt(3)
    v_mfma_f32_16x16x32_bf16 v[96:99], v[24:27], a[176:179], v[96:99]
    ds_read_b128 v[16:19], v4 offset:26624
    v_cvt_pk_bf16_f32 v252, v220, v221
    v_mfma_f32_16x16x32_bf16 v[100:103], v[24:27], a[180:183], v[100:103]
    v_cvt_pk_bf16_f32 v253, v222, v223
    buffer_store_dwordx2 v[252:253], v3, s[4:7], s66 offen offset:1536 sc1
    v_mfma_f32_16x16x32_bf16 v[104:107], v[24:27], a[184:187], v[104:107]
    v_mfma_f32_16x16x32_bf16 v[108:111], v[24:27], a[188:191], v[108:111]
    s_waitcnt lgkmcnt(3)
    v_mfma_f32_16x16x32_bf16 v[112:115], v[28:31], a[176:179], v[112:115]
    ds_read_b128 v[20:23], v4 offset:27648
    v_mfma_f32_16x16x32_bf16 v[116:119], v[28:31], a[180:183], v[116:119]
    v_mfma_f32_16x16x32_bf16 v[120:123], v[28:31], a[184:187], v[120:123]
    v_mfma_f32_16x16x32_bf16 v[124:127], v[28:31], a[188:191], v[124:127]
    s_waitcnt lgkmcnt(3)
    v_mfma_f32_16x16x32_bf16 v[96:99], v[8:11], a[192:195], v[96:99]
    ds_read_b128 v[24:27], v4 offset:28672
    v_mfma_f32_16x16x32_bf16 v[100:103], v[8:11], a[196:199], v[100:103]
    v_mfma_f32_16x16x32_bf16 v[104:107], v[8:11], a[200:203], v[104:107]
    v_mfma_f32_16x16x32_bf16 v[108:111], v[8:11], a[204:207], v[108:111]
    s_waitcnt lgkmcnt(3)
    v_mfma_f32_16x16x32_bf16 v[112:115], v[12:15], a[192:195], v[112:115]
    ds_read_b128 v[28:31], v4 offset:29696
    v_mfma_f32_16x16x32_bf16 v[116:119], v[12:15], a[196:199], v[116:119]
    v_mfma_f32_16x16x32_bf16 v[120:123], v[12:15], a[200:203], v[120:123]
    v_mfma_f32_16x16x32_bf16 v[124:127], v[12:15], a[204:207], v[124:127]
    s_waitcnt lgkmcnt(3)
    v_mfma_f32_16x16x32_bf16 v[96:99], v[16:19], a[208:211], v[96:99]
    ds_read_b128 v[8:11], v4 offset:30720
    v_mfma_f32_16x16x32_bf16 v[100:103], v[16:19], a[212:215], v[100:103]
    v_mfma_f32_16x16x32_bf16 v[104:107], v[16:19], a[216:219], v[104:107]
    v_mfma_f32_16x16x32_bf16 v[108:111], v[16:19], a[220:223], v[108:111]
    s_waitcnt lgkmcnt(3)
    v_mfma_f32_16x16x32_bf16 v[112:115], v[20:23], a[208:211], v[112:115]
    ds_read_b128 v[12:15], v4 offset:31744
    v_mfma_f32_16x16x32_bf16 v[116:119], v[20:23], a[212:215], v[116:119]
    v_mfma_f32_16x16x32_bf16 v[120:123], v[20:23], a[216:219], v[120:123]
    v_mfma_f32_16x16x32_bf16 v[124:127], v[20:23], a[220:223], v[124:127]
    s_waitcnt lgkmcnt(3)
    v_mfma_f32_16x16x32_bf16 v[96:99], v[24:27], a[224:227], v[96:99]
    ds_read_b128 v[16:19], v4 offset:32768
    v_mfma_f32_16x16x32_bf16 v[100:103], v[24:27], a[228:231], v[100:103]
    v_mfma_f32_16x16x32_bf16 v[104:107], v[24:27], a[232:235], v[104:107]
    v_mfma_f32_16x16x32_bf16 v[108:111], v[24:27], a[236:239], v[108:111]
    s_waitcnt lgkmcnt(3)
    v_mfma_f32_16x16x32_bf16 v[112:115], v[28:31], a[224:227], v[112:115]
    ds_read_b128 v[20:23], v4 offset:33792
    v_mfma_f32_16x16x32_bf16 v[116:119], v[28:31], a[228:231], v[116:119]
    v_mfma_f32_16x16x32_bf16 v[120:123], v[28:31], a[232:235], v[120:123]
    v_mfma_f32_16x16x32_bf16 v[124:127], v[28:31], a[236:239], v[124:127]
    s_waitcnt lgkmcnt(3)
    v_mfma_f32_16x16x32_bf16 v[96:99], v[8:11], a[240:243], v[96:99]
    ds_read_b128 v[24:27], v4 offset:34816
    v_mfma_f32_16x16x32_bf16 v[100:103], v[8:11], a[244:247], v[100:103]
    v_mfma_f32_16x16x32_bf16 v[104:107], v[8:11], a[248:251], v[104:107]
    v_mfma_f32_16x16x32_bf16 v[108:111], v[8:11], a[252:255], v[108:111]
    ds_read_b128 v[136:139], v5 offset:256
    ds_read_b128 v[140:143], v5 offset:320
    s_waitcnt lgkmcnt(5)
    v_mfma_f32_16x16x32_bf16 v[112:115], v[12:15], a[240:243], v[112:115]
    ds_read_b128 v[28:31], v4 offset:35840
    v_mfma_f32_16x16x32_bf16 v[116:119], v[12:15], a[244:247], v[116:119]
    v_mfma_f32_16x16x32_bf16 v[120:123], v[12:15], a[248:251], v[120:123]
    v_mfma_f32_16x16x32_bf16 v[124:127], v[12:15], a[252:255], v[124:127]
    s_waitcnt lgkmcnt(5)
    v_mfma_f32_16x16x32_bf16 v[96:99], v[16:19], v[32:35], v[96:99]
    s_waitcnt vmcnt(22)
    s_barrier
    v_mfma_f32_16x16x32_bf16 v[100:103], v[16:19], v[36:39], v[100:103]
    v_add_u32 v4, 0x9000, v4
    ds_read_b128 v[8:11], v4 offset:0
    v_mfma_f32_16x16x32_bf16 v[104:107], v[16:19], v[40:43], v[104:107]
    v_mfma_f32_16x16x32_bf16 v[108:111], v[16:19], v[44:47], v[108:111]
    s_waitcnt lgkmcnt(5)
    v_mfma_f32_16x16x32_bf16 v[112:115], v[20:23], v[32:35], v[112:115]
    ds_read_b128 v[12:15], v4 offset:1024
    v_mfma_f32_16x16x32_bf16 v[116:119], v[20:23], v[36:39], v[116:119]
    v_mfma_f32_16x16x32_bf16 v[120:123], v[20:23], v[40:43], v[120:123]
    v_mfma_f32_16x16x32_bf16 v[124:127], v[20:23], v[44:47], v[124:127]
    s_waitcnt lgkmcnt(5)
    v_mfma_f32_16x16x32_bf16 v[96:99], v[24:27], v[48:51], v[96:99]
    ds_read_b128 v[16:19], v4 offset:2048
    v_mfma_f32_16x16x32_bf16 v[100:103], v[24:27], v[52:55], v[100:103]
    v_mfma_f32_16x16x32_bf16 v[104:107], v[24:27], v[56:59], v[104:107]
    v_mfma_f32_16x16x32_bf16 v[108:111], v[24:27], v[60:63], v[108:111]
    s_waitcnt lgkmcnt(3)
    v_mfma_f32_16x16x32_bf16 v[112:115], v[28:31], v[48:51], v[112:115]
    ds_read_b128 v[20:23], v4 offset:3072
    v_mfma_f32_16x16x32_bf16 v[116:119], v[28:31], v[52:55], v[116:119]
    v_mfma_f32_16x16x32_bf16 v[120:123], v[28:31], v[56:59], v[120:123]
    v_mfma_f32_16x16x32_bf16 v[124:127], v[28:31], v[60:63], v[124:127]
    s_waitcnt lgkmcnt(3)
    v_mfma_f32_16x16x32_bf16 v[64:67], v[8:11], a[0:3], 0
    ds_read_b128 v[24:27], v4 offset:4096
    v_mfma_f32_16x16x32_bf16 v[68:71], v[8:11], a[4:7], 0
    v_mfma_f32_16x16x32_bf16 v[72:75], v[8:11], a[8:11], 0
    v_mfma_f32_16x16x32_bf16 v[76:79], v[8:11], a[12:15], 0
    s_waitcnt lgkmcnt(3)
    v_mfma_f32_16x16x32_bf16 v[80:83], v[12:15], a[0:3], 0
    ds_read_b128 v[28:31], v4 offset:5120
    v_mfma_f32_16x16x32_bf16 v[84:87], v[12:15], a[4:7], 0
    v_fmac_f32 v96, v136, v128
    v_fmac_f32 v97, v137, v128
    v_mfma_f32_16x16x32_bf16 v[88:91], v[12:15], a[8:11], 0
    v_fmac_f32 v98, v138, v128
    v_fmac_f32 v99, v139, v128
    v_mfma_f32_16x16x32_bf16 v[92:95], v[12:15], a[12:15], 0
    v_fmac_f32 v112, v140, v128
    v_fmac_f32 v113, v141, v128
    s_waitcnt lgkmcnt(3)
    v_mfma_f32_16x16x32_bf16 v[64:67], v[16:19], a[16:19], v[64:67]
    ds_read_b128 v[8:11], v4 offset:6144
    v_fmac_f32 v114, v142, v128
    v_mfma_f32_16x16x32_bf16 v[68:71], v[16:19], a[20:23], v[68:71]
    v_fmac_f32 v115, v143, v128
    v_mul_f32 v96, v96, v132
    v_mfma_f32_16x16x32_bf16 v[72:75], v[16:19], a[24:27], v[72:75]
    v_mul_f32 v97, v97, v132
    v_mul_f32 v98, v98, v132
    v_mfma_f32_16x16x32_bf16 v[76:79], v[16:19], a[28:31], v[76:79]
    v_mul_f32 v99, v99, v132
    v_mul_f32 v96, v96, v112
    s_waitcnt lgkmcnt(3)
    v_mfma_f32_16x16x32_bf16 v[80:83], v[20:23], a[16:19], v[80:83]
    ds_read_b128 v[12:15], v4 offset:7168
    v_mul_f32 v97, v97, v113
    v_mfma_f32_16x16x32_bf16 v[84:87], v[20:23], a[20:23], v[84:87]
    v_mul_f32 v98, v98, v114
    v_mul_f32 v99, v99, v115
    v_mfma_f32_16x16x32_bf16 v[88:91], v[20:23], a[24:27], v[88:91]
    v_cvt_pk_bf16_f32 v178, v96, v97
    v_cvt_pk_bf16_f32 v179, v98, v99
    v_mfma_f32_16x16x32_bf16 v[92:95], v[20:23], a[28:31], v[92:95]
    s_add_u32 s66, s51, 0
    buffer_store_dwordx4 v[176:179], v2, s[4:7], s66 offen offset:0 sc1
    s_waitcnt lgkmcnt(3)
    v_mfma_f32_16x16x32_bf16 v[64:67], v[24:27], a[32:35], v[64:67]
    ds_read_b128 v[16:19], v4 offset:8192
    v_fmac_f32 v100, v136, v129
    v_mfma_f32_16x16x32_bf16 v[68:71], v[24:27], a[36:39], v[68:71]
    v_fmac_f32 v101, v137, v129
    v_fmac_f32 v102, v138, v129
    v_mfma_f32_16x16x32_bf16 v[72:75], v[24:27], a[40:43], v[72:75]
    v_fmac_f32 v103, v139, v129
    v_fmac_f32 v116, v140, v129
    v_mfma_f32_16x16x32_bf16 v[76:79], v[24:27], a[44:47], v[76:79]
    v_fmac_f32 v117, v141, v129
    v_fmac_f32 v118, v142, v129
    s_waitcnt lgkmcnt(3)
    v_mfma_f32_16x16x32_bf16 v[80:83], v[28:31], a[32:35], v[80:83]
    ds_read_b128 v[20:23], v4 offset:9216
    v_fmac_f32 v119, v143, v129
    v_mfma_f32_16x16x32_bf16 v[84:87], v[28:31], a[36:39], v[84:87]
    v_mul_f32 v100, v100, v133
    v_mul_f32 v101, v101, v133
    v_mfma_f32_16x16x32_bf16 v[88:91], v[28:31], a[40:43], v[88:91]
    v_mul_f32 v102, v102, v133
    v_mul_f32 v103, v103, v133
    v_mfma_f32_16x16x32_bf16 v[92:95], v[28:31], a[44:47], v[92:95]
    v_mul_f32 v100, v100, v116
    v_mul_f32 v101, v101, v117
    s_waitcnt lgkmcnt(3)
    v_mfma_f32_16x16x32_bf16 v[64:67], v[8:11], a[48:51], v[64:67]
    ds_read_b128 v[24:27], v4 offset:10240
    v_mul_f32 v102, v102, v118
    v_mfma_f32_16x16x32_bf16 v[68:71], v[8:11], a[52:55], v[68:71]
    v_mul_f32 v103, v103, v119
    v_cvt_pk_bf16_f32 v182, v100, v101
    v_mfma_f32_16x16x32_bf16 v[72:75], v[8:11], a[56:59], v[72:75]
    v_cvt_pk_bf16_f32 v183, v102, v103
    buffer_store_dwordx4 v[180:183], v2, s[4:7], s66 offen offset:1024 sc1
    v_mfma_f32_16x16x32_bf16 v[76:79], v[8:11], a[60:63], v[76:79]
    v_fmac_f32 v104, v136, v130
    v_fmac_f32 v105, v137, v130
    s_waitcnt lgkmcnt(3)
    v_mfma_f32_16x16x32_bf16 v[80:83], v[12:15], a[48:51], v[80:83]
    ds_read_b128 v[28:31], v4 offset:11264
    v_fmac_f32 v106, v138, v130
    v_mfma_f32_16x16x32_bf16 v[84:87], v[12:15], a[52:55], v[84:87]
    v_fmac_f32 v107, v139, v130
    v_fmac_f32 v120, v140, v130
    v_mfma_f32_16x16x32_bf16 v[88:91], v[12:15], a[56:59], v[88:91]
    v_fmac_f32 v121, v141, v130
    v_fmac_f32 v122, v142, v130
    v_mfma_f32_16x16x32_bf16 v[92:95], v[12:15], a[60:63], v[92:95]
    v_fmac_f32 v123, v143, v130
    v_mul_f32 v104, v104, v134
    s_waitcnt lgkmcnt(3)
    v_mfma_f32_16x16x32_bf16 v[64:67], v[16:19], a[64:67], v[64:67]
    ds_read_b128 v[8:11], v4 offset:12288
    v_mul_f32 v105, v105, v134
    v_mfma_f32_16x16x32_bf16 v[68:71], v[16:19], a[68:71], v[68:71]
    v_mul_f32 v106, v106, v134
    v_mul_f32 v107, v107, v134
    v_mfma_f32_16x16x32_bf16 v[72:75], v[16:19], a[72:75], v[72:75]
    v_mul_f32 v104, v104, v120
    v_mul_f32 v105, v105, v121
    v_mfma_f32_16x16x32_bf16 v[76:79], v[16:19], a[76:79], v[76:79]
    v_mul_f32 v106, v106, v122
    v_mul_f32 v107, v107, v123
    s_waitcnt lgkmcnt(3)
    v_mfma_f32_16x16x32_bf16 v[80:83], v[20:23], a[64:67], v[80:83]
    ds_read_b128 v[12:15], v4 offset:13312
    v_cvt_pk_bf16_f32 v186, v104, v105
    v_mfma_f32_16x16x32_bf16 v[84:87], v[20:23], a[68:71], v[84:87]
    v_cvt_pk_bf16_f32 v187, v106, v107
    buffer_store_dwordx4 v[184:187], v2, s[4:7], s66 offen offset:2048 sc1
    v_mfma_f32_16x16x32_bf16 v[88:91], v[20:23], a[72:75], v[88:91]
    v_fmac_f32 v108, v136, v131
    v_fmac_f32 v109, v137, v131
    v_mfma_f32_16x16x32_bf16 v[92:95], v[20:23], a[76:79], v[92:95]
    v_fmac_f32 v110, v138, v131
    v_fmac_f32 v111, v139, v131
    s_waitcnt lgkmcnt(3)
    v_mfma_f32_16x16x32_bf16 v[64:67], v[24:27], a[80:83], v[64:67]
    ds_read_b128 v[16:19], v4 offset:14336
    v_fmac_f32 v124, v140, v131
    v_mfma_f32_16x16x32_bf16 v[68:71], v[24:27], a[84:87], v[68:71]
    v_fmac_f32 v125, v141, v131
    v_fmac_f32 v126, v142, v131
    v_mfma_f32_16x16x32_bf16 v[72:75], v[24:27], a[88:91], v[72:75]
    v_fmac_f32 v127, v143, v131
    v_mul_f32 v108, v108, v135
    v_mfma_f32_16x16x32_bf16 v[76:79], v[24:27], a[92:95], v[76:79]
    v_mul_f32 v109, v109, v135
    v_mul_f32 v110, v110, v135
    s_waitcnt lgkmcnt(3)
    v_mfma_f32_16x16x32_bf16 v[80:83], v[28:31], a[80:83], v[80:83]
    ds_read_b128 v[20:23], v4 offset:15360
    v_mul_f32 v111, v111, v135
    v_mfma_f32_16x16x32_bf16 v[84:87], v[28:31], a[84:87], v[84:87]
    v_mul_f32 v108, v108, v124
    v_mul_f32 v109, v109, v125
    v_mfma_f32_16x16x32_bf16 v[88:91], v[28:31], a[88:91], v[88:91]
    v_mul_f32 v110, v110, v126
    v_mul_f32 v111, v111, v127
    v_mfma_f32_16x16x32_bf16 v[92:95], v[28:31], a[92:95], v[92:95]
    v_cvt_pk_bf16_f32 v190, v108, v109
    v_cvt_pk_bf16_f32 v191, v110, v111
    s_waitcnt lgkmcnt(3)
    v_mfma_f32_16x16x32_bf16 v[64:67], v[8:11], a[96:99], v[64:67]
    ds_read_b128 v[24:27], v4 offset:16384
    buffer_store_dwordx4 v[188:191], v2, s[4:7], s66 offen offset:3072 sc1
    v_mfma_f32_16x16x32_bf16 v[68:71], v[8:11], a[100:103], v[68:71]
    v_mfma_f32_16x16x32_bf16 v[72:75], v[8:11], a[104:107], v[72:75]
    v_mfma_f32_16x16x32_bf16 v[76:79], v[8:11], a[108:111], v[76:79]
    s_waitcnt lgkmcnt(3)
    v_mfma_f32_16x16x32_bf16 v[80:83], v[12:15], a[96:99], v[80:83]
    ds_read_b128 v[28:31], v4 offset:17408
    v_mfma_f32_16x16x32_bf16 v[84:87], v[12:15], a[100:103], v[84:87]
    v_mfma_f32_16x16x32_bf16 v[88:91], v[12:15], a[104:107], v[88:91]
    v_mfma_f32_16x16x32_bf16 v[92:95], v[12:15], a[108:111], v[92:95]
    s_waitcnt lgkmcnt(3)
    v_mfma_f32_16x16x32_bf16 v[64:67], v[16:19], a[112:115], v[64:67]
    ds_read_b128 v[8:11], v4 offset:18432
    v_mfma_f32_16x16x32_bf16 v[68:71], v[16:19], a[116:119], v[68:71]
    v_mfma_f32_16x16x32_bf16 v[72:75], v[16:19], a[120:123], v[72:75]
    v_mfma_f32_16x16x32_bf16 v[76:79], v[16:19], a[124:127], v[76:79]
    s_waitcnt lgkmcnt(3)
    v_mfma_f32_16x16x32_bf16 v[80:83], v[20:23], a[112:115], v[80:83]
    ds_read_b128 v[12:15], v4 offset:19456
    v_mfma_f32_16x16x32_bf16 v[84:87], v[20:23], a[116:119], v[84:87]
    v_mfma_f32_16x16x32_bf16 v[88:91], v[20:23], a[120:123], v[88:91]
    v_mfma_f32_16x16x32_bf16 v[92:95], v[20:23], a[124:127], v[92:95]
    s_waitcnt lgkmcnt(3)
    v_mfma_f32_16x16x32_bf16 v[64:67], v[24:27], a[128:131], v[64:67]
    ds_read_b128 v[16:19], v4 offset:20480
    v_mfma_f32_16x16x32_bf16 v[68:71], v[24:27], a[132:135], v[68:71]
    v_mfma_f32_16x16x32_bf16 v[72:75], v[24:27], a[136:139], v[72:75]
    v_mfma_f32_16x16x32_bf16 v[76:79], v[24:27], a[140:143], v[76:79]
    s_waitcnt lgkmcnt(3)
    v_mfma_f32_16x16x32_bf16 v[80:83], v[28:31], a[128:131], v[80:83]
    ds_read_b128 v[20:23], v4 offset:21504
    v_mfma_f32_16x16x32_bf16 v[84:87], v[28:31], a[132:135], v[84:87]
    v_mfma_f32_16x16x32_bf16 v[88:91], v[28:31], a[136:139], v[88:91]
    v_mfma_f32_16x16x32_bf16 v[92:95], v[28:31], a[140:143], v[92:95]
    s_waitcnt lgkmcnt(3)
    v_mfma_f32_16x16x32_bf16 v[64:67], v[8:11], a[144:147], v[64:67]
    ds_read_b128 v[24:27], v4 offset:22528
    v_mfma_f32_16x16x32_bf16 v[68:71], v[8:11], a[148:151], v[68:71]
    v_mfma_f32_16x16x32_bf16 v[72:75], v[8:11], a[152:155], v[72:75]
    v_mfma_f32_16x16x32_bf16 v[76:79], v[8:11], a[156:159], v[76:79]
    s_waitcnt lgkmcnt(3)
    v_mfma_f32_16x16x32_bf16 v[80:83], v[12:15], a[144:147], v[80:83]
    ds_read_b128 v[28:31], v4 offset:23552
    v_mfma_f32_16x16x32_bf16 v[84:87], v[12:15], a[148:151], v[84:87]
    v_mfma_f32_16x16x32_bf16 v[88:91], v[12:15], a[152:155], v[88:91]
    v_mfma_f32_16x16x32_bf16 v[92:95], v[12:15], a[156:159], v[92:95]
    s_waitcnt lgkmcnt(3)
    v_mfma_f32_16x16x32_bf16 v[64:67], v[16:19], a[160:163], v[64:67]
    ds_read_b128 v[8:11], v4 offset:24576
    v_mfma_f32_16x16x32_bf16 v[68:71], v[16:19], a[164:167], v[68:71]
    v_mfma_f32_16x16x32_bf16 v[72:75], v[16:19], a[168:171], v[72:75]
    v_mfma_f32_16x16x32_bf16 v[76:79], v[16:19], a[172:175], v[76:79]
    s_waitcnt lgkmcnt(3)
    v_mfma_f32_16x16x32_bf16 v[80:83], v[20:23], a[160:163], v[80:83]
    ds_read_b128 v[12:15], v4 offset:25600
    v_mfma_f32_16x16x32_bf16 v[84:87], v[20:23], a[164:167], v[84:87]
    v_mfma_f32_16x16x32_bf16 v[88:91], v[20:23], a[168:171], v[88:91]
    v_mfma_f32_16x16x32_bf16 v[92:95], v[20:23], a[172:175], v[92:95]
    s_waitcnt lgkmcnt(3)
    v_mfma_f32_16x16x32_bf16 v[64:67], v[24:27], a[176:179], v[64:67]
    ds_read_b128 v[16:19], v4 offset:26624
    v_mfma_f32_16x16x32_bf16 v[68:71], v[24:27], a[180:183], v[68:71]
    v_mfma_f32_16x16x32_bf16 v[72:75], v[24:27], a[184:187], v[72:75]
    v_mfma_f32_16x16x32_bf16 v[76:79], v[24:27], a[188:191], v[76:79]
    s_waitcnt lgkmcnt(3)
    v_mfma_f32_16x16x32_bf16 v[80:83], v[28:31], a[176:179], v[80:83]
    ds_read_b128 v[20:23], v4 offset:27648
    v_mfma_f32_16x16x32_bf16 v[84:87], v[28:31], a[180:183], v[84:87]
    v_mfma_f32_16x16x32_bf16 v[88:91], v[28:31], a[184:187], v[88:91]
    v_mfma_f32_16x16x32_bf16 v[92:95], v[28:31], a[188:191], v[92:95]
    s_waitcnt lgkmcnt(3)
    v_mfma_f32_16x16x32_bf16 v[64:67], v[8:11], a[192:195], v[64:67]
    ds_read_b128 v[24:27], v4 offset:28672
    v_mfma_f32_16x16x32_bf16 v[68:71], v[8:11], a[196:199], v[68:71]
    v_mfma_f32_16x16x32_bf16 v[72:75], v[8:11], a[200:203], v[72:75]
    v_mfma_f32_16x16x32_bf16 v[76:79], v[8:11], a[204:207], v[76:79]
    s_waitcnt lgkmcnt(3)
    v_mfma_f32_16x16x32_bf16 v[80:83], v[12:15], a[192:195], v[80:83]
    ds_read_b128 v[28:31], v4 offset:29696
    v_mfma_f32_16x16x32_bf16 v[84:87], v[12:15], a[196:199], v[84:87]
    v_mfma_f32_16x16x32_bf16 v[88:91], v[12:15], a[200:203], v[88:91]
    v_mfma_f32_16x16x32_bf16 v[92:95], v[12:15], a[204:207], v[92:95]
    s_waitcnt lgkmcnt(3)
    v_mfma_f32_16x16x32_bf16 v[64:67], v[16:19], a[208:211], v[64:67]
    ds_read_b128 v[8:11], v4 offset:30720
    v_mfma_f32_16x16x32_bf16 v[68:71], v[16:19], a[212:215], v[68:71]
    v_mfma_f32_16x16x32_bf16 v[72:75], v[16:19], a[216:219], v[72:75]
    v_mfma_f32_16x16x32_bf16 v[76:79], v[16:19], a[220:223], v[76:79]
    s_waitcnt lgkmcnt(3)
    v_mfma_f32_16x16x32_bf16 v[80:83], v[20:23], a[208:211], v[80:83]
    ds_read_b128 v[12:15], v4 offset:31744
    v_mfma_f32_16x16x32_bf16 v[84:87], v[20:23], a[212:215], v[84:87]
    v_mfma_f32_16x16x32_bf16 v[88:91], v[20:23], a[216:219], v[88:91]
    v_mfma_f32_16x16x32_bf16 v[92:95], v[20:23], a[220:223], v[92:95]
    s_waitcnt lgkmcnt(3)
    v_mfma_f32_16x16x32_bf16 v[64:67], v[24:27], a[224:227], v[64:67]
    ds_read_b128 v[16:19], v4 offset:32768
    v_mfma_f32_16x16x32_bf16 v[68:71], v[24:27], a[228:231], v[68:71]
    v_mfma_f32_16x16x32_bf16 v[72:75], v[24:27], a[232:235], v[72:75]
    v_mfma_f32_16x16x32_bf16 v[76:79], v[24:27], a[236:239], v[76:79]
    s_waitcnt lgkmcnt(3)
    v_mfma_f32_16x16x32_bf16 v[80:83], v[28:31], a[224:227], v[80:83]
    ds_read_b128 v[20:23], v4 offset:33792
    v_mfma_f32_16x16x32_bf16 v[84:87], v[28:31], a[228:231], v[84:87]
    v_mfma_f32_16x16x32_bf16 v[88:91], v[28:31], a[232:235], v[88:91]
    v_mfma_f32_16x16x32_bf16 v[92:95], v[28:31], a[236:239], v[92:95]
    s_waitcnt lgkmcnt(3)
    v_mfma_f32_16x16x32_bf16 v[64:67], v[8:11], a[240:243], v[64:67]
    ds_read_b128 v[24:27], v4 offset:34816
    v_mfma_f32_16x16x32_bf16 v[68:71], v[8:11], a[244:247], v[68:71]
    v_mfma_f32_16x16x32_bf16 v[72:75], v[8:11], a[248:251], v[72:75]
    v_mfma_f32_16x16x32_bf16 v[76:79], v[8:11], a[252:255], v[76:79]
    ds_read_b128 v[144:147], v5 offset:384
    ds_read_b128 v[148:151], v5 offset:448
    s_waitcnt lgkmcnt(5)
    v_mfma_f32_16x16x32_bf16 v[80:83], v[12:15], a[240:243], v[80:83]
    ds_read_b128 v[28:31], v4 offset:35840
    v_mfma_f32_16x16x32_bf16 v[84:87], v[12:15], a[244:247], v[84:87]
    v_mfma_f32_16x16x32_bf16 v[88:91], v[12:15], a[248:251], v[88:91]
    v_mfma_f32_16x16x32_bf16 v[92:95], v[12:15], a[252:255], v[92:95]
    s_waitcnt lgkmcnt(5)
    v_mfma_f32_16x16x32_bf16 v[64:67], v[16:19], v[32:35], v[64:67]
    s_waitcnt vmcnt(17)
    s_barrier
    v_mfma_f32_16x16x32_bf16 v[68:71], v[16:19], v[36:39], v[68:71]
    v_add_u32 v4, 0xfffe5000, v4
    ds_read_b128 v[8:11], v4 offset:0
    v_mfma_f32_16x16x32_bf16 v[72:75], v[16:19], v[40:43], v[72:75]
    s_add_u32 m0, s49, 73728
    s_add_u32 s61, s48, 221184
    v_mfma_f32_16x16x32_bf16 v[76:79], v[16:19], v[44:47], v[76:79]
    buffer_load_dwordx4 v2, s[4:7], s61 offen offset:0 lds
    buffer_load_dwordx4 v2, s[4:7], s61 offen offset:1024 lds
    s_waitcnt lgkmcnt(5)
    v_mfma_f32_16x16x32_bf16 v[80:83], v[20:23], v[32:35], v[80:83]
    ds_read_b128 v[12:15], v4 offset:1024
    buffer_load_dwordx4 v2, s[4:7], s61 offen offset:2048 lds
    v_mfma_f32_16x16x32_bf16 v[84:87], v[20:23], v[36:39], v[84:87]
    buffer_load_dwordx4 v2, s[4:7], s61 offen offset:3072 lds
    s_add_u32 m0, s49, 77824
    v_mfma_f32_16x16x32_bf16 v[88:91], v[20:23], v[40:43], v[88:91]
    s_add_u32 s61, s48, 225280
    buffer_load_dwordx4 v2, s[4:7], s61 offen offset:0 lds
    v_mfma_f32_16x16x32_bf16 v[92:95], v[20:23], v[44:47], v[92:95]
    buffer_load_dwordx4 v2, s[4:7], s61 offen offset:1024 lds
    buffer_load_dwordx4 v2, s[4:7], s61 offen offset:2048 lds
    s_waitcnt lgkmcnt(5)
    v_mfma_f32_16x16x32_bf16 v[64:67], v[24:27], v[48:51], v[64:67]
    ds_read_b128 v[16:19], v4 offset:2048
    buffer_load_dwordx4 v2, s[4:7], s61 offen offset:3072 lds
    v_mfma_f32_16x16x32_bf16 v[68:71], v[24:27], v[52:55], v[68:71]
    s_add_u32 m0, s49, 81920
    s_add_u32 s61, s48, 229376
    v_mfma_f32_16x16x32_bf16 v[72:75], v[24:27], v[56:59], v[72:75]
    buffer_load_dwordx4 v2, s[4:7], s61 offen offset:0 lds
    v_mfma_f32_16x16x32_bf16 v[76:79], v[24:27], v[60:63], v[76:79]
    s_waitcnt lgkmcnt(3)
    v_mfma_f32_16x16x32_bf16 v[80:83], v[28:31], v[48:51], v[80:83]
    ds_read_b128 v[20:23], v4 offset:3072
    v_mfma_f32_16x16x32_bf16 v[84:87], v[28:31], v[52:55], v[84:87]
    v_mfma_f32_16x16x32_bf16 v[88:91], v[28:31], v[56:59], v[88:91]
    v_mfma_f32_16x16x32_bf16 v[92:95], v[28:31], v[60:63], v[92:95]
    s_waitcnt lgkmcnt(3)
    v_mfma_f32_16x16x32_bf16 v[96:99], v[8:11], a[0:3], 0
    ds_read_b128 v[24:27], v4 offset:4096
    v_mfma_f32_16x16x32_bf16 v[100:103], v[8:11], a[4:7], 0
    v_mfma_f32_16x16x32_bf16 v[104:107], v[8:11], a[8:11], 0
    v_mfma_f32_16x16x32_bf16 v[108:111], v[8:11], a[12:15], 0
    s_waitcnt lgkmcnt(3)
    v_mfma_f32_16x16x32_bf16 v[112:115], v[12:15], a[0:3], 0
    ds_read_b128 v[28:31], v4 offset:5120
    v_mfma_f32_16x16x32_bf16 v[116:119], v[12:15], a[4:7], 0
    v_fmac_f32 v64, v144, v128
    v_fmac_f32 v65, v145, v128
    v_mfma_f32_16x16x32_bf16 v[120:123], v[12:15], a[8:11], 0
    v_fmac_f32 v66, v146, v128
    v_fmac_f32 v67, v147, v128
    v_mfma_f32_16x16x32_bf16 v[124:127], v[12:15], a[12:15], 0
    v_fmac_f32 v80, v148, v128
    v_fmac_f32 v81, v149, v128
    s_waitcnt lgkmcnt(3)
    v_mfma_f32_16x16x32_bf16 v[96:99], v[16:19], a[16:19], v[96:99]
    ds_read_b128 v[8:11], v4 offset:6144
    v_fmac_f32 v82, v150, v128
    v_mfma_f32_16x16x32_bf16 v[100:103], v[16:19], a[20:23], v[100:103]
    v_fmac_f32 v83, v151, v128
    v_mul_f32 v64, v64, v132
    v_mfma_f32_16x16x32_bf16 v[104:107], v[16:19], a[24:27], v[104:107]
    v_mul_f32 v65, v65, v132
    v_mul_f32 v66, v66, v132
    v_mfma_f32_16x16x32_bf16 v[108:111], v[16:19], a[28:31], v[108:111]
    v_mul_f32 v67, v67, v132
    v_mul_f32 v64, v64, v80
    s_waitcnt lgkmcnt(3)
    v_mfma_f32_16x16x32_bf16 v[112:115], v[20:23], a[16:19], v[112:115]
    ds_read_b128 v[12:15], v4 offset:7168
    v_mul_f32 v65, v65, v81
    v_mfma_f32_16x16x32_bf16 v[116:119], v[20:23], a[20:23], v[116:119]
    v_mul_f32 v66, v66, v82
    v_mul_f32 v67, v67, v83
    v_mfma_f32_16x16x32_bf16 v[120:123], v[20:23], a[24:27], v[120:123]
    v_cvt_pk_bf16_f32 v192, v64, v65
    v_cvt_pk_bf16_f32 v193, v66, v67
    v_mfma_f32_16x16x32_bf16 v[124:127], v[20:23], a[28:31], v[124:127]
    v_fmac_f32 v68, v144, v129
    v_fmac_f32 v69, v145, v129
    s_waitcnt lgkmcnt(3)
    v_mfma_f32_16x16x32_bf16 v[96:99], v[24:27], a[32:35], v[96:99]
    ds_read_b128 v[16:19], v4 offset:8192
    v_fmac_f32 v70, v146, v129
    v_mfma_f32_16x16x32_bf16 v[100:103], v[24:27], a[36:39], v[100:103]
    v_fmac_f32 v71, v147, v129
    v_fmac_f32 v84, v148, v129
    v_mfma_f32_16x16x32_bf16 v[104:107], v[24:27], a[40:43], v[104:107]
    v_fmac_f32 v85, v149, v129
    v_fmac_f32 v86, v150, v129
    v_mfma_f32_16x16x32_bf16 v[108:111], v[24:27], a[44:47], v[108:111]
    v_fmac_f32 v87, v151, v129
    v_mul_f32 v68, v68, v133
    s_waitcnt lgkmcnt(3)
    v_mfma_f32_16x16x32_bf16 v[112:115], v[28:31], a[32:35], v[112:115]
    ds_read_b128 v[20:23], v4 offset:9216
    v_mul_f32 v69, v69, v133
    v_mfma_f32_16x16x32_bf16 v[116:119], v[28:31], a[36:39], v[116:119]
    v_mul_f32 v70, v70, v133
    v_mul_f32 v71, v71, v133
    v_mfma_f32_16x16x32_bf16 v[120:123], v[28:31], a[40:43], v[120:123]
    v_mul_f32 v68, v68, v84
    v_mul_f32 v69, v69, v85
    v_mfma_f32_16x16x32_bf16 v[124:127], v[28:31], a[44:47], v[124:127]
    v_mul_f32 v70, v70, v86
    v_mul_f32 v71, v71, v87
    s_waitcnt lgkmcnt(3)
    v_mfma_f32_16x16x32_bf16 v[96:99], v[8:11], a[48:51], v[96:99]
    ds_read_b128 v[24:27], v4 offset:10240
    v_cvt_pk_bf16_f32 v196, v68, v69
    v_mfma_f32_16x16x32_bf16 v[100:103], v[8:11], a[52:55], v[100:103]
    v_cvt_pk_bf16_f32 v197, v70, v71
    v_fmac_f32 v72, v144, v130
    v_mfma_f32_16x16x32_bf16 v[104:107], v[8:11], a[56:59], v[104:107]
    v_fmac_f32 v73, v145, v130
    v_fmac_f32 v74, v146, v130
    v_mfma_f32_16x16x32_bf16 v[108:111], v[8:11], a[60:63], v[108:111]
    v_fmac_f32 v75, v147, v130
    v_fmac_f32 v88, v148, v130
    s_waitcnt lgkmcnt(3)
    v_mfma_f32_16x16x32_bf16 v[112:115], v[12:15], a[48:51], v[112:115]
    ds_read_b128 v[28:31], v4 offset:11264
    v_fmac_f32 v89, v149, v130
    v_mfma_f32_16x16x32_bf16 v[116:119], v[12:15], a[52:55], v[116:119]
    v_fmac_f32 v90, v150, v130
    v_fmac_f32 v91, v151, v130
    v_mfma_f32_16x16x32_bf16 v[120:123], v[12:15], a[56:59], v[120:123]
    v_mul_f32 v72, v72, v134
    v_mul_f32 v73, v73, v134
    v_mfma_f32_16x16x32_bf16 v[124:127], v[12:15], a[60:63], v[124:127]
    v_mul_f32 v74, v74, v134
    v_mul_f32 v75, v75, v134
    s_waitcnt lgkmcnt(3)
    v_mfma_f32_16x16x32_bf16 v[96:99], v[16:19], a[64:67], v[96:99]
    ds_read_b128 v[8:11], v4 offset:12288
    v_mul_f32 v72, v72, v88
    v_mfma_f32_16x16x32_bf16 v[100:103], v[16:19], a[68:71], v[100:103]
    v_mul_f32 v73, v73, v89
    v_mul_f32 v74, v74, v90
    v_mfma_f32_16x16x32_bf16 v[104:107], v[16:19], a[72:75], v[104:107]
    v_mul_f32 v75, v75, v91
    v_cvt_pk_bf16_f32 v200, v72, v73
    v_mfma_f32_16x16x32_bf16 v[108:111], v[16:19], a[76:79], v[108:111]
    v_cvt_pk_bf16_f32 v201, v74, v75
    v_fmac_f32 v76, v144, v131
    s_waitcnt lgkmcnt(3)
    v_mfma_f32_16x16x32_bf16 v[112:115], v[20:23], a[64:67], v[112:115]
    ds_read_b128 v[12:15], v4 offset:13312
    v_fmac_f32 v77, v145, v131
    v_mfma_f32_16x16x32_bf16 v[116:119], v[20:23], a[68:71], v[116:119]
    v_fmac_f32 v78, v146, v131
    v_fmac_f32 v79, v147, v131
    v_mfma_f32_16x16x32_bf16 v[120:123], v[20:23], a[72:75], v[120:123]
    v_fmac_f32 v92, v148, v131
    v_fmac_f32 v93, v149, v131
    v_mfma_f32_16x16x32_bf16 v[124:127], v[20:23], a[76:79], v[124:127]
    v_fmac_f32 v94, v150, v131
    v_fmac_f32 v95, v151, v131
    s_waitcnt lgkmcnt(3)
    v_mfma_f32_16x16x32_bf16 v[96:99], v[24:27], a[80:83], v[96:99]
    ds_read_b128 v[16:19], v4 offset:14336
    v_mul_f32 v76, v76, v135
    v_mfma_f32_16x16x32_bf16 v[100:103], v[24:27], a[84:87], v[100:103]
    v_mul_f32 v77, v77, v135
    v_mul_f32 v78, v78, v135
    v_mfma_f32_16x16x32_bf16 v[104:107], v[24:27], a[88:91], v[104:107]
    v_mul_f32 v79, v79, v135
    v_mul_f32 v76, v76, v92
    v_mfma_f32_16x16x32_bf16 v[108:111], v[24:27], a[92:95], v[108:111]
    v_mul_f32 v77, v77, v93
    v_mul_f32 v78, v78, v94
    s_waitcnt lgkmcnt(3)
    v_mfma_f32_16x16x32_bf16 v[112:115], v[28:31], a[80:83], v[112:115]
    ds_read_b128 v[20:23], v4 offset:15360
    v_mul_f32 v79, v79, v95
    v_mfma_f32_16x16x32_bf16 v[116:119], v[28:31], a[84:87], v[116:119]
    v_cvt_pk_bf16_f32 v204, v76, v77
    v_cvt_pk_bf16_f32 v205, v78, v79
    v_mfma_f32_16x16x32_bf16 v[120:123], v[28:31], a[88:91], v[120:123]
    v_mfma_f32_16x16x32_bf16 v[124:127], v[28:31], a[92:95], v[124:127]
    s_waitcnt lgkmcnt(3)
    v_mfma_f32_16x16x32_bf16 v[96:99], v[8:11], a[96:99], v[96:99]
    ds_read_b128 v[24:27], v4 offset:16384
    v_mfma_f32_16x16x32_bf16 v[100:103], v[8:11], a[100:103], v[100:103]
    v_mfma_f32_16x16x32_bf16 v[104:107], v[8:11], a[104:107], v[104:107]
    v_mfma_f32_16x16x32_bf16 v[108:111], v[8:11], a[108:111], v[108:111]
    s_waitcnt lgkmcnt(3)
    v_mfma_f32_16x16x32_bf16 v[112:115], v[12:15], a[96:99], v[112:115]
    ds_read_b128 v[28:31], v4 offset:17408
    v_mfma_f32_16x16x32_bf16 v[116:119], v[12:15], a[100:103], v[116:119]
    v_mfma_f32_16x16x32_bf16 v[120:123], v[12:15], a[104:107], v[120:123]
    v_mfma_f32_16x16x32_bf16 v[124:127], v[12:15], a[108:111], v[124:127]
    s_waitcnt lgkmcnt(3)
    v_mfma_f32_16x16x32_bf16 v[96:99], v[16:19], a[112:115], v[96:99]
    ds_read_b128 v[8:11], v4 offset:18432
    v_mfma_f32_16x16x32_bf16 v[100:103], v[16:19], a[116:119], v[100:103]
    v_mfma_f32_16x16x32_bf16 v[104:107], v[16:19], a[120:123], v[104:107]
    v_mfma_f32_16x16x32_bf16 v[108:111], v[16:19], a[124:127], v[108:111]
    s_waitcnt lgkmcnt(3)
    v_mfma_f32_16x16x32_bf16 v[112:115], v[20:23], a[112:115], v[112:115]
    ds_read_b128 v[12:15], v4 offset:19456
    v_mfma_f32_16x16x32_bf16 v[116:119], v[20:23], a[116:119], v[116:119]
    v_mfma_f32_16x16x32_bf16 v[120:123], v[20:23], a[120:123], v[120:123]
    v_mfma_f32_16x16x32_bf16 v[124:127], v[20:23], a[124:127], v[124:127]
    s_waitcnt lgkmcnt(3)
    v_mfma_f32_16x16x32_bf16 v[96:99], v[24:27], a[128:131], v[96:99]
    ds_read_b128 v[16:19], v4 offset:20480
    v_mfma_f32_16x16x32_bf16 v[100:103], v[24:27], a[132:135], v[100:103]
    v_mfma_f32_16x16x32_bf16 v[104:107], v[24:27], a[136:139], v[104:107]
    v_mfma_f32_16x16x32_bf16 v[108:111], v[24:27], a[140:143], v[108:111]
    s_waitcnt lgkmcnt(3)
    v_mfma_f32_16x16x32_bf16 v[112:115], v[28:31], a[128:131], v[112:115]
    ds_read_b128 v[20:23], v4 offset:21504
    v_mfma_f32_16x16x32_bf16 v[116:119], v[28:31], a[132:135], v[116:119]
    v_mfma_f32_16x16x32_bf16 v[120:123], v[28:31], a[136:139], v[120:123]
    v_mfma_f32_16x16x32_bf16 v[124:127], v[28:31], a[140:143], v[124:127]
    s_waitcnt lgkmcnt(3)
    v_mfma_f32_16x16x32_bf16 v[96:99], v[8:11], a[144:147], v[96:99]
    ds_read_b128 v[24:27], v4 offset:22528
    v_mfma_f32_16x16x32_bf16 v[100:103], v[8:11], a[148:151], v[100:103]
    v_mfma_f32_16x16x32_bf16 v[104:107], v[8:11], a[152:155], v[104:107]
    v_mfma_f32_16x16x32_bf16 v[108:111], v[8:11], a[156:159], v[108:111]
    s_waitcnt lgkmcnt(3)
    v_mfma_f32_16x16x32_bf16 v[112:115], v[12:15], a[144:147], v[112:115]
    ds_read_b128 v[28:31], v4 offset:23552
    v_mfma_f32_16x16x32_bf16 v[116:119], v[12:15], a[148:151], v[116:119]
    v_mfma_f32_16x16x32_bf16 v[120:123], v[12:15], a[152:155], v[120:123]
    v_mfma_f32_16x16x32_bf16 v[124:127], v[12:15], a[156:159], v[124:127]
    s_waitcnt lgkmcnt(3)
    v_mfma_f32_16x16x32_bf16 v[96:99], v[16:19], a[160:163], v[96:99]
    ds_read_b128 v[8:11], v4 offset:24576
    v_mfma_f32_16x16x32_bf16 v[100:103], v[16:19], a[164:167], v[100:103]
    v_mfma_f32_16x16x32_bf16 v[104:107], v[16:19], a[168:171], v[104:107]
    v_mfma_f32_16x16x32_bf16 v[108:111], v[16:19], a[172:175], v[108:111]
    s_waitcnt lgkmcnt(3)
    v_mfma_f32_16x16x32_bf16 v[112:115], v[20:23], a[160:163], v[112:115]
    ds_read_b128 v[12:15], v4 offset:25600
    v_mfma_f32_16x16x32_bf16 v[116:119], v[20:23], a[164:167], v[116:119]
    v_mfma_f32_16x16x32_bf16 v[120:123], v[20:23], a[168:171], v[120:123]
    v_mfma_f32_16x16x32_bf16 v[124:127], v[20:23], a[172:175], v[124:127]
    s_waitcnt lgkmcnt(3)
    v_mfma_f32_16x16x32_bf16 v[96:99], v[24:27], a[176:179], v[96:99]
    ds_read_b128 v[16:19], v4 offset:26624
    v_mfma_f32_16x16x32_bf16 v[100:103], v[24:27], a[180:183], v[100:103]
    v_mfma_f32_16x16x32_bf16 v[104:107], v[24:27], a[184:187], v[104:107]
    v_mfma_f32_16x16x32_bf16 v[108:111], v[24:27], a[188:191], v[108:111]
    s_waitcnt lgkmcnt(3)
    v_mfma_f32_16x16x32_bf16 v[112:115], v[28:31], a[176:179], v[112:115]
    ds_read_b128 v[20:23], v4 offset:27648
    v_mfma_f32_16x16x32_bf16 v[116:119], v[28:31], a[180:183], v[116:119]
    v_mfma_f32_16x16x32_bf16 v[120:123], v[28:31], a[184:187], v[120:123]
    v_mfma_f32_16x16x32_bf16 v[124:127], v[28:31], a[188:191], v[124:127]
    s_waitcnt lgkmcnt(3)
    v_mfma_f32_16x16x32_bf16 v[96:99], v[8:11], a[192:195], v[96:99]
    ds_read_b128 v[24:27], v4 offset:28672
    v_mfma_f32_16x16x32_bf16 v[100:103], v[8:11], a[196:199], v[100:103]
    v_mfma_f32_16x16x32_bf16 v[104:107], v[8:11], a[200:203], v[104:107]
    v_mfma_f32_16x16x32_bf16 v[108:111], v[8:11], a[204:207], v[108:111]
    s_waitcnt lgkmcnt(3)
    v_mfma_f32_16x16x32_bf16 v[112:115], v[12:15], a[192:195], v[112:115]
    ds_read_b128 v[28:31], v4 offset:29696
    v_mfma_f32_16x16x32_bf16 v[116:119], v[12:15], a[196:199], v[116:119]
    v_mfma_f32_16x16x32_bf16 v[120:123], v[12:15], a[200:203], v[120:123]
    v_mfma_f32_16x16x32_bf16 v[124:127], v[12:15], a[204:207], v[124:127]
    s_waitcnt lgkmcnt(3)
    v_mfma_f32_16x16x32_bf16 v[96:99], v[16:19], a[208:211], v[96:99]
    ds_read_b128 v[8:11], v4 offset:30720
    v_mfma_f32_16x16x32_bf16 v[100:103], v[16:19], a[212:215], v[100:103]
    v_mfma_f32_16x16x32_bf16 v[104:107], v[16:19], a[216:219], v[104:107]
    v_mfma_f32_16x16x32_bf16 v[108:111], v[16:19], a[220:223], v[108:111]
    s_waitcnt lgkmcnt(3)
    v_mfma_f32_16x16x32_bf16 v[112:115], v[20:23], a[208:211], v[112:115]
    ds_read_b128 v[12:15], v4 offset:31744
    v_mfma_f32_16x16x32_bf16 v[116:119], v[20:23], a[212:215], v[116:119]
    v_mfma_f32_16x16x32_bf16 v[120:123], v[20:23], a[216:219], v[120:123]
    v_mfma_f32_16x16x32_bf16 v[124:127], v[20:23], a[220:223], v[124:127]
    s_waitcnt lgkmcnt(3)
    v_mfma_f32_16x16x32_bf16 v[96:99], v[24:27], a[224:227], v[96:99]
    ds_read_b128 v[16:19], v4 offset:32768
    v_mfma_f32_16x16x32_bf16 v[100:103], v[24:27], a[228:231], v[100:103]
    v_mfma_f32_16x16x32_bf16 v[104:107], v[24:27], a[232:235], v[104:107]
    v_mfma_f32_16x16x32_bf16 v[108:111], v[24:27], a[236:239], v[108:111]
    s_waitcnt lgkmcnt(3)
    v_mfma_f32_16x16x32_bf16 v[112:115], v[28:31], a[224:227], v[112:115]
    ds_read_b128 v[20:23], v4 offset:33792
    v_mfma_f32_16x16x32_bf16 v[116:119], v[28:31], a[228:231], v[116:119]
    v_mfma_f32_16x16x32_bf16 v[120:123], v[28:31], a[232:235], v[120:123]
    v_mfma_f32_16x16x32_bf16 v[124:127], v[28:31], a[236:239], v[124:127]
    s_waitcnt lgkmcnt(3)
    v_mfma_f32_16x16x32_bf16 v[96:99], v[8:11], a[240:243], v[96:99]
    ds_read_b128 v[24:27], v4 offset:34816
    v_mfma_f32_16x16x32_bf16 v[100:103], v[8:11], a[244:247], v[100:103]
    v_mfma_f32_16x16x32_bf16 v[104:107], v[8:11], a[248:251], v[104:107]
    v_mfma_f32_16x16x32_bf16 v[108:111], v[8:11], a[252:255], v[108:111]
    ds_read_b128 v[136:139], v5 offset:512
    ds_read_b128 v[140:143], v5 offset:576
    s_waitcnt lgkmcnt(5)
    v_mfma_f32_16x16x32_bf16 v[112:115], v[12:15], a[240:243], v[112:115]
    ds_read_b128 v[28:31], v4 offset:35840
    v_mfma_f32_16x16x32_bf16 v[116:119], v[12:15], a[244:247], v[116:119]
    v_mfma_f32_16x16x32_bf16 v[120:123], v[12:15], a[248:251], v[120:123]
    v_mfma_f32_16x16x32_bf16 v[124:127], v[12:15], a[252:255], v[124:127]
    s_waitcnt lgkmcnt(5)
    v_mfma_f32_16x16x32_bf16 v[96:99], v[16:19], v[32:35], v[96:99]
    s_waitcnt vmcnt(17)
    s_barrier
    v_mfma_f32_16x16x32_bf16 v[100:103], v[16:19], v[36:39], v[100:103]
    v_add_u32 v4, 0x9000, v4
    ds_read_b128 v[8:11], v4 offset:0
    v_mfma_f32_16x16x32_bf16 v[104:107], v[16:19], v[40:43], v[104:107]
    s_add_u32 m0, s49, 110592
    s_add_u32 s61, s48, 258048
    v_mfma_f32_16x16x32_bf16 v[108:111], v[16:19], v[44:47], v[108:111]
    buffer_load_dwordx4 v2, s[4:7], s61 offen offset:0 lds
    buffer_load_dwordx4 v2, s[4:7], s61 offen offset:1024 lds
    s_waitcnt lgkmcnt(5)
    v_mfma_f32_16x16x32_bf16 v[112:115], v[20:23], v[32:35], v[112:115]
    ds_read_b128 v[12:15], v4 offset:1024
    buffer_load_dwordx4 v2, s[4:7], s61 offen offset:2048 lds
    v_mfma_f32_16x16x32_bf16 v[116:119], v[20:23], v[36:39], v[116:119]
    buffer_load_dwordx4 v2, s[4:7], s61 offen offset:3072 lds
    s_add_u32 m0, s49, 114688
    v_mfma_f32_16x16x32_bf16 v[120:123], v[20:23], v[40:43], v[120:123]
    s_add_u32 s61, s48, 262144
    buffer_load_dwordx4 v2, s[4:7], s61 offen offset:0 lds
    v_mfma_f32_16x16x32_bf16 v[124:127], v[20:23], v[44:47], v[124:127]
    buffer_load_dwordx4 v2, s[4:7], s61 offen offset:1024 lds
    buffer_load_dwordx4 v2, s[4:7], s61 offen offset:2048 lds
    s_waitcnt lgkmcnt(5)
    v_mfma_f32_16x16x32_bf16 v[96:99], v[24:27], v[48:51], v[96:99]
    ds_read_b128 v[16:19], v4 offset:2048
    buffer_load_dwordx4 v2, s[4:7], s61 offen offset:3072 lds
    v_mfma_f32_16x16x32_bf16 v[100:103], v[24:27], v[52:55], v[100:103]
    s_add_u32 m0, s49, 118784
    s_add_u32 s61, s48, 266240
    v_mfma_f32_16x16x32_bf16 v[104:107], v[24:27], v[56:59], v[104:107]
    buffer_load_dwordx4 v2, s[4:7], s61 offen offset:0 lds
    v_mfma_f32_16x16x32_bf16 v[108:111], v[24:27], v[60:63], v[108:111]
    s_waitcnt lgkmcnt(3)
    v_mfma_f32_16x16x32_bf16 v[112:115], v[28:31], v[48:51], v[112:115]
    ds_read_b128 v[20:23], v4 offset:3072
    v_mfma_f32_16x16x32_bf16 v[116:119], v[28:31], v[52:55], v[116:119]
    v_mfma_f32_16x16x32_bf16 v[120:123], v[28:31], v[56:59], v[120:123]
    v_mfma_f32_16x16x32_bf16 v[124:127], v[28:31], v[60:63], v[124:127]
    s_waitcnt lgkmcnt(3)
    v_mfma_f32_16x16x32_bf16 v[64:67], v[8:11], a[0:3], 0
    ds_read_b128 v[24:27], v4 offset:4096
    v_mfma_f32_16x16x32_bf16 v[68:71], v[8:11], a[4:7], 0
    v_mfma_f32_16x16x32_bf16 v[72:75], v[8:11], a[8:11], 0
    v_mfma_f32_16x16x32_bf16 v[76:79], v[8:11], a[12:15], 0
    s_waitcnt lgkmcnt(3)
    v_mfma_f32_16x16x32_bf16 v[80:83], v[12:15], a[0:3], 0
    ds_read_b128 v[28:31], v4 offset:5120
    v_mfma_f32_16x16x32_bf16 v[84:87], v[12:15], a[4:7], 0
    v_fmac_f32 v96, v136, v128
    v_fmac_f32 v97, v137, v128
    v_mfma_f32_16x16x32_bf16 v[88:91], v[12:15], a[8:11], 0
    v_fmac_f32 v98, v138, v128
    v_fmac_f32 v99, v139, v128
    v_mfma_f32_16x16x32_bf16 v[92:95], v[12:15], a[12:15], 0
    v_fmac_f32 v112, v140, v128
    v_fmac_f32 v113, v141, v128
    s_waitcnt lgkmcnt(3)
    v_mfma_f32_16x16x32_bf16 v[64:67], v[16:19], a[16:19], v[64:67]
    ds_read_b128 v[8:11], v4 offset:6144
    v_fmac_f32 v114, v142, v128
    v_mfma_f32_16x16x32_bf16 v[68:71], v[16:19], a[20:23], v[68:71]
    v_fmac_f32 v115, v143, v128
    v_mul_f32 v96, v96, v132
    v_mfma_f32_16x16x32_bf16 v[72:75], v[16:19], a[24:27], v[72:75]
    v_mul_f32 v97, v97, v132
    v_mul_f32 v98, v98, v132
    v_mfma_f32_16x16x32_bf16 v[76:79], v[16:19], a[28:31], v[76:79]
    v_mul_f32 v99, v99, v132
    v_mul_f32 v96, v96, v112
    s_waitcnt lgkmcnt(3)
    v_mfma_f32_16x16x32_bf16 v[80:83], v[20:23], a[16:19], v[80:83]
    ds_read_b128 v[12:15], v4 offset:7168
    v_mul_f32 v97, v97, v113
    v_mfma_f32_16x16x32_bf16 v[84:87], v[20:23], a[20:23], v[84:87]
    v_mul_f32 v98, v98, v114
    v_mul_f32 v99, v99, v115
    v_mfma_f32_16x16x32_bf16 v[88:91], v[20:23], a[24:27], v[88:91]
    v_cvt_pk_bf16_f32 v194, v96, v97
    v_cvt_pk_bf16_f32 v195, v98, v99
    v_mfma_f32_16x16x32_bf16 v[92:95], v[20:23], a[28:31], v[92:95]
    s_add_u32 s66, s51, 16384
    buffer_store_dwordx4 v[192:195], v2, s[4:7], s66 offen offset:0 sc1
    s_waitcnt lgkmcnt(3)
    v_mfma_f32_16x16x32_bf16 v[64:67], v[24:27], a[32:35], v[64:67]
    ds_read_b128 v[16:19], v4 offset:8192
    v_fmac_f32 v100, v136, v129
    v_mfma_f32_16x16x32_bf16 v[68:71], v[24:27], a[36:39], v[68:71]
    v_fmac_f32 v101, v137, v129
    v_fmac_f32 v102, v138, v129
    v_mfma_f32_16x16x32_bf16 v[72:75], v[24:27], a[40:43], v[72:75]
    v_fmac_f32 v103, v139, v129
    v_fmac_f32 v116, v140, v129
    v_mfma_f32_16x16x32_bf16 v[76:79], v[24:27], a[44:47], v[76:79]
    v_fmac_f32 v117, v141, v129
    v_fmac_f32 v118, v142, v129
    s_waitcnt lgkmcnt(3)
    v_mfma_f32_16x16x32_bf16 v[80:83], v[28:31], a[32:35], v[80:83]
    ds_read_b128 v[20:23], v4 offset:9216
    v_fmac_f32 v119, v143, v129
    v_mfma_f32_16x16x32_bf16 v[84:87], v[28:31], a[36:39], v[84:87]
    v_mul_f32 v100, v100, v133
    v_mul_f32 v101, v101, v133
    v_mfma_f32_16x16x32_bf16 v[88:91], v[28:31], a[40:43], v[88:91]
    v_mul_f32 v102, v102, v133
    v_mul_f32 v103, v103, v133
    v_mfma_f32_16x16x32_bf16 v[92:95], v[28:31], a[44:47], v[92:95]
    v_mul_f32 v100, v100, v116
    v_mul_f32 v101, v101, v117
    s_waitcnt lgkmcnt(3)
    v_mfma_f32_16x16x32_bf16 v[64:67], v[8:11], a[48:51], v[64:67]
    ds_read_b128 v[24:27], v4 offset:10240
    v_mul_f32 v102, v102, v118
    v_mfma_f32_16x16x32_bf16 v[68:71], v[8:11], a[52:55], v[68:71]
    v_mul_f32 v103, v103, v119
    v_cvt_pk_bf16_f32 v198, v100, v101
    v_mfma_f32_16x16x32_bf16 v[72:75], v[8:11], a[56:59], v[72:75]
    v_cvt_pk_bf16_f32 v199, v102, v103
    buffer_store_dwordx4 v[196:199], v2, s[4:7], s66 offen offset:1024 sc1
    v_mfma_f32_16x16x32_bf16 v[76:79], v[8:11], a[60:63], v[76:79]
    v_fmac_f32 v104, v136, v130
    v_fmac_f32 v105, v137, v130
    s_waitcnt lgkmcnt(3)
    v_mfma_f32_16x16x32_bf16 v[80:83], v[12:15], a[48:51], v[80:83]
    ds_read_b128 v[28:31], v4 offset:11264
    v_fmac_f32 v106, v138, v130
    v_mfma_f32_16x16x32_bf16 v[84:87], v[12:15], a[52:55], v[84:87]
    v_fmac_f32 v107, v139, v130
    v_fmac_f32 v120, v140, v130
    v_mfma_f32_16x16x32_bf16 v[88:91], v[12:15], a[56:59], v[88:91]
    v_fmac_f32 v121, v141, v130
    v_fmac_f32 v122, v142, v130
    v_mfma_f32_16x16x32_bf16 v[92:95], v[12:15], a[60:63], v[92:95]
    v_fmac_f32 v123, v143, v130
    v_mul_f32 v104, v104, v134
    s_waitcnt lgkmcnt(3)
    v_mfma_f32_16x16x32_bf16 v[64:67], v[16:19], a[64:67], v[64:67]
    ds_read_b128 v[8:11], v4 offset:12288
    v_mul_f32 v105, v105, v134
    v_mfma_f32_16x16x32_bf16 v[68:71], v[16:19], a[68:71], v[68:71]
    v_mul_f32 v106, v106, v134
    v_mul_f32 v107, v107, v134
    v_mfma_f32_16x16x32_bf16 v[72:75], v[16:19], a[72:75], v[72:75]
    v_mul_f32 v104, v104, v120
    v_mul_f32 v105, v105, v121
    v_mfma_f32_16x16x32_bf16 v[76:79], v[16:19], a[76:79], v[76:79]
    v_mul_f32 v106, v106, v122
    v_mul_f32 v107, v107, v123
    s_waitcnt lgkmcnt(3)
    v_mfma_f32_16x16x32_bf16 v[80:83], v[20:23], a[64:67], v[80:83]
    ds_read_b128 v[12:15], v4 offset:13312
    v_cvt_pk_bf16_f32 v202, v104, v105
    v_mfma_f32_16x16x32_bf16 v[84:87], v[20:23], a[68:71], v[84:87]
    v_cvt_pk_bf16_f32 v203, v106, v107
    buffer_store_dwordx4 v[200:203], v2, s[4:7], s66 offen offset:2048 sc1
    v_mfma_f32_16x16x32_bf16 v[88:91], v[20:23], a[72:75], v[88:91]
    v_fmac_f32 v108, v136, v131
    v_fmac_f32 v109, v137, v131
    v_mfma_f32_16x16x32_bf16 v[92:95], v[20:23], a[76:79], v[92:95]
    v_fmac_f32 v110, v138, v131
    v_fmac_f32 v111, v139, v131
    s_waitcnt lgkmcnt(3)
    v_mfma_f32_16x16x32_bf16 v[64:67], v[24:27], a[80:83], v[64:67]
    ds_read_b128 v[16:19], v4 offset:14336
    v_fmac_f32 v124, v140, v131
    v_mfma_f32_16x16x32_bf16 v[68:71], v[24:27], a[84:87], v[68:71]
    v_fmac_f32 v125, v141, v131
    v_fmac_f32 v126, v142, v131
    v_mfma_f32_16x16x32_bf16 v[72:75], v[24:27], a[88:91], v[72:75]
    v_fmac_f32 v127, v143, v131
    v_mul_f32 v108, v108, v135
    v_mfma_f32_16x16x32_bf16 v[76:79], v[24:27], a[92:95], v[76:79]
    v_mul_f32 v109, v109, v135
    v_mul_f32 v110, v110, v135
    s_waitcnt lgkmcnt(3)
    v_mfma_f32_16x16x32_bf16 v[80:83], v[28:31], a[80:83], v[80:83]
    ds_read_b128 v[20:23], v4 offset:15360
    v_mul_f32 v111, v111, v135
    v_mfma_f32_16x16x32_bf16 v[84:87], v[28:31], a[84:87], v[84:87]
    v_mul_f32 v108, v108, v124
    v_mul_f32 v109, v109, v125
    v_mfma_f32_16x16x32_bf16 v[88:91], v[28:31], a[88:91], v[88:91]
    v_mul_f32 v110, v110, v126
    v_mul_f32 v111, v111, v127
    v_mfma_f32_16x16x32_bf16 v[92:95], v[28:31], a[92:95], v[92:95]
    v_cvt_pk_bf16_f32 v206, v108, v109
    v_cvt_pk_bf16_f32 v207, v110, v111
    s_waitcnt lgkmcnt(3)
    v_mfma_f32_16x16x32_bf16 v[64:67], v[8:11], a[96:99], v[64:67]
    ds_read_b128 v[24:27], v4 offset:16384
    buffer_store_dwordx4 v[204:207], v2, s[4:7], s66 offen offset:3072 sc1
    v_mfma_f32_16x16x32_bf16 v[68:71], v[8:11], a[100:103], v[68:71]
    v_mfma_f32_16x16x32_bf16 v[72:75], v[8:11], a[104:107], v[72:75]
    v_mfma_f32_16x16x32_bf16 v[76:79], v[8:11], a[108:111], v[76:79]
    s_waitcnt lgkmcnt(3)
    v_mfma_f32_16x16x32_bf16 v[80:83], v[12:15], a[96:99], v[80:83]
    ds_read_b128 v[28:31], v4 offset:17408
    v_mfma_f32_16x16x32_bf16 v[84:87], v[12:15], a[100:103], v[84:87]
    v_mfma_f32_16x16x32_bf16 v[88:91], v[12:15], a[104:107], v[88:91]
    v_mfma_f32_16x16x32_bf16 v[92:95], v[12:15], a[108:111], v[92:95]
    s_waitcnt lgkmcnt(3)
    v_mfma_f32_16x16x32_bf16 v[64:67], v[16:19], a[112:115], v[64:67]
    ds_read_b128 v[8:11], v4 offset:18432
    v_mfma_f32_16x16x32_bf16 v[68:71], v[16:19], a[116:119], v[68:71]
    v_mfma_f32_16x16x32_bf16 v[72:75], v[16:19], a[120:123], v[72:75]
    v_mfma_f32_16x16x32_bf16 v[76:79], v[16:19], a[124:127], v[76:79]
    s_waitcnt lgkmcnt(3)
    v_mfma_f32_16x16x32_bf16 v[80:83], v[20:23], a[112:115], v[80:83]
    ds_read_b128 v[12:15], v4 offset:19456
    v_mfma_f32_16x16x32_bf16 v[84:87], v[20:23], a[116:119], v[84:87]
    v_mfma_f32_16x16x32_bf16 v[88:91], v[20:23], a[120:123], v[88:91]
    v_mfma_f32_16x16x32_bf16 v[92:95], v[20:23], a[124:127], v[92:95]
    s_waitcnt lgkmcnt(3)
    v_mfma_f32_16x16x32_bf16 v[64:67], v[24:27], a[128:131], v[64:67]
    ds_read_b128 v[16:19], v4 offset:20480
    v_mfma_f32_16x16x32_bf16 v[68:71], v[24:27], a[132:135], v[68:71]
    v_mfma_f32_16x16x32_bf16 v[72:75], v[24:27], a[136:139], v[72:75]
    v_mfma_f32_16x16x32_bf16 v[76:79], v[24:27], a[140:143], v[76:79]
    s_waitcnt lgkmcnt(3)
    v_mfma_f32_16x16x32_bf16 v[80:83], v[28:31], a[128:131], v[80:83]
    ds_read_b128 v[20:23], v4 offset:21504
    v_mfma_f32_16x16x32_bf16 v[84:87], v[28:31], a[132:135], v[84:87]
    v_mfma_f32_16x16x32_bf16 v[88:91], v[28:31], a[136:139], v[88:91]
    v_mfma_f32_16x16x32_bf16 v[92:95], v[28:31], a[140:143], v[92:95]
    s_waitcnt lgkmcnt(3)
    v_mfma_f32_16x16x32_bf16 v[64:67], v[8:11], a[144:147], v[64:67]
    ds_read_b128 v[24:27], v4 offset:22528
    v_mfma_f32_16x16x32_bf16 v[68:71], v[8:11], a[148:151], v[68:71]
    v_mfma_f32_16x16x32_bf16 v[72:75], v[8:11], a[152:155], v[72:75]
    v_mfma_f32_16x16x32_bf16 v[76:79], v[8:11], a[156:159], v[76:79]
    s_waitcnt lgkmcnt(3)
    v_mfma_f32_16x16x32_bf16 v[80:83], v[12:15], a[144:147], v[80:83]
    ds_read_b128 v[28:31], v4 offset:23552
    v_mfma_f32_16x16x32_bf16 v[84:87], v[12:15], a[148:151], v[84:87]
    v_mfma_f32_16x16x32_bf16 v[88:91], v[12:15], a[152:155], v[88:91]
    v_mfma_f32_16x16x32_bf16 v[92:95], v[12:15], a[156:159], v[92:95]
    s_waitcnt lgkmcnt(3)
    v_mfma_f32_16x16x32_bf16 v[64:67], v[16:19], a[160:163], v[64:67]
    ds_read_b128 v[8:11], v4 offset:24576
    v_mfma_f32_16x16x32_bf16 v[68:71], v[16:19], a[164:167], v[68:71]
    v_mfma_f32_16x16x32_bf16 v[72:75], v[16:19], a[168:171], v[72:75]
    v_mfma_f32_16x16x32_bf16 v[76:79], v[16:19], a[172:175], v[76:79]
    s_waitcnt lgkmcnt(3)
    v_mfma_f32_16x16x32_bf16 v[80:83], v[20:23], a[160:163], v[80:83]
    ds_read_b128 v[12:15], v4 offset:25600
    v_mfma_f32_16x16x32_bf16 v[84:87], v[20:23], a[164:167], v[84:87]
    v_mfma_f32_16x16x32_bf16 v[88:91], v[20:23], a[168:171], v[88:91]
    v_mfma_f32_16x16x32_bf16 v[92:95], v[20:23], a[172:175], v[92:95]
    s_waitcnt lgkmcnt(3)
    v_mfma_f32_16x16x32_bf16 v[64:67], v[24:27], a[176:179], v[64:67]
    ds_read_b128 v[16:19], v4 offset:26624
    v_mfma_f32_16x16x32_bf16 v[68:71], v[24:27], a[180:183], v[68:71]
    v_mfma_f32_16x16x32_bf16 v[72:75], v[24:27], a[184:187], v[72:75]
    v_mfma_f32_16x16x32_bf16 v[76:79], v[24:27], a[188:191], v[76:79]
    s_waitcnt lgkmcnt(3)
    v_mfma_f32_16x16x32_bf16 v[80:83], v[28:31], a[176:179], v[80:83]
    ds_read_b128 v[20:23], v4 offset:27648
    v_mfma_f32_16x16x32_bf16 v[84:87], v[28:31], a[180:183], v[84:87]
    v_mfma_f32_16x16x32_bf16 v[88:91], v[28:31], a[184:187], v[88:91]
    v_mfma_f32_16x16x32_bf16 v[92:95], v[28:31], a[188:191], v[92:95]
    s_waitcnt lgkmcnt(3)
    v_mfma_f32_16x16x32_bf16 v[64:67], v[8:11], a[192:195], v[64:67]
    ds_read_b128 v[24:27], v4 offset:28672
    v_mfma_f32_16x16x32_bf16 v[68:71], v[8:11], a[196:199], v[68:71]
    v_mfma_f32_16x16x32_bf16 v[72:75], v[8:11], a[200:203], v[72:75]
    v_mfma_f32_16x16x32_bf16 v[76:79], v[8:11], a[204:207], v[76:79]
    s_waitcnt lgkmcnt(3)
    v_mfma_f32_16x16x32_bf16 v[80:83], v[12:15], a[192:195], v[80:83]
    ds_read_b128 v[28:31], v4 offset:29696
    v_mfma_f32_16x16x32_bf16 v[84:87], v[12:15], a[196:199], v[84:87]
    v_mfma_f32_16x16x32_bf16 v[88:91], v[12:15], a[200:203], v[88:91]
    v_mfma_f32_16x16x32_bf16 v[92:95], v[12:15], a[204:207], v[92:95]
    s_waitcnt lgkmcnt(3)
    v_mfma_f32_16x16x32_bf16 v[64:67], v[16:19], a[208:211], v[64:67]
    ds_read_b128 v[8:11], v4 offset:30720
    v_mfma_f32_16x16x32_bf16 v[68:71], v[16:19], a[212:215], v[68:71]
    v_mfma_f32_16x16x32_bf16 v[72:75], v[16:19], a[216:219], v[72:75]
    v_mfma_f32_16x16x32_bf16 v[76:79], v[16:19], a[220:223], v[76:79]
    s_waitcnt lgkmcnt(3)
    v_mfma_f32_16x16x32_bf16 v[80:83], v[20:23], a[208:211], v[80:83]
    ds_read_b128 v[12:15], v4 offset:31744
    v_mfma_f32_16x16x32_bf16 v[84:87], v[20:23], a[212:215], v[84:87]
    v_mfma_f32_16x16x32_bf16 v[88:91], v[20:23], a[216:219], v[88:91]
    v_mfma_f32_16x16x32_bf16 v[92:95], v[20:23], a[220:223], v[92:95]
    s_waitcnt lgkmcnt(3)
    v_mfma_f32_16x16x32_bf16 v[64:67], v[24:27], a[224:227], v[64:67]
    ds_read_b128 v[16:19], v4 offset:32768
    v_mfma_f32_16x16x32_bf16 v[68:71], v[24:27], a[228:231], v[68:71]
    v_mfma_f32_16x16x32_bf16 v[72:75], v[24:27], a[232:235], v[72:75]
    v_mfma_f32_16x16x32_bf16 v[76:79], v[24:27], a[236:239], v[76:79]
    s_waitcnt lgkmcnt(3)
    v_mfma_f32_16x16x32_bf16 v[80:83], v[28:31], a[224:227], v[80:83]
    ds_read_b128 v[20:23], v4 offset:33792
    v_mfma_f32_16x16x32_bf16 v[84:87], v[28:31], a[228:231], v[84:87]
    v_mfma_f32_16x16x32_bf16 v[88:91], v[28:31], a[232:235], v[88:91]
    v_mfma_f32_16x16x32_bf16 v[92:95], v[28:31], a[236:239], v[92:95]
    s_waitcnt lgkmcnt(3)
    v_mfma_f32_16x16x32_bf16 v[64:67], v[8:11], a[240:243], v[64:67]
    ds_read_b128 v[24:27], v4 offset:34816
    v_mfma_f32_16x16x32_bf16 v[68:71], v[8:11], a[244:247], v[68:71]
    v_mfma_f32_16x16x32_bf16 v[72:75], v[8:11], a[248:251], v[72:75]
    v_mfma_f32_16x16x32_bf16 v[76:79], v[8:11], a[252:255], v[76:79]
    ds_read_b128 v[144:147], v5 offset:640
    ds_read_b128 v[148:151], v5 offset:704
    s_waitcnt lgkmcnt(5)
    v_mfma_f32_16x16x32_bf16 v[80:83], v[12:15], a[240:243], v[80:83]
    ds_read_b128 v[28:31], v4 offset:35840
    v_mfma_f32_16x16x32_bf16 v[84:87], v[12:15], a[244:247], v[84:87]
    v_mfma_f32_16x16x32_bf16 v[88:91], v[12:15], a[248:251], v[88:91]
    v_mfma_f32_16x16x32_bf16 v[92:95], v[12:15], a[252:255], v[92:95]
    s_waitcnt lgkmcnt(5)
    v_mfma_f32_16x16x32_bf16 v[64:67], v[16:19], v[32:35], v[64:67]
    s_waitcnt vmcnt(13)
    s_barrier
    v_mfma_f32_16x16x32_bf16 v[68:71], v[16:19], v[36:39], v[68:71]
    v_add_u32 v4, 0x9000, v4
    ds_read_b128 v[8:11], v4 offset:0
    v_mfma_f32_16x16x32_bf16 v[72:75], v[16:19], v[40:43], v[72:75]
    s_add_u32 m0, s49, 0
    s_add_u32 s61, s48, 294912
    v_mfma_f32_16x16x32_bf16 v[76:79], v[16:19], v[44:47], v[76:79]
    buffer_load_dwordx4 v2, s[4:7], s61 offen offset:0 lds
    buffer_load_dwordx4 v2, s[4:7], s61 offen offset:1024 lds
    s_waitcnt lgkmcnt(5)
    v_mfma_f32_16x16x32_bf16 v[80:83], v[20:23], v[32:35], v[80:83]
    ds_read_b128 v[12:15], v4 offset:1024
    buffer_load_dwordx4 v2, s[4:7], s61 offen offset:2048 lds
    v_mfma_f32_16x16x32_bf16 v[84:87], v[20:23], v[36:39], v[84:87]
    buffer_load_dwordx4 v2, s[4:7], s61 offen offset:3072 lds
    s_add_u32 m0, s49, 4096
    v_mfma_f32_16x16x32_bf16 v[88:91], v[20:23], v[40:43], v[88:91]
    s_add_u32 s61, s48, 299008
    buffer_load_dwordx4 v2, s[4:7], s61 offen offset:0 lds
    v_mfma_f32_16x16x32_bf16 v[92:95], v[20:23], v[44:47], v[92:95]
    buffer_load_dwordx4 v2, s[4:7], s61 offen offset:1024 lds
    buffer_load_dwordx4 v2, s[4:7], s61 offen offset:2048 lds
    s_waitcnt lgkmcnt(5)
    v_mfma_f32_16x16x32_bf16 v[64:67], v[24:27], v[48:51], v[64:67]
    ds_read_b128 v[16:19], v4 offset:2048
    buffer_load_dwordx4 v2, s[4:7], s61 offen offset:3072 lds
    v_mfma_f32_16x16x32_bf16 v[68:71], v[24:27], v[52:55], v[68:71]
    s_add_u32 m0, s49, 8192
    s_add_u32 s61, s48, 303104
    v_mfma_f32_16x16x32_bf16 v[72:75], v[24:27], v[56:59], v[72:75]
    buffer_load_dwordx4 v2, s[4:7], s61 offen offset:0 lds
    v_mfma_f32_16x16x32_bf16 v[76:79], v[24:27], v[60:63], v[76:79]
    s_waitcnt lgkmcnt(3)
    v_mfma_f32_16x16x32_bf16 v[80:83], v[28:31], v[48:51], v[80:83]
    ds_read_b128 v[20:23], v4 offset:3072
    v_mfma_f32_16x16x32_bf16 v[84:87], v[28:31], v[52:55], v[84:87]
    v_mfma_f32_16x16x32_bf16 v[88:91], v[28:31], v[56:59], v[88:91]
    v_mfma_f32_16x16x32_bf16 v[92:95], v[28:31], v[60:63], v[92:95]
    s_waitcnt lgkmcnt(3)
    v_mfma_f32_16x16x32_bf16 v[96:99], v[8:11], a[0:3], 0
    ds_read_b128 v[24:27], v4 offset:4096
    v_mfma_f32_16x16x32_bf16 v[100:103], v[8:11], a[4:7], 0
    v_mfma_f32_16x16x32_bf16 v[104:107], v[8:11], a[8:11], 0
    v_mfma_f32_16x16x32_bf16 v[108:111], v[8:11], a[12:15], 0
    s_waitcnt lgkmcnt(3)
    v_mfma_f32_16x16x32_bf16 v[112:115], v[12:15], a[0:3], 0
    ds_read_b128 v[28:31], v4 offset:5120
    v_mfma_f32_16x16x32_bf16 v[116:119], v[12:15], a[4:7], 0
    v_fmac_f32 v64, v144, v128
    v_fmac_f32 v65, v145, v128
    v_mfma_f32_16x16x32_bf16 v[120:123], v[12:15], a[8:11], 0
    v_fmac_f32 v66, v146, v128
    v_fmac_f32 v67, v147, v128
    v_mfma_f32_16x16x32_bf16 v[124:127], v[12:15], a[12:15], 0
    v_fmac_f32 v80, v148, v128
    v_fmac_f32 v81, v149, v128
    s_waitcnt lgkmcnt(3)
    v_mfma_f32_16x16x32_bf16 v[96:99], v[16:19], a[16:19], v[96:99]
    ds_read_b128 v[8:11], v4 offset:6144
    v_fmac_f32 v82, v150, v128
    v_mfma_f32_16x16x32_bf16 v[100:103], v[16:19], a[20:23], v[100:103]
    v_fmac_f32 v83, v151, v128
    v_mul_f32 v64, v64, v132
    v_mfma_f32_16x16x32_bf16 v[104:107], v[16:19], a[24:27], v[104:107]
    v_mul_f32 v65, v65, v132
    v_mul_f32 v66, v66, v132
    v_mfma_f32_16x16x32_bf16 v[108:111], v[16:19], a[28:31], v[108:111]
    v_mul_f32 v67, v67, v132
    v_mul_f32 v64, v64, v80
    s_waitcnt lgkmcnt(3)
    v_mfma_f32_16x16x32_bf16 v[112:115], v[20:23], a[16:19], v[112:115]
    ds_read_b128 v[12:15], v4 offset:7168
    v_mul_f32 v65, v65, v81
    v_mfma_f32_16x16x32_bf16 v[116:119], v[20:23], a[20:23], v[116:119]
    v_mul_f32 v66, v66, v82
    v_mul_f32 v67, v67, v83
    v_mfma_f32_16x16x32_bf16 v[120:123], v[20:23], a[24:27], v[120:123]
    v_cvt_pk_bf16_f32 v208, v64, v65
    v_cvt_pk_bf16_f32 v209, v66, v67
    v_mfma_f32_16x16x32_bf16 v[124:127], v[20:23], a[28:31], v[124:127]
    v_fmac_f32 v68, v144, v129
    v_fmac_f32 v69, v145, v129
    s_waitcnt lgkmcnt(3)
    v_mfma_f32_16x16x32_bf16 v[96:99], v[24:27], a[32:35], v[96:99]
    ds_read_b128 v[16:19], v4 offset:8192
    v_fmac_f32 v70, v146, v129
    v_mfma_f32_16x16x32_bf16 v[100:103], v[24:27], a[36:39], v[100:103]
    v_fmac_f32 v71, v147, v129
    v_fmac_f32 v84, v148, v129
    v_mfma_f32_16x16x32_bf16 v[104:107], v[24:27], a[40:43], v[104:107]
    v_fmac_f32 v85, v149, v129
    v_fmac_f32 v86, v150, v129
    v_mfma_f32_16x16x32_bf16 v[108:111], v[24:27], a[44:47], v[108:111]
    v_fmac_f32 v87, v151, v129
    v_mul_f32 v68, v68, v133
    s_waitcnt lgkmcnt(3)
    v_mfma_f32_16x16x32_bf16 v[112:115], v[28:31], a[32:35], v[112:115]
    ds_read_b128 v[20:23], v4 offset:9216
    v_mul_f32 v69, v69, v133
    v_mfma_f32_16x16x32_bf16 v[116:119], v[28:31], a[36:39], v[116:119]
    v_mul_f32 v70, v70, v133
    v_mul_f32 v71, v71, v133
    v_mfma_f32_16x16x32_bf16 v[120:123], v[28:31], a[40:43], v[120:123]
    v_mul_f32 v68, v68, v84
    v_mul_f32 v69, v69, v85
    v_mfma_f32_16x16x32_bf16 v[124:127], v[28:31], a[44:47], v[124:127]
    v_mul_f32 v70, v70, v86
    v_mul_f32 v71, v71, v87
    s_waitcnt lgkmcnt(3)
    v_mfma_f32_16x16x32_bf16 v[96:99], v[8:11], a[48:51], v[96:99]
    ds_read_b128 v[24:27], v4 offset:10240
    v_cvt_pk_bf16_f32 v212, v68, v69
    v_mfma_f32_16x16x32_bf16 v[100:103], v[8:11], a[52:55], v[100:103]
    v_cvt_pk_bf16_f32 v213, v70, v71
    v_fmac_f32 v72, v144, v130
    v_mfma_f32_16x16x32_bf16 v[104:107], v[8:11], a[56:59], v[104:107]
    v_fmac_f32 v73, v145, v130
    v_fmac_f32 v74, v146, v130
    v_mfma_f32_16x16x32_bf16 v[108:111], v[8:11], a[60:63], v[108:111]
    v_fmac_f32 v75, v147, v130
    v_fmac_f32 v88, v148, v130
    s_waitcnt lgkmcnt(3)
    v_mfma_f32_16x16x32_bf16 v[112:115], v[12:15], a[48:51], v[112:115]
    ds_read_b128 v[28:31], v4 offset:11264
    v_fmac_f32 v89, v149, v130
    v_mfma_f32_16x16x32_bf16 v[116:119], v[12:15], a[52:55], v[116:119]
    v_fmac_f32 v90, v150, v130
    v_fmac_f32 v91, v151, v130
    v_mfma_f32_16x16x32_bf16 v[120:123], v[12:15], a[56:59], v[120:123]
    v_mul_f32 v72, v72, v134
    v_mul_f32 v73, v73, v134
    v_mfma_f32_16x16x32_bf16 v[124:127], v[12:15], a[60:63], v[124:127]
    v_mul_f32 v74, v74, v134
    v_mul_f32 v75, v75, v134
    s_waitcnt lgkmcnt(3)
    v_mfma_f32_16x16x32_bf16 v[96:99], v[16:19], a[64:67], v[96:99]
    ds_read_b128 v[8:11], v4 offset:12288
    v_mul_f32 v72, v72, v88
    v_mfma_f32_16x16x32_bf16 v[100:103], v[16:19], a[68:71], v[100:103]
    v_mul_f32 v73, v73, v89
    v_mul_f32 v74, v74, v90
    v_mfma_f32_16x16x32_bf16 v[104:107], v[16:19], a[72:75], v[104:107]
    v_mul_f32 v75, v75, v91
    v_cvt_pk_bf16_f32 v216, v72, v73
    v_mfma_f32_16x16x32_bf16 v[108:111], v[16:19], a[76:79], v[108:111]
    v_cvt_pk_bf16_f32 v217, v74, v75
    v_fmac_f32 v76, v144, v131
    s_waitcnt lgkmcnt(3)
    v_mfma_f32_16x16x32_bf16 v[112:115], v[20:23], a[64:67], v[112:115]
    ds_read_b128 v[12:15], v4 offset:13312
    v_fmac_f32 v77, v145, v131
    v_mfma_f32_16x16x32_bf16 v[116:119], v[20:23], a[68:71], v[116:119]
    v_fmac_f32 v78, v146, v131
    v_fmac_f32 v79, v147, v131
    v_mfma_f32_16x16x32_bf16 v[120:123], v[20:23], a[72:75], v[120:123]
    v_fmac_f32 v92, v148, v131
    v_fmac_f32 v93, v149, v131
    v_mfma_f32_16x16x32_bf16 v[124:127], v[20:23], a[76:79], v[124:127]
    v_fmac_f32 v94, v150, v131
    v_fmac_f32 v95, v151, v131
    s_waitcnt lgkmcnt(3)
    v_mfma_f32_16x16x32_bf16 v[96:99], v[24:27], a[80:83], v[96:99]
    ds_read_b128 v[16:19], v4 offset:14336
    v_mul_f32 v76, v76, v135
    v_mfma_f32_16x16x32_bf16 v[100:103], v[24:27], a[84:87], v[100:103]
    v_mul_f32 v77, v77, v135
    v_mul_f32 v78, v78, v135
    v_mfma_f32_16x16x32_bf16 v[104:107], v[24:27], a[88:91], v[104:107]
    v_mul_f32 v79, v79, v135
    v_mul_f32 v76, v76, v92
    v_mfma_f32_16x16x32_bf16 v[108:111], v[24:27], a[92:95], v[108:111]
    v_mul_f32 v77, v77, v93
    v_mul_f32 v78, v78, v94
    s_waitcnt lgkmcnt(3)
    v_mfma_f32_16x16x32_bf16 v[112:115], v[28:31], a[80:83], v[112:115]
    ds_read_b128 v[20:23], v4 offset:15360
    v_mul_f32 v79, v79, v95
    v_mfma_f32_16x16x32_bf16 v[116:119], v[28:31], a[84:87], v[116:119]
    v_cvt_pk_bf16_f32 v220, v76, v77
    v_cvt_pk_bf16_f32 v221, v78, v79
    v_mfma_f32_16x16x32_bf16 v[120:123], v[28:31], a[88:91], v[120:123]
    v_mfma_f32_16x16x32_bf16 v[124:127], v[28:31], a[92:95], v[124:127]
    s_waitcnt lgkmcnt(3)
    v_mfma_f32_16x16x32_bf16 v[96:99], v[8:11], a[96:99], v[96:99]
    ds_read_b128 v[24:27], v4 offset:16384
    v_mfma_f32_16x16x32_bf16 v[100:103], v[8:11], a[100:103], v[100:103]
    v_mfma_f32_16x16x32_bf16 v[104:107], v[8:11], a[104:107], v[104:107]
    v_mfma_f32_16x16x32_bf16 v[108:111], v[8:11], a[108:111], v[108:111]
    s_waitcnt lgkmcnt(3)
    v_mfma_f32_16x16x32_bf16 v[112:115], v[12:15], a[96:99], v[112:115]
    ds_read_b128 v[28:31], v4 offset:17408
    v_mfma_f32_16x16x32_bf16 v[116:119], v[12:15], a[100:103], v[116:119]
    v_mfma_f32_16x16x32_bf16 v[120:123], v[12:15], a[104:107], v[120:123]
    v_mfma_f32_16x16x32_bf16 v[124:127], v[12:15], a[108:111], v[124:127]
    s_waitcnt lgkmcnt(3)
    v_mfma_f32_16x16x32_bf16 v[96:99], v[16:19], a[112:115], v[96:99]
    ds_read_b128 v[8:11], v4 offset:18432
    v_mfma_f32_16x16x32_bf16 v[100:103], v[16:19], a[116:119], v[100:103]
    v_mfma_f32_16x16x32_bf16 v[104:107], v[16:19], a[120:123], v[104:107]
    v_mfma_f32_16x16x32_bf16 v[108:111], v[16:19], a[124:127], v[108:111]
    s_waitcnt lgkmcnt(3)
    v_mfma_f32_16x16x32_bf16 v[112:115], v[20:23], a[112:115], v[112:115]
    ds_read_b128 v[12:15], v4 offset:19456
    v_mfma_f32_16x16x32_bf16 v[116:119], v[20:23], a[116:119], v[116:119]
    v_mfma_f32_16x16x32_bf16 v[120:123], v[20:23], a[120:123], v[120:123]
    v_mfma_f32_16x16x32_bf16 v[124:127], v[20:23], a[124:127], v[124:127]
    s_waitcnt lgkmcnt(3)
    v_mfma_f32_16x16x32_bf16 v[96:99], v[24:27], a[128:131], v[96:99]
    ds_read_b128 v[16:19], v4 offset:20480
    v_mfma_f32_16x16x32_bf16 v[100:103], v[24:27], a[132:135], v[100:103]
    v_mfma_f32_16x16x32_bf16 v[104:107], v[24:27], a[136:139], v[104:107]
    v_mfma_f32_16x16x32_bf16 v[108:111], v[24:27], a[140:143], v[108:111]
    s_waitcnt lgkmcnt(3)
    v_mfma_f32_16x16x32_bf16 v[112:115], v[28:31], a[128:131], v[112:115]
    ds_read_b128 v[20:23], v4 offset:21504
    v_mfma_f32_16x16x32_bf16 v[116:119], v[28:31], a[132:135], v[116:119]
    v_mfma_f32_16x16x32_bf16 v[120:123], v[28:31], a[136:139], v[120:123]
    v_mfma_f32_16x16x32_bf16 v[124:127], v[28:31], a[140:143], v[124:127]
    s_waitcnt lgkmcnt(3)
    v_mfma_f32_16x16x32_bf16 v[96:99], v[8:11], a[144:147], v[96:99]
    ds_read_b128 v[24:27], v4 offset:22528
    v_mfma_f32_16x16x32_bf16 v[100:103], v[8:11], a[148:151], v[100:103]
    v_mfma_f32_16x16x32_bf16 v[104:107], v[8:11], a[152:155], v[104:107]
    v_mfma_f32_16x16x32_bf16 v[108:111], v[8:11], a[156:159], v[108:111]
    s_waitcnt lgkmcnt(3)
    v_mfma_f32_16x16x32_bf16 v[112:115], v[12:15], a[144:147], v[112:115]
    ds_read_b128 v[28:31], v4 offset:23552
    v_mfma_f32_16x16x32_bf16 v[116:119], v[12:15], a[148:151], v[116:119]
    v_mfma_f32_16x16x32_bf16 v[120:123], v[12:15], a[152:155], v[120:123]
    v_mfma_f32_16x16x32_bf16 v[124:127], v[12:15], a[156:159], v[124:127]
    v_mov_b32 v6, 1
    v_mov_b32 v7, 0
    s_waitcnt lgkmcnt(3)
    v_mfma_f32_16x16x32_bf16 v[96:99], v[16:19], a[160:163], v[96:99]
    ds_read_b128 v[8:11], v4 offset:24576
    s_waitcnt vmcnt(9)
    v_mfma_f32_16x16x32_bf16 v[100:103], v[16:19], a[164:167], v[100:103]
    s_mov_b64 exec, 1
    buffer_store_dword v6, v7, s[4:7], s67 offen sc1
    s_mov_b64 exec, -1
    v_mfma_f32_16x16x32_bf16 v[104:107], v[16:19], a[168:171], v[104:107]
    v_mfma_f32_16x16x32_bf16 v[108:111], v[16:19], a[172:175], v[108:111]
    s_waitcnt lgkmcnt(3)
    v_mfma_f32_16x16x32_bf16 v[112:115], v[20:23], a[160:163], v[112:115]
    ds_read_b128 v[12:15], v4 offset:25600
    v_mfma_f32_16x16x32_bf16 v[116:119], v[20:23], a[164:167], v[116:119]
    v_mfma_f32_16x16x32_bf16 v[120:123], v[20:23], a[168:171], v[120:123]
    v_mfma_f32_16x16x32_bf16 v[124:127], v[20:23], a[172:175], v[124:127]
    s_waitcnt lgkmcnt(3)
    v_mfma_f32_16x16x32_bf16 v[96:99], v[24:27], a[176:179], v[96:99]
    ds_read_b128 v[16:19], v4 offset:26624
    v_mfma_f32_16x16x32_bf16 v[100:103], v[24:27], a[180:183], v[100:103]
    v_mfma_f32_16x16x32_bf16 v[104:107], v[24:27], a[184:187], v[104:107]
    v_mfma_f32_16x16x32_bf16 v[108:111], v[24:27], a[188:191], v[108:111]
    s_waitcnt lgkmcnt(3)
    v_mfma_f32_16x16x32_bf16 v[112:115], v[28:31], a[176:179], v[112:115]
    ds_read_b128 v[20:23], v4 offset:27648
    v_mfma_f32_16x16x32_bf16 v[116:119], v[28:31], a[180:183], v[116:119]
    v_mfma_f32_16x16x32_bf16 v[120:123], v[28:31], a[184:187], v[120:123]
    v_mfma_f32_16x16x32_bf16 v[124:127], v[28:31], a[188:191], v[124:127]
    s_waitcnt lgkmcnt(3)
    v_mfma_f32_16x16x32_bf16 v[96:99], v[8:11], a[192:195], v[96:99]
    ds_read_b128 v[24:27], v4 offset:28672
    v_mfma_f32_16x16x32_bf16 v[100:103], v[8:11], a[196:199], v[100:103]
    v_mfma_f32_16x16x32_bf16 v[104:107], v[8:11], a[200:203], v[104:107]
    v_mfma_f32_16x16x32_bf16 v[108:111], v[8:11], a[204:207], v[108:111]
    s_waitcnt lgkmcnt(3)
    v_mfma_f32_16x16x32_bf16 v[112:115], v[12:15], a[192:195], v[112:115]
    ds_read_b128 v[28:31], v4 offset:29696
    v_mfma_f32_16x16x32_bf16 v[116:119], v[12:15], a[196:199], v[116:119]
    v_mfma_f32_16x16x32_bf16 v[120:123], v[12:15], a[200:203], v[120:123]
    v_mfma_f32_16x16x32_bf16 v[124:127], v[12:15], a[204:207], v[124:127]
    s_waitcnt lgkmcnt(3)
    v_mfma_f32_16x16x32_bf16 v[96:99], v[16:19], a[208:211], v[96:99]
    ds_read_b128 v[8:11], v4 offset:30720
    v_mfma_f32_16x16x32_bf16 v[100:103], v[16:19], a[212:215], v[100:103]
    v_mfma_f32_16x16x32_bf16 v[104:107], v[16:19], a[216:219], v[104:107]
    v_mfma_f32_16x16x32_bf16 v[108:111], v[16:19], a[220:223], v[108:111]
    s_waitcnt lgkmcnt(3)
    v_mfma_f32_16x16x32_bf16 v[112:115], v[20:23], a[208:211], v[112:115]
    ds_read_b128 v[12:15], v4 offset:31744
    v_mfma_f32_16x16x32_bf16 v[116:119], v[20:23], a[212:215], v[116:119]
    v_mfma_f32_16x16x32_bf16 v[120:123], v[20:23], a[216:219], v[120:123]
    v_mfma_f32_16x16x32_bf16 v[124:127], v[20:23], a[220:223], v[124:127]
    s_waitcnt lgkmcnt(3)
    v_mfma_f32_16x16x32_bf16 v[96:99], v[24:27], a[224:227], v[96:99]
    ds_read_b128 v[16:19], v4 offset:32768
    v_mfma_f32_16x16x32_bf16 v[100:103], v[24:27], a[228:231], v[100:103]
    v_mfma_f32_16x16x32_bf16 v[104:107], v[24:27], a[232:235], v[104:107]
    v_mfma_f32_16x16x32_bf16 v[108:111], v[24:27], a[236:239], v[108:111]
    s_waitcnt lgkmcnt(3)
    v_mfma_f32_16x16x32_bf16 v[112:115], v[28:31], a[224:227], v[112:115]
    ds_read_b128 v[20:23], v4 offset:33792
    v_mfma_f32_16x16x32_bf16 v[116:119], v[28:31], a[228:231], v[116:119]
    v_mfma_f32_16x16x32_bf16 v[120:123], v[28:31], a[232:235], v[120:123]
    v_mfma_f32_16x16x32_bf16 v[124:127], v[28:31], a[236:239], v[124:127]
    s_waitcnt lgkmcnt(3)
    v_mfma_f32_16x16x32_bf16 v[96:99], v[8:11], a[240:243], v[96:99]
    ds_read_b128 v[24:27], v4 offset:34816
    v_mfma_f32_16x16x32_bf16 v[100:103], v[8:11], a[244:247], v[100:103]
    v_mfma_f32_16x16x32_bf16 v[104:107], v[8:11], a[248:251], v[104:107]
    v_mfma_f32_16x16x32_bf16 v[108:111], v[8:11], a[252:255], v[108:111]
    ds_read_b128 v[136:139], v5 offset:768
    ds_read_b128 v[140:143], v5 offset:832
    s_waitcnt lgkmcnt(5)
    v_mfma_f32_16x16x32_bf16 v[112:115], v[12:15], a[240:243], v[112:115]
    ds_read_b128 v[28:31], v4 offset:35840
    v_mfma_f32_16x16x32_bf16 v[116:119], v[12:15], a[244:247], v[116:119]
    v_mfma_f32_16x16x32_bf16 v[120:123], v[12:15], a[248:251], v[120:123]
    v_mfma_f32_16x16x32_bf16 v[124:127], v[12:15], a[252:255], v[124:127]
    s_waitcnt lgkmcnt(5)
    v_mfma_f32_16x16x32_bf16 v[96:99], v[16:19], v[32:35], v[96:99]
    s_barrier
    v_mfma_f32_16x16x32_bf16 v[100:103], v[16:19], v[36:39], v[100:103]
    v_add_u32 v4, 0x9000, v4
    ds_read_b128 v[8:11], v4 offset:0
    v_mfma_f32_16x16x32_bf16 v[104:107], v[16:19], v[40:43], v[104:107]
    s_add_u32 m0, s49, 36864
    s_add_u32 s61, s48, 331776
    v_mfma_f32_16x16x32_bf16 v[108:111], v[16:19], v[44:47], v[108:111]
    buffer_load_dwordx4 v2, s[4:7], s61 offen offset:0 lds
    buffer_load_dwordx4 v2, s[4:7], s61 offen offset:1024 lds
    s_waitcnt lgkmcnt(5)
    v_mfma_f32_16x16x32_bf16 v[112:115], v[20:23], v[32:35], v[112:115]
    ds_read_b128 v[12:15], v4 offset:1024
    buffer_load_dwordx4 v2, s[4:7], s61 offen offset:2048 lds
    v_mfma_f32_16x16x32_bf16 v[116:119], v[20:23], v[36:39], v[116:119]
    buffer_load_dwordx4 v2, s[4:7], s61 offen offset:3072 lds
    s_add_u32 m0, s49, 40960
    v_mfma_f32_16x16x32_bf16 v[120:123], v[20:23], v[40:43], v[120:123]
    s_add_u32 s61, s48, 335872
    buffer_load_dwordx4 v2, s[4:7], s61 offen offset:0 lds
    v_mfma_f32_16x16x32_bf16 v[124:127], v[20:23], v[44:47], v[124:127]
    buffer_load_dwordx4 v2, s[4:7], s61 offen offset:1024 lds
    buffer_load_dwordx4 v2, s[4:7], s61 offen offset:2048 lds
    s_waitcnt lgkmcnt(5)
    v_mfma_f32_16x16x32_bf16 v[96:99], v[24:27], v[48:51], v[96:99]
    ds_read_b128 v[16:19], v4 offset:2048
    buffer_load_dwordx4 v2, s[4:7], s61 offen offset:3072 lds
    v_mfma_f32_16x16x32_bf16 v[100:103], v[24:27], v[52:55], v[100:103]
    s_add_u32 m0, s49, 45056
    s_add_u32 s61, s48, 339968
    v_mfma_f32_16x16x32_bf16 v[104:107], v[24:27], v[56:59], v[104:107]
    buffer_load_dwordx4 v2, s[4:7], s61 offen offset:0 lds
    v_mfma_f32_16x16x32_bf16 v[108:111], v[24:27], v[60:63], v[108:111]
    s_waitcnt lgkmcnt(3)
    v_mfma_f32_16x16x32_bf16 v[112:115], v[28:31], v[48:51], v[112:115]
    ds_read_b128 v[20:23], v4 offset:3072
    v_mfma_f32_16x16x32_bf16 v[116:119], v[28:31], v[52:55], v[116:119]
    v_mfma_f32_16x16x32_bf16 v[120:123], v[28:31], v[56:59], v[120:123]
    v_mfma_f32_16x16x32_bf16 v[124:127], v[28:31], v[60:63], v[124:127]
    s_waitcnt lgkmcnt(3)
    v_mfma_f32_16x16x32_bf16 v[64:67], v[8:11], a[0:3], 0
    ds_read_b128 v[24:27], v4 offset:4096
    v_mfma_f32_16x16x32_bf16 v[68:71], v[8:11], a[4:7], 0
    v_mfma_f32_16x16x32_bf16 v[72:75], v[8:11], a[8:11], 0
    v_mfma_f32_16x16x32_bf16 v[76:79], v[8:11], a[12:15], 0
    s_waitcnt lgkmcnt(3)
    v_mfma_f32_16x16x32_bf16 v[80:83], v[12:15], a[0:3], 0
    ds_read_b128 v[28:31], v4 offset:5120
    v_mfma_f32_16x16x32_bf16 v[84:87], v[12:15], a[4:7], 0
    v_fmac_f32 v96, v136, v128
    v_fmac_f32 v97, v137, v128
    v_mfma_f32_16x16x32_bf16 v[88:91], v[12:15], a[8:11], 0
    v_fmac_f32 v98, v138, v128
    v_fmac_f32 v99, v139, v128
    v_mfma_f32_16x16x32_bf16 v[92:95], v[12:15], a[12:15], 0
    v_fmac_f32 v112, v140, v128
    v_fmac_f32 v113, v141, v128
    s_waitcnt lgkmcnt(3)
    v_mfma_f32_16x16x32_bf16 v[64:67], v[16:19], a[16:19], v[64:67]
    ds_read_b128 v[8:11], v4 offset:6144
    v_fmac_f32 v114, v142, v128
    v_mfma_f32_16x16x32_bf16 v[68:71], v[16:19], a[20:23], v[68:71]
    v_fmac_f32 v115, v143, v128
    v_mul_f32 v96, v96, v132
    v_mfma_f32_16x16x32_bf16 v[72:75], v[16:19], a[24:27], v[72:75]
    v_mul_f32 v97, v97, v132
    v_mul_f32 v98, v98, v132
    v_mfma_f32_16x16x32_bf16 v[76:79], v[16:19], a[28:31], v[76:79]
    v_mul_f32 v99, v99, v132
    v_mul_f32 v96, v96, v112
    s_waitcnt lgkmcnt(3)
    v_mfma_f32_16x16x32_bf16 v[80:83], v[20:23], a[16:19], v[80:83]
    ds_read_b128 v[12:15], v4 offset:7168
    v_mul_f32 v97, v97, v113
    v_mfma_f32_16x16x32_bf16 v[84:87], v[20:23], a[20:23], v[84:87]
    v_mul_f32 v98, v98, v114
    v_mul_f32 v99, v99, v115
    v_mfma_f32_16x16x32_bf16 v[88:91], v[20:23], a[24:27], v[88:91]
    v_cvt_pk_bf16_f32 v210, v96, v97
    v_cvt_pk_bf16_f32 v211, v98, v99
    v_mfma_f32_16x16x32_bf16 v[92:95], v[20:23], a[28:31], v[92:95]
    s_add_u32 s66, s51, 32768
    buffer_store_dwordx4 v[208:211], v2, s[4:7], s66 offen offset:0 sc1
    s_waitcnt lgkmcnt(3)
    v_mfma_f32_16x16x32_bf16 v[64:67], v[24:27], a[32:35], v[64:67]
    ds_read_b128 v[16:19], v4 offset:8192
    v_fmac_f32 v100, v136, v129
    v_mfma_f32_16x16x32_bf16 v[68:71], v[24:27], a[36:39], v[68:71]
    v_fmac_f32 v101, v137, v129
    v_fmac_f32 v102, v138, v129
    v_mfma_f32_16x16x32_bf16 v[72:75], v[24:27], a[40:43], v[72:75]
    v_fmac_f32 v103, v139, v129
    v_fmac_f32 v116, v140, v129
    v_mfma_f32_16x16x32_bf16 v[76:79], v[24:27], a[44:47], v[76:79]
    v_fmac_f32 v117, v141, v129
    v_fmac_f32 v118, v142, v129
    s_waitcnt lgkmcnt(3)
    v_mfma_f32_16x16x32_bf16 v[80:83], v[28:31], a[32:35], v[80:83]
    ds_read_b128 v[20:23], v4 offset:9216
    v_fmac_f32 v119, v143, v129
    v_mfma_f32_16x16x32_bf16 v[84:87], v[28:31], a[36:39], v[84:87]
    v_mul_f32 v100, v100, v133
    v_mul_f32 v101, v101, v133
    v_mfma_f32_16x16x32_bf16 v[88:91], v[28:31], a[40:43], v[88:91]
    v_mul_f32 v102, v102, v133
    v_mul_f32 v103, v103, v133
    v_mfma_f32_16x16x32_bf16 v[92:95], v[28:31], a[44:47], v[92:95]
    v_mul_f32 v100, v100, v116
    v_mul_f32 v101, v101, v117
    s_waitcnt lgkmcnt(3)
    v_mfma_f32_16x16x32_bf16 v[64:67], v[8:11], a[48:51], v[64:67]
    ds_read_b128 v[24:27], v4 offset:10240
    v_mul_f32 v102, v102, v118
    v_mfma_f32_16x16x32_bf16 v[68:71], v[8:11], a[52:55], v[68:71]
    v_mul_f32 v103, v103, v119
    v_cvt_pk_bf16_f32 v214, v100, v101
    v_mfma_f32_16x16x32_bf16 v[72:75], v[8:11], a[56:59], v[72:75]
    v_cvt_pk_bf16_f32 v215, v102, v103
    buffer_store_dwordx4 v[212:215], v2, s[4:7], s66 offen offset:1024 sc1
    v_mfma_f32_16x16x32_bf16 v[76:79], v[8:11], a[60:63], v[76:79]
    v_fmac_f32 v104, v136, v130
    v_fmac_f32 v105, v137, v130
    s_waitcnt lgkmcnt(3)
    v_mfma_f32_16x16x32_bf16 v[80:83], v[12:15], a[48:51], v[80:83]
    ds_read_b128 v[28:31], v4 offset:11264
    v_fmac_f32 v106, v138, v130
    v_mfma_f32_16x16x32_bf16 v[84:87], v[12:15], a[52:55], v[84:87]
    v_fmac_f32 v107, v139, v130
    v_fmac_f32 v120, v140, v130
    v_mfma_f32_16x16x32_bf16 v[88:91], v[12:15], a[56:59], v[88:91]
    v_fmac_f32 v121, v141, v130
    v_fmac_f32 v122, v142, v130
    v_mfma_f32_16x16x32_bf16 v[92:95], v[12:15], a[60:63], v[92:95]
    v_fmac_f32 v123, v143, v130
    v_mul_f32 v104, v104, v134
    s_waitcnt lgkmcnt(3)
    v_mfma_f32_16x16x32_bf16 v[64:67], v[16:19], a[64:67], v[64:67]
    ds_read_b128 v[8:11], v4 offset:12288
    v_mul_f32 v105, v105, v134
    v_mfma_f32_16x16x32_bf16 v[68:71], v[16:19], a[68:71], v[68:71]
    v_mul_f32 v106, v106, v134
    v_mul_f32 v107, v107, v134
    v_mfma_f32_16x16x32_bf16 v[72:75], v[16:19], a[72:75], v[72:75]
    v_mul_f32 v104, v104, v120
    v_mul_f32 v105, v105, v121
    v_mfma_f32_16x16x32_bf16 v[76:79], v[16:19], a[76:79], v[76:79]
    v_mul_f32 v106, v106, v122
    v_mul_f32 v107, v107, v123
    s_waitcnt lgkmcnt(3)
    v_mfma_f32_16x16x32_bf16 v[80:83], v[20:23], a[64:67], v[80:83]
    ds_read_b128 v[12:15], v4 offset:13312
    v_cvt_pk_bf16_f32 v218, v104, v105
    v_mfma_f32_16x16x32_bf16 v[84:87], v[20:23], a[68:71], v[84:87]
    v_cvt_pk_bf16_f32 v219, v106, v107
    buffer_store_dwordx4 v[216:219], v2, s[4:7], s66 offen offset:2048 sc1
    v_mfma_f32_16x16x32_bf16 v[88:91], v[20:23], a[72:75], v[88:91]
    v_fmac_f32 v108, v136, v131
    v_fmac_f32 v109, v137, v131
    v_mfma_f32_16x16x32_bf16 v[92:95], v[20:23], a[76:79], v[92:95]
    v_fmac_f32 v110, v138, v131
    v_fmac_f32 v111, v139, v131
    s_waitcnt lgkmcnt(3)
    v_mfma_f32_16x16x32_bf16 v[64:67], v[24:27], a[80:83], v[64:67]
    ds_read_b128 v[16:19], v4 offset:14336
    v_fmac_f32 v124, v140, v131
    v_mfma_f32_16x16x32_bf16 v[68:71], v[24:27], a[84:87], v[68:71]
    v_fmac_f32 v125, v141, v131
    v_fmac_f32 v126, v142, v131
    v_mfma_f32_16x16x32_bf16 v[72:75], v[24:27], a[88:91], v[72:75]
    v_fmac_f32 v127, v143, v131
    v_mul_f32 v108, v108, v135
    v_mfma_f32_16x16x32_bf16 v[76:79], v[24:27], a[92:95], v[76:79]
    v_mul_f32 v109, v109, v135
    v_mul_f32 v110, v110, v135
    s_waitcnt lgkmcnt(3)
    v_mfma_f32_16x16x32_bf16 v[80:83], v[28:31], a[80:83], v[80:83]
    ds_read_b128 v[20:23], v4 offset:15360
    v_mul_f32 v111, v111, v135
    v_mfma_f32_16x16x32_bf16 v[84:87], v[28:31], a[84:87], v[84:87]
    v_mul_f32 v108, v108, v124
    v_mul_f32 v109, v109, v125
    v_mfma_f32_16x16x32_bf16 v[88:91], v[28:31], a[88:91], v[88:91]
    v_mul_f32 v110, v110, v126
    v_mul_f32 v111, v111, v127
    v_mfma_f32_16x16x32_bf16 v[92:95], v[28:31], a[92:95], v[92:95]
    v_cvt_pk_bf16_f32 v222, v108, v109
    v_cvt_pk_bf16_f32 v223, v110, v111
    s_waitcnt lgkmcnt(3)
    v_mfma_f32_16x16x32_bf16 v[64:67], v[8:11], a[96:99], v[64:67]
    ds_read_b128 v[24:27], v4 offset:16384
    buffer_store_dwordx4 v[220:223], v2, s[4:7], s66 offen offset:3072 sc1
    v_mfma_f32_16x16x32_bf16 v[68:71], v[8:11], a[100:103], v[68:71]
    v_mfma_f32_16x16x32_bf16 v[72:75], v[8:11], a[104:107], v[72:75]
    v_mfma_f32_16x16x32_bf16 v[76:79], v[8:11], a[108:111], v[76:79]
    s_waitcnt lgkmcnt(3)
    v_mfma_f32_16x16x32_bf16 v[80:83], v[12:15], a[96:99], v[80:83]
    ds_read_b128 v[28:31], v4 offset:17408
    v_mfma_f32_16x16x32_bf16 v[84:87], v[12:15], a[100:103], v[84:87]
    v_mfma_f32_16x16x32_bf16 v[88:91], v[12:15], a[104:107], v[88:91]
    v_mfma_f32_16x16x32_bf16 v[92:95], v[12:15], a[108:111], v[92:95]
    s_waitcnt lgkmcnt(3)
    v_mfma_f32_16x16x32_bf16 v[64:67], v[16:19], a[112:115], v[64:67]
    ds_read_b128 v[8:11], v4 offset:18432
    v_mfma_f32_16x16x32_bf16 v[68:71], v[16:19], a[116:119], v[68:71]
    v_mfma_f32_16x16x32_bf16 v[72:75], v[16:19], a[120:123], v[72:75]
    v_mfma_f32_16x16x32_bf16 v[76:79], v[16:19], a[124:127], v[76:79]
    s_waitcnt lgkmcnt(3)
    v_mfma_f32_16x16x32_bf16 v[80:83], v[20:23], a[112:115], v[80:83]
    ds_read_b128 v[12:15], v4 offset:19456
    v_mfma_f32_16x16x32_bf16 v[84:87], v[20:23], a[116:119], v[84:87]
    v_mfma_f32_16x16x32_bf16 v[88:91], v[20:23], a[120:123], v[88:91]
    v_mfma_f32_16x16x32_bf16 v[92:95], v[20:23], a[124:127], v[92:95]
    s_waitcnt lgkmcnt(3)
    v_mfma_f32_16x16x32_bf16 v[64:67], v[24:27], a[128:131], v[64:67]
    ds_read_b128 v[16:19], v4 offset:20480
    v_mfma_f32_16x16x32_bf16 v[68:71], v[24:27], a[132:135], v[68:71]
    v_mfma_f32_16x16x32_bf16 v[72:75], v[24:27], a[136:139], v[72:75]
    v_mfma_f32_16x16x32_bf16 v[76:79], v[24:27], a[140:143], v[76:79]
    s_waitcnt lgkmcnt(3)
    v_mfma_f32_16x16x32_bf16 v[80:83], v[28:31], a[128:131], v[80:83]
    ds_read_b128 v[20:23], v4 offset:21504
    v_mfma_f32_16x16x32_bf16 v[84:87], v[28:31], a[132:135], v[84:87]
    v_mfma_f32_16x16x32_bf16 v[88:91], v[28:31], a[136:139], v[88:91]
    v_mfma_f32_16x16x32_bf16 v[92:95], v[28:31], a[140:143], v[92:95]
    s_waitcnt lgkmcnt(3)
    v_mfma_f32_16x16x32_bf16 v[64:67], v[8:11], a[144:147], v[64:67]
    ds_read_b128 v[24:27], v4 offset:22528
    v_mfma_f32_16x16x32_bf16 v[68:71], v[8:11], a[148:151], v[68:71]
    v_mfma_f32_16x16x32_bf16 v[72:75], v[8:11], a[152:155], v[72:75]
    v_mfma_f32_16x16x32_bf16 v[76:79], v[8:11], a[156:159], v[76:79]
    s_waitcnt lgkmcnt(3)
    v_mfma_f32_16x16x32_bf16 v[80:83], v[12:15], a[144:147], v[80:83]
    ds_read_b128 v[28:31], v4 offset:23552
    v_mfma_f32_16x16x32_bf16 v[84:87], v[12:15], a[148:151], v[84:87]
    v_mfma_f32_16x16x32_bf16 v[88:91], v[12:15], a[152:155], v[88:91]
    v_mfma_f32_16x16x32_bf16 v[92:95], v[12:15], a[156:159], v[92:95]
    s_waitcnt lgkmcnt(3)
    v_mfma_f32_16x16x32_bf16 v[64:67], v[16:19], a[160:163], v[64:67]
    ds_read_b128 v[8:11], v4 offset:24576
    v_mfma_f32_16x16x32_bf16 v[68:71], v[16:19], a[164:167], v[68:71]
    v_and_b32 v7, 3, v1
    v_mfma_f32_16x16x32_bf16 v[72:75], v[16:19], a[168:171], v[72:75]
    v_lshlrev_b32 v7, 2, v7
    v_mfma_f32_16x16x32_bf16 v[76:79], v[16:19], a[172:175], v[76:79]
    buffer_load_dword v6, v7, s[4:7], s52 offen sc1
    s_waitcnt lgkmcnt(3)
    v_mfma_f32_16x16x32_bf16 v[80:83], v[20:23], a[160:163], v[80:83]
    ds_read_b128 v[12:15], v4 offset:25600
    v_mfma_f32_16x16x32_bf16 v[84:87], v[20:23], a[164:167], v[84:87]
    v_mfma_f32_16x16x32_bf16 v[88:91], v[20:23], a[168:171], v[88:91]
    v_mfma_f32_16x16x32_bf16 v[92:95], v[20:23], a[172:175], v[92:95]
    s_waitcnt lgkmcnt(3)
    v_mfma_f32_16x16x32_bf16 v[64:67], v[24:27], a[176:179], v[64:67]
    ds_read_b128 v[16:19], v4 offset:26624
    v_mfma_f32_16x16x32_bf16 v[68:71], v[24:27], a[180:183], v[68:71]
    v_mfma_f32_16x16x32_bf16 v[72:75], v[24:27], a[184:187], v[72:75]
    v_mfma_f32_16x16x32_bf16 v[76:79], v[24:27], a[188:191], v[76:79]
    s_waitcnt lgkmcnt(3)
    v_mfma_f32_16x16x32_bf16 v[80:83], v[28:31], a[176:179], v[80:83]
    ds_read_b128 v[20:23], v4 offset:27648
    v_mfma_f32_16x16x32_bf16 v[84:87], v[28:31], a[180:183], v[84:87]
    v_mfma_f32_16x16x32_bf16 v[88:91], v[28:31], a[184:187], v[88:91]
    v_mfma_f32_16x16x32_bf16 v[92:95], v[28:31], a[188:191], v[92:95]
    s_waitcnt lgkmcnt(3)
    v_mfma_f32_16x16x32_bf16 v[64:67], v[8:11], a[192:195], v[64:67]
    ds_read_b128 v[24:27], v4 offset:28672
    v_mfma_f32_16x16x32_bf16 v[68:71], v[8:11], a[196:199], v[68:71]
    v_mfma_f32_16x16x32_bf16 v[72:75], v[8:11], a[200:203], v[72:75]
    v_mfma_f32_16x16x32_bf16 v[76:79], v[8:11], a[204:207], v[76:79]
    s_waitcnt lgkmcnt(3)
    v_mfma_f32_16x16x32_bf16 v[80:83], v[12:15], a[192:195], v[80:83]
    ds_read_b128 v[28:31], v4 offset:29696
    v_mfma_f32_16x16x32_bf16 v[84:87], v[12:15], a[196:199], v[84:87]
    v_mfma_f32_16x16x32_bf16 v[88:91], v[12:15], a[200:203], v[88:91]
    v_mfma_f32_16x16x32_bf16 v[92:95], v[12:15], a[204:207], v[92:95]
    s_waitcnt lgkmcnt(3)
    v_mfma_f32_16x16x32_bf16 v[64:67], v[16:19], a[208:211], v[64:67]
    ds_read_b128 v[8:11], v4 offset:30720
    v_mfma_f32_16x16x32_bf16 v[68:71], v[16:19], a[212:215], v[68:71]
    v_mfma_f32_16x16x32_bf16 v[72:75], v[16:19], a[216:219], v[72:75]
    v_mfma_f32_16x16x32_bf16 v[76:79], v[16:19], a[220:223], v[76:79]
    s_waitcnt lgkmcnt(3)
    v_mfma_f32_16x16x32_bf16 v[80:83], v[20:23], a[208:211], v[80:83]
    ds_read_b128 v[12:15], v4 offset:31744
    v_mfma_f32_16x16x32_bf16 v[84:87], v[20:23], a[212:215], v[84:87]
    v_mfma_f32_16x16x32_bf16 v[88:91], v[20:23], a[216:219], v[88:91]
    v_mfma_f32_16x16x32_bf16 v[92:95], v[20:23], a[220:223], v[92:95]
    s_waitcnt lgkmcnt(3)
    v_mfma_f32_16x16x32_bf16 v[64:67], v[24:27], a[224:227], v[64:67]
    ds_read_b128 v[16:19], v4 offset:32768
    v_mfma_f32_16x16x32_bf16 v[68:71], v[24:27], a[228:231], v[68:71]
    v_mfma_f32_16x16x32_bf16 v[72:75], v[24:27], a[232:235], v[72:75]
    v_mfma_f32_16x16x32_bf16 v[76:79], v[24:27], a[236:239], v[76:79]
    s_waitcnt lgkmcnt(3)
    v_mfma_f32_16x16x32_bf16 v[80:83], v[28:31], a[224:227], v[80:83]
    ds_read_b128 v[20:23], v4 offset:33792
    v_mfma_f32_16x16x32_bf16 v[84:87], v[28:31], a[228:231], v[84:87]
    v_mfma_f32_16x16x32_bf16 v[88:91], v[28:31], a[232:235], v[88:91]
    v_mfma_f32_16x16x32_bf16 v[92:95], v[28:31], a[236:239], v[92:95]
    s_waitcnt lgkmcnt(3)
    v_mfma_f32_16x16x32_bf16 v[64:67], v[8:11], a[240:243], v[64:67]
    ds_read_b128 v[24:27], v4 offset:34816
    v_mfma_f32_16x16x32_bf16 v[68:71], v[8:11], a[244:247], v[68:71]
    v_mfma_f32_16x16x32_bf16 v[72:75], v[8:11], a[248:251], v[72:75]
    v_mfma_f32_16x16x32_bf16 v[76:79], v[8:11], a[252:255], v[76:79]
    ds_read_b128 v[144:147], v5 offset:896
    ds_read_b128 v[148:151], v5 offset:960
    s_waitcnt lgkmcnt(5)
    v_mfma_f32_16x16x32_bf16 v[80:83], v[12:15], a[240:243], v[80:83]
    ds_read_b128 v[28:31], v4 offset:35840
    v_mfma_f32_16x16x32_bf16 v[84:87], v[12:15], a[244:247], v[84:87]
    v_mfma_f32_16x16x32_bf16 v[88:91], v[12:15], a[248:251], v[88:91]
    v_mfma_f32_16x16x32_bf16 v[92:95], v[12:15], a[252:255], v[92:95]
    s_waitcnt lgkmcnt(5)
    v_mfma_f32_16x16x32_bf16 v[64:67], v[16:19], v[32:35], v[64:67]
    s_waitcnt vmcnt(15)
    s_barrier
    v_mfma_f32_16x16x32_bf16 v[68:71], v[16:19], v[36:39], v[68:71]
    v_add_u32 v4, 0xfffe5000, v4
    ds_read_b128 v[8:11], v4 offset:0
    v_mfma_f32_16x16x32_bf16 v[72:75], v[16:19], v[40:43], v[72:75]
    s_add_u32 m0, s49, 73728
    s_add_u32 s61, s48, 368640
    v_mfma_f32_16x16x32_bf16 v[76:79], v[16:19], v[44:47], v[76:79]
    buffer_load_dwordx4 v2, s[4:7], s61 offen offset:0 lds
    buffer_load_dwordx4 v2, s[4:7], s61 offen offset:1024 lds
    s_waitcnt lgkmcnt(5)
    v_mfma_f32_16x16x32_bf16 v[80:83], v[20:23], v[32:35], v[80:83]
    ds_read_b128 v[12:15], v4 offset:1024
    buffer_load_dwordx4 v2, s[4:7], s61 offen offset:2048 lds
    v_mfma_f32_16x16x32_bf16 v[84:87], v[20:23], v[36:39], v[84:87]
    buffer_load_dwordx4 v2, s[4:7], s61 offen offset:3072 lds
    s_add_u32 m0, s49, 77824
    v_mfma_f32_16x16x32_bf16 v[88:91], v[20:23], v[40:43], v[88:91]
    s_add_u32 s61, s48, 372736
    buffer_load_dwordx4 v2, s[4:7], s61 offen offset:0 lds
    v_mfma_f32_16x16x32_bf16 v[92:95], v[20:23], v[44:47], v[92:95]
    buffer_load_dwordx4 v2, s[4:7], s61 offen offset:1024 lds
    buffer_load_dwordx4 v2, s[4:7], s61 offen offset:2048 lds
    s_waitcnt lgkmcnt(5)
    v_mfma_f32_16x16x32_bf16 v[64:67], v[24:27], v[48:51], v[64:67]
    ds_read_b128 v[16:19], v4 offset:2048
    buffer_load_dwordx4 v2, s[4:7], s61 offen offset:3072 lds
    v_mfma_f32_16x16x32_bf16 v[68:71], v[24:27], v[52:55], v[68:71]
    s_add_u32 m0, s49, 81920
    s_add_u32 s61, s48, 376832
    v_mfma_f32_16x16x32_bf16 v[72:75], v[24:27], v[56:59], v[72:75]
    buffer_load_dwordx4 v2, s[4:7], s61 offen offset:0 lds
    v_mfma_f32_16x16x32_bf16 v[76:79], v[24:27], v[60:63], v[76:79]
    s_waitcnt vmcnt(9)
    v_cmp_le_u32 vcc, 1, v6
    s_nop 0
    s_cmp_eq_u64 vcc, exec
    s_cbranch_scc0 L_pa_slow_34
L_pa_back_35:
    s_waitcnt lgkmcnt(3)
    v_mfma_f32_16x16x32_bf16 v[80:83], v[28:31], v[48:51], v[80:83]
    ds_read_b128 v[20:23], v4 offset:3072
    v_mfma_f32_16x16x32_bf16 v[84:87], v[28:31], v[52:55], v[84:87]
    v_mfma_f32_16x16x32_bf16 v[88:91], v[28:31], v[56:59], v[88:91]
    v_mfma_f32_16x16x32_bf16 v[92:95], v[28:31], v[60:63], v[92:95]
    s_add_u32 s60, s56, s65
    buffer_load_dwordx2 v[242:243], v3, s[4:7], s60 offen offset:0 sc1
    s_waitcnt lgkmcnt(3)
    v_mfma_f32_16x16x32_bf16 v[96:99], v[8:11], a[0:3], 0
    ds_read_b128 v[24:27], v4 offset:4096
    buffer_load_dwordx2 v[246:247], v3, s[4:7], s60 offen offset:512 sc1
    v_mfma_f32_16x16x32_bf16 v[100:103], v[8:11], a[4:7], 0
    buffer_load_dwordx2 v[250:251], v3, s[4:7], s60 offen offset:1024 sc1
    buffer_load_dwordx2 v[254:255], v3, s[4:7], s60 offen offset:1536 sc1
    v_mfma_f32_16x16x32_bf16 v[104:107], v[8:11], a[8:11], 0
    v_mfma_f32_16x16x32_bf16 v[108:111], v[8:11], a[12:15], 0
    s_waitcnt lgkmcnt(3)
    v_mfma_f32_16x16x32_bf16 v[112:115], v[12:15], a[0:3], 0
    ds_read_b128 v[28:31], v4 offset:5120
    v_mfma_f32_16x16x32_bf16 v[116:119], v[12:15], a[4:7], 0
    v_fmac_f32 v64, v144, v128
    v_fmac_f32 v65, v145, v128
    v_mfma_f32_16x16x32_bf16 v[120:123], v[12:15], a[8:11], 0
    v_fmac_f32 v66, v146, v128
    v_fmac_f32 v67, v147, v128
    v_mfma_f32_16x16x32_bf16 v[124:127], v[12:15], a[12:15], 0
    s_add_u32 s60, s57, s65
    buffer_load_dwordx2 a[0:1], v3, s[4:7], s60 offen offset:0 sc1
    s_waitcnt lgkmcnt(3)
    v_mfma_f32_16x16x32_bf16 v[96:99], v[16:19], a[16:19], v[96:99]
    ds_read_b128 v[8:11], v4 offset:6144
    buffer_load_dwordx2 a[4:5], v3, s[4:7], s60 offen offset:512 sc1
    v_mfma_f32_16x16x32_bf16 v[100:103], v[16:19], a[20:23], v[100:103]
    buffer_load_dwordx2 a[8:9], v3, s[4:7], s60 offen offset:1024 sc1
    buffer_load_dwordx2 a[12:13], v3, s[4:7], s60 offen offset:1536 sc1
    v_mfma_f32_16x16x32_bf16 v[104:107], v[16:19], a[24:27], v[104:107]
    s_add_u32 s60, s58, s65
    buffer_load_dwordx2 a[2:3], v3, s[4:7], s60 offen offset:0 sc1
    v_mfma_f32_16x16x32_bf16 v[108:111], v[16:19], a[28:31], v[108:111]
    buffer_load_dwordx2 a[6:7], v3, s[4:7], s60 offen offset:512 sc1
    buffer_load_dwordx2 a[10:11], v3, s[4:7], s60 offen offset:1024 sc1
    s_waitcnt lgkmcnt(3)
    v_mfma_f32_16x16x32_bf16 v[112:115], v[20:23], a[16:19], v[112:115]
    ds_read_b128 v[12:15], v4 offset:7168
    buffer_load_dwordx2 a[14:15], v3, s[4:7], s60 offen offset:1536 sc1
    v_mfma_f32_16x16x32_bf16 v[116:119], v[20:23], a[20:23], v[116:119]
    v_fmac_f32 v80, v148, v128
    v_fmac_f32 v81, v149, v128
    v_mfma_f32_16x16x32_bf16 v[120:123], v[20:23], a[24:27], v[120:123]
    v_fmac_f32 v82, v150, v128
    v_fmac_f32 v83, v151, v128
    v_mfma_f32_16x16x32_bf16 v[124:127], v[20:23], a[28:31], v[124:127]
    s_add_u32 s60, s56, 0
    buffer_load_dwordx4 a[16:19], v2, s[4:7], s60 offen offset:0 sc1
    s_waitcnt lgkmcnt(3)
    v_mfma_f32_16x16x32_bf16 v[96:99], v[24:27], a[32:35], v[96:99]
    ds_read_b128 v[16:19], v4 offset:8192
    buffer_load_dwordx4 a[20:23], v2, s[4:7], s60 offen offset:1024 sc1
    v_mfma_f32_16x16x32_bf16 v[100:103], v[24:27], a[36:39], v[100:103]
    buffer_load_dwordx4 a[24:27], v2, s[4:7], s60 offen offset:2048 sc1
    buffer_load_dwordx4 a[28:31], v2, s[4:7], s60 offen offset:3072 sc1
    v_mfma_f32_16x16x32_bf16 v[104:107], v[24:27], a[40:43], v[104:107]
    v_mul_f32 v64, v64, v132
    v_mul_f32 v65, v65, v132
    v_mfma_f32_16x16x32_bf16 v[108:111], v[24:27], a[44:47], v[108:111]
    v_mul_f32 v66, v66, v132
    v_mul_f32 v67, v67, v132
    s_waitcnt lgkmcnt(3)
    v_mfma_f32_16x16x32_bf16 v[112:115], v[28:31], a[32:35], v[112:115]
    ds_read_b128 v[20:23], v4 offset:9216
    v_mul_f32 v64, v64, v80
    v_mfma_f32_16x16x32_bf16 v[116:119], v[28:31], a[36:39], v[116:119]
    v_mul_f32 v65, v65, v81
    v_mul_f32 v66, v66, v82
    v_mfma_f32_16x16x32_bf16 v[120:123], v[28:31], a[40:43], v[120:123]
    v_mul_f32 v67, v67, v83
    v_cvt_pk_bf16_f32 v224, v64, v65
    v_mfma_f32_16x16x32_bf16 v[124:127], v[28:31], a[44:47], v[124:127]
    v_cvt_pk_bf16_f32 v225, v66, v67
    v_fmac_f32 v68, v144, v129
    s_waitcnt lgkmcnt(3)
    v_mfma_f32_16x16x32_bf16 v[96:99], v[8:11], a[48:51], v[96:99]
    ds_read_b128 v[24:27], v4 offset:10240
    v_fmac_f32 v69, v145, v129
    v_mfma_f32_16x16x32_bf16 v[100:103], v[8:11], a[52:55], v[100:103]
    v_fmac_f32 v70, v146, v129
    v_fmac_f32 v71, v147, v129
    v_mfma_f32_16x16x32_bf16 v[104:107], v[8:11], a[56:59], v[104:107]
    v_fmac_f32 v84, v148, v129
    v_fmac_f32 v85, v149, v129
    v_mfma_f32_16x16x32_bf16 v[108:111], v[8:11], a[60:63], v[108:111]
    v_fmac_f32 v86, v150, v129
    v_fmac_f32 v87, v151, v129
    s_waitcnt lgkmcnt(3)
    v_mfma_f32_16x16x32_bf16 v[112:115], v[12:15], a[48:51], v[112:115]
    ds_read_b128 v[28:31], v4 offset:11264
    v_mul_f32 v68, v68, v133
    v_mfma_f32_16x16x32_bf16 v[116:119], v[12:15], a[52:55], v[116:119]
    v_mul_f32 v69, v69, v133
    v_mul_f32 v70, v70, v133
    v_mfma_f32_16x16x32_bf16 v[120:123], v[12:15], a[56:59], v[120:123]
    v_mul_f32 v71, v71, v133
    v_mul_f32 v68, v68, v84
    v_mfma_f32_16x16x32_bf16 v[124:127], v[12:15], a[60:63], v[124:127]
    s_add_u32 s60, s57, 0
    buffer_load_dwordx4 a[32:35], v2, s[4:7], s60 offen offset:0 sc1
    s_waitcnt lgkmcnt(3)
    v_mfma_f32_16x16x32_bf16 v[96:99], v[16:19], a[64:67], v[96:99]
    ds_read_b128 v[8:11], v4 offset:12288
    buffer_load_dwordx4 a[36:39], v2, s[4:7], s60 offen offset:1024 sc1
    v_mfma_f32_16x16x32_bf16 v[100:103], v[16:19], a[68:71], v[100:103]
    buffer_load_dwordx4 a[40:43], v2, s[4:7], s60 offen offset:2048 sc1
    buffer_load_dwordx4 a[44:47], v2, s[4:7], s60 offen offset:3072 sc1
    v_mfma_f32_16x16x32_bf16 v[104:107], v[16:19], a[72:75], v[104:107]
    v_mul_f32 v69, v69, v85
    v_mul_f32 v70, v70, v86
    v_mfma_f32_16x16x32_bf16 v[108:111], v[16:19], a[76:79], v[108:111]
    v_mul_f32 v71, v71, v87
    v_cvt_pk_bf16_f32 v228, v68, v69
    s_waitcnt lgkmcnt(3)
    v_mfma_f32_16x16x32_bf16 v[112:115], v[20:23], a[64:67], v[112:115]
    ds_read_b128 v[12:15], v4 offset:13312
    v_cvt_pk_bf16_f32 v229, v70, v71
    v_mfma_f32_16x16x32_bf16 v[116:119], v[20:23], a[68:71], v[116:119]
    v_fmac_f32 v72, v144, v130
    v_fmac_f32 v73, v145, v130
    v_mfma_f32_16x16x32_bf16 v[120:123], v[20:23], a[72:75], v[120:123]
    v_fmac_f32 v74, v146, v130
    v_fmac_f32 v75, v147, v130
    v_mfma_f32_16x16x32_bf16 v[124:127], v[20:23], a[76:79], v[124:127]
    v_fmac_f32 v88, v148, v130
    v_fmac_f32 v89, v149, v130
    s_waitcnt lgkmcnt(3)
    v_mfma_f32_16x16x32_bf16 v[96:99], v[24:27], a[80:83], v[96:99]
    ds_read_b128 v[16:19], v4 offset:14336
    v_fmac_f32 v90, v150, v130
    v_mfma_f32_16x16x32_bf16 v[100:103], v[24:27], a[84:87], v[100:103]
    v_fmac_f32 v91, v151, v130
    v_mul_f32 v72, v72, v134
    v_mfma_f32_16x16x32_bf16 v[104:107], v[24:27], a[88:91], v[104:107]
    v_mul_f32 v73, v73, v134
    v_mul_f32 v74, v74, v134
    v_mfma_f32_16x16x32_bf16 v[108:111], v[24:27], a[92:95], v[108:111]
    v_mul_f32 v75, v75, v134
    v_mul_f32 v72, v72, v88
    s_waitcnt lgkmcnt(3)
    v_mfma_f32_16x16x32_bf16 v[112:115], v[28:31], a[80:83], v[112:115]
    ds_read_b128 v[20:23], v4 offset:15360
    v_mul_f32 v73, v73, v89
    v_mfma_f32_16x16x32_bf16 v[116:119], v[28:31], a[84:87], v[116:119]
    v_mul_f32 v74, v74, v90
    v_mul_f32 v75, v75, v91
    v_mfma_f32_16x16x32_bf16 v[120:123], v[28:31], a[88:91], v[120:123]
    v_cvt_pk_bf16_f32 v232, v72, v73
    v_cvt_pk_bf16_f32 v233, v74, v75
    v_mfma_f32_16x16x32_bf16 v[124:127], v[28:31], a[92:95], v[124:127]
    s_add_u32 s60, s58, 0
    buffer_load_dwordx4 a[48:51], v2, s[4:7], s60 offen offset:0 sc1
    s_waitcnt lgkmcnt(3)
    v_mfma_f32_16x16x32_bf16 v[96:99], v[8:11], a[96:99], v[96:99]
    ds_read_b128 v[24:27], v4 offset:16384
    buffer_load_dwordx4 a[52:55], v2, s[4:7], s60 offen offset:1024 sc1
    v_mfma_f32_16x16x32_bf16 v[100:103], v[8:11], a[100:103], v[100:103]
    buffer_load_dwordx4 a[56:59], v2, s[4:7], s60 offen offset:2048 sc1
    buffer_load_dwordx4 a[60:63], v2, s[4:7], s60 offen offset:3072 sc1
    v_mfma_f32_16x16x32_bf16 v[104:107], v[8:11], a[104:107], v[104:107]
    v_fmac_f32 v76, v144, v131
    v_fmac_f32 v77, v145, v131
    v_mfma_f32_16x16x32_bf16 v[108:111], v[8:11], a[108:111], v[108:111]
    v_fmac_f32 v78, v146, v131
    v_fmac_f32 v79, v147, v131
    s_waitcnt lgkmcnt(3)
    v_mfma_f32_16x16x32_bf16 v[112:115], v[12:15], a[96:99], v[112:115]
    ds_read_b128 v[28:31], v4 offset:17408
    v_fmac_f32 v92, v148, v131
    v_mfma_f32_16x16x32_bf16 v[116:119], v[12:15], a[100:103], v[116:119]
    v_fmac_f32 v93, v149, v131
    v_fmac_f32 v94, v150, v131
    v_mfma_f32_16x16x32_bf16 v[120:123], v[12:15], a[104:107], v[120:123]
    v_fmac_f32 v95, v151, v131
    v_mul_f32 v76, v76, v135
    v_mfma_f32_16x16x32_bf16 v[124:127], v[12:15], a[108:111], v[124:127]
    v_mul_f32 v77, v77, v135
    v_mul_f32 v78, v78, v135
    s_waitcnt lgkmcnt(3)
    v_mfma_f32_16x16x32_bf16 v[96:99], v[16:19], a[112:115], v[96:99]
    ds_read_b128 v[8:11], v4 offset:18432
    v_mul_f32 v79, v79, v135
    v_mfma_f32_16x16x32_bf16 v[100:103], v[16:19], a[116:119], v[100:103]
    v_mul_f32 v76, v76, v92
    v_mul_f32 v77, v77, v93
    v_mfma_f32_16x16x32_bf16 v[104:107], v[16:19], a[120:123], v[104:107]
    v_mul_f32 v78, v78, v94
    v_mul_f32 v79, v79, v95
    v_mfma_f32_16x16x32_bf16 v[108:111], v[16:19], a[124:127], v[108:111]
    v_cvt_pk_bf16_f32 v236, v76, v77
    v_cvt_pk_bf16_f32 v237, v78, v79
    s_waitcnt lgkmcnt(3)
    v_mfma_f32_16x16x32_bf16 v[112:115], v[20:23], a[112:115], v[112:115]
    ds_read_b128 v[12:15], v4 offset:19456
    v_mfma_f32_16x16x32_bf16 v[116:119], v[20:23], a[116:119], v[116:119]
    v_mfma_f32_16x16x32_bf16 v[120:123], v[20:23], a[120:123], v[120:123]
    v_mfma_f32_16x16x32_bf16 v[124:127], v[20:23], a[124:127], v[124:127]
    s_add_u32 s60, s56, 16384
    buffer_load_dwordx4 a[64:67], v2, s[4:7], s60 offen offset:0 sc1
    s_waitcnt lgkmcnt(3)
    v_mfma_f32_16x16x32_bf16 v[96:99], v[24:27], a[128:131], v[96:99]
    ds_read_b128 v[16:19], v4 offset:20480
    buffer_load_dwordx4 a[68:71], v2, s[4:7], s60 offen offset:1024 sc1
    v_mfma_f32_16x16x32_bf16 v[100:103], v[24:27], a[132:135], v[100:103]
    buffer_load_dwordx4 a[72:75], v2, s[4:7], s60 offen offset:2048 sc1
    buffer_load_dwordx4 a[76:79], v2, s[4:7], s60 offen offset:3072 sc1
    v_mfma_f32_16x16x32_bf16 v[104:107], v[24:27], a[136:139], v[104:107]
    v_mfma_f32_16x16x32_bf16 v[108:111], v[24:27], a[140:143], v[108:111]
    s_waitcnt lgkmcnt(3)
    v_mfma_f32_16x16x32_bf16 v[112:115], v[28:31], a[128:131], v[112:115]
    ds_read_b128 v[20:23], v4 offset:21504
    v_mfma_f32_16x16x32_bf16 v[116:119], v[28:31], a[132:135], v[116:119]
    v_mfma_f32_16x16x32_bf16 v[120:123], v[28:31], a[136:139], v[120:123]
    v_mfma_f32_16x16x32_bf16 v[124:127], v[28:31], a[140:143], v[124:127]
    s_waitcnt lgkmcnt(3)
    v_mfma_f32_16x16x32_bf16 v[96:99], v[8:11], a[144:147], v[96:99]
    ds_read_b128 v[24:27], v4 offset:22528
    v_mfma_f32_16x16x32_bf16 v[100:103], v[8:11], a[148:151], v[100:103]
    v_mfma_f32_16x16x32_bf16 v[104:107], v[8:11], a[152:155], v[104:107]
    v_mfma_f32_16x16x32_bf16 v[108:111], v[8:11], a[156:159], v[108:111]
    s_waitcnt lgkmcnt(3)
    v_mfma_f32_16x16x32_bf16 v[112:115], v[12:15], a[144:147], v[112:115]
    ds_read_b128 v[28:31], v4 offset:23552
    v_mfma_f32_16x16x32_bf16 v[116:119], v[12:15], a[148:151], v[116:119]
    v_mfma_f32_16x16x32_bf16 v[120:123], v[12:15], a[152:155], v[120:123]
    v_mfma_f32_16x16x32_bf16 v[124:127], v[12:15], a[156:159], v[124:127]
    s_add_u32 s60, s57, 16384
    buffer_load_dwordx4 a[80:83], v2, s[4:7], s60 offen offset:0 sc1
    s_waitcnt lgkmcnt(3)
    v_mfma_f32_16x16x32_bf16 v[96:99], v[16:19], a[160:163], v[96:99]
    ds_read_b128 v[8:11], v4 offset:24576
    buffer_load_dwordx4 a[84:87], v2, s[4:7], s60 offen offset:1024 sc1
    v_mfma_f32_16x16x32_bf16 v[100:103], v[16:19], a[164:167], v[100:103]
    buffer_load_dwordx4 a[88:91], v2, s[4:7], s60 offen offset:2048 sc1
    buffer_load_dwordx4 a[92:95], v2, s[4:7], s60 offen offset:3072 sc1
    v_mfma_f32_16x16x32_bf16 v[104:107], v[16:19], a[168:171], v[104:107]
    v_mfma_f32_16x16x32_bf16 v[108:111], v[16:19], a[172:175], v[108:111]
    s_waitcnt lgkmcnt(3)
    v_mfma_f32_16x16x32_bf16 v[112:115], v[20:23], a[160:163], v[112:115]
    ds_read_b128 v[12:15], v4 offset:25600
    v_mfma_f32_16x16x32_bf16 v[116:119], v[20:23], a[164:167], v[116:119]
    v_mfma_f32_16x16x32_bf16 v[120:123], v[20:23], a[168:171], v[120:123]
    v_mfma_f32_16x16x32_bf16 v[124:127], v[20:23], a[172:175], v[124:127]
    s_waitcnt lgkmcnt(3)
    v_mfma_f32_16x16x32_bf16 v[96:99], v[24:27], a[176:179], v[96:99]
    ds_read_b128 v[16:19], v4 offset:26624
    v_mfma_f32_16x16x32_bf16 v[100:103], v[24:27], a[180:183], v[100:103]
    v_mfma_f32_16x16x32_bf16 v[104:107], v[24:27], a[184:187], v[104:107]
    v_mfma_f32_16x16x32_bf16 v[108:111], v[24:27], a[188:191], v[108:111]
    s_waitcnt lgkmcnt(3)
    v_mfma_f32_16x16x32_bf16 v[112:115], v[28:31], a[176:179], v[112:115]
    ds_read_b128 v[20:23], v4 offset:27648
    v_mfma_f32_16x16x32_bf16 v[116:119], v[28:31], a[180:183], v[116:119]
    v_mfma_f32_16x16x32_bf16 v[120:123], v[28:31], a[184:187], v[120:123]
    v_mfma_f32_16x16x32_bf16 v[124:127], v[28:31], a[188:191], v[124:127]
    s_add_u32 s60, s58, 16384
    buffer_load_dwordx4 a[96:99], v2, s[4:7], s60 offen offset:0 sc1
    s_waitcnt lgkmcnt(3)
    v_mfma_f32_16x16x32_bf16 v[96:99], v[8:11], a[192:195], v[96:99]
    ds_read_b128 v[24:27], v4 offset:28672
    buffer_load_dwordx4 a[100:103], v2, s[4:7], s60 offen offset:1024 sc1
    v_mfma_f32_16x16x32_bf16 v[100:103], v[8:11], a[196:199], v[100:103]
    buffer_load_dwordx4 a[104:107], v2, s[4:7], s60 offen offset:2048 sc1
    buffer_load_dwordx4 a[108:111], v2, s[4:7], s60 offen offset:3072 sc1
    v_mfma_f32_16x16x32_bf16 v[104:107], v[8:11], a[200:203], v[104:107]
    v_mfma_f32_16x16x32_bf16 v[108:111], v[8:11], a[204:207], v[108:111]
    s_waitcnt lgkmcnt(3)
    v_mfma_f32_16x16x32_bf16 v[112:115], v[12:15], a[192:195], v[112:115]
    ds_read_b128 v[28:31], v4 offset:29696
    v_mfma_f32_16x16x32_bf16 v[116:119], v[12:15], a[196:199], v[116:119]
    v_mfma_f32_16x16x32_bf16 v[120:123], v[12:15], a[200:203], v[120:123]
    v_mfma_f32_16x16x32_bf16 v[124:127], v[12:15], a[204:207], v[124:127]
    s_waitcnt lgkmcnt(3)
    v_mfma_f32_16x16x32_bf16 v[96:99], v[16:19], a[208:211], v[96:99]
    ds_read_b128 v[8:11], v4 offset:30720
    v_mfma_f32_16x16x32_bf16 v[100:103], v[16:19], a[212:215], v[100:103]
    v_mfma_f32_16x16x32_bf16 v[104:107], v[16:19], a[216:219], v[104:107]
    v_mfma_f32_16x16x32_bf16 v[108:111], v[16:19], a[220:223], v[108:111]
    s_waitcnt lgkmcnt(3)
    v_mfma_f32_16x16x32_bf16 v[112:115], v[20:23], a[208:211], v[112:115]
    ds_read_b128 v[12:15], v4 offset:31744
    v_mfma_f32_16x16x32_bf16 v[116:119], v[20:23], a[212:215], v[116:119]
    v_mfma_f32_16x16x32_bf16 v[120:123], v[20:23], a[216:219], v[120:123]
    v_mfma_f32_16x16x32_bf16 v[124:127], v[20:23], a[220:223], v[124:127]
    s_waitcnt lgkmcnt(3)
    v_mfma_f32_16x16x32_bf16 v[96:99], v[24:27], a[224:227], v[96:99]
    ds_read_b128 v[16:19], v4 offset:32768
    v_mfma_f32_16x16x32_bf16 v[100:103], v[24:27], a[228:231], v[100:103]
    v_mfma_f32_16x16x32_bf16 v[104:107], v[24:27], a[232:235], v[104:107]
    v_mfma_f32_16x16x32_bf16 v[108:111], v[24:27], a[236:239], v[108:111]
    s_waitcnt lgkmcnt(3)
    v_mfma_f32_16x16x32_bf16 v[112:115], v[28:31], a[224:227], v[112:115]
    ds_read_b128 v[20:23], v4 offset:33792
    v_mfma_f32_16x16x32_bf16 v[116:119], v[28:31], a[228:231], v[116:119]
    v_mfma_f32_16x16x32_bf16 v[120:123], v[28:31], a[232:235], v[120:123]
    v_mfma_f32_16x16x32_bf16 v[124:127], v[28:31], a[236:239], v[124:127]
    s_waitcnt lgkmcnt(3)
    v_mfma_f32_16x16x32_bf16 v[96:99], v[8:11], a[240:243], v[96:99]
    ds_read_b128 v[24:27], v4 offset:34816
    v_mfma_f32_16x16x32_bf16 v[100:103], v[8:11], a[244:247], v[100:103]
    v_mfma_f32_16x16x32_bf16 v[104:107], v[8:11], a[248:251], v[104:107]
    v_mfma_f32_16x16x32_bf16 v[108:111], v[8:11], a[252:255], v[108:111]
    ds_read_b128 v[136:139], v5 offset:1024
    ds_read_b128 v[140:143], v5 offset:1088
    s_waitcnt lgkmcnt(5)
    v_mfma_f32_16x16x32_bf16 v[112:115], v[12:15], a[240:243], v[112:115]
    ds_read_b128 v[28:31], v4 offset:35840
    v_mfma_f32_16x16x32_bf16 v[116:119], v[12:15], a[244:247], v[116:119]
    v_mfma_f32_16x16x32_bf16 v[120:123], v[12:15], a[248:251], v[120:123]
    v_mfma_f32_16x16x32_bf16 v[124:127], v[12:15], a[252:255], v[124:127]
    s_waitcnt lgkmcnt(5)
    v_mfma_f32_16x16x32_bf16 v[96:99], v[16:19], v[32:35], v[96:99]
    s_barrier
    v_mfma_f32_16x16x32_bf16 v[100:103], v[16:19], v[36:39], v[100:103]
    v_add_u32 v4, 0x9000, v4
    ds_read_b128 v[8:11], v4 offset:0
    v_mfma_f32_16x16x32_bf16 v[104:107], v[16:19], v[40:43], v[104:107]
    s_add_u32 m0, s49, 110592
    s_add_u32 s61, s48, 405504
    v_mfma_f32_16x16x32_bf16 v[108:111], v[16:19], v[44:47], v[108:111]
    buffer_load_dwordx4 v2, s[4:7], s61 offen offset:0 lds
    buffer_load_dwordx4 v2, s[4:7], s61 offen offset:1024 lds
    s_waitcnt lgkmcnt(5)
    v_mfma_f32_16x16x32_bf16 v[112:115], v[20:23], v[32:35], v[112:115]
    ds_read_b128 v[12:15], v4 offset:1024
    buffer_load_dwordx4 v2, s[4:7], s61 offen offset:2048 lds
    v_mfma_f32_16x16x32_bf16 v[116:119], v[20:23], v[36:39], v[116:119]
    buffer_load_dwordx4 v2, s[4:7], s61 offen offset:3072 lds
    s_add_u32 m0, s49, 114688
    v_mfma_f32_16x16x32_bf16 v[120:123], v[20:23], v[40:43], v[120:123]
    s_add_u32 s61, s48, 409600
    buffer_load_dwordx4 v2, s[4:7], s61 offen offset:0 lds
    v_mfma_f32_16x16x32_bf16 v[124:127], v[20:23], v[44:47], v[124:127]
    buffer_load_dwordx4 v2, s[4:7], s61 offen offset:1024 lds
    buffer_load_dwordx4 v2, s[4:7], s61 offen offset:2048 lds
    s_waitcnt lgkmcnt(5)
    v_mfma_f32_16x16x32_bf16 v[96:99], v[24:27], v[48:51], v[96:99]
    ds_read_b128 v[16:19], v4 offset:2048
    buffer_load_dwordx4 v2, s[4:7], s61 offen offset:3072 lds
    v_mfma_f32_16x16x32_bf16 v[100:103], v[24:27], v[52:55], v[100:103]
    s_add_u32 m0, s49, 118784
    s_add_u32 s61, s48, 413696
    v_mfma_f32_16x16x32_bf16 v[104:107], v[24:27], v[56:59], v[104:107]
    buffer_load_dwordx4 v2, s[4:7], s61 offen offset:0 lds
    v_mfma_f32_16x16x32_bf16 v[108:111], v[24:27], v[60:63], v[108:111]
    s_waitcnt lgkmcnt(3)
    v_mfma_f32_16x16x32_bf16 v[112:115], v[28:31], v[48:51], v[112:115]
    ds_read_b128 v[20:23], v4 offset:3072
    v_mfma_f32_16x16x32_bf16 v[116:119], v[28:31], v[52:55], v[116:119]
    v_mfma_f32_16x16x32_bf16 v[120:123], v[28:31], v[56:59], v[120:123]
    v_mfma_f32_16x16x32_bf16 v[124:127], v[28:31], v[60:63], v[124:127]
    s_waitcnt lgkmcnt(3)
    v_mfma_f32_16x16x32_bf16 v[32:35], v[8:11], v[176:179], 0
    ds_read_b128 v[24:27], v4 offset:4096
    v_mfma_f32_16x16x32_bf16 v[40:43], v[8:11], v[180:183], 0
    v_mfma_f32_16x16x32_bf16 v[48:51], v[8:11], v[184:187], 0
    v_mfma_f32_16x16x32_bf16 v[56:59], v[8:11], v[188:191], 0
    s_waitcnt lgkmcnt(3)
    v_mfma_f32_16x16x32_bf16 v[36:39], v[12:15], v[176:179], 0
    ds_read_b128 v[28:31], v4 offset:5120
    v_mfma_f32_16x16x32_bf16 v[44:47], v[12:15], v[180:183], 0
    v_fmac_f32 v96, v136, v128
    v_fmac_f32 v97, v137, v128
    v_mfma_f32_16x16x32_bf16 v[52:55], v[12:15], v[184:187], 0
    v_fmac_f32 v98, v138, v128
    v_fmac_f32 v99, v139, v128
    v_mfma_f32_16x16x32_bf16 v[60:63], v[12:15], v[188:191], 0
    v_fmac_f32 v112, v140, v128
    v_fmac_f32 v113, v141, v128
    s_waitcnt lgkmcnt(3)
    v_mfma_f32_16x16x32_bf16 v[64:67], v[16:19], v[176:179], 0
    ds_read_b128 v[8:11], v4 offset:6144
    v_fmac_f32 v114, v142, v128
    v_mfma_f32_16x16x32_bf16 v[72:75], v[16:19], v[180:183], 0
    v_fmac_f32 v115, v143, v128
    v_mul_f32 v96, v96, v132
    v_mfma_f32_16x16x32_bf16 v[80:83], v[16:19], v[184:187], 0
    v_mul_f32 v97, v97, v132
    v_mul_f32 v98, v98, v132
    v_mfma_f32_16x16x32_bf16 v[88:91], v[16:19], v[188:191], 0
    v_mul_f32 v99, v99, v132
    v_mul_f32 v96, v96, v112
    s_waitcnt lgkmcnt(3)
    v_mfma_f32_16x16x32_bf16 v[68:71], v[20:23], v[176:179], 0
    ds_read_b128 v[12:15], v4 offset:7168
    v_mul_f32 v97, v97, v113
    v_mfma_f32_16x16x32_bf16 v[76:79], v[20:23], v[180:183], 0
    v_mul_f32 v98, v98, v114
    v_mul_f32 v99, v99, v115
    v_mfma_f32_16x16x32_bf16 v[84:87], v[20:23], v[184:187], 0
    v_cvt_pk_bf16_f32 v226, v96, v97
    v_cvt_pk_bf16_f32 v227, v98, v99
    v_mfma_f32_16x16x32_bf16 v[92:95], v[20:23], v[188:191], 0
    s_add_u32 s66, s51, 49152
    buffer_store_dwordx4 v[224:227], v2, s[4:7], s66 offen offset:0 sc1
    s_waitcnt lgkmcnt(3)
    v_mfma_f32_16x16x32_bf16 v[32:35], v[24:27], v[192:195], v[32:35]
    ds_read_b128 v[16:19], v4 offset:8192
    v_fmac_f32 v100, v136, v129
    v_mfma_f32_16x16x32_bf16 v[40:43], v[24:27], v[196:199], v[40:43]
    v_fmac_f32 v101, v137, v129
    v_fmac_f32 v102, v138, v129
    v_mfma_f32_16x16x32_bf16 v[48:51], v[24:27], v[200:203], v[48:51]
    v_fmac_f32 v103, v139, v129
    v_fmac_f32 v116, v140, v129
    v_mfma_f32_16x16x32_bf16 v[56:59], v[24:27], v[204:207], v[56:59]
    v_fmac_f32 v117, v141, v129
    v_fmac_f32 v118, v142, v129
    s_waitcnt lgkmcnt(3)
    v_mfma_f32_16x16x32_bf16 v[36:39], v[28:31], v[192:195], v[36:39]
    ds_read_b128 v[20:23], v4 offset:9216
    v_fmac_f32 v119, v143, v129
    v_mfma_f32_16x16x32_bf16 v[44:47], v[28:31], v[196:199], v[44:47]
    v_mul_f32 v100, v100, v133
    v_mul_f32 v101, v101, v133
    v_mfma_f32_16x16x32_bf16 v[52:55], v[28:31], v[200:203], v[52:55]
    v_mul_f32 v102, v102, v133
    v_mul_f32 v103, v103, v133
    v_mfma_f32_16x16x32_bf16 v[60:63], v[28:31], v[204:207], v[60:63]
    v_mul_f32 v100, v100, v116
    v_mul_f32 v101, v101, v117
    s_waitcnt lgkmcnt(3)
    v_mfma_f32_16x16x32_bf16 v[64:67], v[8:11], v[192:195], v[64:67]
    ds_read_b128 v[24:27], v4 offset:10240
    v_mul_f32 v102, v102, v118
    v_mfma_f32_16x16x32_bf16 v[72:75], v[8:11], v[196:199], v[72:75]
    v_mul_f32 v103, v103, v119
    v_cvt_pk_bf16_f32 v230, v100, v101
    v_mfma_f32_16x16x32_bf16 v[80:83], v[8:11], v[200:203], v[80:83]
    v_cvt_pk_bf16_f32 v231, v102, v103
    buffer_store_dwordx4 v[228:231], v2, s[4:7], s66 offen offset:1024 sc1
    v_mfma_f32_16x16x32_bf16 v[88:91], v[8:11], v[204:207], v[88:91]
    v_fmac_f32 v104, v136, v130
    v_fmac_f32 v105, v137, v130
    s_waitcnt lgkmcnt(3)
    v_mfma_f32_16x16x32_bf16 v[68:71], v[12:15], v[192:195], v[68:71]
    ds_read_b128 v[28:31], v4 offset:11264
    v_fmac_f32 v106, v138, v130
    v_mfma_f32_16x16x32_bf16 v[76:79], v[12:15], v[196:199], v[76:79]
    v_fmac_f32 v107, v139, v130
    v_fmac_f32 v120, v140, v130
    v_mfma_f32_16x16x32_bf16 v[84:87], v[12:15], v[200:203], v[84:87]
    v_fmac_f32 v121, v141, v130
    v_fmac_f32 v122, v142, v130
    v_mfma_f32_16x16x32_bf16 v[92:95], v[12:15], v[204:207], v[92:95]
    v_fmac_f32 v123, v143, v130
    v_mul_f32 v104, v104, v134
    s_waitcnt lgkmcnt(3)
    v_mfma_f32_16x16x32_bf16 v[32:35], v[16:19], v[208:211], v[32:35]
    ds_read_b128 v[8:11], v4 offset:12288
    v_mul_f32 v105, v105, v134
    v_mfma_f32_16x16x32_bf16 v[40:43], v[16:19], v[212:215], v[40:43]
    v_mul_f32 v106, v106, v134
    v_mul_f32 v107, v107, v134
    v_mfma_f32_16x16x32_bf16 v[48:51], v[16:19], v[216:219], v[48:51]
    v_mul_f32 v104, v104, v120
    v_mul_f32 v105, v105, v121
    v_mfma_f32_16x16x32_bf16 v[56:59], v[16:19], v[220:223], v[56:59]
    v_mul_f32 v106, v106, v122
    v_mul_f32 v107, v107, v123
    s_waitcnt lgkmcnt(3)
    v_mfma_f32_16x16x32_bf16 v[36:39], v[20:23], v[208:211], v[36:39]
    ds_read_b128 v[12:15], v4 offset:13312
    v_cvt_pk_bf16_f32 v234, v104, v105
    v_mfma_f32_16x16x32_bf16 v[44:47], v[20:23], v[212:215], v[44:47]
    v_cvt_pk_bf16_f32 v235, v106, v107
    buffer_store_dwordx4 v[232:235], v2, s[4:7], s66 offen offset:2048 sc1
    v_mfma_f32_16x16x32_bf16 v[52:55], v[20:23], v[216:219], v[52:55]
    v_fmac_f32 v108, v136, v131
    v_fmac_f32 v109, v137, v131
    v_mfma_f32_16x16x32_bf16 v[60:63], v[20:23], v[220:223], v[60:63]
    v_fmac_f32 v110, v138, v131
    v_fmac_f32 v111, v139, v131
    s_waitcnt lgkmcnt(3)
    v_mfma_f32_16x16x32_bf16 v[64:67], v[24:27], v[208:211], v[64:67]
    ds_read_b128 v[16:19], v4 offset:14336
    v_fmac_f32 v124, v140, v131
    v_mfma_f32_16x16x32_bf16 v[72:75], v[24:27], v[212:215], v[72:75]
    v_fmac_f32 v125, v141, v131
    v_fmac_f32 v126, v142, v131
    v_mfma_f32_16x16x32_bf16 v[80:83], v[24:27], v[216:219], v[80:83]
    v_fmac_f32 v127, v143, v131
    v_mul_f32 v108, v108, v135
    v_mfma_f32_16x16x32_bf16 v[88:91], v[24:27], v[220:223], v[88:91]
    v_mul_f32 v109, v109, v135
    v_mul_f32 v110, v110, v135
    s_waitcnt lgkmcnt(3)
    v_mfma_f32_16x16x32_bf16 v[68:71], v[28:31], v[208:211], v[68:71]
    ds_read_b128 v[20:23], v4 offset:15360
    v_mul_f32 v111, v111, v135
    v_mfma_f32_16x16x32_bf16 v[76:79], v[28:31], v[212:215], v[76:79]
    v_mul_f32 v108, v108, v124
    v_mul_f32 v109, v109, v125
    v_mfma_f32_16x16x32_bf16 v[84:87], v[28:31], v[216:219], v[84:87]
    v_mul_f32 v110, v110, v126
    v_mul_f32 v111, v111, v127
    v_mfma_f32_16x16x32_bf16 v[92:95], v[28:31], v[220:223], v[92:95]
    v_cvt_pk_bf16_f32 v238, v108, v109
    v_cvt_pk_bf16_f32 v239, v110, v111
    buffer_store_dwordx4 v[236:239], v2, s[4:7], s66 offen offset:3072 sc1
    s_waitcnt lgkmcnt(3)
    v_mfma_f32_16x16x32_bf16 v[96:99], v[8:11], v[176:179], 0
    ds_read_b128 v[24:27], v4 offset:16384
    v_mfma_f32_16x16x32_bf16 v[104:107], v[8:11], v[180:183], 0
    v_mfma_f32_16x16x32_bf16 v[112:115], v[8:11], v[184:187], 0
    v_mfma_f32_16x16x32_bf16 v[120:123], v[8:11], v[188:191], 0
    s_waitcnt lgkmcnt(3)
    v_mfma_f32_16x16x32_bf16 v[100:103], v[12:15], v[176:179], 0
    ds_read_b128 v[28:31], v4 offset:17408
    v_mfma_f32_16x16x32_bf16 v[108:111], v[12:15], v[180:183], 0
    v_mfma_f32_16x16x32_bf16 v[116:119], v[12:15], v[184:187], 0
    v_mfma_f32_16x16x32_bf16 v[124:127], v[12:15], v[188:191], 0
    s_waitcnt lgkmcnt(3)
    v_mfma_f32_16x16x32_bf16 v[128:131], v[16:19], v[176:179], 0
    ds_read_b128 v[8:11], v4 offset:18432
    v_mfma_f32_16x16x32_bf16 v[136:139], v[16:19], v[180:183], 0
    v_mfma_f32_16x16x32_bf16 v[144:147], v[16:19], v[184:187], 0
    v_mfma_f32_16x16x32_bf16 v[152:155], v[16:19], v[188:191], 0
    s_waitcnt lgkmcnt(3)
    v_mfma_f32_16x16x32_bf16 v[132:135], v[20:23], v[176:179], 0
    ds_read_b128 v[12:15], v4 offset:19456
    v_mfma_f32_16x16x32_bf16 v[140:143], v[20:23], v[180:183], 0
    v_mfma_f32_16x16x32_bf16 v[148:151], v[20:23], v[184:187], 0
    v_mfma_f32_16x16x32_bf16 v[156:159], v[20:23], v[188:191], 0
    s_waitcnt lgkmcnt(3)
    v_mfma_f32_16x16x32_bf16 v[160:163], v[24:27], v[176:179], 0
    ds_read_b128 v[16:19], v4 offset:20480
    v_mfma_f32_16x16x32_bf16 v[164:167], v[24:27], v[180:183], 0
    v_mfma_f32_16x16x32_bf16 v[168:171], v[24:27], v[184:187], 0
    v_mfma_f32_16x16x32_bf16 v[172:175], v[24:27], v[188:191], 0
    s_waitcnt lgkmcnt(3)
    v_mfma_f32_16x16x32_bf16 v[96:99], v[28:31], v[192:195], v[96:99]
    ds_read_b128 v[20:23], v4 offset:21504
    v_mfma_f32_16x16x32_bf16 v[104:107], v[28:31], v[196:199], v[104:107]
    v_mfma_f32_16x16x32_bf16 v[112:115], v[28:31], v[200:203], v[112:115]
    v_mfma_f32_16x16x32_bf16 v[120:123], v[28:31], v[204:207], v[120:123]
    s_waitcnt lgkmcnt(3)
    v_mfma_f32_16x16x32_bf16 v[100:103], v[8:11], v[192:195], v[100:103]
    ds_read_b128 v[24:27], v4 offset:22528
    v_mfma_f32_16x16x32_bf16 v[108:111], v[8:11], v[196:199], v[108:111]
    v_mfma_f32_16x16x32_bf16 v[116:119], v[8:11], v[200:203], v[116:119]
    v_mfma_f32_16x16x32_bf16 v[124:127], v[8:11], v[204:207], v[124:127]
    s_waitcnt lgkmcnt(3)
    v_mfma_f32_16x16x32_bf16 v[128:131], v[12:15], v[192:195], v[128:131]
    ds_read_b128 v[28:31], v4 offset:23552
    v_mfma_f32_16x16x32_bf16 v[136:139], v[12:15], v[196:199], v[136:139]
    v_mfma_f32_16x16x32_bf16 v[144:147], v[12:15], v[200:203], v[144:147]
    v_mfma_f32_16x16x32_bf16 v[152:155], v[12:15], v[204:207], v[152:155]
    s_waitcnt lgkmcnt(3)
    v_mfma_f32_16x16x32_bf16 v[132:135], v[16:19], v[192:195], v[132:135]
    ds_read_b128 v[8:11], v4 offset:24576
    v_mfma_f32_16x16x32_bf16 v[140:143], v[16:19], v[196:199], v[140:143]
    v_mfma_f32_16x16x32_bf16 v[148:151], v[16:19], v[200:203], v[148:151]
    v_mfma_f32_16x16x32_bf16 v[156:159], v[16:19], v[204:207], v[156:159]
    s_waitcnt lgkmcnt(3)
    v_mfma_f32_16x16x32_bf16 v[160:163], v[20:23], v[192:195], v[160:163]
    ds_read_b128 v[12:15], v4 offset:25600
    v_mfma_f32_16x16x32_bf16 v[164:167], v[20:23], v[196:199], v[164:167]
    v_mfma_f32_16x16x32_bf16 v[168:171], v[20:23], v[200:203], v[168:171]
    v_mfma_f32_16x16x32_bf16 v[172:175], v[20:23], v[204:207], v[172:175]
    s_waitcnt lgkmcnt(3)
    v_mfma_f32_16x16x32_bf16 v[96:99], v[24:27], v[208:211], v[96:99]
    ds_read_b128 v[16:19], v4 offset:26624
    v_mfma_f32_16x16x32_bf16 v[104:107], v[24:27], v[212:215], v[104:107]
    v_mfma_f32_16x16x32_bf16 v[112:115], v[24:27], v[216:219], v[112:115]
    v_mfma_f32_16x16x32_bf16 v[120:123], v[24:27], v[220:223], v[120:123]
    s_waitcnt lgkmcnt(3)
    v_mfma_f32_16x16x32_bf16 v[100:103], v[28:31], v[208:211], v[100:103]
    ds_read_b128 v[20:23], v4 offset:27648
    v_mfma_f32_16x16x32_bf16 v[108:111], v[28:31], v[212:215], v[108:111]
    v_mfma_f32_16x16x32_bf16 v[116:119], v[28:31], v[216:219], v[116:119]
    v_mfma_f32_16x16x32_bf16 v[124:127], v[28:31], v[220:223], v[124:127]
    s_waitcnt lgkmcnt(3)
    v_mfma_f32_16x16x32_bf16 v[128:131], v[8:11], v[208:211], v[128:131]
    ds_read_b128 v[24:27], v4 offset:28672
    v_mfma_f32_16x16x32_bf16 v[136:139], v[8:11], v[212:215], v[136:139]
    v_mfma_f32_16x16x32_bf16 v[144:147], v[8:11], v[216:219], v[144:147]
    v_mfma_f32_16x16x32_bf16 v[152:155], v[8:11], v[220:223], v[152:155]
    s_waitcnt lgkmcnt(3)
    v_mfma_f32_16x16x32_bf16 v[132:135], v[12:15], v[208:211], v[132:135]
    ds_read_b128 v[28:31], v4 offset:29696
    v_mfma_f32_16x16x32_bf16 v[140:143], v[12:15], v[212:215], v[140:143]
    v_mfma_f32_16x16x32_bf16 v[148:151], v[12:15], v[216:219], v[148:151]
    v_mfma_f32_16x16x32_bf16 v[156:159], v[12:15], v[220:223], v[156:159]
    s_waitcnt lgkmcnt(3)
    v_mfma_f32_16x16x32_bf16 v[160:163], v[16:19], v[208:211], v[160:163]
    ds_read_b128 v[8:11], v4 offset:30720
    v_mfma_f32_16x16x32_bf16 v[164:167], v[16:19], v[212:215], v[164:167]
    v_mfma_f32_16x16x32_bf16 v[168:171], v[16:19], v[216:219], v[168:171]
    v_mfma_f32_16x16x32_bf16 v[172:175], v[16:19], v[220:223], v[172:175]
    s_waitcnt lgkmcnt(3)
    v_mfma_f32_16x16x32_bf16 v[32:35], v[20:23], v[224:227], v[32:35]
    ds_read_b128 v[12:15], v4 offset:31744
    v_mfma_f32_16x16x32_bf16 v[40:43], v[20:23], v[228:231], v[40:43]
    v_mfma_f32_16x16x32_bf16 v[48:51], v[20:23], v[232:235], v[48:51]
    v_mfma_f32_16x16x32_bf16 v[56:59], v[20:23], v[236:239], v[56:59]
    s_waitcnt lgkmcnt(3)
    v_mfma_f32_16x16x32_bf16 v[36:39], v[24:27], v[224:227], v[36:39]
    ds_read_b128 v[16:19], v4 offset:32768
    v_mfma_f32_16x16x32_bf16 v[44:47], v[24:27], v[228:231], v[44:47]
    v_mfma_f32_16x16x32_bf16 v[52:55], v[24:27], v[232:235], v[52:55]
    v_mfma_f32_16x16x32_bf16 v[60:63], v[24:27], v[236:239], v[60:63]
    s_waitcnt lgkmcnt(3)
    v_mfma_f32_16x16x32_bf16 v[64:67], v[28:31], v[224:227], v[64:67]
    ds_read_b128 v[20:23], v4 offset:33792
    v_mfma_f32_16x16x32_bf16 v[72:75], v[28:31], v[228:231], v[72:75]
    v_mov_b32 v6, 2
    v_mov_b32 v7, 0
    v_mfma_f32_16x16x32_bf16 v[80:83], v[28:31], v[232:235], v[80:83]
    s_waitcnt vmcnt(0)
    v_mfma_f32_16x16x32_bf16 v[88:91], v[28:31], v[236:239], v[88:91]
    s_mov_b64 exec, 1
    buffer_store_dword v6, v7, s[4:7], s67 offen sc1
    s_mov_b64 exec, -1
    s_waitcnt lgkmcnt(3)
    v_mfma_f32_16x16x32_bf16 v[68:71], v[8:11], v[224:227], v[68:71]
    ds_read_b128 v[24:27], v4 offset:34816
    v_mfma_f32_16x16x32_bf16 v[76:79], v[8:11], v[228:231], v[76:79]
    v_mfma_f32_16x16x32_bf16 v[84:87], v[8:11], v[232:235], v[84:87]
    v_mfma_f32_16x16x32_bf16 v[92:95], v[8:11], v[236:239], v[92:95]
    s_waitcnt lgkmcnt(3)
    v_mfma_f32_16x16x32_bf16 v[96:99], v[12:15], v[224:227], v[96:99]
    ds_read_b128 v[28:31], v4 offset:35840
    v_mfma_f32_16x16x32_bf16 v[104:107], v[12:15], v[228:231], v[104:107]
    v_mfma_f32_16x16x32_bf16 v[112:115], v[12:15], v[232:235], v[112:115]
    v_mfma_f32_16x16x32_bf16 v[120:123], v[12:15], v[236:239], v[120:123]
    s_waitcnt lgkmcnt(3)
    v_mfma_f32_16x16x32_bf16 v[100:103], v[16:19], v[224:227], v[100:103]
    s_barrier
    v_mfma_f32_16x16x32_bf16 v[108:111], v[16:19], v[228:231], v[108:111]
    v_add_u32 v4, 0x9000, v4
    ds_read_b128 v[8:11], v4 offset:0
    v_mfma_f32_16x16x32_bf16 v[116:119], v[16:19], v[232:235], v[116:119]
    s_add_u32 m0, s49, 0
    s_add_u32 s61, s48, 442368
    v_mfma_f32_16x16x32_bf16 v[124:127], v[16:19], v[236:239], v[124:127]
    buffer_load_dwordx4 v2, s[4:7], s61 offen offset:0 lds
    buffer_load_dwordx4 v2, s[4:7], s61 offen offset:1024 lds
    s_waitcnt lgkmcnt(3)
    v_mfma_f32_16x16x32_bf16 v[128:131], v[20:23], v[224:227], v[128:131]
    ds_read_b128 v[12:15], v4 offset:1024
    buffer_load_dwordx4 v2, s[4:7], s61 offen offset:2048 lds
    v_mfma_f32_16x16x32_bf16 v[136:139], v[20:23], v[228:231], v[136:139]
    buffer_load_dwordx4 v2, s[4:7], s61 offen offset:3072 lds
    s_add_u32 m0, s49, 4096
    v_mfma_f32_16x16x32_bf16 v[144:147], v[20:23], v[232:235], v[144:147]
    s_add_u32 s61, s48, 446464
    buffer_load_dwordx4 v2, s[4:7], s61 offen offset:0 lds
    v_mfma_f32_16x16x32_bf16 v[152:155], v[20:23], v[236:239], v[152:155]
    buffer_load_dwordx4 v2, s[4:7], s61 offen offset:1024 lds
    buffer_load_dwordx4 v2, s[4:7], s61 offen offset:2048 lds
    s_waitcnt lgkmcnt(3)
    v_mfma_f32_16x16x32_bf16 v[132:135], v[24:27], v[224:227], v[132:135]
    ds_read_b128 v[16:19], v4 offset:2048
    buffer_load_dwordx4 v2, s[4:7], s61 offen offset:3072 lds
    v_mfma_f32_16x16x32_bf16 v[140:143], v[24:27], v[228:231], v[140:143]
    s_add_u32 m0, s49, 8192
    s_add_u32 s61, s48, 450560
    v_mfma_f32_16x16x32_bf16 v[148:151], v[24:27], v[232:235], v[148:151]
    buffer_load_dwordx4 v2, s[4:7], s61 offen offset:0 lds
    v_mfma_f32_16x16x32_bf16 v[156:159], v[24:27], v[236:239], v[156:159]
    s_waitcnt lgkmcnt(3)
    v_mfma_f32_16x16x32_bf16 v[160:163], v[28:31], v[224:227], v[160:163]
    ds_read_b128 v[20:23], v4 offset:3072
    v_mfma_f32_16x16x32_bf16 v[164:167], v[28:31], v[228:231], v[164:167]
    v_mfma_f32_16x16x32_bf16 v[168:171], v[28:31], v[232:235], v[168:171]
    v_mfma_f32_16x16x32_bf16 v[172:175], v[28:31], v[236:239], v[172:175]
    s_waitcnt lgkmcnt(3)
    v_mfma_f32_16x16x32_bf16 v[32:35], v[8:11], v[240:243], v[32:35]
    ds_read_b128 v[24:27], v4 offset:4096
    v_mfma_f32_16x16x32_bf16 v[40:43], v[8:11], v[244:247], v[40:43]
    v_mfma_f32_16x16x32_bf16 v[48:51], v[8:11], v[248:251], v[48:51]
    v_mfma_f32_16x16x32_bf16 v[56:59], v[8:11], v[252:255], v[56:59]
    s_waitcnt lgkmcnt(3)
    v_mfma_f32_16x16x32_bf16 v[36:39], v[12:15], v[240:243], v[36:39]
    ds_read_b128 v[28:31], v4 offset:5120
    v_mfma_f32_16x16x32_bf16 v[44:47], v[12:15], v[244:247], v[44:47]
    v_mfma_f32_16x16x32_bf16 v[52:55], v[12:15], v[248:251], v[52:55]
    v_mfma_f32_16x16x32_bf16 v[60:63], v[12:15], v[252:255], v[60:63]
    s_waitcnt lgkmcnt(3)
    v_mfma_f32_16x16x32_bf16 v[64:67], v[16:19], v[240:243], v[64:67]
    ds_read_b128 v[8:11], v4 offset:6144
    v_mfma_f32_16x16x32_bf16 v[72:75], v[16:19], v[244:247], v[72:75]
    v_mfma_f32_16x16x32_bf16 v[80:83], v[16:19], v[248:251], v[80:83]
    v_mfma_f32_16x16x32_bf16 v[88:91], v[16:19], v[252:255], v[88:91]
    s_waitcnt lgkmcnt(3)
    v_mfma_f32_16x16x32_bf16 v[68:71], v[20:23], v[240:243], v[68:71]
    ds_read_b128 v[12:15], v4 offset:7168
    v_mfma_f32_16x16x32_bf16 v[76:79], v[20:23], v[244:247], v[76:79]
    v_mfma_f32_16x16x32_bf16 v[84:87], v[20:23], v[248:251], v[84:87]
    v_mfma_f32_16x16x32_bf16 v[92:95], v[20:23], v[252:255], v[92:95]
    s_waitcnt lgkmcnt(3)
    v_mfma_f32_16x16x32_bf16 v[96:99], v[24:27], v[240:243], v[96:99]
    ds_read_b128 v[16:19], v4 offset:8192
    v_mfma_f32_16x16x32_bf16 v[104:107], v[24:27], v[244:247], v[104:107]
    v_mfma_f32_16x16x32_bf16 v[112:115], v[24:27], v[248:251], v[112:115]
    v_mfma_f32_16x16x32_bf16 v[120:123], v[24:27], v[252:255], v[120:123]
    s_waitcnt lgkmcnt(3)
    v_mfma_f32_16x16x32_bf16 v[100:103], v[28:31], v[240:243], v[100:103]
    ds_read_b128 v[20:23], v4 offset:9216
    v_mfma_f32_16x16x32_bf16 v[108:111], v[28:31], v[244:247], v[108:111]
    v_mfma_f32_16x16x32_bf16 v[116:119], v[28:31], v[248:251], v[116:119]
    v_mfma_f32_16x16x32_bf16 v[124:127], v[28:31], v[252:255], v[124:127]
    s_waitcnt lgkmcnt(3)
    v_mfma_f32_16x16x32_bf16 v[128:131], v[8:11], v[240:243], v[128:131]
    ds_read_b128 v[24:27], v4 offset:10240
    v_mfma_f32_16x16x32_bf16 v[136:139], v[8:11], v[244:247], v[136:139]
    v_mfma_f32_16x16x32_bf16 v[144:147], v[8:11], v[248:251], v[144:147]
    v_mfma_f32_16x16x32_bf16 v[152:155], v[8:11], v[252:255], v[152:155]
    s_waitcnt lgkmcnt(3)
    v_mfma_f32_16x16x32_bf16 v[132:135], v[12:15], v[240:243], v[132:135]
    ds_read_b128 v[28:31], v4 offset:11264
    v_mfma_f32_16x16x32_bf16 v[140:143], v[12:15], v[244:247], v[140:143]
    v_mfma_f32_16x16x32_bf16 v[148:151], v[12:15], v[248:251], v[148:151]
    v_mfma_f32_16x16x32_bf16 v[156:159], v[12:15], v[252:255], v[156:159]
    s_waitcnt lgkmcnt(3)
    v_mfma_f32_16x16x32_bf16 v[160:163], v[16:19], v[240:243], v[160:163]
    ds_read_b128 v[8:11], v4 offset:12288
    v_mfma_f32_16x16x32_bf16 v[164:167], v[16:19], v[244:247], v[164:167]
    v_mfma_f32_16x16x32_bf16 v[168:171], v[16:19], v[248:251], v[168:171]
    v_mfma_f32_16x16x32_bf16 v[172:175], v[16:19], v[252:255], v[172:175]
    s_waitcnt lgkmcnt(3)
    v_mfma_f32_16x16x32_bf16 v[32:35], v[20:23], a[0:3], v[32:35]
    ds_read_b128 v[12:15], v4 offset:13312
    v_mfma_f32_16x16x32_bf16 v[40:43], v[20:23], a[4:7], v[40:43]
    v_mfma_f32_16x16x32_bf16 v[48:51], v[20:23], a[8:11], v[48:51]
    v_mfma_f32_16x16x32_bf16 v[56:59], v[20:23], a[12:15], v[56:59]
    v_and_b32 v7, 3, v1
    s_waitcnt lgkmcnt(3)
    v_mfma_f32_16x16x32_bf16 v[36:39], v[24:27], a[0:3], v[36:39]
    ds_read_b128 v[16:19], v4 offset:14336
    v_lshlrev_b32 v7, 2, v7
    v_mfma_f32_16x16x32_bf16 v[44:47], v[24:27], a[4:7], v[44:47]
    buffer_load_dword v6, v7, s[4:7], s52 offen sc1
    v_mfma_f32_16x16x32_bf16 v[52:55], v[24:27], a[8:11], v[52:55]
    v_mfma_f32_16x16x32_bf16 v[60:63], v[24:27], a[12:15], v[60:63]
    s_waitcnt lgkmcnt(3)
    v_mfma_f32_16x16x32_bf16 v[64:67], v[28:31], a[0:3], v[64:67]
    ds_read_b128 v[20:23], v4 offset:15360
    v_mfma_f32_16x16x32_bf16 v[72:75], v[28:31], a[4:7], v[72:75]
    v_mfma_f32_16x16x32_bf16 v[80:83], v[28:31], a[8:11], v[80:83]
    v_mfma_f32_16x16x32_bf16 v[88:91], v[28:31], a[12:15], v[88:91]
    s_waitcnt lgkmcnt(3)
    v_mfma_f32_16x16x32_bf16 v[68:71], v[8:11], a[0:3], v[68:71]
    ds_read_b128 v[24:27], v4 offset:16384
    v_mfma_f32_16x16x32_bf16 v[76:79], v[8:11], a[4:7], v[76:79]
    v_mfma_f32_16x16x32_bf16 v[84:87], v[8:11], a[8:11], v[84:87]
    v_mfma_f32_16x16x32_bf16 v[92:95], v[8:11], a[12:15], v[92:95]
    s_waitcnt lgkmcnt(3)
    v_mfma_f32_16x16x32_bf16 v[96:99], v[12:15], a[0:3], v[96:99]
    ds_read_b128 v[28:31], v4 offset:17408
    v_mfma_f32_16x16x32_bf16 v[104:107], v[12:15], a[4:7], v[104:107]
    v_mfma_f32_16x16x32_bf16 v[112:115], v[12:15], a[8:11], v[112:115]
    v_mfma_f32_16x16x32_bf16 v[120:123], v[12:15], a[12:15], v[120:123]
    s_waitcnt lgkmcnt(3)
    v_mfma_f32_16x16x32_bf16 v[100:103], v[16:19], a[0:3], v[100:103]
    ds_read_b128 v[8:11], v4 offset:18432
    v_mfma_f32_16x16x32_bf16 v[108:111], v[16:19], a[4:7], v[108:111]
    v_mfma_f32_16x16x32_bf16 v[116:119], v[16:19], a[8:11], v[116:119]
    v_mfma_f32_16x16x32_bf16 v[124:127], v[16:19], a[12:15], v[124:127]
    s_waitcnt lgkmcnt(3)
    v_mfma_f32_16x16x32_bf16 v[128:131], v[20:23], a[0:3], v[128:131]
    ds_read_b128 v[12:15], v4 offset:19456
    v_mfma_f32_16x16x32_bf16 v[136:139], v[20:23], a[4:7], v[136:139]
    v_mfma_f32_16x16x32_bf16 v[144:147], v[20:23], a[8:11], v[144:147]
    v_mfma_f32_16x16x32_bf16 v[152:155], v[20:23], a[12:15], v[152:155]
    s_waitcnt lgkmcnt(3)
    v_mfma_f32_16x16x32_bf16 v[132:135], v[24:27], a[0:3], v[132:135]
    ds_read_b128 v[16:19], v4 offset:20480
    v_mfma_f32_16x16x32_bf16 v[140:143], v[24:27], a[4:7], v[140:143]
    v_mfma_f32_16x16x32_bf16 v[148:151], v[24:27], a[8:11], v[148:151]
    v_mfma_f32_16x16x32_bf16 v[156:159], v[24:27], a[12:15], v[156:159]
    s_waitcnt lgkmcnt(3)
    v_mfma_f32_16x16x32_bf16 v[160:163], v[28:31], a[0:3], v[160:163]
    ds_read_b128 v[20:23], v4 offset:21504
    v_mfma_f32_16x16x32_bf16 v[164:167], v[28:31], a[4:7], v[164:167]
    v_mfma_f32_16x16x32_bf16 v[168:171], v[28:31], a[8:11], v[168:171]
    v_mfma_f32_16x16x32_bf16 v[172:175], v[28:31], a[12:15], v[172:175]
    s_waitcnt vmcnt(0)
    v_cmp_le_u32 vcc, 2, v6
    s_nop 0
    s_cmp_eq_u64 vcc, exec
    s_cbranch_scc0 L_pb_slow_36
L_pb_back_37:
    s_waitcnt lgkmcnt(3)
    v_mfma_f32_16x16x32_bf16 v[32:35], v[8:11], a[16:19], v[32:35]
    ds_read_b128 v[24:27], v4 offset:22528
    s_add_u32 s60, s56, 32768
    v_mfma_f32_16x16x32_bf16 v[40:43], v[8:11], a[20:23], v[40:43]
    buffer_load_dwordx4 a[112:115], v2, s[4:7], s60 offen offset:0 sc1
    buffer_load_dwordx4 a[116:119], v2, s[4:7], s60 offen offset:1024 sc1
    v_mfma_f32_16x16x32_bf16 v[48:51], v[8:11], a[24:27], v[48:51]
    buffer_load_dwordx4 a[120:123], v2, s[4:7], s60 offen offset:2048 sc1
    buffer_load_dwordx4 a[124:127], v2, s[4:7], s60 offen offset:3072 sc1
    v_mfma_f32_16x16x32_bf16 v[56:59], v[8:11], a[28:31], v[56:59]
    s_and_b32 s68, s46, 1
    s_mul_i32 s69, s68, 5120
    s_waitcnt lgkmcnt(3)
    v_mfma_f32_16x16x32_bf16 v[36:39], v[12:15], a[16:19], v[36:39]
    ds_read_b128 v[28:31], v4 offset:23552
    s_add_u32 s69, s69, s53
    v_mfma_f32_16x16x32_bf16 v[44:47], v[12:15], a[20:23], v[44:47]
    s_lshl_b32 s68, s68, 9
    s_add_u32 s68, s68, s53
    v_mfma_f32_16x16x32_bf16 v[52:55], v[12:15], a[24:27], v[52:55]
    s_add_u32 s60, s57, 32768
    buffer_load_dwordx4 a[128:131], v2, s[4:7], s60 offen offset:0 sc1
    v_mfma_f32_16x16x32_bf16 v[60:63], v[12:15], a[28:31], v[60:63]
    buffer_load_dwordx4 a[132:135], v2, s[4:7], s60 offen offset:1024 sc1
    buffer_load_dwordx4 a[136:139], v2, s[4:7], s60 offen offset:2048 sc1
    s_waitcnt lgkmcnt(3)
    v_mfma_f32_16x16x32_bf16 v[64:67], v[16:19], a[16:19], v[64:67]
    ds_read_b128 v[8:11], v4 offset:24576
    buffer_load_dwordx4 a[140:143], v2, s[4:7], s60 offen offset:3072 sc1
    v_mfma_f32_16x16x32_bf16 v[72:75], v[16:19], a[20:23], v[72:75]
    v_and_b32 v0, 15, v1
    v_lshlrev_b32 v0, 5, v0
    v_mfma_f32_16x16x32_bf16 v[80:83], v[16:19], a[24:27], v[80:83]
    v_lshrrev_b32 v5, 4, v1
    v_lshl_add_u32 v0, v5, 3, v0
    v_mfma_f32_16x16x32_bf16 v[88:91], v[16:19], a[28:31], v[88:91]
    s_waitcnt lgkmcnt(3)
    v_mfma_f32_16x16x32_bf16 v[68:71], v[20:23], a[16:19], v[68:71]
    ds_read_b128 v[12:15], v4 offset:25600
    s_add_u32 s60, s58, 32768
    v_mfma_f32_16x16x32_bf16 v[76:79], v[20:23], a[20:23], v[76:79]
    buffer_load_dwordx4 a[144:147], v2, s[4:7], s60 offen offset:0 sc1
    buffer_load_dwordx4 a[148:151], v2, s[4:7], s60 offen offset:1024 sc1
    v_mfma_f32_16x16x32_bf16 v[84:87], v[20:23], a[24:27], v[84:87]
    buffer_load_dwordx4 a[152:155], v2, s[4:7], s60 offen offset:2048 sc1
    buffer_load_dwordx4 a[156:159], v2, s[4:7], s60 offen offset:3072 sc1
    v_mfma_f32_16x16x32_bf16 v[92:95], v[20:23], a[28:31], v[92:95]
    s_waitcnt lgkmcnt(3)
    v_mfma_f32_16x16x32_bf16 v[96:99], v[24:27], a[16:19], v[96:99]
    ds_read_b128 v[16:19], v4 offset:26624
    v_mfma_f32_16x16x32_bf16 v[104:107], v[24:27], a[20:23], v[104:107]
    v_mfma_f32_16x16x32_bf16 v[112:115], v[24:27], a[24:27], v[112:115]
    s_add_u32 s60, s56, 49152
    buffer_load_dwordx4 a[160:163], v2, s[4:7], s60 offen offset:0 sc1
    v_mfma_f32_16x16x32_bf16 v[120:123], v[24:27], a[28:31], v[120:123]
    buffer_load_dwordx4 a[164:167], v2, s[4:7], s60 offen offset:1024 sc1
    buffer_load_dwordx4 a[168:171], v2, s[4:7], s60 offen offset:2048 sc1
    s_waitcnt lgkmcnt(3)
    v_mfma_f32_16x16x32_bf16 v[100:103], v[28:31], a[16:19], v[100:103]
    ds_read_b128 v[20:23], v4 offset:27648
    buffer_load_dwordx4 a[172:175], v2, s[4:7], s60 offen offset:3072 sc1
    v_mfma_f32_16x16x32_bf16 v[108:111], v[28:31], a[20:23], v[108:111]
    v_mfma_f32_16x16x32_bf16 v[116:119], v[28:31], a[24:27], v[116:119]
    v_mfma_f32_16x16x32_bf16 v[124:127], v[28:31], a[28:31], v[124:127]
    s_waitcnt lgkmcnt(3)
    v_mfma_f32_16x16x32_bf16 v[128:131], v[8:11], a[16:19], v[128:131]
    ds_read_b128 v[24:27], v4 offset:28672
    s_add_u32 s60, s57, 49152
    v_mfma_f32_16x16x32_bf16 v[136:139], v[8:11], a[20:23], v[136:139]
    buffer_load_dwordx4 a[176:179], v2, s[4:7], s60 offen offset:0 sc1
    buffer_load_dwordx4 a[180:183], v2, s[4:7], s60 offen offset:1024 sc1
    v_mfma_f32_16x16x32_bf16 v[144:147], v[8:11], a[24:27], v[144:147]
    buffer_load_dwordx4 a[184:187], v2, s[4:7], s60 offen offset:2048 sc1
    buffer_load_dwordx4 a[188:191], v2, s[4:7], s60 offen offset:3072 sc1
    v_mfma_f32_16x16x32_bf16 v[152:155], v[8:11], a[28:31], v[152:155]
    s_waitcnt lgkmcnt(3)
    v_mfma_f32_16x16x32_bf16 v[132:135], v[12:15], a[16:19], v[132:135]
    ds_read_b128 v[28:31], v4 offset:29696
    v_mfma_f32_16x16x32_bf16 v[140:143], v[12:15], a[20:23], v[140:143]
    v_mfma_f32_16x16x32_bf16 v[148:151], v[12:15], a[24:27], v[148:151]
    s_add_u32 s60, s58, 49152
    buffer_load_dwordx4 a[192:195], v2, s[4:7], s60 offen offset:0 sc1
    v_mfma_f32_16x16x32_bf16 v[156:159], v[12:15], a[28:31], v[156:159]
    buffer_load_dwordx4 a[196:199], v2, s[4:7], s60 offen offset:1024 sc1
    buffer_load_dwordx4 a[200:203], v2, s[4:7], s60 offen offset:2048 sc1
    s_waitcnt lgkmcnt(3)
    v_mfma_f32_16x16x32_bf16 v[160:163], v[16:19], a[16:19], v[160:163]
    ds_read_b128 v[8:11], v4 offset:30720
    buffer_load_dwordx4 a[204:207], v2, s[4:7], s60 offen offset:3072 sc1
    v_mfma_f32_16x16x32_bf16 v[164:167], v[16:19], a[20:23], v[164:167]
    v_mfma_f32_16x16x32_bf16 v[168:171], v[16:19], a[24:27], v[168:171]
    v_mfma_f32_16x16x32_bf16 v[172:175], v[16:19], a[28:31], v[172:175]
    s_waitcnt lgkmcnt(3)
    v_mfma_f32_16x16x32_bf16 v[32:35], v[20:23], a[32:35], v[32:35]
    ds_read_b128 v[12:15], v4 offset:31744
    v_mfma_f32_16x16x32_bf16 v[40:43], v[20:23], a[36:39], v[40:43]
    v_mfma_f32_16x16x32_bf16 v[48:51], v[20:23], a[40:43], v[48:51]
    v_mfma_f32_16x16x32_bf16 v[56:59], v[20:23], a[44:47], v[56:59]
    s_waitcnt lgkmcnt(3)
    v_mfma_f32_16x16x32_bf16 v[36:39], v[24:27], a[32:35], v[36:39]
    ds_read_b128 v[16:19], v4 offset:32768
    v_mfma_f32_16x16x32_bf16 v[44:47], v[24:27], a[36:39], v[44:47]
    v_mfma_f32_16x16x32_bf16 v[52:55], v[24:27], a[40:43], v[52:55]
    v_mfma_f32_16x16x32_bf16 v[60:63], v[24:27], a[44:47], v[60:63]
    s_waitcnt lgkmcnt(3)
    v_mfma_f32_16x16x32_bf16 v[64:67], v[28:31], a[32:35], v[64:67]
    ds_read_b128 v[20:23], v4 offset:33792
    v_mfma_f32_16x16x32_bf16 v[72:75], v[28:31], a[36:39], v[72:75]
    v_mfma_f32_16x16x32_bf16 v[80:83], v[28:31], a[40:43], v[80:83]
    v_mfma_f32_16x16x32_bf16 v[88:91], v[28:31], a[44:47], v[88:91]
    s_waitcnt lgkmcnt(3)
    v_mfma_f32_16x16x32_bf16 v[68:71], v[8:11], a[32:35], v[68:71]
    ds_read_b128 v[24:27], v4 offset:34816
    v_mfma_f32_16x16x32_bf16 v[76:79], v[8:11], a[36:39], v[76:79]
    v_mfma_f32_16x16x32_bf16 v[84:87], v[8:11], a[40:43], v[84:87]
    v_mfma_f32_16x16x32_bf16 v[92:95], v[8:11], a[44:47], v[92:95]
    s_waitcnt lgkmcnt(3)
    v_mfma_f32_16x16x32_bf16 v[96:99], v[12:15], a[32:35], v[96:99]
    ds_read_b128 v[28:31], v4 offset:35840
    v_mfma_f32_16x16x32_bf16 v[104:107], v[12:15], a[36:39], v[104:107]
    v_mfma_f32_16x16x32_bf16 v[112:115], v[12:15], a[40:43], v[112:115]
    v_mfma_f32_16x16x32_bf16 v[120:123], v[12:15], a[44:47], v[120:123]
    s_waitcnt lgkmcnt(3)
    v_mfma_f32_16x16x32_bf16 v[100:103], v[16:19], a[32:35], v[100:103]
    s_barrier
    v_mfma_f32_16x16x32_bf16 v[108:111], v[16:19], a[36:39], v[108:111]
    v_add_u32 v4, 0x9000, v4
    ds_read_b128 v[8:11], v4 offset:0
    v_mfma_f32_16x16x32_bf16 v[116:119], v[16:19], a[40:43], v[116:119]
    s_add_u32 m0, s63, 36864
    s_add_u32 s61, s62, 479232
    v_mfma_f32_16x16x32_bf16 v[124:127], v[16:19], a[44:47], v[124:127]
    buffer_load_dwordx4 v2, s[4:7], s61 offen offset:0 lds
    buffer_load_dwordx4 v2, s[4:7], s61 offen offset:1024 lds
    s_waitcnt lgkmcnt(3)
    v_mfma_f32_16x16x32_bf16 v[128:131], v[20:23], a[32:35], v[128:131]
    ds_read_b128 v[12:15], v4 offset:1024
    buffer_load_dwordx4 v2, s[4:7], s61 offen offset:2048 lds
    v_mfma_f32_16x16x32_bf16 v[136:139], v[20:23], a[36:39], v[136:139]
    buffer_load_dwordx4 v2, s[4:7], s61 offen offset:3072 lds
    s_add_u32 m0, s63, 40960
    v_mfma_f32_16x16x32_bf16 v[144:147], v[20:23], a[40:43], v[144:147]
    s_add_u32 s61, s62, 483328
    buffer_load_dwordx4 v2, s[4:7], s61 offen offset:0 lds
    v_mfma_f32_16x16x32_bf16 v[152:155], v[20:23], a[44:47], v[152:155]
    s_waitcnt lgkmcnt(3)
    v_mfma_f32_16x16x32_bf16 v[132:135], v[24:27], a[32:35], v[132:135]
    ds_read_b128 v[16:19], v4 offset:2048
    v_mfma_f32_16x16x32_bf16 v[140:143], v[24:27], a[36:39], v[140:143]
    v_mfma_f32_16x16x32_bf16 v[148:151], v[24:27], a[40:43], v[148:151]
    v_mfma_f32_16x16x32_bf16 v[156:159], v[24:27], a[44:47], v[156:159]
    s_waitcnt lgkmcnt(3)
    v_mfma_f32_16x16x32_bf16 v[160:163], v[28:31], a[32:35], v[160:163]
    ds_read_b128 v[20:23], v4 offset:3072
    v_mfma_f32_16x16x32_bf16 v[164:167], v[28:31], a[36:39], v[164:167]
    v_mfma_f32_16x16x32_bf16 v[168:171], v[28:31], a[40:43], v[168:171]
    v_mfma_f32_16x16x32_bf16 v[172:175], v[28:31], a[44:47], v[172:175]
    s_waitcnt lgkmcnt(3)
    v_mfma_f32_16x16x32_bf16 v[32:35], v[8:11], a[48:51], v[32:35]
    ds_read_b128 v[24:27], v4 offset:4096
    v_mfma_f32_16x16x32_bf16 v[40:43], v[8:11], a[52:55], v[40:43]
    v_mfma_f32_16x16x32_bf16 v[48:51], v[8:11], a[56:59], v[48:51]
    v_mfma_f32_16x16x32_bf16 v[56:59], v[8:11], a[60:63], v[56:59]
    s_waitcnt lgkmcnt(3)
    v_mfma_f32_16x16x32_bf16 v[36:39], v[12:15], a[48:51], v[36:39]
    ds_read_b128 v[28:31], v4 offset:5120
    v_mfma_f32_16x16x32_bf16 v[44:47], v[12:15], a[52:55], v[44:47]
    v_mfma_f32_16x16x32_bf16 v[52:55], v[12:15], a[56:59], v[52:55]
    v_mfma_f32_16x16x32_bf16 v[60:63], v[12:15], a[60:63], v[60:63]
    s_waitcnt lgkmcnt(3)
    v_mfma_f32_16x16x32_bf16 v[64:67], v[16:19], a[48:51], v[64:67]
    ds_read_b128 v[8:11], v4 offset:6144
    v_mfma_f32_16x16x32_bf16 v[72:75], v[16:19], a[52:55], v[72:75]
    v_mfma_f32_16x16x32_bf16 v[80:83], v[16:19], a[56:59], v[80:83]
    v_mfma_f32_16x16x32_bf16 v[88:91], v[16:19], a[60:63], v[88:91]
    s_waitcnt lgkmcnt(3)
    v_mfma_f32_16x16x32_bf16 v[68:71], v[20:23], a[48:51], v[68:71]
    ds_read_b128 v[12:15], v4 offset:7168
    v_mfma_f32_16x16x32_bf16 v[76:79], v[20:23], a[52:55], v[76:79]
    v_mfma_f32_16x16x32_bf16 v[84:87], v[20:23], a[56:59], v[84:87]
    v_mfma_f32_16x16x32_bf16 v[92:95], v[20:23], a[60:63], v[92:95]
    s_waitcnt lgkmcnt(3)
    v_mfma_f32_16x16x32_bf16 v[96:99], v[24:27], a[48:51], v[96:99]
    ds_read_b128 v[16:19], v4 offset:8192
    v_mfma_f32_16x16x32_bf16 v[104:107], v[24:27], a[52:55], v[104:107]
    v_mfma_f32_16x16x32_bf16 v[112:115], v[24:27], a[56:59], v[112:115]
    v_mfma_f32_16x16x32_bf16 v[120:123], v[24:27], a[60:63], v[120:123]
    s_waitcnt lgkmcnt(3)
    v_mfma_f32_16x16x32_bf16 v[100:103], v[28:31], a[48:51], v[100:103]
    ds_read_b128 v[20:23], v4 offset:9216
    v_mfma_f32_16x16x32_bf16 v[108:111], v[28:31], a[52:55], v[108:111]
    v_mfma_f32_16x16x32_bf16 v[116:119], v[28:31], a[56:59], v[116:119]
    v_mfma_f32_16x16x32_bf16 v[124:127], v[28:31], a[60:63], v[124:127]
    s_waitcnt lgkmcnt(3)
    v_mfma_f32_16x16x32_bf16 v[128:131], v[8:11], a[48:51], v[128:131]
    ds_read_b128 v[24:27], v4 offset:10240
    v_mfma_f32_16x16x32_bf16 v[136:139], v[8:11], a[52:55], v[136:139]
    v_mfma_f32_16x16x32_bf16 v[144:147], v[8:11], a[56:59], v[144:147]
    v_mfma_f32_16x16x32_bf16 v[152:155], v[8:11], a[60:63], v[152:155]
    s_waitcnt lgkmcnt(3)
    v_mfma_f32_16x16x32_bf16 v[132:135], v[12:15], a[48:51], v[132:135]
    ds_read_b128 v[28:31], v4 offset:11264
    v_mfma_f32_16x16x32_bf16 v[140:143], v[12:15], a[52:55], v[140:143]
    v_mfma_f32_16x16x32_bf16 v[148:151], v[12:15], a[56:59], v[148:151]
    v_mfma_f32_16x16x32_bf16 v[156:159], v[12:15], a[60:63], v[156:159]
    s_waitcnt lgkmcnt(3)
    v_mfma_f32_16x16x32_bf16 v[160:163], v[16:19], a[48:51], v[160:163]
    ds_read_b128 v[8:11], v4 offset:12288
    v_mfma_f32_16x16x32_bf16 v[164:167], v[16:19], a[52:55], v[164:167]
    v_mfma_f32_16x16x32_bf16 v[168:171], v[16:19], a[56:59], v[168:171]
    v_mfma_f32_16x16x32_bf16 v[172:175], v[16:19], a[60:63], v[172:175]
    s_waitcnt lgkmcnt(3)
    v_mfma_f32_16x16x32_bf16 v[32:35], v[20:23], a[64:67], v[32:35]
    ds_read_b128 v[12:15], v4 offset:13312
    v_mfma_f32_16x16x32_bf16 v[40:43], v[20:23], a[68:71], v[40:43]
    v_mfma_f32_16x16x32_bf16 v[48:51], v[20:23], a[72:75], v[48:51]
    v_mfma_f32_16x16x32_bf16 v[56:59], v[20:23], a[76:79], v[56:59]
    s_waitcnt lgkmcnt(3)
    v_mfma_f32_16x16x32_bf16 v[36:39], v[24:27], a[64:67], v[36:39]
    ds_read_b128 v[16:19], v4 offset:14336
    v_mfma_f32_16x16x32_bf16 v[44:47], v[24:27], a[68:71], v[44:47]
    v_mfma_f32_16x16x32_bf16 v[52:55], v[24:27], a[72:75], v[52:55]
    v_mfma_f32_16x16x32_bf16 v[60:63], v[24:27], a[76:79], v[60:63]
    s_waitcnt lgkmcnt(3)
    v_mfma_f32_16x16x32_bf16 v[32:35], v[28:31], a[80:83], v[32:35]
    ds_read_b128 v[20:23], v4 offset:15360
    v_mfma_f32_16x16x32_bf16 v[40:43], v[28:31], a[84:87], v[40:43]
    v_mfma_f32_16x16x32_bf16 v[48:51], v[28:31], a[88:91], v[48:51]
    v_mfma_f32_16x16x32_bf16 v[56:59], v[28:31], a[92:95], v[56:59]
    s_waitcnt lgkmcnt(3)
    v_mfma_f32_16x16x32_bf16 v[36:39], v[8:11], a[80:83], v[36:39]
    ds_read_b128 v[24:27], v4 offset:16384
    v_mfma_f32_16x16x32_bf16 v[44:47], v[8:11], a[84:87], v[44:47]
    v_mfma_f32_16x16x32_bf16 v[52:55], v[8:11], a[88:91], v[52:55]
    v_mfma_f32_16x16x32_bf16 v[60:63], v[8:11], a[92:95], v[60:63]
    s_waitcnt lgkmcnt(3)
    v_mfma_f32_16x16x32_bf16 v[32:35], v[12:15], a[96:99], v[32:35]
    ds_read_b128 v[28:31], v4 offset:17408
    v_mfma_f32_16x16x32_bf16 v[40:43], v[12:15], a[100:103], v[40:43]
    v_mfma_f32_16x16x32_bf16 v[48:51], v[12:15], a[104:107], v[48:51]
    v_mfma_f32_16x16x32_bf16 v[56:59], v[12:15], a[108:111], v[56:59]
    s_waitcnt lgkmcnt(3)
    v_mfma_f32_16x16x32_bf16 v[36:39], v[16:19], a[96:99], v[36:39]
    ds_read_b128 v[8:11], v4 offset:18432
    v_mfma_f32_16x16x32_bf16 v[44:47], v[16:19], a[100:103], v[44:47]
    v_mfma_f32_16x16x32_bf16 v[52:55], v[16:19], a[104:107], v[52:55]
    v_mfma_f32_16x16x32_bf16 v[60:63], v[16:19], a[108:111], v[60:63]
    s_waitcnt vmcnt(28) lgkmcnt(3)
    v_mfma_f32_16x16x32_bf16 v[32:35], v[20:23], a[112:115], v[32:35]
    ds_read_b128 v[12:15], v4 offset:19456
    s_waitcnt vmcnt(27)
    v_mfma_f32_16x16x32_bf16 v[40:43], v[20:23], a[116:119], v[40:43]
    s_waitcnt vmcnt(26)
    v_mfma_f32_16x16x32_bf16 v[48:51], v[20:23], a[120:123], v[48:51]
    s_waitcnt vmcnt(25)
    v_mfma_f32_16x16x32_bf16 v[56:59], v[20:23], a[124:127], v[56:59]
    s_waitcnt lgkmcnt(3)
    v_mfma_f32_16x16x32_bf16 v[36:39], v[24:27], a[112:115], v[36:39]
    ds_read_b128 v[16:19], v4 offset:20480
    v_mfma_f32_16x16x32_bf16 v[44:47], v[24:27], a[116:119], v[44:47]
    v_mfma_f32_16x16x32_bf16 v[52:55], v[24:27], a[120:123], v[52:55]
    v_mfma_f32_16x16x32_bf16 v[60:63], v[24:27], a[124:127], v[60:63]
    s_waitcnt vmcnt(24) lgkmcnt(3)
    v_mfma_f32_16x16x32_bf16 v[32:35], v[28:31], a[128:131], v[32:35]
    ds_read_b128 v[20:23], v4 offset:21504
    s_waitcnt vmcnt(23)
    v_mfma_f32_16x16x32_bf16 v[40:43], v[28:31], a[132:135], v[40:43]
    s_waitcnt vmcnt(22)
    v_mfma_f32_16x16x32_bf16 v[48:51], v[28:31], a[136:139], v[48:51]
    s_waitcnt vmcnt(21)
    v_mfma_f32_16x16x32_bf16 v[56:59], v[28:31], a[140:143], v[56:59]
    s_waitcnt lgkmcnt(3)
    v_mfma_f32_16x16x32_bf16 v[36:39], v[8:11], a[128:131], v[36:39]
    ds_read_b128 v[24:27], v4 offset:22528
    v_mfma_f32_16x16x32_bf16 v[44:47], v[8:11], a[132:135], v[44:47]
    v_mfma_f32_16x16x32_bf16 v[52:55], v[8:11], a[136:139], v[52:55]
    v_mfma_f32_16x16x32_bf16 v[60:63], v[8:11], a[140:143], v[60:63]
    s_waitcnt vmcnt(20) lgkmcnt(3)
    v_mfma_f32_16x16x32_bf16 v[32:35], v[12:15], a[144:147], v[32:35]
    ds_read_b128 v[28:31], v4 offset:23552
    s_waitcnt vmcnt(19)
    v_mfma_f32_16x16x32_bf16 v[40:43], v[12:15], a[148:151], v[40:43]
    s_waitcnt vmcnt(18)
    v_mfma_f32_16x16x32_bf16 v[48:51], v[12:15], a[152:155], v[48:51]
    s_waitcnt vmcnt(17)
    v_mfma_f32_16x16x32_bf16 v[56:59], v[12:15], a[156:159], v[56:59]
    s_waitcnt lgkmcnt(3)
    v_mfma_f32_16x16x32_bf16 v[36:39], v[16:19], a[144:147], v[36:39]
    ds_read_b128 v[8:11], v4 offset:24576
    v_mfma_f32_16x16x32_bf16 v[44:47], v[16:19], a[148:151], v[44:47]
    v_mfma_f32_16x16x32_bf16 v[52:55], v[16:19], a[152:155], v[52:55]
    v_mfma_f32_16x16x32_bf16 v[60:63], v[16:19], a[156:159], v[60:63]
    s_waitcnt vmcnt(16) lgkmcnt(3)
    v_mfma_f32_16x16x32_bf16 v[32:35], v[20:23], a[160:163], v[32:35]
    ds_read_b128 v[12:15], v4 offset:25600
    s_waitcnt vmcnt(15)
    v_mfma_f32_16x16x32_bf16 v[40:43], v[20:23], a[164:167], v[40:43]
    s_waitcnt vmcnt(14)
    v_mfma_f32_16x16x32_bf16 v[48:51], v[20:23], a[168:171], v[48:51]
    s_waitcnt vmcnt(13)
    v_mfma_f32_16x16x32_bf16 v[56:59], v[20:23], a[172:175], v[56:59]
    s_waitcnt lgkmcnt(3)
    v_mfma_f32_16x16x32_bf16 v[36:39], v[24:27], a[160:163], v[36:39]
    ds_read_b128 v[16:19], v4 offset:26624
    v_mfma_f32_16x16x32_bf16 v[44:47], v[24:27], a[164:167], v[44:47]
    v_mfma_f32_16x16x32_bf16 v[52:55], v[24:27], a[168:171], v[52:55]
    v_mfma_f32_16x16x32_bf16 v[60:63], v[24:27], a[172:175], v[60:63]
    s_waitcnt vmcnt(12) lgkmcnt(3)
    v_mfma_f32_16x16x32_bf16 v[32:35], v[28:31], a[176:179], v[32:35]
    ds_read_b128 v[20:23], v4 offset:27648
    s_waitcnt vmcnt(11)
    v_mfma_f32_16x16x32_bf16 v[40:43], v[28:31], a[180:183], v[40:43]
    s_waitcnt vmcnt(10)
    v_mfma_f32_16x16x32_bf16 v[48:51], v[28:31], a[184:187], v[48:51]
    s_waitcnt vmcnt(9)
    v_mfma_f32_16x16x32_bf16 v[56:59], v[28:31], a[188:191], v[56:59]
    s_waitcnt lgkmcnt(3)
    v_mfma_f32_16x16x32_bf16 v[36:39], v[8:11], a[176:179], v[36:39]
    ds_read_b128 v[24:27], v4 offset:28672
    v_mfma_f32_16x16x32_bf16 v[44:47], v[8:11], a[180:183], v[44:47]
    v_mfma_f32_16x16x32_bf16 v[52:55], v[8:11], a[184:187], v[52:55]
    v_mfma_f32_16x16x32_bf16 v[60:63], v[8:11], a[188:191], v[60:63]
    s_waitcnt vmcnt(8) lgkmcnt(3)
    v_mfma_f32_16x16x32_bf16 v[32:35], v[12:15], a[192:195], v[32:35]
    ds_read_b128 v[28:31], v4 offset:29696
    s_waitcnt vmcnt(7)
    v_mfma_f32_16x16x32_bf16 v[40:43], v[12:15], a[196:199], v[40:43]
    s_waitcnt vmcnt(6)
    v_mfma_f32_16x16x32_bf16 v[48:51], v[12:15], a[200:203], v[48:51]
    s_waitcnt vmcnt(5)
    v_mfma_f32_16x16x32_bf16 v[56:59], v[12:15], a[204:207], v[56:59]
    s_waitcnt lgkmcnt(3)
    v_mfma_f32_16x16x32_bf16 v[36:39], v[16:19], a[192:195], v[36:39]
    ds_read_b128 v[8:11], v4 offset:30720
    v_mfma_f32_16x16x32_bf16 v[44:47], v[16:19], a[196:199], v[44:47]
    v_mfma_f32_16x16x32_bf16 v[52:55], v[16:19], a[200:203], v[52:55]
    v_mfma_f32_16x16x32_bf16 v[60:63], v[16:19], a[204:207], v[60:63]
    s_waitcnt lgkmcnt(3)
    v_mfma_f32_16x16x32_bf16 v[64:67], v[20:23], a[64:67], v[64:67]
    ds_read_b128 v[12:15], v4 offset:31744
    v_mfma_f32_16x16x32_bf16 v[72:75], v[20:23], a[68:71], v[72:75]
    v_mfma_f32_16x16x32_bf16 v[80:83], v[20:23], a[72:75], v[80:83]
    v_mfma_f32_16x16x32_bf16 v[88:91], v[20:23], a[76:79], v[88:91]
    v_cvt_pk_bf16_f32 v32, v32, v33
    v_cvt_pk_bf16_f32 v33, v34, v35
    s_waitcnt lgkmcnt(3)
    v_mfma_f32_16x16x32_bf16 v[68:71], v[24:27], a[64:67], v[68:71]
    ds_read_b128 v[16:19], v4 offset:32768
    v_cvt_pk_bf16_f32 v34, v36, v37
    v_mfma_f32_16x16x32_bf16 v[76:79], v[24:27], a[68:71], v[76:79]
    v_cvt_pk_bf16_f32 v35, v38, v39
    s_add_u32 s70, s69, 0
    v_mfma_f32_16x16x32_bf16 v[84:87], v[24:27], a[72:75], v[84:87]
    buffer_store_dwordx4 v[32:35], v2, s[4:7], s70 offen sc1
    v_cvt_pk_bf16_f32 v40, v40, v41
    v_mfma_f32_16x16x32_bf16 v[92:95], v[24:27], a[76:79], v[92:95]
    v_cvt_pk_bf16_f32 v41, v42, v43
    v_cvt_pk_bf16_f32 v42, v44, v45
    s_waitcnt lgkmcnt(3)
    v_mfma_f32_16x16x32_bf16 v[64:67], v[28:31], a[80:83], v[64:67]
    ds_read_b128 v[20:23], v4 offset:33792
    v_cvt_pk_bf16_f32 v43, v46, v47
    v_mfma_f32_16x16x32_bf16 v[72:75], v[28:31], a[84:87], v[72:75]
    s_add_u32 s70, s69, 18432
    buffer_store_dwordx4 v[40:43], v2, s[4:7], s70 offen sc1
    v_mfma_f32_16x16x32_bf16 v[80:83], v[28:31], a[88:91], v[80:83]
    v_cvt_pk_bf16_f32 v48, v48, v49
    v_cvt_pk_bf16_f32 v49, v50, v51
    v_mfma_f32_16x16x32_bf16 v[88:91], v[28:31], a[92:95], v[88:91]
    v_cvt_pk_bf16_f32 v50, v52, v53
    v_cvt_pk_bf16_f32 v51, v54, v55
    s_waitcnt lgkmcnt(3)
    v_mfma_f32_16x16x32_bf16 v[68:71], v[8:11], a[80:83], v[68:71]
    ds_read_b128 v[24:27], v4 offset:34816
    s_add_u32 s70, s69, 36864
    v_mfma_f32_16x16x32_bf16 v[76:79], v[8:11], a[84:87], v[76:79]
    buffer_store_dwordx4 v[48:51], v2, s[4:7], s70 offen sc1
    v_cvt_pk_bf16_f32 v56, v56, v57
    v_mfma_f32_16x16x32_bf16 v[84:87], v[8:11], a[88:91], v[84:87]
    v_cvt_pk_bf16_f32 v57, v58, v59
    v_cvt_pk_bf16_f32 v58, v60, v61
    v_mfma_f32_16x16x32_bf16 v[92:95], v[8:11], a[92:95], v[92:95]
    v_cvt_pk_bf16_f32 v59, v62, v63
    s_add_u32 s70, s69, 55296
    s_waitcnt lgkmcnt(3)
    v_mfma_f32_16x16x32_bf16 v[64:67], v[12:15], a[96:99], v[64:67]
    ds_read_b128 v[28:31], v4 offset:35840
    buffer_store_dwordx4 v[56:59], v2, s[4:7], s70 offen sc1
    v_mfma_f32_16x16x32_bf16 v[72:75], v[12:15], a[100:103], v[72:75]
    v_mfma_f32_16x16x32_bf16 v[80:83], v[12:15], a[104:107], v[80:83]
    v_mfma_f32_16x16x32_bf16 v[88:91], v[12:15], a[108:111], v[88:91]
    s_waitcnt lgkmcnt(3)
    v_mfma_f32_16x16x32_bf16 v[68:71], v[16:19], a[96:99], v[68:71]
    s_barrier
    v_mfma_f32_16x16x32_bf16 v[76:79], v[16:19], a[100:103], v[76:79]
    v_add_u32 v4, 0xfffe5000, v4
    ds_read_b128 v[8:11], v4 offset:0
    v_mfma_f32_16x16x32_bf16 v[84:87], v[16:19], a[104:107], v[84:87]
    v_mfma_f32_16x16x32_bf16 v[92:95], v[16:19], a[108:111], v[92:95]
    s_waitcnt lgkmcnt(3)
    v_mfma_f32_16x16x32_bf16 v[64:67], v[20:23], a[112:115], v[64:67]
    ds_read_b128 v[12:15], v4 offset:1024
    v_mfma_f32_16x16x32_bf16 v[72:75], v[20:23], a[116:119], v[72:75]
    v_mfma_f32_16x16x32_bf16 v[80:83], v[20:23], a[120:123], v[80:83]
    v_mfma_f32_16x16x32_bf16 v[88:91], v[20:23], a[124:127], v[88:91]
    s_waitcnt lgkmcnt(3)
    v_mfma_f32_16x16x32_bf16 v[68:71], v[24:27], a[112:115], v[68:71]
    ds_read_b128 v[16:19], v4 offset:2048
    v_mfma_f32_16x16x32_bf16 v[76:79], v[24:27], a[116:119], v[76:79]
    v_mfma_f32_16x16x32_bf16 v[84:87], v[24:27], a[120:123], v[84:87]
    v_mfma_f32_16x16x32_bf16 v[92:95], v[24:27], a[124:127], v[92:95]
    s_waitcnt lgkmcnt(3)
    v_mfma_f32_16x16x32_bf16 v[64:67], v[28:31], a[128:131], v[64:67]
    ds_read_b128 v[20:23], v4 offset:3072
    v_mfma_f32_16x16x32_bf16 v[72:75], v[28:31], a[132:135], v[72:75]
    v_mfma_f32_16x16x32_bf16 v[80:83], v[28:31], a[136:139], v[80:83]
    v_mfma_f32_16x16x32_bf16 v[88:91], v[28:31], a[140:143], v[88:91]
    s_waitcnt lgkmcnt(3)
    v_mfma_f32_16x16x32_bf16 v[68:71], v[8:11], a[128:131], v[68:71]
    ds_read_b128 v[24:27], v4 offset:4096
    v_mfma_f32_16x16x32_bf16 v[76:79], v[8:11], a[132:135], v[76:79]
    v_mfma_f32_16x16x32_bf16 v[84:87], v[8:11], a[136:139], v[84:87]
    v_mfma_f32_16x16x32_bf16 v[92:95], v[8:11], a[140:143], v[92:95]
    s_waitcnt lgkmcnt(3)
    v_mfma_f32_16x16x32_bf16 v[64:67], v[12:15], a[144:147], v[64:67]
    ds_read_b128 v[28:31], v4 offset:5120
    v_mfma_f32_16x16x32_bf16 v[72:75], v[12:15], a[148:151], v[72:75]
    v_mfma_f32_16x16x32_bf16 v[80:83], v[12:15], a[152:155], v[80:83]
    v_mfma_f32_16x16x32_bf16 v[88:91], v[12:15], a[156:159], v[88:91]
    s_waitcnt lgkmcnt(3)
    v_mfma_f32_16x16x32_bf16 v[68:71], v[16:19], a[144:147], v[68:71]
    ds_read_b128 v[8:11], v4 offset:6144
    v_mfma_f32_16x16x32_bf16 v[76:79], v[16:19], a[148:151], v[76:79]
    v_mfma_f32_16x16x32_bf16 v[84:87], v[16:19], a[152:155], v[84:87]
    v_mfma_f32_16x16x32_bf16 v[92:95], v[16:19], a[156:159], v[92:95]
    s_waitcnt lgkmcnt(3)
    v_mfma_f32_16x16x32_bf16 v[64:67], v[20:23], a[160:163], v[64:67]
    ds_read_b128 v[12:15], v4 offset:7168
    v_mfma_f32_16x16x32_bf16 v[72:75], v[20:23], a[164:167], v[72:75]
    v_mfma_f32_16x16x32_bf16 v[80:83], v[20:23], a[168:171], v[80:83]
    v_mfma_f32_16x16x32_bf16 v[88:91], v[20:23], a[172:175], v[88:91]
    s_waitcnt lgkmcnt(3)
    v_mfma_f32_16x16x32_bf16 v[68:71], v[24:27], a[160:163], v[68:71]
    ds_read_b128 v[16:19], v4 offset:8192
    v_mfma_f32_16x16x32_bf16 v[76:79], v[24:27], a[164:167], v[76:79]
    v_mfma_f32_16x16x32_bf16 v[84:87], v[24:27], a[168:171], v[84:87]
    v_mfma_f32_16x16x32_bf16 v[92:95], v[24:27], a[172:175], v[92:95]
    s_waitcnt lgkmcnt(3)
    v_mfma_f32_16x16x32_bf16 v[64:67], v[28:31], a[176:179], v[64:67]
    ds_read_b128 v[20:23], v4 offset:9216
    v_mfma_f32_16x16x32_bf16 v[72:75], v[28:31], a[180:183], v[72:75]
    v_mfma_f32_16x16x32_bf16 v[80:83], v[28:31], a[184:187], v[80:83]
    v_mfma_f32_16x16x32_bf16 v[88:91], v[28:31], a[188:191], v[88:91]
    s_waitcnt lgkmcnt(3)
    v_mfma_f32_16x16x32_bf16 v[68:71], v[8:11], a[176:179], v[68:71]
    ds_read_b128 v[24:27], v4 offset:10240
    v_mfma_f32_16x16x32_bf16 v[76:79], v[8:11], a[180:183], v[76:79]
    v_mfma_f32_16x16x32_bf16 v[84:87], v[8:11], a[184:187], v[84:87]
    v_mfma_f32_16x16x32_bf16 v[92:95], v[8:11], a[188:191], v[92:95]
    s_waitcnt lgkmcnt(3)
    v_mfma_f32_16x16x32_bf16 v[64:67], v[12:15], a[192:195], v[64:67]
    ds_read_b128 v[28:31], v4 offset:11264
    v_mfma_f32_16x16x32_bf16 v[72:75], v[12:15], a[196:199], v[72:75]
    v_mfma_f32_16x16x32_bf16 v[80:83], v[12:15], a[200:203], v[80:83]
    v_mfma_f32_16x16x32_bf16 v[88:91], v[12:15], a[204:207], v[88:91]
    s_waitcnt lgkmcnt(3)
    v_mfma_f32_16x16x32_bf16 v[68:71], v[16:19], a[192:195], v[68:71]
    ds_read_b128 v[8:11], v4 offset:12288
    v_mfma_f32_16x16x32_bf16 v[76:79], v[16:19], a[196:199], v[76:79]
    v_mfma_f32_16x16x32_bf16 v[84:87], v[16:19], a[200:203], v[84:87]
    v_mfma_f32_16x16x32_bf16 v[92:95], v[16:19], a[204:207], v[92:95]
    s_waitcnt lgkmcnt(3)
    v_mfma_f32_16x16x32_bf16 v[96:99], v[20:23], a[64:67], v[96:99]
    ds_read_b128 v[12:15], v4 offset:13312
    v_mfma_f32_16x16x32_bf16 v[104:107], v[20:23], a[68:71], v[104:107]
    v_mfma_f32_16x16x32_bf16 v[112:115], v[20:23], a[72:75], v[112:115]
    v_mfma_f32_16x16x32_bf16 v[120:123], v[20:23], a[76:79], v[120:123]
    v_cvt_pk_bf16_f32 v64, v64, v65
    v_cvt_pk_bf16_f32 v65, v66, v67
    s_waitcnt lgkmcnt(3)
    v_mfma_f32_16x16x32_bf16 v[100:103], v[24:27], a[64:67], v[100:103]
    ds_read_b128 v[16:19], v4 offset:14336
    v_cvt_pk_bf16_f32 v66, v68, v69
    v_mfma_f32_16x16x32_bf16 v[108:111], v[24:27], a[68:71], v[108:111]
    v_cvt_pk_bf16_f32 v67, v70, v71
    s_add_u32 s70, s69, 1024
    v_mfma_f32_16x16x32_bf16 v[116:119], v[24:27], a[72:75], v[116:119]
    buffer_store_dwordx4 v[64:67], v2, s[4:7], s70 offen sc1
    v_cvt_pk_bf16_f32 v72, v72, v73
    v_mfma_f32_16x16x32_bf16 v[124:127], v[24:27], a[76:79], v[124:127]
    v_cvt_pk_bf16_f32 v73, v74, v75
    v_cvt_pk_bf16_f32 v74, v76, v77
    s_waitcnt lgkmcnt(3)
    v_mfma_f32_16x16x32_bf16 v[96:99], v[28:31], a[80:83], v[96:99]
    ds_read_b128 v[20:23], v4 offset:15360
    v_cvt_pk_bf16_f32 v75, v78, v79
    v_mfma_f32_16x16x32_bf16 v[104:107], v[28:31], a[84:87], v[104:107]
    s_add_u32 s70, s69, 19456
    buffer_store_dwordx4 v[72:75], v2, s[4:7], s70 offen sc1
    v_mfma_f32_16x16x32_bf16 v[112:115], v[28:31], a[88:91], v[112:115]
    v_cvt_pk_bf16_f32 v80, v80, v81
    v_cvt_pk_bf16_f32 v81, v82, v83
    v_mfma_f32_16x16x32_bf16 v[120:123], v[28:31], a[92:95], v[120:123]
    v_cvt_pk_bf16_f32 v82, v84, v85
    v_cvt_pk_bf16_f32 v83, v86, v87
    s_waitcnt lgkmcnt(3)
    v_mfma_f32_16x16x32_bf16 v[100:103], v[8:11], a[80:83], v[100:103]
    ds_read_b128 v[24:27], v4 offset:16384
    s_add_u32 s70, s69, 37888
    v_mfma_f32_16x16x32_bf16 v[108:111], v[8:11], a[84:87], v[108:111]
    buffer_store_dwordx4 v[80:83], v2, s[4:7], s70 offen sc1
    v_cvt_pk_bf16_f32 v88, v88, v89
    v_mfma_f32_16x16x32_bf16 v[116:119], v[8:11], a[88:91], v[116:119]
    v_cvt_pk_bf16_f32 v89, v90, v91
    v_cvt_pk_bf16_f32 v90, v92, v93
    v_mfma_f32_16x16x32_bf16 v[124:127], v[8:11], a[92:95], v[124:127]
    v_cvt_pk_bf16_f32 v91, v94, v95
    s_add_u32 s70, s69, 56320
    s_waitcnt lgkmcnt(3)
    v_mfma_f32_16x16x32_bf16 v[96:99], v[12:15], a[96:99], v[96:99]
    ds_read_b128 v[28:31], v4 offset:17408
    buffer_store_dwordx4 v[88:91], v2, s[4:7], s70 offen sc1
    v_mfma_f32_16x16x32_bf16 v[104:107], v[12:15], a[100:103], v[104:107]
    v_mfma_f32_16x16x32_bf16 v[112:115], v[12:15], a[104:107], v[112:115]
    v_mfma_f32_16x16x32_bf16 v[120:123], v[12:15], a[108:111], v[120:123]
    s_waitcnt lgkmcnt(3)
    v_mfma_f32_16x16x32_bf16 v[100:103], v[16:19], a[96:99], v[100:103]
    ds_read_b128 v[8:11], v4 offset:18432
    v_mfma_f32_16x16x32_bf16 v[108:111], v[16:19], a[100:103], v[108:111]
    v_mfma_f32_16x16x32_bf16 v[116:119], v[16:19], a[104:107], v[116:119]
    v_mfma_f32_16x16x32_bf16 v[124:127], v[16:19], a[108:111], v[124:127]
    s_waitcnt lgkmcnt(3)
    v_mfma_f32_16x16x32_bf16 v[96:99], v[20:23], a[112:115], v[96:99]
    ds_read_b128 v[12:15], v4 offset:19456
    v_mfma_f32_16x16x32_bf16 v[104:107], v[20:23], a[116:119], v[104:107]
    v_mfma_f32_16x16x32_bf16 v[112:115], v[20:23], a[120:123], v[112:115]
    v_mfma_f32_16x16x32_bf16 v[120:123], v[20:23], a[124:127], v[120:123]
    s_waitcnt lgkmcnt(3)
    v_mfma_f32_16x16x32_bf16 v[100:103], v[24:27], a[112:115], v[100:103]
    ds_read_b128 v[16:19], v4 offset:20480
    v_mfma_f32_16x16x32_bf16 v[108:111], v[24:27], a[116:119], v[108:111]
    v_mfma_f32_16x16x32_bf16 v[116:119], v[24:27], a[120:123], v[116:119]
    v_mfma_f32_16x16x32_bf16 v[124:127], v[24:27], a[124:127], v[124:127]
    s_waitcnt lgkmcnt(3)
    v_mfma_f32_16x16x32_bf16 v[96:99], v[28:31], a[128:131], v[96:99]
    ds_read_b128 v[20:23], v4 offset:21504
    v_mfma_f32_16x16x32_bf16 v[104:107], v[28:31], a[132:135], v[104:107]
    v_mfma_f32_16x16x32_bf16 v[112:115], v[28:31], a[136:139], v[112:115]
    v_mfma_f32_16x16x32_bf16 v[120:123], v[28:31], a[140:143], v[120:123]
    s_waitcnt lgkmcnt(3)
    v_mfma_f32_16x16x32_bf16 v[100:103], v[8:11], a[128:131], v[100:103]
    ds_read_b128 v[24:27], v4 offset:22528
    v_mfma_f32_16x16x32_bf16 v[108:111], v[8:11], a[132:135], v[108:111]
    v_mfma_f32_16x16x32_bf16 v[116:119], v[8:11], a[136:139], v[116:119]
    v_mfma_f32_16x16x32_bf16 v[124:127], v[8:11], a[140:143], v[124:127]
    s_waitcnt lgkmcnt(3)
    v_mfma_f32_16x16x32_bf16 v[96:99], v[12:15], a[144:147], v[96:99]
    ds_read_b128 v[28:31], v4 offset:23552
    v_mfma_f32_16x16x32_bf16 v[104:107], v[12:15], a[148:151], v[104:107]
    v_mfma_f32_16x16x32_bf16 v[112:115], v[12:15], a[152:155], v[112:115]
    v_mfma_f32_16x16x32_bf16 v[120:123], v[12:15], a[156:159], v[120:123]
    s_waitcnt lgkmcnt(3)
    v_mfma_f32_16x16x32_bf16 v[100:103], v[16:19], a[144:147], v[100:103]
    ds_read_b128 v[8:11], v4 offset:24576
    v_mfma_f32_16x16x32_bf16 v[108:111], v[16:19], a[148:151], v[108:111]
    v_mfma_f32_16x16x32_bf16 v[116:119], v[16:19], a[152:155], v[116:119]
    v_mfma_f32_16x16x32_bf16 v[124:127], v[16:19], a[156:159], v[124:127]
    s_waitcnt lgkmcnt(3)
    v_mfma_f32_16x16x32_bf16 v[96:99], v[20:23], a[160:163], v[96:99]
    ds_read_b128 v[12:15], v4 offset:25600
    v_mfma_f32_16x16x32_bf16 v[104:107], v[20:23], a[164:167], v[104:107]
    v_mfma_f32_16x16x32_bf16 v[112:115], v[20:23], a[168:171], v[112:115]
    v_mfma_f32_16x16x32_bf16 v[120:123], v[20:23], a[172:175], v[120:123]
    s_waitcnt lgkmcnt(3)
    v_mfma_f32_16x16x32_bf16 v[100:103], v[24:27], a[160:163], v[100:103]
    ds_read_b128 v[16:19], v4 offset:26624
    v_mfma_f32_16x16x32_bf16 v[108:111], v[24:27], a[164:167], v[108:111]
    v_mfma_f32_16x16x32_bf16 v[116:119], v[24:27], a[168:171], v[116:119]
    v_mfma_f32_16x16x32_bf16 v[124:127], v[24:27], a[172:175], v[124:127]
    s_waitcnt lgkmcnt(3)
    v_mfma_f32_16x16x32_bf16 v[96:99], v[28:31], a[176:179], v[96:99]
    ds_read_b128 v[20:23], v4 offset:27648
    v_mfma_f32_16x16x32_bf16 v[104:107], v[28:31], a[180:183], v[104:107]
    v_mfma_f32_16x16x32_bf16 v[112:115], v[28:31], a[184:187], v[112:115]
    v_mfma_f32_16x16x32_bf16 v[120:123], v[28:31], a[188:191], v[120:123]
    s_waitcnt lgkmcnt(3)
    v_mfma_f32_16x16x32_bf16 v[100:103], v[8:11], a[176:179], v[100:103]
    ds_read_b128 v[24:27], v4 offset:28672
    v_mfma_f32_16x16x32_bf16 v[108:111], v[8:11], a[180:183], v[108:111]
    v_mfma_f32_16x16x32_bf16 v[116:119], v[8:11], a[184:187], v[116:119]
    v_mfma_f32_16x16x32_bf16 v[124:127], v[8:11], a[188:191], v[124:127]
    s_waitcnt lgkmcnt(3)
    v_mfma_f32_16x16x32_bf16 v[96:99], v[12:15], a[192:195], v[96:99]
    ds_read_b128 v[28:31], v4 offset:29696
    v_mfma_f32_16x16x32_bf16 v[104:107], v[12:15], a[196:199], v[104:107]
    v_mfma_f32_16x16x32_bf16 v[112:115], v[12:15], a[200:203], v[112:115]
    v_mfma_f32_16x16x32_bf16 v[120:123], v[12:15], a[204:207], v[120:123]
    s_waitcnt lgkmcnt(3)
    v_mfma_f32_16x16x32_bf16 v[100:103], v[16:19], a[192:195], v[100:103]
    ds_read_b128 v[8:11], v4 offset:30720
    v_mfma_f32_16x16x32_bf16 v[108:111], v[16:19], a[196:199], v[108:111]
    v_mfma_f32_16x16x32_bf16 v[116:119], v[16:19], a[200:203], v[116:119]
    v_mfma_f32_16x16x32_bf16 v[124:127], v[16:19], a[204:207], v[124:127]
    s_waitcnt lgkmcnt(3)
    v_mfma_f32_16x16x32_bf16 v[128:131], v[20:23], a[64:67], v[128:131]
    ds_read_b128 v[12:15], v4 offset:31744
    v_mfma_f32_16x16x32_bf16 v[136:139], v[20:23], a[68:71], v[136:139]
    v_mfma_f32_16x16x32_bf16 v[144:147], v[20:23], a[72:75], v[144:147]
    v_mfma_f32_16x16x32_bf16 v[152:155], v[20:23], a[76:79], v[152:155]
    v_cvt_pk_bf16_f32 v96, v96, v97
    v_cvt_pk_bf16_f32 v97, v98, v99
    s_waitcnt lgkmcnt(3)
    v_mfma_f32_16x16x32_bf16 v[132:135], v[24:27], a[64:67], v[132:135]
    ds_read_b128 v[16:19], v4 offset:32768
    v_cvt_pk_bf16_f32 v98, v100, v101
    v_mfma_f32_16x16x32_bf16 v[140:143], v[24:27], a[68:71], v[140:143]
    v_cvt_pk_bf16_f32 v99, v102, v103
    s_add_u32 s70, s69, 2048
    v_mfma_f32_16x16x32_bf16 v[148:151], v[24:27], a[72:75], v[148:151]
    buffer_store_dwordx4 v[96:99], v2, s[4:7], s70 offen sc1
    v_cvt_pk_bf16_f32 v104, v104, v105
    v_mfma_f32_16x16x32_bf16 v[156:159], v[24:27], a[76:79], v[156:159]
    v_cvt_pk_bf16_f32 v105, v106, v107
    v_cvt_pk_bf16_f32 v106, v108, v109
    s_waitcnt lgkmcnt(3)
    v_mfma_f32_16x16x32_bf16 v[128:131], v[28:31], a[80:83], v[128:131]
    ds_read_b128 v[20:23], v4 offset:33792
    v_cvt_pk_bf16_f32 v107, v110, v111
    v_mfma_f32_16x16x32_bf16 v[136:139], v[28:31], a[84:87], v[136:139]
    s_add_u32 s70, s69, 20480
    buffer_store_dwordx4 v[104:107], v2, s[4:7], s70 offen sc1
    v_mfma_f32_16x16x32_bf16 v[144:147], v[28:31], a[88:91], v[144:147]
    v_cvt_pk_bf16_f32 v112, v112, v113
    v_cvt_pk_bf16_f32 v113, v114, v115
    v_mfma_f32_16x16x32_bf16 v[152:155], v[28:31], a[92:95], v[152:155]
    v_cvt_pk_bf16_f32 v114, v116, v117
    v_cvt_pk_bf16_f32 v115, v118, v119
    s_waitcnt lgkmcnt(3)
    v_mfma_f32_16x16x32_bf16 v[132:135], v[8:11], a[80:83], v[132:135]
    ds_read_b128 v[24:27], v4 offset:34816
    s_add_u32 s70, s69, 38912
    v_mfma_f32_16x16x32_bf16 v[140:143], v[8:11], a[84:87], v[140:143]
    buffer_store_dwordx4 v[112:115], v2, s[4:7], s70 offen sc1
    v_cvt_pk_bf16_f32 v120, v120, v121
    v_mfma_f32_16x16x32_bf16 v[148:151], v[8:11], a[88:91], v[148:151]
    v_cvt_pk_bf16_f32 v121, v122, v123
    v_cvt_pk_bf16_f32 v122, v124, v125
    v_mfma_f32_16x16x32_bf16 v[156:159], v[8:11], a[92:95], v[156:159]
    v_cvt_pk_bf16_f32 v123, v126, v127
    s_add_u32 s70, s69, 57344
    s_waitcnt lgkmcnt(3)
    v_mfma_f32_16x16x32_bf16 v[128:131], v[12:15], a[96:99], v[128:131]
    ds_read_b128 v[28:31], v4 offset:35840
    buffer_store_dwordx4 v[120:123], v2, s[4:7], s70 offen sc1
    v_mfma_f32_16x16x32_bf16 v[136:139], v[12:15], a[100:103], v[136:139]
    v_mfma_f32_16x16x32_bf16 v[144:147], v[12:15], a[104:107], v[144:147]
    v_mfma_f32_16x16x32_bf16 v[152:155], v[12:15], a[108:111], v[152:155]
    s_waitcnt lgkmcnt(3)
    v_mfma_f32_16x16x32_bf16 v[132:135], v[16:19], a[96:99], v[132:135]
    s_waitcnt vmcnt(12)
    s_barrier
    v_mfma_f32_16x16x32_bf16 v[140:143], v[16:19], a[100:103], v[140:143]
    v_add_u32 v4, 0x9000, v4
    ds_read_b128 v[8:11], v4 offset:0
    v_mfma_f32_16x16x32_bf16 v[148:151], v[16:19], a[104:107], v[148:151]
    v_mfma_f32_16x16x32_bf16 v[156:159], v[16:19], a[108:111], v[156:159]
    s_waitcnt lgkmcnt(3)
    v_mfma_f32_16x16x32_bf16 v[128:131], v[20:23], a[112:115], v[128:131]
    ds_read_b128 v[12:15], v4 offset:1024
    v_mfma_f32_16x16x32_bf16 v[136:139], v[20:23], a[116:119], v[136:139]
    v_mfma_f32_16x16x32_bf16 v[144:147], v[20:23], a[120:123], v[144:147]
    v_mfma_f32_16x16x32_bf16 v[152:155], v[20:23], a[124:127], v[152:155]
    s_waitcnt lgkmcnt(3)
    v_mfma_f32_16x16x32_bf16 v[132:135], v[24:27], a[112:115], v[132:135]
    ds_read_b128 v[16:19], v4 offset:2048
    v_mfma_f32_16x16x32_bf16 v[140:143], v[24:27], a[116:119], v[140:143]
    v_mfma_f32_16x16x32_bf16 v[148:151], v[24:27], a[120:123], v[148:151]
    v_mfma_f32_16x16x32_bf16 v[156:159], v[24:27], a[124:127], v[156:159]
    s_waitcnt lgkmcnt(3)
    v_mfma_f32_16x16x32_bf16 v[128:131], v[28:31], a[128:131], v[128:131]
    ds_read_b128 v[20:23], v4 offset:3072
    v_mfma_f32_16x16x32_bf16 v[136:139], v[28:31], a[132:135], v[136:139]
    v_mfma_f32_16x16x32_bf16 v[144:147], v[28:31], a[136:139], v[144:147]
    v_mfma_f32_16x16x32_bf16 v[152:155], v[28:31], a[140:143], v[152:155]
    s_waitcnt lgkmcnt(3)
    v_mfma_f32_16x16x32_bf16 v[132:135], v[8:11], a[128:131], v[132:135]
    ds_read_b128 v[24:27], v4 offset:4096
    v_mfma_f32_16x16x32_bf16 v[140:143], v[8:11], a[132:135], v[140:143]
    v_mfma_f32_16x16x32_bf16 v[148:151], v[8:11], a[136:139], v[148:151]
    v_mfma_f32_16x16x32_bf16 v[156:159], v[8:11], a[140:143], v[156:159]
    s_waitcnt lgkmcnt(3)
    v_mfma_f32_16x16x32_bf16 v[128:131], v[12:15], a[144:147], v[128:131]
    ds_read_b128 v[28:31], v4 offset:5120
    v_mfma_f32_16x16x32_bf16 v[136:139], v[12:15], a[148:151], v[136:139]
    v_mfma_f32_16x16x32_bf16 v[144:147], v[12:15], a[152:155], v[144:147]
    v_mfma_f32_16x16x32_bf16 v[152:155], v[12:15], a[156:159], v[152:155]
    s_waitcnt lgkmcnt(3)
    v_mfma_f32_16x16x32_bf16 v[132:135], v[16:19], a[144:147], v[132:135]
    ds_read_b128 v[8:11], v4 offset:6144
    v_mfma_f32_16x16x32_bf16 v[140:143], v[16:19], a[148:151], v[140:143]
    v_mfma_f32_16x16x32_bf16 v[148:151], v[16:19], a[152:155], v[148:151]
    v_mfma_f32_16x16x32_bf16 v[156:159], v[16:19], a[156:159], v[156:159]
    s_waitcnt lgkmcnt(3)
    v_mfma_f32_16x16x32_bf16 v[128:131], v[20:23], a[160:163], v[128:131]
    ds_read_b128 v[12:15], v4 offset:7168
    v_mfma_f32_16x16x32_bf16 v[136:139], v[20:23], a[164:167], v[136:139]
    v_mfma_f32_16x16x32_bf16 v[144:147], v[20:23], a[168:171], v[144:147]
    v_mfma_f32_16x16x32_bf16 v[152:155], v[20:23], a[172:175], v[152:155]
    s_waitcnt lgkmcnt(3)
    v_mfma_f32_16x16x32_bf16 v[132:135], v[24:27], a[160:163], v[132:135]
    ds_read_b128 v[16:19], v4 offset:8192
    v_mfma_f32_16x16x32_bf16 v[140:143], v[24:27], a[164:167], v[140:143]
    v_mfma_f32_16x16x32_bf16 v[148:151], v[24:27], a[168:171], v[148:151]
    v_mfma_f32_16x16x32_bf16 v[156:159], v[24:27], a[172:175], v[156:159]
    s_waitcnt lgkmcnt(3)
    v_mfma_f32_16x16x32_bf16 v[128:131], v[28:31], a[176:179], v[128:131]
    ds_read_b128 v[20:23], v4 offset:9216
    v_mfma_f32_16x16x32_bf16 v[136:139], v[28:31], a[180:183], v[136:139]
    v_mfma_f32_16x16x32_bf16 v[144:147], v[28:31], a[184:187], v[144:147]
    v_mfma_f32_16x16x32_bf16 v[152:155], v[28:31], a[188:191], v[152:155]
    s_waitcnt lgkmcnt(3)
    v_mfma_f32_16x16x32_bf16 v[132:135], v[8:11], a[176:179], v[132:135]
    ds_read_b128 v[24:27], v4 offset:10240
    v_mfma_f32_16x16x32_bf16 v[140:143], v[8:11], a[180:183], v[140:143]
    v_mfma_f32_16x16x32_bf16 v[148:151], v[8:11], a[184:187], v[148:151]
    v_mfma_f32_16x16x32_bf16 v[156:159], v[8:11], a[188:191], v[156:159]
    s_waitcnt lgkmcnt(3)
    v_mfma_f32_16x16x32_bf16 v[128:131], v[12:15], a[192:195], v[128:131]
    ds_read_b128 v[28:31], v4 offset:11264
    v_mfma_f32_16x16x32_bf16 v[136:139], v[12:15], a[196:199], v[136:139]
    v_mfma_f32_16x16x32_bf16 v[144:147], v[12:15], a[200:203], v[144:147]
    v_mfma_f32_16x16x32_bf16 v[152:155], v[12:15], a[204:207], v[152:155]
    s_waitcnt lgkmcnt(3)
    v_mfma_f32_16x16x32_bf16 v[132:135], v[16:19], a[192:195], v[132:135]
    ds_read_b128 v[8:11], v4 offset:12288
    v_mfma_f32_16x16x32_bf16 v[140:143], v[16:19], a[196:199], v[140:143]
    v_mfma_f32_16x16x32_bf16 v[148:151], v[16:19], a[200:203], v[148:151]
    v_mfma_f32_16x16x32_bf16 v[156:159], v[16:19], a[204:207], v[156:159]
    s_waitcnt lgkmcnt(3)
    v_mfma_f32_16x16x32_bf16 v[160:163], v[20:23], a[64:67], v[160:163]
    ds_read_b128 v[12:15], v4 offset:13312
    v_mfma_f32_16x16x32_bf16 v[164:167], v[20:23], a[68:71], v[164:167]
    v_mfma_f32_16x16x32_bf16 v[168:171], v[20:23], a[72:75], v[168:171]
    v_mfma_f32_16x16x32_bf16 v[172:175], v[20:23], a[76:79], v[172:175]
    v_cvt_pk_bf16_f32 v128, v128, v129
    v_cvt_pk_bf16_f32 v129, v130, v131
    s_waitcnt lgkmcnt(3)
    v_mfma_f32_16x16x32_bf16 v[160:163], v[24:27], a[80:83], v[160:163]
    ds_read_b128 v[16:19], v4 offset:14336
    v_cvt_pk_bf16_f32 v130, v132, v133
    v_mfma_f32_16x16x32_bf16 v[164:167], v[24:27], a[84:87], v[164:167]
    v_cvt_pk_bf16_f32 v131, v134, v135
    s_add_u32 s70, s69, 3072
    v_mfma_f32_16x16x32_bf16 v[168:171], v[24:27], a[88:91], v[168:171]
    buffer_store_dwordx4 v[128:131], v2, s[4:7], s70 offen sc1
    v_cvt_pk_bf16_f32 v136, v136, v137
    v_mfma_f32_16x16x32_bf16 v[172:175], v[24:27], a[92:95], v[172:175]
    v_cvt_pk_bf16_f32 v137, v138, v139
    v_cvt_pk_bf16_f32 v138, v140, v141
    s_waitcnt lgkmcnt(3)
    v_mfma_f32_16x16x32_bf16 v[160:163], v[28:31], a[96:99], v[160:163]
    ds_read_b128 v[20:23], v4 offset:15360
    v_cvt_pk_bf16_f32 v139, v142, v143
    v_mfma_f32_16x16x32_bf16 v[164:167], v[28:31], a[100:103], v[164:167]
    s_add_u32 s70, s69, 21504
    buffer_store_dwordx4 v[136:139], v2, s[4:7], s70 offen sc1
    v_mfma_f32_16x16x32_bf16 v[168:171], v[28:31], a[104:107], v[168:171]
    v_cvt_pk_bf16_f32 v144, v144, v145
    v_cvt_pk_bf16_f32 v145, v146, v147
    v_mfma_f32_16x16x32_bf16 v[172:175], v[28:31], a[108:111], v[172:175]
    v_cvt_pk_bf16_f32 v146, v148, v149
    v_cvt_pk_bf16_f32 v147, v150, v151
    s_waitcnt lgkmcnt(3)
    v_mfma_f32_16x16x32_bf16 v[160:163], v[8:11], a[112:115], v[160:163]
    ds_read_b128 v[24:27], v4 offset:16384
    s_add_u32 s70, s69, 39936
    v_mfma_f32_16x16x32_bf16 v[164:167], v[8:11], a[116:119], v[164:167]
    buffer_store_dwordx4 v[144:147], v2, s[4:7], s70 offen sc1
    v_cvt_pk_bf16_f32 v152, v152, v153
    v_mfma_f32_16x16x32_bf16 v[168:171], v[8:11], a[120:123], v[168:171]
    v_cvt_pk_bf16_f32 v153, v154, v155
    v_cvt_pk_bf16_f32 v154, v156, v157
    v_mfma_f32_16x16x32_bf16 v[172:175], v[8:11], a[124:127], v[172:175]
    v_cvt_pk_bf16_f32 v155, v158, v159
    s_add_u32 s70, s69, 58368
    s_waitcnt lgkmcnt(3)
    v_mfma_f32_16x16x32_bf16 v[160:163], v[12:15], a[128:131], v[160:163]
    ds_read_b128 v[28:31], v4 offset:17408
    buffer_store_dwordx4 v[152:155], v2, s[4:7], s70 offen sc1
    v_mfma_f32_16x16x32_bf16 v[164:167], v[12:15], a[132:135], v[164:167]
    v_mfma_f32_16x16x32_bf16 v[168:171], v[12:15], a[136:139], v[168:171]
    v_mfma_f32_16x16x32_bf16 v[172:175], v[12:15], a[140:143], v[172:175]
    s_waitcnt lgkmcnt(3)
    v_mfma_f32_16x16x32_bf16 v[160:163], v[16:19], a[144:147], v[160:163]
    v_mfma_f32_16x16x32_bf16 v[164:167], v[16:19], a[148:151], v[164:167]
    v_mfma_f32_16x16x32_bf16 v[168:171], v[16:19], a[152:155], v[168:171]
    v_mfma_f32_16x16x32_bf16 v[172:175], v[16:19], a[156:159], v[172:175]
    s_waitcnt lgkmcnt(2)
    v_mfma_f32_16x16x32_bf16 v[160:163], v[20:23], a[160:163], v[160:163]
    v_mfma_f32_16x16x32_bf16 v[164:167], v[20:23], a[164:167], v[164:167]
    v_mfma_f32_16x16x32_bf16 v[168:171], v[20:23], a[168:171], v[168:171]
    v_mfma_f32_16x16x32_bf16 v[172:175], v[20:23], a[172:175], v[172:175]
    s_waitcnt lgkmcnt(1)
    v_mfma_f32_16x16x32_bf16 v[160:163], v[24:27], a[176:179], v[160:163]
    v_mfma_f32_16x16x32_bf16 v[164:167], v[24:27], a[180:183], v[164:167]
    v_mfma_f32_16x16x32_bf16 v[168:171], v[24:27], a[184:187], v[168:171]
    v_mfma_f32_16x16x32_bf16 v[172:175], v[24:27], a[188:191], v[172:175]
    s_waitcnt lgkmcnt(0)
    v_mfma_f32_16x16x32_bf16 v[160:163], v[28:31], a[192:195], v[160:163]
    v_mfma_f32_16x16x32_bf16 v[164:167], v[28:31], a[196:199], v[164:167]
    v_mfma_f32_16x16x32_bf16 v[168:171], v[28:31], a[200:203], v[168:171]
    v_mfma_f32_16x16x32_bf16 v[172:175], v[28:31], a[204:207], v[172:175]
    s_nop 4
    v_cvt_pk_bf16_f32 v160, v160, v161
    v_cvt_pk_bf16_f32 v161, v162, v163
    s_add_u32 s70, s68, 4096
    buffer_store_dwordx2 v[160:161], v0, s[4:7], s70 offen sc1
    v_cvt_pk_bf16_f32 v164, v164, v165
    v_cvt_pk_bf16_f32 v165, v166, v167
    s_add_u32 s70, s68, 22528
    buffer_store_dwordx2 v[164:165], v0, s[4:7], s70 offen sc1
    v_cvt_pk_bf16_f32 v168, v168, v169
    v_cvt_pk_bf16_f32 v169, v170, v171
    s_add_u32 s70, s68, 40960
    buffer_store_dwordx2 v[168:169], v0, s[4:7], s70 offen sc1
    v_cvt_pk_bf16_f32 v172, v172, v173
    v_cvt_pk_bf16_f32 v173, v174, v175
    s_add_u32 s70, s68, 59392
    buffer_store_dwordx2 v[172:173], v0, s[4:7], s70 offen sc1
ffn1_kernel_end:
    s_endpgm
L_pa_slow_34:
    s_mov_b32 s64, 0x40000
L_spin_38:
    buffer_load_dword v6, v7, s[4:7], s52 offen sc1
    s_waitcnt vmcnt(0)
    v_cmp_le_u32 vcc, 1, v6
    s_sub_u32 s64, s64, 1
    s_cbranch_scc1 L_pa_back_35
    s_cmp_eq_u64 vcc, exec
    s_cbranch_scc1 L_pa_back_35
    s_branch L_spin_38
L_pb_slow_36:
    s_mov_b32 s64, 0x40000
L_spin_39:
    buffer_load_dword v6, v7, s[4:7], s52 offen sc1
    s_waitcnt vmcnt(0)
    v_cmp_le_u32 vcc, 2, v6
    s_sub_u32 s64, s64, 1
    s_cbranch_scc1 L_pb_back_37
    s_cmp_eq_u64 vcc, exec
    s_cbranch_scc1 L_pb_back_37
    s_branch L_spin_39
.section .rodata,"a"
.p2align 6
.amdhsa_kernel ffn1_kernel
  .amdhsa_next_free_vgpr 512
  .amdhsa_next_free_sgpr 102
  .amdhsa_accum_offset 256
  .amdhsa_group_segment_fixed_size 0
  .amdhsa_kernarg_size 80
  .amdhsa_user_sgpr_count 2
  .amdhsa_user_sgpr_kernarg_segment_ptr 1
  .amdhsa_system_sgpr_workgroup_id_x 1
  .amdhsa_float_denorm_mode_32 3
.end_amdhsa_kernel
.text
.globl red1_kernel
.p2align 8
.type red1_kernel,@function
red1_kernel:
    s_cmp_ge_u32 s2, 256
    s_cbranch_scc1 red1_kernel_end
    s_load_dwordx16 s[24:39], s[0:1], 0
    s_load_dwordx4 s[40:43], s[0:1], 64
    v_lshrrev_b32 v1, 6, v0
    s_and_b32 s21, s2, 7
    v_readfirstlane_b32 s20, v1
    s_lshr_b32 s22, s2, 3
    v_and_b32 v1, 63, v0
    v_lshlrev_b32 v2, 4, v1
    s_waitcnt lgkmcnt(0)
    s_mov_b32 s4, s42
    s_mov_b32 s5, s43
    s_mov_b32 s6, 0x10000000
    s_mov_b32 s7, 0x20000
    s_lshl_b32 s47, s21, 5
    s_add_u32 s47, s47, s22
    v_and_b32 v8, 7, v1
    v_lshrrev_b32 v9, 3, v1
    s_lshl_b32 s48, s47, 3
    v_add_u32 v3, s48, v8
    v_mul_u32_u24 v3, 1152, v3
    s_mul_i32 s48, s20, 384
    v_lshl_add_u32 v3, v9, 4, v3
    v_add_u32 v3, s48, v3
    s_lshr_b32 s48, s47, 1
    s_mul_i32 s48, s48, 18432
    s_and_b32 s49, s47, 1
    s_lshl_b32 s49, s49, 7
    s_add_u32 s48, s48, s49
    s_mul_i32 s49, s20, 6144
    s_add_u32 s48, s48, s49
    v_lshlrev_b32 v8, 4, v8
    v_lshl_add_u32 v8, v9, 8, v8
    v_add_u32 v4, s48, v8
    v_lshrrev_b32 v8, 3, v1
    v_and_b32 v9, 7, v1
    s_and_b32 s48, s47, 1
    s_lshl_b32 s48, s48, 3
    v_add_u32 v9, s48, v9
    v_lshlrev_b32 v9, 4, v9
    v_bfe_u32 v10, v8, 1, 1
    v_and_b32 v11, 1, v8
    v_lshl_add_u32 v9, v11, 4, v9
    v_lshl_add_u32 v9, v10, 9, v9
    v_and_b32 v10, 3, v8
    v_lshlrev_b32 v10, 8, v10
    v_sub_u32 v9, v9, v10
    s_mul_i32 s48, s20, 6
    v_lshrrev_b32 v8, 2, v8
    v_add_u32 v8, s48, v8
    v_add_u32 v10, 0, v8
    v_cmp_eq_u32 vcc, 4, v10
    v_cmp_eq_u32 s[56:57], 13, v10
    s_nop 0
    s_or_b64 vcc, vcc, s[56:57]
    v_cndmask_b32 v10, 0, v9, vcc
    v_add3_u32 v5, v4, v10, 0
    v_add_u32 v5, 0, v5
    v_add_u32 v10, 2, v8
    v_cmp_eq_u32 vcc, 4, v10
    v_cmp_eq_u32 s[56:57], 13, v10
    s_nop 0
    s_or_b64 vcc, vcc, s[56:57]
    v_cndmask_b32 v10, 0, v9, vcc
    v_add3_u32 v6, v4, v10, 0
    v_add_u32 v6, 2048, v6
    v_add_u32 v10, 4, v8
    v_cmp_eq_u32 vcc, 4, v10
    v_cmp_eq_u32 s[56:57], 13, v10
    s_nop 0
    s_or_b64 vcc, vcc, s[56:57]
    v_cndmask_b32 v10, 0, v9, vcc
    v_add3_u32 v7, v4, v10, 0
    v_add_u32 v7, 4096, v7
    s_cmp_eq_u32 s20, 3
    s_cbranch_scc1 L_w3a_40
    s_mov_b32 s48, 76021760
    buffer_load_dwordx4 v[16:19], v4, s[4:7], s48 offen offset:0
    buffer_load_dwordx4 v[52:55], v4, s[4:7], s48 offen offset:2048
    s_add_u32 s48, s48, 4096
    buffer_load_dwordx4 v[88:91], v4, s[4:7], s48 offen offset:0
    s_mov_b32 s48, 100663296
    buffer_load_dwordx4 v[20:23], v5, s[4:7], s48 offen
    buffer_load_dwordx4 v[56:59], v6, s[4:7], s48 offen
    buffer_load_dwordx4 v[92:95], v7, s[4:7], s48 offen
    s_mov_b32 s48, 103022592
    buffer_load_dwordx4 v[24:27], v5, s[4:7], s48 offen
    buffer_load_dwordx4 v[60:63], v6, s[4:7], s48 offen
    buffer_load_dwordx4 v[96:99], v7, s[4:7], s48 offen
    s_mov_b32 s48, 105381888
    buffer_load_dwordx4 v[28:31], v5, s[4:7], s48 offen
    buffer_load_dwordx4 v[64:67], v6, s[4:7], s48 offen
    buffer_load_dwordx4 v[100:103], v7, s[4:7], s48 offen
    s_mov_b32 s48, 107741184
    buffer_load_dwordx4 v[32:35], v5, s[4:7], s48 offen
    buffer_load_dwordx4 v[68:71], v6, s[4:7], s48 offen
    buffer_load_dwordx4 v[104:107], v7, s[4:7], s48 offen
    s_mov_b32 s48, 110100480
    buffer_load_dwordx4 v[36:39], v5, s[4:7], s48 offen
    buffer_load_dwordx4 v[72:75], v6, s[4:7], s48 offen
    buffer_load_dwordx4 v[108:111], v7, s[4:7], s48 offen
    s_mov_b32 s48, 112459776
    buffer_load_dwordx4 v[40:43], v5, s[4:7], s48 offen
    buffer_load_dwordx4 v[76:79], v6, s[4:7], s48 offen
    buffer_load_dwordx4 v[112:115], v7, s[4:7], s48 offen
    s_mov_b32 s48, 114819072
    buffer_load_dwordx4 v[44:47], v5, s[4:7], s48 offen
    buffer_load_dwordx4 v[80:83], v6, s[4:7], s48 offen
    buffer_load_dwordx4 v[116:119], v7, s[4:7], s48 offen
    s_mov_b32 s48, 117178368
    buffer_load_dwordx4 v[48:51], v5, s[4:7], s48 offen
    buffer_load_dwordx4 v[84:87], v6, s[4:7], s48 offen
    buffer_load_dwordx4 v[120:123], v7, s[4:7], s48 offen
    s_waitcnt vmcnt(26)
    v_lshlrev_b32 v128, 16, v16
    v_and_b32 v129, 0xffff0000, v16
    v_lshlrev_b32 v130, 16, v17
    v_and_b32 v131, 0xffff0000, v17
    v_lshlrev_b32 v132, 16, v18
    v_and_b32 v133, 0xffff0000, v18
    v_lshlrev_b32 v134, 16, v19
    v_and_b32 v135, 0xffff0000, v19
    s_waitcnt vmcnt(25)
    v_lshlrev_b32 v136, 16, v52
    v_and_b32 v137, 0xffff0000, v52
    v_lshlrev_b32 v138, 16, v53
    v_and_b32 v139, 0xffff0000, v53
    v_lshlrev_b32 v140, 16, v54
    v_and_b32 v141, 0xffff0000, v54
    v_lshlrev_b32 v142, 16, v55
    v_and_b32 v143, 0xffff0000, v55
    s_waitcnt vmcnt(24)
    v_lshlrev_b32 v144, 16, v88
    v_and_b32 v145, 0xffff0000, v88
    v_lshlrev_b32 v146, 16, v89
    v_and_b32 v147, 0xffff0000, v89
    v_lshlrev_b32 v148, 16, v90
    v_and_b32 v149, 0xffff0000, v90
    v_lshlrev_b32 v150, 16, v91
    v_and_b32 v151, 0xffff0000, v91
    s_waitcnt vmcnt(23)
    v_lshlrev_b32 v8, 16, v20
    v_and_b32 v9, 0xffff0000, v20
    v_add_f32 v128, v128, v8
    v_add_f32 v129, v129, v9
    v_lshlrev_b32 v10, 16, v21
    v_and_b32 v11, 0xffff0000, v21
    v_add_f32 v130, v130, v10
    v_add_f32 v131, v131, v11
    v_lshlrev_b32 v8, 16, v22
    v_and_b32 v9, 0xffff0000, v22
    v_add_f32 v132, v132, v8
    v_add_f32 v133, v133, v9
    v_lshlrev_b32 v10, 16, v23
    v_and_b32 v11, 0xffff0000, v23
    v_add_f32 v134, v134, v10
    v_add_f32 v135, v135, v11
    s_waitcnt vmcnt(22)
    v_lshlrev_b32 v8, 16, v56
    v_and_b32 v9, 0xffff0000, v56
    v_add_f32 v136, v136, v8
    v_add_f32 v137, v137, v9
    v_lshlrev_b32 v10, 16, v57
    v_and_b32 v11, 0xffff0000, v57
    v_add_f32 v138, v138, v10
    v_add_f32 v139, v139, v11
    v_lshlrev_b32 v8, 16, v58
    v_and_b32 v9, 0xffff0000, v58
    v_add_f32 v140, v140, v8
    v_add_f32 v141, v141, v9
    v_lshlrev_b32 v10, 16, v59
    v_and_b32 v11, 0xffff0000, v59
    v_add_f32 v142, v142, v10
    v_add_f32 v143, v143, v11
    s_waitcnt vmcnt(21)
    v_lshlrev_b32 v8, 16, v92
    v_and_b32 v9, 0xffff0000, v92
    v_add_f32 v144, v144, v8
    v_add_f32 v145, v145, v9
    v_lshlrev_b32 v10, 16, v93
    v_and_b32 v11, 0xffff0000, v93
    v_add_f32 v146, v146, v10
    v_add_f32 v147, v147, v11
    v_lshlrev_b32 v8, 16, v94
    v_and_b32 v9, 0xffff0000, v94
    v_add_f32 v148, v148, v8
    v_add_f32 v149, v149, v9
    v_lshlrev_b32 v10, 16, v95
    v_and_b32 v11, 0xffff0000, v95
    v_add_f32 v150, v150, v10
    v_add_f32 v151, v151, v11
    s_waitcnt vmcnt(20)
    v_lshlrev_b32 v8, 16, v24
    v_and_b32 v9, 0xffff0000, v24
    v_add_f32 v128, v128, v8
    v_add_f32 v129, v129, v9
    v_lshlrev_b32 v10, 16, v25
    v_and_b32 v11, 0xffff0000, v25
    v_add_f32 v130, v130, v10
    v_add_f32 v131, v131, v11
    v_lshlrev_b32 v8, 16, v26
    v_and_b32 v9, 0xffff0000, v26
    v_add_f32 v132, v132, v8
    v_add_f32 v133, v133, v9
    v_lshlrev_b32 v10, 16, v27
    v_and_b32 v11, 0xffff0000, v27
    v_add_f32 v134, v134, v10
    v_add_f32 v135, v135, v11
    s_waitcnt vmcnt(19)
    v_lshlrev_b32 v8, 16, v60
    v_and_b32 v9, 0xffff0000, v60
    v_add_f32 v136, v136, v8
    v_add_f32 v137, v137, v9
    v_lshlrev_b32 v10, 16, v61
    v_and_b32 v11, 0xffff0000, v61
    v_add_f32 v138, v138, v10
    v_add_f32 v139, v139, v11
    v_lshlrev_b32 v8, 16, v62
    v_and_b32 v9, 0xffff0000, v62
    v_add_f32 v140, v140, v8
    v_add_f32 v141, v141, v9
    v_lshlrev_b32 v10, 16, v63
    v_and_b32 v11, 0xffff0000, v63
    v_add_f32 v142, v142, v10
    v_add_f32 v143, v143, v11
    s_waitcnt vmcnt(18)
    v_lshlrev_b32 v8, 16, v96
    v_and_b32 v9, 0xffff0000, v96
    v_add_f32 v144, v144, v8
    v_add_f32 v145, v145, v9
    v_lshlrev_b32 v10, 16, v97
    v_and_b32 v11, 0xffff0000, v97
    v_add_f32 v146, v146, v10
    v_add_f32 v147, v147, v11
    v_lshlrev_b32 v8, 16, v98
    v_and_b32 v9, 0xffff0000, v98
    v_add_f32 v148, v148, v8
    v_add_f32 v149, v149, v9
    v_lshlrev_b32 v10, 16, v99
    v_and_b32 v11, 0xffff0000, v99
    v_add_f32 v150, v150, v10
    v_add_f32 v151, v151, v11
    s_waitcnt vmcnt(17)
    v_lshlrev_b32 v8, 16, v28
    v_and_b32 v9, 0xffff0000, v28
    v_add_f32 v128, v128, v8
    v_add_f32 v129, v129, v9
    v_lshlrev_b32 v10, 16, v29
    v_and_b32 v11, 0xffff0000, v29
    v_add_f32 v130, v130, v10
    v_add_f32 v131, v131, v11
    v_lshlrev_b32 v8, 16, v30
    v_and_b32 v9, 0xffff0000, v30
    v_add_f32 v132, v132, v8
    v_add_f32 v133, v133, v9
    v_lshlrev_b32 v10, 16, v31
    v_and_b32 v11, 0xffff0000, v31
    v_add_f32 v134, v134, v10
    v_add_f32 v135, v135, v11
    s_waitcnt vmcnt(16)
    v_lshlrev_b32 v8, 16, v64
    v_and_b32 v9, 0xffff0000, v64
    v_add_f32 v136, v136, v8
    v_add_f32 v137, v137, v9
    v_lshlrev_b32 v10, 16, v65
    v_and_b32 v11, 0xffff0000, v65
    v_add_f32 v138, v138, v10
    v_add_f32 v139, v139, v11
    v_lshlrev_b32 v8, 16, v66
    v_and_b32 v9, 0xffff0000, v66
    v_add_f32 v140, v140, v8
    v_add_f32 v141, v141, v9
    v_lshlrev_b32 v10, 16, v67
    v_and_b32 v11, 0xffff0000, v67
    v_add_f32 v142, v142, v10
    v_add_f32 v143, v143, v11
    s_waitcnt vmcnt(15)
    v_lshlrev_b32 v8, 16, v100
    v_and_b32 v9, 0xffff0000, v100
    v_add_f32 v144, v144, v8
    v_add_f32 v145, v145, v9
    v_lshlrev_b32 v10, 16, v101
    v_and_b32 v11, 0xffff0000, v101
    v_add_f32 v146, v146, v10
    v_add_f32 v147, v147, v11
    v_lshlrev_b32 v8, 16, v102
    v_and_b32 v9, 0xffff0000, v102
    v_add_f32 v148, v148, v8
    v_add_f32 v149, v149, v9
    v_lshlrev_b32 v10, 16, v103
    v_and_b32 v11, 0xffff0000, v103
    v_add_f32 v150, v150, v10
    v_add_f32 v151, v151, v11
    s_waitcnt vmcnt(14)
    v_lshlrev_b32 v8, 16, v32
    v_and_b32 v9, 0xffff0000, v32
    v_add_f32 v128, v128, v8
    v_add_f32 v129, v129, v9
    v_lshlrev_b32 v10, 16, v33
    v_and_b32 v11, 0xffff0000, v33
    v_add_f32 v130, v130, v10
    v_add_f32 v131, v131, v11
    v_lshlrev_b32 v8, 16, v34
    v_and_b32 v9, 0xffff0000, v34
    v_add_f32 v132, v132, v8
    v_add_f32 v133, v133, v9
    v_lshlrev_b32 v10, 16, v35
    v_and_b32 v11, 0xffff0000, v35
    v_add_f32 v134, v134, v10
    v_add_f32 v135, v135, v11
    s_waitcnt vmcnt(13)
    v_lshlrev_b32 v8, 16, v68
    v_and_b32 v9, 0xffff0000, v68
    v_add_f32 v136, v136, v8
    v_add_f32 v137, v137, v9
    v_lshlrev_b32 v10, 16, v69
    v_and_b32 v11, 0xffff0000, v69
    v_add_f32 v138, v138, v10
    v_add_f32 v139, v139, v11
    v_lshlrev_b32 v8, 16, v70
    v_and_b32 v9, 0xffff0000, v70
    v_add_f32 v140, v140, v8
    v_add_f32 v141, v141, v9
    v_lshlrev_b32 v10, 16, v71
    v_and_b32 v11, 0xffff0000, v71
    v_add_f32 v142, v142, v10
    v_add_f32 v143, v143, v11
    s_waitcnt vmcnt(12)
    v_lshlrev_b32 v8, 16, v104
    v_and_b32 v9, 0xffff0000, v104
    v_add_f32 v144, v144, v8
    v_add_f32 v145, v145, v9
    v_lshlrev_b32 v10, 16, v105
    v_and_b32 v11, 0xffff0000, v105
    v_add_f32 v146, v146, v10
    v_add_f32 v147, v147, v11
    v_lshlrev_b32 v8, 16, v106
    v_and_b32 v9, 0xffff0000, v106
    v_add_f32 v148, v148, v8
    v_add_f32 v149, v149, v9
    v_lshlrev_b32 v10, 16, v107
    v_and_b32 v11, 0xffff0000, v107
    v_add_f32 v150, v150, v10
    v_add_f32 v151, v151, v11
    s_waitcnt vmcnt(11)
    v_lshlrev_b32 v8, 16, v36
    v_and_b32 v9, 0xffff0000, v36
    v_add_f32 v128, v128, v8
    v_add_f32 v129, v129, v9
    v_lshlrev_b32 v10, 16, v37
    v_and_b32 v11, 0xffff0000, v37
    v_add_f32 v130, v130, v10
    v_add_f32 v131, v131, v11
    v_lshlrev_b32 v8, 16, v38
    v_and_b32 v9, 0xffff0000, v38
    v_add_f32 v132, v132, v8
    v_add_f32 v133, v133, v9
    v_lshlrev_b32 v10, 16, v39
    v_and_b32 v11, 0xffff0000, v39
    v_add_f32 v134, v134, v10
    v_add_f32 v135, v135, v11
    s_waitcnt vmcnt(10)
    v_lshlrev_b32 v8, 16, v72
    v_and_b32 v9, 0xffff0000, v72
    v_add_f32 v136, v136, v8
    v_add_f32 v137, v137, v9
    v_lshlrev_b32 v10, 16, v73
    v_and_b32 v11, 0xffff0000, v73
    v_add_f32 v138, v138, v10
    v_add_f32 v139, v139, v11
    v_lshlrev_b32 v8, 16, v74
    v_and_b32 v9, 0xffff0000, v74
    v_add_f32 v140, v140, v8
    v_add_f32 v141, v141, v9
    v_lshlrev_b32 v10, 16, v75
    v_and_b32 v11, 0xffff0000, v75
    v_add_f32 v142, v142, v10
    v_add_f32 v143, v143, v11
    s_waitcnt vmcnt(9)
    v_lshlrev_b32 v8, 16, v108
    v_and_b32 v9, 0xffff0000, v108
    v_add_f32 v144, v144, v8
    v_add_f32 v145, v145, v9
    v_lshlrev_b32 v10, 16, v109
    v_and_b32 v11, 0xffff0000, v109
    v_add_f32 v146, v146, v10
    v_add_f32 v147, v147, v11
    v_lshlrev_b32 v8, 16, v110
    v_and_b32 v9, 0xffff0000, v110
    v_add_f32 v148, v148, v8
    v_add_f32 v149, v149, v9
    v_lshlrev_b32 v10, 16, v111
    v_and_b32 v11, 0xffff0000, v111
    v_add_f32 v150, v150, v10
    v_add_f32 v151, v151, v11
    s_waitcnt vmcnt(8)
    v_lshlrev_b32 v8, 16, v40
    v_and_b32 v9, 0xffff0000, v40
    v_add_f32 v128, v128, v8
    v_add_f32 v129, v129, v9
    v_lshlrev_b32 v10, 16, v41
    v_and_b32 v11, 0xffff0000, v41
    v_add_f32 v130, v130, v10
    v_add_f32 v131, v131, v11
    v_lshlrev_b32 v8, 16, v42
    v_and_b32 v9, 0xffff0000, v42
    v_add_f32 v132, v132, v8
    v_add_f32 v133, v133, v9
    v_lshlrev_b32 v10, 16, v43
    v_and_b32 v11, 0xffff0000, v43
    v_add_f32 v134, v134, v10
    v_add_f32 v135, v135, v11
    s_waitcnt vmcnt(7)
    v_lshlrev_b32 v8, 16, v76
    v_and_b32 v9, 0xffff0000, v76
    v_add_f32 v136, v136, v8
    v_add_f32 v137, v137, v9
    v_lshlrev_b32 v10, 16, v77
    v_and_b32 v11, 0xffff0000, v77
    v_add_f32 v138, v138, v10
    v_add_f32 v139, v139, v11
    v_lshlrev_b32 v8, 16, v78
    v_and_b32 v9, 0xffff0000, v78
    v_add_f32 v140, v140, v8
    v_add_f32 v141, v141, v9
    v_lshlrev_b32 v10, 16, v79
    v_and_b32 v11, 0xffff0000, v79
    v_add_f32 v142, v142, v10
    v_add_f32 v143, v143, v11
    s_waitcnt vmcnt(6)
    v_lshlrev_b32 v8, 16, v112
    v_and_b32 v9, 0xffff0000, v112
    v_add_f32 v144, v144, v8
    v_add_f32 v145, v145, v9
    v_lshlrev_b32 v10, 16, v113
    v_and_b32 v11, 0xffff0000, v113
    v_add_f32 v146, v146, v10
    v_add_f32 v147, v147, v11
    v_lshlrev_b32 v8, 16, v114
    v_and_b32 v9, 0xffff0000, v114
    v_add_f32 v148, v148, v8
    v_add_f32 v149, v149, v9
    v_lshlrev_b32 v10, 16, v115
    v_and_b32 v11, 0xffff0000, v115
    v_add_f32 v150, v150, v10
    v_add_f32 v151, v151, v11
    s_waitcnt vmcnt(5)
    v_lshlrev_b32 v8, 16, v44
    v_and_b32 v9, 0xffff0000, v44
    v_add_f32 v128, v128, v8
    v_add_f32 v129, v129, v9
    v_lshlrev_b32 v10, 16, v45
    v_and_b32 v11, 0xffff0000, v45
    v_add_f32 v130, v130, v10
    v_add_f32 v131, v131, v11
    v_lshlrev_b32 v8, 16, v46
    v_and_b32 v9, 0xffff0000, v46
    v_add_f32 v132, v132, v8
    v_add_f32 v133, v133, v9
    v_lshlrev_b32 v10, 16, v47
    v_and_b32 v11, 0xffff0000, v47
    v_add_f32 v134, v134, v10
    v_add_f32 v135, v135, v11
    s_waitcnt vmcnt(4)
    v_lshlrev_b32 v8, 16, v80
    v_and_b32 v9, 0xffff0000, v80
    v_add_f32 v136, v136, v8
    v_add_f32 v137, v137, v9
    v_lshlrev_b32 v10, 16, v81
    v_and_b32 v11, 0xffff0000, v81
    v_add_f32 v138, v138, v10
    v_add_f32 v139, v139, v11
    v_lshlrev_b32 v8, 16, v82
    v_and_b32 v9, 0xffff0000, v82
    v_add_f32 v140, v140, v8
    v_add_f32 v141, v141, v9
    v_lshlrev_b32 v10, 16, v83
    v_and_b32 v11, 0xffff0000, v83
    v_add_f32 v142, v142, v10
    v_add_f32 v143, v143, v11
    s_waitcnt vmcnt(3)
    v_lshlrev_b32 v8, 16, v116
    v_and_b32 v9, 0xffff0000, v116
    v_add_f32 v144, v144, v8
    v_add_f32 v145, v145, v9
    v_lshlrev_b32 v10, 16, v117
    v_and_b32 v11, 0xffff0000, v117
    v_add_f32 v146, v146, v10
    v_add_f32 v147, v147, v11
    v_lshlrev_b32 v8, 16, v118
    v_and_b32 v9, 0xffff0000, v118
    v_add_f32 v148, v148, v8
    v_add_f32 v149, v149, v9
    v_lshlrev_b32 v10, 16, v119
    v_and_b32 v11, 0xffff0000, v119
    v_add_f32 v150, v150, v10
    v_add_f32 v151, v151, v11
    s_waitcnt vmcnt(2)
    v_lshlrev_b32 v8, 16, v48
    v_and_b32 v9, 0xffff0000, v48
    v_add_f32 v128, v128, v8
    v_add_f32 v129, v129, v9
    v_lshlrev_b32 v10, 16, v49
    v_and_b32 v11, 0xffff0000, v49
    v_add_f32 v130, v130, v10
    v_add_f32 v131, v131, v11
    v_lshlrev_b32 v8, 16, v50
    v_and_b32 v9, 0xffff0000, v50
    v_add_f32 v132, v132, v8
    v_add_f32 v133, v133, v9
    v_lshlrev_b32 v10, 16, v51
    v_and_b32 v11, 0xffff0000, v51
    v_add_f32 v134, v134, v10
    v_add_f32 v135, v135, v11
    s_waitcnt vmcnt(1)
    v_lshlrev_b32 v8, 16, v84
    v_and_b32 v9, 0xffff0000, v84
    v_add_f32 v136, v136, v8
    v_add_f32 v137, v137, v9
    v_lshlrev_b32 v10, 16, v85
    v_and_b32 v11, 0xffff0000, v85
    v_add_f32 v138, v138, v10
    v_add_f32 v139, v139, v11
    v_lshlrev_b32 v8, 16, v86
    v_and_b32 v9, 0xffff0000, v86
    v_add_f32 v140, v140, v8
    v_add_f32 v141, v141, v9
    v_lshlrev_b32 v10, 16, v87
    v_and_b32 v11, 0xffff0000, v87
    v_add_f32 v142, v142, v10
    v_add_f32 v143, v143, v11
    s_waitcnt vmcnt(0)
    v_lshlrev_b32 v8, 16, v120
    v_and_b32 v9, 0xffff0000, v120
    v_add_f32 v144, v144, v8
    v_add_f32 v145, v145, v9
    v_lshlrev_b32 v10, 16, v121
    v_and_b32 v11, 0xffff0000, v121
    v_add_f32 v146, v146, v10
    v_add_f32 v147, v147, v11
    v_lshlrev_b32 v8, 16, v122
    v_and_b32 v9, 0xffff0000, v122
    v_add_f32 v148, v148, v8
    v_add_f32 v149, v149, v9
    v_lshlrev_b32 v10, 16, v123
    v_and_b32 v11, 0xffff0000, v123
    v_add_f32 v150, v150, v10
    v_add_f32 v151, v151, v11
    s_mov_b32 s16, s38
    s_mov_b32 s17, s39
    s_mov_b32 s18, 0x240000
    s_mov_b32 s19, 0x20000
    v_cvt_pk_bf16_f32 v160, v128, v129
    v_cvt_pk_bf16_f32 v161, v130, v131
    v_cvt_pk_bf16_f32 v162, v132, v133
    v_cvt_pk_bf16_f32 v163, v134, v135
    buffer_store_dwordx4 v[160:163], v3, s[16:19], 0 offen offset:0
    v_cvt_pk_bf16_f32 v164, v136, v137
    v_cvt_pk_bf16_f32 v165, v138, v139
    v_cvt_pk_bf16_f32 v166, v140, v141
    v_cvt_pk_bf16_f32 v167, v142, v143
    buffer_store_dwordx4 v[164:167], v3, s[16:19], 0 offen offset:128
    v_cvt_pk_bf16_f32 v168, v144, v145
    v_cvt_pk_bf16_f32 v169, v146, v147
    v_cvt_pk_bf16_f32 v170, v148, v149
    v_cvt_pk_bf16_f32 v171, v150, v151
    buffer_store_dwordx4 v[168:171], v3, s[16:19], 0 offen offset:256
L_w3a_40:
red1_kernel_end:
    s_endpgm
.section .rodata,"a"
.p2align 6
.amdhsa_kernel red1_kernel
  .amdhsa_next_free_vgpr 176
  .amdhsa_next_free_sgpr 102
  .amdhsa_accum_offset 176
  .amdhsa_group_segment_fixed_size 0
  .amdhsa_kernarg_size 80
  .amdhsa_user_sgpr_count 2
  .amdhsa_user_sgpr_kernarg_segment_ptr 1
  .amdhsa_system_sgpr_workgroup_id_x 1
  .amdhsa_float_denorm_mode_32 3
.end_amdhsa_kernel
```

```asm
; @launch kernel=prep_kernel grid=(256,1,1) block=(256,1,1) lds=73984
; @launch kernel=qkv0_kernel grid=(256,1,1) block=(256,1,1) lds=162816
; @launch kernel=wo0_kernel grid=(256,1,1) block=(256,1,1) lds=110592
; @launch kernel=ffn0_kernel grid=(256,1,1) block=(256,1,1) lds=149504
; @launch kernel=red0_kernel grid=(256,1,1) block=(256,1,1) lds=256
; @launch kernel=qkv1_kernel grid=(256,1,1) block=(256,1,1) lds=162816
; @launch kernel=wo1_kernel grid=(256,1,1) block=(256,1,1) lds=110592
; @launch kernel=ffn1_kernel grid=(256,1,1) block=(256,1,1) lds=149504
; @launch kernel=red1_kernel grid=(256,1,1) block=(256,1,1) lds=256
.amdgcn_target "amdgcn-amd-amdhsa--gfx950"
.text
.globl prep_kernel
.p2align 8
.type prep_kernel,@function
prep_kernel:
    s_cmp_ge_u32 s2, 256
    s_cbranch_scc1 prep_kernel_end
    s_load_dwordx16 s[24:39], s[0:1], 0
    s_load_dwordx4 s[40:43], s[0:1], 64
    v_lshrrev_b32 v1, 6, v0
    s_and_b32 s21, s2, 7
    v_readfirstlane_b32 s20, v1
    s_lshr_b32 s22, s2, 3
    v_and_b32 v1, 63, v0
    v_lshlrev_b32 v2, 4, v1
    v_lshlrev_b32 v3, 7, v0
    s_getpc_b64 s[16:17]
L_pc_1:
    v_min_u32 v4, prep_kernel_end-L_pc_1, v3
    global_load_dword v4, v4, s[16:17]
    s_waitcnt lgkmcnt(0)
    s_mov_b32 s4, s42
    s_mov_b32 s5, s43
    s_mov_b32 s6, 0x10000000
    s_mov_b32 s7, 0x20000
    s_mov_b32 s8, s24
    s_mov_b32 s9, s25
    s_mov_b32 s10, 0x240000
    s_mov_b32 s11, 0x20000
    s_lshl_b32 s46, s2, 10
    s_add_u32 s46, s46, 3932160
    v_lshlrev_b32 v5, 2, v0
    v_mov_b32 v6, 0
    buffer_store_dword v6, v5, s[4:7], s46 offen
    s_lshl_b32 s47, s21, 5
    s_add_u32 s47, s47, s22
    v_and_b32 v5, 7, v1
    v_lshrrev_b32 v6, 3, v1
    s_lshl_b32 s48, s47, 3
    v_add_u32 v3, s48, v5
    v_mul_u32_u24 v3, 1152, v3
    s_mul_i32 s48, s20, 384
    v_lshl_add_u32 v3, v6, 4, v3
    v_add_u32 v3, s48, v3
    s_lshr_b32 s48, s47, 1
    s_mul_i32 s48, s48, 18432
    s_and_b32 s49, s47, 1
    s_lshl_b32 s49, s49, 7
    s_add_u32 s48, s48, s49
    s_mul_i32 s49, s20, 6144
    s_add_u32 s48, s48, s49
    v_lshlrev_b32 v5, 4, v5
    v_lshl_add_u32 v5, v6, 8, v5
    s_waitcnt vmcnt(1)
    v_add_u32 v4, s48, v5
    buffer_load_dwordx4 v[8:11], v3, s[8:11], 0 offen offset:0
    buffer_load_dwordx4 v[12:15], v3, s[8:11], 0 offen offset:128
    buffer_load_dwordx4 v[16:19], v3, s[8:11], 0 offen offset:256
    s_lshl_b32 s23, s2, 2
    s_add_u32 s23, s23, s20
    s_mul_i32 s94, s20, 18432
    s_add_u32 s94, s94, 256
    s_add_u32 s95, s94, 9216
    s_cmp_ge_u32 s23, 1152
    s_cbranch_scc1 L_ud_4
    s_mul_i32 s56, s23, 1821
    s_lshr_b32 s56, s56, 16
    s_mul_i32 s86, s56, 36
    s_sub_u32 s86, s23, s86
    s_and_b32 s87, s86, 1
    s_lshr_b32 s88, s86, 1
    s_cmp_eq_u32 s87, 0
    s_cselect_b32 s12, s32, s34
    s_cselect_b32 s13, s33, s35
    s_mul_i32 s50, s88, 294912
    s_mul_i32 s89, s56, 288
    s_add_u32 s50, s50, s89
    s_mov_b32 s51, 73728
    s_mov_b32 s52, 36864
    s_mov_b32 s53, 9216
    s_mov_b32 s54, 0
    s_mov_b32 s55, 256
    s_mul_i32 s89, s56, 486
    s_add_u32 s89, s89, s86
    s_lshl_b32 s89, s89, 10
    s_add_u32 s89, s89, 4194304
    s_add_u32 s58, s89, 36864
    s_add_u32 s59, s89, 73728
    s_add_u32 s60, s89, 110592
    s_add_u32 s61, s89, 147456
    s_add_u32 s62, s89, 184320
    s_add_u32 s63, s89, 221184
    s_add_u32 s64, s89, 258048
    s_add_u32 s65, s89, 294912
    s_add_u32 s66, s89, 0
    s_lshl_b32 s89, s56, 1
    s_add_u32 s89, s89, s87
    s_mul_i32 s89, s89, 18
    s_add_u32 s89, s89, s88
    s_mul_i32 s89, s89, 576
    s_add_u32 s57, s89, 2883584
    s_branch L_udone_5
L_ud_4:
    s_sub_u32 s86, s23, 1152
    s_mul_i32 s56, s86, 3641
    s_lshr_b32 s56, s56, 16
    s_mul_i32 s87, s56, 18
    s_sub_u32 s86, s86, s87
    s_mov_b32 s12, s36
    s_mov_b32 s13, s37
    s_mov_b32 s57, 0
    s_mov_b32 s53, 1152
    s_and_b32 s87, s56, 3
    s_and_b32 s88, s87, 1
    s_lshl_b32 s54, s88, 5
    s_cmp_eq_u32 s88, 0
    s_cselect_b32 s55, 256, 0
    s_mov_b32 s91, -165888
    s_cselect_b32 s91, 165888, s91
    s_mov_b32 s51, 9216
    s_mov_b32 s52, 4608
    s_cmp_ge_u32 s86, 4
    s_cbranch_scc1 L_ush_6
    s_mov_b32 s89, s87
    s_lshl_b32 s90, s86, 5
    s_branch L_urows_8
L_ush_6:
    s_cmp_ge_u32 s86, 6
    s_cbranch_scc1 L_urm_7
    s_sub_u32 s89, s86, 4
    s_lshl_b32 s89, s89, 1
    s_xor_b32 s89, s89, s87
    s_mov_b32 s90, 128
    s_mov_b32 s51, 4608
    s_mov_b32 s52, s91
    s_branch L_urows_8
L_urm_7:
    s_sub_u32 s89, s86, 6
    s_mul_i32 s90, s89, 21846
    s_lshr_b32 s90, s90, 16
    s_mul_i32 s91, s90, 3
    s_sub_u32 s89, s89, s91
    s_add_u32 s89, s89, 1
    s_xor_b32 s89, s89, s87
    s_lshl_b32 s90, s90, 5
L_urows_8:
    s_mul_i32 s89, s89, 144
    s_add_u32 s89, s89, s90
    s_lshr_b32 s90, s56, 2
    s_mul_i32 s90, s90, 576
    s_add_u32 s89, s89, s90
    s_mul_i32 s89, s89, 1152
    s_mul_i32 s90, s87, 288
    s_add_u32 s50, s89, s90
    s_mul_i32 s89, s56, 486
    s_add_u32 s89, s89, 324
    s_lshl_b32 s89, s89, 10
    s_add_u32 s89, s89, 4194304
    s_cmp_ge_u32 s86, 3
    s_cbranch_scc1 L_ub_9
    s_sub_u32 s90, s86, 0
    s_mul_i32 s91, s90, 4096
    s_add_u32 s91, s91, 0
    s_add_u32 s58, s91, s89
    s_mul_i32 s91, s90, 4096
    s_add_u32 s91, s91, 1024
    s_add_u32 s59, s91, s89
    s_mul_i32 s91, s90, 4096
    s_add_u32 s91, s91, 2048
    s_add_u32 s60, s91, s89
    s_mul_i32 s91, s90, 4096
    s_add_u32 s91, s91, 3072
    s_add_u32 s61, s91, s89
    s_mul_i32 s91, s90, 5120
    s_add_u32 s91, s91, 12288
    s_add_u32 s62, s91, s89
    s_mul_i32 s91, s90, 5120
    s_add_u32 s91, s91, 13312
    s_add_u32 s63, s91, s89
    s_mul_i32 s91, s90, 5120
    s_add_u32 s91, s91, 14336
    s_add_u32 s64, s91, s89
    s_mul_i32 s91, s90, 5120
    s_add_u32 s91, s91, 15360
    s_add_u32 s65, s91, s89
    s_mul_i32 s91, s90, 5120
    s_add_u32 s91, s91, 16384
    s_add_u32 s66, s91, s89
    s_branch L_udone_5
L_ub_9:
    s_cmp_ge_u32 s86, 9
    s_cbranch_scc1 L_uc_10
    s_sub_u32 s90, s86, 3
    s_mul_i32 s91, s90, 9216
    s_add_u32 s91, s91, 27648
    s_add_u32 s58, s91, s89
    s_mul_i32 s91, s90, 9216
    s_add_u32 s91, s91, 28672
    s_add_u32 s59, s91, s89
    s_mul_i32 s91, s90, 9216
    s_add_u32 s91, s91, 29696
    s_add_u32 s60, s91, s89
    s_mul_i32 s91, s90, 9216
    s_add_u32 s91, s91, 30720
    s_add_u32 s61, s91, s89
    s_mul_i32 s91, s90, 9216
    s_add_u32 s91, s91, 31744
    s_add_u32 s62, s91, s89
    s_mul_i32 s91, s90, 9216
    s_add_u32 s91, s91, 32768
    s_add_u32 s63, s91, s89
    s_mul_i32 s91, s90, 9216
    s_add_u32 s91, s91, 33792
    s_add_u32 s64, s91, s89
    s_mul_i32 s91, s90, 9216
    s_add_u32 s91, s91, 34816
    s_add_u32 s65, s91, s89
    s_mul_i32 s91, s90, 9216
    s_add_u32 s91, s91, 35840
    s_add_u32 s66, s91, s89
    s_branch L_udone_5
L_uc_10:
    s_sub_u32 s90, s86, 9
    s_mul_i32 s91, s90, 2048
    s_add_u32 s91, s91, 82944
    s_add_u32 s58, s91, s89
    s_mul_i32 s91, s90, 2048
    s_add_u32 s91, s91, 83968
    s_add_u32 s59, s91, s89
    s_mul_i32 s91, s90, 2048
    s_add_u32 s91, s91, 101376
    s_add_u32 s60, s91, s89
    s_mul_i32 s91, s90, 2048
    s_add_u32 s91, s91, 102400
    s_add_u32 s61, s91, s89
    s_mul_i32 s91, s90, 2048
    s_add_u32 s91, s91, 119808
    s_add_u32 s62, s91, s89
    s_mul_i32 s91, s90, 2048
    s_add_u32 s91, s91, 120832
    s_add_u32 s63, s91, s89
    s_mul_i32 s91, s90, 2048
    s_add_u32 s91, s91, 138240
    s_add_u32 s64, s91, s89
    s_mul_i32 s91, s90, 2048
    s_add_u32 s91, s91, 139264
    s_add_u32 s65, s91, s89
    s_mul_i32 s91, s90, 1024
    s_add_u32 s91, s91, 156672
    s_add_u32 s66, s91, s89
L_udone_5:
    s_mov_b32 s14, 0x510000
    s_mov_b32 s15, 0x20000
    v_add_u32 v64, 0, v1
    v_mul_u32_u24 v65, 3641, v64
    v_lshrrev_b32 v65, 16, v65
    v_mul_u32_u24 v66, 18, v65
    v_sub_u32 v64, v64, v66
    v_lshlrev_b32 v64, 4, v64
    v_lshrrev_b32 v66, 3, v65
    v_mul_lo_u32 v66, v66, s51
    v_bfe_u32 v67, v65, 2, 1
    v_mul_lo_u32 v67, v67, s52
    v_and_b32 v65, 3, v65
    v_mul_lo_u32 v65, v65, s53
    v_add3_u32 v64, v64, v66, v67
    v_add3_u32 v64, v64, v65, s50
    s_add_u32 m0, s94, 0
    s_nop 0
    buffer_load_dwordx4 v64, s[12:15], 0 offen lds
    v_add_u32 v64, 64, v1
    v_mul_u32_u24 v65, 3641, v64
    v_lshrrev_b32 v65, 16, v65
    v_mul_u32_u24 v66, 18, v65
    v_sub_u32 v64, v64, v66
    v_lshlrev_b32 v64, 4, v64
    v_lshrrev_b32 v66, 3, v65
    v_mul_lo_u32 v66, v66, s51
    v_bfe_u32 v67, v65, 2, 1
    v_mul_lo_u32 v67, v67, s52
    v_and_b32 v65, 3, v65
    v_mul_lo_u32 v65, v65, s53
    v_add3_u32 v64, v64, v66, v67
    v_add3_u32 v64, v64, v65, s50
    s_add_u32 m0, s94, 1024
    s_nop 0
    buffer_load_dwordx4 v64, s[12:15], 0 offen lds
    v_add_u32 v64, 128, v1
    v_mul_u32_u24 v65, 3641, v64
    v_lshrrev_b32 v65, 16, v65
    v_mul_u32_u24 v66, 18, v65
    v_sub_u32 v64, v64, v66
    v_lshlrev_b32 v64, 4, v64
    v_lshrrev_b32 v66, 3, v65
    v_mul_lo_u32 v66, v66, s51
    v_bfe_u32 v67, v65, 2, 1
    v_mul_lo_u32 v67, v67, s52
    v_and_b32 v65, 3, v65
    v_mul_lo_u32 v65, v65, s53
    v_add3_u32 v64, v64, v66, v67
    v_add3_u32 v64, v64, v65, s50
    s_add_u32 m0, s94, 2048
    s_nop 0
    buffer_load_dwordx4 v64, s[12:15], 0 offen lds
    v_add_u32 v64, 192, v1
    v_mul_u32_u24 v65, 3641, v64
    v_lshrrev_b32 v65, 16, v65
    v_mul_u32_u24 v66, 18, v65
    v_sub_u32 v64, v64, v66
    v_lshlrev_b32 v64, 4, v64
    v_lshrrev_b32 v66, 3, v65
    v_mul_lo_u32 v66, v66, s51
    v_bfe_u32 v67, v65, 2, 1
    v_mul_lo_u32 v67, v67, s52
    v_and_b32 v65, 3, v65
    v_mul_lo_u32 v65, v65, s53
    v_add3_u32 v64, v64, v66, v67
    v_add3_u32 v64, v64, v65, s50
    s_add_u32 m0, s94, 3072
    s_nop 0
    buffer_load_dwordx4 v64, s[12:15], 0 offen lds
    v_add_u32 v64, 256, v1
    v_mul_u32_u24 v65, 3641, v64
    v_lshrrev_b32 v65, 16, v65
    v_mul_u32_u24 v66, 18, v65
    v_sub_u32 v64, v64, v66
    v_lshlrev_b32 v64, 4, v64
    v_lshrrev_b32 v66, 3, v65
    v_mul_lo_u32 v66, v66, s51
    v_bfe_u32 v67, v65, 2, 1
    v_mul_lo_u32 v67, v67, s52
    v_and_b32 v65, 3, v65
    v_mul_lo_u32 v65, v65, s53
    v_add3_u32 v64, v64, v66, v67
    v_add3_u32 v64, v64, v65, s50
    s_add_u32 m0, s94, 4096
    s_nop 0
    buffer_load_dwordx4 v64, s[12:15], 0 offen lds
    v_add_u32 v64, 320, v1
    v_mul_u32_u24 v65, 3641, v64
    v_lshrrev_b32 v65, 16, v65
    v_mul_u32_u24 v66, 18, v65
    v_sub_u32 v64, v64, v66
    v_lshlrev_b32 v64, 4, v64
    v_lshrrev_b32 v66, 3, v65
    v_mul_lo_u32 v66, v66, s51
    v_bfe_u32 v67, v65, 2, 1
    v_mul_lo_u32 v67, v67, s52
    v_and_b32 v65, 3, v65
    v_mul_lo_u32 v65, v65, s53
    v_add3_u32 v64, v64, v66, v67
    v_add3_u32 v64, v64, v65, s50
    s_add_u32 m0, s94, 5120
    s_nop 0
    buffer_load_dwordx4 v64, s[12:15], 0 offen lds
    v_add_u32 v64, 384, v1
    v_mul_u32_u24 v65, 3641, v64
    v_lshrrev_b32 v65, 16, v65
    v_mul_u32_u24 v66, 18, v65
    v_sub_u32 v64, v64, v66
    v_lshlrev_b32 v64, 4, v64
    v_lshrrev_b32 v66, 3, v65
    v_mul_lo_u32 v66, v66, s51
    v_bfe_u32 v67, v65, 2, 1
    v_mul_lo_u32 v67, v67, s52
    v_and_b32 v65, 3, v65
    v_mul_lo_u32 v65, v65, s53
    v_add3_u32 v64, v64, v66, v67
    v_add3_u32 v64, v64, v65, s50
    s_add_u32 m0, s94, 6144
    s_nop 0
    buffer_load_dwordx4 v64, s[12:15], 0 offen lds
    v_add_u32 v64, 448, v1
    v_mul_u32_u24 v65, 3641, v64
    v_lshrrev_b32 v65, 16, v65
    v_mul_u32_u24 v66, 18, v65
    v_sub_u32 v64, v64, v66
    v_lshlrev_b32 v64, 4, v64
    v_lshrrev_b32 v66, 3, v65
    v_mul_lo_u32 v66, v66, s51
    v_bfe_u32 v67, v65, 2, 1
    v_mul_lo_u32 v67, v67, s52
    v_and_b32 v65, 3, v65
    v_mul_lo_u32 v65, v65, s53
    v_add3_u32 v64, v64, v66, v67
    v_add3_u32 v64, v64, v65, s50
    s_add_u32 m0, s94, 7168
    s_nop 0
    buffer_load_dwordx4 v64, s[12:15], 0 offen lds
    v_add_u32 v64, 512, v1
    v_mul_u32_u24 v65, 3641, v64
    v_lshrrev_b32 v65, 16, v65
    v_mul_u32_u24 v66, 18, v65
    v_sub_u32 v64, v64, v66
    v_lshlrev_b32 v64, 4, v64
    v_lshrrev_b32 v66, 3, v65
    v_mul_lo_u32 v66, v66, s51
    v_bfe_u32 v67, v65, 2, 1
    v_mul_lo_u32 v67, v67, s52
    v_and_b32 v65, 3, v65
    v_mul_lo_u32 v65, v65, s53
    v_add3_u32 v64, v64, v66, v67
    v_add3_u32 v64, v64, v65, s50
    s_add_u32 m0, s94, 8192
    s_nop 0
    buffer_load_dwordx4 v64, s[12:15], 0 offen lds
    s_add_u32 s96, s23, 1024
    s_cmp_ge_u32 s96, 1728
    s_cbranch_scc1 L_no1_11
    s_cmp_ge_u32 s96, 1152
    s_cbranch_scc1 L_ud_12
    s_mul_i32 s74, s96, 1821
    s_lshr_b32 s74, s74, 16
    s_mul_i32 s86, s74, 36
    s_sub_u32 s86, s96, s86
    s_and_b32 s87, s86, 1
    s_lshr_b32 s88, s86, 1
    s_cmp_eq_u32 s87, 0
    s_cselect_b32 s16, s32, s34
    s_cselect_b32 s17, s33, s35
    s_mul_i32 s68, s88, 294912
    s_mul_i32 s89, s74, 288
    s_add_u32 s68, s68, s89
    s_mov_b32 s69, 73728
    s_mov_b32 s70, 36864
    s_mov_b32 s71, 9216
    s_mov_b32 s72, 0
    s_mov_b32 s73, 256
    s_mul_i32 s89, s74, 486
    s_add_u32 s89, s89, s86
    s_lshl_b32 s89, s89, 10
    s_add_u32 s89, s89, 4194304
    s_add_u32 s76, s89, 36864
    s_add_u32 s77, s89, 73728
    s_add_u32 s78, s89, 110592
    s_add_u32 s79, s89, 147456
    s_add_u32 s80, s89, 184320
    s_add_u32 s81, s89, 221184
    s_add_u32 s82, s89, 258048
    s_add_u32 s83, s89, 294912
    s_add_u32 s84, s89, 0
    s_lshl_b32 s89, s74, 1
    s_add_u32 s89, s89, s87
    s_mul_i32 s89, s89, 18
    s_add_u32 s89, s89, s88
    s_mul_i32 s89, s89, 576
    s_add_u32 s75, s89, 2883584
    s_branch L_udone_13
L_ud_12:
    s_sub_u32 s86, s96, 1152
    s_mul_i32 s74, s86, 3641
    s_lshr_b32 s74, s74, 16
    s_mul_i32 s87, s74, 18
    s_sub_u32 s86, s86, s87
    s_mov_b32 s16, s36
    s_mov_b32 s17, s37
    s_mov_b32 s75, 0
    s_mov_b32 s71, 1152
    s_and_b32 s87, s74, 3
    s_and_b32 s88, s87, 1
    s_lshl_b32 s72, s88, 5
    s_cmp_eq_u32 s88, 0
    s_cselect_b32 s73, 256, 0
    s_mov_b32 s91, -165888
    s_cselect_b32 s91, 165888, s91
    s_mov_b32 s69, 9216
    s_mov_b32 s70, 4608
    s_cmp_ge_u32 s86, 4
    s_cbranch_scc1 L_ush_14
    s_mov_b32 s89, s87
    s_lshl_b32 s90, s86, 5
    s_branch L_urows_16
L_ush_14:
    s_cmp_ge_u32 s86, 6
    s_cbranch_scc1 L_urm_15
    s_sub_u32 s89, s86, 4
    s_lshl_b32 s89, s89, 1
    s_xor_b32 s89, s89, s87
    s_mov_b32 s90, 128
    s_mov_b32 s69, 4608
    s_mov_b32 s70, s91
    s_branch L_urows_16
L_urm_15:
    s_sub_u32 s89, s86, 6
    s_mul_i32 s90, s89, 21846
    s_lshr_b32 s90, s90, 16
    s_mul_i32 s91, s90, 3
    s_sub_u32 s89, s89, s91
    s_add_u32 s89, s89, 1
    s_xor_b32 s89, s89, s87
    s_lshl_b32 s90, s90, 5
L_urows_16:
    s_mul_i32 s89, s89, 144
    s_add_u32 s89, s89, s90
    s_lshr_b32 s90, s74, 2
    s_mul_i32 s90, s90, 576
    s_add_u32 s89, s89, s90
    s_mul_i32 s89, s89, 1152
    s_mul_i32 s90, s87, 288
    s_add_u32 s68, s89, s90
    s_mul_i32 s89, s74, 486
    s_add_u32 s89, s89, 324
    s_lshl_b32 s89, s89, 10
    s_add_u32 s89, s89, 4194304
    s_cmp_ge_u32 s86, 3
    s_cbranch_scc1 L_ub_17
    s_sub_u32 s90, s86, 0
    s_mul_i32 s91, s90, 4096
    s_add_u32 s91, s91, 0
    s_add_u32 s76, s91, s89
    s_mul_i32 s91, s90, 4096
    s_add_u32 s91, s91, 1024
    s_add_u32 s77, s91, s89
    s_mul_i32 s91, s90, 4096
    s_add_u32 s91, s91, 2048
    s_add_u32 s78, s91, s89
    s_mul_i32 s91, s90, 4096
    s_add_u32 s91, s91, 3072
    s_add_u32 s79, s91, s89
    s_mul_i32 s91, s90, 5120
    s_add_u32 s91, s91, 12288
    s_add_u32 s80, s91, s89
    s_mul_i32 s91, s90, 5120
    s_add_u32 s91, s91, 13312
    s_add_u32 s81, s91, s89
    s_mul_i32 s91, s90, 5120
    s_add_u32 s91, s91, 14336
    s_add_u32 s82, s91, s89
    s_mul_i32 s91, s90, 5120
    s_add_u32 s91, s91, 15360
    s_add_u32 s83, s91, s89
    s_mul_i32 s91, s90, 5120
    s_add_u32 s91, s91, 16384
    s_add_u32 s84, s91, s89
    s_branch L_udone_13
L_ub_17:
    s_cmp_ge_u32 s86, 9
    s_cbranch_scc1 L_uc_18
    s_sub_u32 s90, s86, 3
    s_mul_i32 s91, s90, 9216
    s_add_u32 s91, s91, 27648
    s_add_u32 s76, s91, s89
    s_mul_i32 s91, s90, 9216
    s_add_u32 s91, s91, 28672
    s_add_u32 s77, s91, s89
    s_mul_i32 s91, s90, 9216
    s_add_u32 s91, s91, 29696
    s_add_u32 s78, s91, s89
    s_mul_i32 s91, s90, 9216
    s_add_u32 s91, s91, 30720
    s_add_u32 s79, s91, s89
    s_mul_i32 s91, s90, 9216
    s_add_u32 s91, s91, 31744
    s_add_u32 s80, s91, s89
    s_mul_i32 s91, s90, 9216
    s_add_u32 s91, s91, 32768
    s_add_u32 s81, s91, s89
    s_mul_i32 s91, s90, 9216
    s_add_u32 s91, s91, 33792
    s_add_u32 s82, s91, s89
    s_mul_i32 s91, s90, 9216
    s_add_u32 s91, s91, 34816
    s_add_u32 s83, s91, s89
    s_mul_i32 s91, s90, 9216
    s_add_u32 s91, s91, 35840
    s_add_u32 s84, s91, s89
    s_branch L_udone_13
L_uc_18:
    s_sub_u32 s90, s86, 9
    s_mul_i32 s91, s90, 2048
    s_add_u32 s91, s91, 82944
    s_add_u32 s76, s91, s89
    s_mul_i32 s91, s90, 2048
    s_add_u32 s91, s91, 83968
    s_add_u32 s77, s91, s89
    s_mul_i32 s91, s90, 2048
    s_add_u32 s91, s91, 101376
    s_add_u32 s78, s91, s89
    s_mul_i32 s91, s90, 2048
    s_add_u32 s91, s91, 102400
    s_add_u32 s79, s91, s89
    s_mul_i32 s91, s90, 2048
    s_add_u32 s91, s91, 119808
    s_add_u32 s80, s91, s89
    s_mul_i32 s91, s90, 2048
    s_add_u32 s91, s91, 120832
    s_add_u32 s81, s91, s89
    s_mul_i32 s91, s90, 2048
    s_add_u32 s91, s91, 138240
    s_add_u32 s82, s91, s89
    s_mul_i32 s91, s90, 2048
    s_add_u32 s91, s91, 139264
    s_add_u32 s83, s91, s89
    s_mul_i32 s91, s90, 1024
    s_add_u32 s91, s91, 156672
    s_add_u32 s84, s91, s89
L_udone_13:
    s_mov_b32 s18, 0x510000
    s_mov_b32 s19, 0x20000
    v_add_u32 v64, 0, v1
    v_mul_u32_u24 v65, 3641, v64
    v_lshrrev_b32 v65, 16, v65
    v_mul_u32_u24 v66, 18, v65
    v_sub_u32 v64, v64, v66
    v_lshlrev_b32 v64, 4, v64
    v_lshrrev_b32 v66, 3, v65
    v_mul_lo_u32 v66, v66, s69
    v_bfe_u32 v67, v65, 2, 1
    v_mul_lo_u32 v67, v67, s70
    v_and_b32 v65, 3, v65
    v_mul_lo_u32 v65, v65, s71
    v_add3_u32 v64, v64, v66, v67
    v_add3_u32 v64, v64, v65, s68
    s_add_u32 m0, s95, 0
    s_nop 0
    buffer_load_dwordx4 v64, s[16:19], 0 offen lds
    v_add_u32 v64, 64, v1
    v_mul_u32_u24 v65, 3641, v64
    v_lshrrev_b32 v65, 16, v65
    v_mul_u32_u24 v66, 18, v65
    v_sub_u32 v64, v64, v66
    v_lshlrev_b32 v64, 4, v64
    v_lshrrev_b32 v66, 3, v65
    v_mul_lo_u32 v66, v66, s69
    v_bfe_u32 v67, v65, 2, 1
    v_mul_lo_u32 v67, v67, s70
    v_and_b32 v65, 3, v65
    v_mul_lo_u32 v65, v65, s71
    v_add3_u32 v64, v64, v66, v67
    v_add3_u32 v64, v64, v65, s68
    s_add_u32 m0, s95, 1024
    s_nop 0
    buffer_load_dwordx4 v64, s[16:19], 0 offen lds
    v_add_u32 v64, 128, v1
    v_mul_u32_u24 v65, 3641, v64
    v_lshrrev_b32 v65, 16, v65
    v_mul_u32_u24 v66, 18, v65
    v_sub_u32 v64, v64, v66
    v_lshlrev_b32 v64, 4, v64
    v_lshrrev_b32 v66, 3, v65
    v_mul_lo_u32 v66, v66, s69
    v_bfe_u32 v67, v65, 2, 1
    v_mul_lo_u32 v67, v67, s70
    v_and_b32 v65, 3, v65
    v_mul_lo_u32 v65, v65, s71
    v_add3_u32 v64, v64, v66, v67
    v_add3_u32 v64, v64, v65, s68
    s_add_u32 m0, s95, 2048
    s_nop 0
    buffer_load_dwordx4 v64, s[16:19], 0 offen lds
    v_add_u32 v64, 192, v1
    v_mul_u32_u24 v65, 3641, v64
    v_lshrrev_b32 v65, 16, v65
    v_mul_u32_u24 v66, 18, v65
    v_sub_u32 v64, v64, v66
    v_lshlrev_b32 v64, 4, v64
    v_lshrrev_b32 v66, 3, v65
    v_mul_lo_u32 v66, v66, s69
    v_bfe_u32 v67, v65, 2, 1
    v_mul_lo_u32 v67, v67, s70
    v_and_b32 v65, 3, v65
    v_mul_lo_u32 v65, v65, s71
    v_add3_u32 v64, v64, v66, v67
    v_add3_u32 v64, v64, v65, s68
    s_add_u32 m0, s95, 3072
    s_nop 0
    buffer_load_dwordx4 v64, s[16:19], 0 offen lds
    v_add_u32 v64, 256, v1
    v_mul_u32_u24 v65, 3641, v64
    v_lshrrev_b32 v65, 16, v65
    v_mul_u32_u24 v66, 18, v65
    v_sub_u32 v64, v64, v66
    v_lshlrev_b32 v64, 4, v64
    v_lshrrev_b32 v66, 3, v65
    v_mul_lo_u32 v66, v66, s69
    v_bfe_u32 v67, v65, 2, 1
    v_mul_lo_u32 v67, v67, s70
    v_and_b32 v65, 3, v65
    v_mul_lo_u32 v65, v65, s71
    v_add3_u32 v64, v64, v66, v67
    v_add3_u32 v64, v64, v65, s68
    s_add_u32 m0, s95, 4096
    s_nop 0
    buffer_load_dwordx4 v64, s[16:19], 0 offen lds
    v_add_u32 v64, 320, v1
    v_mul_u32_u24 v65, 3641, v64
    v_lshrrev_b32 v65, 16, v65
    v_mul_u32_u24 v66, 18, v65
    v_sub_u32 v64, v64, v66
    v_lshlrev_b32 v64, 4, v64
    v_lshrrev_b32 v66, 3, v65
    v_mul_lo_u32 v66, v66, s69
    v_bfe_u32 v67, v65, 2, 1
    v_mul_lo_u32 v67, v67, s70
    v_and_b32 v65, 3, v65
    v_mul_lo_u32 v65, v65, s71
    v_add3_u32 v64, v64, v66, v67
    v_add3_u32 v64, v64, v65, s68
    s_add_u32 m0, s95, 5120
    s_nop 0
    buffer_load_dwordx4 v64, s[16:19], 0 offen lds
    v_add_u32 v64, 384, v1
    v_mul_u32_u24 v65, 3641, v64
    v_lshrrev_b32 v65, 16, v65
    v_mul_u32_u24 v66, 18, v65
    v_sub_u32 v64, v64, v66
    v_lshlrev_b32 v64, 4, v64
    v_lshrrev_b32 v66, 3, v65
    v_mul_lo_u32 v66, v66, s69
    v_bfe_u32 v67, v65, 2, 1
    v_mul_lo_u32 v67, v67, s70
    v_and_b32 v65, 3, v65
    v_mul_lo_u32 v65, v65, s71
    v_add3_u32 v64, v64, v66, v67
    v_add3_u32 v64, v64, v65, s68
    s_add_u32 m0, s95, 6144
    s_nop 0
    buffer_load_dwordx4 v64, s[16:19], 0 offen lds
    v_add_u32 v64, 448, v1
    v_mul_u32_u24 v65, 3641, v64
    v_lshrrev_b32 v65, 16, v65
    v_mul_u32_u24 v66, 18, v65
    v_sub_u32 v64, v64, v66
    v_lshlrev_b32 v64, 4, v64
    v_lshrrev_b32 v66, 3, v65
    v_mul_lo_u32 v66, v66, s69
    v_bfe_u32 v67, v65, 2, 1
    v_mul_lo_u32 v67, v67, s70
    v_and_b32 v65, 3, v65
    v_mul_lo_u32 v65, v65, s71
    v_add3_u32 v64, v64, v66, v67
    v_add3_u32 v64, v64, v65, s68
    s_add_u32 m0, s95, 7168
    s_nop 0
    buffer_load_dwordx4 v64, s[16:19], 0 offen lds
    v_add_u32 v64, 512, v1
    v_mul_u32_u24 v65, 3641, v64
    v_lshrrev_b32 v65, 16, v65
    v_mul_u32_u24 v66, 18, v65
    v_sub_u32 v64, v64, v66
    v_lshlrev_b32 v64, 4, v64
    v_lshrrev_b32 v66, 3, v65
    v_mul_lo_u32 v66, v66, s69
    v_bfe_u32 v67, v65, 2, 1
    v_mul_lo_u32 v67, v67, s70
    v_and_b32 v65, 3, v65
    v_mul_lo_u32 v65, v65, s71
    v_add3_u32 v64, v64, v66, v67
    v_add3_u32 v64, v64, v65, s68
    s_add_u32 m0, s95, 8192
    s_nop 0
    buffer_load_dwordx4 v64, s[16:19], 0 offen lds
L_no1_11:
    s_waitcnt vmcnt(11)
    v_lshlrev_b32 v20, 16, v8
    v_and_b32 v21, 0xffff0000, v8
    v_lshlrev_b32 v22, 16, v9
    v_and_b32 v23, 0xffff0000, v9
    v_lshlrev_b32 v24, 16, v10
    v_and_b32 v25, 0xffff0000, v10
    v_lshlrev_b32 v26, 16, v11
    v_and_b32 v27, 0xffff0000, v11
    s_waitcnt vmcnt(10)
    v_lshlrev_b32 v28, 16, v12
    v_and_b32 v29, 0xffff0000, v12
    v_lshlrev_b32 v30, 16, v13
    v_and_b32 v31, 0xffff0000, v13
    v_lshlrev_b32 v32, 16, v14
    v_and_b32 v33, 0xffff0000, v14
    v_lshlrev_b32 v34, 16, v15
    v_and_b32 v35, 0xffff0000, v15
    s_waitcnt vmcnt(9)
    v_lshlrev_b32 v36, 16, v16
    v_and_b32 v37, 0xffff0000, v16
    v_lshlrev_b32 v38, 16, v17
    v_and_b32 v39, 0xffff0000, v17
    v_lshlrev_b32 v40, 16, v18
    v_and_b32 v41, 0xffff0000, v18
    v_lshlrev_b32 v42, 16, v19
    v_and_b32 v43, 0xffff0000, v19
    v_add_f32 v44, v20, v21
    v_add_f32 v64, v22, v23
    v_add_f32 v44, v44, v24
    v_add_f32 v64, v64, v25
    v_add_f32 v44, v44, v26
    v_add_f32 v64, v64, v27
    v_add_f32 v44, v44, v28
    v_add_f32 v64, v64, v29
    v_add_f32 v44, v44, v30
    v_add_f32 v64, v64, v31
    v_add_f32 v44, v44, v32
    v_add_f32 v64, v64, v33
    v_add_f32 v44, v44, v34
    v_add_f32 v64, v64, v35
    v_add_f32 v44, v44, v36
    v_add_f32 v64, v64, v37
    v_add_f32 v44, v44, v38
    v_add_f32 v64, v64, v39
    v_add_f32 v44, v44, v40
    v_add_f32 v64, v64, v41
    v_add_f32 v44, v44, v42
    v_add_f32 v64, v64, v43
    v_add_f32 v44, v44, v64
    s_nop 1
    v_add_f32_dpp v44, v44, v44 row_ror:8 row_mask:0xf bank_mask:0xf
    v_mov_b32 v64, v44
    s_nop 1
    v_permlane16_swap_b32 v44, v64
    v_add_f32 v44, v44, v64
    v_mov_b32 v64, v44
    s_nop 1
    v_permlane32_swap_b32 v44, v64
    v_add_f32 v44, v44, v64
    v_mul_f32 v65, 0x3baaaaab, v44
    v_sub_f32 v64, v20, v65
    v_mul_f32 v45, v64, v64
    v_sub_f32 v67, v21, v65
    v_fmac_f32 v45, v67, v67
    v_sub_f32 v66, v22, v65
    v_fmac_f32 v45, v66, v66
    v_sub_f32 v67, v23, v65
    v_fmac_f32 v45, v67, v67
    v_sub_f32 v66, v24, v65
    v_fmac_f32 v45, v66, v66
    v_sub_f32 v67, v25, v65
    v_fmac_f32 v45, v67, v67
    v_sub_f32 v66, v26, v65
    v_fmac_f32 v45, v66, v66
    v_sub_f32 v67, v27, v65
    v_fmac_f32 v45, v67, v67
    v_sub_f32 v66, v28, v65
    v_fmac_f32 v45, v66, v66
    v_sub_f32 v67, v29, v65
    v_fmac_f32 v45, v67, v67
    v_sub_f32 v66, v30, v65
    v_fmac_f32 v45, v66, v66
    v_sub_f32 v67, v31, v65
    v_fmac_f32 v45, v67, v67
    v_sub_f32 v66, v32, v65
    v_fmac_f32 v45, v66, v66
    v_sub_f32 v67, v33, v65
    v_fmac_f32 v45, v67, v67
    v_sub_f32 v66, v34, v65
    v_fmac_f32 v45, v66, v66
    v_sub_f32 v67, v35, v65
    v_fmac_f32 v45, v67, v67
    v_sub_f32 v66, v36, v65
    v_fmac_f32 v45, v66, v66
    v_sub_f32 v67, v37, v65
    v_fmac_f32 v45, v67, v67
    v_sub_f32 v66, v38, v65
    v_fmac_f32 v45, v66, v66
    v_sub_f32 v67, v39, v65
    v_fmac_f32 v45, v67, v67
    v_sub_f32 v66, v40, v65
    v_fmac_f32 v45, v66, v66
    v_sub_f32 v67, v41, v65
    v_fmac_f32 v45, v67, v67
    v_sub_f32 v66, v42, v65
    v_fmac_f32 v45, v66, v66
    v_sub_f32 v67, v43, v65
    v_fmac_f32 v45, v67, v67
    s_nop 1
    v_add_f32_dpp v45, v45, v45 row_ror:8 row_mask:0xf bank_mask:0xf
    v_mov_b32 v64, v45
    s_nop 1
    v_permlane16_swap_b32 v45, v64
    v_add_f32 v45, v45, v64
    v_mov_b32 v64, v45
    s_nop 1
    v_permlane32_swap_b32 v45, v64
    v_add_f32 v45, v45, v64
    v_and_b32 v64, 7, v1
    s_mul_i32 s46, s20, 64
    v_lshl_add_u32 v64, v64, 3, s46
    ds_write_b64 v64, v[44:45] offset:0
    s_waitcnt lgkmcnt(0)
    s_barrier
    v_and_b32 v64, 7, v1
    v_lshlrev_b32 v64, 3, v64
    ds_read_b64 v[44:45], v64 offset:0
    ds_read_b64 v[46:47], v64 offset:64
    ds_read_b64 v[48:49], v64 offset:128
    s_waitcnt lgkmcnt(1)
    v_add_f32 v64, v44, v46
    s_waitcnt lgkmcnt(0)
    v_add_f32 v64, v64, v48
    v_mul_f32 v64, 0x3ae38e39, v64
    v_add_f32 v65, v45, v47
    v_add_f32 v65, v65, v49
    v_mul_f32 v66, 0x3baaaaab, v44
    v_sub_f32 v66, v66, v64
    v_mul_f32 v66, v66, v66
    v_fmac_f32 v65, 0x43400000, v66
    v_mul_f32 v66, 0x3baaaaab, v46
    v_sub_f32 v66, v66, v64
    v_mul_f32 v66, v66, v66
    v_fmac_f32 v65, 0x43400000, v66
    v_mul_f32 v66, 0x3baaaaab, v48
    v_sub_f32 v66, v66, v64
    v_mul_f32 v66, v66, v66
    v_fmac_f32 v65, 0x43400000, v66
    v_mul_f32 v65, 0x3ae38e39, v65
    v_cvt_pk_bf16_f32 v65, v65, v65
    v_lshlrev_b32 v65, 16, v65
    v_add_f32 v65, 0x3727c5ac, v65
    v_cvt_pk_bf16_f32 v65, v65, v65
    v_lshlrev_b32 v65, 16, v65
    v_sqrt_f32 v65, v65
    s_nop 0
    v_cvt_pk_bf16_f32 v65, v65, v65
    v_lshlrev_b32 v65, 16, v65
    v_rcp_f32 v65, v65
    v_cvt_pk_bf16_f32 v64, v64, v64
    v_lshlrev_b32 v64, 16, v64
    v_sub_f32 v20, v20, v64
    v_sub_f32 v21, v21, v64
    v_cvt_pk_bf16_f32 v66, v20, v21
    v_lshlrev_b32 v20, 16, v66
    v_and_b32 v21, 0xffff0000, v66
    v_mul_f32 v20, v20, v65
    v_mul_f32 v21, v21, v65
    v_cvt_pk_bf16_f32 v52, v20, v21
    v_sub_f32 v22, v22, v64
    v_sub_f32 v23, v23, v64
    v_cvt_pk_bf16_f32 v66, v22, v23
    v_lshlrev_b32 v22, 16, v66
    v_and_b32 v23, 0xffff0000, v66
    v_mul_f32 v22, v22, v65
    v_mul_f32 v23, v23, v65
    v_cvt_pk_bf16_f32 v53, v22, v23
    v_sub_f32 v24, v24, v64
    v_sub_f32 v25, v25, v64
    v_cvt_pk_bf16_f32 v66, v24, v25
    v_lshlrev_b32 v24, 16, v66
    v_and_b32 v25, 0xffff0000, v66
    v_mul_f32 v24, v24, v65
    v_mul_f32 v25, v25, v65
    v_cvt_pk_bf16_f32 v54, v24, v25
    v_sub_f32 v26, v26, v64
    v_sub_f32 v27, v27, v64
    v_cvt_pk_bf16_f32 v66, v26, v27
    v_lshlrev_b32 v26, 16, v66
    v_and_b32 v27, 0xffff0000, v66
    v_mul_f32 v26, v26, v65
    v_mul_f32 v27, v27, v65
    v_cvt_pk_bf16_f32 v55, v26, v27
    v_sub_f32 v28, v28, v64
    v_sub_f32 v29, v29, v64
    v_cvt_pk_bf16_f32 v66, v28, v29
    v_lshlrev_b32 v28, 16, v66
    v_and_b32 v29, 0xffff0000, v66
    v_mul_f32 v28, v28, v65
    v_mul_f32 v29, v29, v65
    v_cvt_pk_bf16_f32 v56, v28, v29
    v_sub_f32 v30, v30, v64
    v_sub_f32 v31, v31, v64
    v_cvt_pk_bf16_f32 v66, v30, v31
    v_lshlrev_b32 v30, 16, v66
    v_and_b32 v31, 0xffff0000, v66
    v_mul_f32 v30, v30, v65
    v_mul_f32 v31, v31, v65
    v_cvt_pk_bf16_f32 v57, v30, v31
    v_sub_f32 v32, v32, v64
    v_sub_f32 v33, v33, v64
    v_cvt_pk_bf16_f32 v66, v32, v33
    v_lshlrev_b32 v32, 16, v66
    v_and_b32 v33, 0xffff0000, v66
    v_mul_f32 v32, v32, v65
    v_mul_f32 v33, v33, v65
    v_cvt_pk_bf16_f32 v58, v32, v33
    v_sub_f32 v34, v34, v64
    v_sub_f32 v35, v35, v64
    v_cvt_pk_bf16_f32 v66, v34, v35
    v_lshlrev_b32 v34, 16, v66
    v_and_b32 v35, 0xffff0000, v66
    v_mul_f32 v34, v34, v65
    v_mul_f32 v35, v35, v65
    v_cvt_pk_bf16_f32 v59, v34, v35
    v_sub_f32 v36, v36, v64
    v_sub_f32 v37, v37, v64
    v_cvt_pk_bf16_f32 v66, v36, v37
    v_lshlrev_b32 v36, 16, v66
    v_and_b32 v37, 0xffff0000, v66
    v_mul_f32 v36, v36, v65
    v_mul_f32 v37, v37, v65
    v_cvt_pk_bf16_f32 v60, v36, v37
    v_sub_f32 v38, v38, v64
    v_sub_f32 v39, v39, v64
    v_cvt_pk_bf16_f32 v66, v38, v39
    v_lshlrev_b32 v38, 16, v66
    v_and_b32 v39, 0xffff0000, v66
    v_mul_f32 v38, v38, v65
    v_mul_f32 v39, v39, v65
    v_cvt_pk_bf16_f32 v61, v38, v39
    v_sub_f32 v40, v40, v64
    v_sub_f32 v41, v41, v64
    v_cvt_pk_bf16_f32 v66, v40, v41
    v_lshlrev_b32 v40, 16, v66
    v_and_b32 v41, 0xffff0000, v66
    v_mul_f32 v40, v40, v65
    v_mul_f32 v41, v41, v65
    v_cvt_pk_bf16_f32 v62, v40, v41
    v_sub_f32 v42, v42, v64
    v_sub_f32 v43, v43, v64
    v_cvt_pk_bf16_f32 v66, v42, v43
    v_lshlrev_b32 v42, 16, v66
    v_and_b32 v43, 0xffff0000, v66
    v_mul_f32 v42, v42, v65
    v_mul_f32 v43, v43, v65
    v_cvt_pk_bf16_f32 v63, v42, v43
    s_cmp_eq_u32 s20, 3
    s_cbranch_scc1 L_noln_3
    s_mov_b32 s46, 20971520
    buffer_store_dwordx4 v[52:55], v4, s[4:7], s46 offen offset:0
    buffer_store_dwordx4 v[56:59], v4, s[4:7], s46 offen offset:2048
    s_add_u32 s46, s46, 4096
    buffer_store_dwordx4 v[60:63], v4, s[4:7], s46 offen offset:0
L_noln_3:
    v_lshrrev_b32 v64, 4, v1
    v_bfe_u32 v66, v1, 2, 2
    v_lshl_add_u32 v64, v64, 3, v66
    v_mul_u32_u24 v64, 288, v64
    v_add_u32 v64, s94, v64
    v_and_b32 v66, 3, v1
    v_lshl_add_u32 v65, v66, 3, v64
    v_add_u32 v65, s55, v65
    v_lshl_add_u32 v64, v66, 4, v64
    v_add_u32 v64, s54, v64
    s_waitcnt vmcnt(0)
    ds_read_b64_tr_b16 v[72:73], v64 offset:0
    ds_read_b64_tr_b16 v[74:75], v64 offset:1152
    ds_read_b64_tr_b16 v[76:77], v64 offset:8
    ds_read_b64_tr_b16 v[78:79], v64 offset:1160
    ds_read_b64_tr_b16 v[80:81], v64 offset:64
    ds_read_b64_tr_b16 v[82:83], v64 offset:1216
    ds_read_b64_tr_b16 v[84:85], v64 offset:72
    ds_read_b64_tr_b16 v[86:87], v64 offset:1224
    ds_read_b64_tr_b16 v[88:89], v64 offset:128
    ds_read_b64_tr_b16 v[90:91], v64 offset:1280
    ds_read_b64_tr_b16 v[92:93], v64 offset:136
    ds_read_b64_tr_b16 v[94:95], v64 offset:1288
    ds_read_b64_tr_b16 v[96:97], v64 offset:192
    ds_read_b64_tr_b16 v[98:99], v64 offset:1344
    ds_read_b64_tr_b16 v[100:101], v64 offset:200
    ds_read_b64_tr_b16 v[102:103], v64 offset:1352
    ds_read_b64_tr_b16 v[104:105], v65 offset:0
    ds_read_b64_tr_b16 v[106:107], v65 offset:1152
    s_waitcnt lgkmcnt(15)
    buffer_store_dwordx4 v[72:75], v2, s[4:7], s58 offen
    s_waitcnt lgkmcnt(14)
    buffer_store_dwordx4 v[76:79], v2, s[4:7], s59 offen
    s_waitcnt lgkmcnt(12)
    buffer_store_dwordx4 v[80:83], v2, s[4:7], s60 offen
    s_waitcnt lgkmcnt(10)
    buffer_store_dwordx4 v[84:87], v2, s[4:7], s61 offen
    s_waitcnt lgkmcnt(8)
    buffer_store_dwordx4 v[88:91], v2, s[4:7], s62 offen
    s_waitcnt lgkmcnt(6)
    buffer_store_dwordx4 v[92:95], v2, s[4:7], s63 offen
    s_waitcnt lgkmcnt(4)
    buffer_store_dwordx4 v[96:99], v2, s[4:7], s64 offen
    s_waitcnt lgkmcnt(2)
    buffer_store_dwordx4 v[100:103], v2, s[4:7], s65 offen
    s_waitcnt lgkmcnt(0)
    buffer_store_dwordx4 v[104:107], v2, s[4:7], s66 offen
    s_cmp_eq_u32 s57, 0
    s_cbranch_scc1 L_nocs_19
    v_mov_b32 v68, 0x3f803f80
    v_mov_b32 v69, 0x3f803f80
    v_mov_b32 v70, 0x3f803f80
    v_mov_b32 v71, 0x3f803f80
    s_nop 1
    v_mfma_f32_16x16x32_bf16 v[108:111], v[72:75], v[68:71], 0
    v_mfma_f32_16x16x32_bf16 v[112:115], v[76:79], v[68:71], 0
    v_mfma_f32_16x16x32_bf16 v[116:119], v[80:83], v[68:71], 0
    v_mfma_f32_16x16x32_bf16 v[120:123], v[84:87], v[68:71], 0
    v_mfma_f32_16x16x32_bf16 v[124:127], v[88:91], v[68:71], 0
    v_mfma_f32_16x16x32_bf16 v[128:131], v[92:95], v[68:71], 0
    v_mfma_f32_16x16x32_bf16 v[132:135], v[96:99], v[68:71], 0
    v_mfma_f32_16x16x32_bf16 v[136:139], v[100:103], v[68:71], 0
    v_mfma_f32_16x16x32_bf16 v[140:143], v[104:107], v[68:71], 0
    v_and_b32 v66, 15, v1
    v_cmp_eq_u32 vcc, 0, v66
    s_nop 0
    s_and_saveexec_b64 s[44:45], vcc
    buffer_store_dwordx4 v[108:111], v1, s[4:7], s57 offen offset:64
    buffer_store_dwordx4 v[112:115], v1, s[4:7], s57 offen offset:128
    buffer_store_dwordx4 v[116:119], v1, s[4:7], s57 offen offset:192
    buffer_store_dwordx4 v[120:123], v1, s[4:7], s57 offen offset:256
    buffer_store_dwordx4 v[124:127], v1, s[4:7], s57 offen offset:320
    buffer_store_dwordx4 v[128:131], v1, s[4:7], s57 offen offset:384
    buffer_store_dwordx4 v[132:135], v1, s[4:7], s57 offen offset:448
    buffer_store_dwordx4 v[136:139], v1, s[4:7], s57 offen offset:512
    buffer_store_dwordx4 v[140:143], v1, s[4:7], s57 offen offset:0
    s_mov_b64 exec, s[44:45]
L_nocs_19:
    s_cmp_ge_u32 s96, 1728
    s_cbranch_scc1 L_no2_20
    s_waitcnt vmcnt(0) lgkmcnt(0)
    v_lshrrev_b32 v64, 4, v1
    v_bfe_u32 v66, v1, 2, 2
    v_lshl_add_u32 v64, v64, 3, v66
    v_mul_u32_u24 v64, 288, v64
    v_add_u32 v64, s95, v64
    v_and_b32 v66, 3, v1
    v_lshl_add_u32 v65, v66, 3, v64
    v_add_u32 v65, s73, v65
    v_lshl_add_u32 v64, v66, 4, v64
    v_add_u32 v64, s72, v64
    ds_read_b64_tr_b16 v[72:73], v64 offset:0
    ds_read_b64_tr_b16 v[74:75], v64 offset:1152
    ds_read_b64_tr_b16 v[76:77], v64 offset:8
    ds_read_b64_tr_b16 v[78:79], v64 offset:1160
    ds_read_b64_tr_b16 v[80:81], v64 offset:64
    ds_read_b64_tr_b16 v[82:83], v64 offset:1216
    ds_read_b64_tr_b16 v[84:85], v64 offset:72
    ds_read_b64_tr_b16 v[86:87], v64 offset:1224
    ds_read_b64_tr_b16 v[88:89], v64 offset:128
    ds_read_b64_tr_b16 v[90:91], v64 offset:1280
    ds_read_b64_tr_b16 v[92:93], v64 offset:136
    ds_read_b64_tr_b16 v[94:95], v64 offset:1288
    ds_read_b64_tr_b16 v[96:97], v64 offset:192
    ds_read_b64_tr_b16 v[98:99], v64 offset:1344
    ds_read_b64_tr_b16 v[100:101], v64 offset:200
    ds_read_b64_tr_b16 v[102:103], v64 offset:1352
    ds_read_b64_tr_b16 v[104:105], v65 offset:0
    ds_read_b64_tr_b16 v[106:107], v65 offset:1152
    s_waitcnt lgkmcnt(15)
    buffer_store_dwordx4 v[72:75], v2, s[4:7], s76 offen
    s_waitcnt lgkmcnt(14)
    buffer_store_dwordx4 v[76:79], v2, s[4:7], s77 offen
    s_waitcnt lgkmcnt(12)
    buffer_store_dwordx4 v[80:83], v2, s[4:7], s78 offen
    s_waitcnt lgkmcnt(10)
    buffer_store_dwordx4 v[84:87], v2, s[4:7], s79 offen
    s_waitcnt lgkmcnt(8)
    buffer_store_dwordx4 v[88:91], v2, s[4:7], s80 offen
    s_waitcnt lgkmcnt(6)
    buffer_store_dwordx4 v[92:95], v2, s[4:7], s81 offen
    s_waitcnt lgkmcnt(4)
    buffer_store_dwordx4 v[96:99], v2, s[4:7], s82 offen
    s_waitcnt lgkmcnt(2)
    buffer_store_dwordx4 v[100:103], v2, s[4:7], s83 offen
    s_waitcnt lgkmcnt(0)
    buffer_store_dwordx4 v[104:107], v2, s[4:7], s84 offen
    s_cmp_eq_u32 s75, 0
    s_cbranch_scc1 L_nocs_22
    v_mov_b32 v68, 0x3f803f80
    v_mov_b32 v69, 0x3f803f80
    v_mov_b32 v70, 0x3f803f80
    v_mov_b32 v71, 0x3f803f80
    s_nop 1
    v_mfma_f32_16x16x32_bf16 v[108:111], v[72:75], v[68:71], 0
    v_mfma_f32_16x16x32_bf16 v[112:115], v[76:79], v[68:71], 0
    v_mfma_f32_16x16x32_bf16 v[116:119], v[80:83], v[68:71], 0
    v_mfma_f32_16x16x32_bf16 v[120:123], v[84:87], v[68:71], 0
    v_mfma_f32_16x16x32_bf16 v[124:127], v[88:91], v[68:71], 0
    v_mfma_f32_16x16x32_bf16 v[128:131], v[92:95], v[68:71], 0
    v_mfma_f32_16x16x32_bf16 v[132:135], v[96:99], v[68:71], 0
    v_mfma_f32_16x16x32_bf16 v[136:139], v[100:103], v[68:71], 0
    v_mfma_f32_16x16x32_bf16 v[140:143], v[104:107], v[68:71], 0
    v_and_b32 v66, 15, v1
    v_cmp_eq_u32 vcc, 0, v66
    s_nop 0
    s_and_saveexec_b64 s[44:45], vcc
    buffer_store_dwordx4 v[108:111], v1, s[4:7], s75 offen offset:64
    buffer_store_dwordx4 v[112:115], v1, s[4:7], s75 offen offset:128
    buffer_store_dwordx4 v[116:119], v1, s[4:7], s75 offen offset:192
    buffer_store_dwordx4 v[120:123], v1, s[4:7], s75 offen offset:256
    buffer_store_dwordx4 v[124:127], v1, s[4:7], s75 offen offset:320
    buffer_store_dwordx4 v[128:131], v1, s[4:7], s75 offen offset:384
    buffer_store_dwordx4 v[132:135], v1, s[4:7], s75 offen offset:448
    buffer_store_dwordx4 v[136:139], v1, s[4:7], s75 offen offset:512
    buffer_store_dwordx4 v[140:143], v1, s[4:7], s75 offen offset:0
    s_mov_b64 exec, s[44:45]
L_nocs_22:
L_no2_20:
    s_waitcnt vmcnt(0) lgkmcnt(0)
    s_cmp_lt_u32 s23, 628
    s_cbranch_scc1 L_fin_2
    s_sub_u32 s23, s23, 628
    s_cmp_ge_u32 s23, 288
    s_cbranch_scc1 L_wo_23
    s_mul_i32 s86, s23, 3641
    s_lshr_b32 s86, s86, 16
    s_mul_i32 s87, s86, 18
    s_sub_u32 s87, s23, s87
    s_mul_i32 s88, s86, 72
    s_and_b32 s89, s88, 8
    s_and_b32 s88, s88, -16
    s_mul_i32 s90, s87, 110592
    s_add_u32 s88, s88, s90
    s_mov_b32 s90, 27648
    s_mov_b32 s91, 13824
    s_mov_b32 s92, 3456
    s_mul_i32 s93, s23, 7168
    s_mov_b32 s12, s26
    s_mov_b32 s13, s27
    s_mov_b32 s14, 0x1e6000
    s_mov_b32 s15, 0x20000
    v_add_u32 v64, 0, v1
    v_mul_u32_u24 v65, 4370, v64
    v_lshrrev_b32 v65, 16, v65
    v_mul_u32_u24 v66, 15, v65
    v_sub_u32 v64, v64, v66
    v_mul_u32_u24 v66, 13108, v64
    v_lshrrev_b32 v66, 16, v66
    v_mul_u32_u24 v66, 1072, v66
    v_lshl_add_u32 v64, v64, 4, v66
    v_lshrrev_b32 v66, 3, v65
    v_mul_lo_u32 v66, v66, s90
    v_bfe_u32 v67, v65, 2, 1
    v_mul_lo_u32 v67, v67, s91
    v_and_b32 v65, 3, v65
    v_mul_lo_u32 v65, v65, s92
    v_add3_u32 v64, v64, v66, v67
    v_add3_u32 v64, v64, v65, s88
    s_add_u32 m0, s94, 0
    s_nop 0
    buffer_load_dwordx4 v64, s[12:15], 0 offen lds
    v_add_u32 v64, 64, v1
    v_mul_u32_u24 v65, 4370, v64
    v_lshrrev_b32 v65, 16, v65
    v_mul_u32_u24 v66, 15, v65
    v_sub_u32 v64, v64, v66
    v_mul_u32_u24 v66, 13108, v64
    v_lshrrev_b32 v66, 16, v66
    v_mul_u32_u24 v66, 1072, v66
    v_lshl_add_u32 v64, v64, 4, v66
    v_lshrrev_b32 v66, 3, v65
    v_mul_lo_u32 v66, v66, s90
    v_bfe_u32 v67, v65, 2, 1
    v_mul_lo_u32 v67, v67, s91
    v_and_b32 v65, 3, v65
    v_mul_lo_u32 v65, v65, s92
    v_add3_u32 v64, v64, v66, v67
    v_add3_u32 v64, v64, v65, s88
    s_add_u32 m0, s94, 1024
    s_nop 0
    buffer_load_dwordx4 v64, s[12:15], 0 offen lds
    v_add_u32 v64, 128, v1
    v_mul_u32_u24 v65, 4370, v64
    v_lshrrev_b32 v65, 16, v65
    v_mul_u32_u24 v66, 15, v65
    v_sub_u32 v64, v64, v66
    v_mul_u32_u24 v66, 13108, v64
    v_lshrrev_b32 v66, 16, v66
    v_mul_u32_u24 v66, 1072, v66
    v_lshl_add_u32 v64, v64, 4, v66
    v_lshrrev_b32 v66, 3, v65
    v_mul_lo_u32 v66, v66, s90
    v_bfe_u32 v67, v65, 2, 1
    v_mul_lo_u32 v67, v67, s91
    v_and_b32 v65, 3, v65
    v_mul_lo_u32 v65, v65, s92
    v_add3_u32 v64, v64, v66, v67
    v_add3_u32 v64, v64, v65, s88
    s_add_u32 m0, s94, 2048
    s_nop 0
    buffer_load_dwordx4 v64, s[12:15], 0 offen lds
    v_add_u32 v64, 192, v1
    v_mul_u32_u24 v65, 4370, v64
    v_lshrrev_b32 v65, 16, v65
    v_mul_u32_u24 v66, 15, v65
    v_sub_u32 v64, v64, v66
    v_mul_u32_u24 v66, 13108, v64
    v_lshrrev_b32 v66, 16, v66
    v_mul_u32_u24 v66, 1072, v66
    v_lshl_add_u32 v64, v64, 4, v66
    v_lshrrev_b32 v66, 3, v65
    v_mul_lo_u32 v66, v66, s90
    v_bfe_u32 v67, v65, 2, 1
    v_mul_lo_u32 v67, v67, s91
    v_and_b32 v65, 3, v65
    v_mul_lo_u32 v65, v65, s92
    v_add3_u32 v64, v64, v66, v67
    v_add3_u32 v64, v64, v65, s88
    s_add_u32 m0, s94, 3072
    s_nop 0
    buffer_load_dwordx4 v64, s[12:15], 0 offen lds
    v_add_u32 v64, 256, v1
    v_mul_u32_u24 v65, 4370, v64
    v_lshrrev_b32 v65, 16, v65
    v_mul_u32_u24 v66, 15, v65
    v_sub_u32 v64, v64, v66
    v_mul_u32_u24 v66, 13108, v64
    v_lshrrev_b32 v66, 16, v66
    v_mul_u32_u24 v66, 1072, v66
    v_lshl_add_u32 v64, v64, 4, v66
    v_lshrrev_b32 v66, 3, v65
    v_mul_lo_u32 v66, v66, s90
    v_bfe_u32 v67, v65, 2, 1
    v_mul_lo_u32 v67, v67, s91
    v_and_b32 v65, 3, v65
    v_mul_lo_u32 v65, v65, s92
    v_add3_u32 v64, v64, v66, v67
    v_add3_u32 v64, v64, v65, s88
    s_add_u32 m0, s94, 4096
    s_nop 0
    buffer_load_dwordx4 v64, s[12:15], 0 offen lds
    v_add_u32 v64, 320, v1
    v_mul_u32_u24 v65, 4370, v64
    v_lshrrev_b32 v65, 16, v65
    v_mul_u32_u24 v66, 15, v65
    v_sub_u32 v64, v64, v66
    v_mul_u32_u24 v66, 13108, v64
    v_lshrrev_b32 v66, 16, v66
    v_mul_u32_u24 v66, 1072, v66
    v_lshl_add_u32 v64, v64, 4, v66
    v_lshrrev_b32 v66, 3, v65
    v_mul_lo_u32 v66, v66, s90
    v_bfe_u32 v67, v65, 2, 1
    v_mul_lo_u32 v67, v67, s91
    v_and_b32 v65, 3, v65
    v_mul_lo_u32 v65, v65, s92
    v_add3_u32 v64, v64, v66, v67
    v_add3_u32 v64, v64, v65, s88
    s_add_u32 m0, s94, 5120
    s_nop 0
    buffer_load_dwordx4 v64, s[12:15], 0 offen lds
    v_add_u32 v64, 384, v1
    v_mul_u32_u24 v65, 4370, v64
    v_lshrrev_b32 v65, 16, v65
    v_mul_u32_u24 v66, 15, v65
    v_sub_u32 v64, v64, v66
    v_mul_u32_u24 v66, 13108, v64
    v_lshrrev_b32 v66, 16, v66
    v_mul_u32_u24 v66, 1072, v66
    v_lshl_add_u32 v64, v64, 4, v66
    v_lshrrev_b32 v66, 3, v65
    v_mul_lo_u32 v66, v66, s90
    v_bfe_u32 v67, v65, 2, 1
    v_mul_lo_u32 v67, v67, s91
    v_and_b32 v65, 3, v65
    v_mul_lo_u32 v65, v65, s92
    v_add3_u32 v64, v64, v66, v67
    v_add3_u32 v64, v64, v65, s88
    s_add_u32 m0, s94, 6144
    s_nop 0
    buffer_load_dwordx4 v64, s[12:15], 0 offen lds
    v_add_u32 v64, 448, v1
    v_mul_u32_u24 v65, 4370, v64
    v_lshrrev_b32 v65, 16, v65
    v_mul_u32_u24 v66, 15, v65
    v_sub_u32 v64, v64, v66
    v_mul_u32_u24 v66, 13108, v64
    v_lshrrev_b32 v66, 16, v66
    v_mul_u32_u24 v66, 1072, v66
    v_lshl_add_u32 v64, v64, 4, v66
    v_lshrrev_b32 v66, 3, v65
    v_mul_lo_u32 v66, v66, s90
    v_bfe_u32 v67, v65, 2, 1
    v_mul_lo_u32 v67, v67, s91
    v_and_b32 v65, 3, v65
    v_mul_lo_u32 v65, v65, s92
    v_add3_u32 v64, v64, v66, v67
    v_add3_u32 v64, v64, v65, s88
    s_add_u32 m0, s94, 7168
    s_nop 0
    buffer_load_dwordx4 v64, s[12:15], 0 offen lds
    v_lshrrev_b32 v64, 4, v1
    v_bfe_u32 v66, v1, 2, 2
    v_lshl_add_u32 v64, v64, 3, v66
    v_mul_u32_u24 v64, 240, v64
    v_add_u32 v64, s94, v64
    v_and_b32 v66, 3, v1
    v_add_u32 v64, s89, v64
    v_and_b32 v67, 1, v66
    v_mul_u32_u24 v67, 160, v67
    v_lshrrev_b32 v65, 1, v66
    v_mul_u32_u24 v65, 80, v65
    v_add3_u32 v65, v65, v67, v64
    v_cmp_eq_u32 vcc, 3, v66
    s_nop 1
    v_cndmask_b32 v65, v65, v64, vcc
    v_lshl_add_u32 v64, v66, 3, v64
    s_waitcnt vmcnt(0)
    ds_read_b64_tr_b16 v[72:73], v64 offset:0
    ds_read_b64_tr_b16 v[74:75], v64 offset:960
    ds_read_b64_tr_b16 v[76:77], v64 offset:40
    ds_read_b64_tr_b16 v[78:79], v64 offset:1000
    ds_read_b64_tr_b16 v[80:81], v64 offset:80
    ds_read_b64_tr_b16 v[82:83], v64 offset:1040
    ds_read_b64_tr_b16 v[84:85], v64 offset:120
    ds_read_b64_tr_b16 v[86:87], v64 offset:1080
    ds_read_b64_tr_b16 v[88:89], v64 offset:160
    ds_read_b64_tr_b16 v[90:91], v64 offset:1120
    ds_read_b64_tr_b16 v[92:93], v64 offset:200
    ds_read_b64_tr_b16 v[94:95], v64 offset:1160
    ds_read_b64_tr_b16 v[96:97], v65 offset:32
    ds_read_b64_tr_b16 v[98:99], v65 offset:992
    v_and_b32 v66, 15, v1
    v_cmp_gt_u32 vcc, 12, v66
    s_waitcnt lgkmcnt(1)
    s_nop 0
    v_cndmask_b32 v96, 0, v96, vcc
    v_cndmask_b32 v97, 0, v97, vcc
    s_waitcnt lgkmcnt(0)
    v_cndmask_b32 v98, 0, v98, vcc
    v_cndmask_b32 v99, 0, v99, vcc
    s_add_u32 s93, s93, 0
    buffer_store_dwordx4 v[72:75], v2, s[4:7], s93 offen offset:0
    buffer_store_dwordx4 v[76:79], v2, s[4:7], s93 offen offset:1024
    buffer_store_dwordx4 v[80:83], v2, s[4:7], s93 offen offset:2048
    buffer_store_dwordx4 v[84:87], v2, s[4:7], s93 offen offset:3072
    s_add_u32 s93, s93, 4096
    buffer_store_dwordx4 v[88:91], v2, s[4:7], s93 offen offset:0
    buffer_store_dwordx4 v[92:95], v2, s[4:7], s93 offen offset:1024
    buffer_store_dwordx4 v[96:99], v2, s[4:7], s93 offen offset:2048
    s_waitcnt vmcnt(0) lgkmcnt(0)
    s_branch L_fin_2
L_wo_23:
    s_sub_u32 s23, s23, 288
    s_mul_i32 s86, s23, 3641
    s_lshr_b32 s86, s86, 16
    s_mul_i32 s87, s86, 18
    s_sub_u32 s87, s23, s87
    s_mul_i32 s88, s87, 41472
    s_sub_u32 s89, s87, 16
    s_mul_i32 s89, s89, 331776
    s_add_u32 s89, s89, 18432
    s_cmp_lt_u32 s87, 16
    s_cselect_b32 s88, s88, s89
    s_mov_b32 s90, 82944
    s_mov_b32 s91, 41472
    s_cselect_b32 s90, 4608, s90
    s_cselect_b32 s91, 23040, s91
    s_mul_i32 s89, s86, 192
    s_add_u32 s88, s88, s89
    s_mov_b32 s92, 1152
    s_mul_i32 s93, s23, 6144
    s_mov_b32 s12, s28
    s_mov_b32 s13, s29
    s_mov_b32 s14, 0xa2000
    s_mov_b32 s15, 0x20000
    v_add_u32 v64, 0, v1
    v_mul_u32_u24 v65, 5462, v64
    v_lshrrev_b32 v65, 16, v65
    v_mul_u32_u24 v66, 12, v65
    v_sub_u32 v64, v64, v66
    v_lshlrev_b32 v64, 4, v64
    v_lshrrev_b32 v66, 3, v65
    v_mul_lo_u32 v66, v66, s90
    v_bfe_u32 v67, v65, 2, 1
    v_mul_lo_u32 v67, v67, s91
    v_and_b32 v65, 3, v65
    v_mul_lo_u32 v65, v65, s92
    v_add3_u32 v64, v64, v66, v67
    v_add3_u32 v64, v64, v65, s88
    s_add_u32 m0, s94, 0
    s_nop 0
    buffer_load_dwordx4 v64, s[12:15], 0 offen lds
    v_add_u32 v64, 64, v1
    v_mul_u32_u24 v65, 5462, v64
    v_lshrrev_b32 v65, 16, v65
    v_mul_u32_u24 v66, 12, v65
    v_sub_u32 v64, v64, v66
    v_lshlrev_b32 v64, 4, v64
    v_lshrrev_b32 v66, 3, v65
    v_mul_lo_u32 v66, v66, s90
    v_bfe_u32 v67, v65, 2, 1
    v_mul_lo_u32 v67, v67, s91
    v_and_b32 v65, 3, v65
    v_mul_lo_u32 v65, v65, s92
    v_add3_u32 v64, v64, v66, v67
    v_add3_u32 v64, v64, v65, s88
    s_add_u32 m0, s94, 1024
    s_nop 0
    buffer_load_dwordx4 v64, s[12:15], 0 offen lds
    v_add_u32 v64, 128, v1
    v_mul_u32_u24 v65, 5462, v64
    v_lshrrev_b32 v65, 16, v65
    v_mul_u32_u24 v66, 12, v65
    v_sub_u32 v64, v64, v66
    v_lshlrev_b32 v64, 4, v64
    v_lshrrev_b32 v66, 3, v65
    v_mul_lo_u32 v66, v66, s90
    v_bfe_u32 v67, v65, 2, 1
    v_mul_lo_u32 v67, v67, s91
    v_and_b32 v65, 3, v65
    v_mul_lo_u32 v65, v65, s92
    v_add3_u32 v64, v64, v66, v67
    v_add3_u32 v64, v64, v65, s88
    s_add_u32 m0, s94, 2048
    s_nop 0
    buffer_load_dwordx4 v64, s[12:15], 0 offen lds
    v_add_u32 v64, 192, v1
    v_mul_u32_u24 v65, 5462, v64
    v_lshrrev_b32 v65, 16, v65
    v_mul_u32_u24 v66, 12, v65
    v_sub_u32 v64, v64, v66
    v_lshlrev_b32 v64, 4, v64
    v_lshrrev_b32 v66, 3, v65
    v_mul_lo_u32 v66, v66, s90
    v_bfe_u32 v67, v65, 2, 1
    v_mul_lo_u32 v67, v67, s91
    v_and_b32 v65, 3, v65
    v_mul_lo_u32 v65, v65, s92
    v_add3_u32 v64, v64, v66, v67
    v_add3_u32 v64, v64, v65, s88
    s_add_u32 m0, s94, 3072
    s_nop 0
    buffer_load_dwordx4 v64, s[12:15], 0 offen lds
    v_add_u32 v64, 256, v1
    v_mul_u32_u24 v65, 5462, v64
    v_lshrrev_b32 v65, 16, v65
    v_mul_u32_u24 v66, 12, v65
    v_sub_u32 v64, v64, v66
    v_lshlrev_b32 v64, 4, v64
    v_lshrrev_b32 v66, 3, v65
    v_mul_lo_u32 v66, v66, s90
    v_bfe_u32 v67, v65, 2, 1
    v_mul_lo_u32 v67, v67, s91
    v_and_b32 v65, 3, v65
    v_mul_lo_u32 v65, v65, s92
    v_add3_u32 v64, v64, v66, v67
    v_add3_u32 v64, v64, v65, s88
    s_add_u32 m0, s94, 4096
    s_nop 0
    buffer_load_dwordx4 v64, s[12:15], 0 offen lds
    v_add_u32 v64, 320, v1
    v_mul_u32_u24 v65, 5462, v64
    v_lshrrev_b32 v65, 16, v65
    v_mul_u32_u24 v66, 12, v65
    v_sub_u32 v64, v64, v66
    v_lshlrev_b32 v64, 4, v64
    v_lshrrev_b32 v66, 3, v65
    v_mul_lo_u32 v66, v66, s90
    v_bfe_u32 v67, v65, 2, 1
    v_mul_lo_u32 v67, v67, s91
    v_and_b32 v65, 3, v65
    v_mul_lo_u32 v65, v65, s92
    v_add3_u32 v64, v64, v66, v67
    v_add3_u32 v64, v64, v65, s88
    s_add_u32 m0, s94, 5120
    s_nop 0
    buffer_load_dwordx4 v64, s[12:15], 0 offen lds
    v_lshrrev_b32 v64, 4, v1
    v_bfe_u32 v66, v1, 2, 2
    v_lshl_add_u32 v64, v64, 3, v66
    v_mul_u32_u24 v64, 192, v64
    v_add_u32 v64, s94, v64
    v_and_b32 v66, 3, v1
    v_lshl_add_u32 v64, v66, 4, v64
    s_waitcnt vmcnt(0)
    ds_read_b64_tr_b16 v[72:73], v64 offset:0
    ds_read_b64_tr_b16 v[74:75], v64 offset:768
    ds_read_b64_tr_b16 v[76:77], v64 offset:8
    ds_read_b64_tr_b16 v[78:79], v64 offset:776
    ds_read_b64_tr_b16 v[80:81], v64 offset:64
    ds_read_b64_tr_b16 v[82:83], v64 offset:832
    ds_read_b64_tr_b16 v[84:85], v64 offset:72
    ds_read_b64_tr_b16 v[86:87], v64 offset:840
    ds_read_b64_tr_b16 v[88:89], v64 offset:128
    ds_read_b64_tr_b16 v[90:91], v64 offset:896
    ds_read_b64_tr_b16 v[92:93], v64 offset:136
    ds_read_b64_tr_b16 v[94:95], v64 offset:904
    s_add_u32 s93, s93, 2097152
    s_waitcnt lgkmcnt(10)
    buffer_store_dwordx4 v[72:75], v2, s[4:7], s93 offen offset:0
    s_waitcnt lgkmcnt(8)
    buffer_store_dwordx4 v[76:79], v2, s[4:7], s93 offen offset:1024
    s_waitcnt lgkmcnt(6)
    buffer_store_dwordx4 v[80:83], v2, s[4:7], s93 offen offset:2048
    s_waitcnt lgkmcnt(4)
    buffer_store_dwordx4 v[84:87], v2, s[4:7], s93 offen offset:3072
    s_add_u32 s93, s93, 4096
    s_waitcnt lgkmcnt(2)
    buffer_store_dwordx4 v[88:91], v2, s[4:7], s93 offen offset:0
    s_waitcnt lgkmcnt(0)
    buffer_store_dwordx4 v[92:95], v2, s[4:7], s93 offen offset:1024
    s_waitcnt vmcnt(0) lgkmcnt(0)
L_fin_2:
prep_kernel_end:
    s_endpgm
.section .rodata,"a"
.p2align 6
.amdhsa_kernel prep_kernel
  .amdhsa_next_free_vgpr 152
  .amdhsa_next_free_sgpr 102
  .amdhsa_accum_offset 152
  .amdhsa_group_segment_fixed_size 0
  .amdhsa_kernarg_size 80
  .amdhsa_user_sgpr_count 2
  .amdhsa_user_sgpr_kernarg_segment_ptr 1
  .amdhsa_system_sgpr_workgroup_id_x 1
  .amdhsa_float_denorm_mode_32 3
.end_amdhsa_kernel
.text
.globl qkv0_kernel
.p2align 8
.type qkv0_kernel,@function
qkv0_kernel:
    s_cmp_ge_u32 s2, 256
    s_cbranch_scc1 qkv0_kernel_end
    s_load_dwordx16 s[24:39], s[0:1], 0
    s_load_dwordx4 s[40:43], s[0:1], 64
    v_lshrrev_b32 v1, 6, v0
    s_and_b32 s21, s2, 7
    v_readfirstlane_b32 s20, v1
    s_lshr_b32 s22, s2, 3
    v_and_b32 v1, 63, v0
    v_lshlrev_b32 v2, 4, v1
    v_lshlrev_b32 v3, 7, v0
    s_getpc_b64 s[16:17]
L_pc_24:
    v_min_u32 v4, qkv0_kernel_end-L_pc_24, v3
    global_load_dword v4, v4, s[16:17]
    s_waitcnt lgkmcnt(0)
    s_mov_b32 s4, s42
    s_mov_b32 s5, s43
    s_mov_b32 s6, 0x10000000
    s_mov_b32 s7, 0x20000
    s_lshr_b32 s44, s22, 4
    s_lshl_b32 s52, s21, 1
    s_add_u32 s44, s44, s52
    s_and_b32 s45, s22, 15
    s_lshl_b32 s46, s44, 3
    s_mul_i32 s47, s45, 129024
    s_lshl_b32 s50, s20, 11
    s_add_u32 s47, s47, s50
    s_add_u32 s47, s47, 0
    s_add_u32 s48, s47, 1024
    s_max_u32 s52, s46, 1
    s_sub_u32 s52, s52, 1
    s_mul_i32 s52, s52, 18432
    s_add_u32 s52, s52, 20971520
    s_cmp_eq_u32 s20, 3
    s_cselect_b32 s48, s52, s48
    s_mov_b32 s49, 7168
    s_cselect_b32 s49, 1024, s49
    s_lshl_b32 s52, s20, 1
    s_add_u32 s46, s46, s52
    s_mul_i32 s51, s46, 18432
    s_add_u32 s51, s51, 20971520
    s_mov_b32 m0, s50
    s_nop 0
    buffer_load_dwordx4 v2, s[4:7], s47 offen lds
    s_add_u32 m0, s50, 1024
    s_nop 0
    buffer_load_dwordx4 v2, s[4:7], s48 offen lds
    s_add_u32 s50, s50, 8192
    s_add_u32 s47, s47, 7168
    s_add_u32 s48, s48, s49
    s_add_u32 s52, s51, 0
    buffer_load_dwordx4 a[0:3], v2, s[4:7], s52 offen
    s_add_u32 s52, s51, 18432
    buffer_load_dwordx4 a[72:75], v2, s[4:7], s52 offen
    s_mov_b32 m0, s50
    s_nop 0
    buffer_load_dwordx4 v2, s[4:7], s47 offen lds
    s_add_u32 m0, s50, 1024
    s_nop 0
    buffer_load_dwordx4 v2, s[4:7], s48 offen lds
    s_add_u32 s50, s50, 8192
    s_add_u32 s47, s47, 7168
    s_add_u32 s48, s48, s49
    s_add_u32 s52, s51, 1024
    buffer_load_dwordx4 a[4:7], v2, s[4:7], s52 offen
    s_add_u32 s52, s51, 19456
    buffer_load_dwordx4 a[76:79], v2, s[4:7], s52 offen
    s_mov_b32 m0, s50
    s_nop 0
    buffer_load_dwordx4 v2, s[4:7], s47 offen lds
    s_add_u32 m0, s50, 1024
    s_nop 0
    buffer_load_dwordx4 v2, s[4:7], s48 offen lds
    s_add_u32 s50, s50, 8192
    s_add_u32 s47, s47, 7168
    s_add_u32 s48, s48, s49
    s_add_u32 s52, s51, 2048
    buffer_load_dwordx4 a[8:11], v2, s[4:7], s52 offen
    s_add_u32 s52, s51, 20480
    buffer_load_dwordx4 a[80:83], v2, s[4:7], s52 offen
    s_mov_b32 m0, s50
    s_nop 0
    buffer_load_dwordx4 v2, s[4:7], s47 offen lds
    s_add_u32 m0, s50, 1024
    s_nop 0
    buffer_load_dwordx4 v2, s[4:7], s48 offen lds
    s_add_u32 s50, s50, 8192
    s_add_u32 s47, s47, 7168
    s_add_u32 s48, s48, s49
    s_add_u32 s52, s51, 3072
    buffer_load_dwordx4 a[12:15], v2, s[4:7], s52 offen
    s_add_u32 s52, s51, 21504
    buffer_load_dwordx4 a[84:87], v2, s[4:7], s52 offen
    s_mov_b32 m0, s50
    s_nop 0
    buffer_load_dwordx4 v2, s[4:7], s47 offen lds
    s_add_u32 m0, s50, 1024
    s_nop 0
    buffer_load_dwordx4 v2, s[4:7], s48 offen lds
    s_add_u32 s50, s50, 8192
    s_add_u32 s47, s47, 7168
    s_add_u32 s48, s48, s49
    s_add_u32 s52, s51, 4096
    buffer_load_dwordx4 a[16:19], v2, s[4:7], s52 offen
    s_add_u32 s52, s51, 22528
    buffer_load_dwordx4 a[88:91], v2, s[4:7], s52 offen
    s_mov_b32 m0, s50
    s_nop 0
    buffer_load_dwordx4 v2, s[4:7], s47 offen lds
    s_add_u32 m0, s50, 1024
    s_nop 0
    buffer_load_dwordx4 v2, s[4:7], s48 offen lds
    s_add_u32 s50, s50, 8192
    s_add_u32 s47, s47, 7168
    s_add_u32 s48, s48, s49
    s_add_u32 s52, s51, 5120
    buffer_load_dwordx4 a[20:23], v2, s[4:7], s52 offen
    s_add_u32 s52, s51, 23552
    buffer_load_dwordx4 a[92:95], v2, s[4:7], s52 offen
    s_mov_b32 m0, s50
    s_nop 0
    buffer_load_dwordx4 v2, s[4:7], s47 offen lds
    s_add_u32 m0, s50, 1024
    s_nop 0
    buffer_load_dwordx4 v2, s[4:7], s48 offen lds
    s_add_u32 s50, s50, 8192
    s_add_u32 s47, s47, 7168
    s_add_u32 s48, s48, s49
    s_add_u32 s52, s51, 6144
    buffer_load_dwordx4 a[24:27], v2, s[4:7], s52 offen
    s_add_u32 s52, s51, 24576
    buffer_load_dwordx4 a[96:99], v2, s[4:7], s52 offen
    s_mov_b32 m0, s50
    s_nop 0
    buffer_load_dwordx4 v2, s[4:7], s47 offen lds
    s_add_u32 m0, s50, 1024
    s_nop 0
    buffer_load_dwordx4 v2, s[4:7], s48 offen lds
    s_add_u32 s50, s50, 8192
    s_add_u32 s47, s47, 7168
    s_add_u32 s48, s48, s49
    s_add_u32 s52, s51, 7168
    buffer_load_dwordx4 a[28:31], v2, s[4:7], s52 offen
    s_add_u32 s52, s51, 25600
    buffer_load_dwordx4 a[100:103], v2, s[4:7], s52 offen
    s_mov_b32 m0, s50
    s_nop 0
    buffer_load_dwordx4 v2, s[4:7], s47 offen lds
    s_add_u32 m0, s50, 1024
    s_nop 0
    buffer_load_dwordx4 v2, s[4:7], s48 offen lds
    s_add_u32 s50, s50, 8192
    s_add_u32 s47, s47, 7168
    s_add_u32 s48, s48, s49
    s_add_u32 s52, s51, 8192
    buffer_load_dwordx4 a[32:35], v2, s[4:7], s52 offen
    s_add_u32 s52, s51, 26624
    buffer_load_dwordx4 a[104:107], v2, s[4:7], s52 offen
    s_mov_b32 m0, s50
    s_nop 0
    buffer_load_dwordx4 v2, s[4:7], s47 offen lds
    s_add_u32 m0, s50, 1024
    s_nop 0
    buffer_load_dwordx4 v2, s[4:7], s48 offen lds
    s_add_u32 s50, s50, 8192
    s_add_u32 s47, s47, 7168
    s_add_u32 s48, s48, s49
    s_add_u32 s52, s51, 9216
    buffer_load_dwordx4 a[36:39], v2, s[4:7], s52 offen
    s_add_u32 s52, s51, 27648
    buffer_load_dwordx4 a[108:111], v2, s[4:7], s52 offen
    s_mov_b32 m0, s50
    s_nop 0
    buffer_load_dwordx4 v2, s[4:7], s47 offen lds
    s_add_u32 m0, s50, 1024
    s_nop 0
    buffer_load_dwordx4 v2, s[4:7], s48 offen lds
    s_add_u32 s50, s50, 8192
    s_add_u32 s47, s47, 7168
    s_add_u32 s48, s48, s49
    s_add_u32 s52, s51, 10240
    buffer_load_dwordx4 a[40:43], v2, s[4:7], s52 offen
    s_add_u32 s52, s51, 28672
    buffer_load_dwordx4 a[112:115], v2, s[4:7], s52 offen
    s_mov_b32 m0, s50
    s_nop 0
    buffer_load_dwordx4 v2, s[4:7], s47 offen lds
    s_add_u32 m0, s50, 1024
    s_nop 0
    buffer_load_dwordx4 v2, s[4:7], s48 offen lds
    s_add_u32 s50, s50, 8192
    s_add_u32 s47, s47, 7168
    s_add_u32 s48, s48, s49
    s_add_u32 s52, s51, 11264
    buffer_load_dwordx4 a[44:47], v2, s[4:7], s52 offen
    s_add_u32 s52, s51, 29696
    buffer_load_dwordx4 a[116:119], v2, s[4:7], s52 offen
    s_min_u32 s52, s20, 2
    s_add_u32 s53, s52, 2
    s_add_u32 s54, s52, 4
    s_cmp_ge_u32 s20, 2
    s_cselect_b32 s53, 6, s53
    s_lshl_b32 s53, s53, 10
    s_lshl_b32 s54, s54, 10
    v_mov_b32 v3, v2
    s_waitcnt vmcnt(48)
    v_add_u32 v4, s53, v2
    v_add_u32 v5, s54, v2
    v_and_b32 v6, 15, v1
    v_lshrrev_b32 v7, 4, v1
    v_lshlrev_b32 v7, 2, v7
    v_sub_u32 v6, v6, v7
    v_mov_b32 v8, 0xf149f2ca
    s_or_b32 s52, s44, s20
    s_cmp_eq_u32 s52, 0
    s_cselect_b64 s[56:57], -1, 0
    v_subrev_u32 v7, 0, v6
    v_and_b32 v9, 0xfffffff1, v7
    v_cmp_eq_u32 vcc, 0, v9
    v_add_u32 v7, 16, v7
    v_and_b32 v9, 0xfffffff1, v7
    v_cndmask_b32_e64 v168, v8, 0, vcc
    v_cmp_eq_u32 vcc, 0, v9
    s_nop 1
    v_cndmask_b32_e64 v172, v8, 0, vcc
    v_cndmask_b32_e64 v176, v172, v8, s[56:57]
    v_subrev_u32 v7, 1, v6
    v_and_b32 v9, 0xfffffff1, v7
    v_cmp_eq_u32 vcc, 0, v9
    v_add_u32 v7, 16, v7
    v_and_b32 v9, 0xfffffff1, v7
    v_cndmask_b32_e64 v169, v8, 0, vcc
    v_cmp_eq_u32 vcc, 0, v9
    s_nop 1
    v_cndmask_b32_e64 v173, v8, 0, vcc
    v_cndmask_b32_e64 v177, v173, v8, s[56:57]
    v_subrev_u32 v7, 2, v6
    v_and_b32 v9, 0xfffffff1, v7
    v_cmp_eq_u32 vcc, 0, v9
    v_add_u32 v7, 16, v7
    v_and_b32 v9, 0xfffffff1, v7
    v_cndmask_b32_e64 v170, v8, 0, vcc
    v_cmp_eq_u32 vcc, 0, v9
    s_nop 1
    v_cndmask_b32_e64 v174, v8, 0, vcc
    v_cndmask_b32_e64 v178, v174, v8, s[56:57]
    v_subrev_u32 v7, 3, v6
    v_and_b32 v9, 0xfffffff1, v7
    v_cmp_eq_u32 vcc, 0, v9
    v_add_u32 v7, 16, v7
    v_and_b32 v9, 0xfffffff1, v7
    v_cndmask_b32_e64 v171, v8, 0, vcc
    v_cmp_eq_u32 vcc, 0, v9
    s_nop 1
    v_cndmask_b32_e64 v175, v8, 0, vcc
    v_cndmask_b32_e64 v179, v175, v8, s[56:57]
    s_waitcnt vmcnt(38)
    s_barrier
    ds_read_b128 v[88:91], v3 offset:0
    ds_read_b128 v[92:95], v3 offset:1024
    ds_read_b128 v[96:99], v3 offset:2048
    ds_read_b128 v[100:103], v3 offset:3072
    ds_read_b128 v[112:115], v3 offset:6144
    ds_read_b128 v[104:107], v3 offset:4096
    ds_read_b128 v[108:111], v3 offset:5120
    ds_read_b128 v[144:147], v3 offset:7168
    ds_read_b128 v[148:151], v4 offset:0
    ds_read_b128 v[152:155], v5 offset:0
    s_mov_b32 m0, s50
    s_nop 0
    buffer_load_dwordx4 v2, s[4:7], s47 offen lds
    s_waitcnt lgkmcnt(9)
    v_mfma_f32_16x16x32_bf16 v[16:19], v[88:91], a[0:3], 0
    s_add_u32 m0, s50, 1024
    ds_read_b128 v[116:119], v3 offset:8192
    v_mfma_f32_16x16x32_bf16 v[48:51], v[88:91], a[72:75], 0
    ds_read_b128 v[120:123], v3 offset:9216
    s_waitcnt lgkmcnt(10)
    v_mfma_f32_16x16x32_bf16 v[20:23], v[92:95], a[0:3], 0
    ds_read_b128 v[124:127], v3 offset:10240
    v_mfma_f32_16x16x32_bf16 v[52:55], v[92:95], a[72:75], 0
    buffer_load_dwordx4 v2, s[4:7], s48 offen lds
    s_add_u32 s50, s50, 8192
    s_waitcnt lgkmcnt(10)
    v_mfma_f32_16x16x32_bf16 v[24:27], v[96:99], a[0:3], 0
    s_add_u32 s47, s47, 7168
    s_add_u32 s48, s48, s49
    v_mfma_f32_16x16x32_bf16 v[56:59], v[96:99], a[72:75], 0
    s_add_u32 s52, s51, 12288
    ds_read_b128 v[128:131], v3 offset:11264
    s_waitcnt lgkmcnt(10)
    v_mfma_f32_16x16x32_bf16 v[28:31], v[100:103], a[0:3], 0
    ds_read_b128 v[140:143], v3 offset:14336
    ds_read_b128 v[132:135], v3 offset:12288
    v_mfma_f32_16x16x32_bf16 v[60:63], v[100:103], a[72:75], 0
    buffer_load_dwordx4 a[48:51], v2, s[4:7], s52 offen
    s_add_u32 s52, s51, 30720
    s_waitcnt lgkmcnt(11)
    v_mfma_f32_16x16x32_bf16 v[32:35], v[112:115], a[0:3], 0
    ds_read_b128 v[136:139], v3 offset:13312
    ds_read_b128 v[156:159], v3 offset:15360
    v_mfma_f32_16x16x32_bf16 v[64:67], v[112:115], a[72:75], 0
    ds_read_b128 v[160:163], v4 offset:8192
    ds_read_b128 v[164:167], v5 offset:8192
    v_mfma_f32_16x16x32_bf16 v[44:47], a[0:3], v[112:115], 0
    v_mfma_f32_16x16x32_bf16 v[76:79], a[72:75], v[112:115], 0
    buffer_load_dwordx4 a[120:123], v2, s[4:7], s52 offen
    s_waitcnt lgkmcnt(14)
    v_mfma_f32_16x16x32_bf16 v[36:39], a[0:3], v[104:107], 0
    v_mfma_f32_16x16x32_bf16 v[68:71], a[72:75], v[104:107], 0
    s_waitcnt lgkmcnt(13)
    v_mfma_f32_16x16x32_bf16 v[40:43], a[0:3], v[108:111], 0
    v_mfma_f32_16x16x32_bf16 v[72:75], a[72:75], v[108:111], 0
    s_waitcnt lgkmcnt(11)
    v_mfma_f32_16x16x32_bf16 v[80:83], v[148:151], v[144:147], 0
    s_waitcnt lgkmcnt(10)
    v_mfma_f32_16x16x32_bf16 v[84:87], v[144:147], v[152:155], 0
    s_mov_b32 m0, s50
    s_nop 0
    buffer_load_dwordx4 v2, s[4:7], s47 offen lds
    s_waitcnt lgkmcnt(9)
    v_mfma_f32_16x16x32_bf16 v[16:19], v[116:119], a[4:7], v[16:19]
    s_add_u32 m0, s50, 1024
    ds_read_b128 v[88:91], v3 offset:16384
    v_mfma_f32_16x16x32_bf16 v[48:51], v[116:119], a[76:79], v[48:51]
    ds_read_b128 v[92:95], v3 offset:17408
    s_waitcnt lgkmcnt(10)
    v_mfma_f32_16x16x32_bf16 v[20:23], v[120:123], a[4:7], v[20:23]
    ds_read_b128 v[96:99], v3 offset:18432
    v_mfma_f32_16x16x32_bf16 v[52:55], v[120:123], a[76:79], v[52:55]
    buffer_load_dwordx4 v2, s[4:7], s48 offen lds
    s_add_u32 s50, s50, 8192
    s_waitcnt lgkmcnt(10)
    v_mfma_f32_16x16x32_bf16 v[24:27], v[124:127], a[4:7], v[24:27]
    s_add_u32 s47, s47, 7168
    s_add_u32 s48, s48, s49
    v_mfma_f32_16x16x32_bf16 v[56:59], v[124:127], a[76:79], v[56:59]
    s_add_u32 s52, s51, 13312
    ds_read_b128 v[100:103], v3 offset:19456
    s_waitcnt lgkmcnt(10)
    v_mfma_f32_16x16x32_bf16 v[28:31], v[128:131], a[4:7], v[28:31]
    ds_read_b128 v[112:115], v3 offset:22528
    ds_read_b128 v[104:107], v3 offset:20480
    v_mfma_f32_16x16x32_bf16 v[60:63], v[128:131], a[76:79], v[60:63]
    buffer_load_dwordx4 a[52:55], v2, s[4:7], s52 offen
    s_add_u32 s52, s51, 31744
    s_waitcnt lgkmcnt(11)
    v_mfma_f32_16x16x32_bf16 v[32:35], v[140:143], a[4:7], v[32:35]
    ds_read_b128 v[108:111], v3 offset:21504
    ds_read_b128 v[144:147], v3 offset:23552
    v_mfma_f32_16x16x32_bf16 v[64:67], v[140:143], a[76:79], v[64:67]
    ds_read_b128 v[148:151], v4 offset:16384
    ds_read_b128 v[152:155], v5 offset:16384
    v_mfma_f32_16x16x32_bf16 v[44:47], a[4:7], v[140:143], v[44:47]
    v_mfma_f32_16x16x32_bf16 v[76:79], a[76:79], v[140:143], v[76:79]
    buffer_load_dwordx4 a[124:127], v2, s[4:7], s52 offen
    s_waitcnt lgkmcnt(14)
    v_mfma_f32_16x16x32_bf16 v[36:39], a[4:7], v[132:135], v[36:39]
    v_mfma_f32_16x16x32_bf16 v[68:71], a[76:79], v[132:135], v[68:71]
    s_waitcnt lgkmcnt(13)
    v_mfma_f32_16x16x32_bf16 v[40:43], a[4:7], v[136:139], v[40:43]
    v_mfma_f32_16x16x32_bf16 v[72:75], a[76:79], v[136:139], v[72:75]
    s_waitcnt lgkmcnt(11)
    v_mfma_f32_16x16x32_bf16 v[80:83], v[160:163], v[156:159], v[80:83]
    s_waitcnt lgkmcnt(10)
    v_mfma_f32_16x16x32_bf16 v[84:87], v[156:159], v[164:167], v[84:87]
    s_mov_b32 m0, s50
    s_nop 0
    buffer_load_dwordx4 v2, s[4:7], s47 offen lds
    s_waitcnt vmcnt(46) lgkmcnt(9)
    v_mfma_f32_16x16x32_bf16 v[16:19], v[88:91], a[8:11], v[16:19]
    s_waitcnt vmcnt(35)
    s_barrier
    v_mfma_f32_16x16x32_bf16 v[48:51], v[88:91], a[80:83], v[48:51]
    s_add_u32 m0, s50, 1024
    ds_read_b128 v[116:119], v3 offset:24576
    s_waitcnt lgkmcnt(9)
    v_mfma_f32_16x16x32_bf16 v[20:23], v[92:95], a[8:11], v[20:23]
    ds_read_b128 v[120:123], v3 offset:25600
    ds_read_b128 v[124:127], v3 offset:26624
    v_mfma_f32_16x16x32_bf16 v[52:55], v[92:95], a[80:83], v[52:55]
    buffer_load_dwordx4 v2, s[4:7], s48 offen lds
    s_add_u32 s50, s50, 8192
    s_waitcnt lgkmcnt(10)
    v_mfma_f32_16x16x32_bf16 v[24:27], v[96:99], a[8:11], v[24:27]
    s_add_u32 s47, s47, 7168
    s_add_u32 s48, s48, s49
    v_mfma_f32_16x16x32_bf16 v[56:59], v[96:99], a[80:83], v[56:59]
    s_add_u32 s52, s51, 14336
    ds_read_b128 v[128:131], v3 offset:27648
    s_waitcnt lgkmcnt(10)
    v_mfma_f32_16x16x32_bf16 v[28:31], v[100:103], a[8:11], v[28:31]
    ds_read_b128 v[140:143], v3 offset:30720
    ds_read_b128 v[132:135], v3 offset:28672
    v_mfma_f32_16x16x32_bf16 v[60:63], v[100:103], a[80:83], v[60:63]
    buffer_load_dwordx4 a[56:59], v2, s[4:7], s52 offen
    s_add_u32 s52, s51, 32768
    s_waitcnt lgkmcnt(11)
    v_mfma_f32_16x16x32_bf16 v[32:35], v[112:115], a[8:11], v[32:35]
    ds_read_b128 v[136:139], v3 offset:29696
    ds_read_b128 v[156:159], v3 offset:31744
    v_mfma_f32_16x16x32_bf16 v[64:67], v[112:115], a[80:83], v[64:67]
    ds_read_b128 v[160:163], v4 offset:24576
    ds_read_b128 v[164:167], v5 offset:24576
    v_mfma_f32_16x16x32_bf16 v[44:47], a[8:11], v[112:115], v[44:47]
    v_mfma_f32_16x16x32_bf16 v[76:79], a[80:83], v[112:115], v[76:79]
    buffer_load_dwordx4 a[128:131], v2, s[4:7], s52 offen
    s_waitcnt lgkmcnt(14)
    v_mfma_f32_16x16x32_bf16 v[36:39], a[8:11], v[104:107], v[36:39]
    v_mfma_f32_16x16x32_bf16 v[68:71], a[80:83], v[104:107], v[68:71]
    s_waitcnt lgkmcnt(13)
    v_mfma_f32_16x16x32_bf16 v[40:43], a[8:11], v[108:111], v[40:43]
    v_mfma_f32_16x16x32_bf16 v[72:75], a[80:83], v[108:111], v[72:75]
    s_waitcnt lgkmcnt(11)
    v_mfma_f32_16x16x32_bf16 v[80:83], v[148:151], v[144:147], v[80:83]
    s_waitcnt lgkmcnt(10)
    v_mfma_f32_16x16x32_bf16 v[84:87], v[144:147], v[152:155], v[84:87]
    s_mov_b32 m0, s50
    s_nop 0
    buffer_load_dwordx4 v2, s[4:7], s47 offen lds
    s_waitcnt lgkmcnt(9)
    v_mfma_f32_16x16x32_bf16 v[16:19], v[116:119], a[12:15], v[16:19]
    s_add_u32 m0, s50, 1024
    ds_read_b128 v[88:91], v3 offset:32768
    v_mfma_f32_16x16x32_bf16 v[48:51], v[116:119], a[84:87], v[48:51]
    ds_read_b128 v[92:95], v3 offset:33792
    s_waitcnt lgkmcnt(10)
    v_mfma_f32_16x16x32_bf16 v[20:23], v[120:123], a[12:15], v[20:23]
    ds_read_b128 v[96:99], v3 offset:34816
    v_mfma_f32_16x16x32_bf16 v[52:55], v[120:123], a[84:87], v[52:55]
    buffer_load_dwordx4 v2, s[4:7], s48 offen lds
    s_add_u32 s50, s50, 8192
    s_waitcnt lgkmcnt(10)
    v_mfma_f32_16x16x32_bf16 v[24:27], v[124:127], a[12:15], v[24:27]
    s_add_u32 s47, s47, 7168
    s_add_u32 s48, s48, s49
    v_mfma_f32_16x16x32_bf16 v[56:59], v[124:127], a[84:87], v[56:59]
    s_add_u32 s52, s51, 15360
    ds_read_b128 v[100:103], v3 offset:35840
    s_waitcnt lgkmcnt(10)
    v_mfma_f32_16x16x32_bf16 v[28:31], v[128:131], a[12:15], v[28:31]
    ds_read_b128 v[112:115], v3 offset:38912
    ds_read_b128 v[104:107], v3 offset:36864
    v_mfma_f32_16x16x32_bf16 v[60:63], v[128:131], a[84:87], v[60:63]
    buffer_load_dwordx4 a[60:63], v2, s[4:7], s52 offen
    s_add_u32 s52, s51, 33792
    s_waitcnt lgkmcnt(11)
    v_mfma_f32_16x16x32_bf16 v[32:35], v[140:143], a[12:15], v[32:35]
    ds_read_b128 v[108:111], v3 offset:37888
    ds_read_b128 v[144:147], v3 offset:39936
    v_mfma_f32_16x16x32_bf16 v[64:67], v[140:143], a[84:87], v[64:67]
    ds_read_b128 v[148:151], v4 offset:32768
    ds_read_b128 v[152:155], v5 offset:32768
    v_mfma_f32_16x16x32_bf16 v[44:47], a[12:15], v[140:143], v[44:47]
    v_mfma_f32_16x16x32_bf16 v[76:79], a[84:87], v[140:143], v[76:79]
    buffer_load_dwordx4 a[132:135], v2, s[4:7], s52 offen
    s_waitcnt lgkmcnt(14)
    v_mfma_f32_16x16x32_bf16 v[36:39], a[12:15], v[132:135], v[36:39]
    v_mfma_f32_16x16x32_bf16 v[68:71], a[84:87], v[132:135], v[68:71]
    s_waitcnt lgkmcnt(13)
    v_mfma_f32_16x16x32_bf16 v[40:43], a[12:15], v[136:139], v[40:43]
    v_mfma_f32_16x16x32_bf16 v[72:75], a[84:87], v[136:139], v[72:75]
    s_waitcnt lgkmcnt(11)
    v_mfma_f32_16x16x32_bf16 v[80:83], v[160:163], v[156:159], v[80:83]
    s_waitcnt lgkmcnt(10)
    v_mfma_f32_16x16x32_bf16 v[84:87], v[156:159], v[164:167], v[84:87]
    s_mov_b32 m0, s50
    s_nop 0
    buffer_load_dwordx4 v2, s[4:7], s47 offen lds
    s_waitcnt lgkmcnt(9)
    v_mfma_f32_16x16x32_bf16 v[16:19], v[88:91], a[16:19], v[16:19]
    s_add_u32 m0, s50, 1024
    ds_read_b128 v[116:119], v3 offset:40960
    v_mfma_f32_16x16x32_bf16 v[48:51], v[88:91], a[88:91], v[48:51]
    ds_read_b128 v[120:123], v3 offset:41984
    s_waitcnt lgkmcnt(10)
    v_mfma_f32_16x16x32_bf16 v[20:23], v[92:95], a[16:19], v[20:23]
    ds_read_b128 v[124:127], v3 offset:43008
    v_mfma_f32_16x16x32_bf16 v[52:55], v[92:95], a[88:91], v[52:55]
    buffer_load_dwordx4 v2, s[4:7], s48 offen lds
    s_add_u32 s50, s50, 8192
    s_waitcnt lgkmcnt(10)
    v_mfma_f32_16x16x32_bf16 v[24:27], v[96:99], a[16:19], v[24:27]
    s_add_u32 s47, s47, 7168
    s_add_u32 s48, s48, s49
    v_mfma_f32_16x16x32_bf16 v[56:59], v[96:99], a[88:91], v[56:59]
    s_add_u32 s52, s51, 16384
    ds_read_b128 v[128:131], v3 offset:44032
    s_waitcnt lgkmcnt(10)
    v_mfma_f32_16x16x32_bf16 v[28:31], v[100:103], a[16:19], v[28:31]
    ds_read_b128 v[140:143], v3 offset:47104
    ds_read_b128 v[132:135], v3 offset:45056
    v_mfma_f32_16x16x32_bf16 v[60:63], v[100:103], a[88:91], v[60:63]
    buffer_load_dwordx4 a[64:67], v2, s[4:7], s52 offen
    s_add_u32 s52, s51, 34816
    s_waitcnt lgkmcnt(11)
    v_mfma_f32_16x16x32_bf16 v[32:35], v[112:115], a[16:19], v[32:35]
    ds_read_b128 v[136:139], v3 offset:46080
    ds_read_b128 v[156:159], v3 offset:48128
    v_mfma_f32_16x16x32_bf16 v[64:67], v[112:115], a[88:91], v[64:67]
    ds_read_b128 v[160:163], v4 offset:40960
    ds_read_b128 v[164:167], v5 offset:40960
    v_mfma_f32_16x16x32_bf16 v[44:47], a[16:19], v[112:115], v[44:47]
    v_mfma_f32_16x16x32_bf16 v[76:79], a[88:91], v[112:115], v[76:79]
    buffer_load_dwordx4 a[136:139], v2, s[4:7], s52 offen
    s_waitcnt lgkmcnt(14)
    v_mfma_f32_16x16x32_bf16 v[36:39], a[16:19], v[104:107], v[36:39]
    v_mfma_f32_16x16x32_bf16 v[68:71], a[88:91], v[104:107], v[68:71]
    s_waitcnt lgkmcnt(13)
    v_mfma_f32_16x16x32_bf16 v[40:43], a[16:19], v[108:111], v[40:43]
    v_mfma_f32_16x16x32_bf16 v[72:75], a[88:91], v[108:111], v[72:75]
    s_waitcnt lgkmcnt(11)
    v_mfma_f32_16x16x32_bf16 v[80:83], v[148:151], v[144:147], v[80:83]
    s_waitcnt lgkmcnt(10)
    v_mfma_f32_16x16x32_bf16 v[84:87], v[144:147], v[152:155], v[84:87]
    s_mov_b32 m0, s50
    s_nop 0
    buffer_load_dwordx4 v2, s[4:7], s47 offen lds
    s_waitcnt vmcnt(46) lgkmcnt(9)
    v_mfma_f32_16x16x32_bf16 v[16:19], v[116:119], a[20:23], v[16:19]
    s_waitcnt vmcnt(35)
    s_barrier
    v_mfma_f32_16x16x32_bf16 v[48:51], v[116:119], a[92:95], v[48:51]
    s_add_u32 m0, s50, 1024
    ds_read_b128 v[88:91], v3 offset:49152
    s_waitcnt lgkmcnt(9)
    v_mfma_f32_16x16x32_bf16 v[20:23], v[120:123], a[20:23], v[20:23]
    ds_read_b128 v[92:95], v3 offset:50176
    ds_read_b128 v[96:99], v3 offset:51200
    v_mfma_f32_16x16x32_bf16 v[52:55], v[120:123], a[92:95], v[52:55]
    buffer_load_dwordx4 v2, s[4:7], s48 offen lds
    s_add_u32 s50, s50, 8192
    s_waitcnt lgkmcnt(10)
    v_mfma_f32_16x16x32_bf16 v[24:27], v[124:127], a[20:23], v[24:27]
    s_add_u32 s47, s47, 7168
    s_add_u32 s48, s48, s49
    v_mfma_f32_16x16x32_bf16 v[56:59], v[124:127], a[92:95], v[56:59]
    s_add_u32 s52, s51, 17408
    ds_read_b128 v[100:103], v3 offset:52224
    s_waitcnt lgkmcnt(10)
    v_mfma_f32_16x16x32_bf16 v[28:31], v[128:131], a[20:23], v[28:31]
    ds_read_b128 v[112:115], v3 offset:55296
    ds_read_b128 v[104:107], v3 offset:53248
    v_mfma_f32_16x16x32_bf16 v[60:63], v[128:131], a[92:95], v[60:63]
    buffer_load_dwordx4 a[68:71], v2, s[4:7], s52 offen
    s_add_u32 s52, s51, 35840
    s_waitcnt lgkmcnt(11)
    v_mfma_f32_16x16x32_bf16 v[32:35], v[140:143], a[20:23], v[32:35]
    ds_read_b128 v[108:111], v3 offset:54272
    ds_read_b128 v[144:147], v3 offset:56320
    v_mfma_f32_16x16x32_bf16 v[64:67], v[140:143], a[92:95], v[64:67]
    ds_read_b128 v[148:151], v4 offset:49152
    ds_read_b128 v[152:155], v5 offset:49152
    v_mfma_f32_16x16x32_bf16 v[44:47], a[20:23], v[140:143], v[44:47]
    v_mfma_f32_16x16x32_bf16 v[76:79], a[92:95], v[140:143], v[76:79]
    buffer_load_dwordx4 a[140:143], v2, s[4:7], s52 offen
    s_waitcnt lgkmcnt(14)
    v_mfma_f32_16x16x32_bf16 v[36:39], a[20:23], v[132:135], v[36:39]
    v_mfma_f32_16x16x32_bf16 v[68:71], a[92:95], v[132:135], v[68:71]
    s_waitcnt lgkmcnt(13)
    v_mfma_f32_16x16x32_bf16 v[40:43], a[20:23], v[136:139], v[40:43]
    v_mfma_f32_16x16x32_bf16 v[72:75], a[92:95], v[136:139], v[72:75]
    s_waitcnt lgkmcnt(11)
    v_mfma_f32_16x16x32_bf16 v[80:83], v[160:163], v[156:159], v[80:83]
    s_waitcnt lgkmcnt(10)
    v_mfma_f32_16x16x32_bf16 v[84:87], v[156:159], v[164:167], v[84:87]
    s_waitcnt lgkmcnt(9)
    v_mfma_f32_16x16x32_bf16 v[16:19], v[88:91], a[24:27], v[16:19]
    ds_read_b128 v[116:119], v3 offset:57344
    v_mfma_f32_16x16x32_bf16 v[48:51], v[88:91], a[96:99], v[48:51]
    ds_read_b128 v[120:123], v3 offset:58368
    s_waitcnt lgkmcnt(10)
    v_mfma_f32_16x16x32_bf16 v[20:23], v[92:95], a[24:27], v[20:23]
    ds_read_b128 v[124:127], v3 offset:59392
    v_mfma_f32_16x16x32_bf16 v[52:55], v[92:95], a[96:99], v[52:55]
    ds_read_b128 v[128:131], v3 offset:60416
    s_waitcnt lgkmcnt(11)
    v_mfma_f32_16x16x32_bf16 v[24:27], v[96:99], a[24:27], v[24:27]
    ds_read_b128 v[140:143], v3 offset:63488
    v_mfma_f32_16x16x32_bf16 v[56:59], v[96:99], a[96:99], v[56:59]
    ds_read_b128 v[132:135], v3 offset:61440
    s_waitcnt lgkmcnt(12)
    v_mfma_f32_16x16x32_bf16 v[28:31], v[100:103], a[24:27], v[28:31]
    ds_read_b128 v[136:139], v3 offset:62464
    v_mfma_f32_16x16x32_bf16 v[60:63], v[100:103], a[96:99], v[60:63]
    ds_read_b128 v[156:159], v3 offset:64512
    s_waitcnt lgkmcnt(13)
    v_mfma_f32_16x16x32_bf16 v[32:35], v[112:115], a[24:27], v[32:35]
    ds_read_b128 v[160:163], v4 offset:57344
    v_mfma_f32_16x16x32_bf16 v[64:67], v[112:115], a[96:99], v[64:67]
    ds_read_b128 v[164:167], v5 offset:57344
    v_mfma_f32_16x16x32_bf16 v[44:47], a[24:27], v[112:115], v[44:47]
    v_mfma_f32_16x16x32_bf16 v[76:79], a[96:99], v[112:115], v[76:79]
    s_waitcnt lgkmcnt(14)
    v_mfma_f32_16x16x32_bf16 v[36:39], a[24:27], v[104:107], v[36:39]
    v_mfma_f32_16x16x32_bf16 v[68:71], a[96:99], v[104:107], v[68:71]
    s_waitcnt lgkmcnt(13)
    v_mfma_f32_16x16x32_bf16 v[40:43], a[24:27], v[108:111], v[40:43]
    v_mfma_f32_16x16x32_bf16 v[72:75], a[96:99], v[108:111], v[72:75]
    s_waitcnt lgkmcnt(11)
    v_mfma_f32_16x16x32_bf16 v[80:83], v[148:151], v[144:147], v[80:83]
    s_waitcnt lgkmcnt(10)
    v_mfma_f32_16x16x32_bf16 v[84:87], v[144:147], v[152:155], v[84:87]
    s_waitcnt lgkmcnt(9)
    v_mfma_f32_16x16x32_bf16 v[16:19], v[116:119], a[28:31], v[16:19]
    v_add_u32 v3, 0x10000, v3
    v_mfma_f32_16x16x32_bf16 v[48:51], v[116:119], a[100:103], v[48:51]
    v_add_u32 v4, 0x10000, v4
    s_waitcnt lgkmcnt(8)
    v_mfma_f32_16x16x32_bf16 v[20:23], v[120:123], a[28:31], v[20:23]
    v_add_u32 v5, 0x10000, v5
    v_mfma_f32_16x16x32_bf16 v[52:55], v[120:123], a[100:103], v[52:55]
    ds_read_b128 v[88:91], v3 offset:0
    s_waitcnt lgkmcnt(8)
    v_mfma_f32_16x16x32_bf16 v[24:27], v[124:127], a[28:31], v[24:27]
    ds_read_b128 v[92:95], v3 offset:1024
    v_mfma_f32_16x16x32_bf16 v[56:59], v[124:127], a[100:103], v[56:59]
    ds_read_b128 v[96:99], v3 offset:2048
    s_waitcnt lgkmcnt(9)
    v_mfma_f32_16x16x32_bf16 v[28:31], v[128:131], a[28:31], v[28:31]
    ds_read_b128 v[100:103], v3 offset:3072
    v_mfma_f32_16x16x32_bf16 v[60:63], v[128:131], a[100:103], v[60:63]
    ds_read_b128 v[112:115], v3 offset:6144
    s_waitcnt lgkmcnt(10)
    v_mfma_f32_16x16x32_bf16 v[32:35], v[140:143], a[28:31], v[32:35]
    ds_read_b128 v[104:107], v3 offset:4096
    v_mfma_f32_16x16x32_bf16 v[64:67], v[140:143], a[100:103], v[64:67]
    ds_read_b128 v[108:111], v3 offset:5120
    v_mfma_f32_16x16x32_bf16 v[44:47], a[28:31], v[140:143], v[44:47]
    ds_read_b128 v[144:147], v3 offset:7168
    v_mfma_f32_16x16x32_bf16 v[76:79], a[100:103], v[140:143], v[76:79]
    ds_read_b128 v[148:151], v4 offset:0
    s_waitcnt lgkmcnt(13)
    v_mfma_f32_16x16x32_bf16 v[36:39], a[28:31], v[132:135], v[36:39]
    ds_read_b128 v[152:155], v5 offset:0
    v_mfma_f32_16x16x32_bf16 v[68:71], a[100:103], v[132:135], v[68:71]
    s_waitcnt lgkmcnt(13)
    v_mfma_f32_16x16x32_bf16 v[40:43], a[28:31], v[136:139], v[40:43]
    v_mfma_f32_16x16x32_bf16 v[72:75], a[100:103], v[136:139], v[72:75]
    s_waitcnt lgkmcnt(11)
    v_mfma_f32_16x16x32_bf16 v[80:83], v[160:163], v[156:159], v[80:83]
    s_waitcnt lgkmcnt(10)
    v_mfma_f32_16x16x32_bf16 v[84:87], v[156:159], v[164:167], v[84:87]
    s_waitcnt vmcnt(37) lgkmcnt(9)
    v_mfma_f32_16x16x32_bf16 v[16:19], v[88:91], a[32:35], v[16:19]
    s_waitcnt vmcnt(26)
    s_barrier
    v_mfma_f32_16x16x32_bf16 v[48:51], v[88:91], a[104:107], v[48:51]
    ds_read_b128 v[116:119], v3 offset:8192
    ds_read_b128 v[120:123], v3 offset:9216
    s_waitcnt lgkmcnt(10)
    v_mfma_f32_16x16x32_bf16 v[20:23], v[92:95], a[32:35], v[20:23]
    ds_read_b128 v[124:127], v3 offset:10240
    v_mfma_f32_16x16x32_bf16 v[52:55], v[92:95], a[104:107], v[52:55]
    ds_read_b128 v[128:131], v3 offset:11264
    s_waitcnt lgkmcnt(11)
    v_mfma_f32_16x16x32_bf16 v[24:27], v[96:99], a[32:35], v[24:27]
    ds_read_b128 v[140:143], v3 offset:14336
    v_mfma_f32_16x16x32_bf16 v[56:59], v[96:99], a[104:107], v[56:59]
    ds_read_b128 v[132:135], v3 offset:12288
    s_waitcnt lgkmcnt(12)
    v_mfma_f32_16x16x32_bf16 v[28:31], v[100:103], a[32:35], v[28:31]
    ds_read_b128 v[136:139], v3 offset:13312
    v_mfma_f32_16x16x32_bf16 v[60:63], v[100:103], a[104:107], v[60:63]
    ds_read_b128 v[156:159], v3 offset:15360
    s_waitcnt lgkmcnt(13)
    v_mfma_f32_16x16x32_bf16 v[32:35], v[112:115], a[32:35], v[32:35]
    ds_read_b128 v[160:163], v4 offset:8192
    v_mfma_f32_16x16x32_bf16 v[64:67], v[112:115], a[104:107], v[64:67]
    ds_read_b128 v[164:167], v5 offset:8192
    v_mfma_f32_16x16x32_bf16 v[44:47], a[32:35], v[112:115], v[44:47]
    v_mfma_f32_16x16x32_bf16 v[76:79], a[104:107], v[112:115], v[76:79]
    s_waitcnt lgkmcnt(14)
    v_mfma_f32_16x16x32_bf16 v[36:39], a[32:35], v[104:107], v[36:39]
    v_mfma_f32_16x16x32_bf16 v[68:71], a[104:107], v[104:107], v[68:71]
    s_waitcnt lgkmcnt(13)
    v_mfma_f32_16x16x32_bf16 v[40:43], a[32:35], v[108:111], v[40:43]
    v_mfma_f32_16x16x32_bf16 v[72:75], a[104:107], v[108:111], v[72:75]
    s_waitcnt lgkmcnt(11)
    v_mfma_f32_16x16x32_bf16 v[80:83], v[148:151], v[144:147], v[80:83]
    s_waitcnt lgkmcnt(10)
    v_mfma_f32_16x16x32_bf16 v[84:87], v[144:147], v[152:155], v[84:87]
    s_waitcnt lgkmcnt(9)
    v_mfma_f32_16x16x32_bf16 v[16:19], v[116:119], a[36:39], v[16:19]
    ds_read_b128 v[88:91], v3 offset:16384
    v_mfma_f32_16x16x32_bf16 v[48:51], v[116:119], a[108:111], v[48:51]
    ds_read_b128 v[92:95], v3 offset:17408
    s_waitcnt lgkmcnt(10)
    v_mfma_f32_16x16x32_bf16 v[20:23], v[120:123], a[36:39], v[20:23]
    ds_read_b128 v[96:99], v3 offset:18432
    v_mfma_f32_16x16x32_bf16 v[52:55], v[120:123], a[108:111], v[52:55]
    ds_read_b128 v[100:103], v3 offset:19456
    s_waitcnt lgkmcnt(11)
    v_mfma_f32_16x16x32_bf16 v[24:27], v[124:127], a[36:39], v[24:27]
    ds_read_b128 v[112:115], v3 offset:22528
    v_mfma_f32_16x16x32_bf16 v[56:59], v[124:127], a[108:111], v[56:59]
    ds_read_b128 v[104:107], v3 offset:20480
    s_waitcnt lgkmcnt(12)
    v_mfma_f32_16x16x32_bf16 v[28:31], v[128:131], a[36:39], v[28:31]
    ds_read_b128 v[108:111], v3 offset:21504
    v_mfma_f32_16x16x32_bf16 v[60:63], v[128:131], a[108:111], v[60:63]
    ds_read_b128 v[144:147], v3 offset:23552
    s_waitcnt lgkmcnt(13)
    v_mfma_f32_16x16x32_bf16 v[32:35], v[140:143], a[36:39], v[32:35]
    ds_read_b128 v[148:151], v4 offset:16384
    v_mfma_f32_16x16x32_bf16 v[64:67], v[140:143], a[108:111], v[64:67]
    ds_read_b128 v[152:155], v5 offset:16384
    v_mfma_f32_16x16x32_bf16 v[44:47], a[36:39], v[140:143], v[44:47]
    v_mfma_f32_16x16x32_bf16 v[76:79], a[108:111], v[140:143], v[76:79]
    s_waitcnt lgkmcnt(14)
    v_mfma_f32_16x16x32_bf16 v[36:39], a[36:39], v[132:135], v[36:39]
    v_mfma_f32_16x16x32_bf16 v[68:71], a[108:111], v[132:135], v[68:71]
    s_waitcnt lgkmcnt(13)
    v_mfma_f32_16x16x32_bf16 v[40:43], a[36:39], v[136:139], v[40:43]
    v_mfma_f32_16x16x32_bf16 v[72:75], a[108:111], v[136:139], v[72:75]
    s_waitcnt lgkmcnt(11)
    v_mfma_f32_16x16x32_bf16 v[80:83], v[160:163], v[156:159], v[80:83]
    s_waitcnt lgkmcnt(10)
    v_mfma_f32_16x16x32_bf16 v[84:87], v[156:159], v[164:167], v[84:87]
    s_waitcnt lgkmcnt(9)
    v_mfma_f32_16x16x32_bf16 v[16:19], v[88:91], a[40:43], v[16:19]
    ds_read_b128 v[116:119], v3 offset:24576
    v_mfma_f32_16x16x32_bf16 v[48:51], v[88:91], a[112:115], v[48:51]
    ds_read_b128 v[120:123], v3 offset:25600
    s_waitcnt lgkmcnt(10)
    v_mfma_f32_16x16x32_bf16 v[20:23], v[92:95], a[40:43], v[20:23]
    ds_read_b128 v[124:127], v3 offset:26624
    v_mfma_f32_16x16x32_bf16 v[52:55], v[92:95], a[112:115], v[52:55]
    ds_read_b128 v[128:131], v3 offset:27648
    s_waitcnt lgkmcnt(11)
    v_mfma_f32_16x16x32_bf16 v[24:27], v[96:99], a[40:43], v[24:27]
    ds_read_b128 v[140:143], v3 offset:30720
    v_mfma_f32_16x16x32_bf16 v[56:59], v[96:99], a[112:115], v[56:59]
    ds_read_b128 v[132:135], v3 offset:28672
    s_waitcnt lgkmcnt(12)
    v_mfma_f32_16x16x32_bf16 v[28:31], v[100:103], a[40:43], v[28:31]
    ds_read_b128 v[136:139], v3 offset:29696
    v_mfma_f32_16x16x32_bf16 v[60:63], v[100:103], a[112:115], v[60:63]
    ds_read_b128 v[156:159], v3 offset:31744
    s_waitcnt lgkmcnt(13)
    v_mfma_f32_16x16x32_bf16 v[32:35], v[112:115], a[40:43], v[32:35]
    ds_read_b128 v[160:163], v4 offset:24576
    v_mfma_f32_16x16x32_bf16 v[64:67], v[112:115], a[112:115], v[64:67]
    ds_read_b128 v[164:167], v5 offset:24576
    v_mfma_f32_16x16x32_bf16 v[44:47], a[40:43], v[112:115], v[44:47]
    v_mfma_f32_16x16x32_bf16 v[76:79], a[112:115], v[112:115], v[76:79]
    s_waitcnt lgkmcnt(14)
    v_mfma_f32_16x16x32_bf16 v[36:39], a[40:43], v[104:107], v[36:39]
    v_mfma_f32_16x16x32_bf16 v[68:71], a[112:115], v[104:107], v[68:71]
    s_waitcnt lgkmcnt(13)
    v_mfma_f32_16x16x32_bf16 v[40:43], a[40:43], v[108:111], v[40:43]
    v_mfma_f32_16x16x32_bf16 v[72:75], a[112:115], v[108:111], v[72:75]
    s_waitcnt lgkmcnt(11)
    v_mfma_f32_16x16x32_bf16 v[80:83], v[148:151], v[144:147], v[80:83]
    s_waitcnt lgkmcnt(10)
    v_mfma_f32_16x16x32_bf16 v[84:87], v[144:147], v[152:155], v[84:87]
    s_waitcnt vmcnt(25) lgkmcnt(9)
    v_mfma_f32_16x16x32_bf16 v[16:19], v[116:119], a[44:47], v[16:19]
    s_waitcnt vmcnt(14)
    s_barrier
    v_mfma_f32_16x16x32_bf16 v[48:51], v[116:119], a[116:119], v[48:51]
    ds_read_b128 v[88:91], v3 offset:32768
    ds_read_b128 v[92:95], v3 offset:33792
    s_waitcnt lgkmcnt(10)
    v_mfma_f32_16x16x32_bf16 v[20:23], v[120:123], a[44:47], v[20:23]
    ds_read_b128 v[96:99], v3 offset:34816
    v_mfma_f32_16x16x32_bf16 v[52:55], v[120:123], a[116:119], v[52:55]
    ds_read_b128 v[100:103], v3 offset:35840
    s_waitcnt lgkmcnt(11)
    v_mfma_f32_16x16x32_bf16 v[24:27], v[124:127], a[44:47], v[24:27]
    ds_read_b128 v[112:115], v3 offset:38912
    v_mfma_f32_16x16x32_bf16 v[56:59], v[124:127], a[116:119], v[56:59]
    ds_read_b128 v[104:107], v3 offset:36864
    s_waitcnt lgkmcnt(12)
    v_mfma_f32_16x16x32_bf16 v[28:31], v[128:131], a[44:47], v[28:31]
    ds_read_b128 v[108:111], v3 offset:37888
    v_mfma_f32_16x16x32_bf16 v[60:63], v[128:131], a[116:119], v[60:63]
    ds_read_b128 v[144:147], v3 offset:39936
    s_waitcnt lgkmcnt(13)
    v_mfma_f32_16x16x32_bf16 v[32:35], v[140:143], a[44:47], v[32:35]
    ds_read_b128 v[148:151], v4 offset:32768
    v_mfma_f32_16x16x32_bf16 v[64:67], v[140:143], a[116:119], v[64:67]
    ds_read_b128 v[152:155], v5 offset:32768
    v_mfma_f32_16x16x32_bf16 v[44:47], a[44:47], v[140:143], v[44:47]
    v_mfma_f32_16x16x32_bf16 v[76:79], a[116:119], v[140:143], v[76:79]
    s_waitcnt lgkmcnt(14)
    v_mfma_f32_16x16x32_bf16 v[36:39], a[44:47], v[132:135], v[36:39]
    v_mfma_f32_16x16x32_bf16 v[68:71], a[116:119], v[132:135], v[68:71]
    s_waitcnt lgkmcnt(13)
    v_mfma_f32_16x16x32_bf16 v[40:43], a[44:47], v[136:139], v[40:43]
    v_mfma_f32_16x16x32_bf16 v[72:75], a[116:119], v[136:139], v[72:75]
    s_waitcnt lgkmcnt(11)
    v_mfma_f32_16x16x32_bf16 v[80:83], v[160:163], v[156:159], v[80:83]
    s_waitcnt lgkmcnt(10)
    v_mfma_f32_16x16x32_bf16 v[84:87], v[156:159], v[164:167], v[84:87]
    s_waitcnt lgkmcnt(9)
    v_mfma_f32_16x16x32_bf16 v[16:19], v[88:91], a[48:51], v[16:19]
    ds_read_b128 v[116:119], v3 offset:40960
    v_mfma_f32_16x16x32_bf16 v[48:51], v[88:91], a[120:123], v[48:51]
    ds_read_b128 v[120:123], v3 offset:41984
    s_waitcnt lgkmcnt(10)
    v_mfma_f32_16x16x32_bf16 v[20:23], v[92:95], a[48:51], v[20:23]
    ds_read_b128 v[124:127], v3 offset:43008
    v_mfma_f32_16x16x32_bf16 v[52:55], v[92:95], a[120:123], v[52:55]
    ds_read_b128 v[128:131], v3 offset:44032
    s_waitcnt lgkmcnt(11)
    v_mfma_f32_16x16x32_bf16 v[24:27], v[96:99], a[48:51], v[24:27]
    ds_read_b128 v[140:143], v3 offset:47104
    v_mfma_f32_16x16x32_bf16 v[56:59], v[96:99], a[120:123], v[56:59]
    ds_read_b128 v[132:135], v3 offset:45056
    s_waitcnt lgkmcnt(12)
    v_mfma_f32_16x16x32_bf16 v[28:31], v[100:103], a[48:51], v[28:31]
    ds_read_b128 v[136:139], v3 offset:46080
    v_mfma_f32_16x16x32_bf16 v[60:63], v[100:103], a[120:123], v[60:63]
    ds_read_b128 v[156:159], v3 offset:48128
    s_waitcnt lgkmcnt(13)
    v_mfma_f32_16x16x32_bf16 v[32:35], v[112:115], a[48:51], v[32:35]
    ds_read_b128 v[160:163], v4 offset:40960
    v_mfma_f32_16x16x32_bf16 v[64:67], v[112:115], a[120:123], v[64:67]
    ds_read_b128 v[164:167], v5 offset:40960
    v_mfma_f32_16x16x32_bf16 v[44:47], a[48:51], v[112:115], v[44:47]
    v_mfma_f32_16x16x32_bf16 v[76:79], a[120:123], v[112:115], v[76:79]
    s_waitcnt lgkmcnt(14)
    v_mfma_f32_16x16x32_bf16 v[36:39], a[48:51], v[104:107], v[36:39]
    v_mfma_f32_16x16x32_bf16 v[68:71], a[120:123], v[104:107], v[68:71]
    s_waitcnt lgkmcnt(13)
    v_mfma_f32_16x16x32_bf16 v[40:43], a[48:51], v[108:111], v[40:43]
    v_mfma_f32_16x16x32_bf16 v[72:75], a[120:123], v[108:111], v[72:75]
    s_waitcnt lgkmcnt(11)
    v_mfma_f32_16x16x32_bf16 v[80:83], v[148:151], v[144:147], v[80:83]
    s_waitcnt lgkmcnt(10)
    v_mfma_f32_16x16x32_bf16 v[84:87], v[144:147], v[152:155], v[84:87]
    s_waitcnt lgkmcnt(9)
    v_mfma_f32_16x16x32_bf16 v[16:19], v[116:119], a[52:55], v[16:19]
    ds_read_b128 v[88:91], v3 offset:49152
    v_mfma_f32_16x16x32_bf16 v[48:51], v[116:119], a[124:127], v[48:51]
    ds_read_b128 v[92:95], v3 offset:50176
    s_waitcnt lgkmcnt(10)
    v_mfma_f32_16x16x32_bf16 v[20:23], v[120:123], a[52:55], v[20:23]
    ds_read_b128 v[96:99], v3 offset:51200
    v_mfma_f32_16x16x32_bf16 v[52:55], v[120:123], a[124:127], v[52:55]
    ds_read_b128 v[100:103], v3 offset:52224
    s_waitcnt lgkmcnt(11)
    v_mfma_f32_16x16x32_bf16 v[24:27], v[124:127], a[52:55], v[24:27]
    ds_read_b128 v[112:115], v3 offset:55296
    v_mfma_f32_16x16x32_bf16 v[56:59], v[124:127], a[124:127], v[56:59]
    ds_read_b128 v[104:107], v3 offset:53248
    s_waitcnt lgkmcnt(12)
    v_mfma_f32_16x16x32_bf16 v[28:31], v[128:131], a[52:55], v[28:31]
    ds_read_b128 v[108:111], v3 offset:54272
    v_mfma_f32_16x16x32_bf16 v[60:63], v[128:131], a[124:127], v[60:63]
    ds_read_b128 v[144:147], v3 offset:56320
    s_waitcnt lgkmcnt(13)
    v_mfma_f32_16x16x32_bf16 v[32:35], v[140:143], a[52:55], v[32:35]
    ds_read_b128 v[148:151], v4 offset:49152
    v_mfma_f32_16x16x32_bf16 v[64:67], v[140:143], a[124:127], v[64:67]
    ds_read_b128 v[152:155], v5 offset:49152
    v_mfma_f32_16x16x32_bf16 v[44:47], a[52:55], v[140:143], v[44:47]
    v_mfma_f32_16x16x32_bf16 v[76:79], a[124:127], v[140:143], v[76:79]
    s_waitcnt lgkmcnt(14)
    v_mfma_f32_16x16x32_bf16 v[36:39], a[52:55], v[132:135], v[36:39]
    v_mfma_f32_16x16x32_bf16 v[68:71], a[124:127], v[132:135], v[68:71]
    s_waitcnt lgkmcnt(13)
    v_mfma_f32_16x16x32_bf16 v[40:43], a[52:55], v[136:139], v[40:43]
    v_mfma_f32_16x16x32_bf16 v[72:75], a[124:127], v[136:139], v[72:75]
    s_waitcnt lgkmcnt(11)
    v_mfma_f32_16x16x32_bf16 v[80:83], v[160:163], v[156:159], v[80:83]
    s_waitcnt lgkmcnt(10)
    v_mfma_f32_16x16x32_bf16 v[84:87], v[156:159], v[164:167], v[84:87]
    s_waitcnt vmcnt(13) lgkmcnt(9)
    v_mfma_f32_16x16x32_bf16 v[16:19], v[88:91], a[56:59], v[16:19]
    s_waitcnt vmcnt(2)
    s_barrier
    v_mfma_f32_16x16x32_bf16 v[48:51], v[88:91], a[128:131], v[48:51]
    ds_read_b128 v[116:119], v3 offset:57344
    ds_read_b128 v[120:123], v3 offset:58368
    s_waitcnt lgkmcnt(10)
    v_mfma_f32_16x16x32_bf16 v[20:23], v[92:95], a[56:59], v[20:23]
    ds_read_b128 v[124:127], v3 offset:59392
    v_mfma_f32_16x16x32_bf16 v[52:55], v[92:95], a[128:131], v[52:55]
    ds_read_b128 v[128:131], v3 offset:60416
    s_waitcnt lgkmcnt(11)
    v_mfma_f32_16x16x32_bf16 v[24:27], v[96:99], a[56:59], v[24:27]
    ds_read_b128 v[140:143], v3 offset:63488
    v_mfma_f32_16x16x32_bf16 v[56:59], v[96:99], a[128:131], v[56:59]
    ds_read_b128 v[132:135], v3 offset:61440
    s_waitcnt lgkmcnt(12)
    v_mfma_f32_16x16x32_bf16 v[28:31], v[100:103], a[56:59], v[28:31]
    ds_read_b128 v[136:139], v3 offset:62464
    v_mfma_f32_16x16x32_bf16 v[60:63], v[100:103], a[128:131], v[60:63]
    ds_read_b128 v[156:159], v3 offset:64512
    s_waitcnt lgkmcnt(13)
    v_mfma_f32_16x16x32_bf16 v[32:35], v[112:115], a[56:59], v[32:35]
    ds_read_b128 v[160:163], v4 offset:57344
    v_mfma_f32_16x16x32_bf16 v[64:67], v[112:115], a[128:131], v[64:67]
    ds_read_b128 v[164:167], v5 offset:57344
    v_mfma_f32_16x16x32_bf16 v[44:47], a[56:59], v[112:115], v[44:47]
    v_mfma_f32_16x16x32_bf16 v[76:79], a[128:131], v[112:115], v[76:79]
    s_waitcnt lgkmcnt(14)
    v_mfma_f32_16x16x32_bf16 v[36:39], a[56:59], v[104:107], v[36:39]
    v_mfma_f32_16x16x32_bf16 v[68:71], a[128:131], v[104:107], v[68:71]
    s_waitcnt lgkmcnt(13)
    v_mfma_f32_16x16x32_bf16 v[40:43], a[56:59], v[108:111], v[40:43]
    v_mfma_f32_16x16x32_bf16 v[72:75], a[128:131], v[108:111], v[72:75]
    s_waitcnt lgkmcnt(11)
    v_mfma_f32_16x16x32_bf16 v[80:83], v[148:151], v[144:147], v[80:83]
    s_waitcnt lgkmcnt(10)
    v_mfma_f32_16x16x32_bf16 v[84:87], v[144:147], v[152:155], v[84:87]
    s_waitcnt lgkmcnt(9)
    v_mfma_f32_16x16x32_bf16 v[16:19], v[116:119], a[60:63], v[16:19]
    v_add_u32 v3, 0x10000, v3
    v_mfma_f32_16x16x32_bf16 v[48:51], v[116:119], a[132:135], v[48:51]
    v_add_u32 v4, 0x10000, v4
    s_waitcnt lgkmcnt(8)
    v_mfma_f32_16x16x32_bf16 v[20:23], v[120:123], a[60:63], v[20:23]
    v_add_u32 v5, 0x10000, v5
    v_mfma_f32_16x16x32_bf16 v[52:55], v[120:123], a[132:135], v[52:55]
    ds_read_b128 v[88:91], v3 offset:0
    s_waitcnt lgkmcnt(8)
    v_mfma_f32_16x16x32_bf16 v[24:27], v[124:127], a[60:63], v[24:27]
    ds_read_b128 v[92:95], v3 offset:1024
    v_mfma_f32_16x16x32_bf16 v[56:59], v[124:127], a[132:135], v[56:59]
    ds_read_b128 v[96:99], v3 offset:2048
    s_waitcnt lgkmcnt(9)
    v_mfma_f32_16x16x32_bf16 v[28:31], v[128:131], a[60:63], v[28:31]
    ds_read_b128 v[100:103], v3 offset:3072
    v_mfma_f32_16x16x32_bf16 v[60:63], v[128:131], a[132:135], v[60:63]
    ds_read_b128 v[112:115], v3 offset:6144
    s_waitcnt lgkmcnt(10)
    v_mfma_f32_16x16x32_bf16 v[32:35], v[140:143], a[60:63], v[32:35]
    ds_read_b128 v[104:107], v3 offset:4096
    v_mfma_f32_16x16x32_bf16 v[64:67], v[140:143], a[132:135], v[64:67]
    ds_read_b128 v[108:111], v3 offset:5120
    v_mfma_f32_16x16x32_bf16 v[44:47], a[60:63], v[140:143], v[44:47]
    ds_read_b128 v[144:147], v3 offset:7168
    v_mfma_f32_16x16x32_bf16 v[76:79], a[132:135], v[140:143], v[76:79]
    ds_read_b128 v[148:151], v4 offset:0
    s_waitcnt lgkmcnt(13)
    v_mfma_f32_16x16x32_bf16 v[36:39], a[60:63], v[132:135], v[36:39]
    ds_read_b128 v[152:155], v5 offset:0
    v_mfma_f32_16x16x32_bf16 v[68:71], a[132:135], v[132:135], v[68:71]
    s_waitcnt lgkmcnt(13)
    v_mfma_f32_16x16x32_bf16 v[40:43], a[60:63], v[136:139], v[40:43]
    v_mfma_f32_16x16x32_bf16 v[72:75], a[132:135], v[136:139], v[72:75]
    s_waitcnt lgkmcnt(11)
    v_mfma_f32_16x16x32_bf16 v[80:83], v[160:163], v[156:159], v[80:83]
    s_waitcnt lgkmcnt(10)
    v_mfma_f32_16x16x32_bf16 v[84:87], v[156:159], v[164:167], v[84:87]
    s_waitcnt lgkmcnt(9)
    v_mfma_f32_16x16x32_bf16 v[16:19], v[88:91], a[64:67], v[16:19]
    ds_read_b128 v[116:119], v3 offset:8192
    v_mfma_f32_16x16x32_bf16 v[48:51], v[88:91], a[136:139], v[48:51]
    ds_read_b128 v[120:123], v3 offset:9216
    s_waitcnt lgkmcnt(10)
    v_mfma_f32_16x16x32_bf16 v[20:23], v[92:95], a[64:67], v[20:23]
    ds_read_b128 v[124:127], v3 offset:10240
    v_mfma_f32_16x16x32_bf16 v[52:55], v[92:95], a[136:139], v[52:55]
    ds_read_b128 v[128:131], v3 offset:11264
    s_waitcnt lgkmcnt(11)
    v_mfma_f32_16x16x32_bf16 v[24:27], v[96:99], a[64:67], v[24:27]
    ds_read_b128 v[140:143], v3 offset:14336
    v_mfma_f32_16x16x32_bf16 v[56:59], v[96:99], a[136:139], v[56:59]
    ds_read_b128 v[132:135], v3 offset:12288
    s_waitcnt lgkmcnt(12)
    v_mfma_f32_16x16x32_bf16 v[28:31], v[100:103], a[64:67], v[28:31]
    ds_read_b128 v[136:139], v3 offset:13312
    v_mfma_f32_16x16x32_bf16 v[60:63], v[100:103], a[136:139], v[60:63]
    ds_read_b128 v[156:159], v3 offset:15360
    s_waitcnt lgkmcnt(13)
    v_mfma_f32_16x16x32_bf16 v[32:35], v[112:115], a[64:67], v[32:35]
    ds_read_b128 v[160:163], v4 offset:8192
    v_mfma_f32_16x16x32_bf16 v[64:67], v[112:115], a[136:139], v[64:67]
    ds_read_b128 v[164:167], v5 offset:8192
    v_mfma_f32_16x16x32_bf16 v[44:47], a[64:67], v[112:115], v[44:47]
    v_mfma_f32_16x16x32_bf16 v[76:79], a[136:139], v[112:115], v[76:79]
    s_waitcnt lgkmcnt(14)
    v_mfma_f32_16x16x32_bf16 v[36:39], a[64:67], v[104:107], v[36:39]
    v_mfma_f32_16x16x32_bf16 v[68:71], a[136:139], v[104:107], v[68:71]
    s_waitcnt lgkmcnt(13)
    v_mfma_f32_16x16x32_bf16 v[40:43], a[64:67], v[108:111], v[40:43]
    v_mfma_f32_16x16x32_bf16 v[72:75], a[136:139], v[108:111], v[72:75]
    s_waitcnt lgkmcnt(11)
    v_mfma_f32_16x16x32_bf16 v[80:83], v[148:151], v[144:147], v[80:83]
    s_waitcnt lgkmcnt(10)
    v_mfma_f32_16x16x32_bf16 v[84:87], v[144:147], v[152:155], v[84:87]
    s_waitcnt vmcnt(1) lgkmcnt(9)
    v_mfma_f32_16x16x32_bf16 v[16:19], v[116:119], a[68:71], v[16:19]
    s_waitcnt vmcnt(0)
    v_mfma_f32_16x16x32_bf16 v[48:51], v[116:119], a[140:143], v[48:51]
    s_waitcnt lgkmcnt(8)
    v_mfma_f32_16x16x32_bf16 v[20:23], v[120:123], a[68:71], v[20:23]
    v_mfma_f32_16x16x32_bf16 v[52:55], v[120:123], a[140:143], v[52:55]
    s_waitcnt lgkmcnt(7)
    v_mfma_f32_16x16x32_bf16 v[24:27], v[124:127], a[68:71], v[24:27]
    v_mfma_f32_16x16x32_bf16 v[56:59], v[124:127], a[140:143], v[56:59]
    s_waitcnt lgkmcnt(6)
    v_mfma_f32_16x16x32_bf16 v[28:31], v[128:131], a[68:71], v[28:31]
    v_mfma_f32_16x16x32_bf16 v[60:63], v[128:131], a[140:143], v[60:63]
    s_waitcnt lgkmcnt(5)
    v_mfma_f32_16x16x32_bf16 v[32:35], v[140:143], a[68:71], v[32:35]
    v_mfma_f32_16x16x32_bf16 v[64:67], v[140:143], a[140:143], v[64:67]
    v_mfma_f32_16x16x32_bf16 v[44:47], a[68:71], v[140:143], v[44:47]
    v_mfma_f32_16x16x32_bf16 v[76:79], a[140:143], v[140:143], v[76:79]
    s_waitcnt lgkmcnt(4)
    v_mfma_f32_16x16x32_bf16 v[36:39], a[68:71], v[132:135], v[36:39]
    v_mfma_f32_16x16x32_bf16 v[68:71], a[140:143], v[132:135], v[68:71]
    s_waitcnt lgkmcnt(3)
    v_mfma_f32_16x16x32_bf16 v[40:43], a[68:71], v[136:139], v[40:43]
    v_mfma_f32_16x16x32_bf16 v[72:75], a[140:143], v[136:139], v[72:75]
    s_waitcnt lgkmcnt(1)
    v_mfma_f32_16x16x32_bf16 v[80:83], v[160:163], v[156:159], v[80:83]
    s_waitcnt lgkmcnt(0)
    v_mfma_f32_16x16x32_bf16 v[84:87], v[156:159], v[164:167], v[84:87]
    v_lshlrev_b32 v6, 3, v1
    v_add_u32 v6, 147456, v6
    s_mul_i32 s52, s20, 3072
    v_add_u32 v7, s52, v6
    v_cvt_pk_bf16_f32 v100, v56, v57
    v_cvt_pk_bf16_f32 v101, v58, v59
    v_cvt_pk_bf16_f32 v104, v60, v61
    v_cvt_pk_bf16_f32 v105, v62, v63
    v_cvt_pk_bf16_f32 v134, v64, v65
    v_cvt_pk_bf16_f32 v137, v66, v67
    v_mov_b32 v102, 0
    v_mov_b32 v103, 0
    v_cvt_pk_bf16_f32 v110, v68, v69
    v_cvt_pk_bf16_f32 v111, v70, v71
    v_cvt_pk_bf16_f32 v116, v72, v73
    v_cvt_pk_bf16_f32 v117, v74, v75
    v_cvt_pk_bf16_f32 v122, v76, v77
    v_cvt_pk_bf16_f32 v123, v78, v79
    v_permlane32_swap_b32 v134, v102
    v_permlane32_swap_b32 v137, v103
    ds_write_b64 v7, v[100:101] offset:3072
    ds_write_b64 v7, v[102:103] offset:3584
    ds_write_b64 v7, v[104:105] offset:4096
    ds_write_b64 v7, v[110:111] offset:4608
    ds_write_b64 v7, v[116:117] offset:5120
    ds_write_b64 v7, v[122:123] offset:5632
    v_cvt_pk_bf16_f32 v140, v80, v81
    v_cvt_pk_bf16_f32 v141, v82, v83
    v_cvt_pk_bf16_f32 v142, v84, v85
    v_cvt_pk_bf16_f32 v143, v86, v87
    s_min_u32 s52, s20, 2
    s_lshl_b32 s53, s52, 1
    s_cmp_ge_u32 s20, 2
    s_cselect_b32 s53, 1, s53
    s_lshl_b32 s53, s53, 9
    s_add_u32 s52, s52, 3
    s_lshl_b32 s52, s52, 9
    v_add_u32 v8, s53, v6
    v_add_u32 v9, s52, v6
    s_cmp_lt_u32 s20, 2
    s_cbranch_scc1 L_noswap_25
    v_mov_b32 v10, 0
    v_mov_b32 v11, 0
    s_nop 1
    v_permlane32_swap_b32 v140, v10
    v_permlane32_swap_b32 v141, v11
    v_mov_b32 v140, v10
    v_mov_b32 v141, v11
L_noswap_25:
    ds_write_b64 v8, v[140:141]
    ds_write_b64 v9, v[142:143]
    v_cvt_pk_bf16_f32 v132, v48, v49
    v_cvt_pk_bf16_f32 v133, v50, v51
    v_cvt_pk_bf16_f32 v138, v52, v53
    v_cvt_pk_bf16_f32 v139, v54, v55
    v_mov_b32 v135, 0
    v_mov_b32 v136, 0
    v_cvt_pk_bf16_f32 v94, v24, v25
    v_cvt_pk_bf16_f32 v95, v26, v27
    v_cvt_pk_bf16_f32 v98, v28, v29
    v_cvt_pk_bf16_f32 v99, v30, v31
    v_cvt_pk_bf16_f32 v126, v32, v33
    v_cvt_pk_bf16_f32 v129, v34, v35
    v_mov_b32 v96, 0
    v_mov_b32 v97, 0
    v_cvt_pk_bf16_f32 v108, v36, v37
    v_cvt_pk_bf16_f32 v109, v38, v39
    v_cvt_pk_bf16_f32 v114, v40, v41
    v_cvt_pk_bf16_f32 v115, v42, v43
    v_cvt_pk_bf16_f32 v120, v44, v45
    v_cvt_pk_bf16_f32 v121, v46, v47
    v_permlane32_swap_b32 v126, v96
    v_permlane32_swap_b32 v129, v97
    v_cvt_pk_bf16_f32 v124, v16, v17
    v_cvt_pk_bf16_f32 v125, v18, v19
    v_cvt_pk_bf16_f32 v130, v20, v21
    v_cvt_pk_bf16_f32 v131, v22, v23
    v_mov_b32 v127, 0
    v_mov_b32 v128, 0
    v_mov_b32 v12, 0x3f803f80
    v_mov_b32 v13, 0x3f803f80
    v_mov_b32 v14, 0x3f803f80
    v_mov_b32 v15, 0x3f803f80
    v_mfma_f32_16x16x32_bf16 v[32:35], v[94:97], v[132:135], v[172:175]
    v_mfma_f32_16x16x32_bf16 v[36:39], v[100:103], v[132:135], v[168:171]
    v_mfma_f32_16x16x32_bf16 v[20:23], v[94:97], v[124:127], v[168:171]
    v_mfma_f32_16x16x32_bf16 v[40:43], v[96:99], v[136:139], v[172:175]
    v_mfma_f32_16x16x32_bf16 v[44:47], v[102:105], v[136:139], v[168:171]
    v_mfma_f32_16x16x32_bf16 v[28:31], v[96:99], v[128:131], v[168:171]
    s_waitcnt lgkmcnt(0)
    s_barrier
    ds_read_b64 v[88:89], v7 offset:0
    ds_read_b64 v[90:91], v7 offset:512
    ds_read_b64 v[92:93], v7 offset:1024
    ds_read_b64 v[106:107], v7 offset:1536
    ds_read_b64 v[112:113], v7 offset:2048
    ds_read_b64 v[118:119], v7 offset:2560
    s_mov_b32 s52, 0x3eae1a93
    s_waitcnt lgkmcnt(4)
    v_mfma_f32_16x16x32_bf16 v[16:19], v[88:91], v[124:127], v[176:179]
    s_waitcnt lgkmcnt(3)
    v_mfma_f32_16x16x32_bf16 v[24:27], v[90:93], v[128:131], v[176:179]
    v_max3_f32 v48, v32, v33, v34
    v_max3_f32 v49, v40, v41, v42
    s_nop 3
    v_max3_f32 v50, v16, v17, v18
    s_nop 0
    v_max3_f32 v51, v24, v25, v26
    v_max3_f32 v48, v48, v35, v36
    v_max3_f32 v49, v49, v43, v44
    v_max3_f32 v50, v50, v19, v20
    v_max3_f32 v51, v51, v27, v28
    v_max3_f32 v48, v48, v37, v38
    v_max3_f32 v49, v49, v45, v46
    v_max3_f32 v50, v50, v21, v22
    v_max3_f32 v51, v51, v29, v30
    v_max_f32 v48, v48, v39
    v_max_f32 v49, v49, v47
    v_max_f32 v50, v50, v23
    v_max_f32 v51, v51, v31
    v_mov_b32 v52, v48
    v_mov_b32 v53, v49
    v_mov_b32 v54, v50
    v_mov_b32 v55, v51
    v_permlane16_swap_b32 v48, v52
    v_permlane16_swap_b32 v49, v53
    v_permlane16_swap_b32 v50, v54
    v_permlane16_swap_b32 v51, v55
    v_max_f32 v48, v48, v52
    v_max_f32 v49, v49, v53
    v_max_f32 v50, v50, v54
    v_max_f32 v51, v51, v55
    v_mov_b32 v52, v48
    v_mov_b32 v53, v49
    v_mov_b32 v54, v50
    v_mov_b32 v55, v51
    v_permlane32_swap_b32 v48, v52
    v_permlane32_swap_b32 v49, v53
    v_permlane32_swap_b32 v50, v54
    v_permlane32_swap_b32 v51, v55
    v_max_f32 v48, v48, v52
    v_max_f32 v49, v49, v53
    v_max_f32 v50, v50, v54
    v_max_f32 v51, v51, v55
    v_mul_f32 v48, s52, v48
    v_mul_f32 v49, s52, v49
    v_mul_f32 v50, s52, v50
    v_mul_f32 v51, s52, v51
    v_fma_f32 v32, v32, s52, -v48
    v_fma_f32 v40, v40, s52, -v49
    v_fma_f32 v16, v16, s52, -v50
    v_fma_f32 v24, v24, s52, -v51
    v_fma_f32 v33, v33, s52, -v48
    v_fma_f32 v41, v41, s52, -v49
    v_fma_f32 v17, v17, s52, -v50
    v_fma_f32 v25, v25, s52, -v51
    v_fma_f32 v34, v34, s52, -v48
    v_fma_f32 v42, v42, s52, -v49
    v_fma_f32 v18, v18, s52, -v50
    v_fma_f32 v26, v26, s52, -v51
    v_fma_f32 v35, v35, s52, -v48
    v_fma_f32 v43, v43, s52, -v49
    v_fma_f32 v19, v19, s52, -v50
    v_fma_f32 v27, v27, s52, -v51
    v_fma_f32 v36, v36, s52, -v48
    v_fma_f32 v44, v44, s52, -v49
    v_fma_f32 v20, v20, s52, -v50
    v_fma_f32 v28, v28, s52, -v51
    v_fma_f32 v37, v37, s52, -v48
    v_fma_f32 v45, v45, s52, -v49
    v_fma_f32 v21, v21, s52, -v50
    v_fma_f32 v29, v29, s52, -v51
    v_fma_f32 v38, v38, s52, -v48
    v_fma_f32 v46, v46, s52, -v49
    v_fma_f32 v22, v22, s52, -v50
    v_fma_f32 v30, v30, s52, -v51
    v_fma_f32 v39, v39, s52, -v48
    v_fma_f32 v47, v47, s52, -v49
    v_fma_f32 v23, v23, s52, -v50
    v_fma_f32 v31, v31, s52, -v51
    v_exp_f32 v32, v32
    v_exp_f32 v40, v40
    v_exp_f32 v16, v16
    v_exp_f32 v24, v24
    v_exp_f32 v33, v33
    v_exp_f32 v41, v41
    v_exp_f32 v17, v17
    v_exp_f32 v25, v25
    v_exp_f32 v34, v34
    v_exp_f32 v42, v42
    v_exp_f32 v18, v18
    v_exp_f32 v26, v26
    v_exp_f32 v35, v35
    v_exp_f32 v43, v43
    v_exp_f32 v19, v19
    v_exp_f32 v27, v27
    v_exp_f32 v36, v36
    v_exp_f32 v44, v44
    v_exp_f32 v20, v20
    v_exp_f32 v28, v28
    v_exp_f32 v37, v37
    v_exp_f32 v45, v45
    v_exp_f32 v21, v21
    v_exp_f32 v29, v29
    v_exp_f32 v38, v38
    v_exp_f32 v46, v46
    v_exp_f32 v22, v22
    v_exp_f32 v30, v30
    v_exp_f32 v39, v39
    v_exp_f32 v47, v47
    v_exp_f32 v23, v23
    v_exp_f32 v31, v31
    v_cvt_pk_bf16_f32 v56, v32, v33
    v_cvt_pk_bf16_f32 v60, v40, v41
    v_cvt_pk_bf16_f32 v64, v16, v17
    v_cvt_pk_bf16_f32 v68, v24, v25
    v_cvt_pk_bf16_f32 v57, v34, v35
    v_cvt_pk_bf16_f32 v61, v42, v43
    v_cvt_pk_bf16_f32 v65, v18, v19
    v_cvt_pk_bf16_f32 v69, v26, v27
    v_cvt_pk_bf16_f32 v58, v36, v37
    v_cvt_pk_bf16_f32 v62, v44, v45
    v_cvt_pk_bf16_f32 v66, v20, v21
    v_cvt_pk_bf16_f32 v70, v28, v29
    v_cvt_pk_bf16_f32 v59, v38, v39
    v_cvt_pk_bf16_f32 v63, v46, v47
    v_cvt_pk_bf16_f32 v67, v22, v23
    v_cvt_pk_bf16_f32 v71, v30, v31
    v_mfma_f32_16x16x32_bf16 v[188:191], v[12:15], v[56:59], 0
    v_mfma_f32_16x16x32_bf16 v[180:183], v[108:111], v[56:59], 0
    v_mfma_f32_16x16x32_bf16 v[184:187], v[120:123], v[56:59], 0
    v_mfma_f32_16x16x32_bf16 v[200:203], v[12:15], v[60:63], 0
    v_mfma_f32_16x16x32_bf16 v[192:195], v[114:117], v[60:63], 0
    v_mfma_f32_16x16x32_bf16 v[196:199], v[120:123], v[60:63], 0
    v_mfma_f32_16x16x32_bf16 v[212:215], v[12:15], v[64:67], 0
    s_waitcnt lgkmcnt(2)
    v_mfma_f32_16x16x32_bf16 v[204:207], v[106:109], v[64:67], 0
    s_waitcnt lgkmcnt(0)
    v_mfma_f32_16x16x32_bf16 v[208:211], v[118:121], v[64:67], 0
    v_mfma_f32_16x16x32_bf16 v[224:227], v[12:15], v[68:71], 0
    v_mfma_f32_16x16x32_bf16 v[216:219], v[112:115], v[68:71], 0
    v_mfma_f32_16x16x32_bf16 v[220:223], v[118:121], v[68:71], 0
    s_lshl_b32 s53, s46, 4
    s_add_u32 s53, s53, s45
    s_lshl_b32 s54, s53, 10
    s_add_u32 s54, s54, 23330816
    s_lshl_b32 s55, s53, 7
    s_add_u32 s55, s55, 25427840
    v_lshlrev_b32 v6, 3, v1
    v_rcp_f32 v188, v188
    v_rcp_f32 v200, v200
    v_rcp_f32 v212, v212
    v_rcp_f32 v224, v224
    v_mul_f32 v180, v180, v188
    v_mul_f32 v181, v181, v188
    v_mul_f32 v182, v182, v188
    v_mul_f32 v183, v183, v188
    v_mul_f32 v184, v184, v188
    v_mul_f32 v185, v185, v188
    v_cvt_pk_bf16_f32 v76, v180, v181
    v_cvt_pk_bf16_f32 v77, v182, v183
    v_cvt_pk_bf16_f32 v82, v184, v185
    v_mul_f32 v192, v192, v200
    v_mul_f32 v193, v193, v200
    v_mul_f32 v194, v194, v200
    v_mul_f32 v195, v195, v200
    v_mul_f32 v198, v198, v200
    v_mul_f32 v199, v199, v200
    v_cvt_pk_bf16_f32 v78, v192, v193
    v_cvt_pk_bf16_f32 v79, v194, v195
    v_cvt_pk_bf16_f32 v83, v198, v199
    s_add_u32 s53, s54, 16384
    buffer_store_dwordx4 v[76:79], v2, s[4:7], s53 offen
    v_mul_f32 v204, v204, v212
    v_mul_f32 v205, v205, v212
    v_mul_f32 v206, v206, v212
    v_mul_f32 v207, v207, v212
    v_mul_f32 v208, v208, v212
    v_mul_f32 v209, v209, v212
    v_cvt_pk_bf16_f32 v72, v204, v205
    v_cvt_pk_bf16_f32 v73, v206, v207
    v_cvt_pk_bf16_f32 v80, v208, v209
    v_mul_f32 v216, v216, v224
    v_mul_f32 v217, v217, v224
    v_mul_f32 v218, v218, v224
    v_mul_f32 v219, v219, v224
    v_mul_f32 v222, v222, v224
    v_mul_f32 v223, v223, v224
    v_cvt_pk_bf16_f32 v74, v216, v217
    v_cvt_pk_bf16_f32 v75, v218, v219
    v_cvt_pk_bf16_f32 v81, v222, v223
    s_add_u32 s53, s54, 0
    buffer_store_dwordx4 v[72:75], v2, s[4:7], s53 offen
    s_mov_b32 exec_lo, 0xffff0000
    s_mov_b32 exec_hi, 0
    buffer_store_dwordx2 v[80:81], v6, s[4:7], s55 offen offset:0
    buffer_store_dwordx2 v[82:83], v6, s[4:7], s55 offen offset:2048
    s_mov_b64 exec, -1
    s_waitcnt vmcnt(0) lgkmcnt(0)
qkv0_kernel_end:
    s_endpgm
.section .rodata,"a"
.p2align 6
.amdhsa_kernel qkv0_kernel
  .amdhsa_next_free_vgpr 400
  .amdhsa_next_free_sgpr 102
  .amdhsa_accum_offset 256
  .amdhsa_group_segment_fixed_size 0
  .amdhsa_kernarg_size 80
  .amdhsa_user_sgpr_count 2
  .amdhsa_user_sgpr_kernarg_segment_ptr 1
  .amdhsa_system_sgpr_workgroup_id_x 1
  .amdhsa_float_denorm_mode_32 3
.end_amdhsa_kernel
.text
.globl wo0_kernel
.p2align 8
.type wo0_kernel,@function
wo0_kernel:
    s_cmp_ge_u32 s2, 256
    s_cbranch_scc1 wo0_kernel_end
    s_load_dwordx16 s[24:39], s[0:1], 0
    s_load_dwordx4 s[40:43], s[0:1], 64
    v_lshrrev_b32 v1, 6, v0
    s_and_b32 s21, s2, 7
    v_readfirstlane_b32 s20, v1
    s_lshr_b32 s22, s2, 3
    v_and_b32 v1, 63, v0
    v_lshlrev_b32 v2, 4, v1
    v_lshlrev_b32 v3, 7, v0
    s_getpc_b64 s[16:17]
L_pc_26:
    v_min_u32 v4, wo0_kernel_end-L_pc_26, v3
    global_load_dword v4, v4, s[16:17]
    s_waitcnt lgkmcnt(0)
    s_mov_b32 s4, s42
    s_mov_b32 s5, s43
    s_mov_b32 s6, 0x10000000
    s_mov_b32 s7, 0x20000
    s_cmp_ge_u32 s22, 24
    s_cbranch_scc1 L_cs_27
    s_mul_i32 s44, s22, 10923
    s_lshr_b32 s44, s44, 16
    s_mul_i32 s52, s44, 6
    s_sub_u32 s45, s22, s52
    s_lshl_b32 s52, s21, 2
    s_add_u32 s44, s44, s52
    s_lshl_b32 s46, s44, 2
    s_add_u32 s46, s46, s20
    s_mul_i32 s47, s45, 110592
    s_mul_i32 s48, s20, 3072
    s_add_u32 s47, s47, s48
    s_add_u32 s47, s47, 2097152
    s_lshl_b32 s49, s46, 14
    s_add_u32 s49, s49, 23330816
    s_lshl_b32 s50, s46, 11
    s_add_u32 s50, s50, 25427968
    v_and_b32 v3, 15, v1
    s_waitcnt vmcnt(0)
    v_lshrrev_b32 v4, 4, v1
    v_lshlrev_b32 v5, 3, v3
    v_lshl_add_u32 v5, v4, 8, v5
    s_lshl_b32 s52, s46, 4
    v_add_u32 v6, s52, v3
    v_lshlrev_b32 v7, 3, v6
    v_mul_u32_u24 v6, 1152, v6
    v_lshl_add_u32 v6, v4, 4, v6
    s_mul_i32 s51, s45, 192
    s_mov_b32 s8, s24
    s_mov_b32 s9, s25
    s_mov_b32 s10, 0x240000
    s_mov_b32 s11, 0x20000
    s_mov_b32 m0, s48
    s_nop 0
    buffer_load_dwordx4 v2, s[4:7], s47 offen offset:0 lds
    buffer_load_dwordx4 v2, s[4:7], s47 offen offset:1024 lds
    buffer_load_dwordx4 v2, s[4:7], s47 offen offset:2048 lds
    s_add_u32 s48, s48, 12288
    s_add_u32 s47, s47, 12288
    buffer_load_dwordx4 v[16:19], v2, s[4:7], s49 offen offset:0
    buffer_load_dwordx4 v[20:23], v2, s[4:7], s49 offen offset:1024
    s_mov_b32 m0, s48
    s_nop 0
    buffer_load_dwordx4 v2, s[4:7], s47 offen offset:0 lds
    buffer_load_dwordx4 v2, s[4:7], s47 offen offset:1024 lds
    buffer_load_dwordx4 v2, s[4:7], s47 offen offset:2048 lds
    s_add_u32 s48, s48, 12288
    s_add_u32 s47, s47, 12288
    buffer_load_dwordx4 v[24:27], v2, s[4:7], s49 offen offset:2048
    buffer_load_dwordx4 v[28:31], v2, s[4:7], s49 offen offset:3072
    s_mov_b32 m0, s48
    s_nop 0
    buffer_load_dwordx4 v2, s[4:7], s47 offen offset:0 lds
    buffer_load_dwordx4 v2, s[4:7], s47 offen offset:1024 lds
    buffer_load_dwordx4 v2, s[4:7], s47 offen offset:2048 lds
    s_add_u32 s48, s48, 12288
    s_add_u32 s47, s47, 12288
    s_add_u32 s49, s49, 4096
    buffer_load_dwordx4 v[32:35], v2, s[4:7], s49 offen offset:0
    buffer_load_dwordx4 v[36:39], v2, s[4:7], s49 offen offset:1024
    s_mov_b32 m0, s48
    s_nop 0
    buffer_load_dwordx4 v2, s[4:7], s47 offen offset:0 lds
    buffer_load_dwordx4 v2, s[4:7], s47 offen offset:1024 lds
    buffer_load_dwordx4 v2, s[4:7], s47 offen offset:2048 lds
    s_add_u32 s48, s48, 12288
    s_add_u32 s47, s47, 12288
    buffer_load_dwordx4 v[40:43], v2, s[4:7], s49 offen offset:2048
    buffer_load_dwordx4 v[44:47], v2, s[4:7], s49 offen offset:3072
    s_mov_b32 m0, s48
    s_nop 0
    buffer_load_dwordx4 v2, s[4:7], s47 offen offset:0 lds
    buffer_load_dwordx4 v2, s[4:7], s47 offen offset:1024 lds
    buffer_load_dwordx4 v2, s[4:7], s47 offen offset:2048 lds
    s_add_u32 s48, s48, 12288
    s_add_u32 s47, s47, 12288
    s_add_u32 s49, s49, 4096
    buffer_load_dwordx4 v[48:51], v2, s[4:7], s49 offen offset:0
    buffer_load_dwordx4 v[52:55], v2, s[4:7], s49 offen offset:1024
    s_mov_b32 m0, s48
    s_nop 0
    buffer_load_dwordx4 v2, s[4:7], s47 offen offset:0 lds
    buffer_load_dwordx4 v2, s[4:7], s47 offen offset:1024 lds
    buffer_load_dwordx4 v2, s[4:7], s47 offen offset:2048 lds
    s_add_u32 s48, s48, 12288
    s_add_u32 s47, s47, 12288
    buffer_load_dwordx4 v[56:59], v2, s[4:7], s49 offen offset:2048
    buffer_load_dwordx4 v[60:63], v2, s[4:7], s49 offen offset:3072
    s_mov_b32 m0, s48
    s_nop 0
    buffer_load_dwordx4 v2, s[4:7], s47 offen offset:0 lds
    buffer_load_dwordx4 v2, s[4:7], s47 offen offset:1024 lds
    buffer_load_dwordx4 v2, s[4:7], s47 offen offset:2048 lds
    s_add_u32 s48, s48, 12288
    s_add_u32 s47, s47, 12288
    s_add_u32 s49, s49, 4096
    buffer_load_dwordx4 v[64:67], v2, s[4:7], s49 offen offset:0
    buffer_load_dwordx4 v[68:71], v2, s[4:7], s49 offen offset:1024
    s_mov_b32 m0, s48
    s_nop 0
    buffer_load_dwordx4 v2, s[4:7], s47 offen offset:0 lds
    buffer_load_dwordx4 v2, s[4:7], s47 offen offset:1024 lds
    buffer_load_dwordx4 v2, s[4:7], s47 offen offset:2048 lds
    s_add_u32 s48, s48, 12288
    s_add_u32 s47, s47, 12288
    buffer_load_dwordx4 v[72:75], v2, s[4:7], s49 offen offset:2048
    buffer_load_dwordx4 v[76:79], v2, s[4:7], s49 offen offset:3072
    s_mov_b32 m0, s48
    s_nop 0
    buffer_load_dwordx4 v2, s[4:7], s47 offen offset:0 lds
    buffer_load_dwordx4 v2, s[4:7], s47 offen offset:1024 lds
    buffer_load_dwordx4 v2, s[4:7], s47 offen offset:2048 lds
    s_add_u32 s48, s48, 12288
    s_add_u32 s47, s47, 12288
    buffer_load_dwordx2 v[80:81], v5, s[4:7], s50 offen offset:0
    buffer_load_dwordx2 v[82:83], v5, s[4:7], s50 offen offset:128
    buffer_load_dwordx2 v[84:85], v5, s[4:7], s50 offen offset:1024
    buffer_load_dwordx2 v[86:87], v5, s[4:7], s50 offen offset:1152
    buffer_load_dwordx4 v[160:163], v6, s[8:11], s51 offen offset:0
    buffer_load_dwordx4 v[164:167], v6, s[8:11], s51 offen offset:64
    buffer_load_dwordx4 v[168:171], v6, s[8:11], s51 offen offset:128
    v_mov_b32 v8, v2
    s_waitcnt vmcnt(37)
    s_barrier
    ds_read_b128 v[112:115], v8 offset:0
    ds_read_b128 v[116:119], v8 offset:1024
    ds_read_b128 v[120:123], v8 offset:2048
    ds_read_b128 v[124:127], v8 offset:3072
    ds_read_b128 v[128:131], v8 offset:4096
    ds_read_b128 v[132:135], v8 offset:5120
    ds_read_b128 v[136:139], v8 offset:6144
    ds_read_b128 v[140:143], v8 offset:7168
    s_waitcnt lgkmcnt(7)
    v_mfma_f32_16x16x32_bf16 v[88:91], v[112:115], v[16:19], 0
    ds_read_b128 v[144:147], v8 offset:8192
    s_waitcnt lgkmcnt(7)
    v_mfma_f32_16x16x32_bf16 v[92:95], v[116:119], v[16:19], 0
    ds_read_b128 v[148:151], v8 offset:9216
    s_waitcnt lgkmcnt(7)
    v_mfma_f32_16x16x32_bf16 v[96:99], v[120:123], v[16:19], 0
    ds_read_b128 v[152:155], v8 offset:10240
    s_waitcnt lgkmcnt(7)
    v_mfma_f32_16x16x32_bf16 v[100:103], v[124:127], v[16:19], 0
    ds_read_b128 v[156:159], v8 offset:11264
    s_waitcnt lgkmcnt(7)
    v_mfma_f32_16x16x32_bf16 v[104:107], v[128:131], v[16:19], 0
    s_waitcnt lgkmcnt(6)
    v_mfma_f32_16x16x32_bf16 v[108:111], v[132:135], v[16:19], 0
    ds_read_b128 v[112:115], v8 offset:12288
    ds_read_b128 v[116:119], v8 offset:13312
    s_waitcnt lgkmcnt(7)
    v_mfma_f32_16x16x32_bf16 v[88:91], v[136:139], v[20:23], v[88:91]
    ds_read_b128 v[120:123], v8 offset:14336
    s_waitcnt lgkmcnt(7)
    v_mfma_f32_16x16x32_bf16 v[92:95], v[140:143], v[20:23], v[92:95]
    ds_read_b128 v[124:127], v8 offset:15360
    s_waitcnt lgkmcnt(7)
    v_mfma_f32_16x16x32_bf16 v[96:99], v[144:147], v[20:23], v[96:99]
    ds_read_b128 v[128:131], v8 offset:16384
    s_waitcnt lgkmcnt(7)
    v_mfma_f32_16x16x32_bf16 v[100:103], v[148:151], v[20:23], v[100:103]
    ds_read_b128 v[132:135], v8 offset:17408
    s_waitcnt lgkmcnt(7)
    v_mfma_f32_16x16x32_bf16 v[104:107], v[152:155], v[20:23], v[104:107]
    s_waitcnt lgkmcnt(6)
    v_mfma_f32_16x16x32_bf16 v[108:111], v[156:159], v[20:23], v[108:111]
    ds_read_b128 v[136:139], v8 offset:18432
    ds_read_b128 v[140:143], v8 offset:19456
    s_waitcnt lgkmcnt(7)
    v_mfma_f32_16x16x32_bf16 v[88:91], v[112:115], v[24:27], v[88:91]
    ds_read_b128 v[144:147], v8 offset:20480
    s_waitcnt lgkmcnt(7)
    v_mfma_f32_16x16x32_bf16 v[92:95], v[116:119], v[24:27], v[92:95]
    ds_read_b128 v[148:151], v8 offset:21504
    s_waitcnt lgkmcnt(7)
    v_mfma_f32_16x16x32_bf16 v[96:99], v[120:123], v[24:27], v[96:99]
    ds_read_b128 v[152:155], v8 offset:22528
    s_waitcnt lgkmcnt(7)
    v_mfma_f32_16x16x32_bf16 v[100:103], v[124:127], v[24:27], v[100:103]
    ds_read_b128 v[156:159], v8 offset:23552
    s_waitcnt lgkmcnt(7)
    v_mfma_f32_16x16x32_bf16 v[104:107], v[128:131], v[24:27], v[104:107]
    s_waitcnt lgkmcnt(6)
    v_mfma_f32_16x16x32_bf16 v[108:111], v[132:135], v[24:27], v[108:111]
    ds_read_b128 v[112:115], v8 offset:24576
    ds_read_b128 v[116:119], v8 offset:25600
    s_waitcnt lgkmcnt(7)
    v_mfma_f32_16x16x32_bf16 v[88:91], v[136:139], v[28:31], v[88:91]
    ds_read_b128 v[120:123], v8 offset:26624
    s_waitcnt lgkmcnt(7)
    v_mfma_f32_16x16x32_bf16 v[92:95], v[140:143], v[28:31], v[92:95]
    ds_read_b128 v[124:127], v8 offset:27648
    s_waitcnt lgkmcnt(7)
    v_mfma_f32_16x16x32_bf16 v[96:99], v[144:147], v[28:31], v[96:99]
    ds_read_b128 v[128:131], v8 offset:28672
    s_waitcnt lgkmcnt(7)
    v_mfma_f32_16x16x32_bf16 v[100:103], v[148:151], v[28:31], v[100:103]
    ds_read_b128 v[132:135], v8 offset:29696
    s_waitcnt lgkmcnt(7)
    v_mfma_f32_16x16x32_bf16 v[104:107], v[152:155], v[28:31], v[104:107]
    s_waitcnt lgkmcnt(6)
    v_mfma_f32_16x16x32_bf16 v[108:111], v[156:159], v[28:31], v[108:111]
    ds_read_b128 v[136:139], v8 offset:30720
    ds_read_b128 v[140:143], v8 offset:31744
    s_waitcnt vmcnt(36) lgkmcnt(7)
    v_mfma_f32_16x16x32_bf16 v[88:91], v[112:115], v[32:35], v[88:91]
    ds_read_b128 v[144:147], v8 offset:32768
    s_waitcnt lgkmcnt(7)
    v_mfma_f32_16x16x32_bf16 v[92:95], v[116:119], v[32:35], v[92:95]
    ds_read_b128 v[148:151], v8 offset:33792
    s_waitcnt lgkmcnt(7)
    v_mfma_f32_16x16x32_bf16 v[96:99], v[120:123], v[32:35], v[96:99]
    ds_read_b128 v[152:155], v8 offset:34816
    s_waitcnt lgkmcnt(7)
    v_mfma_f32_16x16x32_bf16 v[100:103], v[124:127], v[32:35], v[100:103]
    ds_read_b128 v[156:159], v8 offset:35840
    s_waitcnt lgkmcnt(7)
    v_mfma_f32_16x16x32_bf16 v[104:107], v[128:131], v[32:35], v[104:107]
    s_waitcnt lgkmcnt(6)
    v_mfma_f32_16x16x32_bf16 v[108:111], v[132:135], v[32:35], v[108:111]
    s_waitcnt vmcnt(22)
    s_barrier
    s_waitcnt lgkmcnt(5)
    v_mfma_f32_16x16x32_bf16 v[88:91], v[136:139], v[36:39], v[88:91]
    ds_read_b128 v[112:115], v8 offset:36864
    ds_read_b128 v[116:119], v8 offset:37888
    s_waitcnt lgkmcnt(6)
    v_mfma_f32_16x16x32_bf16 v[92:95], v[140:143], v[36:39], v[92:95]
    ds_read_b128 v[120:123], v8 offset:38912
    ds_read_b128 v[124:127], v8 offset:39936
    s_waitcnt lgkmcnt(7)
    v_mfma_f32_16x16x32_bf16 v[96:99], v[144:147], v[36:39], v[96:99]
    ds_read_b128 v[128:131], v8 offset:40960
    s_waitcnt lgkmcnt(7)
    v_mfma_f32_16x16x32_bf16 v[100:103], v[148:151], v[36:39], v[100:103]
    ds_read_b128 v[132:135], v8 offset:41984
    s_waitcnt lgkmcnt(7)
    v_mfma_f32_16x16x32_bf16 v[104:107], v[152:155], v[36:39], v[104:107]
    s_waitcnt lgkmcnt(6)
    v_mfma_f32_16x16x32_bf16 v[108:111], v[156:159], v[36:39], v[108:111]
    ds_read_b128 v[136:139], v8 offset:43008
    ds_read_b128 v[140:143], v8 offset:44032
    s_waitcnt lgkmcnt(7)
    v_mfma_f32_16x16x32_bf16 v[88:91], v[112:115], v[40:43], v[88:91]
    ds_read_b128 v[144:147], v8 offset:45056
    s_waitcnt lgkmcnt(7)
    v_mfma_f32_16x16x32_bf16 v[92:95], v[116:119], v[40:43], v[92:95]
    ds_read_b128 v[148:151], v8 offset:46080
    s_waitcnt lgkmcnt(7)
    v_mfma_f32_16x16x32_bf16 v[96:99], v[120:123], v[40:43], v[96:99]
    ds_read_b128 v[152:155], v8 offset:47104
    s_waitcnt lgkmcnt(7)
    v_mfma_f32_16x16x32_bf16 v[100:103], v[124:127], v[40:43], v[100:103]
    ds_read_b128 v[156:159], v8 offset:48128
    s_waitcnt lgkmcnt(7)
    v_mfma_f32_16x16x32_bf16 v[104:107], v[128:131], v[40:43], v[104:107]
    s_waitcnt lgkmcnt(6)
    v_mfma_f32_16x16x32_bf16 v[108:111], v[132:135], v[40:43], v[108:111]
    ds_read_b128 v[112:115], v8 offset:49152
    ds_read_b128 v[116:119], v8 offset:50176
    s_waitcnt lgkmcnt(7)
    v_mfma_f32_16x16x32_bf16 v[88:91], v[136:139], v[44:47], v[88:91]
    ds_read_b128 v[120:123], v8 offset:51200
    s_waitcnt lgkmcnt(7)
    v_mfma_f32_16x16x32_bf16 v[92:95], v[140:143], v[44:47], v[92:95]
    ds_read_b128 v[124:127], v8 offset:52224
    s_waitcnt lgkmcnt(7)
    v_mfma_f32_16x16x32_bf16 v[96:99], v[144:147], v[44:47], v[96:99]
    ds_read_b128 v[128:131], v8 offset:53248
    s_waitcnt lgkmcnt(7)
    v_mfma_f32_16x16x32_bf16 v[100:103], v[148:151], v[44:47], v[100:103]
    ds_read_b128 v[132:135], v8 offset:54272
    s_waitcnt lgkmcnt(7)
    v_mfma_f32_16x16x32_bf16 v[104:107], v[152:155], v[44:47], v[104:107]
    s_waitcnt lgkmcnt(6)
    v_mfma_f32_16x16x32_bf16 v[108:111], v[156:159], v[44:47], v[108:111]
    ds_read_b128 v[136:139], v8 offset:55296
    ds_read_b128 v[140:143], v8 offset:56320
    s_waitcnt lgkmcnt(7)
    v_mfma_f32_16x16x32_bf16 v[88:91], v[112:115], v[48:51], v[88:91]
    ds_read_b128 v[144:147], v8 offset:57344
    s_waitcnt lgkmcnt(7)
    v_mfma_f32_16x16x32_bf16 v[92:95], v[116:119], v[48:51], v[92:95]
    ds_read_b128 v[148:151], v8 offset:58368
    s_waitcnt lgkmcnt(7)
    v_mfma_f32_16x16x32_bf16 v[96:99], v[120:123], v[48:51], v[96:99]
    ds_read_b128 v[152:155], v8 offset:59392
    s_waitcnt lgkmcnt(7)
    v_mfma_f32_16x16x32_bf16 v[100:103], v[124:127], v[48:51], v[100:103]
    ds_read_b128 v[156:159], v8 offset:60416
    s_waitcnt lgkmcnt(7)
    v_mfma_f32_16x16x32_bf16 v[104:107], v[128:131], v[48:51], v[104:107]
    s_waitcnt lgkmcnt(6)
    v_mfma_f32_16x16x32_bf16 v[108:111], v[132:135], v[48:51], v[108:111]
    v_add_u32 v8, 61440, v8
    ds_read_b128 v[112:115], v8 offset:0
    s_waitcnt lgkmcnt(6)
    v_mfma_f32_16x16x32_bf16 v[88:91], v[136:139], v[52:55], v[88:91]
    ds_read_b128 v[116:119], v8 offset:1024
    s_waitcnt lgkmcnt(6)
    v_mfma_f32_16x16x32_bf16 v[92:95], v[140:143], v[52:55], v[92:95]
    ds_read_b128 v[120:123], v8 offset:2048
    s_waitcnt lgkmcnt(6)
    v_mfma_f32_16x16x32_bf16 v[96:99], v[144:147], v[52:55], v[96:99]
    ds_read_b128 v[124:127], v8 offset:3072
    s_waitcnt lgkmcnt(6)
    v_mfma_f32_16x16x32_bf16 v[100:103], v[148:151], v[52:55], v[100:103]
    ds_read_b128 v[128:131], v8 offset:4096
    s_waitcnt lgkmcnt(6)
    v_mfma_f32_16x16x32_bf16 v[104:107], v[152:155], v[52:55], v[104:107]
    ds_read_b128 v[132:135], v8 offset:5120
    s_waitcnt lgkmcnt(6)
    v_mfma_f32_16x16x32_bf16 v[108:111], v[156:159], v[52:55], v[108:111]
    ds_read_b128 v[136:139], v8 offset:6144
    ds_read_b128 v[140:143], v8 offset:7168
    s_waitcnt vmcnt(21) lgkmcnt(7)
    v_mfma_f32_16x16x32_bf16 v[88:91], v[112:115], v[56:59], v[88:91]
    ds_read_b128 v[144:147], v8 offset:8192
    s_waitcnt lgkmcnt(7)
    v_mfma_f32_16x16x32_bf16 v[92:95], v[116:119], v[56:59], v[92:95]
    ds_read_b128 v[148:151], v8 offset:9216
    s_waitcnt lgkmcnt(7)
    v_mfma_f32_16x16x32_bf16 v[96:99], v[120:123], v[56:59], v[96:99]
    ds_read_b128 v[152:155], v8 offset:10240
    s_waitcnt lgkmcnt(7)
    v_mfma_f32_16x16x32_bf16 v[100:103], v[124:127], v[56:59], v[100:103]
    ds_read_b128 v[156:159], v8 offset:11264
    s_waitcnt lgkmcnt(7)
    v_mfma_f32_16x16x32_bf16 v[104:107], v[128:131], v[56:59], v[104:107]
    s_waitcnt lgkmcnt(6)
    v_mfma_f32_16x16x32_bf16 v[108:111], v[132:135], v[56:59], v[108:111]
    s_waitcnt vmcnt(7)
    s_barrier
    s_waitcnt lgkmcnt(5)
    v_mfma_f32_16x16x32_bf16 v[88:91], v[136:139], v[60:63], v[88:91]
    ds_read_b128 v[112:115], v8 offset:12288
    ds_read_b128 v[116:119], v8 offset:13312
    s_waitcnt lgkmcnt(6)
    v_mfma_f32_16x16x32_bf16 v[92:95], v[140:143], v[60:63], v[92:95]
    ds_read_b128 v[120:123], v8 offset:14336
    ds_read_b128 v[124:127], v8 offset:15360
    s_waitcnt lgkmcnt(7)
    v_mfma_f32_16x16x32_bf16 v[96:99], v[144:147], v[60:63], v[96:99]
    ds_read_b128 v[128:131], v8 offset:16384
    s_waitcnt lgkmcnt(7)
    v_mfma_f32_16x16x32_bf16 v[100:103], v[148:151], v[60:63], v[100:103]
    ds_read_b128 v[132:135], v8 offset:17408
    s_waitcnt lgkmcnt(7)
    v_mfma_f32_16x16x32_bf16 v[104:107], v[152:155], v[60:63], v[104:107]
    s_waitcnt lgkmcnt(6)
    v_mfma_f32_16x16x32_bf16 v[108:111], v[156:159], v[60:63], v[108:111]
    ds_read_b128 v[136:139], v8 offset:18432
    ds_read_b128 v[140:143], v8 offset:19456
    s_waitcnt lgkmcnt(7)
    v_mfma_f32_16x16x32_bf16 v[88:91], v[112:115], v[64:67], v[88:91]
    ds_read_b128 v[144:147], v8 offset:20480
    s_waitcnt lgkmcnt(7)
    v_mfma_f32_16x16x32_bf16 v[92:95], v[116:119], v[64:67], v[92:95]
    ds_read_b128 v[148:151], v8 offset:21504
    s_waitcnt lgkmcnt(7)
    v_mfma_f32_16x16x32_bf16 v[96:99], v[120:123], v[64:67], v[96:99]
    ds_read_b128 v[152:155], v8 offset:22528
    s_waitcnt lgkmcnt(7)
    v_mfma_f32_16x16x32_bf16 v[100:103], v[124:127], v[64:67], v[100:103]
    ds_read_b128 v[156:159], v8 offset:23552
    s_waitcnt lgkmcnt(7)
    v_mfma_f32_16x16x32_bf16 v[104:107], v[128:131], v[64:67], v[104:107]
    s_waitcnt lgkmcnt(6)
    v_mfma_f32_16x16x32_bf16 v[108:111], v[132:135], v[64:67], v[108:111]
    ds_read_b128 v[112:115], v8 offset:24576
    ds_read_b128 v[116:119], v8 offset:25600
    s_waitcnt lgkmcnt(7)
    v_mfma_f32_16x16x32_bf16 v[88:91], v[136:139], v[68:71], v[88:91]
    ds_read_b128 v[120:123], v8 offset:26624
    s_waitcnt lgkmcnt(7)
    v_mfma_f32_16x16x32_bf16 v[92:95], v[140:143], v[68:71], v[92:95]
    ds_read_b128 v[124:127], v8 offset:27648
    s_waitcnt lgkmcnt(7)
    v_mfma_f32_16x16x32_bf16 v[96:99], v[144:147], v[68:71], v[96:99]
    ds_read_b128 v[128:131], v8 offset:28672
    s_waitcnt lgkmcnt(7)
    v_mfma_f32_16x16x32_bf16 v[100:103], v[148:151], v[68:71], v[100:103]
    ds_read_b128 v[132:135], v8 offset:29696
    s_waitcnt lgkmcnt(7)
    v_mfma_f32_16x16x32_bf16 v[104:107], v[152:155], v[68:71], v[104:107]
    s_waitcnt lgkmcnt(6)
    v_mfma_f32_16x16x32_bf16 v[108:111], v[156:159], v[68:71], v[108:111]
    ds_read_b128 v[136:139], v8 offset:30720
    ds_read_b128 v[140:143], v8 offset:31744
    s_waitcnt lgkmcnt(7)
    v_mfma_f32_16x16x32_bf16 v[88:91], v[112:115], v[72:75], v[88:91]
    ds_read_b128 v[144:147], v8 offset:32768
    s_waitcnt lgkmcnt(7)
    v_mfma_f32_16x16x32_bf16 v[92:95], v[116:119], v[72:75], v[92:95]
    ds_read_b128 v[148:151], v8 offset:33792
    s_waitcnt lgkmcnt(7)
    v_mfma_f32_16x16x32_bf16 v[96:99], v[120:123], v[72:75], v[96:99]
    ds_read_b128 v[152:155], v8 offset:34816
    s_waitcnt lgkmcnt(7)
    v_mfma_f32_16x16x32_bf16 v[100:103], v[124:127], v[72:75], v[100:103]
    ds_read_b128 v[156:159], v8 offset:35840
    s_waitcnt lgkmcnt(7)
    v_mfma_f32_16x16x32_bf16 v[104:107], v[128:131], v[72:75], v[104:107]
    s_waitcnt lgkmcnt(6)
    v_mfma_f32_16x16x32_bf16 v[108:111], v[132:135], v[72:75], v[108:111]
    ds_read_b128 v[112:115], v8 offset:36864
    ds_read_b128 v[116:119], v8 offset:37888
    s_waitcnt lgkmcnt(7)
    v_mfma_f32_16x16x32_bf16 v[88:91], v[136:139], v[76:79], v[88:91]
    ds_read_b128 v[120:123], v8 offset:38912
    s_waitcnt lgkmcnt(7)
    v_mfma_f32_16x16x32_bf16 v[92:95], v[140:143], v[76:79], v[92:95]
    ds_read_b128 v[124:127], v8 offset:39936
    s_waitcnt lgkmcnt(7)
    v_mfma_f32_16x16x32_bf16 v[96:99], v[144:147], v[76:79], v[96:99]
    ds_read_b128 v[128:131], v8 offset:40960
    s_waitcnt lgkmcnt(7)
    v_mfma_f32_16x16x32_bf16 v[100:103], v[148:151], v[76:79], v[100:103]
    ds_read_b128 v[132:135], v8 offset:41984
    s_waitcnt lgkmcnt(7)
    v_mfma_f32_16x16x32_bf16 v[104:107], v[152:155], v[76:79], v[104:107]
    s_waitcnt lgkmcnt(6)
    v_mfma_f32_16x16x32_bf16 v[108:111], v[156:159], v[76:79], v[108:111]
    ds_read_b128 v[136:139], v8 offset:43008
    ds_read_b128 v[140:143], v8 offset:44032
    s_waitcnt vmcnt(5) lgkmcnt(7)
    v_mfma_f32_16x16x32_bf16 v[88:91], v[112:115], v[80:83], v[88:91]
    ds_read_b128 v[144:147], v8 offset:45056
    s_waitcnt lgkmcnt(7)
    v_mfma_f32_16x16x32_bf16 v[92:95], v[116:119], v[80:83], v[92:95]
    ds_read_b128 v[148:151], v8 offset:46080
    s_waitcnt lgkmcnt(7)
    v_mfma_f32_16x16x32_bf16 v[96:99], v[120:123], v[80:83], v[96:99]
    ds_read_b128 v[152:155], v8 offset:47104
    s_waitcnt lgkmcnt(7)
    v_mfma_f32_16x16x32_bf16 v[100:103], v[124:127], v[80:83], v[100:103]
    ds_read_b128 v[156:159], v8 offset:48128
    s_waitcnt lgkmcnt(7)
    v_mfma_f32_16x16x32_bf16 v[104:107], v[128:131], v[80:83], v[104:107]
    s_waitcnt lgkmcnt(6)
    v_mfma_f32_16x16x32_bf16 v[108:111], v[132:135], v[80:83], v[108:111]
    s_waitcnt vmcnt(3) lgkmcnt(5)
    v_mfma_f32_16x16x32_bf16 v[88:91], v[136:139], v[84:87], v[88:91]
    s_waitcnt lgkmcnt(4)
    v_mfma_f32_16x16x32_bf16 v[92:95], v[140:143], v[84:87], v[92:95]
    s_waitcnt lgkmcnt(3)
    v_mfma_f32_16x16x32_bf16 v[96:99], v[144:147], v[84:87], v[96:99]
    s_waitcnt lgkmcnt(2)
    v_mfma_f32_16x16x32_bf16 v[100:103], v[148:151], v[84:87], v[100:103]
    s_waitcnt lgkmcnt(1)
    v_mfma_f32_16x16x32_bf16 v[104:107], v[152:155], v[84:87], v[104:107]
    s_waitcnt lgkmcnt(0)
    v_mfma_f32_16x16x32_bf16 v[108:111], v[156:159], v[84:87], v[108:111]
    s_waitcnt vmcnt(2)
    v_lshlrev_b32 v16, 16, v160
    v_and_b32 v17, 0xffff0000, v160
    v_lshlrev_b32 v18, 16, v161
    v_and_b32 v19, 0xffff0000, v161
    v_lshlrev_b32 v20, 16, v162
    v_and_b32 v21, 0xffff0000, v162
    v_lshlrev_b32 v22, 16, v163
    v_and_b32 v23, 0xffff0000, v163
    s_waitcnt vmcnt(1)
    v_lshlrev_b32 v24, 16, v164
    v_and_b32 v25, 0xffff0000, v164
    v_lshlrev_b32 v26, 16, v165
    v_and_b32 v27, 0xffff0000, v165
    v_lshlrev_b32 v28, 16, v166
    v_and_b32 v29, 0xffff0000, v166
    v_lshlrev_b32 v30, 16, v167
    v_and_b32 v31, 0xffff0000, v167
    s_waitcnt vmcnt(0)
    v_lshlrev_b32 v32, 16, v168
    v_and_b32 v33, 0xffff0000, v168
    v_lshlrev_b32 v34, 16, v169
    v_and_b32 v35, 0xffff0000, v169
    v_lshlrev_b32 v36, 16, v170
    v_and_b32 v37, 0xffff0000, v170
    v_lshlrev_b32 v38, 16, v171
    v_and_b32 v39, 0xffff0000, v171
    v_add_f32 v16, v16, v88
    v_add_f32 v17, v17, v89
    v_add_f32 v18, v18, v90
    v_add_f32 v19, v19, v91
    v_add_f32 v20, v20, v92
    v_add_f32 v21, v21, v93
    v_add_f32 v22, v22, v94
    v_add_f32 v23, v23, v95
    v_add_f32 v24, v24, v96
    v_add_f32 v25, v25, v97
    v_add_f32 v26, v26, v98
    v_add_f32 v27, v27, v99
    v_add_f32 v28, v28, v100
    v_add_f32 v29, v29, v101
    v_add_f32 v30, v30, v102
    v_add_f32 v31, v31, v103
    v_add_f32 v32, v32, v104
    v_add_f32 v33, v33, v105
    v_add_f32 v34, v34, v106
    v_add_f32 v35, v35, v107
    v_add_f32 v36, v36, v108
    v_add_f32 v37, v37, v109
    v_add_f32 v38, v38, v110
    v_add_f32 v39, v39, v111
    s_mul_i32 s52, s46, 18
    s_mul_i32 s53, s45, 3
    s_add_u32 s52, s52, s53
    s_lshl_b32 s52, s52, 10
    s_add_u32 s52, s52, 25690112
    v_cvt_pk_bf16_f32 v40, v16, v17
    v_cvt_pk_bf16_f32 v41, v18, v19
    v_cvt_pk_bf16_f32 v42, v20, v21
    v_cvt_pk_bf16_f32 v43, v22, v23
    buffer_store_dwordx4 v[40:43], v2, s[4:7], s52 offen offset:0
    v_cvt_pk_bf16_f32 v44, v24, v25
    v_cvt_pk_bf16_f32 v45, v26, v27
    v_cvt_pk_bf16_f32 v46, v28, v29
    v_cvt_pk_bf16_f32 v47, v30, v31
    buffer_store_dwordx4 v[44:47], v2, s[4:7], s52 offen offset:1024
    v_cvt_pk_bf16_f32 v48, v32, v33
    v_cvt_pk_bf16_f32 v49, v34, v35
    v_cvt_pk_bf16_f32 v50, v36, v37
    v_cvt_pk_bf16_f32 v51, v38, v39
    buffer_store_dwordx4 v[48:51], v2, s[4:7], s52 offen offset:2048
    v_lshlrev_b32 v16, 16, v40
    v_and_b32 v17, 0xffff0000, v40
    v_lshlrev_b32 v18, 16, v41
    v_and_b32 v19, 0xffff0000, v41
    v_lshlrev_b32 v20, 16, v42
    v_and_b32 v21, 0xffff0000, v42
    v_lshlrev_b32 v22, 16, v43
    v_and_b32 v23, 0xffff0000, v43
    v_lshlrev_b32 v24, 16, v44
    v_and_b32 v25, 0xffff0000, v44
    v_lshlrev_b32 v26, 16, v45
    v_and_b32 v27, 0xffff0000, v45
    v_lshlrev_b32 v28, 16, v46
    v_and_b32 v29, 0xffff0000, v46
    v_lshlrev_b32 v30, 16, v47
    v_and_b32 v31, 0xffff0000, v47
    v_lshlrev_b32 v32, 16, v48
    v_and_b32 v33, 0xffff0000, v48
    v_lshlrev_b32 v34, 16, v49
    v_and_b32 v35, 0xffff0000, v49
    v_lshlrev_b32 v36, 16, v50
    v_and_b32 v37, 0xffff0000, v50
    v_lshlrev_b32 v38, 16, v51
    v_and_b32 v39, 0xffff0000, v51
    v_add_f32 v56, v16, v17
    v_add_f32 v58, v18, v19
    v_add_f32 v56, v56, v20
    v_add_f32 v58, v58, v21
    v_add_f32 v56, v56, v22
    v_add_f32 v58, v58, v23
    v_add_f32 v56, v56, v24
    v_add_f32 v58, v58, v25
    v_add_f32 v56, v56, v26
    v_add_f32 v58, v58, v27
    v_add_f32 v56, v56, v28
    v_add_f32 v58, v58, v29
    v_add_f32 v56, v56, v30
    v_add_f32 v58, v58, v31
    v_add_f32 v56, v56, v32
    v_add_f32 v58, v58, v33
    v_add_f32 v56, v56, v34
    v_add_f32 v58, v58, v35
    v_add_f32 v56, v56, v36
    v_add_f32 v58, v58, v37
    v_add_f32 v56, v56, v38
    v_add_f32 v58, v58, v39
    v_add_f32 v56, v56, v58
    v_mov_b32 v58, v56
    s_nop 1
    v_permlane16_swap_b32 v56, v58
    v_add_f32 v56, v56, v58
    v_mov_b32 v58, v56
    s_nop 1
    v_permlane32_swap_b32 v56, v58
    v_add_f32 v56, v56, v58
    v_mul_f32 v59, 0x3c2aaaab, v56
    v_sub_f32 v58, v16, v59
    v_mul_f32 v57, v58, v58
    v_sub_f32 v61, v17, v59
    v_fmac_f32 v57, v61, v61
    v_sub_f32 v60, v18, v59
    v_fmac_f32 v57, v60, v60
    v_sub_f32 v61, v19, v59
    v_fmac_f32 v57, v61, v61
    v_sub_f32 v60, v20, v59
    v_fmac_f32 v57, v60, v60
    v_sub_f32 v61, v21, v59
    v_fmac_f32 v57, v61, v61
    v_sub_f32 v60, v22, v59
    v_fmac_f32 v57, v60, v60
    v_sub_f32 v61, v23, v59
    v_fmac_f32 v57, v61, v61
    v_sub_f32 v60, v24, v59
    v_fmac_f32 v57, v60, v60
    v_sub_f32 v61, v25, v59
    v_fmac_f32 v57, v61, v61
    v_sub_f32 v60, v26, v59
    v_fmac_f32 v57, v60, v60
    v_sub_f32 v61, v27, v59
    v_fmac_f32 v57, v61, v61
    v_sub_f32 v60, v28, v59
    v_fmac_f32 v57, v60, v60
    v_sub_f32 v61, v29, v59
    v_fmac_f32 v57, v61, v61
    v_sub_f32 v60, v30, v59
    v_fmac_f32 v57, v60, v60
    v_sub_f32 v61, v31, v59
    v_fmac_f32 v57, v61, v61
    v_sub_f32 v60, v32, v59
    v_fmac_f32 v57, v60, v60
    v_sub_f32 v61, v33, v59
    v_fmac_f32 v57, v61, v61
    v_sub_f32 v60, v34, v59
    v_fmac_f32 v57, v60, v60
    v_sub_f32 v61, v35, v59
    v_fmac_f32 v57, v61, v61
    v_sub_f32 v60, v36, v59
    v_fmac_f32 v57, v60, v60
    v_sub_f32 v61, v37, v59
    v_fmac_f32 v57, v61, v61
    v_sub_f32 v60, v38, v59
    v_fmac_f32 v57, v60, v60
    v_sub_f32 v61, v39, v59
    v_fmac_f32 v57, v61, v61
    v_mov_b32 v58, v57
    s_nop 1
    v_permlane16_swap_b32 v57, v58
    v_add_f32 v57, v57, v58
    v_mov_b32 v58, v57
    s_nop 1
    v_permlane32_swap_b32 v57, v58
    v_add_f32 v57, v57, v58
    s_lshl_b32 s52, s45, 14
    s_add_u32 s52, s52, 28049408
    s_mov_b32 exec_lo, 0xffff
    s_mov_b32 exec_hi, 0
    buffer_store_dwordx2 v[56:57], v7, s[4:7], s52 offen
    s_mov_b64 exec, -1
    s_waitcnt vmcnt(0) lgkmcnt(0)
    s_waitcnt vmcnt(0) lgkmcnt(0)
    s_branch wo0_kernel_end
L_cs_27:
    s_cmp_lg_u32 s20, 0
    s_cbranch_scc1 wo0_kernel_end
    s_lshl_b32 s23, s21, 3
    s_add_u32 s23, s23, s22
    s_sub_u32 s23, s23, 24
    s_mul_i32 s44, s23, 10368
    s_add_u32 s44, s44, 2883584
    s_lshr_b32 s45, s23, 1
    s_mul_i32 s45, s45, 1152
    s_and_b32 s46, s23, 1
    s_lshl_b32 s46, s46, 6
    s_add_u32 s45, s45, s46
    s_add_u32 s45, s45, 3670016
    v_lshrrev_b32 v3, 2, v1
    v_lshlrev_b32 v3, 7, v3
    s_waitcnt vmcnt(0)
    v_and_b32 v4, 3, v1
    v_lshl_add_u32 v3, v4, 4, v3
    s_mov_b32 exec_hi, 15
    buffer_load_dwordx4 v[8:11], v2, s[4:7], s44 offen offset:0
    buffer_load_dwordx4 v[12:15], v2, s[4:7], s44 offen offset:576
    buffer_load_dwordx4 v[16:19], v2, s[4:7], s44 offen offset:1152
    buffer_load_dwordx4 v[20:23], v2, s[4:7], s44 offen offset:1728
    buffer_load_dwordx4 v[24:27], v2, s[4:7], s44 offen offset:2304
    buffer_load_dwordx4 v[28:31], v2, s[4:7], s44 offen offset:2880
    s_add_u32 s44, s44, 3456
    buffer_load_dwordx4 v[32:35], v2, s[4:7], s44 offen offset:0
    buffer_load_dwordx4 v[36:39], v2, s[4:7], s44 offen offset:576
    buffer_load_dwordx4 v[40:43], v2, s[4:7], s44 offen offset:1152
    buffer_load_dwordx4 v[44:47], v2, s[4:7], s44 offen offset:1728
    buffer_load_dwordx4 v[48:51], v2, s[4:7], s44 offen offset:2304
    buffer_load_dwordx4 v[52:55], v2, s[4:7], s44 offen offset:2880
    s_add_u32 s44, s44, 3456
    buffer_load_dwordx4 v[56:59], v2, s[4:7], s44 offen offset:0
    buffer_load_dwordx4 v[60:63], v2, s[4:7], s44 offen offset:576
    buffer_load_dwordx4 v[64:67], v2, s[4:7], s44 offen offset:1152
    buffer_load_dwordx4 v[68:71], v2, s[4:7], s44 offen offset:1728
    buffer_load_dwordx4 v[72:75], v2, s[4:7], s44 offen offset:2304
    buffer_load_dwordx4 v[76:79], v2, s[4:7], s44 offen offset:2880
    s_waitcnt vmcnt(16)
    v_add_f32 v8, v8, v12
    v_add_f32 v9, v9, v13
    v_add_f32 v10, v10, v14
    v_add_f32 v11, v11, v15
    s_waitcnt vmcnt(15)
    v_add_f32 v8, v8, v16
    v_add_f32 v9, v9, v17
    v_add_f32 v10, v10, v18
    v_add_f32 v11, v11, v19
    s_waitcnt vmcnt(14)
    v_add_f32 v8, v8, v20
    v_add_f32 v9, v9, v21
    v_add_f32 v10, v10, v22
    v_add_f32 v11, v11, v23
    s_waitcnt vmcnt(13)
    v_add_f32 v8, v8, v24
    v_add_f32 v9, v9, v25
    v_add_f32 v10, v10, v26
    v_add_f32 v11, v11, v27
    s_waitcnt vmcnt(12)
    v_add_f32 v8, v8, v28
    v_add_f32 v9, v9, v29
    v_add_f32 v10, v10, v30
    v_add_f32 v11, v11, v31
    s_waitcnt vmcnt(11)
    v_add_f32 v8, v8, v32
    v_add_f32 v9, v9, v33
    v_add_f32 v10, v10, v34
    v_add_f32 v11, v11, v35
    s_waitcnt vmcnt(10)
    v_add_f32 v8, v8, v36
    v_add_f32 v9, v9, v37
    v_add_f32 v10, v10, v38
    v_add_f32 v11, v11, v39
    s_waitcnt vmcnt(9)
    v_add_f32 v8, v8, v40
    v_add_f32 v9, v9, v41
    v_add_f32 v10, v10, v42
    v_add_f32 v11, v11, v43
    s_waitcnt vmcnt(8)
    v_add_f32 v8, v8, v44
    v_add_f32 v9, v9, v45
    v_add_f32 v10, v10, v46
    v_add_f32 v11, v11, v47
    s_waitcnt vmcnt(7)
    v_add_f32 v8, v8, v48
    v_add_f32 v9, v9, v49
    v_add_f32 v10, v10, v50
    v_add_f32 v11, v11, v51
    s_waitcnt vmcnt(6)
    v_add_f32 v8, v8, v52
    v_add_f32 v9, v9, v53
    v_add_f32 v10, v10, v54
    v_add_f32 v11, v11, v55
    s_waitcnt vmcnt(5)
    v_add_f32 v8, v8, v56
    v_add_f32 v9, v9, v57
    v_add_f32 v10, v10, v58
    v_add_f32 v11, v11, v59
    s_waitcnt vmcnt(4)
    v_add_f32 v8, v8, v60
    v_add_f32 v9, v9, v61
    v_add_f32 v10, v10, v62
    v_add_f32 v11, v11, v63
    s_waitcnt vmcnt(3)
    v_add_f32 v8, v8, v64
    v_add_f32 v9, v9, v65
    v_add_f32 v10, v10, v66
    v_add_f32 v11, v11, v67
    s_waitcnt vmcnt(2)
    v_add_f32 v8, v8, v68
    v_add_f32 v9, v9, v69
    v_add_f32 v10, v10, v70
    v_add_f32 v11, v11, v71
    s_waitcnt vmcnt(1)
    v_add_f32 v8, v8, v72
    v_add_f32 v9, v9, v73
    v_add_f32 v10, v10, v74
    v_add_f32 v11, v11, v75
    s_waitcnt vmcnt(0)
    v_add_f32 v8, v8, v76
    v_add_f32 v9, v9, v77
    v_add_f32 v10, v10, v78
    v_add_f32 v11, v11, v79
    buffer_store_dwordx4 v[8:11], v3, s[4:7], s45 offen
    s_mov_b64 exec, -1
wo0_kernel_end:
    s_endpgm
.section .rodata,"a"
.p2align 6
.amdhsa_kernel wo0_kernel
  .amdhsa_next_free_vgpr 176
  .amdhsa_next_free_sgpr 102
  .amdhsa_accum_offset 176
  .amdhsa_group_segment_fixed_size 0
  .amdhsa_kernarg_size 80
  .amdhsa_user_sgpr_count 2
  .amdhsa_user_sgpr_kernarg_segment_ptr 1
  .amdhsa_system_sgpr_workgroup_id_x 1
  .amdhsa_float_denorm_mode_32 3
.end_amdhsa_kernel
.text
.globl ffn0_kernel
.p2align 8
.type ffn0_kernel,@function
ffn0_kernel:
    s_cmp_ge_u32 s2, 256
    s_cbranch_scc1 ffn0_kernel_end
    s_load_dwordx16 s[24:39], s[0:1], 0
    s_load_dwordx4 s[40:43], s[0:1], 64
    v_lshrrev_b32 v1, 6, v0
    s_and_b32 s21, s2, 7
    v_readfirstlane_b32 s20, v1
    s_lshr_b32 s22, s2, 3
    v_and_b32 v1, 63, v0
    v_lshlrev_b32 v2, 4, v1
    v_lshlrev_b32 v3, 7, v0
    s_getpc_b64 s[16:17]
L_pc_28:
    v_min_u32 v4, ffn0_kernel_end-L_pc_28, v3
    global_load_dword v4, v4, s[16:17]
    s_waitcnt lgkmcnt(0)
    s_mov_b32 s4, s42
    s_mov_b32 s5, s43
    s_mov_b32 s6, 0x10000000
    s_mov_b32 s7, 0x20000
    s_lshr_b32 s44, s22, 4
    s_and_b32 s60, s21, 6
    s_add_u32 s44, s44, s60
    s_and_b32 s60, s21, 1
    s_lshl_b32 s60, s60, 4
    s_and_b32 s47, s22, 15
    s_add_u32 s47, s47, s60
    s_lshr_b32 s45, s47, 2
    s_and_b32 s46, s47, 3
    s_mul_i32 s48, s47, 497664
    s_add_u32 s48, s48, 4194304
    s_mul_i32 s63, s20, 9
    s_lshr_b32 s63, s63, 1
    s_lshl_b32 s63, s63, 10
    s_add_u32 s62, s48, s63
    s_mul_i32 s49, s20, 9216
    s_add_u32 s48, s48, s49
    s_lshl_b32 s54, s44, 4
    s_lshl_b32 s60, s20, 2
    s_add_u32 s54, s54, s60
    s_mul_i32 s50, s54, 18432
    s_mul_i32 s53, s45, 2359296
    s_add_u32 s53, s53, s50
    s_add_u32 s50, s50, 25690112
    s_lshr_b32 s60, s46, 1
    s_mul_i32 s60, s60, 9216
    s_add_u32 s53, s53, s60
    s_add_u32 s53, s53, 50331648
    v_lshlrev_b32 v3, 3, v1
    s_waitcnt vmcnt(0)
    v_mov_b32 v4, v2
    s_and_b32 s60, s20, 1
    s_lshl_b32 s60, s60, 10
    s_add_u32 m0, s60, 147456
    s_mul_i32 s61, s47, 1152
    s_add_u32 s61, s61, s60
    s_add_u32 s61, s61, 3670016
    buffer_load_dwordx4 v2, s[4:7], s61 offen lds
    s_add_u32 m0, s49, 0
    s_add_u32 s61, s48, 0
    buffer_load_dwordx4 v2, s[4:7], s61 offen offset:0 lds
    buffer_load_dwordx4 v2, s[4:7], s61 offen offset:1024 lds
    buffer_load_dwordx4 v2, s[4:7], s61 offen offset:2048 lds
    buffer_load_dwordx4 v2, s[4:7], s61 offen offset:3072 lds
    s_add_u32 m0, s49, 4096
    s_add_u32 s61, s48, 4096
    buffer_load_dwordx4 v2, s[4:7], s61 offen offset:0 lds
    buffer_load_dwordx4 v2, s[4:7], s61 offen offset:1024 lds
    buffer_load_dwordx4 v2, s[4:7], s61 offen offset:2048 lds
    buffer_load_dwordx4 v2, s[4:7], s61 offen offset:3072 lds
    s_add_u32 m0, s49, 8192
    s_add_u32 s61, s48, 8192
    buffer_load_dwordx4 v2, s[4:7], s61 offen offset:0 lds
    s_add_u32 m0, s49, 36864
    s_add_u32 s61, s48, 36864
    buffer_load_dwordx4 v2, s[4:7], s61 offen offset:0 lds
    buffer_load_dwordx4 v2, s[4:7], s61 offen offset:1024 lds
    buffer_load_dwordx4 v2, s[4:7], s61 offen offset:2048 lds
    buffer_load_dwordx4 v2, s[4:7], s61 offen offset:3072 lds
    s_add_u32 m0, s49, 40960
    s_add_u32 s61, s48, 40960
    buffer_load_dwordx4 v2, s[4:7], s61 offen offset:0 lds
    buffer_load_dwordx4 v2, s[4:7], s61 offen offset:1024 lds
    buffer_load_dwordx4 v2, s[4:7], s61 offen offset:2048 lds
    buffer_load_dwordx4 v2, s[4:7], s61 offen offset:3072 lds
    s_add_u32 m0, s49, 45056
    s_add_u32 s61, s48, 45056
    buffer_load_dwordx4 v2, s[4:7], s61 offen offset:0 lds
    s_add_u32 s60, s50, 0
    buffer_load_dwordx4 a[0:3], v2, s[4:7], s60 offen offset:0
    buffer_load_dwordx4 a[16:19], v2, s[4:7], s60 offen offset:1024
    buffer_load_dwordx4 a[32:35], v2, s[4:7], s60 offen offset:2048
    buffer_load_dwordx4 a[48:51], v2, s[4:7], s60 offen offset:3072
    s_add_u32 s60, s50, 18432
    buffer_load_dwordx4 a[4:7], v2, s[4:7], s60 offen offset:0
    buffer_load_dwordx4 a[20:23], v2, s[4:7], s60 offen offset:1024
    buffer_load_dwordx4 a[36:39], v2, s[4:7], s60 offen offset:2048
    buffer_load_dwordx4 a[52:55], v2, s[4:7], s60 offen offset:3072
    s_add_u32 s60, s50, 36864
    buffer_load_dwordx4 a[8:11], v2, s[4:7], s60 offen offset:0
    buffer_load_dwordx4 a[24:27], v2, s[4:7], s60 offen offset:1024
    buffer_load_dwordx4 a[40:43], v2, s[4:7], s60 offen offset:2048
    buffer_load_dwordx4 a[56:59], v2, s[4:7], s60 offen offset:3072
    s_add_u32 s60, s50, 55296
    buffer_load_dwordx4 a[12:15], v2, s[4:7], s60 offen offset:0
    buffer_load_dwordx4 a[28:31], v2, s[4:7], s60 offen offset:1024
    buffer_load_dwordx4 a[44:47], v2, s[4:7], s60 offen offset:2048
    buffer_load_dwordx4 a[60:63], v2, s[4:7], s60 offen offset:3072
    s_add_u32 s60, s50, 4096
    buffer_load_dwordx4 a[64:67], v2, s[4:7], s60 offen offset:0
    buffer_load_dwordx4 a[80:83], v2, s[4:7], s60 offen offset:1024
    buffer_load_dwordx4 a[96:99], v2, s[4:7], s60 offen offset:2048
    buffer_load_dwordx4 a[112:115], v2, s[4:7], s60 offen offset:3072
    s_add_u32 s60, s50, 22528
    buffer_load_dwordx4 a[68:71], v2, s[4:7], s60 offen offset:0
    buffer_load_dwordx4 a[84:87], v2, s[4:7], s60 offen offset:1024
    buffer_load_dwordx4 a[100:103], v2, s[4:7], s60 offen offset:2048
    buffer_load_dwordx4 a[116:119], v2, s[4:7], s60 offen offset:3072
    s_add_u32 s60, s50, 40960
    buffer_load_dwordx4 a[72:75], v2, s[4:7], s60 offen offset:0
    buffer_load_dwordx4 a[88:91], v2, s[4:7], s60 offen offset:1024
    buffer_load_dwordx4 a[104:107], v2, s[4:7], s60 offen offset:2048
    buffer_load_dwordx4 a[120:123], v2, s[4:7], s60 offen offset:3072
    s_add_u32 s60, s50, 59392
    buffer_load_dwordx4 a[76:79], v2, s[4:7], s60 offen offset:0
    buffer_load_dwordx4 a[92:95], v2, s[4:7], s60 offen offset:1024
    buffer_load_dwordx4 a[108:111], v2, s[4:7], s60 offen offset:2048
    buffer_load_dwordx4 a[124:127], v2, s[4:7], s60 offen offset:3072
    s_lshl_b32 s60, s44, 5
    s_add_u32 s60, s60, s47
    s_mul_i32 s51, s60, 73728
    s_add_u32 s51, s51, 30670848
    s_xor_b32 s61, s60, 1
    s_mul_i32 s56, s61, 73728
    s_add_u32 s56, s56, 30670848
    s_xor_b32 s61, s60, 2
    s_mul_i32 s57, s61, 73728
    s_add_u32 s57, s57, 30670848
    s_xor_b32 s61, s60, 3
    s_mul_i32 s58, s61, 73728
    s_add_u32 s58, s58, 30670848
    s_lshr_b32 s52, s60, 2
    s_lshl_b32 s52, s52, 2
    s_add_u32 s52, s52, s20
    s_lshl_b32 s52, s52, 7
    s_add_u32 s52, s52, 3932160
    v_lshrrev_b32 v5, 4, v1
    v_lshlrev_b32 v5, 4, v5
    v_add_u32 v5, 147456, v5
    s_lshl_b32 s60, s54, 4
    v_add_u32 v6, s60, v1
    v_lshlrev_b32 v6, 3, v6
    s_lshl_b32 s60, s20, 12
    s_add_u32 s51, s51, s60
    s_add_u32 s56, s56, s60
    s_add_u32 s57, s57, s60
    s_add_u32 s58, s58, s60
    s_lshl_b32 s65, s20, 11
    s_sub_u32 s65, 65536, s65
    s_lshl_b32 s67, s46, 2
    s_add_u32 s67, s67, s52
    v_add_u32 v7, 0x10000, v2
    s_waitcnt vmcnt(32)
    s_barrier
    ds_read_b128 v[8:11], v4 offset:0
    ds_read_b128 v[12:15], v4 offset:1024
    ds_read_b128 v[16:19], v4 offset:36864
    ds_read_b128 v[20:23], v4 offset:37888
    s_add_u32 s60, s50, 8192
    buffer_load_dwordx4 a[128:131], v2, s[4:7], s60 offen offset:0
    s_waitcnt vmcnt(32) lgkmcnt(3)
    v_mfma_f32_16x16x32_bf16 v[208:211], v[8:11], a[0:3], 0
    ds_read_b128 v[24:27], v4 offset:2048
    s_waitcnt vmcnt(28)
    v_mfma_f32_16x16x32_bf16 v[212:215], v[8:11], a[4:7], 0
    s_waitcnt vmcnt(24)
    v_mfma_f32_16x16x32_bf16 v[216:219], v[8:11], a[8:11], 0
    s_waitcnt vmcnt(20)
    v_mfma_f32_16x16x32_bf16 v[220:223], v[8:11], a[12:15], 0
    buffer_load_dwordx4 a[144:147], v2, s[4:7], s60 offen offset:1024
    s_waitcnt lgkmcnt(3)
    v_mfma_f32_16x16x32_bf16 v[224:227], v[12:15], a[0:3], 0
    ds_read_b128 v[28:31], v4 offset:3072
    v_mfma_f32_16x16x32_bf16 v[228:231], v[12:15], a[4:7], 0
    v_mfma_f32_16x16x32_bf16 v[232:235], v[12:15], a[8:11], 0
    v_mfma_f32_16x16x32_bf16 v[236:239], v[12:15], a[12:15], 0
    buffer_load_dwordx4 a[160:163], v2, s[4:7], s60 offen offset:2048
    s_waitcnt lgkmcnt(3)
    v_mfma_f32_16x16x32_bf16 v[64:67], v[16:19], a[0:3], 0
    ds_read_b128 v[8:11], v4 offset:38912
    v_mfma_f32_16x16x32_bf16 v[68:71], v[16:19], a[4:7], 0
    v_mfma_f32_16x16x32_bf16 v[72:75], v[16:19], a[8:11], 0
    v_mfma_f32_16x16x32_bf16 v[76:79], v[16:19], a[12:15], 0
    buffer_load_dwordx4 a[176:179], v2, s[4:7], s60 offen offset:3072
    s_add_u32 s60, s50, 26624
    s_waitcnt lgkmcnt(3)
    v_mfma_f32_16x16x32_bf16 v[80:83], v[20:23], a[0:3], 0
    ds_read_b128 v[12:15], v4 offset:39936
    v_mfma_f32_16x16x32_bf16 v[84:87], v[20:23], a[4:7], 0
    v_mfma_f32_16x16x32_bf16 v[88:91], v[20:23], a[8:11], 0
    v_mfma_f32_16x16x32_bf16 v[92:95], v[20:23], a[12:15], 0
    buffer_load_dwordx4 a[132:135], v2, s[4:7], s60 offen offset:0
    s_waitcnt lgkmcnt(3)
    v_mfma_f32_16x16x32_bf16 v[208:211], v[24:27], a[16:19], v[208:211]
    ds_read_b128 v[16:19], v4 offset:4096
    v_mfma_f32_16x16x32_bf16 v[212:215], v[24:27], a[20:23], v[212:215]
    v_mfma_f32_16x16x32_bf16 v[216:219], v[24:27], a[24:27], v[216:219]
    s_waitcnt vmcnt(23)
    v_mfma_f32_16x16x32_bf16 v[220:223], v[24:27], a[28:31], v[220:223]
    buffer_load_dwordx4 a[148:151], v2, s[4:7], s60 offen offset:1024
    s_waitcnt lgkmcnt(3)
    v_mfma_f32_16x16x32_bf16 v[224:227], v[28:31], a[16:19], v[224:227]
    ds_read_b128 v[20:23], v4 offset:5120
    v_mfma_f32_16x16x32_bf16 v[228:231], v[28:31], a[20:23], v[228:231]
    v_mfma_f32_16x16x32_bf16 v[232:235], v[28:31], a[24:27], v[232:235]
    v_mfma_f32_16x16x32_bf16 v[236:239], v[28:31], a[28:31], v[236:239]
    buffer_load_dwordx4 a[164:167], v2, s[4:7], s60 offen offset:2048
    s_waitcnt lgkmcnt(3)
    v_mfma_f32_16x16x32_bf16 v[64:67], v[8:11], a[16:19], v[64:67]
    ds_read_b128 v[24:27], v4 offset:40960
    v_mfma_f32_16x16x32_bf16 v[68:71], v[8:11], a[20:23], v[68:71]
    v_mfma_f32_16x16x32_bf16 v[72:75], v[8:11], a[24:27], v[72:75]
    v_mfma_f32_16x16x32_bf16 v[76:79], v[8:11], a[28:31], v[76:79]
    buffer_load_dwordx4 a[180:183], v2, s[4:7], s60 offen offset:3072
    s_add_u32 s60, s50, 45056
    s_waitcnt lgkmcnt(3)
    v_mfma_f32_16x16x32_bf16 v[80:83], v[12:15], a[16:19], v[80:83]
    ds_read_b128 v[28:31], v4 offset:41984
    v_mfma_f32_16x16x32_bf16 v[84:87], v[12:15], a[20:23], v[84:87]
    v_mfma_f32_16x16x32_bf16 v[88:91], v[12:15], a[24:27], v[88:91]
    v_mfma_f32_16x16x32_bf16 v[92:95], v[12:15], a[28:31], v[92:95]
    buffer_load_dwordx4 a[136:139], v2, s[4:7], s60 offen offset:0
    s_waitcnt lgkmcnt(3)
    v_mfma_f32_16x16x32_bf16 v[208:211], v[16:19], a[32:35], v[208:211]
    ds_read_b128 v[8:11], v4 offset:6144
    v_mfma_f32_16x16x32_bf16 v[212:215], v[16:19], a[36:39], v[212:215]
    v_mfma_f32_16x16x32_bf16 v[216:219], v[16:19], a[40:43], v[216:219]
    s_waitcnt vmcnt(26)
    v_mfma_f32_16x16x32_bf16 v[220:223], v[16:19], a[44:47], v[220:223]
    buffer_load_dwordx4 a[152:155], v2, s[4:7], s60 offen offset:1024
    s_waitcnt lgkmcnt(3)
    v_mfma_f32_16x16x32_bf16 v[224:227], v[20:23], a[32:35], v[224:227]
    ds_read_b128 v[12:15], v4 offset:7168
    v_mfma_f32_16x16x32_bf16 v[228:231], v[20:23], a[36:39], v[228:231]
    v_mfma_f32_16x16x32_bf16 v[232:235], v[20:23], a[40:43], v[232:235]
    v_mfma_f32_16x16x32_bf16 v[236:239], v[20:23], a[44:47], v[236:239]
    buffer_load_dwordx4 a[168:171], v2, s[4:7], s60 offen offset:2048
    s_waitcnt lgkmcnt(3)
    v_mfma_f32_16x16x32_bf16 v[64:67], v[24:27], a[32:35], v[64:67]
    ds_read_b128 v[16:19], v4 offset:43008
    v_mfma_f32_16x16x32_bf16 v[68:71], v[24:27], a[36:39], v[68:71]
    v_mfma_f32_16x16x32_bf16 v[72:75], v[24:27], a[40:43], v[72:75]
    v_mfma_f32_16x16x32_bf16 v[76:79], v[24:27], a[44:47], v[76:79]
    buffer_load_dwordx4 a[184:187], v2, s[4:7], s60 offen offset:3072
    s_add_u32 s60, s50, 63488
    s_waitcnt lgkmcnt(3)
    v_mfma_f32_16x16x32_bf16 v[80:83], v[28:31], a[32:35], v[80:83]
    ds_read_b128 v[20:23], v4 offset:44032
    v_mfma_f32_16x16x32_bf16 v[84:87], v[28:31], a[36:39], v[84:87]
    v_mfma_f32_16x16x32_bf16 v[88:91], v[28:31], a[40:43], v[88:91]
    v_mfma_f32_16x16x32_bf16 v[92:95], v[28:31], a[44:47], v[92:95]
    buffer_load_dwordx4 a[140:143], v2, s[4:7], s60 offen offset:0
    s_waitcnt lgkmcnt(3)
    v_mfma_f32_16x16x32_bf16 v[208:211], v[8:11], a[48:51], v[208:211]
    ds_read_b128 v[24:27], v4 offset:8192
    v_mfma_f32_16x16x32_bf16 v[212:215], v[8:11], a[52:55], v[212:215]
    v_mfma_f32_16x16x32_bf16 v[216:219], v[8:11], a[56:59], v[216:219]
    s_waitcnt vmcnt(29)
    v_mfma_f32_16x16x32_bf16 v[220:223], v[8:11], a[60:63], v[220:223]
    buffer_load_dwordx4 a[156:159], v2, s[4:7], s60 offen offset:1024
    s_waitcnt lgkmcnt(3)
    v_mfma_f32_16x16x32_bf16 v[224:227], v[12:15], a[48:51], v[224:227]
    ds_read_b128 v[28:31], v4 offset:9216
    v_mfma_f32_16x16x32_bf16 v[228:231], v[12:15], a[52:55], v[228:231]
    v_mfma_f32_16x16x32_bf16 v[232:235], v[12:15], a[56:59], v[232:235]
    v_mfma_f32_16x16x32_bf16 v[236:239], v[12:15], a[60:63], v[236:239]
    buffer_load_dwordx4 a[172:175], v2, s[4:7], s60 offen offset:2048
    s_waitcnt lgkmcnt(3)
    v_mfma_f32_16x16x32_bf16 v[64:67], v[16:19], a[48:51], v[64:67]
    ds_read_b128 v[8:11], v4 offset:45056
    v_mfma_f32_16x16x32_bf16 v[68:71], v[16:19], a[52:55], v[68:71]
    v_mfma_f32_16x16x32_bf16 v[72:75], v[16:19], a[56:59], v[72:75]
    v_mfma_f32_16x16x32_bf16 v[76:79], v[16:19], a[60:63], v[76:79]
    buffer_load_dwordx4 a[188:191], v2, s[4:7], s60 offen offset:3072
    s_add_u32 s60, s50, 12288
    s_waitcnt lgkmcnt(3)
    v_mfma_f32_16x16x32_bf16 v[80:83], v[20:23], a[48:51], v[80:83]
    ds_read_b128 v[12:15], v4 offset:46080
    v_mfma_f32_16x16x32_bf16 v[84:87], v[20:23], a[52:55], v[84:87]
    v_mfma_f32_16x16x32_bf16 v[88:91], v[20:23], a[56:59], v[88:91]
    v_mfma_f32_16x16x32_bf16 v[92:95], v[20:23], a[60:63], v[92:95]
    buffer_load_dwordx4 a[192:195], v2, s[4:7], s60 offen offset:0
    s_waitcnt vmcnt(32) lgkmcnt(3)
    v_mfma_f32_16x16x32_bf16 v[208:211], v[24:27], a[64:67], v[208:211]
    ds_read_b128 v[16:19], v4 offset:10240
    s_waitcnt vmcnt(28)
    v_mfma_f32_16x16x32_bf16 v[212:215], v[24:27], a[68:71], v[212:215]
    s_waitcnt vmcnt(24)
    v_mfma_f32_16x16x32_bf16 v[216:219], v[24:27], a[72:75], v[216:219]
    s_waitcnt vmcnt(20)
    v_mfma_f32_16x16x32_bf16 v[220:223], v[24:27], a[76:79], v[220:223]
    buffer_load_dwordx4 a[208:211], v2, s[4:7], s60 offen offset:1024
    s_waitcnt lgkmcnt(3)
    v_mfma_f32_16x16x32_bf16 v[224:227], v[28:31], a[64:67], v[224:227]
    ds_read_b128 v[20:23], v4 offset:11264
    v_mfma_f32_16x16x32_bf16 v[228:231], v[28:31], a[68:71], v[228:231]
    v_mfma_f32_16x16x32_bf16 v[232:235], v[28:31], a[72:75], v[232:235]
    v_mfma_f32_16x16x32_bf16 v[236:239], v[28:31], a[76:79], v[236:239]
    buffer_load_dwordx4 a[224:227], v2, s[4:7], s60 offen offset:2048
    s_waitcnt lgkmcnt(3)
    v_mfma_f32_16x16x32_bf16 v[64:67], v[8:11], a[64:67], v[64:67]
    ds_read_b128 v[24:27], v4 offset:47104
    v_mfma_f32_16x16x32_bf16 v[68:71], v[8:11], a[68:71], v[68:71]
    v_mfma_f32_16x16x32_bf16 v[72:75], v[8:11], a[72:75], v[72:75]
    v_mfma_f32_16x16x32_bf16 v[76:79], v[8:11], a[76:79], v[76:79]
    buffer_load_dwordx4 a[240:243], v2, s[4:7], s60 offen offset:3072
    s_add_u32 s60, s50, 30720
    s_waitcnt lgkmcnt(3)
    v_mfma_f32_16x16x32_bf16 v[80:83], v[12:15], a[64:67], v[80:83]
    ds_read_b128 v[28:31], v4 offset:48128
    v_mfma_f32_16x16x32_bf16 v[84:87], v[12:15], a[68:71], v[84:87]
    v_mfma_f32_16x16x32_bf16 v[88:91], v[12:15], a[72:75], v[88:91]
    v_mfma_f32_16x16x32_bf16 v[92:95], v[12:15], a[76:79], v[92:95]
    buffer_load_dwordx4 a[196:199], v2, s[4:7], s60 offen offset:0
    s_waitcnt lgkmcnt(3)
    v_mfma_f32_16x16x32_bf16 v[208:211], v[16:19], a[80:83], v[208:211]
    ds_read_b128 v[8:11], v4 offset:12288
    v_mfma_f32_16x16x32_bf16 v[212:215], v[16:19], a[84:87], v[212:215]
    v_mfma_f32_16x16x32_bf16 v[216:219], v[16:19], a[88:91], v[216:219]
    s_waitcnt vmcnt(23)
    v_mfma_f32_16x16x32_bf16 v[220:223], v[16:19], a[92:95], v[220:223]
    buffer_load_dwordx4 a[212:215], v2, s[4:7], s60 offen offset:1024
    s_waitcnt lgkmcnt(3)
    v_mfma_f32_16x16x32_bf16 v[224:227], v[20:23], a[80:83], v[224:227]
    ds_read_b128 v[12:15], v4 offset:13312
    v_mfma_f32_16x16x32_bf16 v[228:231], v[20:23], a[84:87], v[228:231]
    v_mfma_f32_16x16x32_bf16 v[232:235], v[20:23], a[88:91], v[232:235]
    v_mfma_f32_16x16x32_bf16 v[236:239], v[20:23], a[92:95], v[236:239]
    buffer_load_dwordx4 a[228:231], v2, s[4:7], s60 offen offset:2048
    s_waitcnt lgkmcnt(3)
    v_mfma_f32_16x16x32_bf16 v[64:67], v[24:27], a[80:83], v[64:67]
    ds_read_b128 v[16:19], v4 offset:49152
    v_mfma_f32_16x16x32_bf16 v[68:71], v[24:27], a[84:87], v[68:71]
    v_mfma_f32_16x16x32_bf16 v[72:75], v[24:27], a[88:91], v[72:75]
    v_mfma_f32_16x16x32_bf16 v[76:79], v[24:27], a[92:95], v[76:79]
    buffer_load_dwordx4 a[244:247], v2, s[4:7], s60 offen offset:3072
    s_add_u32 s60, s50, 49152
    s_waitcnt lgkmcnt(3)
    v_mfma_f32_16x16x32_bf16 v[80:83], v[28:31], a[80:83], v[80:83]
    ds_read_b128 v[20:23], v4 offset:50176
    v_mfma_f32_16x16x32_bf16 v[84:87], v[28:31], a[84:87], v[84:87]
    v_mfma_f32_16x16x32_bf16 v[88:91], v[28:31], a[88:91], v[88:91]
    v_mfma_f32_16x16x32_bf16 v[92:95], v[28:31], a[92:95], v[92:95]
    buffer_load_dwordx4 a[200:203], v2, s[4:7], s60 offen offset:0
    s_waitcnt lgkmcnt(3)
    v_mfma_f32_16x16x32_bf16 v[208:211], v[8:11], a[96:99], v[208:211]
    ds_read_b128 v[24:27], v4 offset:14336
    v_mfma_f32_16x16x32_bf16 v[212:215], v[8:11], a[100:103], v[212:215]
    v_mfma_f32_16x16x32_bf16 v[216:219], v[8:11], a[104:107], v[216:219]
    s_waitcnt vmcnt(26)
    v_mfma_f32_16x16x32_bf16 v[220:223], v[8:11], a[108:111], v[220:223]
    buffer_load_dwordx4 a[216:219], v2, s[4:7], s60 offen offset:1024
    s_waitcnt lgkmcnt(3)
    v_mfma_f32_16x16x32_bf16 v[224:227], v[12:15], a[96:99], v[224:227]
    ds_read_b128 v[28:31], v4 offset:15360
    v_mfma_f32_16x16x32_bf16 v[228:231], v[12:15], a[100:103], v[228:231]
    v_mfma_f32_16x16x32_bf16 v[232:235], v[12:15], a[104:107], v[232:235]
    v_mfma_f32_16x16x32_bf16 v[236:239], v[12:15], a[108:111], v[236:239]
    buffer_load_dwordx4 a[232:235], v2, s[4:7], s60 offen offset:2048
    s_waitcnt lgkmcnt(3)
    v_mfma_f32_16x16x32_bf16 v[64:67], v[16:19], a[96:99], v[64:67]
    ds_read_b128 v[8:11], v4 offset:51200
    v_mfma_f32_16x16x32_bf16 v[68:71], v[16:19], a[100:103], v[68:71]
    v_mfma_f32_16x16x32_bf16 v[72:75], v[16:19], a[104:107], v[72:75]
    v_mfma_f32_16x16x32_bf16 v[76:79], v[16:19], a[108:111], v[76:79]
    buffer_load_dwordx4 a[248:251], v2, s[4:7], s60 offen offset:3072
    s_add_u32 s60, s50, 67584
    s_waitcnt lgkmcnt(3)
    v_mfma_f32_16x16x32_bf16 v[80:83], v[20:23], a[96:99], v[80:83]
    ds_read_b128 v[12:15], v4 offset:52224
    v_mfma_f32_16x16x32_bf16 v[84:87], v[20:23], a[100:103], v[84:87]
    v_mfma_f32_16x16x32_bf16 v[88:91], v[20:23], a[104:107], v[88:91]
    v_mfma_f32_16x16x32_bf16 v[92:95], v[20:23], a[108:111], v[92:95]
    buffer_load_dwordx4 a[204:207], v2, s[4:7], s60 offen offset:0
    s_waitcnt lgkmcnt(3)
    v_mfma_f32_16x16x32_bf16 v[208:211], v[24:27], a[112:115], v[208:211]
    ds_read_b128 v[16:19], v4 offset:16384
    v_mfma_f32_16x16x32_bf16 v[212:215], v[24:27], a[116:119], v[212:215]
    v_mfma_f32_16x16x32_bf16 v[216:219], v[24:27], a[120:123], v[216:219]
    s_waitcnt vmcnt(29)
    v_mfma_f32_16x16x32_bf16 v[220:223], v[24:27], a[124:127], v[220:223]
    buffer_load_dwordx4 a[220:223], v2, s[4:7], s60 offen offset:1024
    s_waitcnt lgkmcnt(3)
    v_mfma_f32_16x16x32_bf16 v[224:227], v[28:31], a[112:115], v[224:227]
    ds_read_b128 v[20:23], v4 offset:17408
    v_mfma_f32_16x16x32_bf16 v[228:231], v[28:31], a[116:119], v[228:231]
    v_mfma_f32_16x16x32_bf16 v[232:235], v[28:31], a[120:123], v[232:235]
    v_mfma_f32_16x16x32_bf16 v[236:239], v[28:31], a[124:127], v[236:239]
    buffer_load_dwordx4 a[236:239], v2, s[4:7], s60 offen offset:2048
    s_waitcnt lgkmcnt(3)
    v_mfma_f32_16x16x32_bf16 v[64:67], v[8:11], a[112:115], v[64:67]
    ds_read_b128 v[24:27], v4 offset:53248
    v_mfma_f32_16x16x32_bf16 v[68:71], v[8:11], a[116:119], v[68:71]
    v_mfma_f32_16x16x32_bf16 v[72:75], v[8:11], a[120:123], v[72:75]
    v_mfma_f32_16x16x32_bf16 v[76:79], v[8:11], a[124:127], v[76:79]
    buffer_load_dwordx4 a[252:255], v2, s[4:7], s60 offen offset:3072
    s_add_u32 s60, s50, 16384
    s_waitcnt lgkmcnt(3)
    v_mfma_f32_16x16x32_bf16 v[80:83], v[12:15], a[112:115], v[80:83]
    ds_read_b128 v[28:31], v4 offset:54272
    v_mfma_f32_16x16x32_bf16 v[84:87], v[12:15], a[116:119], v[84:87]
    v_mfma_f32_16x16x32_bf16 v[88:91], v[12:15], a[120:123], v[88:91]
    v_mfma_f32_16x16x32_bf16 v[92:95], v[12:15], a[124:127], v[92:95]
    buffer_load_dwordx4 v[32:35], v2, s[4:7], s60 offen offset:0
    s_waitcnt vmcnt(32) lgkmcnt(3)
    v_mfma_f32_16x16x32_bf16 v[208:211], v[16:19], a[128:131], v[208:211]
    ds_read_b128 v[8:11], v4 offset:18432
    s_waitcnt vmcnt(28)
    v_mfma_f32_16x16x32_bf16 v[212:215], v[16:19], a[132:135], v[212:215]
    s_waitcnt vmcnt(24)
    v_mfma_f32_16x16x32_bf16 v[216:219], v[16:19], a[136:139], v[216:219]
    s_waitcnt vmcnt(20)
    v_mfma_f32_16x16x32_bf16 v[220:223], v[16:19], a[140:143], v[220:223]
    buffer_load_dwordx4 v[48:51], v2, s[4:7], s60 offen offset:1024
    s_add_u32 s60, s50, 34816
    s_waitcnt lgkmcnt(3)
    v_mfma_f32_16x16x32_bf16 v[224:227], v[20:23], a[128:131], v[224:227]
    ds_read_b128 v[12:15], v4 offset:19456
    v_mfma_f32_16x16x32_bf16 v[228:231], v[20:23], a[132:135], v[228:231]
    v_mfma_f32_16x16x32_bf16 v[232:235], v[20:23], a[136:139], v[232:235]
    v_mfma_f32_16x16x32_bf16 v[236:239], v[20:23], a[140:143], v[236:239]
    buffer_load_dwordx4 v[36:39], v2, s[4:7], s60 offen offset:0
    s_waitcnt lgkmcnt(3)
    v_mfma_f32_16x16x32_bf16 v[64:67], v[24:27], a[128:131], v[64:67]
    ds_read_b128 v[16:19], v4 offset:55296
    v_mfma_f32_16x16x32_bf16 v[68:71], v[24:27], a[132:135], v[68:71]
    v_mfma_f32_16x16x32_bf16 v[72:75], v[24:27], a[136:139], v[72:75]
    v_mfma_f32_16x16x32_bf16 v[76:79], v[24:27], a[140:143], v[76:79]
    buffer_load_dwordx4 v[52:55], v2, s[4:7], s60 offen offset:1024
    s_add_u32 s60, s50, 53248
    s_waitcnt lgkmcnt(3)
    v_mfma_f32_16x16x32_bf16 v[80:83], v[28:31], a[128:131], v[80:83]
    ds_read_b128 v[20:23], v4 offset:56320
    v_mfma_f32_16x16x32_bf16 v[84:87], v[28:31], a[132:135], v[84:87]
    v_mfma_f32_16x16x32_bf16 v[88:91], v[28:31], a[136:139], v[88:91]
    v_mfma_f32_16x16x32_bf16 v[92:95], v[28:31], a[140:143], v[92:95]
    buffer_load_dwordx4 v[40:43], v2, s[4:7], s60 offen offset:0
    s_waitcnt lgkmcnt(3)
    v_mfma_f32_16x16x32_bf16 v[208:211], v[8:11], a[144:147], v[208:211]
    ds_read_b128 v[24:27], v4 offset:20480
    v_mfma_f32_16x16x32_bf16 v[212:215], v[8:11], a[148:151], v[212:215]
    v_mfma_f32_16x16x32_bf16 v[216:219], v[8:11], a[152:155], v[216:219]
    s_waitcnt vmcnt(23)
    v_mfma_f32_16x16x32_bf16 v[220:223], v[8:11], a[156:159], v[220:223]
    buffer_load_dwordx4 v[56:59], v2, s[4:7], s60 offen offset:1024
    s_add_u32 s60, s50, 71680
    s_waitcnt lgkmcnt(3)
    v_mfma_f32_16x16x32_bf16 v[224:227], v[12:15], a[144:147], v[224:227]
    ds_read_b128 v[28:31], v4 offset:21504
    v_mfma_f32_16x16x32_bf16 v[228:231], v[12:15], a[148:151], v[228:231]
    v_mfma_f32_16x16x32_bf16 v[232:235], v[12:15], a[152:155], v[232:235]
    v_mfma_f32_16x16x32_bf16 v[236:239], v[12:15], a[156:159], v[236:239]
    buffer_load_dwordx4 v[44:47], v2, s[4:7], s60 offen offset:0
    s_waitcnt lgkmcnt(3)
    v_mfma_f32_16x16x32_bf16 v[64:67], v[16:19], a[144:147], v[64:67]
    ds_read_b128 v[8:11], v4 offset:57344
    v_mfma_f32_16x16x32_bf16 v[68:71], v[16:19], a[148:151], v[68:71]
    v_mfma_f32_16x16x32_bf16 v[72:75], v[16:19], a[152:155], v[72:75]
    v_mfma_f32_16x16x32_bf16 v[76:79], v[16:19], a[156:159], v[76:79]
    buffer_load_dwordx4 v[60:63], v2, s[4:7], s60 offen offset:1024
    s_mov_b32 s60, 28049408
    s_waitcnt lgkmcnt(3)
    v_mfma_f32_16x16x32_bf16 v[80:83], v[20:23], a[144:147], v[80:83]
    ds_read_b128 v[12:15], v4 offset:58368
    v_mfma_f32_16x16x32_bf16 v[84:87], v[20:23], a[148:151], v[84:87]
    v_mfma_f32_16x16x32_bf16 v[88:91], v[20:23], a[152:155], v[88:91]
    v_mfma_f32_16x16x32_bf16 v[92:95], v[20:23], a[156:159], v[92:95]
    buffer_load_dwordx2 v[152:153], v6, s[4:7], s60 offen
    s_mov_b32 s60, 28065792
    s_waitcnt lgkmcnt(3)
    v_mfma_f32_16x16x32_bf16 v[208:211], v[24:27], a[160:163], v[208:211]
    ds_read_b128 v[16:19], v4 offset:22528
    v_mfma_f32_16x16x32_bf16 v[212:215], v[24:27], a[164:167], v[212:215]
    v_mfma_f32_16x16x32_bf16 v[216:219], v[24:27], a[168:171], v[216:219]
    s_waitcnt vmcnt(26)
    v_mfma_f32_16x16x32_bf16 v[220:223], v[24:27], a[172:175], v[220:223]
    buffer_load_dwordx2 v[154:155], v6, s[4:7], s60 offen
    s_mov_b32 s60, 28082176
    s_waitcnt lgkmcnt(3)
    v_mfma_f32_16x16x32_bf16 v[224:227], v[28:31], a[160:163], v[224:227]
    ds_read_b128 v[20:23], v4 offset:23552
    v_mfma_f32_16x16x32_bf16 v[228:231], v[28:31], a[164:167], v[228:231]
    v_mfma_f32_16x16x32_bf16 v[232:235], v[28:31], a[168:171], v[232:235]
    v_mfma_f32_16x16x32_bf16 v[236:239], v[28:31], a[172:175], v[236:239]
    buffer_load_dwordx2 v[156:157], v6, s[4:7], s60 offen
    s_mov_b32 s60, 28098560
    s_waitcnt lgkmcnt(3)
    v_mfma_f32_16x16x32_bf16 v[64:67], v[8:11], a[160:163], v[64:67]
    ds_read_b128 v[24:27], v4 offset:59392
    v_mfma_f32_16x16x32_bf16 v[68:71], v[8:11], a[164:167], v[68:71]
    v_mfma_f32_16x16x32_bf16 v[72:75], v[8:11], a[168:171], v[72:75]
    v_mfma_f32_16x16x32_bf16 v[76:79], v[8:11], a[172:175], v[76:79]
    buffer_load_dwordx2 v[158:159], v6, s[4:7], s60 offen
    s_mov_b32 s60, 28114944
    s_waitcnt lgkmcnt(3)
    v_mfma_f32_16x16x32_bf16 v[80:83], v[12:15], a[160:163], v[80:83]
    ds_read_b128 v[28:31], v4 offset:60416
    v_mfma_f32_16x16x32_bf16 v[84:87], v[12:15], a[164:167], v[84:87]
    v_mfma_f32_16x16x32_bf16 v[88:91], v[12:15], a[168:171], v[88:91]
    v_mfma_f32_16x16x32_bf16 v[92:95], v[12:15], a[172:175], v[92:95]
    buffer_load_dwordx2 v[160:161], v6, s[4:7], s60 offen
    s_mov_b32 s60, 28131328
    s_waitcnt lgkmcnt(3)
    v_mfma_f32_16x16x32_bf16 v[208:211], v[16:19], a[176:179], v[208:211]
    ds_read_b128 v[8:11], v4 offset:24576
    v_mfma_f32_16x16x32_bf16 v[212:215], v[16:19], a[180:183], v[212:215]
    v_mfma_f32_16x16x32_bf16 v[216:219], v[16:19], a[184:187], v[216:219]
    s_waitcnt vmcnt(29)
    v_mfma_f32_16x16x32_bf16 v[220:223], v[16:19], a[188:191], v[220:223]
    buffer_load_dwordx2 v[162:163], v6, s[4:7], s60 offen
    s_add_u32 m0, s49, 73728
    s_waitcnt lgkmcnt(3)
    v_mfma_f32_16x16x32_bf16 v[224:227], v[20:23], a[176:179], v[224:227]
    ds_read_b128 v[12:15], v4 offset:25600
    s_add_u32 s61, s48, 73728
    v_mfma_f32_16x16x32_bf16 v[228:231], v[20:23], a[180:183], v[228:231]
    v_mfma_f32_16x16x32_bf16 v[232:235], v[20:23], a[184:187], v[232:235]
    v_mfma_f32_16x16x32_bf16 v[236:239], v[20:23], a[188:191], v[236:239]
    buffer_load_dwordx4 v2, s[4:7], s61 offen offset:0 lds
    s_waitcnt lgkmcnt(3)
    v_mfma_f32_16x16x32_bf16 v[64:67], v[24:27], a[176:179], v[64:67]
    ds_read_b128 v[16:19], v4 offset:61440
    v_mfma_f32_16x16x32_bf16 v[68:71], v[24:27], a[180:183], v[68:71]
    v_mfma_f32_16x16x32_bf16 v[72:75], v[24:27], a[184:187], v[72:75]
    v_mfma_f32_16x16x32_bf16 v[76:79], v[24:27], a[188:191], v[76:79]
    buffer_load_dwordx4 v2, s[4:7], s61 offen offset:1024 lds
    s_waitcnt lgkmcnt(3)
    v_mfma_f32_16x16x32_bf16 v[80:83], v[28:31], a[176:179], v[80:83]
    ds_read_b128 v[20:23], v4 offset:62464
    v_mfma_f32_16x16x32_bf16 v[84:87], v[28:31], a[180:183], v[84:87]
    v_mfma_f32_16x16x32_bf16 v[88:91], v[28:31], a[184:187], v[88:91]
    v_mfma_f32_16x16x32_bf16 v[92:95], v[28:31], a[188:191], v[92:95]
    buffer_load_dwordx4 v2, s[4:7], s61 offen offset:2048 lds
    s_waitcnt vmcnt(32) lgkmcnt(3)
    v_mfma_f32_16x16x32_bf16 v[208:211], v[8:11], a[192:195], v[208:211]
    ds_read_b128 v[24:27], v4 offset:26624
    s_waitcnt vmcnt(28)
    v_mfma_f32_16x16x32_bf16 v[212:215], v[8:11], a[196:199], v[212:215]
    s_waitcnt vmcnt(24)
    v_mfma_f32_16x16x32_bf16 v[216:219], v[8:11], a[200:203], v[216:219]
    s_waitcnt vmcnt(20)
    v_mfma_f32_16x16x32_bf16 v[220:223], v[8:11], a[204:207], v[220:223]
    buffer_load_dwordx4 v2, s[4:7], s61 offen offset:3072 lds
    s_add_u32 m0, s49, 77824
    s_waitcnt lgkmcnt(3)
    v_mfma_f32_16x16x32_bf16 v[224:227], v[12:15], a[192:195], v[224:227]
    ds_read_b128 v[28:31], v4 offset:27648
    s_add_u32 s61, s48, 77824
    v_mfma_f32_16x16x32_bf16 v[228:231], v[12:15], a[196:199], v[228:231]
    v_mfma_f32_16x16x32_bf16 v[232:235], v[12:15], a[200:203], v[232:235]
    v_mfma_f32_16x16x32_bf16 v[236:239], v[12:15], a[204:207], v[236:239]
    buffer_load_dwordx4 v2, s[4:7], s61 offen offset:0 lds
    s_waitcnt lgkmcnt(3)
    v_mfma_f32_16x16x32_bf16 v[64:67], v[16:19], a[192:195], v[64:67]
    ds_read_b128 v[8:11], v4 offset:63488
    v_mfma_f32_16x16x32_bf16 v[68:71], v[16:19], a[196:199], v[68:71]
    v_mfma_f32_16x16x32_bf16 v[72:75], v[16:19], a[200:203], v[72:75]
    v_mfma_f32_16x16x32_bf16 v[76:79], v[16:19], a[204:207], v[76:79]
    buffer_load_dwordx4 v2, s[4:7], s61 offen offset:1024 lds
    s_waitcnt lgkmcnt(3)
    v_mfma_f32_16x16x32_bf16 v[80:83], v[20:23], a[192:195], v[80:83]
    ds_read_b128 v[12:15], v4 offset:64512
    v_mfma_f32_16x16x32_bf16 v[84:87], v[20:23], a[196:199], v[84:87]
    v_mfma_f32_16x16x32_bf16 v[88:91], v[20:23], a[200:203], v[88:91]
    v_mfma_f32_16x16x32_bf16 v[92:95], v[20:23], a[204:207], v[92:95]
    buffer_load_dwordx4 v2, s[4:7], s61 offen offset:2048 lds
    s_waitcnt lgkmcnt(3)
    v_mfma_f32_16x16x32_bf16 v[208:211], v[24:27], a[208:211], v[208:211]
    ds_read_b128 v[16:19], v4 offset:28672
    v_mfma_f32_16x16x32_bf16 v[212:215], v[24:27], a[212:215], v[212:215]
    v_mfma_f32_16x16x32_bf16 v[216:219], v[24:27], a[216:219], v[216:219]
    s_waitcnt vmcnt(23)
    v_mfma_f32_16x16x32_bf16 v[220:223], v[24:27], a[220:223], v[220:223]
    buffer_load_dwordx4 v2, s[4:7], s61 offen offset:3072 lds
    s_add_u32 m0, s49, 81920
    s_waitcnt lgkmcnt(3)
    v_mfma_f32_16x16x32_bf16 v[224:227], v[28:31], a[208:211], v[224:227]
    ds_read_b128 v[20:23], v4 offset:29696
    s_add_u32 s61, s48, 81920
    v_mfma_f32_16x16x32_bf16 v[228:231], v[28:31], a[212:215], v[228:231]
    v_mfma_f32_16x16x32_bf16 v[232:235], v[28:31], a[216:219], v[232:235]
    v_mfma_f32_16x16x32_bf16 v[236:239], v[28:31], a[220:223], v[236:239]
    buffer_load_dwordx4 v2, s[4:7], s61 offen offset:0 lds
    s_add_u32 m0, s49, 110592
    s_waitcnt lgkmcnt(3)
    v_mfma_f32_16x16x32_bf16 v[64:67], v[8:11], a[208:211], v[64:67]
    ds_read_b128 v[24:27], v7 offset:0
    s_add_u32 s61, s48, 110592
    v_mfma_f32_16x16x32_bf16 v[68:71], v[8:11], a[212:215], v[68:71]
    v_mfma_f32_16x16x32_bf16 v[72:75], v[8:11], a[216:219], v[72:75]
    v_mfma_f32_16x16x32_bf16 v[76:79], v[8:11], a[220:223], v[76:79]
    buffer_load_dwordx4 v2, s[4:7], s61 offen offset:0 lds
    s_waitcnt lgkmcnt(3)
    v_mfma_f32_16x16x32_bf16 v[80:83], v[12:15], a[208:211], v[80:83]
    ds_read_b128 v[28:31], v7 offset:1024
    v_mfma_f32_16x16x32_bf16 v[84:87], v[12:15], a[212:215], v[84:87]
    v_mfma_f32_16x16x32_bf16 v[88:91], v[12:15], a[216:219], v[88:91]
    v_mfma_f32_16x16x32_bf16 v[92:95], v[12:15], a[220:223], v[92:95]
    buffer_load_dwordx4 v2, s[4:7], s61 offen offset:1024 lds
    s_waitcnt lgkmcnt(3)
    v_mfma_f32_16x16x32_bf16 v[208:211], v[16:19], a[224:227], v[208:211]
    ds_read_b128 v[8:11], v4 offset:30720
    v_mfma_f32_16x16x32_bf16 v[212:215], v[16:19], a[228:231], v[212:215]
    v_mfma_f32_16x16x32_bf16 v[216:219], v[16:19], a[232:235], v[216:219]
    s_waitcnt vmcnt(26)
    v_mfma_f32_16x16x32_bf16 v[220:223], v[16:19], a[236:239], v[220:223]
    buffer_load_dwordx4 v2, s[4:7], s61 offen offset:2048 lds
    s_waitcnt lgkmcnt(3)
    v_mfma_f32_16x16x32_bf16 v[224:227], v[20:23], a[224:227], v[224:227]
    ds_read_b128 v[12:15], v4 offset:31744
    v_mfma_f32_16x16x32_bf16 v[228:231], v[20:23], a[228:231], v[228:231]
    v_mfma_f32_16x16x32_bf16 v[232:235], v[20:23], a[232:235], v[232:235]
    v_mfma_f32_16x16x32_bf16 v[236:239], v[20:23], a[236:239], v[236:239]
    buffer_load_dwordx4 v2, s[4:7], s61 offen offset:3072 lds
    s_add_u32 m0, s49, 114688
    s_waitcnt lgkmcnt(3)
    v_mfma_f32_16x16x32_bf16 v[64:67], v[24:27], a[224:227], v[64:67]
    ds_read_b128 v[16:19], v7 offset:2048
    s_add_u32 s61, s48, 114688
    v_mfma_f32_16x16x32_bf16 v[68:71], v[24:27], a[228:231], v[68:71]
    v_mfma_f32_16x16x32_bf16 v[72:75], v[24:27], a[232:235], v[72:75]
    v_mfma_f32_16x16x32_bf16 v[76:79], v[24:27], a[236:239], v[76:79]
    buffer_load_dwordx4 v2, s[4:7], s61 offen offset:0 lds
    s_waitcnt lgkmcnt(3)
    v_mfma_f32_16x16x32_bf16 v[80:83], v[28:31], a[224:227], v[80:83]
    ds_read_b128 v[20:23], v7 offset:3072
    v_mfma_f32_16x16x32_bf16 v[84:87], v[28:31], a[228:231], v[84:87]
    s_waitcnt vmcnt(18)
    v_add_f32 v166, v152, v154
    v_add_f32 v167, v153, v155
    v_mfma_f32_16x16x32_bf16 v[88:91], v[28:31], a[232:235], v[88:91]
    s_waitcnt vmcnt(17)
    v_add_f32 v166, v166, v156
    v_add_f32 v167, v167, v157
    v_mfma_f32_16x16x32_bf16 v[92:95], v[28:31], a[236:239], v[92:95]
    buffer_load_dwordx4 v2, s[4:7], s61 offen offset:1024 lds
    s_waitcnt vmcnt(17)
    v_add_f32 v166, v166, v158
    s_waitcnt lgkmcnt(3)
    v_mfma_f32_16x16x32_bf16 v[208:211], v[8:11], a[240:243], v[208:211]
    ds_read_b128 v[24:27], v4 offset:32768
    v_add_f32 v167, v167, v159
    v_mfma_f32_16x16x32_bf16 v[212:215], v[8:11], a[244:247], v[212:215]
    s_waitcnt vmcnt(16)
    v_add_f32 v166, v166, v160
    v_add_f32 v167, v167, v161
    v_mfma_f32_16x16x32_bf16 v[216:219], v[8:11], a[248:251], v[216:219]
    s_waitcnt vmcnt(15)
    v_add_f32 v166, v166, v162
    v_add_f32 v167, v167, v163
    v_mfma_f32_16x16x32_bf16 v[220:223], v[8:11], a[252:255], v[220:223]
    buffer_load_dwordx4 v2, s[4:7], s61 offen offset:2048 lds
    v_mul_f32 v166, 0xbae38e39, v166
    s_waitcnt lgkmcnt(3)
    v_mfma_f32_16x16x32_bf16 v[224:227], v[12:15], a[240:243], v[224:227]
    ds_read_b128 v[28:31], v4 offset:33792
    v_fmamk_f32 v165, v152, 0x3c2aaaab, v166
    v_mfma_f32_16x16x32_bf16 v[228:231], v[12:15], a[244:247], v[228:231]
    v_mul_f32 v164, v165, v165
    v_fmamk_f32 v165, v154, 0x3c2aaaab, v166
    v_mfma_f32_16x16x32_bf16 v[232:235], v[12:15], a[248:251], v[232:235]
    v_fmac_f32 v164, v165, v165
    v_fmamk_f32 v165, v156, 0x3c2aaaab, v166
    v_mfma_f32_16x16x32_bf16 v[236:239], v[12:15], a[252:255], v[236:239]
    buffer_load_dwordx4 v2, s[4:7], s61 offen offset:3072 lds
    s_add_u32 m0, s49, 118784
    s_waitcnt lgkmcnt(3)
    v_mfma_f32_16x16x32_bf16 v[64:67], v[16:19], a[240:243], v[64:67]
    ds_read_b128 v[8:11], v7 offset:4096
    s_add_u32 s61, s48, 118784
    v_mfma_f32_16x16x32_bf16 v[68:71], v[16:19], a[244:247], v[68:71]
    v_fmac_f32 v164, v165, v165
    v_fmamk_f32 v165, v158, 0x3c2aaaab, v166
    v_mfma_f32_16x16x32_bf16 v[72:75], v[16:19], a[248:251], v[72:75]
    v_fmac_f32 v164, v165, v165
    v_fmamk_f32 v165, v160, 0x3c2aaaab, v166
    v_mfma_f32_16x16x32_bf16 v[76:79], v[16:19], a[252:255], v[76:79]
    buffer_load_dwordx4 v2, s[4:7], s61 offen offset:0 lds
    v_fmac_f32 v164, v165, v165
    s_waitcnt lgkmcnt(3)
    v_mfma_f32_16x16x32_bf16 v[80:83], v[20:23], a[240:243], v[80:83]
    ds_read_b128 v[12:15], v7 offset:5120
    v_fmamk_f32 v165, v162, 0x3c2aaaab, v166
    v_mfma_f32_16x16x32_bf16 v[84:87], v[20:23], a[244:247], v[84:87]
    v_fmac_f32 v164, v165, v165
    v_fmac_f32 v167, 0x42c00000, v164
    v_mfma_f32_16x16x32_bf16 v[88:91], v[20:23], a[248:251], v[88:91]
    v_mov_b32 v165, 0x3727c5ac
    v_fmac_f32 v165, 0x3ae38e39, v167
    v_mfma_f32_16x16x32_bf16 v[92:95], v[20:23], a[252:255], v[92:95]
    v_rcp_f32 v167, v165
    v_and_b32 v164, 15, v1
    s_waitcnt lgkmcnt(3)
    v_mfma_f32_16x16x32_bf16 v[208:211], v[24:27], v[32:35], v[208:211]
    ds_read_b128 v[16:19], v4 offset:34816
    v_lshlrev_b32 v164, 2, v164
    v_mfma_f32_16x16x32_bf16 v[212:215], v[24:27], v[36:39], v[212:215]
    ds_bpermute_b32 v128, v164, v166 offset:0
    ds_bpermute_b32 v132, v164, v167 offset:0
    v_mfma_f32_16x16x32_bf16 v[216:219], v[24:27], v[40:43], v[216:219]
    ds_bpermute_b32 v129, v164, v166 offset:64
    ds_bpermute_b32 v133, v164, v167 offset:64
    v_mfma_f32_16x16x32_bf16 v[220:223], v[24:27], v[44:47], v[220:223]
    ds_bpermute_b32 v130, v164, v166 offset:128
    ds_bpermute_b32 v134, v164, v167 offset:128
    s_waitcnt lgkmcnt(9)
    v_mfma_f32_16x16x32_bf16 v[224:227], v[28:31], v[32:35], v[224:227]
    ds_read_b128 v[20:23], v4 offset:35840
    ds_bpermute_b32 v131, v164, v166 offset:192
    v_mfma_f32_16x16x32_bf16 v[228:231], v[28:31], v[36:39], v[228:231]
    ds_bpermute_b32 v135, v164, v167 offset:192
    v_mfma_f32_16x16x32_bf16 v[232:235], v[28:31], v[40:43], v[232:235]
    v_mfma_f32_16x16x32_bf16 v[236:239], v[28:31], v[44:47], v[236:239]
    s_waitcnt lgkmcnt(11)
    v_mfma_f32_16x16x32_bf16 v[64:67], v[8:11], v[32:35], v[64:67]
    ds_read_b128 v[24:27], v7 offset:6144
    v_mfma_f32_16x16x32_bf16 v[68:71], v[8:11], v[36:39], v[68:71]
    v_mfma_f32_16x16x32_bf16 v[72:75], v[8:11], v[40:43], v[72:75]
    v_mfma_f32_16x16x32_bf16 v[76:79], v[8:11], v[44:47], v[76:79]
    ds_read_b128 v[136:139], v5 offset:0
    ds_read_b128 v[140:143], v5 offset:64
    s_waitcnt lgkmcnt(13)
    v_mfma_f32_16x16x32_bf16 v[80:83], v[12:15], v[32:35], v[80:83]
    ds_read_b128 v[28:31], v7 offset:7168
    ds_read_b128 v[144:147], v5 offset:128
    v_mfma_f32_16x16x32_bf16 v[84:87], v[12:15], v[36:39], v[84:87]
    ds_read_b128 v[148:151], v5 offset:192
    v_mfma_f32_16x16x32_bf16 v[88:91], v[12:15], v[40:43], v[88:91]
    v_mfma_f32_16x16x32_bf16 v[92:95], v[12:15], v[44:47], v[92:95]
    s_waitcnt lgkmcnt(15)
    v_mfma_f32_16x16x32_bf16 v[208:211], v[16:19], v[48:51], v[208:211]
    s_waitcnt vmcnt(9)
    s_waitcnt lgkmcnt(0)
    s_barrier
    v_mfma_f32_16x16x32_bf16 v[212:215], v[16:19], v[52:55], v[212:215]
    v_add_u32 v4, 0x12000, v4
    ds_read_b128 v[8:11], v4 offset:0
    v_mfma_f32_16x16x32_bf16 v[216:219], v[16:19], v[56:59], v[216:219]
    s_add_u32 m0, s49, 0
    s_add_u32 s61, s48, 147456
    v_mfma_f32_16x16x32_bf16 v[220:223], v[16:19], v[60:63], v[220:223]
    buffer_load_dwordx4 v2, s[4:7], s61 offen offset:0 lds
    v_mfma_f32_16x16x32_bf16 v[224:227], v[20:23], v[48:51], v[224:227]
    ds_read_b128 v[12:15], v4 offset:1024
    v_mfma_f32_16x16x32_bf16 v[228:231], v[20:23], v[52:55], v[228:231]
    v_mfma_f32_16x16x32_bf16 v[232:235], v[20:23], v[56:59], v[232:235]
    v_mfma_f32_16x16x32_bf16 v[236:239], v[20:23], v[60:63], v[236:239]
    buffer_load_dwordx4 v2, s[4:7], s61 offen offset:1024 lds
    v_mfma_f32_16x16x32_bf16 v[64:67], v[24:27], v[48:51], v[64:67]
    ds_read_b128 v[16:19], v4 offset:2048
    v_mfma_f32_16x16x32_bf16 v[68:71], v[24:27], v[52:55], v[68:71]
    v_mfma_f32_16x16x32_bf16 v[72:75], v[24:27], v[56:59], v[72:75]
    v_mfma_f32_16x16x32_bf16 v[76:79], v[24:27], v[60:63], v[76:79]
    buffer_load_dwordx4 v2, s[4:7], s61 offen offset:2048 lds
    v_mfma_f32_16x16x32_bf16 v[80:83], v[28:31], v[48:51], v[80:83]
    ds_read_b128 v[20:23], v4 offset:3072
    v_mfma_f32_16x16x32_bf16 v[84:87], v[28:31], v[52:55], v[84:87]
    v_mfma_f32_16x16x32_bf16 v[88:91], v[28:31], v[56:59], v[88:91]
    v_mfma_f32_16x16x32_bf16 v[92:95], v[28:31], v[60:63], v[92:95]
    buffer_load_dwordx4 v2, s[4:7], s61 offen offset:3072 lds
    s_add_u32 m0, s49, 4096
    s_waitcnt lgkmcnt(3)
    v_mfma_f32_16x16x32_bf16 v[96:99], v[8:11], a[0:3], 0
    ds_read_b128 v[24:27], v4 offset:4096
    s_add_u32 s61, s48, 151552
    v_mfma_f32_16x16x32_bf16 v[100:103], v[8:11], a[4:7], 0
    v_mfma_f32_16x16x32_bf16 v[104:107], v[8:11], a[8:11], 0
    v_mfma_f32_16x16x32_bf16 v[108:111], v[8:11], a[12:15], 0
    buffer_load_dwordx4 v2, s[4:7], s61 offen offset:0 lds
    s_waitcnt lgkmcnt(3)
    v_mfma_f32_16x16x32_bf16 v[112:115], v[12:15], a[0:3], 0
    ds_read_b128 v[28:31], v4 offset:5120
    v_mfma_f32_16x16x32_bf16 v[116:119], v[12:15], a[4:7], 0
    v_fmac_f32 v64, v144, v128
    v_fmac_f32 v65, v145, v128
    v_mfma_f32_16x16x32_bf16 v[120:123], v[12:15], a[8:11], 0
    v_fmac_f32 v66, v146, v128
    v_fmac_f32 v67, v147, v128
    v_mfma_f32_16x16x32_bf16 v[124:127], v[12:15], a[12:15], 0
    buffer_load_dwordx4 v2, s[4:7], s61 offen offset:1024 lds
    v_fmac_f32 v80, v148, v128
    s_waitcnt lgkmcnt(3)
    v_mfma_f32_16x16x32_bf16 v[96:99], v[16:19], a[16:19], v[96:99]
    ds_read_b128 v[8:11], v4 offset:6144
    v_fmac_f32 v81, v149, v128
    v_mfma_f32_16x16x32_bf16 v[100:103], v[16:19], a[20:23], v[100:103]
    v_fmac_f32 v82, v150, v128
    v_fmac_f32 v83, v151, v128
    v_mfma_f32_16x16x32_bf16 v[104:107], v[16:19], a[24:27], v[104:107]
    v_mul_f32 v64, v64, v132
    v_mul_f32 v65, v65, v132
    v_mfma_f32_16x16x32_bf16 v[108:111], v[16:19], a[28:31], v[108:111]
    buffer_load_dwordx4 v2, s[4:7], s61 offen offset:2048 lds
    v_mul_f32 v66, v66, v132
    s_waitcnt lgkmcnt(3)
    v_mfma_f32_16x16x32_bf16 v[112:115], v[20:23], a[16:19], v[112:115]
    ds_read_b128 v[12:15], v4 offset:7168
    v_mul_f32 v67, v67, v132
    v_mfma_f32_16x16x32_bf16 v[116:119], v[20:23], a[20:23], v[116:119]
    v_mul_f32 v64, v64, v80
    v_mul_f32 v65, v65, v81
    v_mfma_f32_16x16x32_bf16 v[120:123], v[20:23], a[24:27], v[120:123]
    v_mul_f32 v66, v66, v82
    v_mul_f32 v67, v67, v83
    v_mfma_f32_16x16x32_bf16 v[124:127], v[20:23], a[28:31], v[124:127]
    buffer_load_dwordx4 v2, s[4:7], s61 offen offset:3072 lds
    s_add_u32 m0, s49, 8192
    s_waitcnt lgkmcnt(3)
    v_mfma_f32_16x16x32_bf16 v[96:99], v[24:27], a[32:35], v[96:99]
    ds_read_b128 v[16:19], v4 offset:8192
    s_add_u32 s61, s48, 155648
    v_mfma_f32_16x16x32_bf16 v[100:103], v[24:27], a[36:39], v[100:103]
    v_cvt_pk_bf16_f32 v176, v64, v65
    v_cvt_pk_bf16_f32 v177, v66, v67
    v_mfma_f32_16x16x32_bf16 v[104:107], v[24:27], a[40:43], v[104:107]
    v_fmac_f32 v68, v144, v129
    v_fmac_f32 v69, v145, v129
    v_mfma_f32_16x16x32_bf16 v[108:111], v[24:27], a[44:47], v[108:111]
    buffer_load_dwordx4 v2, s[4:7], s61 offen offset:0 lds
    s_add_u32 m0, s49, 36864
    s_waitcnt lgkmcnt(3)
    v_mfma_f32_16x16x32_bf16 v[112:115], v[28:31], a[32:35], v[112:115]
    ds_read_b128 v[20:23], v4 offset:9216
    s_add_u32 s61, s48, 184320
    v_mfma_f32_16x16x32_bf16 v[116:119], v[28:31], a[36:39], v[116:119]
    v_fmac_f32 v70, v146, v129
    v_fmac_f32 v71, v147, v129
    v_mfma_f32_16x16x32_bf16 v[120:123], v[28:31], a[40:43], v[120:123]
    v_fmac_f32 v84, v148, v129
    v_fmac_f32 v85, v149, v129
    v_mfma_f32_16x16x32_bf16 v[124:127], v[28:31], a[44:47], v[124:127]
    buffer_load_dwordx4 v2, s[4:7], s61 offen offset:0 lds
    v_fmac_f32 v86, v150, v129
    s_waitcnt lgkmcnt(3)
    v_mfma_f32_16x16x32_bf16 v[96:99], v[8:11], a[48:51], v[96:99]
    ds_read_b128 v[24:27], v4 offset:10240
    v_fmac_f32 v87, v151, v129
    v_mfma_f32_16x16x32_bf16 v[100:103], v[8:11], a[52:55], v[100:103]
    v_mul_f32 v68, v68, v133
    v_mul_f32 v69, v69, v133
    v_mfma_f32_16x16x32_bf16 v[104:107], v[8:11], a[56:59], v[104:107]
    v_mul_f32 v70, v70, v133
    v_mul_f32 v71, v71, v133
    v_mfma_f32_16x16x32_bf16 v[108:111], v[8:11], a[60:63], v[108:111]
    buffer_load_dwordx4 v2, s[4:7], s61 offen offset:1024 lds
    v_mul_f32 v68, v68, v84
    s_waitcnt lgkmcnt(3)
    v_mfma_f32_16x16x32_bf16 v[112:115], v[12:15], a[48:51], v[112:115]
    ds_read_b128 v[28:31], v4 offset:11264
    v_mul_f32 v69, v69, v85
    v_mfma_f32_16x16x32_bf16 v[116:119], v[12:15], a[52:55], v[116:119]
    v_mul_f32 v70, v70, v86
    v_mul_f32 v71, v71, v87
    v_mfma_f32_16x16x32_bf16 v[120:123], v[12:15], a[56:59], v[120:123]
    v_cvt_pk_bf16_f32 v180, v68, v69
    v_cvt_pk_bf16_f32 v181, v70, v71
    v_mfma_f32_16x16x32_bf16 v[124:127], v[12:15], a[60:63], v[124:127]
    buffer_load_dwordx4 v2, s[4:7], s61 offen offset:2048 lds
    v_fmac_f32 v72, v144, v130
    s_waitcnt lgkmcnt(3)
    v_mfma_f32_16x16x32_bf16 v[96:99], v[16:19], a[64:67], v[96:99]
    ds_read_b128 v[8:11], v4 offset:12288
    v_fmac_f32 v73, v145, v130
    v_mfma_f32_16x16x32_bf16 v[100:103], v[16:19], a[68:71], v[100:103]
    v_fmac_f32 v74, v146, v130
    v_fmac_f32 v75, v147, v130
    v_mfma_f32_16x16x32_bf16 v[104:107], v[16:19], a[72:75], v[104:107]
    v_fmac_f32 v88, v148, v130
    v_fmac_f32 v89, v149, v130
    v_mfma_f32_16x16x32_bf16 v[108:111], v[16:19], a[76:79], v[108:111]
    buffer_load_dwordx4 v2, s[4:7], s61 offen offset:3072 lds
    s_add_u32 m0, s49, 40960
    s_waitcnt lgkmcnt(3)
    v_mfma_f32_16x16x32_bf16 v[112:115], v[20:23], a[64:67], v[112:115]
    ds_read_b128 v[12:15], v4 offset:13312
    s_add_u32 s61, s48, 188416
    v_mfma_f32_16x16x32_bf16 v[116:119], v[20:23], a[68:71], v[116:119]
    v_fmac_f32 v90, v150, v130
    v_fmac_f32 v91, v151, v130
    v_mfma_f32_16x16x32_bf16 v[120:123], v[20:23], a[72:75], v[120:123]
    v_mul_f32 v72, v72, v134
    v_mul_f32 v73, v73, v134
    v_mfma_f32_16x16x32_bf16 v[124:127], v[20:23], a[76:79], v[124:127]
    buffer_load_dwordx4 v2, s[4:7], s61 offen offset:0 lds
    v_mul_f32 v74, v74, v134
    s_waitcnt lgkmcnt(3)
    v_mfma_f32_16x16x32_bf16 v[96:99], v[24:27], a[80:83], v[96:99]
    ds_read_b128 v[16:19], v4 offset:14336
    v_mul_f32 v75, v75, v134
    v_mfma_f32_16x16x32_bf16 v[100:103], v[24:27], a[84:87], v[100:103]
    v_mul_f32 v72, v72, v88
    v_mul_f32 v73, v73, v89
    v_mfma_f32_16x16x32_bf16 v[104:107], v[24:27], a[88:91], v[104:107]
    v_mul_f32 v74, v74, v90
    v_mul_f32 v75, v75, v91
    v_mfma_f32_16x16x32_bf16 v[108:111], v[24:27], a[92:95], v[108:111]
    buffer_load_dwordx4 v2, s[4:7], s61 offen offset:1024 lds
    v_cvt_pk_bf16_f32 v184, v72, v73
    s_waitcnt lgkmcnt(3)
    v_mfma_f32_16x16x32_bf16 v[112:115], v[28:31], a[80:83], v[112:115]
    ds_read_b128 v[20:23], v4 offset:15360
    v_cvt_pk_bf16_f32 v185, v74, v75
    v_mfma_f32_16x16x32_bf16 v[116:119], v[28:31], a[84:87], v[116:119]
    v_fmac_f32 v76, v144, v131
    v_fmac_f32 v77, v145, v131
    v_mfma_f32_16x16x32_bf16 v[120:123], v[28:31], a[88:91], v[120:123]
    v_fmac_f32 v78, v146, v131
    v_fmac_f32 v79, v147, v131
    v_mfma_f32_16x16x32_bf16 v[124:127], v[28:31], a[92:95], v[124:127]
    buffer_load_dwordx4 v2, s[4:7], s61 offen offset:2048 lds
    v_fmac_f32 v92, v148, v131
    s_waitcnt lgkmcnt(3)
    v_mfma_f32_16x16x32_bf16 v[96:99], v[8:11], a[96:99], v[96:99]
    ds_read_b128 v[24:27], v4 offset:16384
    v_fmac_f32 v93, v149, v131
    v_mfma_f32_16x16x32_bf16 v[100:103], v[8:11], a[100:103], v[100:103]
    v_fmac_f32 v94, v150, v131
    v_fmac_f32 v95, v151, v131
    v_mfma_f32_16x16x32_bf16 v[104:107], v[8:11], a[104:107], v[104:107]
    v_mul_f32 v76, v76, v135
    v_mul_f32 v77, v77, v135
    v_mfma_f32_16x16x32_bf16 v[108:111], v[8:11], a[108:111], v[108:111]
    buffer_load_dwordx4 v2, s[4:7], s61 offen offset:3072 lds
    s_add_u32 m0, s49, 45056
    s_waitcnt lgkmcnt(3)
    v_mfma_f32_16x16x32_bf16 v[112:115], v[12:15], a[96:99], v[112:115]
    ds_read_b128 v[28:31], v4 offset:17408
    s_add_u32 s61, s48, 192512
    v_mfma_f32_16x16x32_bf16 v[116:119], v[12:15], a[100:103], v[116:119]
    v_mul_f32 v78, v78, v135
    v_mul_f32 v79, v79, v135
    v_mfma_f32_16x16x32_bf16 v[120:123], v[12:15], a[104:107], v[120:123]
    v_mul_f32 v76, v76, v92
    v_mul_f32 v77, v77, v93
    v_mfma_f32_16x16x32_bf16 v[124:127], v[12:15], a[108:111], v[124:127]
    buffer_load_dwordx4 v2, s[4:7], s61 offen offset:0 lds
    v_mul_f32 v78, v78, v94
    s_waitcnt lgkmcnt(3)
    v_mfma_f32_16x16x32_bf16 v[96:99], v[16:19], a[112:115], v[96:99]
    ds_read_b128 v[8:11], v4 offset:18432
    v_mul_f32 v79, v79, v95
    v_mfma_f32_16x16x32_bf16 v[100:103], v[16:19], a[116:119], v[100:103]
    v_cvt_pk_bf16_f32 v188, v76, v77
    v_cvt_pk_bf16_f32 v189, v78, v79
    v_mfma_f32_16x16x32_bf16 v[104:107], v[16:19], a[120:123], v[104:107]
    v_fmac_f32 v208, v136, v128
    v_fmac_f32 v209, v137, v128
    v_mfma_f32_16x16x32_bf16 v[108:111], v[16:19], a[124:127], v[108:111]
    v_fmac_f32 v210, v138, v128
    v_fmac_f32 v211, v139, v128
    s_waitcnt lgkmcnt(3)
    v_mfma_f32_16x16x32_bf16 v[112:115], v[20:23], a[112:115], v[112:115]
    ds_read_b128 v[12:15], v4 offset:19456
    v_fmac_f32 v224, v140, v128
    v_mfma_f32_16x16x32_bf16 v[116:119], v[20:23], a[116:119], v[116:119]
    v_fmac_f32 v225, v141, v128
    v_fmac_f32 v226, v142, v128
    v_mfma_f32_16x16x32_bf16 v[120:123], v[20:23], a[120:123], v[120:123]
    v_fmac_f32 v227, v143, v128
    v_mul_f32 v208, v208, v132
    v_mfma_f32_16x16x32_bf16 v[124:127], v[20:23], a[124:127], v[124:127]
    v_mul_f32 v209, v209, v132
    v_mul_f32 v210, v210, v132
    s_waitcnt lgkmcnt(3)
    v_mfma_f32_16x16x32_bf16 v[96:99], v[24:27], a[128:131], v[96:99]
    ds_read_b128 v[16:19], v4 offset:20480
    v_mul_f32 v211, v211, v132
    v_mfma_f32_16x16x32_bf16 v[100:103], v[24:27], a[132:135], v[100:103]
    v_mul_f32 v208, v208, v224
    v_mul_f32 v209, v209, v225
    v_mfma_f32_16x16x32_bf16 v[104:107], v[24:27], a[136:139], v[104:107]
    v_mul_f32 v210, v210, v226
    v_mul_f32 v211, v211, v227
    v_mfma_f32_16x16x32_bf16 v[108:111], v[24:27], a[140:143], v[108:111]
    v_cvt_pk_bf16_f32 v240, v208, v209
    v_cvt_pk_bf16_f32 v241, v210, v211
    s_waitcnt lgkmcnt(3)
    v_mfma_f32_16x16x32_bf16 v[112:115], v[28:31], a[128:131], v[112:115]
    ds_read_b128 v[20:23], v4 offset:21504
    s_add_u32 s66, s51, s65
    v_mfma_f32_16x16x32_bf16 v[116:119], v[28:31], a[132:135], v[116:119]
    buffer_store_dwordx2 v[240:241], v3, s[4:7], s66 offen offset:0 sc1
    v_fmac_f32 v212, v136, v129
    v_mfma_f32_16x16x32_bf16 v[120:123], v[28:31], a[136:139], v[120:123]
    v_fmac_f32 v213, v137, v129
    v_fmac_f32 v214, v138, v129
    v_mfma_f32_16x16x32_bf16 v[124:127], v[28:31], a[140:143], v[124:127]
    v_fmac_f32 v215, v139, v129
    v_fmac_f32 v228, v140, v129
    s_waitcnt lgkmcnt(3)
    v_mfma_f32_16x16x32_bf16 v[96:99], v[8:11], a[144:147], v[96:99]
    ds_read_b128 v[24:27], v4 offset:22528
    v_fmac_f32 v229, v141, v129
    v_mfma_f32_16x16x32_bf16 v[100:103], v[8:11], a[148:151], v[100:103]
    v_fmac_f32 v230, v142, v129
    v_fmac_f32 v231, v143, v129
    v_mfma_f32_16x16x32_bf16 v[104:107], v[8:11], a[152:155], v[104:107]
    v_mul_f32 v212, v212, v133
    v_mul_f32 v213, v213, v133
    v_mfma_f32_16x16x32_bf16 v[108:111], v[8:11], a[156:159], v[108:111]
    v_mul_f32 v214, v214, v133
    v_mul_f32 v215, v215, v133
    s_waitcnt lgkmcnt(3)
    v_mfma_f32_16x16x32_bf16 v[112:115], v[12:15], a[144:147], v[112:115]
    ds_read_b128 v[28:31], v4 offset:23552
    v_mul_f32 v212, v212, v228
    v_mfma_f32_16x16x32_bf16 v[116:119], v[12:15], a[148:151], v[116:119]
    v_mul_f32 v213, v213, v229
    v_mul_f32 v214, v214, v230
    v_mfma_f32_16x16x32_bf16 v[120:123], v[12:15], a[152:155], v[120:123]
    v_mul_f32 v215, v215, v231
    v_cvt_pk_bf16_f32 v244, v212, v213
    v_mfma_f32_16x16x32_bf16 v[124:127], v[12:15], a[156:159], v[124:127]
    v_cvt_pk_bf16_f32 v245, v214, v215
    buffer_store_dwordx2 v[244:245], v3, s[4:7], s66 offen offset:512 sc1
    s_waitcnt lgkmcnt(3)
    v_mfma_f32_16x16x32_bf16 v[96:99], v[16:19], a[160:163], v[96:99]
    ds_read_b128 v[8:11], v4 offset:24576
    v_fmac_f32 v216, v136, v130
    v_mfma_f32_16x16x32_bf16 v[100:103], v[16:19], a[164:167], v[100:103]
    v_fmac_f32 v217, v137, v130
    v_fmac_f32 v218, v138, v130
    v_mfma_f32_16x16x32_bf16 v[104:107], v[16:19], a[168:171], v[104:107]
    v_fmac_f32 v219, v139, v130
    v_fmac_f32 v232, v140, v130
    v_mfma_f32_16x16x32_bf16 v[108:111], v[16:19], a[172:175], v[108:111]
    v_fmac_f32 v233, v141, v130
    v_fmac_f32 v234, v142, v130
    s_waitcnt lgkmcnt(3)
    v_mfma_f32_16x16x32_bf16 v[112:115], v[20:23], a[160:163], v[112:115]
    ds_read_b128 v[12:15], v4 offset:25600
    v_fmac_f32 v235, v143, v130
    v_mfma_f32_16x16x32_bf16 v[116:119], v[20:23], a[164:167], v[116:119]
    v_mul_f32 v216, v216, v134
    v_mul_f32 v217, v217, v134
    v_mfma_f32_16x16x32_bf16 v[120:123], v[20:23], a[168:171], v[120:123]
    v_mul_f32 v218, v218, v134
    v_mul_f32 v219, v219, v134
    v_mfma_f32_16x16x32_bf16 v[124:127], v[20:23], a[172:175], v[124:127]
    v_mul_f32 v216, v216, v232
    v_mul_f32 v217, v217, v233
    s_waitcnt lgkmcnt(3)
    v_mfma_f32_16x16x32_bf16 v[96:99], v[24:27], a[176:179], v[96:99]
    ds_read_b128 v[16:19], v4 offset:26624
    v_mul_f32 v218, v218, v234
    v_mfma_f32_16x16x32_bf16 v[100:103], v[24:27], a[180:183], v[100:103]
    v_mul_f32 v219, v219, v235
    v_cvt_pk_bf16_f32 v248, v216, v217
    v_mfma_f32_16x16x32_bf16 v[104:107], v[24:27], a[184:187], v[104:107]
    v_cvt_pk_bf16_f32 v249, v218, v219
    buffer_store_dwordx2 v[248:249], v3, s[4:7], s66 offen offset:1024 sc1
    v_mfma_f32_16x16x32_bf16 v[108:111], v[24:27], a[188:191], v[108:111]
    v_fmac_f32 v220, v136, v131
    v_fmac_f32 v221, v137, v131
    s_waitcnt lgkmcnt(3)
    v_mfma_f32_16x16x32_bf16 v[112:115], v[28:31], a[176:179], v[112:115]
    ds_read_b128 v[20:23], v4 offset:27648
    v_fmac_f32 v222, v138, v131
    v_mfma_f32_16x16x32_bf16 v[116:119], v[28:31], a[180:183], v[116:119]
    v_fmac_f32 v223, v139, v131
    v_fmac_f32 v236, v140, v131
    v_mfma_f32_16x16x32_bf16 v[120:123], v[28:31], a[184:187], v[120:123]
    v_fmac_f32 v237, v141, v131
    v_fmac_f32 v238, v142, v131
    v_mfma_f32_16x16x32_bf16 v[124:127], v[28:31], a[188:191], v[124:127]
    v_fmac_f32 v239, v143, v131
    v_mul_f32 v220, v220, v135
    s_waitcnt lgkmcnt(3)
    v_mfma_f32_16x16x32_bf16 v[96:99], v[8:11], a[192:195], v[96:99]
    ds_read_b128 v[24:27], v4 offset:28672
    v_mul_f32 v221, v221, v135
    v_mfma_f32_16x16x32_bf16 v[100:103], v[8:11], a[196:199], v[100:103]
    v_mul_f32 v222, v222, v135
    v_mul_f32 v223, v223, v135
    v_mfma_f32_16x16x32_bf16 v[104:107], v[8:11], a[200:203], v[104:107]
    v_mul_f32 v220, v220, v236
    v_mul_f32 v221, v221, v237
    v_mfma_f32_16x16x32_bf16 v[108:111], v[8:11], a[204:207], v[108:111]
    v_mul_f32 v222, v222, v238
    v_mul_f32 v223, v223, v239
    s_waitcnt lgkmcnt(3)
    v_mfma_f32_16x16x32_bf16 v[112:115], v[12:15], a[192:195], v[112:115]
    ds_read_b128 v[28:31], v4 offset:29696
    v_cvt_pk_bf16_f32 v252, v220, v221
    v_mfma_f32_16x16x32_bf16 v[116:119], v[12:15], a[196:199], v[116:119]
    v_cvt_pk_bf16_f32 v253, v222, v223
    buffer_store_dwordx2 v[252:253], v3, s[4:7], s66 offen offset:1536 sc1
    v_mfma_f32_16x16x32_bf16 v[120:123], v[12:15], a[200:203], v[120:123]
    v_mfma_f32_16x16x32_bf16 v[124:127], v[12:15], a[204:207], v[124:127]
    s_waitcnt lgkmcnt(3)
    v_mfma_f32_16x16x32_bf16 v[96:99], v[16:19], a[208:211], v[96:99]
    ds_read_b128 v[8:11], v4 offset:30720
    v_mfma_f32_16x16x32_bf16 v[100:103], v[16:19], a[212:215], v[100:103]
    v_mfma_f32_16x16x32_bf16 v[104:107], v[16:19], a[216:219], v[104:107]
    v_mfma_f32_16x16x32_bf16 v[108:111], v[16:19], a[220:223], v[108:111]
    s_waitcnt lgkmcnt(3)
    v_mfma_f32_16x16x32_bf16 v[112:115], v[20:23], a[208:211], v[112:115]
    ds_read_b128 v[12:15], v4 offset:31744
    v_mfma_f32_16x16x32_bf16 v[116:119], v[20:23], a[212:215], v[116:119]
    v_mfma_f32_16x16x32_bf16 v[120:123], v[20:23], a[216:219], v[120:123]
    v_mfma_f32_16x16x32_bf16 v[124:127], v[20:23], a[220:223], v[124:127]
    s_waitcnt lgkmcnt(3)
    v_mfma_f32_16x16x32_bf16 v[96:99], v[24:27], a[224:227], v[96:99]
    ds_read_b128 v[16:19], v4 offset:32768
    v_mfma_f32_16x16x32_bf16 v[100:103], v[24:27], a[228:231], v[100:103]
    v_mfma_f32_16x16x32_bf16 v[104:107], v[24:27], a[232:235], v[104:107]
    v_mfma_f32_16x16x32_bf16 v[108:111], v[24:27], a[236:239], v[108:111]
    s_waitcnt lgkmcnt(3)
    v_mfma_f32_16x16x32_bf16 v[112:115], v[28:31], a[224:227], v[112:115]
    ds_read_b128 v[20:23], v4 offset:33792
    v_mfma_f32_16x16x32_bf16 v[116:119], v[28:31], a[228:231], v[116:119]
    v_mfma_f32_16x16x32_bf16 v[120:123], v[28:31], a[232:235], v[120:123]
    v_mfma_f32_16x16x32_bf16 v[124:127], v[28:31], a[236:239], v[124:127]
    s_waitcnt lgkmcnt(3)
    v_mfma_f32_16x16x32_bf16 v[96:99], v[8:11], a[240:243], v[96:99]
    ds_read_b128 v[24:27], v4 offset:34816
    v_mfma_f32_16x16x32_bf16 v[100:103], v[8:11], a[244:247], v[100:103]
    v_mfma_f32_16x16x32_bf16 v[104:107], v[8:11], a[248:251], v[104:107]
    v_mfma_f32_16x16x32_bf16 v[108:111], v[8:11], a[252:255], v[108:111]
    ds_read_b128 v[136:139], v5 offset:256
    ds_read_b128 v[140:143], v5 offset:320
    s_waitcnt lgkmcnt(5)
    v_mfma_f32_16x16x32_bf16 v[112:115], v[12:15], a[240:243], v[112:115]
    ds_read_b128 v[28:31], v4 offset:35840
    v_mfma_f32_16x16x32_bf16 v[116:119], v[12:15], a[244:247], v[116:119]
    v_mfma_f32_16x16x32_bf16 v[120:123], v[12:15], a[248:251], v[120:123]
    v_mfma_f32_16x16x32_bf16 v[124:127], v[12:15], a[252:255], v[124:127]
    s_waitcnt lgkmcnt(5)
    v_mfma_f32_16x16x32_bf16 v[96:99], v[16:19], v[32:35], v[96:99]
    s_waitcnt vmcnt(22)
    s_barrier
    v_mfma_f32_16x16x32_bf16 v[100:103], v[16:19], v[36:39], v[100:103]
    v_add_u32 v4, 0x9000, v4
    ds_read_b128 v[8:11], v4 offset:0
    v_mfma_f32_16x16x32_bf16 v[104:107], v[16:19], v[40:43], v[104:107]
    v_mfma_f32_16x16x32_bf16 v[108:111], v[16:19], v[44:47], v[108:111]
    s_waitcnt lgkmcnt(5)
    v_mfma_f32_16x16x32_bf16 v[112:115], v[20:23], v[32:35], v[112:115]
    ds_read_b128 v[12:15], v4 offset:1024
    v_mfma_f32_16x16x32_bf16 v[116:119], v[20:23], v[36:39], v[116:119]
    v_mfma_f32_16x16x32_bf16 v[120:123], v[20:23], v[40:43], v[120:123]
    v_mfma_f32_16x16x32_bf16 v[124:127], v[20:23], v[44:47], v[124:127]
    s_waitcnt lgkmcnt(5)
    v_mfma_f32_16x16x32_bf16 v[96:99], v[24:27], v[48:51], v[96:99]
    ds_read_b128 v[16:19], v4 offset:2048
    v_mfma_f32_16x16x32_bf16 v[100:103], v[24:27], v[52:55], v[100:103]
    v_mfma_f32_16x16x32_bf16 v[104:107], v[24:27], v[56:59], v[104:107]
    v_mfma_f32_16x16x32_bf16 v[108:111], v[24:27], v[60:63], v[108:111]
    s_waitcnt lgkmcnt(3)
    v_mfma_f32_16x16x32_bf16 v[112:115], v[28:31], v[48:51], v[112:115]
    ds_read_b128 v[20:23], v4 offset:3072
    v_mfma_f32_16x16x32_bf16 v[116:119], v[28:31], v[52:55], v[116:119]
    v_mfma_f32_16x16x32_bf16 v[120:123], v[28:31], v[56:59], v[120:123]
    v_mfma_f32_16x16x32_bf16 v[124:127], v[28:31], v[60:63], v[124:127]
    s_waitcnt lgkmcnt(3)
    v_mfma_f32_16x16x32_bf16 v[64:67], v[8:11], a[0:3], 0
    ds_read_b128 v[24:27], v4 offset:4096
    v_mfma_f32_16x16x32_bf16 v[68:71], v[8:11], a[4:7], 0
    v_mfma_f32_16x16x32_bf16 v[72:75], v[8:11], a[8:11], 0
    v_mfma_f32_16x16x32_bf16 v[76:79], v[8:11], a[12:15], 0
    s_waitcnt lgkmcnt(3)
    v_mfma_f32_16x16x32_bf16 v[80:83], v[12:15], a[0:3], 0
    ds_read_b128 v[28:31], v4 offset:5120
    v_mfma_f32_16x16x32_bf16 v[84:87], v[12:15], a[4:7], 0
    v_fmac_f32 v96, v136, v128
    v_fmac_f32 v97, v137, v128
    v_mfma_f32_16x16x32_bf16 v[88:91], v[12:15], a[8:11], 0
    v_fmac_f32 v98, v138, v128
    v_fmac_f32 v99, v139, v128
    v_mfma_f32_16x16x32_bf16 v[92:95], v[12:15], a[12:15], 0
    v_fmac_f32 v112, v140, v128
    v_fmac_f32 v113, v141, v128
    s_waitcnt lgkmcnt(3)
    v_mfma_f32_16x16x32_bf16 v[64:67], v[16:19], a[16:19], v[64:67]
    ds_read_b128 v[8:11], v4 offset:6144
    v_fmac_f32 v114, v142, v128
    v_mfma_f32_16x16x32_bf16 v[68:71], v[16:19], a[20:23], v[68:71]
    v_fmac_f32 v115, v143, v128
    v_mul_f32 v96, v96, v132
    v_mfma_f32_16x16x32_bf16 v[72:75], v[16:19], a[24:27], v[72:75]
    v_mul_f32 v97, v97, v132
    v_mul_f32 v98, v98, v132
    v_mfma_f32_16x16x32_bf16 v[76:79], v[16:19], a[28:31], v[76:79]
    v_mul_f32 v99, v99, v132
    v_mul_f32 v96, v96, v112
    s_waitcnt lgkmcnt(3)
    v_mfma_f32_16x16x32_bf16 v[80:83], v[20:23], a[16:19], v[80:83]
    ds_read_b128 v[12:15], v4 offset:7168
    v_mul_f32 v97, v97, v113
    v_mfma_f32_16x16x32_bf16 v[84:87], v[20:23], a[20:23], v[84:87]
    v_mul_f32 v98, v98, v114
    v_mul_f32 v99, v99, v115
    v_mfma_f32_16x16x32_bf16 v[88:91], v[20:23], a[24:27], v[88:91]
    v_cvt_pk_bf16_f32 v178, v96, v97
    v_cvt_pk_bf16_f32 v179, v98, v99
    v_mfma_f32_16x16x32_bf16 v[92:95], v[20:23], a[28:31], v[92:95]
    s_add_u32 s66, s51, 0
    buffer_store_dwordx4 v[176:179], v2, s[4:7], s66 offen offset:0 sc1
    s_waitcnt lgkmcnt(3)
    v_mfma_f32_16x16x32_bf16 v[64:67], v[24:27], a[32:35], v[64:67]
    ds_read_b128 v[16:19], v4 offset:8192
    v_fmac_f32 v100, v136, v129
    v_mfma_f32_16x16x32_bf16 v[68:71], v[24:27], a[36:39], v[68:71]
    v_fmac_f32 v101, v137, v129
    v_fmac_f32 v102, v138, v129
    v_mfma_f32_16x16x32_bf16 v[72:75], v[24:27], a[40:43], v[72:75]
    v_fmac_f32 v103, v139, v129
    v_fmac_f32 v116, v140, v129
    v_mfma_f32_16x16x32_bf16 v[76:79], v[24:27], a[44:47], v[76:79]
    v_fmac_f32 v117, v141, v129
    v_fmac_f32 v118, v142, v129
    s_waitcnt lgkmcnt(3)
    v_mfma_f32_16x16x32_bf16 v[80:83], v[28:31], a[32:35], v[80:83]
    ds_read_b128 v[20:23], v4 offset:9216
    v_fmac_f32 v119, v143, v129
    v_mfma_f32_16x16x32_bf16 v[84:87], v[28:31], a[36:39], v[84:87]
    v_mul_f32 v100, v100, v133
    v_mul_f32 v101, v101, v133
    v_mfma_f32_16x16x32_bf16 v[88:91], v[28:31], a[40:43], v[88:91]
    v_mul_f32 v102, v102, v133
    v_mul_f32 v103, v103, v133
    v_mfma_f32_16x16x32_bf16 v[92:95], v[28:31], a[44:47], v[92:95]
    v_mul_f32 v100, v100, v116
    v_mul_f32 v101, v101, v117
    s_waitcnt lgkmcnt(3)
    v_mfma_f32_16x16x32_bf16 v[64:67], v[8:11], a[48:51], v[64:67]
    ds_read_b128 v[24:27], v4 offset:10240
    v_mul_f32 v102, v102, v118
    v_mfma_f32_16x16x32_bf16 v[68:71], v[8:11], a[52:55], v[68:71]
    v_mul_f32 v103, v103, v119
    v_cvt_pk_bf16_f32 v182, v100, v101
    v_mfma_f32_16x16x32_bf16 v[72:75], v[8:11], a[56:59], v[72:75]
    v_cvt_pk_bf16_f32 v183, v102, v103
    buffer_store_dwordx4 v[180:183], v2, s[4:7], s66 offen offset:1024 sc1
    v_mfma_f32_16x16x32_bf16 v[76:79], v[8:11], a[60:63], v[76:79]
    v_fmac_f32 v104, v136, v130
    v_fmac_f32 v105, v137, v130
    s_waitcnt lgkmcnt(3)
    v_mfma_f32_16x16x32_bf16 v[80:83], v[12:15], a[48:51], v[80:83]
    ds_read_b128 v[28:31], v4 offset:11264
    v_fmac_f32 v106, v138, v130
    v_mfma_f32_16x16x32_bf16 v[84:87], v[12:15], a[52:55], v[84:87]
    v_fmac_f32 v107, v139, v130
    v_fmac_f32 v120, v140, v130
    v_mfma_f32_16x16x32_bf16 v[88:91], v[12:15], a[56:59], v[88:91]
    v_fmac_f32 v121, v141, v130
    v_fmac_f32 v122, v142, v130
    v_mfma_f32_16x16x32_bf16 v[92:95], v[12:15], a[60:63], v[92:95]
    v_fmac_f32 v123, v143, v130
    v_mul_f32 v104, v104, v134
    s_waitcnt lgkmcnt(3)
    v_mfma_f32_16x16x32_bf16 v[64:67], v[16:19], a[64:67], v[64:67]
    ds_read_b128 v[8:11], v4 offset:12288
    v_mul_f32 v105, v105, v134
    v_mfma_f32_16x16x32_bf16 v[68:71], v[16:19], a[68:71], v[68:71]
    v_mul_f32 v106, v106, v134
    v_mul_f32 v107, v107, v134
    v_mfma_f32_16x16x32_bf16 v[72:75], v[16:19], a[72:75], v[72:75]
    v_mul_f32 v104, v104, v120
    v_mul_f32 v105, v105, v121
    v_mfma_f32_16x16x32_bf16 v[76:79], v[16:19], a[76:79], v[76:79]
    v_mul_f32 v106, v106, v122
    v_mul_f32 v107, v107, v123
    s_waitcnt lgkmcnt(3)
    v_mfma_f32_16x16x32_bf16 v[80:83], v[20:23], a[64:67], v[80:83]
    ds_read_b128 v[12:15], v4 offset:13312
    v_cvt_pk_bf16_f32 v186, v104, v105
    v_mfma_f32_16x16x32_bf16 v[84:87], v[20:23], a[68:71], v[84:87]
    v_cvt_pk_bf16_f32 v187, v106, v107
    buffer_store_dwordx4 v[184:187], v2, s[4:7], s66 offen offset:2048 sc1
    v_mfma_f32_16x16x32_bf16 v[88:91], v[20:23], a[72:75], v[88:91]
    v_fmac_f32 v108, v136, v131
    v_fmac_f32 v109, v137, v131
    v_mfma_f32_16x16x32_bf16 v[92:95], v[20:23], a[76:79], v[92:95]
    v_fmac_f32 v110, v138, v131
    v_fmac_f32 v111, v139, v131
    s_waitcnt lgkmcnt(3)
    v_mfma_f32_16x16x32_bf16 v[64:67], v[24:27], a[80:83], v[64:67]
    ds_read_b128 v[16:19], v4 offset:14336
    v_fmac_f32 v124, v140, v131
    v_mfma_f32_16x16x32_bf16 v[68:71], v[24:27], a[84:87], v[68:71]
    v_fmac_f32 v125, v141, v131
    v_fmac_f32 v126, v142, v131
    v_mfma_f32_16x16x32_bf16 v[72:75], v[24:27], a[88:91], v[72:75]
    v_fmac_f32 v127, v143, v131
    v_mul_f32 v108, v108, v135
    v_mfma_f32_16x16x32_bf16 v[76:79], v[24:27], a[92:95], v[76:79]
    v_mul_f32 v109, v109, v135
    v_mul_f32 v110, v110, v135
    s_waitcnt lgkmcnt(3)
    v_mfma_f32_16x16x32_bf16 v[80:83], v[28:31], a[80:83], v[80:83]
    ds_read_b128 v[20:23], v4 offset:15360
    v_mul_f32 v111, v111, v135
    v_mfma_f32_16x16x32_bf16 v[84:87], v[28:31], a[84:87], v[84:87]
    v_mul_f32 v108, v108, v124
    v_mul_f32 v109, v109, v125
    v_mfma_f32_16x16x32_bf16 v[88:91], v[28:31], a[88:91], v[88:91]
    v_mul_f32 v110, v110, v126
    v_mul_f32 v111, v111, v127
    v_mfma_f32_16x16x32_bf16 v[92:95], v[28:31], a[92:95], v[92:95]
    v_cvt_pk_bf16_f32 v190, v108, v109
    v_cvt_pk_bf16_f32 v191, v110, v111
    s_waitcnt lgkmcnt(3)
    v_mfma_f32_16x16x32_bf16 v[64:67], v[8:11], a[96:99], v[64:67]
    ds_read_b128 v[24:27], v4 offset:16384
    buffer_store_dwordx4 v[188:191], v2, s[4:7], s66 offen offset:3072 sc1
    v_mfma_f32_16x16x32_bf16 v[68:71], v[8:11], a[100:103], v[68:71]
    v_mfma_f32_16x16x32_bf16 v[72:75], v[8:11], a[104:107], v[72:75]
    v_mfma_f32_16x16x32_bf16 v[76:79], v[8:11], a[108:111], v[76:79]
    s_waitcnt lgkmcnt(3)
    v_mfma_f32_16x16x32_bf16 v[80:83], v[12:15], a[96:99], v[80:83]
    ds_read_b128 v[28:31], v4 offset:17408
    v_mfma_f32_16x16x32_bf16 v[84:87], v[12:15], a[100:103], v[84:87]
    v_mfma_f32_16x16x32_bf16 v[88:91], v[12:15], a[104:107], v[88:91]
    v_mfma_f32_16x16x32_bf16 v[92:95], v[12:15], a[108:111], v[92:95]
    s_waitcnt lgkmcnt(3)
    v_mfma_f32_16x16x32_bf16 v[64:67], v[16:19], a[112:115], v[64:67]
    ds_read_b128 v[8:11], v4 offset:18432
    v_mfma_f32_16x16x32_bf16 v[68:71], v[16:19], a[116:119], v[68:71]
    v_mfma_f32_16x16x32_bf16 v[72:75], v[16:19], a[120:123], v[72:75]
    v_mfma_f32_16x16x32_bf16 v[76:79], v[16:19], a[124:127], v[76:79]
    s_waitcnt lgkmcnt(3)
    v_mfma_f32_16x16x32_bf16 v[80:83], v[20:23], a[112:115], v[80:83]
    ds_read_b128 v[12:15], v4 offset:19456
    v_mfma_f32_16x16x32_bf16 v[84:87], v[20:23], a[116:119], v[84:87]
    v_mfma_f32_16x16x32_bf16 v[88:91], v[20:23], a[120:123], v[88:91]
    v_mfma_f32_16x16x32_bf16 v[92:95], v[20:23], a[124:127], v[92:95]
    s_waitcnt lgkmcnt(3)
    v_mfma_f32_16x16x32_bf16 v[64:67], v[24:27], a[128:131], v[64:67]
    ds_read_b128 v[16:19], v4 offset:20480
    v_mfma_f32_16x16x32_bf16 v[68:71], v[24:27], a[132:135], v[68:71]
    v_mfma_f32_16x16x32_bf16 v[72:75], v[24:27], a[136:139], v[72:75]
    v_mfma_f32_16x16x32_bf16 v[76:79], v[24:27], a[140:143], v[76:79]
    s_waitcnt lgkmcnt(3)
    v_mfma_f32_16x16x32_bf16 v[80:83], v[28:31], a[128:131], v[80:83]
    ds_read_b128 v[20:23], v4 offset:21504
    v_mfma_f32_16x16x32_bf16 v[84:87], v[28:31], a[132:135], v[84:87]
    v_mfma_f32_16x16x32_bf16 v[88:91], v[28:31], a[136:139], v[88:91]
    v_mfma_f32_16x16x32_bf16 v[92:95], v[28:31], a[140:143], v[92:95]
    s_waitcnt lgkmcnt(3)
    v_mfma_f32_16x16x32_bf16 v[64:67], v[8:11], a[144:147], v[64:67]
    ds_read_b128 v[24:27], v4 offset:22528
    v_mfma_f32_16x16x32_bf16 v[68:71], v[8:11], a[148:151], v[68:71]
    v_mfma_f32_16x16x32_bf16 v[72:75], v[8:11], a[152:155], v[72:75]
    v_mfma_f32_16x16x32_bf16 v[76:79], v[8:11], a[156:159], v[76:79]
    s_waitcnt lgkmcnt(3)
    v_mfma_f32_16x16x32_bf16 v[80:83], v[12:15], a[144:147], v[80:83]
    ds_read_b128 v[28:31], v4 offset:23552
    v_mfma_f32_16x16x32_bf16 v[84:87], v[12:15], a[148:151], v[84:87]
    v_mfma_f32_16x16x32_bf16 v[88:91], v[12:15], a[152:155], v[88:91]
    v_mfma_f32_16x16x32_bf16 v[92:95], v[12:15], a[156:159], v[92:95]
    s_waitcnt lgkmcnt(3)
    v_mfma_f32_16x16x32_bf16 v[64:67], v[16:19], a[160:163], v[64:67]
    ds_read_b128 v[8:11], v4 offset:24576
    v_mfma_f32_16x16x32_bf16 v[68:71], v[16:19], a[164:167], v[68:71]
    v_mfma_f32_16x16x32_bf16 v[72:75], v[16:19], a[168:171], v[72:75]
    v_mfma_f32_16x16x32_bf16 v[76:79], v[16:19], a[172:175], v[76:79]
    s_waitcnt lgkmcnt(3)
    v_mfma_f32_16x16x32_bf16 v[80:83], v[20:23], a[160:163], v[80:83]
    ds_read_b128 v[12:15], v4 offset:25600
    v_mfma_f32_16x16x32_bf16 v[84:87], v[20:23], a[164:167], v[84:87]
    v_mfma_f32_16x16x32_bf16 v[88:91], v[20:23], a[168:171], v[88:91]
    v_mfma_f32_16x16x32_bf16 v[92:95], v[20:23], a[172:175], v[92:95]
    s_waitcnt lgkmcnt(3)
    v_mfma_f32_16x16x32_bf16 v[64:67], v[24:27], a[176:179], v[64:67]
    ds_read_b128 v[16:19], v4 offset:26624
    v_mfma_f32_16x16x32_bf16 v[68:71], v[24:27], a[180:183], v[68:71]
    v_mfma_f32_16x16x32_bf16 v[72:75], v[24:27], a[184:187], v[72:75]
    v_mfma_f32_16x16x32_bf16 v[76:79], v[24:27], a[188:191], v[76:79]
    s_waitcnt lgkmcnt(3)
    v_mfma_f32_16x16x32_bf16 v[80:83], v[28:31], a[176:179], v[80:83]
    ds_read_b128 v[20:23], v4 offset:27648
    v_mfma_f32_16x16x32_bf16 v[84:87], v[28:31], a[180:183], v[84:87]
    v_mfma_f32_16x16x32_bf16 v[88:91], v[28:31], a[184:187], v[88:91]
    v_mfma_f32_16x16x32_bf16 v[92:95], v[28:31], a[188:191], v[92:95]
    s_waitcnt lgkmcnt(3)
    v_mfma_f32_16x16x32_bf16 v[64:67], v[8:11], a[192:195], v[64:67]
    ds_read_b128 v[24:27], v4 offset:28672
    v_mfma_f32_16x16x32_bf16 v[68:71], v[8:11], a[196:199], v[68:71]
    v_mfma_f32_16x16x32_bf16 v[72:75], v[8:11], a[200:203], v[72:75]
    v_mfma_f32_16x16x32_bf16 v[76:79], v[8:11], a[204:207], v[76:79]
    s_waitcnt lgkmcnt(3)
    v_mfma_f32_16x16x32_bf16 v[80:83], v[12:15], a[192:195], v[80:83]
    ds_read_b128 v[28:31], v4 offset:29696
    v_mfma_f32_16x16x32_bf16 v[84:87], v[12:15], a[196:199], v[84:87]
    v_mfma_f32_16x16x32_bf16 v[88:91], v[12:15], a[200:203], v[88:91]
    v_mfma_f32_16x16x32_bf16 v[92:95], v[12:15], a[204:207], v[92:95]
    s_waitcnt lgkmcnt(3)
    v_mfma_f32_16x16x32_bf16 v[64:67], v[16:19], a[208:211], v[64:67]
    ds_read_b128 v[8:11], v4 offset:30720
    v_mfma_f32_16x16x32_bf16 v[68:71], v[16:19], a[212:215], v[68:71]
    v_mfma_f32_16x16x32_bf16 v[72:75], v[16:19], a[216:219], v[72:75]
    v_mfma_f32_16x16x32_bf16 v[76:79], v[16:19], a[220:223], v[76:79]
    s_waitcnt lgkmcnt(3)
    v_mfma_f32_16x16x32_bf16 v[80:83], v[20:23], a[208:211], v[80:83]
    ds_read_b128 v[12:15], v4 offset:31744
    v_mfma_f32_16x16x32_bf16 v[84:87], v[20:23], a[212:215], v[84:87]
    v_mfma_f32_16x16x32_bf16 v[88:91], v[20:23], a[216:219], v[88:91]
    v_mfma_f32_16x16x32_bf16 v[92:95], v[20:23], a[220:223], v[92:95]
    s_waitcnt lgkmcnt(3)
    v_mfma_f32_16x16x32_bf16 v[64:67], v[24:27], a[224:227], v[64:67]
    ds_read_b128 v[16:19], v4 offset:32768
    v_mfma_f32_16x16x32_bf16 v[68:71], v[24:27], a[228:231], v[68:71]
    v_mfma_f32_16x16x32_bf16 v[72:75], v[24:27], a[232:235], v[72:75]
    v_mfma_f32_16x16x32_bf16 v[76:79], v[24:27], a[236:239], v[76:79]
    s_waitcnt lgkmcnt(3)
    v_mfma_f32_16x16x32_bf16 v[80:83], v[28:31], a[224:227], v[80:83]
    ds_read_b128 v[20:23], v4 offset:33792
    v_mfma_f32_16x16x32_bf16 v[84:87], v[28:31], a[228:231], v[84:87]
    v_mfma_f32_16x16x32_bf16 v[88:91], v[28:31], a[232:235], v[88:91]
    v_mfma_f32_16x16x32_bf16 v[92:95], v[28:31], a[236:239], v[92:95]
    s_waitcnt lgkmcnt(3)
    v_mfma_f32_16x16x32_bf16 v[64:67], v[8:11], a[240:243], v[64:67]
    ds_read_b128 v[24:27], v4 offset:34816
    v_mfma_f32_16x16x32_bf16 v[68:71], v[8:11], a[244:247], v[68:71]
    v_mfma_f32_16x16x32_bf16 v[72:75], v[8:11], a[248:251], v[72:75]
    v_mfma_f32_16x16x32_bf16 v[76:79], v[8:11], a[252:255], v[76:79]
    ds_read_b128 v[144:147], v5 offset:384
    ds_read_b128 v[148:151], v5 offset:448
    s_waitcnt lgkmcnt(5)
    v_mfma_f32_16x16x32_bf16 v[80:83], v[12:15], a[240:243], v[80:83]
    ds_read_b128 v[28:31], v4 offset:35840
    v_mfma_f32_16x16x32_bf16 v[84:87], v[12:15], a[244:247], v[84:87]
    v_mfma_f32_16x16x32_bf16 v[88:91], v[12:15], a[248:251], v[88:91]
    v_mfma_f32_16x16x32_bf16 v[92:95], v[12:15], a[252:255], v[92:95]
    s_waitcnt lgkmcnt(5)
    v_mfma_f32_16x16x32_bf16 v[64:67], v[16:19], v[32:35], v[64:67]
    s_waitcnt vmcnt(17)
    s_barrier
    v_mfma_f32_16x16x32_bf16 v[68:71], v[16:19], v[36:39], v[68:71]
    v_add_u32 v4, 0xfffe5000, v4
    ds_read_b128 v[8:11], v4 offset:0
    v_mfma_f32_16x16x32_bf16 v[72:75], v[16:19], v[40:43], v[72:75]
    s_add_u32 m0, s49, 73728
    s_add_u32 s61, s48, 221184
    v_mfma_f32_16x16x32_bf16 v[76:79], v[16:19], v[44:47], v[76:79]
    buffer_load_dwordx4 v2, s[4:7], s61 offen offset:0 lds
    s_waitcnt lgkmcnt(5)
    v_mfma_f32_16x16x32_bf16 v[80:83], v[20:23], v[32:35], v[80:83]
    ds_read_b128 v[12:15], v4 offset:1024
    v_mfma_f32_16x16x32_bf16 v[84:87], v[20:23], v[36:39], v[84:87]
    v_mfma_f32_16x16x32_bf16 v[88:91], v[20:23], v[40:43], v[88:91]
    v_mfma_f32_16x16x32_bf16 v[92:95], v[20:23], v[44:47], v[92:95]
    buffer_load_dwordx4 v2, s[4:7], s61 offen offset:1024 lds
    s_waitcnt lgkmcnt(5)
    v_mfma_f32_16x16x32_bf16 v[64:67], v[24:27], v[48:51], v[64:67]
    ds_read_b128 v[16:19], v4 offset:2048
    v_mfma_f32_16x16x32_bf16 v[68:71], v[24:27], v[52:55], v[68:71]
    v_mfma_f32_16x16x32_bf16 v[72:75], v[24:27], v[56:59], v[72:75]
    v_mfma_f32_16x16x32_bf16 v[76:79], v[24:27], v[60:63], v[76:79]
    buffer_load_dwordx4 v2, s[4:7], s61 offen offset:2048 lds
    s_waitcnt lgkmcnt(3)
    v_mfma_f32_16x16x32_bf16 v[80:83], v[28:31], v[48:51], v[80:83]
    ds_read_b128 v[20:23], v4 offset:3072
    v_mfma_f32_16x16x32_bf16 v[84:87], v[28:31], v[52:55], v[84:87]
    v_mfma_f32_16x16x32_bf16 v[88:91], v[28:31], v[56:59], v[88:91]
    v_mfma_f32_16x16x32_bf16 v[92:95], v[28:31], v[60:63], v[92:95]
    buffer_load_dwordx4 v2, s[4:7], s61 offen offset:3072 lds
    s_add_u32 m0, s49, 77824
    s_waitcnt lgkmcnt(3)
    v_mfma_f32_16x16x32_bf16 v[96:99], v[8:11], a[0:3], 0
    ds_read_b128 v[24:27], v4 offset:4096
    s_add_u32 s61, s48, 225280
    v_mfma_f32_16x16x32_bf16 v[100:103], v[8:11], a[4:7], 0
    v_mfma_f32_16x16x32_bf16 v[104:107], v[8:11], a[8:11], 0
    v_mfma_f32_16x16x32_bf16 v[108:111], v[8:11], a[12:15], 0
    buffer_load_dwordx4 v2, s[4:7], s61 offen offset:0 lds
    s_waitcnt lgkmcnt(3)
    v_mfma_f32_16x16x32_bf16 v[112:115], v[12:15], a[0:3], 0
    ds_read_b128 v[28:31], v4 offset:5120
    v_mfma_f32_16x16x32_bf16 v[116:119], v[12:15], a[4:7], 0
    v_fmac_f32 v64, v144, v128
    v_fmac_f32 v65, v145, v128
    v_mfma_f32_16x16x32_bf16 v[120:123], v[12:15], a[8:11], 0
    v_fmac_f32 v66, v146, v128
    v_fmac_f32 v67, v147, v128
    v_mfma_f32_16x16x32_bf16 v[124:127], v[12:15], a[12:15], 0
    buffer_load_dwordx4 v2, s[4:7], s61 offen offset:1024 lds
    v_fmac_f32 v80, v148, v128
    s_waitcnt lgkmcnt(3)
    v_mfma_f32_16x16x32_bf16 v[96:99], v[16:19], a[16:19], v[96:99]
    ds_read_b128 v[8:11], v4 offset:6144
    v_fmac_f32 v81, v149, v128
    v_mfma_f32_16x16x32_bf16 v[100:103], v[16:19], a[20:23], v[100:103]
    v_fmac_f32 v82, v150, v128
    v_fmac_f32 v83, v151, v128
    v_mfma_f32_16x16x32_bf16 v[104:107], v[16:19], a[24:27], v[104:107]
    v_mul_f32 v64, v64, v132
    v_mul_f32 v65, v65, v132
    v_mfma_f32_16x16x32_bf16 v[108:111], v[16:19], a[28:31], v[108:111]
    buffer_load_dwordx4 v2, s[4:7], s61 offen offset:2048 lds
    v_mul_f32 v66, v66, v132
    s_waitcnt lgkmcnt(3)
    v_mfma_f32_16x16x32_bf16 v[112:115], v[20:23], a[16:19], v[112:115]
    ds_read_b128 v[12:15], v4 offset:7168
    v_mul_f32 v67, v67, v132
    v_mfma_f32_16x16x32_bf16 v[116:119], v[20:23], a[20:23], v[116:119]
    v_mul_f32 v64, v64, v80
    v_mul_f32 v65, v65, v81
    v_mfma_f32_16x16x32_bf16 v[120:123], v[20:23], a[24:27], v[120:123]
    v_mul_f32 v66, v66, v82
    v_mul_f32 v67, v67, v83
    v_mfma_f32_16x16x32_bf16 v[124:127], v[20:23], a[28:31], v[124:127]
    buffer_load_dwordx4 v2, s[4:7], s61 offen offset:3072 lds
    s_add_u32 m0, s49, 81920
    s_waitcnt lgkmcnt(3)
    v_mfma_f32_16x16x32_bf16 v[96:99], v[24:27], a[32:35], v[96:99]
    ds_read_b128 v[16:19], v4 offset:8192
    s_add_u32 s61, s48, 229376
    v_mfma_f32_16x16x32_bf16 v[100:103], v[24:27], a[36:39], v[100:103]
    v_cvt_pk_bf16_f32 v192, v64, v65
    v_cvt_pk_bf16_f32 v193, v66, v67
    v_mfma_f32_16x16x32_bf16 v[104:107], v[24:27], a[40:43], v[104:107]
    v_fmac_f32 v68, v144, v129
    v_fmac_f32 v69, v145, v129
    v_mfma_f32_16x16x32_bf16 v[108:111], v[24:27], a[44:47], v[108:111]
    buffer_load_dwordx4 v2, s[4:7], s61 offen offset:0 lds
    v_fmac_f32 v70, v146, v129
    s_waitcnt lgkmcnt(3)
    v_mfma_f32_16x16x32_bf16 v[112:115], v[28:31], a[32:35], v[112:115]
    ds_read_b128 v[20:23], v4 offset:9216
    v_fmac_f32 v71, v147, v129
    v_mfma_f32_16x16x32_bf16 v[116:119], v[28:31], a[36:39], v[116:119]
    v_fmac_f32 v84, v148, v129
    v_fmac_f32 v85, v149, v129
    v_mfma_f32_16x16x32_bf16 v[120:123], v[28:31], a[40:43], v[120:123]
    v_fmac_f32 v86, v150, v129
    v_fmac_f32 v87, v151, v129
    v_mfma_f32_16x16x32_bf16 v[124:127], v[28:31], a[44:47], v[124:127]
    v_mul_f32 v68, v68, v133
    v_mul_f32 v69, v69, v133
    s_waitcnt lgkmcnt(3)
    v_mfma_f32_16x16x32_bf16 v[96:99], v[8:11], a[48:51], v[96:99]
    ds_read_b128 v[24:27], v4 offset:10240
    v_mul_f32 v70, v70, v133
    v_mfma_f32_16x16x32_bf16 v[100:103], v[8:11], a[52:55], v[100:103]
    v_mul_f32 v71, v71, v133
    v_mul_f32 v68, v68, v84
    v_mfma_f32_16x16x32_bf16 v[104:107], v[8:11], a[56:59], v[104:107]
    v_mul_f32 v69, v69, v85
    v_mul_f32 v70, v70, v86
    v_mfma_f32_16x16x32_bf16 v[108:111], v[8:11], a[60:63], v[108:111]
    v_mul_f32 v71, v71, v87
    v_cvt_pk_bf16_f32 v196, v68, v69
    s_waitcnt lgkmcnt(3)
    v_mfma_f32_16x16x32_bf16 v[112:115], v[12:15], a[48:51], v[112:115]
    ds_read_b128 v[28:31], v4 offset:11264
    v_cvt_pk_bf16_f32 v197, v70, v71
    v_mfma_f32_16x16x32_bf16 v[116:119], v[12:15], a[52:55], v[116:119]
    v_fmac_f32 v72, v144, v130
    v_fmac_f32 v73, v145, v130
    v_mfma_f32_16x16x32_bf16 v[120:123], v[12:15], a[56:59], v[120:123]
    v_fmac_f32 v74, v146, v130
    v_fmac_f32 v75, v147, v130
    v_mfma_f32_16x16x32_bf16 v[124:127], v[12:15], a[60:63], v[124:127]
    v_fmac_f32 v88, v148, v130
    v_fmac_f32 v89, v149, v130
    s_waitcnt lgkmcnt(3)
    v_mfma_f32_16x16x32_bf16 v[96:99], v[16:19], a[64:67], v[96:99]
    ds_read_b128 v[8:11], v4 offset:12288
    v_fmac_f32 v90, v150, v130
    v_mfma_f32_16x16x32_bf16 v[100:103], v[16:19], a[68:71], v[100:103]
    v_fmac_f32 v91, v151, v130
    v_mul_f32 v72, v72, v134
    v_mfma_f32_16x16x32_bf16 v[104:107], v[16:19], a[72:75], v[104:107]
    v_mul_f32 v73, v73, v134
    v_mul_f32 v74, v74, v134
    v_mfma_f32_16x16x32_bf16 v[108:111], v[16:19], a[76:79], v[108:111]
    v_mul_f32 v75, v75, v134
    v_mul_f32 v72, v72, v88
    s_waitcnt lgkmcnt(3)
    v_mfma_f32_16x16x32_bf16 v[112:115], v[20:23], a[64:67], v[112:115]
    ds_read_b128 v[12:15], v4 offset:13312
    v_mul_f32 v73, v73, v89
    v_mfma_f32_16x16x32_bf16 v[116:119], v[20:23], a[68:71], v[116:119]
    v_mul_f32 v74, v74, v90
    v_mul_f32 v75, v75, v91
    v_mfma_f32_16x16x32_bf16 v[120:123], v[20:23], a[72:75], v[120:123]
    v_cvt_pk_bf16_f32 v200, v72, v73
    v_cvt_pk_bf16_f32 v201, v74, v75
    v_mfma_f32_16x16x32_bf16 v[124:127], v[20:23], a[76:79], v[124:127]
    v_fmac_f32 v76, v144, v131
    v_fmac_f32 v77, v145, v131
    s_waitcnt lgkmcnt(3)
    v_mfma_f32_16x16x32_bf16 v[96:99], v[24:27], a[80:83], v[96:99]
    ds_read_b128 v[16:19], v4 offset:14336
    v_fmac_f32 v78, v146, v131
    v_mfma_f32_16x16x32_bf16 v[100:103], v[24:27], a[84:87], v[100:103]
    v_fmac_f32 v79, v147, v131
    v_fmac_f32 v92, v148, v131
    v_mfma_f32_16x16x32_bf16 v[104:107], v[24:27], a[88:91], v[104:107]
    v_fmac_f32 v93, v149, v131
    v_fmac_f32 v94, v150, v131
    v_mfma_f32_16x16x32_bf16 v[108:111], v[24:27], a[92:95], v[108:111]
    v_fmac_f32 v95, v151, v131
    v_mul_f32 v76, v76, v135
    s_waitcnt lgkmcnt(3)
    v_mfma_f32_16x16x32_bf16 v[112:115], v[28:31], a[80:83], v[112:115]
    ds_read_b128 v[20:23], v4 offset:15360
    v_mul_f32 v77, v77, v135
    v_mfma_f32_16x16x32_bf16 v[116:119], v[28:31], a[84:87], v[116:119]
    v_mul_f32 v78, v78, v135
    v_mul_f32 v79, v79, v135
    v_mfma_f32_16x16x32_bf16 v[120:123], v[28:31], a[88:91], v[120:123]
    v_mul_f32 v76, v76, v92
    v_mul_f32 v77, v77, v93
    v_mfma_f32_16x16x32_bf16 v[124:127], v[28:31], a[92:95], v[124:127]
    v_mul_f32 v78, v78, v94
    v_mul_f32 v79, v79, v95
    s_waitcnt lgkmcnt(3)
    v_mfma_f32_16x16x32_bf16 v[96:99], v[8:11], a[96:99], v[96:99]
    ds_read_b128 v[24:27], v4 offset:16384
    v_cvt_pk_bf16_f32 v204, v76, v77
    v_mfma_f32_16x16x32_bf16 v[100:103], v[8:11], a[100:103], v[100:103]
    v_cvt_pk_bf16_f32 v205, v78, v79
    v_mfma_f32_16x16x32_bf16 v[104:107], v[8:11], a[104:107], v[104:107]
    v_mfma_f32_16x16x32_bf16 v[108:111], v[8:11], a[108:111], v[108:111]
    s_waitcnt lgkmcnt(3)
    v_mfma_f32_16x16x32_bf16 v[112:115], v[12:15], a[96:99], v[112:115]
    ds_read_b128 v[28:31], v4 offset:17408
    v_mfma_f32_16x16x32_bf16 v[116:119], v[12:15], a[100:103], v[116:119]
    v_mfma_f32_16x16x32_bf16 v[120:123], v[12:15], a[104:107], v[120:123]
    v_mfma_f32_16x16x32_bf16 v[124:127], v[12:15], a[108:111], v[124:127]
    s_waitcnt lgkmcnt(3)
    v_mfma_f32_16x16x32_bf16 v[96:99], v[16:19], a[112:115], v[96:99]
    ds_read_b128 v[8:11], v4 offset:18432
    v_mfma_f32_16x16x32_bf16 v[100:103], v[16:19], a[116:119], v[100:103]
    v_mfma_f32_16x16x32_bf16 v[104:107], v[16:19], a[120:123], v[104:107]
    v_mfma_f32_16x16x32_bf16 v[108:111], v[16:19], a[124:127], v[108:111]
    s_waitcnt lgkmcnt(3)
    v_mfma_f32_16x16x32_bf16 v[112:115], v[20:23], a[112:115], v[112:115]
    ds_read_b128 v[12:15], v4 offset:19456
    v_mfma_f32_16x16x32_bf16 v[116:119], v[20:23], a[116:119], v[116:119]
    v_mfma_f32_16x16x32_bf16 v[120:123], v[20:23], a[120:123], v[120:123]
    v_mfma_f32_16x16x32_bf16 v[124:127], v[20:23], a[124:127], v[124:127]
    s_waitcnt lgkmcnt(3)
    v_mfma_f32_16x16x32_bf16 v[96:99], v[24:27], a[128:131], v[96:99]
    ds_read_b128 v[16:19], v4 offset:20480
    v_mfma_f32_16x16x32_bf16 v[100:103], v[24:27], a[132:135], v[100:103]
    v_mfma_f32_16x16x32_bf16 v[104:107], v[24:27], a[136:139], v[104:107]
    v_mfma_f32_16x16x32_bf16 v[108:111], v[24:27], a[140:143], v[108:111]
    s_waitcnt lgkmcnt(3)
    v_mfma_f32_16x16x32_bf16 v[112:115], v[28:31], a[128:131], v[112:115]
    ds_read_b128 v[20:23], v4 offset:21504
    v_mfma_f32_16x16x32_bf16 v[116:119], v[28:31], a[132:135], v[116:119]
    v_mfma_f32_16x16x32_bf16 v[120:123], v[28:31], a[136:139], v[120:123]
    v_mfma_f32_16x16x32_bf16 v[124:127], v[28:31], a[140:143], v[124:127]
    s_waitcnt lgkmcnt(3)
    v_mfma_f32_16x16x32_bf16 v[96:99], v[8:11], a[144:147], v[96:99]
    ds_read_b128 v[24:27], v4 offset:22528
    v_mfma_f32_16x16x32_bf16 v[100:103], v[8:11], a[148:151], v[100:103]
    v_mfma_f32_16x16x32_bf16 v[104:107], v[8:11], a[152:155], v[104:107]
    v_mfma_f32_16x16x32_bf16 v[108:111], v[8:11], a[156:159], v[108:111]
    s_waitcnt lgkmcnt(3)
    v_mfma_f32_16x16x32_bf16 v[112:115], v[12:15], a[144:147], v[112:115]
    ds_read_b128 v[28:31], v4 offset:23552
    v_mfma_f32_16x16x32_bf16 v[116:119], v[12:15], a[148:151], v[116:119]
    v_mfma_f32_16x16x32_bf16 v[120:123], v[12:15], a[152:155], v[120:123]
    v_mfma_f32_16x16x32_bf16 v[124:127], v[12:15], a[156:159], v[124:127]
    s_waitcnt lgkmcnt(3)
    v_mfma_f32_16x16x32_bf16 v[96:99], v[16:19], a[160:163], v[96:99]
    ds_read_b128 v[8:11], v4 offset:24576
    v_mfma_f32_16x16x32_bf16 v[100:103], v[16:19], a[164:167], v[100:103]
    v_mfma_f32_16x16x32_bf16 v[104:107], v[16:19], a[168:171], v[104:107]
    v_mfma_f32_16x16x32_bf16 v[108:111], v[16:19], a[172:175], v[108:111]
    s_waitcnt lgkmcnt(3)
    v_mfma_f32_16x16x32_bf16 v[112:115], v[20:23], a[160:163], v[112:115]
    ds_read_b128 v[12:15], v4 offset:25600
    v_mfma_f32_16x16x32_bf16 v[116:119], v[20:23], a[164:167], v[116:119]
    v_mfma_f32_16x16x32_bf16 v[120:123], v[20:23], a[168:171], v[120:123]
    v_mfma_f32_16x16x32_bf16 v[124:127], v[20:23], a[172:175], v[124:127]
    s_waitcnt lgkmcnt(3)
    v_mfma_f32_16x16x32_bf16 v[96:99], v[24:27], a[176:179], v[96:99]
    ds_read_b128 v[16:19], v4 offset:26624
    v_mfma_f32_16x16x32_bf16 v[100:103], v[24:27], a[180:183], v[100:103]
    v_mfma_f32_16x16x32_bf16 v[104:107], v[24:27], a[184:187], v[104:107]
    v_mfma_f32_16x16x32_bf16 v[108:111], v[24:27], a[188:191], v[108:111]
    s_waitcnt lgkmcnt(3)
    v_mfma_f32_16x16x32_bf16 v[112:115], v[28:31], a[176:179], v[112:115]
    ds_read_b128 v[20:23], v4 offset:27648
    v_mfma_f32_16x16x32_bf16 v[116:119], v[28:31], a[180:183], v[116:119]
    v_mfma_f32_16x16x32_bf16 v[120:123], v[28:31], a[184:187], v[120:123]
    v_mfma_f32_16x16x32_bf16 v[124:127], v[28:31], a[188:191], v[124:127]
    s_waitcnt lgkmcnt(3)
    v_mfma_f32_16x16x32_bf16 v[96:99], v[8:11], a[192:195], v[96:99]
    ds_read_b128 v[24:27], v4 offset:28672
    v_mfma_f32_16x16x32_bf16 v[100:103], v[8:11], a[196:199], v[100:103]
    v_mfma_f32_16x16x32_bf16 v[104:107], v[8:11], a[200:203], v[104:107]
    v_mfma_f32_16x16x32_bf16 v[108:111], v[8:11], a[204:207], v[108:111]
    s_waitcnt lgkmcnt(3)
    v_mfma_f32_16x16x32_bf16 v[112:115], v[12:15], a[192:195], v[112:115]
    ds_read_b128 v[28:31], v4 offset:29696
    v_mfma_f32_16x16x32_bf16 v[116:119], v[12:15], a[196:199], v[116:119]
    v_mfma_f32_16x16x32_bf16 v[120:123], v[12:15], a[200:203], v[120:123]
    v_mfma_f32_16x16x32_bf16 v[124:127], v[12:15], a[204:207], v[124:127]
    s_waitcnt lgkmcnt(3)
    v_mfma_f32_16x16x32_bf16 v[96:99], v[16:19], a[208:211], v[96:99]
    ds_read_b128 v[8:11], v4 offset:30720
    v_mfma_f32_16x16x32_bf16 v[100:103], v[16:19], a[212:215], v[100:103]
    v_mfma_f32_16x16x32_bf16 v[104:107], v[16:19], a[216:219], v[104:107]
    v_mfma_f32_16x16x32_bf16 v[108:111], v[16:19], a[220:223], v[108:111]
    s_waitcnt lgkmcnt(3)
    v_mfma_f32_16x16x32_bf16 v[112:115], v[20:23], a[208:211], v[112:115]
    ds_read_b128 v[12:15], v4 offset:31744
    v_mfma_f32_16x16x32_bf16 v[116:119], v[20:23], a[212:215], v[116:119]
    v_mfma_f32_16x16x32_bf16 v[120:123], v[20:23], a[216:219], v[120:123]
    v_mfma_f32_16x16x32_bf16 v[124:127], v[20:23], a[220:223], v[124:127]
    s_waitcnt lgkmcnt(3)
    v_mfma_f32_16x16x32_bf16 v[96:99], v[24:27], a[224:227], v[96:99]
    ds_read_b128 v[16:19], v4 offset:32768
    v_mfma_f32_16x16x32_bf16 v[100:103], v[24:27], a[228:231], v[100:103]
    v_mfma_f32_16x16x32_bf16 v[104:107], v[24:27], a[232:235], v[104:107]
    v_mfma_f32_16x16x32_bf16 v[108:111], v[24:27], a[236:239], v[108:111]
    s_waitcnt lgkmcnt(3)
    v_mfma_f32_16x16x32_bf16 v[112:115], v[28:31], a[224:227], v[112:115]
    ds_read_b128 v[20:23], v4 offset:33792
    v_mfma_f32_16x16x32_bf16 v[116:119], v[28:31], a[228:231], v[116:119]
    v_mfma_f32_16x16x32_bf16 v[120:123], v[28:31], a[232:235], v[120:123]
    v_mfma_f32_16x16x32_bf16 v[124:127], v[28:31], a[236:239], v[124:127]
    s_waitcnt lgkmcnt(3)
    v_mfma_f32_16x16x32_bf16 v[96:99], v[8:11], a[240:243], v[96:99]
    ds_read_b128 v[24:27], v4 offset:34816
    v_mfma_f32_16x16x32_bf16 v[100:103], v[8:11], a[244:247], v[100:103]
    v_mfma_f32_16x16x32_bf16 v[104:107], v[8:11], a[248:251], v[104:107]
    v_mfma_f32_16x16x32_bf16 v[108:111], v[8:11], a[252:255], v[108:111]
    ds_read_b128 v[136:139], v5 offset:512
    ds_read_b128 v[140:143], v5 offset:576
    s_waitcnt lgkmcnt(5)
    v_mfma_f32_16x16x32_bf16 v[112:115], v[12:15], a[240:243], v[112:115]
    ds_read_b128 v[28:31], v4 offset:35840
    v_mfma_f32_16x16x32_bf16 v[116:119], v[12:15], a[244:247], v[116:119]
    v_mfma_f32_16x16x32_bf16 v[120:123], v[12:15], a[248:251], v[120:123]
    v_mfma_f32_16x16x32_bf16 v[124:127], v[12:15], a[252:255], v[124:127]
    s_waitcnt lgkmcnt(5)
    v_mfma_f32_16x16x32_bf16 v[96:99], v[16:19], v[32:35], v[96:99]
    s_waitcnt vmcnt(17)
    s_barrier
    v_mfma_f32_16x16x32_bf16 v[100:103], v[16:19], v[36:39], v[100:103]
    v_add_u32 v4, 0x9000, v4
    ds_read_b128 v[8:11], v4 offset:0
    v_mfma_f32_16x16x32_bf16 v[104:107], v[16:19], v[40:43], v[104:107]
    s_add_u32 m0, s49, 110592
    s_add_u32 s61, s48, 258048
    v_mfma_f32_16x16x32_bf16 v[108:111], v[16:19], v[44:47], v[108:111]
    buffer_load_dwordx4 v2, s[4:7], s61 offen offset:0 lds
    s_waitcnt lgkmcnt(5)
    v_mfma_f32_16x16x32_bf16 v[112:115], v[20:23], v[32:35], v[112:115]
    ds_read_b128 v[12:15], v4 offset:1024
    v_mfma_f32_16x16x32_bf16 v[116:119], v[20:23], v[36:39], v[116:119]
    v_mfma_f32_16x16x32_bf16 v[120:123], v[20:23], v[40:43], v[120:123]
    v_mfma_f32_16x16x32_bf16 v[124:127], v[20:23], v[44:47], v[124:127]
    buffer_load_dwordx4 v2, s[4:7], s61 offen offset:1024 lds
    s_waitcnt lgkmcnt(5)
    v_mfma_f32_16x16x32_bf16 v[96:99], v[24:27], v[48:51], v[96:99]
    ds_read_b128 v[16:19], v4 offset:2048
    v_mfma_f32_16x16x32_bf16 v[100:103], v[24:27], v[52:55], v[100:103]
    v_mfma_f32_16x16x32_bf16 v[104:107], v[24:27], v[56:59], v[104:107]
    v_mfma_f32_16x16x32_bf16 v[108:111], v[24:27], v[60:63], v[108:111]
    buffer_load_dwordx4 v2, s[4:7], s61 offen offset:2048 lds
    s_waitcnt lgkmcnt(3)
    v_mfma_f32_16x16x32_bf16 v[112:115], v[28:31], v[48:51], v[112:115]
    ds_read_b128 v[20:23], v4 offset:3072
    v_mfma_f32_16x16x32_bf16 v[116:119], v[28:31], v[52:55], v[116:119]
    v_mfma_f32_16x16x32_bf16 v[120:123], v[28:31], v[56:59], v[120:123]
    v_mfma_f32_16x16x32_bf16 v[124:127], v[28:31], v[60:63], v[124:127]
    buffer_load_dwordx4 v2, s[4:7], s61 offen offset:3072 lds
    s_add_u32 m0, s49, 114688
    s_waitcnt lgkmcnt(3)
    v_mfma_f32_16x16x32_bf16 v[64:67], v[8:11], a[0:3], 0
    ds_read_b128 v[24:27], v4 offset:4096
    s_add_u32 s61, s48, 262144
    v_mfma_f32_16x16x32_bf16 v[68:71], v[8:11], a[4:7], 0
    v_mfma_f32_16x16x32_bf16 v[72:75], v[8:11], a[8:11], 0
    v_mfma_f32_16x16x32_bf16 v[76:79], v[8:11], a[12:15], 0
    buffer_load_dwordx4 v2, s[4:7], s61 offen offset:0 lds
    s_waitcnt lgkmcnt(3)
    v_mfma_f32_16x16x32_bf16 v[80:83], v[12:15], a[0:3], 0
    ds_read_b128 v[28:31], v4 offset:5120
    v_mfma_f32_16x16x32_bf16 v[84:87], v[12:15], a[4:7], 0
    v_fmac_f32 v96, v136, v128
    v_fmac_f32 v97, v137, v128
    v_mfma_f32_16x16x32_bf16 v[88:91], v[12:15], a[8:11], 0
    v_fmac_f32 v98, v138, v128
    v_fmac_f32 v99, v139, v128
    v_mfma_f32_16x16x32_bf16 v[92:95], v[12:15], a[12:15], 0
    buffer_load_dwordx4 v2, s[4:7], s61 offen offset:1024 lds
    v_fmac_f32 v112, v140, v128
    s_waitcnt lgkmcnt(3)
    v_mfma_f32_16x16x32_bf16 v[64:67], v[16:19], a[16:19], v[64:67]
    ds_read_b128 v[8:11], v4 offset:6144
    v_fmac_f32 v113, v141, v128
    v_mfma_f32_16x16x32_bf16 v[68:71], v[16:19], a[20:23], v[68:71]
    v_fmac_f32 v114, v142, v128
    v_fmac_f32 v115, v143, v128
    v_mfma_f32_16x16x32_bf16 v[72:75], v[16:19], a[24:27], v[72:75]
    v_mul_f32 v96, v96, v132
    v_mul_f32 v97, v97, v132
    v_mfma_f32_16x16x32_bf16 v[76:79], v[16:19], a[28:31], v[76:79]
    buffer_load_dwordx4 v2, s[4:7], s61 offen offset:2048 lds
    v_mul_f32 v98, v98, v132
    s_waitcnt lgkmcnt(3)
    v_mfma_f32_16x16x32_bf16 v[80:83], v[20:23], a[16:19], v[80:83]
    ds_read_b128 v[12:15], v4 offset:7168
    v_mul_f32 v99, v99, v132
    v_mfma_f32_16x16x32_bf16 v[84:87], v[20:23], a[20:23], v[84:87]
    v_mul_f32 v96, v96, v112
    v_mul_f32 v97, v97, v113
    v_mfma_f32_16x16x32_bf16 v[88:91], v[20:23], a[24:27], v[88:91]
    v_mul_f32 v98, v98, v114
    v_mul_f32 v99, v99, v115
    v_mfma_f32_16x16x32_bf16 v[92:95], v[20:23], a[28:31], v[92:95]
    buffer_load_dwordx4 v2, s[4:7], s61 offen offset:3072 lds
    s_add_u32 m0, s49, 118784
    s_waitcnt lgkmcnt(3)
    v_mfma_f32_16x16x32_bf16 v[64:67], v[24:27], a[32:35], v[64:67]
    ds_read_b128 v[16:19], v4 offset:8192
    s_add_u32 s61, s48, 266240
    v_mfma_f32_16x16x32_bf16 v[68:71], v[24:27], a[36:39], v[68:71]
    v_cvt_pk_bf16_f32 v194, v96, v97
    v_cvt_pk_bf16_f32 v195, v98, v99
    v_mfma_f32_16x16x32_bf16 v[72:75], v[24:27], a[40:43], v[72:75]
    s_add_u32 s66, s51, 16384
    v_mfma_f32_16x16x32_bf16 v[76:79], v[24:27], a[44:47], v[76:79]
    buffer_load_dwordx4 v2, s[4:7], s61 offen offset:0 lds
    s_waitcnt lgkmcnt(3)
    v_mfma_f32_16x16x32_bf16 v[80:83], v[28:31], a[32:35], v[80:83]
    ds_read_b128 v[20:23], v4 offset:9216
    v_mfma_f32_16x16x32_bf16 v[84:87], v[28:31], a[36:39], v[84:87]
    v_mfma_f32_16x16x32_bf16 v[88:91], v[28:31], a[40:43], v[88:91]
    v_mfma_f32_16x16x32_bf16 v[92:95], v[28:31], a[44:47], v[92:95]
    buffer_store_dwordx4 v[192:195], v2, s[4:7], s66 offen offset:0 sc1
    v_fmac_f32 v100, v136, v129
    s_waitcnt lgkmcnt(3)
    v_mfma_f32_16x16x32_bf16 v[64:67], v[8:11], a[48:51], v[64:67]
    ds_read_b128 v[24:27], v4 offset:10240
    v_fmac_f32 v101, v137, v129
    v_mfma_f32_16x16x32_bf16 v[68:71], v[8:11], a[52:55], v[68:71]
    v_fmac_f32 v102, v138, v129
    v_fmac_f32 v103, v139, v129
    v_mfma_f32_16x16x32_bf16 v[72:75], v[8:11], a[56:59], v[72:75]
    v_fmac_f32 v116, v140, v129
    v_fmac_f32 v117, v141, v129
    v_mfma_f32_16x16x32_bf16 v[76:79], v[8:11], a[60:63], v[76:79]
    v_fmac_f32 v118, v142, v129
    v_fmac_f32 v119, v143, v129
    s_waitcnt lgkmcnt(3)
    v_mfma_f32_16x16x32_bf16 v[80:83], v[12:15], a[48:51], v[80:83]
    ds_read_b128 v[28:31], v4 offset:11264
    v_mul_f32 v100, v100, v133
    v_mfma_f32_16x16x32_bf16 v[84:87], v[12:15], a[52:55], v[84:87]
    v_mul_f32 v101, v101, v133
    v_mul_f32 v102, v102, v133
    v_mfma_f32_16x16x32_bf16 v[88:91], v[12:15], a[56:59], v[88:91]
    v_mul_f32 v103, v103, v133
    v_mul_f32 v100, v100, v116
    v_mfma_f32_16x16x32_bf16 v[92:95], v[12:15], a[60:63], v[92:95]
    v_mul_f32 v101, v101, v117
    v_mul_f32 v102, v102, v118
    s_waitcnt lgkmcnt(3)
    v_mfma_f32_16x16x32_bf16 v[64:67], v[16:19], a[64:67], v[64:67]
    ds_read_b128 v[8:11], v4 offset:12288
    v_mul_f32 v103, v103, v119
    v_mfma_f32_16x16x32_bf16 v[68:71], v[16:19], a[68:71], v[68:71]
    v_cvt_pk_bf16_f32 v198, v100, v101
    v_cvt_pk_bf16_f32 v199, v102, v103
    v_mfma_f32_16x16x32_bf16 v[72:75], v[16:19], a[72:75], v[72:75]
    buffer_store_dwordx4 v[196:199], v2, s[4:7], s66 offen offset:1024 sc1
    v_fmac_f32 v104, v136, v130
    v_mfma_f32_16x16x32_bf16 v[76:79], v[16:19], a[76:79], v[76:79]
    v_fmac_f32 v105, v137, v130
    v_fmac_f32 v106, v138, v130
    s_waitcnt lgkmcnt(3)
    v_mfma_f32_16x16x32_bf16 v[80:83], v[20:23], a[64:67], v[80:83]
    ds_read_b128 v[12:15], v4 offset:13312
    v_fmac_f32 v107, v139, v130
    v_mfma_f32_16x16x32_bf16 v[84:87], v[20:23], a[68:71], v[84:87]
    v_fmac_f32 v120, v140, v130
    v_fmac_f32 v121, v141, v130
    v_mfma_f32_16x16x32_bf16 v[88:91], v[20:23], a[72:75], v[88:91]
    v_fmac_f32 v122, v142, v130
    v_fmac_f32 v123, v143, v130
    v_mfma_f32_16x16x32_bf16 v[92:95], v[20:23], a[76:79], v[92:95]
    v_mul_f32 v104, v104, v134
    v_mul_f32 v105, v105, v134
    s_waitcnt lgkmcnt(3)
    v_mfma_f32_16x16x32_bf16 v[64:67], v[24:27], a[80:83], v[64:67]
    ds_read_b128 v[16:19], v4 offset:14336
    v_mul_f32 v106, v106, v134
    v_mfma_f32_16x16x32_bf16 v[68:71], v[24:27], a[84:87], v[68:71]
    v_mul_f32 v107, v107, v134
    v_mul_f32 v104, v104, v120
    v_mfma_f32_16x16x32_bf16 v[72:75], v[24:27], a[88:91], v[72:75]
    v_mul_f32 v105, v105, v121
    v_mul_f32 v106, v106, v122
    v_mfma_f32_16x16x32_bf16 v[76:79], v[24:27], a[92:95], v[76:79]
    v_mul_f32 v107, v107, v123
    v_cvt_pk_bf16_f32 v202, v104, v105
    s_waitcnt lgkmcnt(3)
    v_mfma_f32_16x16x32_bf16 v[80:83], v[28:31], a[80:83], v[80:83]
    ds_read_b128 v[20:23], v4 offset:15360
    v_cvt_pk_bf16_f32 v203, v106, v107
    v_mfma_f32_16x16x32_bf16 v[84:87], v[28:31], a[84:87], v[84:87]
    buffer_store_dwordx4 v[200:203], v2, s[4:7], s66 offen offset:2048 sc1
    v_fmac_f32 v108, v136, v131
    v_mfma_f32_16x16x32_bf16 v[88:91], v[28:31], a[88:91], v[88:91]
    v_fmac_f32 v109, v137, v131
    v_fmac_f32 v110, v138, v131
    v_mfma_f32_16x16x32_bf16 v[92:95], v[28:31], a[92:95], v[92:95]
    v_fmac_f32 v111, v139, v131
    v_fmac_f32 v124, v140, v131
    s_waitcnt lgkmcnt(3)
    v_mfma_f32_16x16x32_bf16 v[64:67], v[8:11], a[96:99], v[64:67]
    ds_read_b128 v[24:27], v4 offset:16384
    v_fmac_f32 v125, v141, v131
    v_mfma_f32_16x16x32_bf16 v[68:71], v[8:11], a[100:103], v[68:71]
    v_fmac_f32 v126, v142, v131
    v_fmac_f32 v127, v143, v131
    v_mfma_f32_16x16x32_bf16 v[72:75], v[8:11], a[104:107], v[72:75]
    v_mul_f32 v108, v108, v135
    v_mul_f32 v109, v109, v135
    v_mfma_f32_16x16x32_bf16 v[76:79], v[8:11], a[108:111], v[76:79]
    v_mul_f32 v110, v110, v135
    v_mul_f32 v111, v111, v135
    s_waitcnt lgkmcnt(3)
    v_mfma_f32_16x16x32_bf16 v[80:83], v[12:15], a[96:99], v[80:83]
    ds_read_b128 v[28:31], v4 offset:17408
    v_mul_f32 v108, v108, v124
    v_mfma_f32_16x16x32_bf16 v[84:87], v[12:15], a[100:103], v[84:87]
    v_mul_f32 v109, v109, v125
    v_mul_f32 v110, v110, v126
    v_mfma_f32_16x16x32_bf16 v[88:91], v[12:15], a[104:107], v[88:91]
    v_mul_f32 v111, v111, v127
    v_cvt_pk_bf16_f32 v206, v108, v109
    v_mfma_f32_16x16x32_bf16 v[92:95], v[12:15], a[108:111], v[92:95]
    v_cvt_pk_bf16_f32 v207, v110, v111
    buffer_store_dwordx4 v[204:207], v2, s[4:7], s66 offen offset:3072 sc1
    s_waitcnt lgkmcnt(3)
    v_mfma_f32_16x16x32_bf16 v[64:67], v[16:19], a[112:115], v[64:67]
    ds_read_b128 v[8:11], v4 offset:18432
    v_mfma_f32_16x16x32_bf16 v[68:71], v[16:19], a[116:119], v[68:71]
    v_mfma_f32_16x16x32_bf16 v[72:75], v[16:19], a[120:123], v[72:75]
    v_mfma_f32_16x16x32_bf16 v[76:79], v[16:19], a[124:127], v[76:79]
    s_waitcnt lgkmcnt(3)
    v_mfma_f32_16x16x32_bf16 v[80:83], v[20:23], a[112:115], v[80:83]
    ds_read_b128 v[12:15], v4 offset:19456
    v_mfma_f32_16x16x32_bf16 v[84:87], v[20:23], a[116:119], v[84:87]
    v_mfma_f32_16x16x32_bf16 v[88:91], v[20:23], a[120:123], v[88:91]
    v_mfma_f32_16x16x32_bf16 v[92:95], v[20:23], a[124:127], v[92:95]
    s_waitcnt lgkmcnt(3)
    v_mfma_f32_16x16x32_bf16 v[64:67], v[24:27], a[128:131], v[64:67]
    ds_read_b128 v[16:19], v4 offset:20480
    v_mfma_f32_16x16x32_bf16 v[68:71], v[24:27], a[132:135], v[68:71]
    v_mfma_f32_16x16x32_bf16 v[72:75], v[24:27], a[136:139], v[72:75]
    v_mfma_f32_16x16x32_bf16 v[76:79], v[24:27], a[140:143], v[76:79]
    s_waitcnt lgkmcnt(3)
    v_mfma_f32_16x16x32_bf16 v[80:83], v[28:31], a[128:131], v[80:83]
    ds_read_b128 v[20:23], v4 offset:21504
    v_mfma_f32_16x16x32_bf16 v[84:87], v[28:31], a[132:135], v[84:87]
    v_mfma_f32_16x16x32_bf16 v[88:91], v[28:31], a[136:139], v[88:91]
    v_mfma_f32_16x16x32_bf16 v[92:95], v[28:31], a[140:143], v[92:95]
    s_waitcnt lgkmcnt(3)
    v_mfma_f32_16x16x32_bf16 v[64:67], v[8:11], a[144:147], v[64:67]
    ds_read_b128 v[24:27], v4 offset:22528
    v_mfma_f32_16x16x32_bf16 v[68:71], v[8:11], a[148:151], v[68:71]
    v_mfma_f32_16x16x32_bf16 v[72:75], v[8:11], a[152:155], v[72:75]
    v_mfma_f32_16x16x32_bf16 v[76:79], v[8:11], a[156:159], v[76:79]
    s_waitcnt lgkmcnt(3)
    v_mfma_f32_16x16x32_bf16 v[80:83], v[12:15], a[144:147], v[80:83]
    ds_read_b128 v[28:31], v4 offset:23552
    v_mfma_f32_16x16x32_bf16 v[84:87], v[12:15], a[148:151], v[84:87]
    v_mfma_f32_16x16x32_bf16 v[88:91], v[12:15], a[152:155], v[88:91]
    v_mfma_f32_16x16x32_bf16 v[92:95], v[12:15], a[156:159], v[92:95]
    s_waitcnt lgkmcnt(3)
    v_mfma_f32_16x16x32_bf16 v[64:67], v[16:19], a[160:163], v[64:67]
    ds_read_b128 v[8:11], v4 offset:24576
    v_mfma_f32_16x16x32_bf16 v[68:71], v[16:19], a[164:167], v[68:71]
    v_mfma_f32_16x16x32_bf16 v[72:75], v[16:19], a[168:171], v[72:75]
    v_mfma_f32_16x16x32_bf16 v[76:79], v[16:19], a[172:175], v[76:79]
    s_waitcnt lgkmcnt(3)
    v_mfma_f32_16x16x32_bf16 v[80:83], v[20:23], a[160:163], v[80:83]
    ds_read_b128 v[12:15], v4 offset:25600
    v_mfma_f32_16x16x32_bf16 v[84:87], v[20:23], a[164:167], v[84:87]
    v_mfma_f32_16x16x32_bf16 v[88:91], v[20:23], a[168:171], v[88:91]
    v_mfma_f32_16x16x32_bf16 v[92:95], v[20:23], a[172:175], v[92:95]
    s_waitcnt lgkmcnt(3)
    v_mfma_f32_16x16x32_bf16 v[64:67], v[24:27], a[176:179], v[64:67]
    ds_read_b128 v[16:19], v4 offset:26624
    v_mfma_f32_16x16x32_bf16 v[68:71], v[24:27], a[180:183], v[68:71]
    v_mfma_f32_16x16x32_bf16 v[72:75], v[24:27], a[184:187], v[72:75]
    v_mfma_f32_16x16x32_bf16 v[76:79], v[24:27], a[188:191], v[76:79]
    s_waitcnt lgkmcnt(3)
    v_mfma_f32_16x16x32_bf16 v[80:83], v[28:31], a[176:179], v[80:83]
    ds_read_b128 v[20:23], v4 offset:27648
    v_mfma_f32_16x16x32_bf16 v[84:87], v[28:31], a[180:183], v[84:87]
    v_mfma_f32_16x16x32_bf16 v[88:91], v[28:31], a[184:187], v[88:91]
    v_mfma_f32_16x16x32_bf16 v[92:95], v[28:31], a[188:191], v[92:95]
    s_waitcnt lgkmcnt(3)
    v_mfma_f32_16x16x32_bf16 v[64:67], v[8:11], a[192:195], v[64:67]
    ds_read_b128 v[24:27], v4 offset:28672
    v_mfma_f32_16x16x32_bf16 v[68:71], v[8:11], a[196:199], v[68:71]
    v_mfma_f32_16x16x32_bf16 v[72:75], v[8:11], a[200:203], v[72:75]
    v_mfma_f32_16x16x32_bf16 v[76:79], v[8:11], a[204:207], v[76:79]
    s_waitcnt lgkmcnt(3)
    v_mfma_f32_16x16x32_bf16 v[80:83], v[12:15], a[192:195], v[80:83]
    ds_read_b128 v[28:31], v4 offset:29696
    v_mfma_f32_16x16x32_bf16 v[84:87], v[12:15], a[196:199], v[84:87]
    v_mfma_f32_16x16x32_bf16 v[88:91], v[12:15], a[200:203], v[88:91]
    v_mfma_f32_16x16x32_bf16 v[92:95], v[12:15], a[204:207], v[92:95]
    s_waitcnt lgkmcnt(3)
    v_mfma_f32_16x16x32_bf16 v[64:67], v[16:19], a[208:211], v[64:67]
    ds_read_b128 v[8:11], v4 offset:30720
    v_mfma_f32_16x16x32_bf16 v[68:71], v[16:19], a[212:215], v[68:71]
    v_mfma_f32_16x16x32_bf16 v[72:75], v[16:19], a[216:219], v[72:75]
    v_mfma_f32_16x16x32_bf16 v[76:79], v[16:19], a[220:223], v[76:79]
    s_waitcnt lgkmcnt(3)
    v_mfma_f32_16x16x32_bf16 v[80:83], v[20:23], a[208:211], v[80:83]
    ds_read_b128 v[12:15], v4 offset:31744
    v_mfma_f32_16x16x32_bf16 v[84:87], v[20:23], a[212:215], v[84:87]
    v_mfma_f32_16x16x32_bf16 v[88:91], v[20:23], a[216:219], v[88:91]
    v_mfma_f32_16x16x32_bf16 v[92:95], v[20:23], a[220:223], v[92:95]
    s_waitcnt lgkmcnt(3)
    v_mfma_f32_16x16x32_bf16 v[64:67], v[24:27], a[224:227], v[64:67]
    ds_read_b128 v[16:19], v4 offset:32768
    v_mfma_f32_16x16x32_bf16 v[68:71], v[24:27], a[228:231], v[68:71]
    v_mfma_f32_16x16x32_bf16 v[72:75], v[24:27], a[232:235], v[72:75]
    v_mfma_f32_16x16x32_bf16 v[76:79], v[24:27], a[236:239], v[76:79]
    s_waitcnt lgkmcnt(3)
    v_mfma_f32_16x16x32_bf16 v[80:83], v[28:31], a[224:227], v[80:83]
    ds_read_b128 v[20:23], v4 offset:33792
    v_mfma_f32_16x16x32_bf16 v[84:87], v[28:31], a[228:231], v[84:87]
    v_mfma_f32_16x16x32_bf16 v[88:91], v[28:31], a[232:235], v[88:91]
    v_mfma_f32_16x16x32_bf16 v[92:95], v[28:31], a[236:239], v[92:95]
    s_waitcnt lgkmcnt(3)
    v_mfma_f32_16x16x32_bf16 v[64:67], v[8:11], a[240:243], v[64:67]
    ds_read_b128 v[24:27], v4 offset:34816
    v_mfma_f32_16x16x32_bf16 v[68:71], v[8:11], a[244:247], v[68:71]
    v_mfma_f32_16x16x32_bf16 v[72:75], v[8:11], a[248:251], v[72:75]
    v_mfma_f32_16x16x32_bf16 v[76:79], v[8:11], a[252:255], v[76:79]
    ds_read_b128 v[144:147], v5 offset:640
    ds_read_b128 v[148:151], v5 offset:704
    s_waitcnt lgkmcnt(5)
    v_mfma_f32_16x16x32_bf16 v[80:83], v[12:15], a[240:243], v[80:83]
    ds_read_b128 v[28:31], v4 offset:35840
    v_mfma_f32_16x16x32_bf16 v[84:87], v[12:15], a[244:247], v[84:87]
    v_mfma_f32_16x16x32_bf16 v[88:91], v[12:15], a[248:251], v[88:91]
    v_mfma_f32_16x16x32_bf16 v[92:95], v[12:15], a[252:255], v[92:95]
    s_waitcnt lgkmcnt(5)
    v_mfma_f32_16x16x32_bf16 v[64:67], v[16:19], v[32:35], v[64:67]
    s_waitcnt vmcnt(13)
    s_barrier
    v_mfma_f32_16x16x32_bf16 v[68:71], v[16:19], v[36:39], v[68:71]
    v_add_u32 v4, 0x9000, v4
    ds_read_b128 v[8:11], v4 offset:0
    v_mfma_f32_16x16x32_bf16 v[72:75], v[16:19], v[40:43], v[72:75]
    s_add_u32 m0, s49, 0
    s_add_u32 s61, s48, 294912
    v_mfma_f32_16x16x32_bf16 v[76:79], v[16:19], v[44:47], v[76:79]
    buffer_load_dwordx4 v2, s[4:7], s61 offen offset:0 lds
    s_waitcnt lgkmcnt(5)
    v_mfma_f32_16x16x32_bf16 v[80:83], v[20:23], v[32:35], v[80:83]
    ds_read_b128 v[12:15], v4 offset:1024
    v_mfma_f32_16x16x32_bf16 v[84:87], v[20:23], v[36:39], v[84:87]
    v_mfma_f32_16x16x32_bf16 v[88:91], v[20:23], v[40:43], v[88:91]
    v_mfma_f32_16x16x32_bf16 v[92:95], v[20:23], v[44:47], v[92:95]
    buffer_load_dwordx4 v2, s[4:7], s61 offen offset:1024 lds
    s_waitcnt lgkmcnt(5)
    v_mfma_f32_16x16x32_bf16 v[64:67], v[24:27], v[48:51], v[64:67]
    ds_read_b128 v[16:19], v4 offset:2048
    v_mfma_f32_16x16x32_bf16 v[68:71], v[24:27], v[52:55], v[68:71]
    v_mfma_f32_16x16x32_bf16 v[72:75], v[24:27], v[56:59], v[72:75]
    v_mfma_f32_16x16x32_bf16 v[76:79], v[24:27], v[60:63], v[76:79]
    buffer_load_dwordx4 v2, s[4:7], s61 offen offset:2048 lds
    s_waitcnt lgkmcnt(3)
    v_mfma_f32_16x16x32_bf16 v[80:83], v[28:31], v[48:51], v[80:83]
    ds_read_b128 v[20:23], v4 offset:3072
    v_mfma_f32_16x16x32_bf16 v[84:87], v[28:31], v[52:55], v[84:87]
    v_mfma_f32_16x16x32_bf16 v[88:91], v[28:31], v[56:59], v[88:91]
    v_mfma_f32_16x16x32_bf16 v[92:95], v[28:31], v[60:63], v[92:95]
    buffer_load_dwordx4 v2, s[4:7], s61 offen offset:3072 lds
    s_add_u32 m0, s49, 4096
    s_waitcnt lgkmcnt(3)
    v_mfma_f32_16x16x32_bf16 v[96:99], v[8:11], a[0:3], 0
    ds_read_b128 v[24:27], v4 offset:4096
    s_add_u32 s61, s48, 299008
    v_mfma_f32_16x16x32_bf16 v[100:103], v[8:11], a[4:7], 0
    v_mfma_f32_16x16x32_bf16 v[104:107], v[8:11], a[8:11], 0
    v_mfma_f32_16x16x32_bf16 v[108:111], v[8:11], a[12:15], 0
    buffer_load_dwordx4 v2, s[4:7], s61 offen offset:0 lds
    s_waitcnt lgkmcnt(3)
    v_mfma_f32_16x16x32_bf16 v[112:115], v[12:15], a[0:3], 0
    ds_read_b128 v[28:31], v4 offset:5120
    v_mfma_f32_16x16x32_bf16 v[116:119], v[12:15], a[4:7], 0
    v_fmac_f32 v64, v144, v128
    v_fmac_f32 v65, v145, v128
    v_mfma_f32_16x16x32_bf16 v[120:123], v[12:15], a[8:11], 0
    v_fmac_f32 v66, v146, v128
    v_fmac_f32 v67, v147, v128
    v_mfma_f32_16x16x32_bf16 v[124:127], v[12:15], a[12:15], 0
    buffer_load_dwordx4 v2, s[4:7], s61 offen offset:1024 lds
    v_fmac_f32 v80, v148, v128
    s_waitcnt lgkmcnt(3)
    v_mfma_f32_16x16x32_bf16 v[96:99], v[16:19], a[16:19], v[96:99]
    ds_read_b128 v[8:11], v4 offset:6144
    v_fmac_f32 v81, v149, v128
    v_mfma_f32_16x16x32_bf16 v[100:103], v[16:19], a[20:23], v[100:103]
    v_fmac_f32 v82, v150, v128
    v_fmac_f32 v83, v151, v128
    v_mfma_f32_16x16x32_bf16 v[104:107], v[16:19], a[24:27], v[104:107]
    v_mul_f32 v64, v64, v132
    v_mul_f32 v65, v65, v132
    v_mfma_f32_16x16x32_bf16 v[108:111], v[16:19], a[28:31], v[108:111]
    buffer_load_dwordx4 v2, s[4:7], s61 offen offset:2048 lds
    v_mul_f32 v66, v66, v132
    s_waitcnt lgkmcnt(3)
    v_mfma_f32_16x16x32_bf16 v[112:115], v[20:23], a[16:19], v[112:115]
    ds_read_b128 v[12:15], v4 offset:7168
    v_mul_f32 v67, v67, v132
    v_mfma_f32_16x16x32_bf16 v[116:119], v[20:23], a[20:23], v[116:119]
    v_mul_f32 v64, v64, v80
    v_mul_f32 v65, v65, v81
    v_mfma_f32_16x16x32_bf16 v[120:123], v[20:23], a[24:27], v[120:123]
    v_mul_f32 v66, v66, v82
    v_mul_f32 v67, v67, v83
    v_mfma_f32_16x16x32_bf16 v[124:127], v[20:23], a[28:31], v[124:127]
    buffer_load_dwordx4 v2, s[4:7], s61 offen offset:3072 lds
    s_add_u32 m0, s49, 8192
    s_waitcnt lgkmcnt(3)
    v_mfma_f32_16x16x32_bf16 v[96:99], v[24:27], a[32:35], v[96:99]
    ds_read_b128 v[16:19], v4 offset:8192
    s_add_u32 s61, s48, 303104
    v_mfma_f32_16x16x32_bf16 v[100:103], v[24:27], a[36:39], v[100:103]
    v_cvt_pk_bf16_f32 v208, v64, v65
    v_cvt_pk_bf16_f32 v209, v66, v67
    v_mfma_f32_16x16x32_bf16 v[104:107], v[24:27], a[40:43], v[104:107]
    v_fmac_f32 v68, v144, v129
    v_fmac_f32 v69, v145, v129
    v_mfma_f32_16x16x32_bf16 v[108:111], v[24:27], a[44:47], v[108:111]
    buffer_load_dwordx4 v2, s[4:7], s61 offen offset:0 lds
    v_fmac_f32 v70, v146, v129
    s_waitcnt lgkmcnt(3)
    v_mfma_f32_16x16x32_bf16 v[112:115], v[28:31], a[32:35], v[112:115]
    ds_read_b128 v[20:23], v4 offset:9216
    v_fmac_f32 v71, v147, v129
    v_mfma_f32_16x16x32_bf16 v[116:119], v[28:31], a[36:39], v[116:119]
    v_fmac_f32 v84, v148, v129
    v_fmac_f32 v85, v149, v129
    v_mfma_f32_16x16x32_bf16 v[120:123], v[28:31], a[40:43], v[120:123]
    v_fmac_f32 v86, v150, v129
    v_fmac_f32 v87, v151, v129
    v_mfma_f32_16x16x32_bf16 v[124:127], v[28:31], a[44:47], v[124:127]
    v_mul_f32 v68, v68, v133
    v_mul_f32 v69, v69, v133
    s_waitcnt lgkmcnt(3)
    v_mfma_f32_16x16x32_bf16 v[96:99], v[8:11], a[48:51], v[96:99]
    ds_read_b128 v[24:27], v4 offset:10240
    v_mul_f32 v70, v70, v133
    v_mfma_f32_16x16x32_bf16 v[100:103], v[8:11], a[52:55], v[100:103]
    v_mul_f32 v71, v71, v133
    v_mul_f32 v68, v68, v84
    v_mfma_f32_16x16x32_bf16 v[104:107], v[8:11], a[56:59], v[104:107]
    v_mul_f32 v69, v69, v85
    v_mul_f32 v70, v70, v86
    v_mfma_f32_16x16x32_bf16 v[108:111], v[8:11], a[60:63], v[108:111]
    v_mul_f32 v71, v71, v87
    v_cvt_pk_bf16_f32 v212, v68, v69
    s_waitcnt lgkmcnt(3)
    v_mfma_f32_16x16x32_bf16 v[112:115], v[12:15], a[48:51], v[112:115]
    ds_read_b128 v[28:31], v4 offset:11264
    v_cvt_pk_bf16_f32 v213, v70, v71
    v_mfma_f32_16x16x32_bf16 v[116:119], v[12:15], a[52:55], v[116:119]
    v_fmac_f32 v72, v144, v130
    v_fmac_f32 v73, v145, v130
    v_mfma_f32_16x16x32_bf16 v[120:123], v[12:15], a[56:59], v[120:123]
    v_fmac_f32 v74, v146, v130
    v_fmac_f32 v75, v147, v130
    v_mfma_f32_16x16x32_bf16 v[124:127], v[12:15], a[60:63], v[124:127]
    v_fmac_f32 v88, v148, v130
    v_fmac_f32 v89, v149, v130
    s_waitcnt lgkmcnt(3)
    v_mfma_f32_16x16x32_bf16 v[96:99], v[16:19], a[64:67], v[96:99]
    ds_read_b128 v[8:11], v4 offset:12288
    v_fmac_f32 v90, v150, v130
    v_mfma_f32_16x16x32_bf16 v[100:103], v[16:19], a[68:71], v[100:103]
    v_fmac_f32 v91, v151, v130
    v_mul_f32 v72, v72, v134
    v_mfma_f32_16x16x32_bf16 v[104:107], v[16:19], a[72:75], v[104:107]
    v_mul_f32 v73, v73, v134
    v_mul_f32 v74, v74, v134
    v_mfma_f32_16x16x32_bf16 v[108:111], v[16:19], a[76:79], v[108:111]
    v_mul_f32 v75, v75, v134
    v_mul_f32 v72, v72, v88
    s_waitcnt lgkmcnt(3)
    v_mfma_f32_16x16x32_bf16 v[112:115], v[20:23], a[64:67], v[112:115]
    ds_read_b128 v[12:15], v4 offset:13312
    v_mul_f32 v73, v73, v89
    v_mfma_f32_16x16x32_bf16 v[116:119], v[20:23], a[68:71], v[116:119]
    v_mul_f32 v74, v74, v90
    v_mul_f32 v75, v75, v91
    v_mfma_f32_16x16x32_bf16 v[120:123], v[20:23], a[72:75], v[120:123]
    v_cvt_pk_bf16_f32 v216, v72, v73
    v_cvt_pk_bf16_f32 v217, v74, v75
    v_mfma_f32_16x16x32_bf16 v[124:127], v[20:23], a[76:79], v[124:127]
    v_fmac_f32 v76, v144, v131
    v_fmac_f32 v77, v145, v131
    s_waitcnt lgkmcnt(3)
    v_mfma_f32_16x16x32_bf16 v[96:99], v[24:27], a[80:83], v[96:99]
    ds_read_b128 v[16:19], v4 offset:14336
    v_fmac_f32 v78, v146, v131
    v_mfma_f32_16x16x32_bf16 v[100:103], v[24:27], a[84:87], v[100:103]
    v_fmac_f32 v79, v147, v131
    v_fmac_f32 v92, v148, v131
    v_mfma_f32_16x16x32_bf16 v[104:107], v[24:27], a[88:91], v[104:107]
    v_fmac_f32 v93, v149, v131
    v_fmac_f32 v94, v150, v131
    v_mfma_f32_16x16x32_bf16 v[108:111], v[24:27], a[92:95], v[108:111]
    v_fmac_f32 v95, v151, v131
    v_mul_f32 v76, v76, v135
    s_waitcnt lgkmcnt(3)
    v_mfma_f32_16x16x32_bf16 v[112:115], v[28:31], a[80:83], v[112:115]
    ds_read_b128 v[20:23], v4 offset:15360
    v_mul_f32 v77, v77, v135
    v_mfma_f32_16x16x32_bf16 v[116:119], v[28:31], a[84:87], v[116:119]
    v_mul_f32 v78, v78, v135
    v_mul_f32 v79, v79, v135
    v_mfma_f32_16x16x32_bf16 v[120:123], v[28:31], a[88:91], v[120:123]
    v_mul_f32 v76, v76, v92
    v_mul_f32 v77, v77, v93
    v_mfma_f32_16x16x32_bf16 v[124:127], v[28:31], a[92:95], v[124:127]
    v_mul_f32 v78, v78, v94
    v_mul_f32 v79, v79, v95
    s_waitcnt lgkmcnt(3)
    v_mfma_f32_16x16x32_bf16 v[96:99], v[8:11], a[96:99], v[96:99]
    ds_read_b128 v[24:27], v4 offset:16384
    v_cvt_pk_bf16_f32 v220, v76, v77
    v_mfma_f32_16x16x32_bf16 v[100:103], v[8:11], a[100:103], v[100:103]
    v_cvt_pk_bf16_f32 v221, v78, v79
    v_mfma_f32_16x16x32_bf16 v[104:107], v[8:11], a[104:107], v[104:107]
    v_mfma_f32_16x16x32_bf16 v[108:111], v[8:11], a[108:111], v[108:111]
    s_waitcnt lgkmcnt(3)
    v_mfma_f32_16x16x32_bf16 v[112:115], v[12:15], a[96:99], v[112:115]
    ds_read_b128 v[28:31], v4 offset:17408
    v_mfma_f32_16x16x32_bf16 v[116:119], v[12:15], a[100:103], v[116:119]
    v_mfma_f32_16x16x32_bf16 v[120:123], v[12:15], a[104:107], v[120:123]
    v_mfma_f32_16x16x32_bf16 v[124:127], v[12:15], a[108:111], v[124:127]
    s_waitcnt lgkmcnt(3)
    v_mfma_f32_16x16x32_bf16 v[96:99], v[16:19], a[112:115], v[96:99]
    ds_read_b128 v[8:11], v4 offset:18432
    v_mfma_f32_16x16x32_bf16 v[100:103], v[16:19], a[116:119], v[100:103]
    v_mov_b32 v6, 1
    v_mov_b32 v0, 0
    v_mfma_f32_16x16x32_bf16 v[104:107], v[16:19], a[120:123], v[104:107]
    v_mfma_f32_16x16x32_bf16 v[108:111], v[16:19], a[124:127], v[108:111]
    s_waitcnt vmcnt(9)
    s_waitcnt lgkmcnt(3)
    v_mfma_f32_16x16x32_bf16 v[112:115], v[20:23], a[112:115], v[112:115]
    ds_read_b128 v[12:15], v4 offset:19456
    v_mfma_f32_16x16x32_bf16 v[116:119], v[20:23], a[116:119], v[116:119]
    s_mov_b64 exec, 1
    buffer_store_dword v6, v0, s[4:7], s67 offen sc1
    s_mov_b64 exec, -1
    v_mfma_f32_16x16x32_bf16 v[120:123], v[20:23], a[120:123], v[120:123]
    v_mfma_f32_16x16x32_bf16 v[124:127], v[20:23], a[124:127], v[124:127]
    s_waitcnt lgkmcnt(3)
    v_mfma_f32_16x16x32_bf16 v[96:99], v[24:27], a[128:131], v[96:99]
    ds_read_b128 v[16:19], v4 offset:20480
    v_mfma_f32_16x16x32_bf16 v[100:103], v[24:27], a[132:135], v[100:103]
    v_mfma_f32_16x16x32_bf16 v[104:107], v[24:27], a[136:139], v[104:107]
    v_mfma_f32_16x16x32_bf16 v[108:111], v[24:27], a[140:143], v[108:111]
    s_waitcnt lgkmcnt(3)
    v_mfma_f32_16x16x32_bf16 v[112:115], v[28:31], a[128:131], v[112:115]
    ds_read_b128 v[20:23], v4 offset:21504
    v_mfma_f32_16x16x32_bf16 v[116:119], v[28:31], a[132:135], v[116:119]
    v_mfma_f32_16x16x32_bf16 v[120:123], v[28:31], a[136:139], v[120:123]
    v_mfma_f32_16x16x32_bf16 v[124:127], v[28:31], a[140:143], v[124:127]
    s_waitcnt lgkmcnt(3)
    v_mfma_f32_16x16x32_bf16 v[96:99], v[8:11], a[144:147], v[96:99]
    ds_read_b128 v[24:27], v4 offset:22528
    v_mfma_f32_16x16x32_bf16 v[100:103], v[8:11], a[148:151], v[100:103]
    v_mfma_f32_16x16x32_bf16 v[104:107], v[8:11], a[152:155], v[104:107]
    v_mfma_f32_16x16x32_bf16 v[108:111], v[8:11], a[156:159], v[108:111]
    s_waitcnt lgkmcnt(3)
    v_mfma_f32_16x16x32_bf16 v[112:115], v[12:15], a[144:147], v[112:115]
    ds_read_b128 v[28:31], v4 offset:23552
    v_mfma_f32_16x16x32_bf16 v[116:119], v[12:15], a[148:151], v[116:119]
    v_mfma_f32_16x16x32_bf16 v[120:123], v[12:15], a[152:155], v[120:123]
    v_mfma_f32_16x16x32_bf16 v[124:127], v[12:15], a[156:159], v[124:127]
    s_waitcnt lgkmcnt(3)
    v_mfma_f32_16x16x32_bf16 v[96:99], v[16:19], a[160:163], v[96:99]
    ds_read_b128 v[8:11], v4 offset:24576
    v_mfma_f32_16x16x32_bf16 v[100:103], v[16:19], a[164:167], v[100:103]
    v_mfma_f32_16x16x32_bf16 v[104:107], v[16:19], a[168:171], v[104:107]
    v_mfma_f32_16x16x32_bf16 v[108:111], v[16:19], a[172:175], v[108:111]
    s_waitcnt lgkmcnt(3)
    v_mfma_f32_16x16x32_bf16 v[112:115], v[20:23], a[160:163], v[112:115]
    ds_read_b128 v[12:15], v4 offset:25600
    v_mfma_f32_16x16x32_bf16 v[116:119], v[20:23], a[164:167], v[116:119]
    v_mfma_f32_16x16x32_bf16 v[120:123], v[20:23], a[168:171], v[120:123]
    v_mfma_f32_16x16x32_bf16 v[124:127], v[20:23], a[172:175], v[124:127]
    s_waitcnt lgkmcnt(3)
    v_mfma_f32_16x16x32_bf16 v[96:99], v[24:27], a[176:179], v[96:99]
    ds_read_b128 v[16:19], v4 offset:26624
    v_mfma_f32_16x16x32_bf16 v[100:103], v[24:27], a[180:183], v[100:103]
    v_mfma_f32_16x16x32_bf16 v[104:107], v[24:27], a[184:187], v[104:107]
    v_mfma_f32_16x16x32_bf16 v[108:111], v[24:27], a[188:191], v[108:111]
    s_waitcnt lgkmcnt(3)
    v_mfma_f32_16x16x32_bf16 v[112:115], v[28:31], a[176:179], v[112:115]
    ds_read_b128 v[20:23], v4 offset:27648
    v_mfma_f32_16x16x32_bf16 v[116:119], v[28:31], a[180:183], v[116:119]
    v_mfma_f32_16x16x32_bf16 v[120:123], v[28:31], a[184:187], v[120:123]
    v_mfma_f32_16x16x32_bf16 v[124:127], v[28:31], a[188:191], v[124:127]
    s_waitcnt lgkmcnt(3)
    v_mfma_f32_16x16x32_bf16 v[96:99], v[8:11], a[192:195], v[96:99]
    ds_read_b128 v[24:27], v4 offset:28672
    v_mfma_f32_16x16x32_bf16 v[100:103], v[8:11], a[196:199], v[100:103]
    v_mfma_f32_16x16x32_bf16 v[104:107], v[8:11], a[200:203], v[104:107]
    v_mfma_f32_16x16x32_bf16 v[108:111], v[8:11], a[204:207], v[108:111]
    s_waitcnt lgkmcnt(3)
    v_mfma_f32_16x16x32_bf16 v[112:115], v[12:15], a[192:195], v[112:115]
    ds_read_b128 v[28:31], v4 offset:29696
    v_mfma_f32_16x16x32_bf16 v[116:119], v[12:15], a[196:199], v[116:119]
    v_mfma_f32_16x16x32_bf16 v[120:123], v[12:15], a[200:203], v[120:123]
    v_mfma_f32_16x16x32_bf16 v[124:127], v[12:15], a[204:207], v[124:127]
    s_waitcnt lgkmcnt(3)
    v_mfma_f32_16x16x32_bf16 v[96:99], v[16:19], a[208:211], v[96:99]
    ds_read_b128 v[8:11], v4 offset:30720
    v_mfma_f32_16x16x32_bf16 v[100:103], v[16:19], a[212:215], v[100:103]
    v_mfma_f32_16x16x32_bf16 v[104:107], v[16:19], a[216:219], v[104:107]
    v_mfma_f32_16x16x32_bf16 v[108:111], v[16:19], a[220:223], v[108:111]
    s_waitcnt lgkmcnt(3)
    v_mfma_f32_16x16x32_bf16 v[112:115], v[20:23], a[208:211], v[112:115]
    ds_read_b128 v[12:15], v4 offset:31744
    v_mfma_f32_16x16x32_bf16 v[116:119], v[20:23], a[212:215], v[116:119]
    v_mfma_f32_16x16x32_bf16 v[120:123], v[20:23], a[216:219], v[120:123]
    v_mfma_f32_16x16x32_bf16 v[124:127], v[20:23], a[220:223], v[124:127]
    s_waitcnt lgkmcnt(3)
    v_mfma_f32_16x16x32_bf16 v[96:99], v[24:27], a[224:227], v[96:99]
    ds_read_b128 v[16:19], v4 offset:32768
    v_mfma_f32_16x16x32_bf16 v[100:103], v[24:27], a[228:231], v[100:103]
    v_mfma_f32_16x16x32_bf16 v[104:107], v[24:27], a[232:235], v[104:107]
    v_mfma_f32_16x16x32_bf16 v[108:111], v[24:27], a[236:239], v[108:111]
    s_waitcnt lgkmcnt(3)
    v_mfma_f32_16x16x32_bf16 v[112:115], v[28:31], a[224:227], v[112:115]
    ds_read_b128 v[20:23], v4 offset:33792
    v_mfma_f32_16x16x32_bf16 v[116:119], v[28:31], a[228:231], v[116:119]
    v_mfma_f32_16x16x32_bf16 v[120:123], v[28:31], a[232:235], v[120:123]
    v_mfma_f32_16x16x32_bf16 v[124:127], v[28:31], a[236:239], v[124:127]
    s_waitcnt lgkmcnt(3)
    v_mfma_f32_16x16x32_bf16 v[96:99], v[8:11], a[240:243], v[96:99]
    ds_read_b128 v[24:27], v4 offset:34816
    v_mfma_f32_16x16x32_bf16 v[100:103], v[8:11], a[244:247], v[100:103]
    v_mfma_f32_16x16x32_bf16 v[104:107], v[8:11], a[248:251], v[104:107]
    v_mfma_f32_16x16x32_bf16 v[108:111], v[8:11], a[252:255], v[108:111]
    ds_read_b128 v[136:139], v5 offset:768
    ds_read_b128 v[140:143], v5 offset:832
    s_waitcnt lgkmcnt(5)
    v_mfma_f32_16x16x32_bf16 v[112:115], v[12:15], a[240:243], v[112:115]
    ds_read_b128 v[28:31], v4 offset:35840
    v_mfma_f32_16x16x32_bf16 v[116:119], v[12:15], a[244:247], v[116:119]
    v_mfma_f32_16x16x32_bf16 v[120:123], v[12:15], a[248:251], v[120:123]
    v_mfma_f32_16x16x32_bf16 v[124:127], v[12:15], a[252:255], v[124:127]
    s_waitcnt lgkmcnt(5)
    v_mfma_f32_16x16x32_bf16 v[96:99], v[16:19], v[32:35], v[96:99]
    s_barrier
    v_mfma_f32_16x16x32_bf16 v[100:103], v[16:19], v[36:39], v[100:103]
    v_add_u32 v4, 0x9000, v4
    ds_read_b128 v[8:11], v4 offset:0
    v_mfma_f32_16x16x32_bf16 v[104:107], v[16:19], v[40:43], v[104:107]
    s_add_u32 m0, s49, 36864
    s_add_u32 s61, s48, 331776
    v_mfma_f32_16x16x32_bf16 v[108:111], v[16:19], v[44:47], v[108:111]
    buffer_load_dwordx4 v2, s[4:7], s61 offen offset:0 lds
    s_waitcnt lgkmcnt(5)
    v_mfma_f32_16x16x32_bf16 v[112:115], v[20:23], v[32:35], v[112:115]
    ds_read_b128 v[12:15], v4 offset:1024
    v_mfma_f32_16x16x32_bf16 v[116:119], v[20:23], v[36:39], v[116:119]
    v_mfma_f32_16x16x32_bf16 v[120:123], v[20:23], v[40:43], v[120:123]
    v_mfma_f32_16x16x32_bf16 v[124:127], v[20:23], v[44:47], v[124:127]
    buffer_load_dwordx4 v2, s[4:7], s61 offen offset:1024 lds
    s_waitcnt lgkmcnt(5)
    v_mfma_f32_16x16x32_bf16 v[96:99], v[24:27], v[48:51], v[96:99]
    ds_read_b128 v[16:19], v4 offset:2048
    v_mfma_f32_16x16x32_bf16 v[100:103], v[24:27], v[52:55], v[100:103]
    v_mfma_f32_16x16x32_bf16 v[104:107], v[24:27], v[56:59], v[104:107]
    v_mfma_f32_16x16x32_bf16 v[108:111], v[24:27], v[60:63], v[108:111]
    buffer_load_dwordx4 v2, s[4:7], s61 offen offset:2048 lds
    s_waitcnt lgkmcnt(3)
    v_mfma_f32_16x16x32_bf16 v[112:115], v[28:31], v[48:51], v[112:115]
    ds_read_b128 v[20:23], v4 offset:3072
    v_mfma_f32_16x16x32_bf16 v[116:119], v[28:31], v[52:55], v[116:119]
    v_mfma_f32_16x16x32_bf16 v[120:123], v[28:31], v[56:59], v[120:123]
    v_mfma_f32_16x16x32_bf16 v[124:127], v[28:31], v[60:63], v[124:127]
    buffer_load_dwordx4 v2, s[4:7], s61 offen offset:3072 lds
    s_add_u32 m0, s49, 40960
    s_waitcnt lgkmcnt(3)
    v_mfma_f32_16x16x32_bf16 v[64:67], v[8:11], a[0:3], 0
    ds_read_b128 v[24:27], v4 offset:4096
    s_add_u32 s61, s48, 335872
    v_mfma_f32_16x16x32_bf16 v[68:71], v[8:11], a[4:7], 0
    v_mfma_f32_16x16x32_bf16 v[72:75], v[8:11], a[8:11], 0
    v_mfma_f32_16x16x32_bf16 v[76:79], v[8:11], a[12:15], 0
    buffer_load_dwordx4 v2, s[4:7], s61 offen offset:0 lds
    s_waitcnt lgkmcnt(3)
    v_mfma_f32_16x16x32_bf16 v[80:83], v[12:15], a[0:3], 0
    ds_read_b128 v[28:31], v4 offset:5120
    v_mfma_f32_16x16x32_bf16 v[84:87], v[12:15], a[4:7], 0
    v_fmac_f32 v96, v136, v128
    v_fmac_f32 v97, v137, v128
    v_mfma_f32_16x16x32_bf16 v[88:91], v[12:15], a[8:11], 0
    v_fmac_f32 v98, v138, v128
    v_fmac_f32 v99, v139, v128
    v_mfma_f32_16x16x32_bf16 v[92:95], v[12:15], a[12:15], 0
    buffer_load_dwordx4 v2, s[4:7], s61 offen offset:1024 lds
    v_fmac_f32 v112, v140, v128
    s_waitcnt lgkmcnt(3)
    v_mfma_f32_16x16x32_bf16 v[64:67], v[16:19], a[16:19], v[64:67]
    ds_read_b128 v[8:11], v4 offset:6144
    v_fmac_f32 v113, v141, v128
    v_mfma_f32_16x16x32_bf16 v[68:71], v[16:19], a[20:23], v[68:71]
    v_fmac_f32 v114, v142, v128
    v_fmac_f32 v115, v143, v128
    v_mfma_f32_16x16x32_bf16 v[72:75], v[16:19], a[24:27], v[72:75]
    v_mul_f32 v96, v96, v132
    v_mul_f32 v97, v97, v132
    v_mfma_f32_16x16x32_bf16 v[76:79], v[16:19], a[28:31], v[76:79]
    buffer_load_dwordx4 v2, s[4:7], s61 offen offset:2048 lds
    v_mul_f32 v98, v98, v132
    s_waitcnt lgkmcnt(3)
    v_mfma_f32_16x16x32_bf16 v[80:83], v[20:23], a[16:19], v[80:83]
    ds_read_b128 v[12:15], v4 offset:7168
    v_mul_f32 v99, v99, v132
    v_mfma_f32_16x16x32_bf16 v[84:87], v[20:23], a[20:23], v[84:87]
    v_mul_f32 v96, v96, v112
    v_mul_f32 v97, v97, v113
    v_mfma_f32_16x16x32_bf16 v[88:91], v[20:23], a[24:27], v[88:91]
    v_mul_f32 v98, v98, v114
    v_mul_f32 v99, v99, v115
    v_mfma_f32_16x16x32_bf16 v[92:95], v[20:23], a[28:31], v[92:95]
    buffer_load_dwordx4 v2, s[4:7], s61 offen offset:3072 lds
    s_add_u32 m0, s49, 45056
    s_waitcnt lgkmcnt(3)
    v_mfma_f32_16x16x32_bf16 v[64:67], v[24:27], a[32:35], v[64:67]
    ds_read_b128 v[16:19], v4 offset:8192
    s_add_u32 s61, s48, 339968
    v_mfma_f32_16x16x32_bf16 v[68:71], v[24:27], a[36:39], v[68:71]
    v_cvt_pk_bf16_f32 v210, v96, v97
    v_cvt_pk_bf16_f32 v211, v98, v99
    v_mfma_f32_16x16x32_bf16 v[72:75], v[24:27], a[40:43], v[72:75]
    s_add_u32 s66, s51, 32768
    v_mfma_f32_16x16x32_bf16 v[76:79], v[24:27], a[44:47], v[76:79]
    buffer_load_dwordx4 v2, s[4:7], s61 offen offset:0 lds
    s_waitcnt lgkmcnt(3)
    v_mfma_f32_16x16x32_bf16 v[80:83], v[28:31], a[32:35], v[80:83]
    ds_read_b128 v[20:23], v4 offset:9216
    v_mfma_f32_16x16x32_bf16 v[84:87], v[28:31], a[36:39], v[84:87]
    v_mfma_f32_16x16x32_bf16 v[88:91], v[28:31], a[40:43], v[88:91]
    v_mfma_f32_16x16x32_bf16 v[92:95], v[28:31], a[44:47], v[92:95]
    buffer_store_dwordx4 v[208:211], v2, s[4:7], s66 offen offset:0 sc1
    v_fmac_f32 v100, v136, v129
    s_waitcnt lgkmcnt(3)
    v_mfma_f32_16x16x32_bf16 v[64:67], v[8:11], a[48:51], v[64:67]
    ds_read_b128 v[24:27], v4 offset:10240
    v_fmac_f32 v101, v137, v129
    v_mfma_f32_16x16x32_bf16 v[68:71], v[8:11], a[52:55], v[68:71]
    v_fmac_f32 v102, v138, v129
    v_fmac_f32 v103, v139, v129
    v_mfma_f32_16x16x32_bf16 v[72:75], v[8:11], a[56:59], v[72:75]
    v_fmac_f32 v116, v140, v129
    v_fmac_f32 v117, v141, v129
    v_mfma_f32_16x16x32_bf16 v[76:79], v[8:11], a[60:63], v[76:79]
    v_fmac_f32 v118, v142, v129
    v_fmac_f32 v119, v143, v129
    s_waitcnt lgkmcnt(3)
    v_mfma_f32_16x16x32_bf16 v[80:83], v[12:15], a[48:51], v[80:83]
    ds_read_b128 v[28:31], v4 offset:11264
    v_mul_f32 v100, v100, v133
    v_mfma_f32_16x16x32_bf16 v[84:87], v[12:15], a[52:55], v[84:87]
    v_mul_f32 v101, v101, v133
    v_mul_f32 v102, v102, v133
    v_mfma_f32_16x16x32_bf16 v[88:91], v[12:15], a[56:59], v[88:91]
    v_mul_f32 v103, v103, v133
    v_mul_f32 v100, v100, v116
    v_mfma_f32_16x16x32_bf16 v[92:95], v[12:15], a[60:63], v[92:95]
    v_mul_f32 v101, v101, v117
    v_mul_f32 v102, v102, v118
    s_waitcnt lgkmcnt(3)
    v_mfma_f32_16x16x32_bf16 v[64:67], v[16:19], a[64:67], v[64:67]
    ds_read_b128 v[8:11], v4 offset:12288
    v_mul_f32 v103, v103, v119
    v_mfma_f32_16x16x32_bf16 v[68:71], v[16:19], a[68:71], v[68:71]
    v_cvt_pk_bf16_f32 v214, v100, v101
    v_cvt_pk_bf16_f32 v215, v102, v103
    v_mfma_f32_16x16x32_bf16 v[72:75], v[16:19], a[72:75], v[72:75]
    buffer_store_dwordx4 v[212:215], v2, s[4:7], s66 offen offset:1024 sc1
    v_fmac_f32 v104, v136, v130
    v_mfma_f32_16x16x32_bf16 v[76:79], v[16:19], a[76:79], v[76:79]
    v_fmac_f32 v105, v137, v130
    v_fmac_f32 v106, v138, v130
    s_waitcnt lgkmcnt(3)
    v_mfma_f32_16x16x32_bf16 v[80:83], v[20:23], a[64:67], v[80:83]
    ds_read_b128 v[12:15], v4 offset:13312
    v_fmac_f32 v107, v139, v130
    v_mfma_f32_16x16x32_bf16 v[84:87], v[20:23], a[68:71], v[84:87]
    v_fmac_f32 v120, v140, v130
    v_fmac_f32 v121, v141, v130
    v_mfma_f32_16x16x32_bf16 v[88:91], v[20:23], a[72:75], v[88:91]
    v_fmac_f32 v122, v142, v130
    v_fmac_f32 v123, v143, v130
    v_mfma_f32_16x16x32_bf16 v[92:95], v[20:23], a[76:79], v[92:95]
    v_mul_f32 v104, v104, v134
    v_mul_f32 v105, v105, v134
    s_waitcnt lgkmcnt(3)
    v_mfma_f32_16x16x32_bf16 v[64:67], v[24:27], a[80:83], v[64:67]
    ds_read_b128 v[16:19], v4 offset:14336
    v_mul_f32 v106, v106, v134
    v_mfma_f32_16x16x32_bf16 v[68:71], v[24:27], a[84:87], v[68:71]
    v_mul_f32 v107, v107, v134
    v_mul_f32 v104, v104, v120
    v_mfma_f32_16x16x32_bf16 v[72:75], v[24:27], a[88:91], v[72:75]
    v_mul_f32 v105, v105, v121
    v_mul_f32 v106, v106, v122
    v_mfma_f32_16x16x32_bf16 v[76:79], v[24:27], a[92:95], v[76:79]
    v_mul_f32 v107, v107, v123
    v_cvt_pk_bf16_f32 v218, v104, v105
    s_waitcnt lgkmcnt(3)
    v_mfma_f32_16x16x32_bf16 v[80:83], v[28:31], a[80:83], v[80:83]
    ds_read_b128 v[20:23], v4 offset:15360
    v_cvt_pk_bf16_f32 v219, v106, v107
    v_mfma_f32_16x16x32_bf16 v[84:87], v[28:31], a[84:87], v[84:87]
    buffer_store_dwordx4 v[216:219], v2, s[4:7], s66 offen offset:2048 sc1
    v_fmac_f32 v108, v136, v131
    v_mfma_f32_16x16x32_bf16 v[88:91], v[28:31], a[88:91], v[88:91]
    v_fmac_f32 v109, v137, v131
    v_fmac_f32 v110, v138, v131
    v_mfma_f32_16x16x32_bf16 v[92:95], v[28:31], a[92:95], v[92:95]
    v_fmac_f32 v111, v139, v131
    v_fmac_f32 v124, v140, v131
    s_waitcnt lgkmcnt(3)
    v_mfma_f32_16x16x32_bf16 v[64:67], v[8:11], a[96:99], v[64:67]
    ds_read_b128 v[24:27], v4 offset:16384
    v_fmac_f32 v125, v141, v131
    v_mfma_f32_16x16x32_bf16 v[68:71], v[8:11], a[100:103], v[68:71]
    v_fmac_f32 v126, v142, v131
    v_fmac_f32 v127, v143, v131
    v_mfma_f32_16x16x32_bf16 v[72:75], v[8:11], a[104:107], v[72:75]
    v_mul_f32 v108, v108, v135
    v_mul_f32 v109, v109, v135
    v_mfma_f32_16x16x32_bf16 v[76:79], v[8:11], a[108:111], v[76:79]
    v_mul_f32 v110, v110, v135
    v_mul_f32 v111, v111, v135
    s_waitcnt lgkmcnt(3)
    v_mfma_f32_16x16x32_bf16 v[80:83], v[12:15], a[96:99], v[80:83]
    ds_read_b128 v[28:31], v4 offset:17408
    v_mul_f32 v108, v108, v124
    v_mfma_f32_16x16x32_bf16 v[84:87], v[12:15], a[100:103], v[84:87]
    v_mul_f32 v109, v109, v125
    v_mul_f32 v110, v110, v126
    v_mfma_f32_16x16x32_bf16 v[88:91], v[12:15], a[104:107], v[88:91]
    v_mul_f32 v111, v111, v127
    v_cvt_pk_bf16_f32 v222, v108, v109
    v_mfma_f32_16x16x32_bf16 v[92:95], v[12:15], a[108:111], v[92:95]
    v_cvt_pk_bf16_f32 v223, v110, v111
    buffer_store_dwordx4 v[220:223], v2, s[4:7], s66 offen offset:3072 sc1
    s_waitcnt lgkmcnt(3)
    v_mfma_f32_16x16x32_bf16 v[64:67], v[16:19], a[112:115], v[64:67]
    ds_read_b128 v[8:11], v4 offset:18432
    v_mfma_f32_16x16x32_bf16 v[68:71], v[16:19], a[116:119], v[68:71]
    v_mfma_f32_16x16x32_bf16 v[72:75], v[16:19], a[120:123], v[72:75]
    v_mfma_f32_16x16x32_bf16 v[76:79], v[16:19], a[124:127], v[76:79]
    s_waitcnt lgkmcnt(3)
    v_mfma_f32_16x16x32_bf16 v[80:83], v[20:23], a[112:115], v[80:83]
    ds_read_b128 v[12:15], v4 offset:19456
    v_mfma_f32_16x16x32_bf16 v[84:87], v[20:23], a[116:119], v[84:87]
    v_mfma_f32_16x16x32_bf16 v[88:91], v[20:23], a[120:123], v[88:91]
    v_mfma_f32_16x16x32_bf16 v[92:95], v[20:23], a[124:127], v[92:95]
    v_and_b32 v7, 3, v1
    v_lshlrev_b32 v7, 2, v7
    s_waitcnt lgkmcnt(3)
    v_mfma_f32_16x16x32_bf16 v[64:67], v[24:27], a[128:131], v[64:67]
    ds_read_b128 v[16:19], v4 offset:20480
    v_mfma_f32_16x16x32_bf16 v[68:71], v[24:27], a[132:135], v[68:71]
    v_mfma_f32_16x16x32_bf16 v[72:75], v[24:27], a[136:139], v[72:75]
    v_mfma_f32_16x16x32_bf16 v[76:79], v[24:27], a[140:143], v[76:79]
    s_waitcnt lgkmcnt(3)
    v_mfma_f32_16x16x32_bf16 v[80:83], v[28:31], a[128:131], v[80:83]
    ds_read_b128 v[20:23], v4 offset:21504
    v_mfma_f32_16x16x32_bf16 v[84:87], v[28:31], a[132:135], v[84:87]
    v_mfma_f32_16x16x32_bf16 v[88:91], v[28:31], a[136:139], v[88:91]
    v_mfma_f32_16x16x32_bf16 v[92:95], v[28:31], a[140:143], v[92:95]
    s_waitcnt lgkmcnt(3)
    v_mfma_f32_16x16x32_bf16 v[64:67], v[8:11], a[144:147], v[64:67]
    ds_read_b128 v[24:27], v4 offset:22528
    v_mfma_f32_16x16x32_bf16 v[68:71], v[8:11], a[148:151], v[68:71]
    v_mfma_f32_16x16x32_bf16 v[72:75], v[8:11], a[152:155], v[72:75]
    v_mfma_f32_16x16x32_bf16 v[76:79], v[8:11], a[156:159], v[76:79]
    s_waitcnt lgkmcnt(3)
    v_mfma_f32_16x16x32_bf16 v[80:83], v[12:15], a[144:147], v[80:83]
    ds_read_b128 v[28:31], v4 offset:23552
    v_mfma_f32_16x16x32_bf16 v[84:87], v[12:15], a[148:151], v[84:87]
    v_mfma_f32_16x16x32_bf16 v[88:91], v[12:15], a[152:155], v[88:91]
    v_mfma_f32_16x16x32_bf16 v[92:95], v[12:15], a[156:159], v[92:95]
    s_waitcnt lgkmcnt(3)
    v_mfma_f32_16x16x32_bf16 v[64:67], v[16:19], a[160:163], v[64:67]
    ds_read_b128 v[8:11], v4 offset:24576
    v_mfma_f32_16x16x32_bf16 v[68:71], v[16:19], a[164:167], v[68:71]
    v_mfma_f32_16x16x32_bf16 v[72:75], v[16:19], a[168:171], v[72:75]
    v_mfma_f32_16x16x32_bf16 v[76:79], v[16:19], a[172:175], v[76:79]
    buffer_load_dword v168, v7, s[4:7], s52 offen sc1
    s_waitcnt lgkmcnt(3)
    v_mfma_f32_16x16x32_bf16 v[80:83], v[20:23], a[160:163], v[80:83]
    ds_read_b128 v[12:15], v4 offset:25600
    v_mfma_f32_16x16x32_bf16 v[84:87], v[20:23], a[164:167], v[84:87]
    v_mfma_f32_16x16x32_bf16 v[88:91], v[20:23], a[168:171], v[88:91]
    v_mfma_f32_16x16x32_bf16 v[92:95], v[20:23], a[172:175], v[92:95]
    s_waitcnt lgkmcnt(3)
    v_mfma_f32_16x16x32_bf16 v[64:67], v[24:27], a[176:179], v[64:67]
    ds_read_b128 v[16:19], v4 offset:26624
    v_mfma_f32_16x16x32_bf16 v[68:71], v[24:27], a[180:183], v[68:71]
    v_mfma_f32_16x16x32_bf16 v[72:75], v[24:27], a[184:187], v[72:75]
    v_mfma_f32_16x16x32_bf16 v[76:79], v[24:27], a[188:191], v[76:79]
    s_waitcnt lgkmcnt(3)
    v_mfma_f32_16x16x32_bf16 v[80:83], v[28:31], a[176:179], v[80:83]
    ds_read_b128 v[20:23], v4 offset:27648
    v_mfma_f32_16x16x32_bf16 v[84:87], v[28:31], a[180:183], v[84:87]
    v_mfma_f32_16x16x32_bf16 v[88:91], v[28:31], a[184:187], v[88:91]
    v_mfma_f32_16x16x32_bf16 v[92:95], v[28:31], a[188:191], v[92:95]
    s_waitcnt lgkmcnt(3)
    v_mfma_f32_16x16x32_bf16 v[64:67], v[8:11], a[192:195], v[64:67]
    ds_read_b128 v[24:27], v4 offset:28672
    v_mfma_f32_16x16x32_bf16 v[68:71], v[8:11], a[196:199], v[68:71]
    v_mfma_f32_16x16x32_bf16 v[72:75], v[8:11], a[200:203], v[72:75]
    v_mfma_f32_16x16x32_bf16 v[76:79], v[8:11], a[204:207], v[76:79]
    s_waitcnt lgkmcnt(3)
    v_mfma_f32_16x16x32_bf16 v[80:83], v[12:15], a[192:195], v[80:83]
    ds_read_b128 v[28:31], v4 offset:29696
    v_mfma_f32_16x16x32_bf16 v[84:87], v[12:15], a[196:199], v[84:87]
    v_mfma_f32_16x16x32_bf16 v[88:91], v[12:15], a[200:203], v[88:91]
    v_mfma_f32_16x16x32_bf16 v[92:95], v[12:15], a[204:207], v[92:95]
    s_waitcnt lgkmcnt(3)
    v_mfma_f32_16x16x32_bf16 v[64:67], v[16:19], a[208:211], v[64:67]
    ds_read_b128 v[8:11], v4 offset:30720
    v_mfma_f32_16x16x32_bf16 v[68:71], v[16:19], a[212:215], v[68:71]
    v_mfma_f32_16x16x32_bf16 v[72:75], v[16:19], a[216:219], v[72:75]
    v_mfma_f32_16x16x32_bf16 v[76:79], v[16:19], a[220:223], v[76:79]
    s_waitcnt lgkmcnt(3)
    v_mfma_f32_16x16x32_bf16 v[80:83], v[20:23], a[208:211], v[80:83]
    ds_read_b128 v[12:15], v4 offset:31744
    v_mfma_f32_16x16x32_bf16 v[84:87], v[20:23], a[212:215], v[84:87]
    v_mfma_f32_16x16x32_bf16 v[88:91], v[20:23], a[216:219], v[88:91]
    v_mfma_f32_16x16x32_bf16 v[92:95], v[20:23], a[220:223], v[92:95]
    s_waitcnt lgkmcnt(3)
    v_mfma_f32_16x16x32_bf16 v[64:67], v[24:27], a[224:227], v[64:67]
    ds_read_b128 v[16:19], v4 offset:32768
    v_mfma_f32_16x16x32_bf16 v[68:71], v[24:27], a[228:231], v[68:71]
    v_mfma_f32_16x16x32_bf16 v[72:75], v[24:27], a[232:235], v[72:75]
    v_mfma_f32_16x16x32_bf16 v[76:79], v[24:27], a[236:239], v[76:79]
    s_waitcnt lgkmcnt(3)
    v_mfma_f32_16x16x32_bf16 v[80:83], v[28:31], a[224:227], v[80:83]
    ds_read_b128 v[20:23], v4 offset:33792
    v_mfma_f32_16x16x32_bf16 v[84:87], v[28:31], a[228:231], v[84:87]
    v_mfma_f32_16x16x32_bf16 v[88:91], v[28:31], a[232:235], v[88:91]
    v_mfma_f32_16x16x32_bf16 v[92:95], v[28:31], a[236:239], v[92:95]
    s_waitcnt lgkmcnt(3)
    v_mfma_f32_16x16x32_bf16 v[64:67], v[8:11], a[240:243], v[64:67]
    ds_read_b128 v[24:27], v4 offset:34816
    v_mfma_f32_16x16x32_bf16 v[68:71], v[8:11], a[244:247], v[68:71]
    v_mfma_f32_16x16x32_bf16 v[72:75], v[8:11], a[248:251], v[72:75]
    v_mfma_f32_16x16x32_bf16 v[76:79], v[8:11], a[252:255], v[76:79]
    s_waitcnt vmcnt(0)
    v_cmp_le_u32 vcc, 1, v168
    s_nop 0
    s_cmp_eq_u64 vcc, exec
    s_cbranch_scc0 L_p0_slow_29
L_p0_back_30:
    s_waitcnt lgkmcnt(3)
    v_mfma_f32_16x16x32_bf16 v[80:83], v[12:15], a[240:243], v[80:83]
    ds_read_b128 v[28:31], v4 offset:35840
    ds_read_b128 v[144:147], v5 offset:896
    v_mfma_f32_16x16x32_bf16 v[84:87], v[12:15], a[244:247], v[84:87]
    s_add_u32 s60, s56, s65
    buffer_load_dwordx2 v[242:243], v3, s[4:7], s60 offen offset:0 sc1
    v_mfma_f32_16x16x32_bf16 v[88:91], v[12:15], a[248:251], v[88:91]
    ds_read_b128 v[148:151], v5 offset:960
    v_mfma_f32_16x16x32_bf16 v[92:95], v[12:15], a[252:255], v[92:95]
    s_waitcnt lgkmcnt(5)
    v_mfma_f32_16x16x32_bf16 v[64:67], v[16:19], v[32:35], v[64:67]
    s_barrier
    v_mfma_f32_16x16x32_bf16 v[68:71], v[16:19], v[36:39], v[68:71]
    v_add_u32 v4, 0xfffe5000, v4
    ds_read_b128 v[8:11], v4 offset:0
    v_mfma_f32_16x16x32_bf16 v[72:75], v[16:19], v[40:43], v[72:75]
    s_add_u32 m0, s49, 73728
    s_add_u32 s61, s48, 368640
    v_mfma_f32_16x16x32_bf16 v[76:79], v[16:19], v[44:47], v[76:79]
    buffer_load_dwordx4 v2, s[4:7], s61 offen offset:0 lds
    s_waitcnt lgkmcnt(5)
    v_mfma_f32_16x16x32_bf16 v[80:83], v[20:23], v[32:35], v[80:83]
    ds_read_b128 v[12:15], v4 offset:1024
    v_mfma_f32_16x16x32_bf16 v[84:87], v[20:23], v[36:39], v[84:87]
    v_mfma_f32_16x16x32_bf16 v[88:91], v[20:23], v[40:43], v[88:91]
    v_mfma_f32_16x16x32_bf16 v[92:95], v[20:23], v[44:47], v[92:95]
    buffer_load_dwordx4 v2, s[4:7], s61 offen offset:1024 lds
    s_waitcnt lgkmcnt(5)
    v_mfma_f32_16x16x32_bf16 v[64:67], v[24:27], v[48:51], v[64:67]
    ds_read_b128 v[16:19], v4 offset:2048
    v_mfma_f32_16x16x32_bf16 v[68:71], v[24:27], v[52:55], v[68:71]
    v_mov_b32 v6, 2
    v_mov_b32 v0, 0
    v_mfma_f32_16x16x32_bf16 v[72:75], v[24:27], v[56:59], v[72:75]
    v_mfma_f32_16x16x32_bf16 v[76:79], v[24:27], v[60:63], v[76:79]
    buffer_load_dwordx4 v2, s[4:7], s61 offen offset:2048 lds
    s_waitcnt lgkmcnt(5)
    v_mfma_f32_16x16x32_bf16 v[80:83], v[28:31], v[48:51], v[80:83]
    ds_read_b128 v[20:23], v4 offset:3072
    v_mfma_f32_16x16x32_bf16 v[84:87], v[28:31], v[52:55], v[84:87]
    v_mfma_f32_16x16x32_bf16 v[88:91], v[28:31], v[56:59], v[88:91]
    s_mov_b64 exec, 1
    buffer_store_dword v6, v0, s[4:7], s67 offen sc1
    s_mov_b64 exec, -1
    v_mfma_f32_16x16x32_bf16 v[92:95], v[28:31], v[60:63], v[92:95]
    s_waitcnt lgkmcnt(3)
    v_mfma_f32_16x16x32_bf16 v[96:99], v[8:11], a[0:3], 0
    ds_read_b128 v[24:27], v4 offset:4096
    v_mfma_f32_16x16x32_bf16 v[100:103], v[8:11], a[4:7], 0
    v_mfma_f32_16x16x32_bf16 v[104:107], v[8:11], a[8:11], 0
    buffer_load_dwordx4 v2, s[4:7], s61 offen offset:3072 lds
    s_add_u32 m0, s49, 77824
    v_mfma_f32_16x16x32_bf16 v[108:111], v[8:11], a[12:15], 0
    s_add_u32 s61, s48, 372736
    s_waitcnt lgkmcnt(3)
    v_mfma_f32_16x16x32_bf16 v[112:115], v[12:15], a[0:3], 0
    ds_read_b128 v[28:31], v4 offset:5120
    v_mfma_f32_16x16x32_bf16 v[116:119], v[12:15], a[4:7], 0
    v_fmac_f32 v64, v144, v128
    v_fmac_f32 v65, v145, v128
    v_mfma_f32_16x16x32_bf16 v[120:123], v[12:15], a[8:11], 0
    buffer_load_dwordx4 v2, s[4:7], s61 offen offset:0 lds
    v_fmac_f32 v66, v146, v128
    v_mfma_f32_16x16x32_bf16 v[124:127], v[12:15], a[12:15], 0
    v_fmac_f32 v67, v147, v128
    v_fmac_f32 v80, v148, v128
    s_waitcnt lgkmcnt(3)
    v_mfma_f32_16x16x32_bf16 v[96:99], v[16:19], a[16:19], v[96:99]
    ds_read_b128 v[8:11], v4 offset:6144
    v_fmac_f32 v81, v149, v128
    v_mfma_f32_16x16x32_bf16 v[100:103], v[16:19], a[20:23], v[100:103]
    v_fmac_f32 v82, v150, v128
    v_fmac_f32 v83, v151, v128
    v_mfma_f32_16x16x32_bf16 v[104:107], v[16:19], a[24:27], v[104:107]
    buffer_load_dwordx4 v2, s[4:7], s61 offen offset:1024 lds
    v_mul_f32 v64, v64, v132
    v_mfma_f32_16x16x32_bf16 v[108:111], v[16:19], a[28:31], v[108:111]
    v_mul_f32 v65, v65, v132
    v_mul_f32 v66, v66, v132
    s_waitcnt lgkmcnt(3)
    v_mfma_f32_16x16x32_bf16 v[112:115], v[20:23], a[16:19], v[112:115]
    ds_read_b128 v[12:15], v4 offset:7168
    v_mul_f32 v67, v67, v132
    v_mfma_f32_16x16x32_bf16 v[116:119], v[20:23], a[20:23], v[116:119]
    v_mul_f32 v64, v64, v80
    v_mul_f32 v65, v65, v81
    v_mfma_f32_16x16x32_bf16 v[120:123], v[20:23], a[24:27], v[120:123]
    buffer_load_dwordx4 v2, s[4:7], s61 offen offset:2048 lds
    v_mul_f32 v66, v66, v82
    v_mfma_f32_16x16x32_bf16 v[124:127], v[20:23], a[28:31], v[124:127]
    v_mul_f32 v67, v67, v83
    v_cvt_pk_bf16_f32 v224, v64, v65
    s_waitcnt lgkmcnt(3)
    v_mfma_f32_16x16x32_bf16 v[96:99], v[24:27], a[32:35], v[96:99]
    ds_read_b128 v[16:19], v4 offset:8192
    v_cvt_pk_bf16_f32 v225, v66, v67
    v_mfma_f32_16x16x32_bf16 v[100:103], v[24:27], a[36:39], v[100:103]
    v_fmac_f32 v68, v144, v129
    v_fmac_f32 v69, v145, v129
    v_mfma_f32_16x16x32_bf16 v[104:107], v[24:27], a[40:43], v[104:107]
    buffer_load_dwordx4 v2, s[4:7], s61 offen offset:3072 lds
    s_add_u32 m0, s49, 81920
    v_mfma_f32_16x16x32_bf16 v[108:111], v[24:27], a[44:47], v[108:111]
    s_add_u32 s61, s48, 376832
    v_fmac_f32 v70, v146, v129
    s_waitcnt lgkmcnt(3)
    v_mfma_f32_16x16x32_bf16 v[112:115], v[28:31], a[32:35], v[112:115]
    ds_read_b128 v[20:23], v4 offset:9216
    v_fmac_f32 v71, v147, v129
    v_mfma_f32_16x16x32_bf16 v[116:119], v[28:31], a[36:39], v[116:119]
    v_fmac_f32 v84, v148, v129
    v_fmac_f32 v85, v149, v129
    v_mfma_f32_16x16x32_bf16 v[120:123], v[28:31], a[40:43], v[120:123]
    buffer_load_dwordx4 v2, s[4:7], s61 offen offset:0 lds
    v_fmac_f32 v86, v150, v129
    v_mfma_f32_16x16x32_bf16 v[124:127], v[28:31], a[44:47], v[124:127]
    v_fmac_f32 v87, v151, v129
    v_mul_f32 v68, v68, v133
    s_waitcnt lgkmcnt(3)
    v_mfma_f32_16x16x32_bf16 v[96:99], v[8:11], a[48:51], v[96:99]
    ds_read_b128 v[24:27], v4 offset:10240
    v_mul_f32 v69, v69, v133
    v_mfma_f32_16x16x32_bf16 v[100:103], v[8:11], a[52:55], v[100:103]
    v_mul_f32 v70, v70, v133
    v_mul_f32 v71, v71, v133
    v_mfma_f32_16x16x32_bf16 v[104:107], v[8:11], a[56:59], v[104:107]
    buffer_load_dwordx2 v[246:247], v3, s[4:7], s60 offen offset:512 sc1
    v_mul_f32 v68, v68, v84
    v_mfma_f32_16x16x32_bf16 v[108:111], v[8:11], a[60:63], v[108:111]
    v_mul_f32 v69, v69, v85
    v_mul_f32 v70, v70, v86
    s_waitcnt lgkmcnt(3)
    v_mfma_f32_16x16x32_bf16 v[112:115], v[12:15], a[48:51], v[112:115]
    ds_read_b128 v[28:31], v4 offset:11264
    v_mul_f32 v71, v71, v87
    v_mfma_f32_16x16x32_bf16 v[116:119], v[12:15], a[52:55], v[116:119]
    v_cvt_pk_bf16_f32 v228, v68, v69
    v_cvt_pk_bf16_f32 v229, v70, v71
    v_mfma_f32_16x16x32_bf16 v[120:123], v[12:15], a[56:59], v[120:123]
    buffer_load_dwordx2 v[250:251], v3, s[4:7], s60 offen offset:1024 sc1
    v_fmac_f32 v72, v144, v130
    v_mfma_f32_16x16x32_bf16 v[124:127], v[12:15], a[60:63], v[124:127]
    v_fmac_f32 v73, v145, v130
    v_fmac_f32 v74, v146, v130
    s_waitcnt lgkmcnt(3)
    v_mfma_f32_16x16x32_bf16 v[96:99], v[16:19], a[64:67], v[96:99]
    ds_read_b128 v[8:11], v4 offset:12288
    v_fmac_f32 v75, v147, v130
    v_mfma_f32_16x16x32_bf16 v[100:103], v[16:19], a[68:71], v[100:103]
    v_fmac_f32 v88, v148, v130
    v_fmac_f32 v89, v149, v130
    v_mfma_f32_16x16x32_bf16 v[104:107], v[16:19], a[72:75], v[104:107]
    buffer_load_dwordx2 v[254:255], v3, s[4:7], s60 offen offset:1536 sc1
    s_add_u32 s60, s57, s65
    v_mfma_f32_16x16x32_bf16 v[108:111], v[16:19], a[76:79], v[108:111]
    v_fmac_f32 v90, v150, v130
    v_fmac_f32 v91, v151, v130
    s_waitcnt lgkmcnt(3)
    v_mfma_f32_16x16x32_bf16 v[112:115], v[20:23], a[64:67], v[112:115]
    ds_read_b128 v[12:15], v4 offset:13312
    v_mul_f32 v72, v72, v134
    v_mfma_f32_16x16x32_bf16 v[116:119], v[20:23], a[68:71], v[116:119]
    v_mul_f32 v73, v73, v134
    v_mul_f32 v74, v74, v134
    v_mfma_f32_16x16x32_bf16 v[120:123], v[20:23], a[72:75], v[120:123]
    buffer_load_dwordx2 a[0:1], v3, s[4:7], s60 offen offset:0 sc1
    v_mul_f32 v75, v75, v134
    v_mfma_f32_16x16x32_bf16 v[124:127], v[20:23], a[76:79], v[124:127]
    v_mul_f32 v72, v72, v88
    v_mul_f32 v73, v73, v89
    s_waitcnt lgkmcnt(3)
    v_mfma_f32_16x16x32_bf16 v[96:99], v[24:27], a[80:83], v[96:99]
    ds_read_b128 v[16:19], v4 offset:14336
    v_mul_f32 v74, v74, v90
    v_mfma_f32_16x16x32_bf16 v[100:103], v[24:27], a[84:87], v[100:103]
    v_mul_f32 v75, v75, v91
    v_cvt_pk_bf16_f32 v232, v72, v73
    v_mfma_f32_16x16x32_bf16 v[104:107], v[24:27], a[88:91], v[104:107]
    buffer_load_dwordx2 a[4:5], v3, s[4:7], s60 offen offset:512 sc1
    v_cvt_pk_bf16_f32 v233, v74, v75
    v_mfma_f32_16x16x32_bf16 v[108:111], v[24:27], a[92:95], v[108:111]
    v_fmac_f32 v76, v144, v131
    v_fmac_f32 v77, v145, v131
    s_waitcnt lgkmcnt(3)
    v_mfma_f32_16x16x32_bf16 v[112:115], v[28:31], a[80:83], v[112:115]
    ds_read_b128 v[20:23], v4 offset:15360
    v_fmac_f32 v78, v146, v131
    v_mfma_f32_16x16x32_bf16 v[116:119], v[28:31], a[84:87], v[116:119]
    v_fmac_f32 v79, v147, v131
    v_fmac_f32 v92, v148, v131
    v_mfma_f32_16x16x32_bf16 v[120:123], v[28:31], a[88:91], v[120:123]
    buffer_load_dwordx2 a[8:9], v3, s[4:7], s60 offen offset:1024 sc1
    v_fmac_f32 v93, v149, v131
    v_mfma_f32_16x16x32_bf16 v[124:127], v[28:31], a[92:95], v[124:127]
    v_fmac_f32 v94, v150, v131
    v_fmac_f32 v95, v151, v131
    s_waitcnt lgkmcnt(3)
    v_mfma_f32_16x16x32_bf16 v[96:99], v[8:11], a[96:99], v[96:99]
    ds_read_b128 v[24:27], v4 offset:16384
    v_mul_f32 v76, v76, v135
    v_mfma_f32_16x16x32_bf16 v[100:103], v[8:11], a[100:103], v[100:103]
    v_mul_f32 v77, v77, v135
    v_mul_f32 v78, v78, v135
    v_mfma_f32_16x16x32_bf16 v[104:107], v[8:11], a[104:107], v[104:107]
    buffer_load_dwordx2 a[12:13], v3, s[4:7], s60 offen offset:1536 sc1
    s_add_u32 s60, s58, s65
    v_mfma_f32_16x16x32_bf16 v[108:111], v[8:11], a[108:111], v[108:111]
    v_mul_f32 v79, v79, v135
    v_mul_f32 v76, v76, v92
    s_waitcnt lgkmcnt(3)
    v_mfma_f32_16x16x32_bf16 v[112:115], v[12:15], a[96:99], v[112:115]
    ds_read_b128 v[28:31], v4 offset:17408
    v_mul_f32 v77, v77, v93
    v_mfma_f32_16x16x32_bf16 v[116:119], v[12:15], a[100:103], v[116:119]
    v_mul_f32 v78, v78, v94
    v_mul_f32 v79, v79, v95
    v_mfma_f32_16x16x32_bf16 v[120:123], v[12:15], a[104:107], v[120:123]
    buffer_load_dwordx2 a[2:3], v3, s[4:7], s60 offen offset:0 sc1
    v_cvt_pk_bf16_f32 v236, v76, v77
    v_mfma_f32_16x16x32_bf16 v[124:127], v[12:15], a[108:111], v[124:127]
    v_cvt_pk_bf16_f32 v237, v78, v79
    s_waitcnt lgkmcnt(3)
    v_mfma_f32_16x16x32_bf16 v[96:99], v[16:19], a[112:115], v[96:99]
    ds_read_b128 v[8:11], v4 offset:18432
    v_mfma_f32_16x16x32_bf16 v[100:103], v[16:19], a[116:119], v[100:103]
    v_mfma_f32_16x16x32_bf16 v[104:107], v[16:19], a[120:123], v[104:107]
    buffer_load_dwordx2 a[6:7], v3, s[4:7], s60 offen offset:512 sc1
    v_mfma_f32_16x16x32_bf16 v[108:111], v[16:19], a[124:127], v[108:111]
    s_waitcnt lgkmcnt(3)
    v_mfma_f32_16x16x32_bf16 v[112:115], v[20:23], a[112:115], v[112:115]
    ds_read_b128 v[12:15], v4 offset:19456
    v_mfma_f32_16x16x32_bf16 v[116:119], v[20:23], a[116:119], v[116:119]
    v_mfma_f32_16x16x32_bf16 v[120:123], v[20:23], a[120:123], v[120:123]
    buffer_load_dwordx2 a[10:11], v3, s[4:7], s60 offen offset:1024 sc1
    v_mfma_f32_16x16x32_bf16 v[124:127], v[20:23], a[124:127], v[124:127]
    s_waitcnt lgkmcnt(3)
    v_mfma_f32_16x16x32_bf16 v[96:99], v[24:27], a[128:131], v[96:99]
    ds_read_b128 v[16:19], v4 offset:20480
    v_mfma_f32_16x16x32_bf16 v[100:103], v[24:27], a[132:135], v[100:103]
    v_mfma_f32_16x16x32_bf16 v[104:107], v[24:27], a[136:139], v[104:107]
    buffer_load_dwordx2 a[14:15], v3, s[4:7], s60 offen offset:1536 sc1
    s_add_u32 s60, s56, 0
    v_mfma_f32_16x16x32_bf16 v[108:111], v[24:27], a[140:143], v[108:111]
    s_waitcnt lgkmcnt(3)
    v_mfma_f32_16x16x32_bf16 v[112:115], v[28:31], a[128:131], v[112:115]
    ds_read_b128 v[20:23], v4 offset:21504
    v_mfma_f32_16x16x32_bf16 v[116:119], v[28:31], a[132:135], v[116:119]
    v_mfma_f32_16x16x32_bf16 v[120:123], v[28:31], a[136:139], v[120:123]
    buffer_load_dwordx4 a[16:19], v2, s[4:7], s60 offen offset:0 sc1
    v_mfma_f32_16x16x32_bf16 v[124:127], v[28:31], a[140:143], v[124:127]
    s_waitcnt lgkmcnt(3)
    v_mfma_f32_16x16x32_bf16 v[96:99], v[8:11], a[144:147], v[96:99]
    ds_read_b128 v[24:27], v4 offset:22528
    v_mfma_f32_16x16x32_bf16 v[100:103], v[8:11], a[148:151], v[100:103]
    v_mfma_f32_16x16x32_bf16 v[104:107], v[8:11], a[152:155], v[104:107]
    buffer_load_dwordx4 a[20:23], v2, s[4:7], s60 offen offset:1024 sc1
    v_mfma_f32_16x16x32_bf16 v[108:111], v[8:11], a[156:159], v[108:111]
    s_waitcnt lgkmcnt(3)
    v_mfma_f32_16x16x32_bf16 v[112:115], v[12:15], a[144:147], v[112:115]
    ds_read_b128 v[28:31], v4 offset:23552
    v_mfma_f32_16x16x32_bf16 v[116:119], v[12:15], a[148:151], v[116:119]
    v_mfma_f32_16x16x32_bf16 v[120:123], v[12:15], a[152:155], v[120:123]
    buffer_load_dwordx4 a[24:27], v2, s[4:7], s60 offen offset:2048 sc1
    v_mfma_f32_16x16x32_bf16 v[124:127], v[12:15], a[156:159], v[124:127]
    s_waitcnt lgkmcnt(3)
    v_mfma_f32_16x16x32_bf16 v[96:99], v[16:19], a[160:163], v[96:99]
    ds_read_b128 v[8:11], v4 offset:24576
    v_mfma_f32_16x16x32_bf16 v[100:103], v[16:19], a[164:167], v[100:103]
    v_mfma_f32_16x16x32_bf16 v[104:107], v[16:19], a[168:171], v[104:107]
    buffer_load_dwordx4 a[28:31], v2, s[4:7], s60 offen offset:3072 sc1
    s_add_u32 s60, s57, 0
    v_mfma_f32_16x16x32_bf16 v[108:111], v[16:19], a[172:175], v[108:111]
    s_waitcnt lgkmcnt(3)
    v_mfma_f32_16x16x32_bf16 v[112:115], v[20:23], a[160:163], v[112:115]
    ds_read_b128 v[12:15], v4 offset:25600
    v_mfma_f32_16x16x32_bf16 v[116:119], v[20:23], a[164:167], v[116:119]
    v_mfma_f32_16x16x32_bf16 v[120:123], v[20:23], a[168:171], v[120:123]
    buffer_load_dwordx4 a[32:35], v2, s[4:7], s60 offen offset:0 sc1
    v_mfma_f32_16x16x32_bf16 v[124:127], v[20:23], a[172:175], v[124:127]
    s_waitcnt lgkmcnt(3)
    v_mfma_f32_16x16x32_bf16 v[96:99], v[24:27], a[176:179], v[96:99]
    ds_read_b128 v[16:19], v4 offset:26624
    v_mfma_f32_16x16x32_bf16 v[100:103], v[24:27], a[180:183], v[100:103]
    v_mfma_f32_16x16x32_bf16 v[104:107], v[24:27], a[184:187], v[104:107]
    buffer_load_dwordx4 a[36:39], v2, s[4:7], s60 offen offset:1024 sc1
    v_mfma_f32_16x16x32_bf16 v[108:111], v[24:27], a[188:191], v[108:111]
    s_waitcnt lgkmcnt(3)
    v_mfma_f32_16x16x32_bf16 v[112:115], v[28:31], a[176:179], v[112:115]
    ds_read_b128 v[20:23], v4 offset:27648
    v_mfma_f32_16x16x32_bf16 v[116:119], v[28:31], a[180:183], v[116:119]
    v_mfma_f32_16x16x32_bf16 v[120:123], v[28:31], a[184:187], v[120:123]
    buffer_load_dwordx4 a[40:43], v2, s[4:7], s60 offen offset:2048 sc1
    v_mfma_f32_16x16x32_bf16 v[124:127], v[28:31], a[188:191], v[124:127]
    s_waitcnt lgkmcnt(3)
    v_mfma_f32_16x16x32_bf16 v[96:99], v[8:11], a[192:195], v[96:99]
    ds_read_b128 v[24:27], v4 offset:28672
    v_mfma_f32_16x16x32_bf16 v[100:103], v[8:11], a[196:199], v[100:103]
    v_mfma_f32_16x16x32_bf16 v[104:107], v[8:11], a[200:203], v[104:107]
    buffer_load_dwordx4 a[44:47], v2, s[4:7], s60 offen offset:3072 sc1
    s_add_u32 s60, s58, 0
    v_mfma_f32_16x16x32_bf16 v[108:111], v[8:11], a[204:207], v[108:111]
    s_waitcnt lgkmcnt(3)
    v_mfma_f32_16x16x32_bf16 v[112:115], v[12:15], a[192:195], v[112:115]
    ds_read_b128 v[28:31], v4 offset:29696
    v_mfma_f32_16x16x32_bf16 v[116:119], v[12:15], a[196:199], v[116:119]
    v_mfma_f32_16x16x32_bf16 v[120:123], v[12:15], a[200:203], v[120:123]
    buffer_load_dwordx4 a[48:51], v2, s[4:7], s60 offen offset:0 sc1
    v_mfma_f32_16x16x32_bf16 v[124:127], v[12:15], a[204:207], v[124:127]
    s_waitcnt lgkmcnt(3)
    v_mfma_f32_16x16x32_bf16 v[96:99], v[16:19], a[208:211], v[96:99]
    ds_read_b128 v[8:11], v4 offset:30720
    v_mfma_f32_16x16x32_bf16 v[100:103], v[16:19], a[212:215], v[100:103]
    v_mfma_f32_16x16x32_bf16 v[104:107], v[16:19], a[216:219], v[104:107]
    buffer_load_dwordx4 a[52:55], v2, s[4:7], s60 offen offset:1024 sc1
    v_mfma_f32_16x16x32_bf16 v[108:111], v[16:19], a[220:223], v[108:111]
    s_waitcnt lgkmcnt(3)
    v_mfma_f32_16x16x32_bf16 v[112:115], v[20:23], a[208:211], v[112:115]
    ds_read_b128 v[12:15], v4 offset:31744
    v_mfma_f32_16x16x32_bf16 v[116:119], v[20:23], a[212:215], v[116:119]
    v_mfma_f32_16x16x32_bf16 v[120:123], v[20:23], a[216:219], v[120:123]
    buffer_load_dwordx4 a[56:59], v2, s[4:7], s60 offen offset:2048 sc1
    v_mfma_f32_16x16x32_bf16 v[124:127], v[20:23], a[220:223], v[124:127]
    s_waitcnt lgkmcnt(3)
    v_mfma_f32_16x16x32_bf16 v[96:99], v[24:27], a[224:227], v[96:99]
    ds_read_b128 v[16:19], v4 offset:32768
    v_mfma_f32_16x16x32_bf16 v[100:103], v[24:27], a[228:231], v[100:103]
    v_mfma_f32_16x16x32_bf16 v[104:107], v[24:27], a[232:235], v[104:107]
    buffer_load_dwordx4 a[60:63], v2, s[4:7], s60 offen offset:3072 sc1
    s_add_u32 s60, s56, 16384
    v_mfma_f32_16x16x32_bf16 v[108:111], v[24:27], a[236:239], v[108:111]
    s_waitcnt lgkmcnt(3)
    v_mfma_f32_16x16x32_bf16 v[112:115], v[28:31], a[224:227], v[112:115]
    ds_read_b128 v[20:23], v4 offset:33792
    v_mfma_f32_16x16x32_bf16 v[116:119], v[28:31], a[228:231], v[116:119]
    v_mfma_f32_16x16x32_bf16 v[120:123], v[28:31], a[232:235], v[120:123]
    buffer_load_dwordx4 a[64:67], v2, s[4:7], s60 offen offset:0 sc1
    v_mfma_f32_16x16x32_bf16 v[124:127], v[28:31], a[236:239], v[124:127]
    s_waitcnt lgkmcnt(3)
    v_mfma_f32_16x16x32_bf16 v[96:99], v[8:11], a[240:243], v[96:99]
    ds_read_b128 v[24:27], v4 offset:34816
    v_mfma_f32_16x16x32_bf16 v[100:103], v[8:11], a[244:247], v[100:103]
    v_mfma_f32_16x16x32_bf16 v[104:107], v[8:11], a[248:251], v[104:107]
    buffer_load_dwordx4 a[68:71], v2, s[4:7], s60 offen offset:1024 sc1
    v_mfma_f32_16x16x32_bf16 v[108:111], v[8:11], a[252:255], v[108:111]
    ds_read_b128 v[136:139], v5 offset:1024
    ds_read_b128 v[140:143], v5 offset:1088
    s_waitcnt lgkmcnt(5)
    v_mfma_f32_16x16x32_bf16 v[112:115], v[12:15], a[240:243], v[112:115]
    ds_read_b128 v[28:31], v4 offset:35840
    v_mfma_f32_16x16x32_bf16 v[116:119], v[12:15], a[244:247], v[116:119]
    v_mfma_f32_16x16x32_bf16 v[120:123], v[12:15], a[248:251], v[120:123]
    buffer_load_dwordx4 a[72:75], v2, s[4:7], s60 offen offset:2048 sc1
    v_mfma_f32_16x16x32_bf16 v[124:127], v[12:15], a[252:255], v[124:127]
    s_waitcnt lgkmcnt(5)
    v_mfma_f32_16x16x32_bf16 v[96:99], v[16:19], v[32:35], v[96:99]
    s_barrier
    v_mfma_f32_16x16x32_bf16 v[100:103], v[16:19], v[36:39], v[100:103]
    v_add_u32 v4, 0x9000, v4
    ds_read_b128 v[8:11], v4 offset:0
    v_mfma_f32_16x16x32_bf16 v[104:107], v[16:19], v[40:43], v[104:107]
    buffer_load_dwordx4 a[76:79], v2, s[4:7], s60 offen offset:3072 sc1
    s_add_u32 s60, s57, 16384
    v_mfma_f32_16x16x32_bf16 v[108:111], v[16:19], v[44:47], v[108:111]
    s_add_u32 m0, s49, 110592
    s_add_u32 s61, s48, 405504
    s_waitcnt lgkmcnt(5)
    v_mfma_f32_16x16x32_bf16 v[112:115], v[20:23], v[32:35], v[112:115]
    ds_read_b128 v[12:15], v4 offset:1024
    v_mfma_f32_16x16x32_bf16 v[116:119], v[20:23], v[36:39], v[116:119]
    v_mfma_f32_16x16x32_bf16 v[120:123], v[20:23], v[40:43], v[120:123]
    buffer_load_dwordx4 a[80:83], v2, s[4:7], s60 offen offset:0 sc1
    v_mfma_f32_16x16x32_bf16 v[124:127], v[20:23], v[44:47], v[124:127]
    s_waitcnt lgkmcnt(5)
    v_mfma_f32_16x16x32_bf16 v[96:99], v[24:27], v[48:51], v[96:99]
    ds_read_b128 v[16:19], v4 offset:2048
    v_mfma_f32_16x16x32_bf16 v[100:103], v[24:27], v[52:55], v[100:103]
    v_mfma_f32_16x16x32_bf16 v[104:107], v[24:27], v[56:59], v[104:107]
    buffer_load_dwordx4 a[84:87], v2, s[4:7], s60 offen offset:1024 sc1
    v_mfma_f32_16x16x32_bf16 v[108:111], v[24:27], v[60:63], v[108:111]
    s_waitcnt lgkmcnt(3)
    v_mfma_f32_16x16x32_bf16 v[112:115], v[28:31], v[48:51], v[112:115]
    ds_read_b128 v[20:23], v4 offset:3072
    v_mfma_f32_16x16x32_bf16 v[116:119], v[28:31], v[52:55], v[116:119]
    v_mfma_f32_16x16x32_bf16 v[120:123], v[28:31], v[56:59], v[120:123]
    buffer_load_dwordx4 a[88:91], v2, s[4:7], s60 offen offset:2048 sc1
    v_mfma_f32_16x16x32_bf16 v[124:127], v[28:31], v[60:63], v[124:127]
    s_waitcnt lgkmcnt(3)
    v_mfma_f32_16x16x32_bf16 v[32:35], v[8:11], v[176:179], 0
    ds_read_b128 v[24:27], v4 offset:4096
    v_mfma_f32_16x16x32_bf16 v[40:43], v[8:11], v[180:183], 0
    v_mfma_f32_16x16x32_bf16 v[48:51], v[8:11], v[184:187], 0
    buffer_load_dwordx4 a[92:95], v2, s[4:7], s60 offen offset:3072 sc1
    s_add_u32 s60, s58, 16384
    v_mfma_f32_16x16x32_bf16 v[56:59], v[8:11], v[188:191], 0
    s_waitcnt lgkmcnt(3)
    v_mfma_f32_16x16x32_bf16 v[36:39], v[12:15], v[176:179], 0
    ds_read_b128 v[28:31], v4 offset:5120
    v_mfma_f32_16x16x32_bf16 v[44:47], v[12:15], v[180:183], 0
    v_fmac_f32 v96, v136, v128
    v_fmac_f32 v97, v137, v128
    v_mfma_f32_16x16x32_bf16 v[52:55], v[12:15], v[184:187], 0
    buffer_load_dwordx4 a[96:99], v2, s[4:7], s60 offen offset:0 sc1
    v_fmac_f32 v98, v138, v128
    v_mfma_f32_16x16x32_bf16 v[60:63], v[12:15], v[188:191], 0
    v_fmac_f32 v99, v139, v128
    v_fmac_f32 v112, v140, v128
    s_waitcnt lgkmcnt(3)
    v_mfma_f32_16x16x32_bf16 v[64:67], v[16:19], v[176:179], 0
    ds_read_b128 v[8:11], v4 offset:6144
    v_fmac_f32 v113, v141, v128
    v_mfma_f32_16x16x32_bf16 v[72:75], v[16:19], v[180:183], 0
    v_fmac_f32 v114, v142, v128
    v_fmac_f32 v115, v143, v128
    v_mfma_f32_16x16x32_bf16 v[80:83], v[16:19], v[184:187], 0
    buffer_load_dwordx4 a[100:103], v2, s[4:7], s60 offen offset:1024 sc1
    v_mul_f32 v96, v96, v132
    v_mfma_f32_16x16x32_bf16 v[88:91], v[16:19], v[188:191], 0
    v_mul_f32 v97, v97, v132
    v_mul_f32 v98, v98, v132
    s_waitcnt lgkmcnt(3)
    v_mfma_f32_16x16x32_bf16 v[68:71], v[20:23], v[176:179], 0
    ds_read_b128 v[12:15], v4 offset:7168
    v_mul_f32 v99, v99, v132
    v_mfma_f32_16x16x32_bf16 v[76:79], v[20:23], v[180:183], 0
    v_mul_f32 v96, v96, v112
    v_mul_f32 v97, v97, v113
    v_mfma_f32_16x16x32_bf16 v[84:87], v[20:23], v[184:187], 0
    buffer_load_dwordx4 a[104:107], v2, s[4:7], s60 offen offset:2048 sc1
    v_mul_f32 v98, v98, v114
    v_mfma_f32_16x16x32_bf16 v[92:95], v[20:23], v[188:191], 0
    v_mul_f32 v99, v99, v115
    v_cvt_pk_bf16_f32 v226, v96, v97
    s_waitcnt lgkmcnt(3)
    v_mfma_f32_16x16x32_bf16 v[32:35], v[24:27], v[192:195], v[32:35]
    ds_read_b128 v[16:19], v4 offset:8192
    v_cvt_pk_bf16_f32 v227, v98, v99
    v_mfma_f32_16x16x32_bf16 v[40:43], v[24:27], v[196:199], v[40:43]
    s_add_u32 s66, s51, 49152
    v_mfma_f32_16x16x32_bf16 v[48:51], v[24:27], v[200:203], v[48:51]
    buffer_store_dwordx4 v[224:227], v2, s[4:7], s66 offen offset:0 sc1
    v_fmac_f32 v100, v136, v129
    v_mfma_f32_16x16x32_bf16 v[56:59], v[24:27], v[204:207], v[56:59]
    v_fmac_f32 v101, v137, v129
    v_fmac_f32 v102, v138, v129
    s_waitcnt lgkmcnt(3)
    v_mfma_f32_16x16x32_bf16 v[36:39], v[28:31], v[192:195], v[36:39]
    ds_read_b128 v[20:23], v4 offset:9216
    v_fmac_f32 v103, v139, v129
    v_mfma_f32_16x16x32_bf16 v[44:47], v[28:31], v[196:199], v[44:47]
    v_fmac_f32 v116, v140, v129
    v_fmac_f32 v117, v141, v129
    v_mfma_f32_16x16x32_bf16 v[52:55], v[28:31], v[200:203], v[52:55]
    buffer_load_dwordx4 a[108:111], v2, s[4:7], s60 offen offset:3072 sc1
    v_fmac_f32 v118, v142, v129
    v_mfma_f32_16x16x32_bf16 v[60:63], v[28:31], v[204:207], v[60:63]
    v_fmac_f32 v119, v143, v129
    v_mul_f32 v100, v100, v133
    s_waitcnt lgkmcnt(3)
    v_mfma_f32_16x16x32_bf16 v[64:67], v[8:11], v[192:195], v[64:67]
    ds_read_b128 v[24:27], v4 offset:10240
    v_mul_f32 v101, v101, v133
    v_mfma_f32_16x16x32_bf16 v[72:75], v[8:11], v[196:199], v[72:75]
    v_mul_f32 v102, v102, v133
    v_mul_f32 v103, v103, v133
    v_mfma_f32_16x16x32_bf16 v[80:83], v[8:11], v[200:203], v[80:83]
    buffer_load_dwordx4 v2, s[4:7], s61 offen offset:0 lds
    v_mul_f32 v100, v100, v116
    v_mfma_f32_16x16x32_bf16 v[88:91], v[8:11], v[204:207], v[88:91]
    v_mul_f32 v101, v101, v117
    v_mul_f32 v102, v102, v118
    s_waitcnt lgkmcnt(3)
    v_mfma_f32_16x16x32_bf16 v[68:71], v[12:15], v[192:195], v[68:71]
    ds_read_b128 v[28:31], v4 offset:11264
    v_mul_f32 v103, v103, v119
    v_mfma_f32_16x16x32_bf16 v[76:79], v[12:15], v[196:199], v[76:79]
    v_cvt_pk_bf16_f32 v230, v100, v101
    v_cvt_pk_bf16_f32 v231, v102, v103
    v_mfma_f32_16x16x32_bf16 v[84:87], v[12:15], v[200:203], v[84:87]
    buffer_store_dwordx4 v[228:231], v2, s[4:7], s66 offen offset:1024 sc1
    v_fmac_f32 v104, v136, v130
    v_mfma_f32_16x16x32_bf16 v[92:95], v[12:15], v[204:207], v[92:95]
    v_fmac_f32 v105, v137, v130
    v_fmac_f32 v106, v138, v130
    s_waitcnt lgkmcnt(3)
    v_mfma_f32_16x16x32_bf16 v[32:35], v[16:19], v[208:211], v[32:35]
    ds_read_b128 v[8:11], v4 offset:12288
    v_fmac_f32 v107, v139, v130
    v_mfma_f32_16x16x32_bf16 v[40:43], v[16:19], v[212:215], v[40:43]
    v_fmac_f32 v120, v140, v130
    v_fmac_f32 v121, v141, v130
    v_mfma_f32_16x16x32_bf16 v[48:51], v[16:19], v[216:219], v[48:51]
    buffer_load_dwordx4 v2, s[4:7], s61 offen offset:1024 lds
    v_fmac_f32 v122, v142, v130
    v_mfma_f32_16x16x32_bf16 v[56:59], v[16:19], v[220:223], v[56:59]
    v_fmac_f32 v123, v143, v130
    v_mul_f32 v104, v104, v134
    s_waitcnt lgkmcnt(3)
    v_mfma_f32_16x16x32_bf16 v[36:39], v[20:23], v[208:211], v[36:39]
    ds_read_b128 v[12:15], v4 offset:13312
    v_mul_f32 v105, v105, v134
    v_mfma_f32_16x16x32_bf16 v[44:47], v[20:23], v[212:215], v[44:47]
    v_mul_f32 v106, v106, v134
    v_mul_f32 v107, v107, v134
    v_mfma_f32_16x16x32_bf16 v[52:55], v[20:23], v[216:219], v[52:55]
    buffer_load_dwordx4 v2, s[4:7], s61 offen offset:2048 lds
    v_mul_f32 v104, v104, v120
    v_mfma_f32_16x16x32_bf16 v[60:63], v[20:23], v[220:223], v[60:63]
    v_mul_f32 v105, v105, v121
    v_mul_f32 v106, v106, v122
    s_waitcnt lgkmcnt(3)
    v_mfma_f32_16x16x32_bf16 v[64:67], v[24:27], v[208:211], v[64:67]
    ds_read_b128 v[16:19], v4 offset:14336
    v_mul_f32 v107, v107, v123
    v_mfma_f32_16x16x32_bf16 v[72:75], v[24:27], v[212:215], v[72:75]
    v_cvt_pk_bf16_f32 v234, v104, v105
    v_cvt_pk_bf16_f32 v235, v106, v107
    v_mfma_f32_16x16x32_bf16 v[80:83], v[24:27], v[216:219], v[80:83]
    buffer_store_dwordx4 v[232:235], v2, s[4:7], s66 offen offset:2048 sc1
    v_fmac_f32 v108, v136, v131
    v_mfma_f32_16x16x32_bf16 v[88:91], v[24:27], v[220:223], v[88:91]
    v_fmac_f32 v109, v137, v131
    v_fmac_f32 v110, v138, v131
    s_waitcnt lgkmcnt(3)
    v_mfma_f32_16x16x32_bf16 v[68:71], v[28:31], v[208:211], v[68:71]
    ds_read_b128 v[20:23], v4 offset:15360
    v_fmac_f32 v111, v139, v131
    v_mfma_f32_16x16x32_bf16 v[76:79], v[28:31], v[212:215], v[76:79]
    v_fmac_f32 v124, v140, v131
    v_fmac_f32 v125, v141, v131
    v_mfma_f32_16x16x32_bf16 v[84:87], v[28:31], v[216:219], v[84:87]
    v_fmac_f32 v126, v142, v131
    v_fmac_f32 v127, v143, v131
    v_mfma_f32_16x16x32_bf16 v[92:95], v[28:31], v[220:223], v[92:95]
    v_mul_f32 v108, v108, v135
    v_mul_f32 v109, v109, v135
    v_mul_f32 v110, v110, v135
    v_mul_f32 v111, v111, v135
    v_mul_f32 v108, v108, v124
    v_mul_f32 v109, v109, v125
    v_mul_f32 v110, v110, v126
    v_mul_f32 v111, v111, v127
    v_cvt_pk_bf16_f32 v238, v108, v109
    v_cvt_pk_bf16_f32 v239, v110, v111
    buffer_store_dwordx4 v[236:239], v2, s[4:7], s66 offen offset:3072 sc1
    s_waitcnt lgkmcnt(3)
    v_mfma_f32_16x16x32_bf16 v[96:99], v[8:11], v[176:179], 0
    ds_read_b128 v[24:27], v4 offset:16384
    v_mfma_f32_16x16x32_bf16 v[104:107], v[8:11], v[180:183], 0
    v_mfma_f32_16x16x32_bf16 v[112:115], v[8:11], v[184:187], 0
    v_mfma_f32_16x16x32_bf16 v[120:123], v[8:11], v[188:191], 0
    buffer_load_dwordx4 v2, s[4:7], s61 offen offset:3072 lds
    s_add_u32 m0, s49, 114688
    s_waitcnt lgkmcnt(3)
    v_mfma_f32_16x16x32_bf16 v[100:103], v[12:15], v[176:179], 0
    ds_read_b128 v[28:31], v4 offset:17408
    s_add_u32 s61, s48, 409600
    v_mfma_f32_16x16x32_bf16 v[108:111], v[12:15], v[180:183], 0
    v_mfma_f32_16x16x32_bf16 v[116:119], v[12:15], v[184:187], 0
    v_mfma_f32_16x16x32_bf16 v[124:127], v[12:15], v[188:191], 0
    buffer_load_dwordx4 v2, s[4:7], s61 offen offset:0 lds
    s_waitcnt lgkmcnt(3)
    v_mfma_f32_16x16x32_bf16 v[128:131], v[16:19], v[176:179], 0
    ds_read_b128 v[8:11], v4 offset:18432
    v_mfma_f32_16x16x32_bf16 v[136:139], v[16:19], v[180:183], 0
    v_mfma_f32_16x16x32_bf16 v[144:147], v[16:19], v[184:187], 0
    v_mfma_f32_16x16x32_bf16 v[152:155], v[16:19], v[188:191], 0
    buffer_load_dword v5, v7, s[4:7], s52 offen sc1
    s_waitcnt lgkmcnt(3)
    v_mfma_f32_16x16x32_bf16 v[132:135], v[20:23], v[176:179], 0
    ds_read_b128 v[12:15], v4 offset:19456
    v_mfma_f32_16x16x32_bf16 v[140:143], v[20:23], v[180:183], 0
    v_mfma_f32_16x16x32_bf16 v[148:151], v[20:23], v[184:187], 0
    v_mfma_f32_16x16x32_bf16 v[156:159], v[20:23], v[188:191], 0
    buffer_load_dwordx4 v2, s[4:7], s61 offen offset:1024 lds
    s_waitcnt lgkmcnt(3)
    v_mfma_f32_16x16x32_bf16 v[160:163], v[24:27], v[176:179], 0
    ds_read_b128 v[16:19], v4 offset:20480
    v_mfma_f32_16x16x32_bf16 v[164:167], v[24:27], v[180:183], 0
    v_mfma_f32_16x16x32_bf16 v[168:171], v[24:27], v[184:187], 0
    v_mfma_f32_16x16x32_bf16 v[172:175], v[24:27], v[188:191], 0
    buffer_load_dwordx4 v2, s[4:7], s61 offen offset:2048 lds
    s_waitcnt lgkmcnt(3)
    v_mfma_f32_16x16x32_bf16 v[96:99], v[28:31], v[192:195], v[96:99]
    ds_read_b128 v[20:23], v4 offset:21504
    v_mfma_f32_16x16x32_bf16 v[104:107], v[28:31], v[196:199], v[104:107]
    v_mfma_f32_16x16x32_bf16 v[112:115], v[28:31], v[200:203], v[112:115]
    v_mfma_f32_16x16x32_bf16 v[120:123], v[28:31], v[204:207], v[120:123]
    buffer_load_dwordx4 v2, s[4:7], s61 offen offset:3072 lds
    s_add_u32 m0, s49, 118784
    s_waitcnt lgkmcnt(3)
    v_mfma_f32_16x16x32_bf16 v[100:103], v[8:11], v[192:195], v[100:103]
    ds_read_b128 v[24:27], v4 offset:22528
    s_add_u32 s61, s48, 413696
    v_mfma_f32_16x16x32_bf16 v[108:111], v[8:11], v[196:199], v[108:111]
    v_mfma_f32_16x16x32_bf16 v[116:119], v[8:11], v[200:203], v[116:119]
    v_mfma_f32_16x16x32_bf16 v[124:127], v[8:11], v[204:207], v[124:127]
    buffer_load_dwordx4 v2, s[4:7], s61 offen offset:0 lds
    s_waitcnt lgkmcnt(3)
    v_mfma_f32_16x16x32_bf16 v[128:131], v[12:15], v[192:195], v[128:131]
    ds_read_b128 v[28:31], v4 offset:23552
    v_mfma_f32_16x16x32_bf16 v[136:139], v[12:15], v[196:199], v[136:139]
    v_mfma_f32_16x16x32_bf16 v[144:147], v[12:15], v[200:203], v[144:147]
    v_mfma_f32_16x16x32_bf16 v[152:155], v[12:15], v[204:207], v[152:155]
    s_waitcnt lgkmcnt(3)
    v_mfma_f32_16x16x32_bf16 v[132:135], v[16:19], v[192:195], v[132:135]
    ds_read_b128 v[8:11], v4 offset:24576
    v_mfma_f32_16x16x32_bf16 v[140:143], v[16:19], v[196:199], v[140:143]
    v_mfma_f32_16x16x32_bf16 v[148:151], v[16:19], v[200:203], v[148:151]
    v_mfma_f32_16x16x32_bf16 v[156:159], v[16:19], v[204:207], v[156:159]
    s_waitcnt lgkmcnt(3)
    v_mfma_f32_16x16x32_bf16 v[160:163], v[20:23], v[192:195], v[160:163]
    ds_read_b128 v[12:15], v4 offset:25600
    v_mfma_f32_16x16x32_bf16 v[164:167], v[20:23], v[196:199], v[164:167]
    v_mfma_f32_16x16x32_bf16 v[168:171], v[20:23], v[200:203], v[168:171]
    v_mfma_f32_16x16x32_bf16 v[172:175], v[20:23], v[204:207], v[172:175]
    s_waitcnt lgkmcnt(3)
    v_mfma_f32_16x16x32_bf16 v[96:99], v[24:27], v[208:211], v[96:99]
    ds_read_b128 v[16:19], v4 offset:26624
    v_mfma_f32_16x16x32_bf16 v[104:107], v[24:27], v[212:215], v[104:107]
    v_mfma_f32_16x16x32_bf16 v[112:115], v[24:27], v[216:219], v[112:115]
    v_mfma_f32_16x16x32_bf16 v[120:123], v[24:27], v[220:223], v[120:123]
    s_waitcnt lgkmcnt(3)
    v_mfma_f32_16x16x32_bf16 v[100:103], v[28:31], v[208:211], v[100:103]
    ds_read_b128 v[20:23], v4 offset:27648
    v_mfma_f32_16x16x32_bf16 v[108:111], v[28:31], v[212:215], v[108:111]
    v_mfma_f32_16x16x32_bf16 v[116:119], v[28:31], v[216:219], v[116:119]
    v_mfma_f32_16x16x32_bf16 v[124:127], v[28:31], v[220:223], v[124:127]
    s_waitcnt lgkmcnt(3)
    v_mfma_f32_16x16x32_bf16 v[128:131], v[8:11], v[208:211], v[128:131]
    ds_read_b128 v[24:27], v4 offset:28672
    v_mfma_f32_16x16x32_bf16 v[136:139], v[8:11], v[212:215], v[136:139]
    v_mfma_f32_16x16x32_bf16 v[144:147], v[8:11], v[216:219], v[144:147]
    v_mfma_f32_16x16x32_bf16 v[152:155], v[8:11], v[220:223], v[152:155]
    s_waitcnt vmcnt(4)
    v_cmp_le_u32 vcc, 2, v5
    s_nop 0
    s_cmp_eq_u64 vcc, exec
    s_cbranch_scc0 L_p1_slow_31
L_p1_back_32:
    s_waitcnt lgkmcnt(3)
    v_mfma_f32_16x16x32_bf16 v[132:135], v[12:15], v[208:211], v[132:135]
    ds_read_b128 v[28:31], v4 offset:29696
    s_add_u32 s60, s56, 32768
    v_mfma_f32_16x16x32_bf16 v[140:143], v[12:15], v[212:215], v[140:143]
    buffer_load_dwordx4 a[112:115], v2, s[4:7], s60 offen offset:0 sc1
    v_mfma_f32_16x16x32_bf16 v[148:151], v[12:15], v[216:219], v[148:151]
    v_mfma_f32_16x16x32_bf16 v[156:159], v[12:15], v[220:223], v[156:159]
    s_waitcnt lgkmcnt(3)
    v_mfma_f32_16x16x32_bf16 v[160:163], v[16:19], v[208:211], v[160:163]
    ds_read_b128 v[8:11], v4 offset:30720
    v_mfma_f32_16x16x32_bf16 v[164:167], v[16:19], v[212:215], v[164:167]
    buffer_load_dwordx4 a[116:119], v2, s[4:7], s60 offen offset:1024 sc1
    v_mfma_f32_16x16x32_bf16 v[168:171], v[16:19], v[216:219], v[168:171]
    v_mfma_f32_16x16x32_bf16 v[172:175], v[16:19], v[220:223], v[172:175]
    s_waitcnt lgkmcnt(3)
    v_mfma_f32_16x16x32_bf16 v[32:35], v[20:23], v[224:227], v[32:35]
    ds_read_b128 v[12:15], v4 offset:31744
    v_mfma_f32_16x16x32_bf16 v[40:43], v[20:23], v[228:231], v[40:43]
    buffer_load_dwordx4 a[120:123], v2, s[4:7], s60 offen offset:2048 sc1
    v_mfma_f32_16x16x32_bf16 v[48:51], v[20:23], v[232:235], v[48:51]
    v_mfma_f32_16x16x32_bf16 v[56:59], v[20:23], v[236:239], v[56:59]
    s_waitcnt lgkmcnt(3)
    v_mfma_f32_16x16x32_bf16 v[36:39], v[24:27], v[224:227], v[36:39]
    ds_read_b128 v[16:19], v4 offset:32768
    v_mfma_f32_16x16x32_bf16 v[44:47], v[24:27], v[228:231], v[44:47]
    buffer_load_dwordx4 a[124:127], v2, s[4:7], s60 offen offset:3072 sc1
    s_add_u32 s60, s57, 32768
    v_mfma_f32_16x16x32_bf16 v[52:55], v[24:27], v[232:235], v[52:55]
    v_mov_b32 v6, 3
    v_mov_b32 v0, 0
    v_mfma_f32_16x16x32_bf16 v[60:63], v[24:27], v[236:239], v[60:63]
    s_waitcnt lgkmcnt(3)
    v_mfma_f32_16x16x32_bf16 v[64:67], v[28:31], v[224:227], v[64:67]
    ds_read_b128 v[20:23], v4 offset:33792
    v_mfma_f32_16x16x32_bf16 v[72:75], v[28:31], v[228:231], v[72:75]
    s_mov_b64 exec, 1
    buffer_store_dword v6, v0, s[4:7], s67 offen sc1
    s_mov_b64 exec, -1
    v_mfma_f32_16x16x32_bf16 v[80:83], v[28:31], v[232:235], v[80:83]
    v_mfma_f32_16x16x32_bf16 v[88:91], v[28:31], v[236:239], v[88:91]
    s_waitcnt lgkmcnt(3)
    v_mfma_f32_16x16x32_bf16 v[68:71], v[8:11], v[224:227], v[68:71]
    ds_read_b128 v[24:27], v4 offset:34816
    v_mfma_f32_16x16x32_bf16 v[76:79], v[8:11], v[228:231], v[76:79]
    buffer_load_dwordx4 a[128:131], v2, s[4:7], s60 offen offset:0 sc1
    v_mfma_f32_16x16x32_bf16 v[84:87], v[8:11], v[232:235], v[84:87]
    v_mfma_f32_16x16x32_bf16 v[92:95], v[8:11], v[236:239], v[92:95]
    s_waitcnt lgkmcnt(3)
    v_mfma_f32_16x16x32_bf16 v[96:99], v[12:15], v[224:227], v[96:99]
    ds_read_b128 v[28:31], v4 offset:35840
    v_mfma_f32_16x16x32_bf16 v[104:107], v[12:15], v[228:231], v[104:107]
    buffer_load_dwordx4 a[132:135], v2, s[4:7], s60 offen offset:1024 sc1
    v_mfma_f32_16x16x32_bf16 v[112:115], v[12:15], v[232:235], v[112:115]
    v_mfma_f32_16x16x32_bf16 v[120:123], v[12:15], v[236:239], v[120:123]
    s_waitcnt lgkmcnt(3)
    v_mfma_f32_16x16x32_bf16 v[100:103], v[16:19], v[224:227], v[100:103]
    s_barrier
    v_mfma_f32_16x16x32_bf16 v[108:111], v[16:19], v[228:231], v[108:111]
    v_add_u32 v4, 0x9000, v4
    ds_read_b128 v[8:11], v4 offset:0
    v_mfma_f32_16x16x32_bf16 v[116:119], v[16:19], v[232:235], v[116:119]
    buffer_load_dwordx4 a[136:139], v2, s[4:7], s60 offen offset:2048 sc1
    s_add_u32 m0, s49, 0
    v_mfma_f32_16x16x32_bf16 v[124:127], v[16:19], v[236:239], v[124:127]
    s_add_u32 s61, s48, 442368
    s_waitcnt lgkmcnt(3)
    v_mfma_f32_16x16x32_bf16 v[128:131], v[20:23], v[224:227], v[128:131]
    ds_read_b128 v[12:15], v4 offset:1024
    v_mfma_f32_16x16x32_bf16 v[136:139], v[20:23], v[228:231], v[136:139]
    v_mfma_f32_16x16x32_bf16 v[144:147], v[20:23], v[232:235], v[144:147]
    buffer_load_dwordx4 a[140:143], v2, s[4:7], s60 offen offset:3072 sc1
    s_add_u32 s60, s58, 32768
    v_mfma_f32_16x16x32_bf16 v[152:155], v[20:23], v[236:239], v[152:155]
    s_waitcnt lgkmcnt(3)
    v_mfma_f32_16x16x32_bf16 v[132:135], v[24:27], v[224:227], v[132:135]
    ds_read_b128 v[16:19], v4 offset:2048
    v_mfma_f32_16x16x32_bf16 v[140:143], v[24:27], v[228:231], v[140:143]
    v_mfma_f32_16x16x32_bf16 v[148:151], v[24:27], v[232:235], v[148:151]
    buffer_load_dwordx4 a[144:147], v2, s[4:7], s60 offen offset:0 sc1
    v_mfma_f32_16x16x32_bf16 v[156:159], v[24:27], v[236:239], v[156:159]
    s_waitcnt lgkmcnt(3)
    v_mfma_f32_16x16x32_bf16 v[160:163], v[28:31], v[224:227], v[160:163]
    ds_read_b128 v[20:23], v4 offset:3072
    v_mfma_f32_16x16x32_bf16 v[164:167], v[28:31], v[228:231], v[164:167]
    v_mfma_f32_16x16x32_bf16 v[168:171], v[28:31], v[232:235], v[168:171]
    buffer_load_dwordx4 a[148:151], v2, s[4:7], s60 offen offset:1024 sc1
    v_mfma_f32_16x16x32_bf16 v[172:175], v[28:31], v[236:239], v[172:175]
    s_waitcnt lgkmcnt(3)
    v_mfma_f32_16x16x32_bf16 v[32:35], v[8:11], v[240:243], v[32:35]
    ds_read_b128 v[24:27], v4 offset:4096
    v_mfma_f32_16x16x32_bf16 v[40:43], v[8:11], v[244:247], v[40:43]
    v_mfma_f32_16x16x32_bf16 v[48:51], v[8:11], v[248:251], v[48:51]
    buffer_load_dwordx4 a[152:155], v2, s[4:7], s60 offen offset:2048 sc1
    v_mfma_f32_16x16x32_bf16 v[56:59], v[8:11], v[252:255], v[56:59]
    s_waitcnt lgkmcnt(3)
    v_mfma_f32_16x16x32_bf16 v[36:39], v[12:15], v[240:243], v[36:39]
    ds_read_b128 v[28:31], v4 offset:5120
    v_mfma_f32_16x16x32_bf16 v[44:47], v[12:15], v[244:247], v[44:47]
    v_mfma_f32_16x16x32_bf16 v[52:55], v[12:15], v[248:251], v[52:55]
    buffer_load_dwordx4 a[156:159], v2, s[4:7], s60 offen offset:3072 sc1
    v_mfma_f32_16x16x32_bf16 v[60:63], v[12:15], v[252:255], v[60:63]
    s_waitcnt lgkmcnt(3)
    v_mfma_f32_16x16x32_bf16 v[64:67], v[16:19], v[240:243], v[64:67]
    ds_read_b128 v[8:11], v4 offset:6144
    v_mfma_f32_16x16x32_bf16 v[72:75], v[16:19], v[244:247], v[72:75]
    v_mfma_f32_16x16x32_bf16 v[80:83], v[16:19], v[248:251], v[80:83]
    buffer_load_dwordx4 v2, s[4:7], s61 offen offset:0 lds
    v_mfma_f32_16x16x32_bf16 v[88:91], v[16:19], v[252:255], v[88:91]
    s_waitcnt lgkmcnt(3)
    v_mfma_f32_16x16x32_bf16 v[68:71], v[20:23], v[240:243], v[68:71]
    ds_read_b128 v[12:15], v4 offset:7168
    v_mfma_f32_16x16x32_bf16 v[76:79], v[20:23], v[244:247], v[76:79]
    v_mfma_f32_16x16x32_bf16 v[84:87], v[20:23], v[248:251], v[84:87]
    buffer_load_dwordx4 v2, s[4:7], s61 offen offset:1024 lds
    v_mfma_f32_16x16x32_bf16 v[92:95], v[20:23], v[252:255], v[92:95]
    s_waitcnt lgkmcnt(3)
    v_mfma_f32_16x16x32_bf16 v[96:99], v[24:27], v[240:243], v[96:99]
    ds_read_b128 v[16:19], v4 offset:8192
    v_mfma_f32_16x16x32_bf16 v[104:107], v[24:27], v[244:247], v[104:107]
    v_mfma_f32_16x16x32_bf16 v[112:115], v[24:27], v[248:251], v[112:115]
    buffer_load_dwordx4 v2, s[4:7], s61 offen offset:2048 lds
    v_mfma_f32_16x16x32_bf16 v[120:123], v[24:27], v[252:255], v[120:123]
    s_waitcnt lgkmcnt(3)
    v_mfma_f32_16x16x32_bf16 v[100:103], v[28:31], v[240:243], v[100:103]
    ds_read_b128 v[20:23], v4 offset:9216
    v_mfma_f32_16x16x32_bf16 v[108:111], v[28:31], v[244:247], v[108:111]
    v_mfma_f32_16x16x32_bf16 v[116:119], v[28:31], v[248:251], v[116:119]
    buffer_load_dwordx4 v2, s[4:7], s61 offen offset:3072 lds
    s_add_u32 m0, s49, 4096
    v_mfma_f32_16x16x32_bf16 v[124:127], v[28:31], v[252:255], v[124:127]
    s_add_u32 s61, s48, 446464
    s_waitcnt lgkmcnt(3)
    v_mfma_f32_16x16x32_bf16 v[128:131], v[8:11], v[240:243], v[128:131]
    ds_read_b128 v[24:27], v4 offset:10240
    v_mfma_f32_16x16x32_bf16 v[136:139], v[8:11], v[244:247], v[136:139]
    v_mfma_f32_16x16x32_bf16 v[144:147], v[8:11], v[248:251], v[144:147]
    buffer_load_dwordx4 v2, s[4:7], s61 offen offset:0 lds
    v_mfma_f32_16x16x32_bf16 v[152:155], v[8:11], v[252:255], v[152:155]
    s_waitcnt lgkmcnt(3)
    v_mfma_f32_16x16x32_bf16 v[132:135], v[12:15], v[240:243], v[132:135]
    ds_read_b128 v[28:31], v4 offset:11264
    v_mfma_f32_16x16x32_bf16 v[140:143], v[12:15], v[244:247], v[140:143]
    v_mfma_f32_16x16x32_bf16 v[148:151], v[12:15], v[248:251], v[148:151]
    buffer_load_dwordx4 v2, s[4:7], s61 offen offset:1024 lds
    v_mfma_f32_16x16x32_bf16 v[156:159], v[12:15], v[252:255], v[156:159]
    s_waitcnt lgkmcnt(3)
    v_mfma_f32_16x16x32_bf16 v[160:163], v[16:19], v[240:243], v[160:163]
    ds_read_b128 v[8:11], v4 offset:12288
    v_mfma_f32_16x16x32_bf16 v[164:167], v[16:19], v[244:247], v[164:167]
    v_mfma_f32_16x16x32_bf16 v[168:171], v[16:19], v[248:251], v[168:171]
    buffer_load_dwordx4 v2, s[4:7], s61 offen offset:2048 lds
    v_mfma_f32_16x16x32_bf16 v[172:175], v[16:19], v[252:255], v[172:175]
    s_waitcnt lgkmcnt(3)
    v_mfma_f32_16x16x32_bf16 v[32:35], v[20:23], a[0:3], v[32:35]
    ds_read_b128 v[12:15], v4 offset:13312
    v_mfma_f32_16x16x32_bf16 v[40:43], v[20:23], a[4:7], v[40:43]
    v_mfma_f32_16x16x32_bf16 v[48:51], v[20:23], a[8:11], v[48:51]
    buffer_load_dwordx4 v2, s[4:7], s61 offen offset:3072 lds
    s_add_u32 m0, s49, 8192
    v_mfma_f32_16x16x32_bf16 v[56:59], v[20:23], a[12:15], v[56:59]
    s_add_u32 s61, s48, 450560
    s_waitcnt lgkmcnt(3)
    v_mfma_f32_16x16x32_bf16 v[36:39], v[24:27], a[0:3], v[36:39]
    ds_read_b128 v[16:19], v4 offset:14336
    v_mfma_f32_16x16x32_bf16 v[44:47], v[24:27], a[4:7], v[44:47]
    v_mfma_f32_16x16x32_bf16 v[52:55], v[24:27], a[8:11], v[52:55]
    buffer_load_dwordx4 v2, s[4:7], s61 offen offset:0 lds
    v_mfma_f32_16x16x32_bf16 v[60:63], v[24:27], a[12:15], v[60:63]
    s_waitcnt lgkmcnt(3)
    v_mfma_f32_16x16x32_bf16 v[64:67], v[28:31], a[0:3], v[64:67]
    ds_read_b128 v[20:23], v4 offset:15360
    v_mfma_f32_16x16x32_bf16 v[72:75], v[28:31], a[4:7], v[72:75]
    v_mfma_f32_16x16x32_bf16 v[80:83], v[28:31], a[8:11], v[80:83]
    v_mfma_f32_16x16x32_bf16 v[88:91], v[28:31], a[12:15], v[88:91]
    s_waitcnt lgkmcnt(3)
    v_mfma_f32_16x16x32_bf16 v[68:71], v[8:11], a[0:3], v[68:71]
    ds_read_b128 v[24:27], v4 offset:16384
    v_mfma_f32_16x16x32_bf16 v[76:79], v[8:11], a[4:7], v[76:79]
    v_mfma_f32_16x16x32_bf16 v[84:87], v[8:11], a[8:11], v[84:87]
    v_mfma_f32_16x16x32_bf16 v[92:95], v[8:11], a[12:15], v[92:95]
    s_waitcnt lgkmcnt(3)
    v_mfma_f32_16x16x32_bf16 v[96:99], v[12:15], a[0:3], v[96:99]
    ds_read_b128 v[28:31], v4 offset:17408
    v_mfma_f32_16x16x32_bf16 v[104:107], v[12:15], a[4:7], v[104:107]
    v_mfma_f32_16x16x32_bf16 v[112:115], v[12:15], a[8:11], v[112:115]
    v_mfma_f32_16x16x32_bf16 v[120:123], v[12:15], a[12:15], v[120:123]
    s_waitcnt lgkmcnt(3)
    v_mfma_f32_16x16x32_bf16 v[100:103], v[16:19], a[0:3], v[100:103]
    ds_read_b128 v[8:11], v4 offset:18432
    v_mfma_f32_16x16x32_bf16 v[108:111], v[16:19], a[4:7], v[108:111]
    v_mfma_f32_16x16x32_bf16 v[116:119], v[16:19], a[8:11], v[116:119]
    v_mfma_f32_16x16x32_bf16 v[124:127], v[16:19], a[12:15], v[124:127]
    s_waitcnt lgkmcnt(3)
    v_mfma_f32_16x16x32_bf16 v[128:131], v[20:23], a[0:3], v[128:131]
    ds_read_b128 v[12:15], v4 offset:19456
    v_mfma_f32_16x16x32_bf16 v[136:139], v[20:23], a[4:7], v[136:139]
    v_mfma_f32_16x16x32_bf16 v[144:147], v[20:23], a[8:11], v[144:147]
    v_mfma_f32_16x16x32_bf16 v[152:155], v[20:23], a[12:15], v[152:155]
    s_waitcnt lgkmcnt(3)
    v_mfma_f32_16x16x32_bf16 v[132:135], v[24:27], a[0:3], v[132:135]
    ds_read_b128 v[16:19], v4 offset:20480
    v_mfma_f32_16x16x32_bf16 v[140:143], v[24:27], a[4:7], v[140:143]
    v_mfma_f32_16x16x32_bf16 v[148:151], v[24:27], a[8:11], v[148:151]
    v_mfma_f32_16x16x32_bf16 v[156:159], v[24:27], a[12:15], v[156:159]
    buffer_load_dword v5, v7, s[4:7], s52 offen sc1
    s_waitcnt lgkmcnt(3)
    v_mfma_f32_16x16x32_bf16 v[160:163], v[28:31], a[0:3], v[160:163]
    ds_read_b128 v[20:23], v4 offset:21504
    v_mfma_f32_16x16x32_bf16 v[164:167], v[28:31], a[4:7], v[164:167]
    v_mfma_f32_16x16x32_bf16 v[168:171], v[28:31], a[8:11], v[168:171]
    v_mfma_f32_16x16x32_bf16 v[172:175], v[28:31], a[12:15], v[172:175]
    s_waitcnt lgkmcnt(3)
    v_mfma_f32_16x16x32_bf16 v[32:35], v[8:11], a[16:19], v[32:35]
    ds_read_b128 v[24:27], v4 offset:22528
    v_mfma_f32_16x16x32_bf16 v[40:43], v[8:11], a[20:23], v[40:43]
    v_mfma_f32_16x16x32_bf16 v[48:51], v[8:11], a[24:27], v[48:51]
    v_mfma_f32_16x16x32_bf16 v[56:59], v[8:11], a[28:31], v[56:59]
    s_waitcnt lgkmcnt(3)
    v_mfma_f32_16x16x32_bf16 v[36:39], v[12:15], a[16:19], v[36:39]
    ds_read_b128 v[28:31], v4 offset:23552
    v_mfma_f32_16x16x32_bf16 v[44:47], v[12:15], a[20:23], v[44:47]
    v_mfma_f32_16x16x32_bf16 v[52:55], v[12:15], a[24:27], v[52:55]
    v_mfma_f32_16x16x32_bf16 v[60:63], v[12:15], a[28:31], v[60:63]
    s_waitcnt lgkmcnt(3)
    v_mfma_f32_16x16x32_bf16 v[64:67], v[16:19], a[16:19], v[64:67]
    ds_read_b128 v[8:11], v4 offset:24576
    v_mfma_f32_16x16x32_bf16 v[72:75], v[16:19], a[20:23], v[72:75]
    v_mfma_f32_16x16x32_bf16 v[80:83], v[16:19], a[24:27], v[80:83]
    v_mfma_f32_16x16x32_bf16 v[88:91], v[16:19], a[28:31], v[88:91]
    s_waitcnt lgkmcnt(3)
    v_mfma_f32_16x16x32_bf16 v[68:71], v[20:23], a[16:19], v[68:71]
    ds_read_b128 v[12:15], v4 offset:25600
    v_mfma_f32_16x16x32_bf16 v[76:79], v[20:23], a[20:23], v[76:79]
    v_mfma_f32_16x16x32_bf16 v[84:87], v[20:23], a[24:27], v[84:87]
    v_mfma_f32_16x16x32_bf16 v[92:95], v[20:23], a[28:31], v[92:95]
    s_waitcnt lgkmcnt(3)
    v_mfma_f32_16x16x32_bf16 v[96:99], v[24:27], a[16:19], v[96:99]
    ds_read_b128 v[16:19], v4 offset:26624
    v_mfma_f32_16x16x32_bf16 v[104:107], v[24:27], a[20:23], v[104:107]
    v_mfma_f32_16x16x32_bf16 v[112:115], v[24:27], a[24:27], v[112:115]
    v_mfma_f32_16x16x32_bf16 v[120:123], v[24:27], a[28:31], v[120:123]
    s_waitcnt lgkmcnt(3)
    v_mfma_f32_16x16x32_bf16 v[100:103], v[28:31], a[16:19], v[100:103]
    ds_read_b128 v[20:23], v4 offset:27648
    v_mfma_f32_16x16x32_bf16 v[108:111], v[28:31], a[20:23], v[108:111]
    v_mfma_f32_16x16x32_bf16 v[116:119], v[28:31], a[24:27], v[116:119]
    v_mfma_f32_16x16x32_bf16 v[124:127], v[28:31], a[28:31], v[124:127]
    s_waitcnt lgkmcnt(3)
    v_mfma_f32_16x16x32_bf16 v[128:131], v[8:11], a[16:19], v[128:131]
    ds_read_b128 v[24:27], v4 offset:28672
    v_mfma_f32_16x16x32_bf16 v[136:139], v[8:11], a[20:23], v[136:139]
    v_mfma_f32_16x16x32_bf16 v[144:147], v[8:11], a[24:27], v[144:147]
    v_mfma_f32_16x16x32_bf16 v[152:155], v[8:11], a[28:31], v[152:155]
    s_waitcnt lgkmcnt(3)
    v_mfma_f32_16x16x32_bf16 v[132:135], v[12:15], a[16:19], v[132:135]
    ds_read_b128 v[28:31], v4 offset:29696
    v_mfma_f32_16x16x32_bf16 v[140:143], v[12:15], a[20:23], v[140:143]
    v_mfma_f32_16x16x32_bf16 v[148:151], v[12:15], a[24:27], v[148:151]
    v_mfma_f32_16x16x32_bf16 v[156:159], v[12:15], a[28:31], v[156:159]
    s_waitcnt lgkmcnt(3)
    v_mfma_f32_16x16x32_bf16 v[160:163], v[16:19], a[16:19], v[160:163]
    ds_read_b128 v[8:11], v4 offset:30720
    v_mfma_f32_16x16x32_bf16 v[164:167], v[16:19], a[20:23], v[164:167]
    v_mfma_f32_16x16x32_bf16 v[168:171], v[16:19], a[24:27], v[168:171]
    v_mfma_f32_16x16x32_bf16 v[172:175], v[16:19], a[28:31], v[172:175]
    s_waitcnt vmcnt(0)
    v_cmp_le_u32 vcc, 3, v5
    s_nop 0
    s_cmp_eq_u64 vcc, exec
    s_cbranch_scc0 L_p2_slow_33
L_p2_back_34:
    s_waitcnt lgkmcnt(3)
    v_mfma_f32_16x16x32_bf16 v[32:35], v[20:23], a[32:35], v[32:35]
    ds_read_b128 v[12:15], v4 offset:31744
    s_add_u32 s60, s56, 49152
    v_mfma_f32_16x16x32_bf16 v[40:43], v[20:23], a[36:39], v[40:43]
    buffer_load_dwordx4 a[160:163], v2, s[4:7], s60 offen offset:0 sc1
    v_mfma_f32_16x16x32_bf16 v[48:51], v[20:23], a[40:43], v[48:51]
    v_mfma_f32_16x16x32_bf16 v[56:59], v[20:23], a[44:47], v[56:59]
    s_and_b32 s68, s46, 1
    s_mul_i32 s69, s68, 5120
    s_waitcnt lgkmcnt(3)
    v_mfma_f32_16x16x32_bf16 v[36:39], v[24:27], a[32:35], v[36:39]
    ds_read_b128 v[16:19], v4 offset:32768
    s_add_u32 s69, s69, s53
    v_mfma_f32_16x16x32_bf16 v[44:47], v[24:27], a[36:39], v[44:47]
    buffer_load_dwordx4 a[164:167], v2, s[4:7], s60 offen offset:1024 sc1
    s_lshl_b32 s68, s68, 9
    v_mfma_f32_16x16x32_bf16 v[52:55], v[24:27], a[40:43], v[52:55]
    s_add_u32 s68, s68, s53
    v_and_b32 v0, 15, v1
    v_mfma_f32_16x16x32_bf16 v[60:63], v[24:27], a[44:47], v[60:63]
    v_lshlrev_b32 v0, 5, v0
    v_lshrrev_b32 v5, 4, v1
    s_waitcnt lgkmcnt(3)
    v_mfma_f32_16x16x32_bf16 v[64:67], v[28:31], a[32:35], v[64:67]
    ds_read_b128 v[20:23], v4 offset:33792
    v_lshl_add_u32 v0, v5, 3, v0
    v_mfma_f32_16x16x32_bf16 v[72:75], v[28:31], a[36:39], v[72:75]
    buffer_load_dwordx4 a[168:171], v2, s[4:7], s60 offen offset:2048 sc1
    v_mfma_f32_16x16x32_bf16 v[80:83], v[28:31], a[40:43], v[80:83]
    v_mfma_f32_16x16x32_bf16 v[88:91], v[28:31], a[44:47], v[88:91]
    s_waitcnt lgkmcnt(3)
    v_mfma_f32_16x16x32_bf16 v[68:71], v[8:11], a[32:35], v[68:71]
    ds_read_b128 v[24:27], v4 offset:34816
    v_mfma_f32_16x16x32_bf16 v[76:79], v[8:11], a[36:39], v[76:79]
    buffer_load_dwordx4 a[172:175], v2, s[4:7], s60 offen offset:3072 sc1
    s_add_u32 s60, s57, 49152
    v_mfma_f32_16x16x32_bf16 v[84:87], v[8:11], a[40:43], v[84:87]
    v_mfma_f32_16x16x32_bf16 v[92:95], v[8:11], a[44:47], v[92:95]
    s_waitcnt lgkmcnt(3)
    v_mfma_f32_16x16x32_bf16 v[96:99], v[12:15], a[32:35], v[96:99]
    ds_read_b128 v[28:31], v4 offset:35840
    v_mfma_f32_16x16x32_bf16 v[104:107], v[12:15], a[36:39], v[104:107]
    buffer_load_dwordx4 a[176:179], v2, s[4:7], s60 offen offset:0 sc1
    v_mfma_f32_16x16x32_bf16 v[112:115], v[12:15], a[40:43], v[112:115]
    v_mfma_f32_16x16x32_bf16 v[120:123], v[12:15], a[44:47], v[120:123]
    s_waitcnt lgkmcnt(3)
    v_mfma_f32_16x16x32_bf16 v[100:103], v[16:19], a[32:35], v[100:103]
    s_barrier
    v_mfma_f32_16x16x32_bf16 v[108:111], v[16:19], a[36:39], v[108:111]
    v_add_u32 v4, 0x9000, v4
    ds_read_b128 v[8:11], v4 offset:0
    v_mfma_f32_16x16x32_bf16 v[116:119], v[16:19], a[40:43], v[116:119]
    buffer_load_dwordx4 a[180:183], v2, s[4:7], s60 offen offset:1024 sc1
    s_add_u32 m0, s63, 36864
    v_mfma_f32_16x16x32_bf16 v[124:127], v[16:19], a[44:47], v[124:127]
    s_add_u32 s61, s62, 479232
    s_waitcnt lgkmcnt(3)
    v_mfma_f32_16x16x32_bf16 v[128:131], v[20:23], a[32:35], v[128:131]
    ds_read_b128 v[12:15], v4 offset:1024
    v_mfma_f32_16x16x32_bf16 v[136:139], v[20:23], a[36:39], v[136:139]
    v_mfma_f32_16x16x32_bf16 v[144:147], v[20:23], a[40:43], v[144:147]
    buffer_load_dwordx4 a[184:187], v2, s[4:7], s60 offen offset:2048 sc1
    v_mfma_f32_16x16x32_bf16 v[152:155], v[20:23], a[44:47], v[152:155]
    s_waitcnt lgkmcnt(3)
    v_mfma_f32_16x16x32_bf16 v[132:135], v[24:27], a[32:35], v[132:135]
    ds_read_b128 v[16:19], v4 offset:2048
    v_mfma_f32_16x16x32_bf16 v[140:143], v[24:27], a[36:39], v[140:143]
    v_mfma_f32_16x16x32_bf16 v[148:151], v[24:27], a[40:43], v[148:151]
    buffer_load_dwordx4 a[188:191], v2, s[4:7], s60 offen offset:3072 sc1
    s_add_u32 s60, s58, 49152
    v_mfma_f32_16x16x32_bf16 v[156:159], v[24:27], a[44:47], v[156:159]
    s_waitcnt lgkmcnt(3)
    v_mfma_f32_16x16x32_bf16 v[160:163], v[28:31], a[32:35], v[160:163]
    ds_read_b128 v[20:23], v4 offset:3072
    v_mfma_f32_16x16x32_bf16 v[164:167], v[28:31], a[36:39], v[164:167]
    v_mfma_f32_16x16x32_bf16 v[168:171], v[28:31], a[40:43], v[168:171]
    buffer_load_dwordx4 a[192:195], v2, s[4:7], s60 offen offset:0 sc1
    v_mfma_f32_16x16x32_bf16 v[172:175], v[28:31], a[44:47], v[172:175]
    s_waitcnt lgkmcnt(3)
    v_mfma_f32_16x16x32_bf16 v[32:35], v[8:11], a[48:51], v[32:35]
    ds_read_b128 v[24:27], v4 offset:4096
    v_mfma_f32_16x16x32_bf16 v[40:43], v[8:11], a[52:55], v[40:43]
    v_mfma_f32_16x16x32_bf16 v[48:51], v[8:11], a[56:59], v[48:51]
    buffer_load_dwordx4 a[196:199], v2, s[4:7], s60 offen offset:1024 sc1
    v_mfma_f32_16x16x32_bf16 v[56:59], v[8:11], a[60:63], v[56:59]
    s_waitcnt lgkmcnt(3)
    v_mfma_f32_16x16x32_bf16 v[36:39], v[12:15], a[48:51], v[36:39]
    ds_read_b128 v[28:31], v4 offset:5120
    v_mfma_f32_16x16x32_bf16 v[44:47], v[12:15], a[52:55], v[44:47]
    v_mfma_f32_16x16x32_bf16 v[52:55], v[12:15], a[56:59], v[52:55]
    buffer_load_dwordx4 a[200:203], v2, s[4:7], s60 offen offset:2048 sc1
    v_mfma_f32_16x16x32_bf16 v[60:63], v[12:15], a[60:63], v[60:63]
    s_waitcnt lgkmcnt(3)
    v_mfma_f32_16x16x32_bf16 v[64:67], v[16:19], a[48:51], v[64:67]
    ds_read_b128 v[8:11], v4 offset:6144
    v_mfma_f32_16x16x32_bf16 v[72:75], v[16:19], a[52:55], v[72:75]
    v_mfma_f32_16x16x32_bf16 v[80:83], v[16:19], a[56:59], v[80:83]
    buffer_load_dwordx4 a[204:207], v2, s[4:7], s60 offen offset:3072 sc1
    v_mfma_f32_16x16x32_bf16 v[88:91], v[16:19], a[60:63], v[88:91]
    s_waitcnt lgkmcnt(3)
    v_mfma_f32_16x16x32_bf16 v[68:71], v[20:23], a[48:51], v[68:71]
    ds_read_b128 v[12:15], v4 offset:7168
    v_mfma_f32_16x16x32_bf16 v[76:79], v[20:23], a[52:55], v[76:79]
    v_mfma_f32_16x16x32_bf16 v[84:87], v[20:23], a[56:59], v[84:87]
    buffer_load_dwordx4 v2, s[4:7], s61 offen offset:0 lds
    v_mfma_f32_16x16x32_bf16 v[92:95], v[20:23], a[60:63], v[92:95]
    s_waitcnt lgkmcnt(3)
    v_mfma_f32_16x16x32_bf16 v[96:99], v[24:27], a[48:51], v[96:99]
    ds_read_b128 v[16:19], v4 offset:8192
    v_mfma_f32_16x16x32_bf16 v[104:107], v[24:27], a[52:55], v[104:107]
    v_mfma_f32_16x16x32_bf16 v[112:115], v[24:27], a[56:59], v[112:115]
    buffer_load_dwordx4 v2, s[4:7], s61 offen offset:1024 lds
    v_mfma_f32_16x16x32_bf16 v[120:123], v[24:27], a[60:63], v[120:123]
    s_waitcnt lgkmcnt(3)
    v_mfma_f32_16x16x32_bf16 v[100:103], v[28:31], a[48:51], v[100:103]
    ds_read_b128 v[20:23], v4 offset:9216
    v_mfma_f32_16x16x32_bf16 v[108:111], v[28:31], a[52:55], v[108:111]
    v_mfma_f32_16x16x32_bf16 v[116:119], v[28:31], a[56:59], v[116:119]
    buffer_load_dwordx4 v2, s[4:7], s61 offen offset:2048 lds
    v_mfma_f32_16x16x32_bf16 v[124:127], v[28:31], a[60:63], v[124:127]
    s_waitcnt lgkmcnt(3)
    v_mfma_f32_16x16x32_bf16 v[128:131], v[8:11], a[48:51], v[128:131]
    ds_read_b128 v[24:27], v4 offset:10240
    v_mfma_f32_16x16x32_bf16 v[136:139], v[8:11], a[52:55], v[136:139]
    v_mfma_f32_16x16x32_bf16 v[144:147], v[8:11], a[56:59], v[144:147]
    buffer_load_dwordx4 v2, s[4:7], s61 offen offset:3072 lds
    s_add_u32 m0, s63, 40960
    v_mfma_f32_16x16x32_bf16 v[152:155], v[8:11], a[60:63], v[152:155]
    s_add_u32 s61, s62, 483328
    s_waitcnt lgkmcnt(3)
    v_mfma_f32_16x16x32_bf16 v[132:135], v[12:15], a[48:51], v[132:135]
    ds_read_b128 v[28:31], v4 offset:11264
    v_mfma_f32_16x16x32_bf16 v[140:143], v[12:15], a[52:55], v[140:143]
    v_mfma_f32_16x16x32_bf16 v[148:151], v[12:15], a[56:59], v[148:151]
    buffer_load_dwordx4 v2, s[4:7], s61 offen offset:0 lds
    v_mfma_f32_16x16x32_bf16 v[156:159], v[12:15], a[60:63], v[156:159]
    s_waitcnt lgkmcnt(3)
    v_mfma_f32_16x16x32_bf16 v[160:163], v[16:19], a[48:51], v[160:163]
    ds_read_b128 v[8:11], v4 offset:12288
    v_mfma_f32_16x16x32_bf16 v[164:167], v[16:19], a[52:55], v[164:167]
    v_mfma_f32_16x16x32_bf16 v[168:171], v[16:19], a[56:59], v[168:171]
    v_mfma_f32_16x16x32_bf16 v[172:175], v[16:19], a[60:63], v[172:175]
    s_waitcnt lgkmcnt(3)
    v_mfma_f32_16x16x32_bf16 v[32:35], v[20:23], a[64:67], v[32:35]
    ds_read_b128 v[12:15], v4 offset:13312
    v_mfma_f32_16x16x32_bf16 v[40:43], v[20:23], a[68:71], v[40:43]
    v_mfma_f32_16x16x32_bf16 v[48:51], v[20:23], a[72:75], v[48:51]
    v_mfma_f32_16x16x32_bf16 v[56:59], v[20:23], a[76:79], v[56:59]
    s_waitcnt lgkmcnt(3)
    v_mfma_f32_16x16x32_bf16 v[36:39], v[24:27], a[64:67], v[36:39]
    ds_read_b128 v[16:19], v4 offset:14336
    v_mfma_f32_16x16x32_bf16 v[44:47], v[24:27], a[68:71], v[44:47]
    v_mfma_f32_16x16x32_bf16 v[52:55], v[24:27], a[72:75], v[52:55]
    v_mfma_f32_16x16x32_bf16 v[60:63], v[24:27], a[76:79], v[60:63]
    s_waitcnt lgkmcnt(3)
    v_mfma_f32_16x16x32_bf16 v[32:35], v[28:31], a[80:83], v[32:35]
    ds_read_b128 v[20:23], v4 offset:15360
    v_mfma_f32_16x16x32_bf16 v[40:43], v[28:31], a[84:87], v[40:43]
    v_mfma_f32_16x16x32_bf16 v[48:51], v[28:31], a[88:91], v[48:51]
    v_mfma_f32_16x16x32_bf16 v[56:59], v[28:31], a[92:95], v[56:59]
    s_waitcnt lgkmcnt(3)
    v_mfma_f32_16x16x32_bf16 v[36:39], v[8:11], a[80:83], v[36:39]
    ds_read_b128 v[24:27], v4 offset:16384
    v_mfma_f32_16x16x32_bf16 v[44:47], v[8:11], a[84:87], v[44:47]
    v_mfma_f32_16x16x32_bf16 v[52:55], v[8:11], a[88:91], v[52:55]
    v_mfma_f32_16x16x32_bf16 v[60:63], v[8:11], a[92:95], v[60:63]
    s_waitcnt lgkmcnt(3)
    v_mfma_f32_16x16x32_bf16 v[32:35], v[12:15], a[96:99], v[32:35]
    ds_read_b128 v[28:31], v4 offset:17408
    v_mfma_f32_16x16x32_bf16 v[40:43], v[12:15], a[100:103], v[40:43]
    v_mfma_f32_16x16x32_bf16 v[48:51], v[12:15], a[104:107], v[48:51]
    v_mfma_f32_16x16x32_bf16 v[56:59], v[12:15], a[108:111], v[56:59]
    s_waitcnt lgkmcnt(3)
    v_mfma_f32_16x16x32_bf16 v[36:39], v[16:19], a[96:99], v[36:39]
    ds_read_b128 v[8:11], v4 offset:18432
    v_mfma_f32_16x16x32_bf16 v[44:47], v[16:19], a[100:103], v[44:47]
    v_mfma_f32_16x16x32_bf16 v[52:55], v[16:19], a[104:107], v[52:55]
    v_mfma_f32_16x16x32_bf16 v[60:63], v[16:19], a[108:111], v[60:63]
    s_waitcnt lgkmcnt(3)
    v_mfma_f32_16x16x32_bf16 v[32:35], v[20:23], a[112:115], v[32:35]
    ds_read_b128 v[12:15], v4 offset:19456
    v_mfma_f32_16x16x32_bf16 v[40:43], v[20:23], a[116:119], v[40:43]
    v_mfma_f32_16x16x32_bf16 v[48:51], v[20:23], a[120:123], v[48:51]
    v_mfma_f32_16x16x32_bf16 v[56:59], v[20:23], a[124:127], v[56:59]
    s_waitcnt lgkmcnt(3)
    v_mfma_f32_16x16x32_bf16 v[36:39], v[24:27], a[112:115], v[36:39]
    ds_read_b128 v[16:19], v4 offset:20480
    v_mfma_f32_16x16x32_bf16 v[44:47], v[24:27], a[116:119], v[44:47]
    v_mfma_f32_16x16x32_bf16 v[52:55], v[24:27], a[120:123], v[52:55]
    v_mfma_f32_16x16x32_bf16 v[60:63], v[24:27], a[124:127], v[60:63]
    s_waitcnt lgkmcnt(3)
    v_mfma_f32_16x16x32_bf16 v[32:35], v[28:31], a[128:131], v[32:35]
    ds_read_b128 v[20:23], v4 offset:21504
    v_mfma_f32_16x16x32_bf16 v[40:43], v[28:31], a[132:135], v[40:43]
    v_mfma_f32_16x16x32_bf16 v[48:51], v[28:31], a[136:139], v[48:51]
    v_mfma_f32_16x16x32_bf16 v[56:59], v[28:31], a[140:143], v[56:59]
    s_waitcnt lgkmcnt(3)
    v_mfma_f32_16x16x32_bf16 v[36:39], v[8:11], a[128:131], v[36:39]
    ds_read_b128 v[24:27], v4 offset:22528
    v_mfma_f32_16x16x32_bf16 v[44:47], v[8:11], a[132:135], v[44:47]
    v_mfma_f32_16x16x32_bf16 v[52:55], v[8:11], a[136:139], v[52:55]
    v_mfma_f32_16x16x32_bf16 v[60:63], v[8:11], a[140:143], v[60:63]
    s_waitcnt lgkmcnt(3)
    v_mfma_f32_16x16x32_bf16 v[32:35], v[12:15], a[144:147], v[32:35]
    ds_read_b128 v[28:31], v4 offset:23552
    v_mfma_f32_16x16x32_bf16 v[40:43], v[12:15], a[148:151], v[40:43]
    v_mfma_f32_16x16x32_bf16 v[48:51], v[12:15], a[152:155], v[48:51]
    v_mfma_f32_16x16x32_bf16 v[56:59], v[12:15], a[156:159], v[56:59]
    s_waitcnt lgkmcnt(3)
    v_mfma_f32_16x16x32_bf16 v[36:39], v[16:19], a[144:147], v[36:39]
    ds_read_b128 v[8:11], v4 offset:24576
    v_mfma_f32_16x16x32_bf16 v[44:47], v[16:19], a[148:151], v[44:47]
    v_mfma_f32_16x16x32_bf16 v[52:55], v[16:19], a[152:155], v[52:55]
    v_mfma_f32_16x16x32_bf16 v[60:63], v[16:19], a[156:159], v[60:63]
    s_waitcnt vmcnt(16) lgkmcnt(3)
    v_mfma_f32_16x16x32_bf16 v[32:35], v[20:23], a[160:163], v[32:35]
    ds_read_b128 v[12:15], v4 offset:25600
    s_waitcnt vmcnt(15)
    v_mfma_f32_16x16x32_bf16 v[40:43], v[20:23], a[164:167], v[40:43]
    s_waitcnt vmcnt(14)
    v_mfma_f32_16x16x32_bf16 v[48:51], v[20:23], a[168:171], v[48:51]
    s_waitcnt vmcnt(13)
    v_mfma_f32_16x16x32_bf16 v[56:59], v[20:23], a[172:175], v[56:59]
    s_waitcnt lgkmcnt(3)
    v_mfma_f32_16x16x32_bf16 v[36:39], v[24:27], a[160:163], v[36:39]
    ds_read_b128 v[16:19], v4 offset:26624
    v_mfma_f32_16x16x32_bf16 v[44:47], v[24:27], a[164:167], v[44:47]
    v_mfma_f32_16x16x32_bf16 v[52:55], v[24:27], a[168:171], v[52:55]
    v_mfma_f32_16x16x32_bf16 v[60:63], v[24:27], a[172:175], v[60:63]
    s_waitcnt vmcnt(12) lgkmcnt(3)
    v_mfma_f32_16x16x32_bf16 v[32:35], v[28:31], a[176:179], v[32:35]
    ds_read_b128 v[20:23], v4 offset:27648
    s_waitcnt vmcnt(11)
    v_mfma_f32_16x16x32_bf16 v[40:43], v[28:31], a[180:183], v[40:43]
    s_waitcnt vmcnt(10)
    v_mfma_f32_16x16x32_bf16 v[48:51], v[28:31], a[184:187], v[48:51]
    s_waitcnt vmcnt(9)
    v_mfma_f32_16x16x32_bf16 v[56:59], v[28:31], a[188:191], v[56:59]
    s_waitcnt lgkmcnt(3)
    v_mfma_f32_16x16x32_bf16 v[36:39], v[8:11], a[176:179], v[36:39]
    ds_read_b128 v[24:27], v4 offset:28672
    v_mfma_f32_16x16x32_bf16 v[44:47], v[8:11], a[180:183], v[44:47]
    v_mfma_f32_16x16x32_bf16 v[52:55], v[8:11], a[184:187], v[52:55]
    v_mfma_f32_16x16x32_bf16 v[60:63], v[8:11], a[188:191], v[60:63]
    s_waitcnt vmcnt(8) lgkmcnt(3)
    v_mfma_f32_16x16x32_bf16 v[32:35], v[12:15], a[192:195], v[32:35]
    ds_read_b128 v[28:31], v4 offset:29696
    s_waitcnt vmcnt(7)
    v_mfma_f32_16x16x32_bf16 v[40:43], v[12:15], a[196:199], v[40:43]
    s_waitcnt vmcnt(6)
    v_mfma_f32_16x16x32_bf16 v[48:51], v[12:15], a[200:203], v[48:51]
    s_waitcnt vmcnt(5)
    v_mfma_f32_16x16x32_bf16 v[56:59], v[12:15], a[204:207], v[56:59]
    s_waitcnt lgkmcnt(3)
    v_mfma_f32_16x16x32_bf16 v[36:39], v[16:19], a[192:195], v[36:39]
    ds_read_b128 v[8:11], v4 offset:30720
    v_mfma_f32_16x16x32_bf16 v[44:47], v[16:19], a[196:199], v[44:47]
    v_mfma_f32_16x16x32_bf16 v[52:55], v[16:19], a[200:203], v[52:55]
    v_mfma_f32_16x16x32_bf16 v[60:63], v[16:19], a[204:207], v[60:63]
    s_waitcnt lgkmcnt(3)
    v_mfma_f32_16x16x32_bf16 v[64:67], v[20:23], a[64:67], v[64:67]
    ds_read_b128 v[12:15], v4 offset:31744
    v_mfma_f32_16x16x32_bf16 v[72:75], v[20:23], a[68:71], v[72:75]
    v_mfma_f32_16x16x32_bf16 v[80:83], v[20:23], a[72:75], v[80:83]
    v_mfma_f32_16x16x32_bf16 v[88:91], v[20:23], a[76:79], v[88:91]
    v_cvt_pk_bf16_f32 v32, v32, v33
    v_cvt_pk_bf16_f32 v33, v34, v35
    s_waitcnt lgkmcnt(3)
    v_mfma_f32_16x16x32_bf16 v[68:71], v[24:27], a[64:67], v[68:71]
    ds_read_b128 v[16:19], v4 offset:32768
    v_cvt_pk_bf16_f32 v34, v36, v37
    v_mfma_f32_16x16x32_bf16 v[76:79], v[24:27], a[68:71], v[76:79]
    v_cvt_pk_bf16_f32 v35, v38, v39
    s_add_u32 s70, s69, 0
    v_mfma_f32_16x16x32_bf16 v[84:87], v[24:27], a[72:75], v[84:87]
    buffer_store_dwordx4 v[32:35], v2, s[4:7], s70 offen sc1
    v_cvt_pk_bf16_f32 v40, v40, v41
    v_mfma_f32_16x16x32_bf16 v[92:95], v[24:27], a[76:79], v[92:95]
    v_cvt_pk_bf16_f32 v41, v42, v43
    v_cvt_pk_bf16_f32 v42, v44, v45
    s_waitcnt lgkmcnt(3)
    v_mfma_f32_16x16x32_bf16 v[64:67], v[28:31], a[80:83], v[64:67]
    ds_read_b128 v[20:23], v4 offset:33792
    v_cvt_pk_bf16_f32 v43, v46, v47
    v_mfma_f32_16x16x32_bf16 v[72:75], v[28:31], a[84:87], v[72:75]
    s_add_u32 s70, s69, 18432
    v_mfma_f32_16x16x32_bf16 v[80:83], v[28:31], a[88:91], v[80:83]
    buffer_store_dwordx4 v[40:43], v2, s[4:7], s70 offen sc1
    v_cvt_pk_bf16_f32 v48, v48, v49
    v_mfma_f32_16x16x32_bf16 v[88:91], v[28:31], a[92:95], v[88:91]
    v_cvt_pk_bf16_f32 v49, v50, v51
    v_cvt_pk_bf16_f32 v50, v52, v53
    s_waitcnt lgkmcnt(3)
    v_mfma_f32_16x16x32_bf16 v[68:71], v[8:11], a[80:83], v[68:71]
    ds_read_b128 v[24:27], v4 offset:34816
    v_cvt_pk_bf16_f32 v51, v54, v55
    v_mfma_f32_16x16x32_bf16 v[76:79], v[8:11], a[84:87], v[76:79]
    s_add_u32 s70, s69, 36864
    v_mfma_f32_16x16x32_bf16 v[84:87], v[8:11], a[88:91], v[84:87]
    buffer_store_dwordx4 v[48:51], v2, s[4:7], s70 offen sc1
    v_cvt_pk_bf16_f32 v56, v56, v57
    v_mfma_f32_16x16x32_bf16 v[92:95], v[8:11], a[92:95], v[92:95]
    v_cvt_pk_bf16_f32 v57, v58, v59
    v_cvt_pk_bf16_f32 v58, v60, v61
    s_waitcnt lgkmcnt(3)
    v_mfma_f32_16x16x32_bf16 v[64:67], v[12:15], a[96:99], v[64:67]
    ds_read_b128 v[28:31], v4 offset:35840
    v_cvt_pk_bf16_f32 v59, v62, v63
    v_mfma_f32_16x16x32_bf16 v[72:75], v[12:15], a[100:103], v[72:75]
    s_add_u32 s70, s69, 55296
    v_mfma_f32_16x16x32_bf16 v[80:83], v[12:15], a[104:107], v[80:83]
    buffer_store_dwordx4 v[56:59], v2, s[4:7], s70 offen sc1
    v_mfma_f32_16x16x32_bf16 v[88:91], v[12:15], a[108:111], v[88:91]
    s_waitcnt lgkmcnt(3)
    v_mfma_f32_16x16x32_bf16 v[68:71], v[16:19], a[96:99], v[68:71]
    s_barrier
    v_mfma_f32_16x16x32_bf16 v[76:79], v[16:19], a[100:103], v[76:79]
    v_add_u32 v4, 0xfffe5000, v4
    ds_read_b128 v[8:11], v4 offset:0
    v_mfma_f32_16x16x32_bf16 v[84:87], v[16:19], a[104:107], v[84:87]
    v_mfma_f32_16x16x32_bf16 v[92:95], v[16:19], a[108:111], v[92:95]
    s_waitcnt lgkmcnt(3)
    v_mfma_f32_16x16x32_bf16 v[64:67], v[20:23], a[112:115], v[64:67]
    ds_read_b128 v[12:15], v4 offset:1024
    v_mfma_f32_16x16x32_bf16 v[72:75], v[20:23], a[116:119], v[72:75]
    v_mfma_f32_16x16x32_bf16 v[80:83], v[20:23], a[120:123], v[80:83]
    v_mfma_f32_16x16x32_bf16 v[88:91], v[20:23], a[124:127], v[88:91]
    s_waitcnt lgkmcnt(3)
    v_mfma_f32_16x16x32_bf16 v[68:71], v[24:27], a[112:115], v[68:71]
    ds_read_b128 v[16:19], v4 offset:2048
    v_mfma_f32_16x16x32_bf16 v[76:79], v[24:27], a[116:119], v[76:79]
    v_mfma_f32_16x16x32_bf16 v[84:87], v[24:27], a[120:123], v[84:87]
    v_mfma_f32_16x16x32_bf16 v[92:95], v[24:27], a[124:127], v[92:95]
    s_waitcnt lgkmcnt(3)
    v_mfma_f32_16x16x32_bf16 v[64:67], v[28:31], a[128:131], v[64:67]
    ds_read_b128 v[20:23], v4 offset:3072
    v_mfma_f32_16x16x32_bf16 v[72:75], v[28:31], a[132:135], v[72:75]
    v_mfma_f32_16x16x32_bf16 v[80:83], v[28:31], a[136:139], v[80:83]
    v_mfma_f32_16x16x32_bf16 v[88:91], v[28:31], a[140:143], v[88:91]
    s_waitcnt lgkmcnt(3)
    v_mfma_f32_16x16x32_bf16 v[68:71], v[8:11], a[128:131], v[68:71]
    ds_read_b128 v[24:27], v4 offset:4096
    v_mfma_f32_16x16x32_bf16 v[76:79], v[8:11], a[132:135], v[76:79]
    v_mfma_f32_16x16x32_bf16 v[84:87], v[8:11], a[136:139], v[84:87]
    v_mfma_f32_16x16x32_bf16 v[92:95], v[8:11], a[140:143], v[92:95]
    s_waitcnt lgkmcnt(3)
    v_mfma_f32_16x16x32_bf16 v[64:67], v[12:15], a[144:147], v[64:67]
    ds_read_b128 v[28:31], v4 offset:5120
    v_mfma_f32_16x16x32_bf16 v[72:75], v[12:15], a[148:151], v[72:75]
    v_mfma_f32_16x16x32_bf16 v[80:83], v[12:15], a[152:155], v[80:83]
    v_mfma_f32_16x16x32_bf16 v[88:91], v[12:15], a[156:159], v[88:91]
    s_waitcnt lgkmcnt(3)
    v_mfma_f32_16x16x32_bf16 v[68:71], v[16:19], a[144:147], v[68:71]
    ds_read_b128 v[8:11], v4 offset:6144
    v_mfma_f32_16x16x32_bf16 v[76:79], v[16:19], a[148:151], v[76:79]
    v_mfma_f32_16x16x32_bf16 v[84:87], v[16:19], a[152:155], v[84:87]
    v_mfma_f32_16x16x32_bf16 v[92:95], v[16:19], a[156:159], v[92:95]
    s_waitcnt lgkmcnt(3)
    v_mfma_f32_16x16x32_bf16 v[64:67], v[20:23], a[160:163], v[64:67]
    ds_read_b128 v[12:15], v4 offset:7168
    v_mfma_f32_16x16x32_bf16 v[72:75], v[20:23], a[164:167], v[72:75]
    v_mfma_f32_16x16x32_bf16 v[80:83], v[20:23], a[168:171], v[80:83]
    v_mfma_f32_16x16x32_bf16 v[88:91], v[20:23], a[172:175], v[88:91]
    s_waitcnt lgkmcnt(3)
    v_mfma_f32_16x16x32_bf16 v[68:71], v[24:27], a[160:163], v[68:71]
    ds_read_b128 v[16:19], v4 offset:8192
    v_mfma_f32_16x16x32_bf16 v[76:79], v[24:27], a[164:167], v[76:79]
    v_mfma_f32_16x16x32_bf16 v[84:87], v[24:27], a[168:171], v[84:87]
    v_mfma_f32_16x16x32_bf16 v[92:95], v[24:27], a[172:175], v[92:95]
    s_waitcnt lgkmcnt(3)
    v_mfma_f32_16x16x32_bf16 v[64:67], v[28:31], a[176:179], v[64:67]
    ds_read_b128 v[20:23], v4 offset:9216
    v_mfma_f32_16x16x32_bf16 v[72:75], v[28:31], a[180:183], v[72:75]
    v_mfma_f32_16x16x32_bf16 v[80:83], v[28:31], a[184:187], v[80:83]
    v_mfma_f32_16x16x32_bf16 v[88:91], v[28:31], a[188:191], v[88:91]
    s_waitcnt lgkmcnt(3)
    v_mfma_f32_16x16x32_bf16 v[68:71], v[8:11], a[176:179], v[68:71]
    ds_read_b128 v[24:27], v4 offset:10240
    v_mfma_f32_16x16x32_bf16 v[76:79], v[8:11], a[180:183], v[76:79]
    v_mfma_f32_16x16x32_bf16 v[84:87], v[8:11], a[184:187], v[84:87]
    v_mfma_f32_16x16x32_bf16 v[92:95], v[8:11], a[188:191], v[92:95]
    s_waitcnt lgkmcnt(3)
    v_mfma_f32_16x16x32_bf16 v[64:67], v[12:15], a[192:195], v[64:67]
    ds_read_b128 v[28:31], v4 offset:11264
    v_mfma_f32_16x16x32_bf16 v[72:75], v[12:15], a[196:199], v[72:75]
    v_mfma_f32_16x16x32_bf16 v[80:83], v[12:15], a[200:203], v[80:83]
    v_mfma_f32_16x16x32_bf16 v[88:91], v[12:15], a[204:207], v[88:91]
    s_waitcnt lgkmcnt(3)
    v_mfma_f32_16x16x32_bf16 v[68:71], v[16:19], a[192:195], v[68:71]
    ds_read_b128 v[8:11], v4 offset:12288
    v_mfma_f32_16x16x32_bf16 v[76:79], v[16:19], a[196:199], v[76:79]
    v_mfma_f32_16x16x32_bf16 v[84:87], v[16:19], a[200:203], v[84:87]
    v_mfma_f32_16x16x32_bf16 v[92:95], v[16:19], a[204:207], v[92:95]
    s_waitcnt lgkmcnt(3)
    v_mfma_f32_16x16x32_bf16 v[96:99], v[20:23], a[64:67], v[96:99]
    ds_read_b128 v[12:15], v4 offset:13312
    v_mfma_f32_16x16x32_bf16 v[104:107], v[20:23], a[68:71], v[104:107]
    v_mfma_f32_16x16x32_bf16 v[112:115], v[20:23], a[72:75], v[112:115]
    v_mfma_f32_16x16x32_bf16 v[120:123], v[20:23], a[76:79], v[120:123]
    v_cvt_pk_bf16_f32 v64, v64, v65
    v_cvt_pk_bf16_f32 v65, v66, v67
    s_waitcnt lgkmcnt(3)
    v_mfma_f32_16x16x32_bf16 v[100:103], v[24:27], a[64:67], v[100:103]
    ds_read_b128 v[16:19], v4 offset:14336
    v_cvt_pk_bf16_f32 v66, v68, v69
    v_mfma_f32_16x16x32_bf16 v[108:111], v[24:27], a[68:71], v[108:111]
    v_cvt_pk_bf16_f32 v67, v70, v71
    s_add_u32 s70, s69, 1024
    v_mfma_f32_16x16x32_bf16 v[116:119], v[24:27], a[72:75], v[116:119]
    buffer_store_dwordx4 v[64:67], v2, s[4:7], s70 offen sc1
    v_cvt_pk_bf16_f32 v72, v72, v73
    v_mfma_f32_16x16x32_bf16 v[124:127], v[24:27], a[76:79], v[124:127]
    v_cvt_pk_bf16_f32 v73, v74, v75
    v_cvt_pk_bf16_f32 v74, v76, v77
    s_waitcnt lgkmcnt(3)
    v_mfma_f32_16x16x32_bf16 v[96:99], v[28:31], a[80:83], v[96:99]
    ds_read_b128 v[20:23], v4 offset:15360
    v_cvt_pk_bf16_f32 v75, v78, v79
    v_mfma_f32_16x16x32_bf16 v[104:107], v[28:31], a[84:87], v[104:107]
    s_add_u32 s70, s69, 19456
    v_mfma_f32_16x16x32_bf16 v[112:115], v[28:31], a[88:91], v[112:115]
    buffer_store_dwordx4 v[72:75], v2, s[4:7], s70 offen sc1
    v_cvt_pk_bf16_f32 v80, v80, v81
    v_mfma_f32_16x16x32_bf16 v[120:123], v[28:31], a[92:95], v[120:123]
    v_cvt_pk_bf16_f32 v81, v82, v83
    v_cvt_pk_bf16_f32 v82, v84, v85
    s_waitcnt lgkmcnt(3)
    v_mfma_f32_16x16x32_bf16 v[100:103], v[8:11], a[80:83], v[100:103]
    ds_read_b128 v[24:27], v4 offset:16384
    v_cvt_pk_bf16_f32 v83, v86, v87
    v_mfma_f32_16x16x32_bf16 v[108:111], v[8:11], a[84:87], v[108:111]
    s_add_u32 s70, s69, 37888
    v_mfma_f32_16x16x32_bf16 v[116:119], v[8:11], a[88:91], v[116:119]
    buffer_store_dwordx4 v[80:83], v2, s[4:7], s70 offen sc1
    v_cvt_pk_bf16_f32 v88, v88, v89
    v_mfma_f32_16x16x32_bf16 v[124:127], v[8:11], a[92:95], v[124:127]
    v_cvt_pk_bf16_f32 v89, v90, v91
    v_cvt_pk_bf16_f32 v90, v92, v93
    s_waitcnt lgkmcnt(3)
    v_mfma_f32_16x16x32_bf16 v[96:99], v[12:15], a[96:99], v[96:99]
    ds_read_b128 v[28:31], v4 offset:17408
    v_cvt_pk_bf16_f32 v91, v94, v95
    v_mfma_f32_16x16x32_bf16 v[104:107], v[12:15], a[100:103], v[104:107]
    s_add_u32 s70, s69, 56320
    v_mfma_f32_16x16x32_bf16 v[112:115], v[12:15], a[104:107], v[112:115]
    buffer_store_dwordx4 v[88:91], v2, s[4:7], s70 offen sc1
    v_mfma_f32_16x16x32_bf16 v[120:123], v[12:15], a[108:111], v[120:123]
    s_waitcnt lgkmcnt(3)
    v_mfma_f32_16x16x32_bf16 v[100:103], v[16:19], a[96:99], v[100:103]
    ds_read_b128 v[8:11], v4 offset:18432
    v_mfma_f32_16x16x32_bf16 v[108:111], v[16:19], a[100:103], v[108:111]
    v_mfma_f32_16x16x32_bf16 v[116:119], v[16:19], a[104:107], v[116:119]
    v_mfma_f32_16x16x32_bf16 v[124:127], v[16:19], a[108:111], v[124:127]
    s_waitcnt lgkmcnt(3)
    v_mfma_f32_16x16x32_bf16 v[96:99], v[20:23], a[112:115], v[96:99]
    ds_read_b128 v[12:15], v4 offset:19456
    v_mfma_f32_16x16x32_bf16 v[104:107], v[20:23], a[116:119], v[104:107]
    v_mfma_f32_16x16x32_bf16 v[112:115], v[20:23], a[120:123], v[112:115]
    v_mfma_f32_16x16x32_bf16 v[120:123], v[20:23], a[124:127], v[120:123]
    s_waitcnt lgkmcnt(3)
    v_mfma_f32_16x16x32_bf16 v[100:103], v[24:27], a[112:115], v[100:103]
    ds_read_b128 v[16:19], v4 offset:20480
    v_mfma_f32_16x16x32_bf16 v[108:111], v[24:27], a[116:119], v[108:111]
    v_mfma_f32_16x16x32_bf16 v[116:119], v[24:27], a[120:123], v[116:119]
    v_mfma_f32_16x16x32_bf16 v[124:127], v[24:27], a[124:127], v[124:127]
    s_waitcnt lgkmcnt(3)
    v_mfma_f32_16x16x32_bf16 v[96:99], v[28:31], a[128:131], v[96:99]
    ds_read_b128 v[20:23], v4 offset:21504
    v_mfma_f32_16x16x32_bf16 v[104:107], v[28:31], a[132:135], v[104:107]
    v_mfma_f32_16x16x32_bf16 v[112:115], v[28:31], a[136:139], v[112:115]
    v_mfma_f32_16x16x32_bf16 v[120:123], v[28:31], a[140:143], v[120:123]
    s_waitcnt lgkmcnt(3)
    v_mfma_f32_16x16x32_bf16 v[100:103], v[8:11], a[128:131], v[100:103]
    ds_read_b128 v[24:27], v4 offset:22528
    v_mfma_f32_16x16x32_bf16 v[108:111], v[8:11], a[132:135], v[108:111]
    v_mfma_f32_16x16x32_bf16 v[116:119], v[8:11], a[136:139], v[116:119]
    v_mfma_f32_16x16x32_bf16 v[124:127], v[8:11], a[140:143], v[124:127]
    s_waitcnt lgkmcnt(3)
    v_mfma_f32_16x16x32_bf16 v[96:99], v[12:15], a[144:147], v[96:99]
    ds_read_b128 v[28:31], v4 offset:23552
    v_mfma_f32_16x16x32_bf16 v[104:107], v[12:15], a[148:151], v[104:107]
    v_mfma_f32_16x16x32_bf16 v[112:115], v[12:15], a[152:155], v[112:115]
    v_mfma_f32_16x16x32_bf16 v[120:123], v[12:15], a[156:159], v[120:123]
    s_waitcnt lgkmcnt(3)
    v_mfma_f32_16x16x32_bf16 v[100:103], v[16:19], a[144:147], v[100:103]
    ds_read_b128 v[8:11], v4 offset:24576
    v_mfma_f32_16x16x32_bf16 v[108:111], v[16:19], a[148:151], v[108:111]
    v_mfma_f32_16x16x32_bf16 v[116:119], v[16:19], a[152:155], v[116:119]
    v_mfma_f32_16x16x32_bf16 v[124:127], v[16:19], a[156:159], v[124:127]
    s_waitcnt lgkmcnt(3)
    v_mfma_f32_16x16x32_bf16 v[96:99], v[20:23], a[160:163], v[96:99]
    ds_read_b128 v[12:15], v4 offset:25600
    v_mfma_f32_16x16x32_bf16 v[104:107], v[20:23], a[164:167], v[104:107]
    v_mfma_f32_16x16x32_bf16 v[112:115], v[20:23], a[168:171], v[112:115]
    v_mfma_f32_16x16x32_bf16 v[120:123], v[20:23], a[172:175], v[120:123]
    s_waitcnt lgkmcnt(3)
    v_mfma_f32_16x16x32_bf16 v[100:103], v[24:27], a[160:163], v[100:103]
    ds_read_b128 v[16:19], v4 offset:26624
    v_mfma_f32_16x16x32_bf16 v[108:111], v[24:27], a[164:167], v[108:111]
    v_mfma_f32_16x16x32_bf16 v[116:119], v[24:27], a[168:171], v[116:119]
    v_mfma_f32_16x16x32_bf16 v[124:127], v[24:27], a[172:175], v[124:127]
    s_waitcnt lgkmcnt(3)
    v_mfma_f32_16x16x32_bf16 v[96:99], v[28:31], a[176:179], v[96:99]
    ds_read_b128 v[20:23], v4 offset:27648
    v_mfma_f32_16x16x32_bf16 v[104:107], v[28:31], a[180:183], v[104:107]
    v_mfma_f32_16x16x32_bf16 v[112:115], v[28:31], a[184:187], v[112:115]
    v_mfma_f32_16x16x32_bf16 v[120:123], v[28:31], a[188:191], v[120:123]
    s_waitcnt lgkmcnt(3)
    v_mfma_f32_16x16x32_bf16 v[100:103], v[8:11], a[176:179], v[100:103]
    ds_read_b128 v[24:27], v4 offset:28672
    v_mfma_f32_16x16x32_bf16 v[108:111], v[8:11], a[180:183], v[108:111]
    v_mfma_f32_16x16x32_bf16 v[116:119], v[8:11], a[184:187], v[116:119]
    v_mfma_f32_16x16x32_bf16 v[124:127], v[8:11], a[188:191], v[124:127]
    s_waitcnt lgkmcnt(3)
    v_mfma_f32_16x16x32_bf16 v[96:99], v[12:15], a[192:195], v[96:99]
    ds_read_b128 v[28:31], v4 offset:29696
    v_mfma_f32_16x16x32_bf16 v[104:107], v[12:15], a[196:199], v[104:107]
    v_mfma_f32_16x16x32_bf16 v[112:115], v[12:15], a[200:203], v[112:115]
    v_mfma_f32_16x16x32_bf16 v[120:123], v[12:15], a[204:207], v[120:123]
    s_waitcnt lgkmcnt(3)
    v_mfma_f32_16x16x32_bf16 v[100:103], v[16:19], a[192:195], v[100:103]
    ds_read_b128 v[8:11], v4 offset:30720
    v_mfma_f32_16x16x32_bf16 v[108:111], v[16:19], a[196:199], v[108:111]
    v_mfma_f32_16x16x32_bf16 v[116:119], v[16:19], a[200:203], v[116:119]
    v_mfma_f32_16x16x32_bf16 v[124:127], v[16:19], a[204:207], v[124:127]
    s_waitcnt lgkmcnt(3)
    v_mfma_f32_16x16x32_bf16 v[128:131], v[20:23], a[64:67], v[128:131]
    ds_read_b128 v[12:15], v4 offset:31744
    v_mfma_f32_16x16x32_bf16 v[136:139], v[20:23], a[68:71], v[136:139]
    v_mfma_f32_16x16x32_bf16 v[144:147], v[20:23], a[72:75], v[144:147]
    v_mfma_f32_16x16x32_bf16 v[152:155], v[20:23], a[76:79], v[152:155]
    v_cvt_pk_bf16_f32 v96, v96, v97
    v_cvt_pk_bf16_f32 v97, v98, v99
    s_waitcnt lgkmcnt(3)
    v_mfma_f32_16x16x32_bf16 v[132:135], v[24:27], a[64:67], v[132:135]
    ds_read_b128 v[16:19], v4 offset:32768
    v_cvt_pk_bf16_f32 v98, v100, v101
    v_mfma_f32_16x16x32_bf16 v[140:143], v[24:27], a[68:71], v[140:143]
    v_cvt_pk_bf16_f32 v99, v102, v103
    s_add_u32 s70, s69, 2048
    v_mfma_f32_16x16x32_bf16 v[148:151], v[24:27], a[72:75], v[148:151]
    buffer_store_dwordx4 v[96:99], v2, s[4:7], s70 offen sc1
    v_cvt_pk_bf16_f32 v104, v104, v105
    v_mfma_f32_16x16x32_bf16 v[156:159], v[24:27], a[76:79], v[156:159]
    v_cvt_pk_bf16_f32 v105, v106, v107
    v_cvt_pk_bf16_f32 v106, v108, v109
    s_waitcnt lgkmcnt(3)
    v_mfma_f32_16x16x32_bf16 v[128:131], v[28:31], a[80:83], v[128:131]
    ds_read_b128 v[20:23], v4 offset:33792
    v_cvt_pk_bf16_f32 v107, v110, v111
    v_mfma_f32_16x16x32_bf16 v[136:139], v[28:31], a[84:87], v[136:139]
    s_add_u32 s70, s69, 20480
    v_mfma_f32_16x16x32_bf16 v[144:147], v[28:31], a[88:91], v[144:147]
    buffer_store_dwordx4 v[104:107], v2, s[4:7], s70 offen sc1
    v_cvt_pk_bf16_f32 v112, v112, v113
    v_mfma_f32_16x16x32_bf16 v[152:155], v[28:31], a[92:95], v[152:155]
    v_cvt_pk_bf16_f32 v113, v114, v115
    v_cvt_pk_bf16_f32 v114, v116, v117
    s_waitcnt lgkmcnt(3)
    v_mfma_f32_16x16x32_bf16 v[132:135], v[8:11], a[80:83], v[132:135]
    ds_read_b128 v[24:27], v4 offset:34816
    v_cvt_pk_bf16_f32 v115, v118, v119
    v_mfma_f32_16x16x32_bf16 v[140:143], v[8:11], a[84:87], v[140:143]
    s_add_u32 s70, s69, 38912
    v_mfma_f32_16x16x32_bf16 v[148:151], v[8:11], a[88:91], v[148:151]
    buffer_store_dwordx4 v[112:115], v2, s[4:7], s70 offen sc1
    v_cvt_pk_bf16_f32 v120, v120, v121
    v_mfma_f32_16x16x32_bf16 v[156:159], v[8:11], a[92:95], v[156:159]
    v_cvt_pk_bf16_f32 v121, v122, v123
    v_cvt_pk_bf16_f32 v122, v124, v125
    s_waitcnt lgkmcnt(3)
    v_mfma_f32_16x16x32_bf16 v[128:131], v[12:15], a[96:99], v[128:131]
    ds_read_b128 v[28:31], v4 offset:35840
    v_cvt_pk_bf16_f32 v123, v126, v127
    v_mfma_f32_16x16x32_bf16 v[136:139], v[12:15], a[100:103], v[136:139]
    s_add_u32 s70, s69, 57344
    v_mfma_f32_16x16x32_bf16 v[144:147], v[12:15], a[104:107], v[144:147]
    buffer_store_dwordx4 v[120:123], v2, s[4:7], s70 offen sc1
    v_mfma_f32_16x16x32_bf16 v[152:155], v[12:15], a[108:111], v[152:155]
    s_waitcnt lgkmcnt(3)
    v_mfma_f32_16x16x32_bf16 v[132:135], v[16:19], a[96:99], v[132:135]
    s_waitcnt vmcnt(12)
    s_barrier
    v_mfma_f32_16x16x32_bf16 v[140:143], v[16:19], a[100:103], v[140:143]
    v_add_u32 v4, 0x9000, v4
    ds_read_b128 v[8:11], v4 offset:0
    v_mfma_f32_16x16x32_bf16 v[148:151], v[16:19], a[104:107], v[148:151]
    v_mfma_f32_16x16x32_bf16 v[156:159], v[16:19], a[108:111], v[156:159]
    s_waitcnt lgkmcnt(3)
    v_mfma_f32_16x16x32_bf16 v[128:131], v[20:23], a[112:115], v[128:131]
    ds_read_b128 v[12:15], v4 offset:1024
    v_mfma_f32_16x16x32_bf16 v[136:139], v[20:23], a[116:119], v[136:139]
    v_mfma_f32_16x16x32_bf16 v[144:147], v[20:23], a[120:123], v[144:147]
    v_mfma_f32_16x16x32_bf16 v[152:155], v[20:23], a[124:127], v[152:155]
    s_waitcnt lgkmcnt(3)
    v_mfma_f32_16x16x32_bf16 v[132:135], v[24:27], a[112:115], v[132:135]
    ds_read_b128 v[16:19], v4 offset:2048
    v_mfma_f32_16x16x32_bf16 v[140:143], v[24:27], a[116:119], v[140:143]
    v_mfma_f32_16x16x32_bf16 v[148:151], v[24:27], a[120:123], v[148:151]
    v_mfma_f32_16x16x32_bf16 v[156:159], v[24:27], a[124:127], v[156:159]
    s_waitcnt lgkmcnt(3)
    v_mfma_f32_16x16x32_bf16 v[128:131], v[28:31], a[128:131], v[128:131]
    ds_read_b128 v[20:23], v4 offset:3072
    v_mfma_f32_16x16x32_bf16 v[136:139], v[28:31], a[132:135], v[136:139]
    v_mfma_f32_16x16x32_bf16 v[144:147], v[28:31], a[136:139], v[144:147]
    v_mfma_f32_16x16x32_bf16 v[152:155], v[28:31], a[140:143], v[152:155]
    s_waitcnt lgkmcnt(3)
    v_mfma_f32_16x16x32_bf16 v[132:135], v[8:11], a[128:131], v[132:135]
    ds_read_b128 v[24:27], v4 offset:4096
    v_mfma_f32_16x16x32_bf16 v[140:143], v[8:11], a[132:135], v[140:143]
    v_mfma_f32_16x16x32_bf16 v[148:151], v[8:11], a[136:139], v[148:151]
    v_mfma_f32_16x16x32_bf16 v[156:159], v[8:11], a[140:143], v[156:159]
    s_waitcnt lgkmcnt(3)
    v_mfma_f32_16x16x32_bf16 v[128:131], v[12:15], a[144:147], v[128:131]
    ds_read_b128 v[28:31], v4 offset:5120
    v_mfma_f32_16x16x32_bf16 v[136:139], v[12:15], a[148:151], v[136:139]
    v_mfma_f32_16x16x32_bf16 v[144:147], v[12:15], a[152:155], v[144:147]
    v_mfma_f32_16x16x32_bf16 v[152:155], v[12:15], a[156:159], v[152:155]
    s_waitcnt lgkmcnt(3)
    v_mfma_f32_16x16x32_bf16 v[132:135], v[16:19], a[144:147], v[132:135]
    ds_read_b128 v[8:11], v4 offset:6144
    v_mfma_f32_16x16x32_bf16 v[140:143], v[16:19], a[148:151], v[140:143]
    v_mfma_f32_16x16x32_bf16 v[148:151], v[16:19], a[152:155], v[148:151]
    v_mfma_f32_16x16x32_bf16 v[156:159], v[16:19], a[156:159], v[156:159]
    s_waitcnt lgkmcnt(3)
    v_mfma_f32_16x16x32_bf16 v[128:131], v[20:23], a[160:163], v[128:131]
    ds_read_b128 v[12:15], v4 offset:7168
    v_mfma_f32_16x16x32_bf16 v[136:139], v[20:23], a[164:167], v[136:139]
    v_mfma_f32_16x16x32_bf16 v[144:147], v[20:23], a[168:171], v[144:147]
    v_mfma_f32_16x16x32_bf16 v[152:155], v[20:23], a[172:175], v[152:155]
    s_waitcnt lgkmcnt(3)
    v_mfma_f32_16x16x32_bf16 v[132:135], v[24:27], a[160:163], v[132:135]
    ds_read_b128 v[16:19], v4 offset:8192
    v_mfma_f32_16x16x32_bf16 v[140:143], v[24:27], a[164:167], v[140:143]
    v_mfma_f32_16x16x32_bf16 v[148:151], v[24:27], a[168:171], v[148:151]
    v_mfma_f32_16x16x32_bf16 v[156:159], v[24:27], a[172:175], v[156:159]
    s_waitcnt lgkmcnt(3)
    v_mfma_f32_16x16x32_bf16 v[128:131], v[28:31], a[176:179], v[128:131]
    ds_read_b128 v[20:23], v4 offset:9216
    v_mfma_f32_16x16x32_bf16 v[136:139], v[28:31], a[180:183], v[136:139]
    v_mfma_f32_16x16x32_bf16 v[144:147], v[28:31], a[184:187], v[144:147]
    v_mfma_f32_16x16x32_bf16 v[152:155], v[28:31], a[188:191], v[152:155]
    s_waitcnt lgkmcnt(3)
    v_mfma_f32_16x16x32_bf16 v[132:135], v[8:11], a[176:179], v[132:135]
    ds_read_b128 v[24:27], v4 offset:10240
    v_mfma_f32_16x16x32_bf16 v[140:143], v[8:11], a[180:183], v[140:143]
    v_mfma_f32_16x16x32_bf16 v[148:151], v[8:11], a[184:187], v[148:151]
    v_mfma_f32_16x16x32_bf16 v[156:159], v[8:11], a[188:191], v[156:159]
    s_waitcnt lgkmcnt(3)
    v_mfma_f32_16x16x32_bf16 v[128:131], v[12:15], a[192:195], v[128:131]
    ds_read_b128 v[28:31], v4 offset:11264
    v_mfma_f32_16x16x32_bf16 v[136:139], v[12:15], a[196:199], v[136:139]
    v_mfma_f32_16x16x32_bf16 v[144:147], v[12:15], a[200:203], v[144:147]
    v_mfma_f32_16x16x32_bf16 v[152:155], v[12:15], a[204:207], v[152:155]
    s_waitcnt lgkmcnt(3)
    v_mfma_f32_16x16x32_bf16 v[132:135], v[16:19], a[192:195], v[132:135]
    ds_read_b128 v[8:11], v4 offset:12288
    v_mfma_f32_16x16x32_bf16 v[140:143], v[16:19], a[196:199], v[140:143]
    v_mfma_f32_16x16x32_bf16 v[148:151], v[16:19], a[200:203], v[148:151]
    v_mfma_f32_16x16x32_bf16 v[156:159], v[16:19], a[204:207], v[156:159]
    s_waitcnt lgkmcnt(3)
    v_mfma_f32_16x16x32_bf16 v[160:163], v[20:23], a[64:67], v[160:163]
    ds_read_b128 v[12:15], v4 offset:13312
    v_mfma_f32_16x16x32_bf16 v[164:167], v[20:23], a[68:71], v[164:167]
    v_mfma_f32_16x16x32_bf16 v[168:171], v[20:23], a[72:75], v[168:171]
    v_mfma_f32_16x16x32_bf16 v[172:175], v[20:23], a[76:79], v[172:175]
    v_cvt_pk_bf16_f32 v128, v128, v129
    v_cvt_pk_bf16_f32 v129, v130, v131
    s_waitcnt lgkmcnt(3)
    v_mfma_f32_16x16x32_bf16 v[160:163], v[24:27], a[80:83], v[160:163]
    ds_read_b128 v[16:19], v4 offset:14336
    v_cvt_pk_bf16_f32 v130, v132, v133
    v_mfma_f32_16x16x32_bf16 v[164:167], v[24:27], a[84:87], v[164:167]
    v_cvt_pk_bf16_f32 v131, v134, v135
    s_add_u32 s70, s69, 3072
    v_mfma_f32_16x16x32_bf16 v[168:171], v[24:27], a[88:91], v[168:171]
    buffer_store_dwordx4 v[128:131], v2, s[4:7], s70 offen sc1
    v_cvt_pk_bf16_f32 v136, v136, v137
    v_mfma_f32_16x16x32_bf16 v[172:175], v[24:27], a[92:95], v[172:175]
    v_cvt_pk_bf16_f32 v137, v138, v139
    v_cvt_pk_bf16_f32 v138, v140, v141
    s_waitcnt lgkmcnt(3)
    v_mfma_f32_16x16x32_bf16 v[160:163], v[28:31], a[96:99], v[160:163]
    ds_read_b128 v[20:23], v4 offset:15360
    v_cvt_pk_bf16_f32 v139, v142, v143
    v_mfma_f32_16x16x32_bf16 v[164:167], v[28:31], a[100:103], v[164:167]
    s_add_u32 s70, s69, 21504
    v_mfma_f32_16x16x32_bf16 v[168:171], v[28:31], a[104:107], v[168:171]
    buffer_store_dwordx4 v[136:139], v2, s[4:7], s70 offen sc1
    v_cvt_pk_bf16_f32 v144, v144, v145
    v_mfma_f32_16x16x32_bf16 v[172:175], v[28:31], a[108:111], v[172:175]
    v_cvt_pk_bf16_f32 v145, v146, v147
    v_cvt_pk_bf16_f32 v146, v148, v149
    s_waitcnt lgkmcnt(3)
    v_mfma_f32_16x16x32_bf16 v[160:163], v[8:11], a[112:115], v[160:163]
    ds_read_b128 v[24:27], v4 offset:16384
    v_cvt_pk_bf16_f32 v147, v150, v151
    v_mfma_f32_16x16x32_bf16 v[164:167], v[8:11], a[116:119], v[164:167]
    s_add_u32 s70, s69, 39936
    v_mfma_f32_16x16x32_bf16 v[168:171], v[8:11], a[120:123], v[168:171]
    buffer_store_dwordx4 v[144:147], v2, s[4:7], s70 offen sc1
    v_cvt_pk_bf16_f32 v152, v152, v153
    v_mfma_f32_16x16x32_bf16 v[172:175], v[8:11], a[124:127], v[172:175]
    v_cvt_pk_bf16_f32 v153, v154, v155
    v_cvt_pk_bf16_f32 v154, v156, v157
    s_waitcnt lgkmcnt(3)
    v_mfma_f32_16x16x32_bf16 v[160:163], v[12:15], a[128:131], v[160:163]
    ds_read_b128 v[28:31], v4 offset:17408
    v_cvt_pk_bf16_f32 v155, v158, v159
    v_mfma_f32_16x16x32_bf16 v[164:167], v[12:15], a[132:135], v[164:167]
    s_add_u32 s70, s69, 58368
    v_mfma_f32_16x16x32_bf16 v[168:171], v[12:15], a[136:139], v[168:171]
    buffer_store_dwordx4 v[152:155], v2, s[4:7], s70 offen sc1
    v_mfma_f32_16x16x32_bf16 v[172:175], v[12:15], a[140:143], v[172:175]
    s_waitcnt lgkmcnt(3)
    v_mfma_f32_16x16x32_bf16 v[160:163], v[16:19], a[144:147], v[160:163]
    v_mfma_f32_16x16x32_bf16 v[164:167], v[16:19], a[148:151], v[164:167]
    v_mfma_f32_16x16x32_bf16 v[168:171], v[16:19], a[152:155], v[168:171]
    v_mfma_f32_16x16x32_bf16 v[172:175], v[16:19], a[156:159], v[172:175]
    s_waitcnt lgkmcnt(2)
    v_mfma_f32_16x16x32_bf16 v[160:163], v[20:23], a[160:163], v[160:163]
    v_mfma_f32_16x16x32_bf16 v[164:167], v[20:23], a[164:167], v[164:167]
    v_mfma_f32_16x16x32_bf16 v[168:171], v[20:23], a[168:171], v[168:171]
    v_mfma_f32_16x16x32_bf16 v[172:175], v[20:23], a[172:175], v[172:175]
    s_waitcnt lgkmcnt(1)
    v_mfma_f32_16x16x32_bf16 v[160:163], v[24:27], a[176:179], v[160:163]
    v_mfma_f32_16x16x32_bf16 v[164:167], v[24:27], a[180:183], v[164:167]
    v_mfma_f32_16x16x32_bf16 v[168:171], v[24:27], a[184:187], v[168:171]
    v_mfma_f32_16x16x32_bf16 v[172:175], v[24:27], a[188:191], v[172:175]
    s_waitcnt lgkmcnt(0)
    v_mfma_f32_16x16x32_bf16 v[160:163], v[28:31], a[192:195], v[160:163]
    v_mfma_f32_16x16x32_bf16 v[164:167], v[28:31], a[196:199], v[164:167]
    v_mfma_f32_16x16x32_bf16 v[168:171], v[28:31], a[200:203], v[168:171]
    v_mfma_f32_16x16x32_bf16 v[172:175], v[28:31], a[204:207], v[172:175]
    s_nop 4
    v_cvt_pk_bf16_f32 v160, v160, v161
    v_cvt_pk_bf16_f32 v161, v162, v163
    s_add_u32 s70, s68, 4096
    buffer_store_dwordx2 v[160:161], v0, s[4:7], s70 offen sc1
    v_cvt_pk_bf16_f32 v164, v164, v165
    v_cvt_pk_bf16_f32 v165, v166, v167
    s_add_u32 s70, s68, 22528
    buffer_store_dwordx2 v[164:165], v0, s[4:7], s70 offen sc1
    v_cvt_pk_bf16_f32 v168, v168, v169
    v_cvt_pk_bf16_f32 v169, v170, v171
    s_add_u32 s70, s68, 40960
    buffer_store_dwordx2 v[168:169], v0, s[4:7], s70 offen sc1
    v_cvt_pk_bf16_f32 v172, v172, v173
    v_cvt_pk_bf16_f32 v173, v174, v175
    s_add_u32 s70, s68, 59392
    buffer_store_dwordx2 v[172:173], v0, s[4:7], s70 offen sc1
    s_waitcnt vmcnt(0) lgkmcnt(0)
ffn0_kernel_end:
    s_endpgm
L_p0_slow_29:
    s_mov_b32 s64, 0x40000
L_spin_35:
    buffer_load_dword v168, v7, s[4:7], s52 offen sc1
    s_waitcnt vmcnt(0)
    v_cmp_le_u32 vcc, 1, v168
    s_sub_u32 s64, s64, 1
    s_cbranch_scc1 L_p0_back_30
    s_cmp_eq_u64 vcc, exec
    s_cbranch_scc1 L_p0_back_30
    s_branch L_spin_35
L_p1_slow_31:
    s_mov_b32 s64, 0x40000
L_spin_36:
    buffer_load_dword v5, v7, s[4:7], s52 offen sc1
    s_waitcnt vmcnt(0)
    v_cmp_le_u32 vcc, 2, v5
    s_sub_u32 s64, s64, 1
    s_cbranch_scc1 L_p1_back_32
    s_cmp_eq_u64 vcc, exec
    s_cbranch_scc1 L_p1_back_32
    s_branch L_spin_36
L_p2_slow_33:
    s_mov_b32 s64, 0x40000
L_spin_37:
    buffer_load_dword v5, v7, s[4:7], s52 offen sc1
    s_waitcnt vmcnt(0)
    v_cmp_le_u32 vcc, 3, v5
    s_sub_u32 s64, s64, 1
    s_cbranch_scc1 L_p2_back_34
    s_cmp_eq_u64 vcc, exec
    s_cbranch_scc1 L_p2_back_34
    s_branch L_spin_37
.section .rodata,"a"
.p2align 6
.amdhsa_kernel ffn0_kernel
  .amdhsa_next_free_vgpr 512
  .amdhsa_next_free_sgpr 102
  .amdhsa_accum_offset 256
  .amdhsa_group_segment_fixed_size 0
  .amdhsa_kernarg_size 80
  .amdhsa_user_sgpr_count 2
  .amdhsa_user_sgpr_kernarg_segment_ptr 1
  .amdhsa_system_sgpr_workgroup_id_x 1
  .amdhsa_float_denorm_mode_32 3
.end_amdhsa_kernel
.text
.globl red0_kernel
.p2align 8
.type red0_kernel,@function
red0_kernel:
    s_cmp_ge_u32 s2, 256
    s_cbranch_scc1 red0_kernel_end
    s_load_dwordx16 s[24:39], s[0:1], 0
    s_load_dwordx4 s[40:43], s[0:1], 64
    v_lshrrev_b32 v1, 6, v0
    s_and_b32 s21, s2, 7
    v_readfirstlane_b32 s20, v1
    s_lshr_b32 s22, s2, 3
    v_and_b32 v1, 63, v0
    v_lshlrev_b32 v2, 4, v1
    v_lshlrev_b32 v3, 7, v0
    s_getpc_b64 s[16:17]
L_pc_38:
    v_min_u32 v4, red0_kernel_end-L_pc_38, v3
    global_load_dword v4, v4, s[16:17]
    s_waitcnt lgkmcnt(0)
    s_mov_b32 s4, s42
    s_mov_b32 s5, s43
    s_mov_b32 s6, 0x10000000
    s_mov_b32 s7, 0x20000
    s_lshl_b32 s47, s21, 5
    s_add_u32 s47, s47, s22
    v_and_b32 v8, 7, v1
    v_lshrrev_b32 v9, 3, v1
    s_lshl_b32 s48, s47, 3
    v_add_u32 v3, s48, v8
    v_mul_u32_u24 v3, 1152, v3
    s_mul_i32 s48, s20, 384
    v_lshl_add_u32 v3, v9, 4, v3
    v_add_u32 v3, s48, v3
    s_lshr_b32 s48, s47, 1
    s_mul_i32 s48, s48, 18432
    s_and_b32 s49, s47, 1
    s_lshl_b32 s49, s49, 7
    s_add_u32 s48, s48, s49
    s_mul_i32 s49, s20, 6144
    s_add_u32 s48, s48, s49
    v_lshlrev_b32 v8, 4, v8
    v_lshl_add_u32 v8, v9, 8, v8
    s_waitcnt vmcnt(0)
    v_add_u32 v4, s48, v8
    v_lshrrev_b32 v8, 3, v1
    v_and_b32 v9, 7, v1
    s_and_b32 s48, s47, 1
    s_lshl_b32 s48, s48, 3
    v_add_u32 v9, s48, v9
    v_lshlrev_b32 v9, 4, v9
    v_bfe_u32 v10, v8, 1, 1
    v_and_b32 v11, 1, v8
    v_lshl_add_u32 v9, v11, 4, v9
    v_lshl_add_u32 v9, v10, 9, v9
    v_and_b32 v10, 3, v8
    v_lshlrev_b32 v10, 8, v10
    v_sub_u32 v9, v9, v10
    s_mul_i32 s48, s20, 6
    v_lshrrev_b32 v8, 2, v8
    v_add_u32 v8, s48, v8
    v_add_u32 v10, 0, v8
    v_cmp_eq_u32 vcc, 4, v10
    v_cmp_eq_u32 s[56:57], 13, v10
    s_nop 0
    s_or_b64 vcc, vcc, s[56:57]
    v_cndmask_b32 v10, 0, v9, vcc
    v_add3_u32 v5, v4, v10, 0
    v_add_u32 v5, 0, v5
    v_add_u32 v10, 2, v8
    v_cmp_eq_u32 vcc, 4, v10
    v_cmp_eq_u32 s[56:57], 13, v10
    s_nop 0
    s_or_b64 vcc, vcc, s[56:57]
    v_cndmask_b32 v10, 0, v9, vcc
    v_add3_u32 v6, v4, v10, 0
    v_add_u32 v6, 2048, v6
    v_add_u32 v10, 4, v8
    v_cmp_eq_u32 vcc, 4, v10
    v_cmp_eq_u32 s[56:57], 13, v10
    s_nop 0
    s_or_b64 vcc, vcc, s[56:57]
    v_cndmask_b32 v10, 0, v9, vcc
    v_add3_u32 v7, v4, v10, 0
    v_add_u32 v7, 4096, v7
    s_cmp_eq_u32 s20, 3
    s_cbranch_scc1 L_w3a_39
    s_mov_b32 s48, 25690112
    buffer_load_dwordx4 v[16:19], v4, s[4:7], s48 offen offset:0
    buffer_load_dwordx4 v[52:55], v4, s[4:7], s48 offen offset:2048
    s_add_u32 s48, s48, 4096
    buffer_load_dwordx4 v[88:91], v4, s[4:7], s48 offen offset:0
    s_mov_b32 s48, 50331648
    buffer_load_dwordx4 v[20:23], v5, s[4:7], s48 offen
    buffer_load_dwordx4 v[56:59], v6, s[4:7], s48 offen
    buffer_load_dwordx4 v[92:95], v7, s[4:7], s48 offen
    s_mov_b32 s48, 52690944
    buffer_load_dwordx4 v[24:27], v5, s[4:7], s48 offen
    buffer_load_dwordx4 v[60:63], v6, s[4:7], s48 offen
    buffer_load_dwordx4 v[96:99], v7, s[4:7], s48 offen
    s_mov_b32 s48, 55050240
    buffer_load_dwordx4 v[28:31], v5, s[4:7], s48 offen
    buffer_load_dwordx4 v[64:67], v6, s[4:7], s48 offen
    buffer_load_dwordx4 v[100:103], v7, s[4:7], s48 offen
    s_mov_b32 s48, 57409536
    buffer_load_dwordx4 v[32:35], v5, s[4:7], s48 offen
    buffer_load_dwordx4 v[68:71], v6, s[4:7], s48 offen
    buffer_load_dwordx4 v[104:107], v7, s[4:7], s48 offen
    s_mov_b32 s48, 59768832
    buffer_load_dwordx4 v[36:39], v5, s[4:7], s48 offen
    buffer_load_dwordx4 v[72:75], v6, s[4:7], s48 offen
    buffer_load_dwordx4 v[108:111], v7, s[4:7], s48 offen
    s_mov_b32 s48, 62128128
    buffer_load_dwordx4 v[40:43], v5, s[4:7], s48 offen
    buffer_load_dwordx4 v[76:79], v6, s[4:7], s48 offen
    buffer_load_dwordx4 v[112:115], v7, s[4:7], s48 offen
    s_mov_b32 s48, 64487424
    buffer_load_dwordx4 v[44:47], v5, s[4:7], s48 offen
    buffer_load_dwordx4 v[80:83], v6, s[4:7], s48 offen
    buffer_load_dwordx4 v[116:119], v7, s[4:7], s48 offen
    s_mov_b32 s48, 66846720
    buffer_load_dwordx4 v[48:51], v5, s[4:7], s48 offen
    buffer_load_dwordx4 v[84:87], v6, s[4:7], s48 offen
    buffer_load_dwordx4 v[120:123], v7, s[4:7], s48 offen
    s_waitcnt vmcnt(26)
    v_lshlrev_b32 v128, 16, v16
    v_and_b32 v129, 0xffff0000, v16
    v_lshlrev_b32 v130, 16, v17
    v_and_b32 v131, 0xffff0000, v17
    v_lshlrev_b32 v132, 16, v18
    v_and_b32 v133, 0xffff0000, v18
    v_lshlrev_b32 v134, 16, v19
    v_and_b32 v135, 0xffff0000, v19
    s_waitcnt vmcnt(25)
    v_lshlrev_b32 v136, 16, v52
    v_and_b32 v137, 0xffff0000, v52
    v_lshlrev_b32 v138, 16, v53
    v_and_b32 v139, 0xffff0000, v53
    v_lshlrev_b32 v140, 16, v54
    v_and_b32 v141, 0xffff0000, v54
    v_lshlrev_b32 v142, 16, v55
    v_and_b32 v143, 0xffff0000, v55
    s_waitcnt vmcnt(24)
    v_lshlrev_b32 v144, 16, v88
    v_and_b32 v145, 0xffff0000, v88
    v_lshlrev_b32 v146, 16, v89
    v_and_b32 v147, 0xffff0000, v89
    v_lshlrev_b32 v148, 16, v90
    v_and_b32 v149, 0xffff0000, v90
    v_lshlrev_b32 v150, 16, v91
    v_and_b32 v151, 0xffff0000, v91
    s_waitcnt vmcnt(23)
    v_lshlrev_b32 v8, 16, v20
    v_and_b32 v9, 0xffff0000, v20
    v_add_f32 v128, v128, v8
    v_add_f32 v129, v129, v9
    v_lshlrev_b32 v10, 16, v21
    v_and_b32 v11, 0xffff0000, v21
    v_add_f32 v130, v130, v10
    v_add_f32 v131, v131, v11
    v_lshlrev_b32 v8, 16, v22
    v_and_b32 v9, 0xffff0000, v22
    v_add_f32 v132, v132, v8
    v_add_f32 v133, v133, v9
    v_lshlrev_b32 v10, 16, v23
    v_and_b32 v11, 0xffff0000, v23
    v_add_f32 v134, v134, v10
    v_add_f32 v135, v135, v11
    s_waitcnt vmcnt(22)
    v_lshlrev_b32 v8, 16, v56
    v_and_b32 v9, 0xffff0000, v56
    v_add_f32 v136, v136, v8
    v_add_f32 v137, v137, v9
    v_lshlrev_b32 v10, 16, v57
    v_and_b32 v11, 0xffff0000, v57
    v_add_f32 v138, v138, v10
    v_add_f32 v139, v139, v11
    v_lshlrev_b32 v8, 16, v58
    v_and_b32 v9, 0xffff0000, v58
    v_add_f32 v140, v140, v8
    v_add_f32 v141, v141, v9
    v_lshlrev_b32 v10, 16, v59
    v_and_b32 v11, 0xffff0000, v59
    v_add_f32 v142, v142, v10
    v_add_f32 v143, v143, v11
    s_waitcnt vmcnt(21)
    v_lshlrev_b32 v8, 16, v92
    v_and_b32 v9, 0xffff0000, v92
    v_add_f32 v144, v144, v8
    v_add_f32 v145, v145, v9
    v_lshlrev_b32 v10, 16, v93
    v_and_b32 v11, 0xffff0000, v93
    v_add_f32 v146, v146, v10
    v_add_f32 v147, v147, v11
    v_lshlrev_b32 v8, 16, v94
    v_and_b32 v9, 0xffff0000, v94
    v_add_f32 v148, v148, v8
    v_add_f32 v149, v149, v9
    v_lshlrev_b32 v10, 16, v95
    v_and_b32 v11, 0xffff0000, v95
    v_add_f32 v150, v150, v10
    v_add_f32 v151, v151, v11
    s_waitcnt vmcnt(20)
    v_lshlrev_b32 v8, 16, v24
    v_and_b32 v9, 0xffff0000, v24
    v_add_f32 v128, v128, v8
    v_add_f32 v129, v129, v9
    v_lshlrev_b32 v10, 16, v25
    v_and_b32 v11, 0xffff0000, v25
    v_add_f32 v130, v130, v10
    v_add_f32 v131, v131, v11
    v_lshlrev_b32 v8, 16, v26
    v_and_b32 v9, 0xffff0000, v26
    v_add_f32 v132, v132, v8
    v_add_f32 v133, v133, v9
    v_lshlrev_b32 v10, 16, v27
    v_and_b32 v11, 0xffff0000, v27
    v_add_f32 v134, v134, v10
    v_add_f32 v135, v135, v11
    s_waitcnt vmcnt(19)
    v_lshlrev_b32 v8, 16, v60
    v_and_b32 v9, 0xffff0000, v60
    v_add_f32 v136, v136, v8
    v_add_f32 v137, v137, v9
    v_lshlrev_b32 v10, 16, v61
    v_and_b32 v11, 0xffff0000, v61
    v_add_f32 v138, v138, v10
    v_add_f32 v139, v139, v11
    v_lshlrev_b32 v8, 16, v62
    v_and_b32 v9, 0xffff0000, v62
    v_add_f32 v140, v140, v8
    v_add_f32 v141, v141, v9
    v_lshlrev_b32 v10, 16, v63
    v_and_b32 v11, 0xffff0000, v63
    v_add_f32 v142, v142, v10
    v_add_f32 v143, v143, v11
    s_waitcnt vmcnt(18)
    v_lshlrev_b32 v8, 16, v96
    v_and_b32 v9, 0xffff0000, v96
    v_add_f32 v144, v144, v8
    v_add_f32 v145, v145, v9
    v_lshlrev_b32 v10, 16, v97
    v_and_b32 v11, 0xffff0000, v97
    v_add_f32 v146, v146, v10
    v_add_f32 v147, v147, v11
    v_lshlrev_b32 v8, 16, v98
    v_and_b32 v9, 0xffff0000, v98
    v_add_f32 v148, v148, v8
    v_add_f32 v149, v149, v9
    v_lshlrev_b32 v10, 16, v99
    v_and_b32 v11, 0xffff0000, v99
    v_add_f32 v150, v150, v10
    v_add_f32 v151, v151, v11
    s_waitcnt vmcnt(17)
    v_lshlrev_b32 v8, 16, v28
    v_and_b32 v9, 0xffff0000, v28
    v_add_f32 v128, v128, v8
    v_add_f32 v129, v129, v9
    v_lshlrev_b32 v10, 16, v29
    v_and_b32 v11, 0xffff0000, v29
    v_add_f32 v130, v130, v10
    v_add_f32 v131, v131, v11
    v_lshlrev_b32 v8, 16, v30
    v_and_b32 v9, 0xffff0000, v30
    v_add_f32 v132, v132, v8
    v_add_f32 v133, v133, v9
    v_lshlrev_b32 v10, 16, v31
    v_and_b32 v11, 0xffff0000, v31
    v_add_f32 v134, v134, v10
    v_add_f32 v135, v135, v11
    s_waitcnt vmcnt(16)
    v_lshlrev_b32 v8, 16, v64
    v_and_b32 v9, 0xffff0000, v64
    v_add_f32 v136, v136, v8
    v_add_f32 v137, v137, v9
    v_lshlrev_b32 v10, 16, v65
    v_and_b32 v11, 0xffff0000, v65
    v_add_f32 v138, v138, v10
    v_add_f32 v139, v139, v11
    v_lshlrev_b32 v8, 16, v66
    v_and_b32 v9, 0xffff0000, v66
    v_add_f32 v140, v140, v8
    v_add_f32 v141, v141, v9
    v_lshlrev_b32 v10, 16, v67
    v_and_b32 v11, 0xffff0000, v67
    v_add_f32 v142, v142, v10
    v_add_f32 v143, v143, v11
    s_waitcnt vmcnt(15)
    v_lshlrev_b32 v8, 16, v100
    v_and_b32 v9, 0xffff0000, v100
    v_add_f32 v144, v144, v8
    v_add_f32 v145, v145, v9
    v_lshlrev_b32 v10, 16, v101
    v_and_b32 v11, 0xffff0000, v101
    v_add_f32 v146, v146, v10
    v_add_f32 v147, v147, v11
    v_lshlrev_b32 v8, 16, v102
    v_and_b32 v9, 0xffff0000, v102
    v_add_f32 v148, v148, v8
    v_add_f32 v149, v149, v9
    v_lshlrev_b32 v10, 16, v103
    v_and_b32 v11, 0xffff0000, v103
    v_add_f32 v150, v150, v10
    v_add_f32 v151, v151, v11
    s_waitcnt vmcnt(14)
    v_lshlrev_b32 v8, 16, v32
    v_and_b32 v9, 0xffff0000, v32
    v_add_f32 v128, v128, v8
    v_add_f32 v129, v129, v9
    v_lshlrev_b32 v10, 16, v33
    v_and_b32 v11, 0xffff0000, v33
    v_add_f32 v130, v130, v10
    v_add_f32 v131, v131, v11
    v_lshlrev_b32 v8, 16, v34
    v_and_b32 v9, 0xffff0000, v34
    v_add_f32 v132, v132, v8
    v_add_f32 v133, v133, v9
    v_lshlrev_b32 v10, 16, v35
    v_and_b32 v11, 0xffff0000, v35
    v_add_f32 v134, v134, v10
    v_add_f32 v135, v135, v11
    s_waitcnt vmcnt(13)
    v_lshlrev_b32 v8, 16, v68
    v_and_b32 v9, 0xffff0000, v68
    v_add_f32 v136, v136, v8
    v_add_f32 v137, v137, v9
    v_lshlrev_b32 v10, 16, v69
    v_and_b32 v11, 0xffff0000, v69
    v_add_f32 v138, v138, v10
    v_add_f32 v139, v139, v11
    v_lshlrev_b32 v8, 16, v70
    v_and_b32 v9, 0xffff0000, v70
    v_add_f32 v140, v140, v8
    v_add_f32 v141, v141, v9
    v_lshlrev_b32 v10, 16, v71
    v_and_b32 v11, 0xffff0000, v71
    v_add_f32 v142, v142, v10
    v_add_f32 v143, v143, v11
    s_waitcnt vmcnt(12)
    v_lshlrev_b32 v8, 16, v104
    v_and_b32 v9, 0xffff0000, v104
    v_add_f32 v144, v144, v8
    v_add_f32 v145, v145, v9
    v_lshlrev_b32 v10, 16, v105
    v_and_b32 v11, 0xffff0000, v105
    v_add_f32 v146, v146, v10
    v_add_f32 v147, v147, v11
    v_lshlrev_b32 v8, 16, v106
    v_and_b32 v9, 0xffff0000, v106
    v_add_f32 v148, v148, v8
    v_add_f32 v149, v149, v9
    v_lshlrev_b32 v10, 16, v107
    v_and_b32 v11, 0xffff0000, v107
    v_add_f32 v150, v150, v10
    v_add_f32 v151, v151, v11
    s_waitcnt vmcnt(11)
    v_lshlrev_b32 v8, 16, v36
    v_and_b32 v9, 0xffff0000, v36
    v_add_f32 v128, v128, v8
    v_add_f32 v129, v129, v9
    v_lshlrev_b32 v10, 16, v37
    v_and_b32 v11, 0xffff0000, v37
    v_add_f32 v130, v130, v10
    v_add_f32 v131, v131, v11
    v_lshlrev_b32 v8, 16, v38
    v_and_b32 v9, 0xffff0000, v38
    v_add_f32 v132, v132, v8
    v_add_f32 v133, v133, v9
    v_lshlrev_b32 v10, 16, v39
    v_and_b32 v11, 0xffff0000, v39
    v_add_f32 v134, v134, v10
    v_add_f32 v135, v135, v11
    s_waitcnt vmcnt(10)
    v_lshlrev_b32 v8, 16, v72
    v_and_b32 v9, 0xffff0000, v72
    v_add_f32 v136, v136, v8
    v_add_f32 v137, v137, v9
    v_lshlrev_b32 v10, 16, v73
    v_and_b32 v11, 0xffff0000, v73
    v_add_f32 v138, v138, v10
    v_add_f32 v139, v139, v11
    v_lshlrev_b32 v8, 16, v74
    v_and_b32 v9, 0xffff0000, v74
    v_add_f32 v140, v140, v8
    v_add_f32 v141, v141, v9
    v_lshlrev_b32 v10, 16, v75
    v_and_b32 v11, 0xffff0000, v75
    v_add_f32 v142, v142, v10
    v_add_f32 v143, v143, v11
    s_waitcnt vmcnt(9)
    v_lshlrev_b32 v8, 16, v108
    v_and_b32 v9, 0xffff0000, v108
    v_add_f32 v144, v144, v8
    v_add_f32 v145, v145, v9
    v_lshlrev_b32 v10, 16, v109
    v_and_b32 v11, 0xffff0000, v109
    v_add_f32 v146, v146, v10
    v_add_f32 v147, v147, v11
    v_lshlrev_b32 v8, 16, v110
    v_and_b32 v9, 0xffff0000, v110
    v_add_f32 v148, v148, v8
    v_add_f32 v149, v149, v9
    v_lshlrev_b32 v10, 16, v111
    v_and_b32 v11, 0xffff0000, v111
    v_add_f32 v150, v150, v10
    v_add_f32 v151, v151, v11
    s_waitcnt vmcnt(8)
    v_lshlrev_b32 v8, 16, v40
    v_and_b32 v9, 0xffff0000, v40
    v_add_f32 v128, v128, v8
    v_add_f32 v129, v129, v9
    v_lshlrev_b32 v10, 16, v41
    v_and_b32 v11, 0xffff0000, v41
    v_add_f32 v130, v130, v10
    v_add_f32 v131, v131, v11
    v_lshlrev_b32 v8, 16, v42
    v_and_b32 v9, 0xffff0000, v42
    v_add_f32 v132, v132, v8
    v_add_f32 v133, v133, v9
    v_lshlrev_b32 v10, 16, v43
    v_and_b32 v11, 0xffff0000, v43
    v_add_f32 v134, v134, v10
    v_add_f32 v135, v135, v11
    s_waitcnt vmcnt(7)
    v_lshlrev_b32 v8, 16, v76
    v_and_b32 v9, 0xffff0000, v76
    v_add_f32 v136, v136, v8
    v_add_f32 v137, v137, v9
    v_lshlrev_b32 v10, 16, v77
    v_and_b32 v11, 0xffff0000, v77
    v_add_f32 v138, v138, v10
    v_add_f32 v139, v139, v11
    v_lshlrev_b32 v8, 16, v78
    v_and_b32 v9, 0xffff0000, v78
    v_add_f32 v140, v140, v8
    v_add_f32 v141, v141, v9
    v_lshlrev_b32 v10, 16, v79
    v_and_b32 v11, 0xffff0000, v79
    v_add_f32 v142, v142, v10
    v_add_f32 v143, v143, v11
    s_waitcnt vmcnt(6)
    v_lshlrev_b32 v8, 16, v112
    v_and_b32 v9, 0xffff0000, v112
    v_add_f32 v144, v144, v8
    v_add_f32 v145, v145, v9
    v_lshlrev_b32 v10, 16, v113
    v_and_b32 v11, 0xffff0000, v113
    v_add_f32 v146, v146, v10
    v_add_f32 v147, v147, v11
    v_lshlrev_b32 v8, 16, v114
    v_and_b32 v9, 0xffff0000, v114
    v_add_f32 v148, v148, v8
    v_add_f32 v149, v149, v9
    v_lshlrev_b32 v10, 16, v115
    v_and_b32 v11, 0xffff0000, v115
    v_add_f32 v150, v150, v10
    v_add_f32 v151, v151, v11
    s_waitcnt vmcnt(5)
    v_lshlrev_b32 v8, 16, v44
    v_and_b32 v9, 0xffff0000, v44
    v_add_f32 v128, v128, v8
    v_add_f32 v129, v129, v9
    v_lshlrev_b32 v10, 16, v45
    v_and_b32 v11, 0xffff0000, v45
    v_add_f32 v130, v130, v10
    v_add_f32 v131, v131, v11
    v_lshlrev_b32 v8, 16, v46
    v_and_b32 v9, 0xffff0000, v46
    v_add_f32 v132, v132, v8
    v_add_f32 v133, v133, v9
    v_lshlrev_b32 v10, 16, v47
    v_and_b32 v11, 0xffff0000, v47
    v_add_f32 v134, v134, v10
    v_add_f32 v135, v135, v11
    s_waitcnt vmcnt(4)
    v_lshlrev_b32 v8, 16, v80
    v_and_b32 v9, 0xffff0000, v80
    v_add_f32 v136, v136, v8
    v_add_f32 v137, v137, v9
    v_lshlrev_b32 v10, 16, v81
    v_and_b32 v11, 0xffff0000, v81
    v_add_f32 v138, v138, v10
    v_add_f32 v139, v139, v11
    v_lshlrev_b32 v8, 16, v82
    v_and_b32 v9, 0xffff0000, v82
    v_add_f32 v140, v140, v8
    v_add_f32 v141, v141, v9
    v_lshlrev_b32 v10, 16, v83
    v_and_b32 v11, 0xffff0000, v83
    v_add_f32 v142, v142, v10
    v_add_f32 v143, v143, v11
    s_waitcnt vmcnt(3)
    v_lshlrev_b32 v8, 16, v116
    v_and_b32 v9, 0xffff0000, v116
    v_add_f32 v144, v144, v8
    v_add_f32 v145, v145, v9
    v_lshlrev_b32 v10, 16, v117
    v_and_b32 v11, 0xffff0000, v117
    v_add_f32 v146, v146, v10
    v_add_f32 v147, v147, v11
    v_lshlrev_b32 v8, 16, v118
    v_and_b32 v9, 0xffff0000, v118
    v_add_f32 v148, v148, v8
    v_add_f32 v149, v149, v9
    v_lshlrev_b32 v10, 16, v119
    v_and_b32 v11, 0xffff0000, v119
    v_add_f32 v150, v150, v10
    v_add_f32 v151, v151, v11
    s_waitcnt vmcnt(2)
    v_lshlrev_b32 v8, 16, v48
    v_and_b32 v9, 0xffff0000, v48
    v_add_f32 v128, v128, v8
    v_add_f32 v129, v129, v9
    v_lshlrev_b32 v10, 16, v49
    v_and_b32 v11, 0xffff0000, v49
    v_add_f32 v130, v130, v10
    v_add_f32 v131, v131, v11
    v_lshlrev_b32 v8, 16, v50
    v_and_b32 v9, 0xffff0000, v50
    v_add_f32 v132, v132, v8
    v_add_f32 v133, v133, v9
    v_lshlrev_b32 v10, 16, v51
    v_and_b32 v11, 0xffff0000, v51
    v_add_f32 v134, v134, v10
    v_add_f32 v135, v135, v11
    s_waitcnt vmcnt(1)
    v_lshlrev_b32 v8, 16, v84
    v_and_b32 v9, 0xffff0000, v84
    v_add_f32 v136, v136, v8
    v_add_f32 v137, v137, v9
    v_lshlrev_b32 v10, 16, v85
    v_and_b32 v11, 0xffff0000, v85
    v_add_f32 v138, v138, v10
    v_add_f32 v139, v139, v11
    v_lshlrev_b32 v8, 16, v86
    v_and_b32 v9, 0xffff0000, v86
    v_add_f32 v140, v140, v8
    v_add_f32 v141, v141, v9
    v_lshlrev_b32 v10, 16, v87
    v_and_b32 v11, 0xffff0000, v87
    v_add_f32 v142, v142, v10
    v_add_f32 v143, v143, v11
    s_waitcnt vmcnt(0)
    v_lshlrev_b32 v8, 16, v120
    v_and_b32 v9, 0xffff0000, v120
    v_add_f32 v144, v144, v8
    v_add_f32 v145, v145, v9
    v_lshlrev_b32 v10, 16, v121
    v_and_b32 v11, 0xffff0000, v121
    v_add_f32 v146, v146, v10
    v_add_f32 v147, v147, v11
    v_lshlrev_b32 v8, 16, v122
    v_and_b32 v9, 0xffff0000, v122
    v_add_f32 v148, v148, v8
    v_add_f32 v149, v149, v9
    v_lshlrev_b32 v10, 16, v123
    v_and_b32 v11, 0xffff0000, v123
    v_add_f32 v150, v150, v10
    v_add_f32 v151, v151, v11
    s_add_u32 s16, s42, 28311552
    s_addc_u32 s17, s43, 0
    s_mov_b32 s18, 0x240000
    s_mov_b32 s19, 0x20000
    v_cvt_pk_bf16_f32 v160, v128, v129
    v_cvt_pk_bf16_f32 v161, v130, v131
    v_cvt_pk_bf16_f32 v162, v132, v133
    v_cvt_pk_bf16_f32 v163, v134, v135
    buffer_store_dwordx4 v[160:163], v3, s[16:19], 0 offen offset:0
    v_cvt_pk_bf16_f32 v164, v136, v137
    v_cvt_pk_bf16_f32 v165, v138, v139
    v_cvt_pk_bf16_f32 v166, v140, v141
    v_cvt_pk_bf16_f32 v167, v142, v143
    buffer_store_dwordx4 v[164:167], v3, s[16:19], 0 offen offset:128
    v_cvt_pk_bf16_f32 v168, v144, v145
    v_cvt_pk_bf16_f32 v169, v146, v147
    v_cvt_pk_bf16_f32 v170, v148, v149
    v_cvt_pk_bf16_f32 v171, v150, v151
    buffer_store_dwordx4 v[168:171], v3, s[16:19], 0 offen offset:256
    v_lshlrev_b32 v128, 16, v160
    v_and_b32 v129, 0xffff0000, v160
    v_lshlrev_b32 v130, 16, v161
    v_and_b32 v131, 0xffff0000, v161
    v_lshlrev_b32 v132, 16, v162
    v_and_b32 v133, 0xffff0000, v162
    v_lshlrev_b32 v134, 16, v163
    v_and_b32 v135, 0xffff0000, v163
    v_lshlrev_b32 v136, 16, v164
    v_and_b32 v137, 0xffff0000, v164
    v_lshlrev_b32 v138, 16, v165
    v_and_b32 v139, 0xffff0000, v165
    v_lshlrev_b32 v140, 16, v166
    v_and_b32 v141, 0xffff0000, v166
    v_lshlrev_b32 v142, 16, v167
    v_and_b32 v143, 0xffff0000, v167
    v_lshlrev_b32 v144, 16, v168
    v_and_b32 v145, 0xffff0000, v168
    v_lshlrev_b32 v146, 16, v169
    v_and_b32 v147, 0xffff0000, v169
    v_lshlrev_b32 v148, 16, v170
    v_and_b32 v149, 0xffff0000, v170
    v_lshlrev_b32 v150, 16, v171
    v_and_b32 v151, 0xffff0000, v171
    v_add_f32 v152, v128, v129
    v_add_f32 v8, v130, v131
    v_add_f32 v152, v152, v132
    v_add_f32 v8, v8, v133
    v_add_f32 v152, v152, v134
    v_add_f32 v8, v8, v135
    v_add_f32 v152, v152, v136
    v_add_f32 v8, v8, v137
    v_add_f32 v152, v152, v138
    v_add_f32 v8, v8, v139
    v_add_f32 v152, v152, v140
    v_add_f32 v8, v8, v141
    v_add_f32 v152, v152, v142
    v_add_f32 v8, v8, v143
    v_add_f32 v152, v152, v144
    v_add_f32 v8, v8, v145
    v_add_f32 v152, v152, v146
    v_add_f32 v8, v8, v147
    v_add_f32 v152, v152, v148
    v_add_f32 v8, v8, v149
    v_add_f32 v152, v152, v150
    v_add_f32 v8, v8, v151
    v_add_f32 v152, v152, v8
    s_nop 1
    v_add_f32_dpp v152, v152, v152 row_ror:8 row_mask:0xf bank_mask:0xf
    v_mov_b32 v8, v152
    s_nop 1
    v_permlane16_swap_b32 v152, v8
    v_add_f32 v152, v152, v8
    v_mov_b32 v8, v152
    s_nop 1
    v_permlane32_swap_b32 v152, v8
    v_add_f32 v152, v152, v8
    v_mul_f32 v9, 0x3baaaaab, v152
    v_sub_f32 v8, v128, v9
    v_mul_f32 v153, v8, v8
    v_sub_f32 v11, v129, v9
    v_fmac_f32 v153, v11, v11
    v_sub_f32 v10, v130, v9
    v_fmac_f32 v153, v10, v10
    v_sub_f32 v11, v131, v9
    v_fmac_f32 v153, v11, v11
    v_sub_f32 v10, v132, v9
    v_fmac_f32 v153, v10, v10
    v_sub_f32 v11, v133, v9
    v_fmac_f32 v153, v11, v11
    v_sub_f32 v10, v134, v9
    v_fmac_f32 v153, v10, v10
    v_sub_f32 v11, v135, v9
    v_fmac_f32 v153, v11, v11
    v_sub_f32 v10, v136, v9
    v_fmac_f32 v153, v10, v10
    v_sub_f32 v11, v137, v9
    v_fmac_f32 v153, v11, v11
    v_sub_f32 v10, v138, v9
    v_fmac_f32 v153, v10, v10
    v_sub_f32 v11, v139, v9
    v_fmac_f32 v153, v11, v11
    v_sub_f32 v10, v140, v9
    v_fmac_f32 v153, v10, v10
    v_sub_f32 v11, v141, v9
    v_fmac_f32 v153, v11, v11
    v_sub_f32 v10, v142, v9
    v_fmac_f32 v153, v10, v10
    v_sub_f32 v11, v143, v9
    v_fmac_f32 v153, v11, v11
    v_sub_f32 v10, v144, v9
    v_fmac_f32 v153, v10, v10
    v_sub_f32 v11, v145, v9
    v_fmac_f32 v153, v11, v11
    v_sub_f32 v10, v146, v9
    v_fmac_f32 v153, v10, v10
    v_sub_f32 v11, v147, v9
    v_fmac_f32 v153, v11, v11
    v_sub_f32 v10, v148, v9
    v_fmac_f32 v153, v10, v10
    v_sub_f32 v11, v149, v9
    v_fmac_f32 v153, v11, v11
    v_sub_f32 v10, v150, v9
    v_fmac_f32 v153, v10, v10
    v_sub_f32 v11, v151, v9
    v_fmac_f32 v153, v11, v11
    s_nop 1
    v_add_f32_dpp v153, v153, v153 row_ror:8 row_mask:0xf bank_mask:0xf
    v_mov_b32 v8, v153
    s_nop 1
    v_permlane16_swap_b32 v153, v8
    v_add_f32 v153, v153, v8
    v_mov_b32 v8, v153
    s_nop 1
    v_permlane32_swap_b32 v153, v8
    v_add_f32 v153, v153, v8
    v_and_b32 v8, 7, v1
    s_mul_i32 s46, s20, 64
    v_lshl_add_u32 v8, v8, 3, s46
    ds_write_b64 v8, v[152:153] offset:0
    s_waitcnt lgkmcnt(0)
L_w3a_39:
    s_barrier
    s_cmp_eq_u32 s20, 3
    s_cbranch_scc1 L_w3b_40
    v_and_b32 v8, 7, v1
    v_lshlrev_b32 v8, 3, v8
    ds_read_b64 v[152:153], v8 offset:0
    ds_read_b64 v[154:155], v8 offset:64
    ds_read_b64 v[156:157], v8 offset:128
    s_waitcnt lgkmcnt(1)
    v_add_f32 v8, v152, v154
    s_waitcnt lgkmcnt(0)
    v_add_f32 v8, v8, v156
    v_mul_f32 v8, 0x3ae38e39, v8
    v_add_f32 v9, v153, v155
    v_add_f32 v9, v9, v157
    v_mul_f32 v10, 0x3baaaaab, v152
    v_sub_f32 v10, v10, v8
    v_mul_f32 v10, v10, v10
    v_fmac_f32 v9, 0x43400000, v10
    v_mul_f32 v10, 0x3baaaaab, v154
    v_sub_f32 v10, v10, v8
    v_mul_f32 v10, v10, v10
    v_fmac_f32 v9, 0x43400000, v10
    v_mul_f32 v10, 0x3baaaaab, v156
    v_sub_f32 v10, v10, v8
    v_mul_f32 v10, v10, v10
    v_fmac_f32 v9, 0x43400000, v10
    v_mul_f32 v9, 0x3ae38e39, v9
    v_cvt_pk_bf16_f32 v9, v9, v9
    v_lshlrev_b32 v9, 16, v9
    v_add_f32 v9, 0x3727c5ac, v9
    v_cvt_pk_bf16_f32 v9, v9, v9
    v_lshlrev_b32 v9, 16, v9
    v_sqrt_f32 v9, v9
    s_nop 0
    v_cvt_pk_bf16_f32 v9, v9, v9
    v_lshlrev_b32 v9, 16, v9
    v_rcp_f32 v9, v9
    v_cvt_pk_bf16_f32 v8, v8, v8
    v_lshlrev_b32 v8, 16, v8
    v_sub_f32 v128, v128, v8
    v_sub_f32 v129, v129, v8
    v_cvt_pk_bf16_f32 v10, v128, v129
    v_lshlrev_b32 v128, 16, v10
    v_and_b32 v129, 0xffff0000, v10
    v_mul_f32 v128, v128, v9
    v_mul_f32 v129, v129, v9
    v_cvt_pk_bf16_f32 v16, v128, v129
    v_sub_f32 v130, v130, v8
    v_sub_f32 v131, v131, v8
    v_cvt_pk_bf16_f32 v10, v130, v131
    v_lshlrev_b32 v130, 16, v10
    v_and_b32 v131, 0xffff0000, v10
    v_mul_f32 v130, v130, v9
    v_mul_f32 v131, v131, v9
    v_cvt_pk_bf16_f32 v17, v130, v131
    v_sub_f32 v132, v132, v8
    v_sub_f32 v133, v133, v8
    v_cvt_pk_bf16_f32 v10, v132, v133
    v_lshlrev_b32 v132, 16, v10
    v_and_b32 v133, 0xffff0000, v10
    v_mul_f32 v132, v132, v9
    v_mul_f32 v133, v133, v9
    v_cvt_pk_bf16_f32 v18, v132, v133
    v_sub_f32 v134, v134, v8
    v_sub_f32 v135, v135, v8
    v_cvt_pk_bf16_f32 v10, v134, v135
    v_lshlrev_b32 v134, 16, v10
    v_and_b32 v135, 0xffff0000, v10
    v_mul_f32 v134, v134, v9
    v_mul_f32 v135, v135, v9
    v_cvt_pk_bf16_f32 v19, v134, v135
    v_sub_f32 v136, v136, v8
    v_sub_f32 v137, v137, v8
    v_cvt_pk_bf16_f32 v10, v136, v137
    v_lshlrev_b32 v136, 16, v10
    v_and_b32 v137, 0xffff0000, v10
    v_mul_f32 v136, v136, v9
    v_mul_f32 v137, v137, v9
    v_cvt_pk_bf16_f32 v20, v136, v137
    v_sub_f32 v138, v138, v8
    v_sub_f32 v139, v139, v8
    v_cvt_pk_bf16_f32 v10, v138, v139
    v_lshlrev_b32 v138, 16, v10
    v_and_b32 v139, 0xffff0000, v10
    v_mul_f32 v138, v138, v9
    v_mul_f32 v139, v139, v9
    v_cvt_pk_bf16_f32 v21, v138, v139
    v_sub_f32 v140, v140, v8
    v_sub_f32 v141, v141, v8
    v_cvt_pk_bf16_f32 v10, v140, v141
    v_lshlrev_b32 v140, 16, v10
    v_and_b32 v141, 0xffff0000, v10
    v_mul_f32 v140, v140, v9
    v_mul_f32 v141, v141, v9
    v_cvt_pk_bf16_f32 v22, v140, v141
    v_sub_f32 v142, v142, v8
    v_sub_f32 v143, v143, v8
    v_cvt_pk_bf16_f32 v10, v142, v143
    v_lshlrev_b32 v142, 16, v10
    v_and_b32 v143, 0xffff0000, v10
    v_mul_f32 v142, v142, v9
    v_mul_f32 v143, v143, v9
    v_cvt_pk_bf16_f32 v23, v142, v143
    v_sub_f32 v144, v144, v8
    v_sub_f32 v145, v145, v8
    v_cvt_pk_bf16_f32 v10, v144, v145
    v_lshlrev_b32 v144, 16, v10
    v_and_b32 v145, 0xffff0000, v10
    v_mul_f32 v144, v144, v9
    v_mul_f32 v145, v145, v9
    v_cvt_pk_bf16_f32 v24, v144, v145
    v_sub_f32 v146, v146, v8
    v_sub_f32 v147, v147, v8
    v_cvt_pk_bf16_f32 v10, v146, v147
    v_lshlrev_b32 v146, 16, v10
    v_and_b32 v147, 0xffff0000, v10
    v_mul_f32 v146, v146, v9
    v_mul_f32 v147, v147, v9
    v_cvt_pk_bf16_f32 v25, v146, v147
    v_sub_f32 v148, v148, v8
    v_sub_f32 v149, v149, v8
    v_cvt_pk_bf16_f32 v10, v148, v149
    v_lshlrev_b32 v148, 16, v10
    v_and_b32 v149, 0xffff0000, v10
    v_mul_f32 v148, v148, v9
    v_mul_f32 v149, v149, v9
    v_cvt_pk_bf16_f32 v26, v148, v149
    v_sub_f32 v150, v150, v8
    v_sub_f32 v151, v151, v8
    v_cvt_pk_bf16_f32 v10, v150, v151
    v_lshlrev_b32 v150, 16, v10
    v_and_b32 v151, 0xffff0000, v10
    v_mul_f32 v150, v150, v9
    v_mul_f32 v151, v151, v9
    v_cvt_pk_bf16_f32 v27, v150, v151
    s_mov_b32 s46, 71303168
    buffer_store_dwordx4 v[16:19], v4, s[4:7], s46 offen offset:0
    buffer_store_dwordx4 v[20:23], v4, s[4:7], s46 offen offset:2048
    s_add_u32 s46, s46, 4096
    buffer_store_dwordx4 v[24:27], v4, s[4:7], s46 offen offset:0
L_w3b_40:
    s_waitcnt vmcnt(0) lgkmcnt(0)
red0_kernel_end:
    s_endpgm
.section .rodata,"a"
.p2align 6
.amdhsa_kernel red0_kernel
  .amdhsa_next_free_vgpr 176
  .amdhsa_next_free_sgpr 102
  .amdhsa_accum_offset 176
  .amdhsa_group_segment_fixed_size 0
  .amdhsa_kernarg_size 80
  .amdhsa_user_sgpr_count 2
  .amdhsa_user_sgpr_kernarg_segment_ptr 1
  .amdhsa_system_sgpr_workgroup_id_x 1
  .amdhsa_float_denorm_mode_32 3
.end_amdhsa_kernel
.text
.globl qkv1_kernel
.p2align 8
.type qkv1_kernel,@function
qkv1_kernel:
    s_cmp_ge_u32 s2, 256
    s_cbranch_scc1 qkv1_kernel_end
    s_load_dwordx16 s[24:39], s[0:1], 0
    s_load_dwordx4 s[40:43], s[0:1], 64
    v_lshrrev_b32 v1, 6, v0
    s_and_b32 s21, s2, 7
    v_readfirstlane_b32 s20, v1
    s_lshr_b32 s22, s2, 3
    v_and_b32 v1, 63, v0
    v_lshlrev_b32 v2, 4, v1
    v_lshlrev_b32 v3, 7, v0
    s_getpc_b64 s[16:17]
L_pc_41:
    v_min_u32 v4, qkv1_kernel_end-L_pc_41, v3
    global_load_dword v4, v4, s[16:17]
    s_waitcnt lgkmcnt(0)
    s_mov_b32 s4, s42
    s_mov_b32 s5, s43
    s_mov_b32 s6, 0x10000000
    s_mov_b32 s7, 0x20000
    s_lshr_b32 s44, s22, 4
    s_lshl_b32 s52, s21, 1
    s_add_u32 s44, s44, s52
    s_and_b32 s45, s22, 15
    s_lshl_b32 s46, s44, 3
    s_mul_i32 s47, s45, 129024
    s_lshl_b32 s50, s20, 11
    s_add_u32 s47, s47, s50
    s_add_u32 s47, s47, 0
    s_add_u32 s48, s47, 1024
    s_max_u32 s52, s46, 1
    s_sub_u32 s52, s52, 1
    s_mul_i32 s52, s52, 18432
    s_add_u32 s52, s52, 71303168
    s_cmp_eq_u32 s20, 3
    s_cselect_b32 s48, s52, s48
    s_mov_b32 s49, 7168
    s_cselect_b32 s49, 1024, s49
    s_lshl_b32 s52, s20, 1
    s_add_u32 s46, s46, s52
    s_mul_i32 s51, s46, 18432
    s_add_u32 s51, s51, 71303168
    s_mov_b32 m0, s50
    s_nop 0
    buffer_load_dwordx4 v2, s[4:7], s47 offen lds
    s_add_u32 m0, s50, 1024
    s_nop 0
    buffer_load_dwordx4 v2, s[4:7], s48 offen lds
    s_add_u32 s50, s50, 8192
    s_add_u32 s47, s47, 7168
    s_add_u32 s48, s48, s49
    s_add_u32 s52, s51, 0
    buffer_load_dwordx4 a[0:3], v2, s[4:7], s52 offen
    s_add_u32 s52, s51, 18432
    buffer_load_dwordx4 a[72:75], v2, s[4:7], s52 offen
    s_mov_b32 m0, s50
    s_nop 0
    buffer_load_dwordx4 v2, s[4:7], s47 offen lds
    s_add_u32 m0, s50, 1024
    s_nop 0
    buffer_load_dwordx4 v2, s[4:7], s48 offen lds
    s_add_u32 s50, s50, 8192
    s_add_u32 s47, s47, 7168
    s_add_u32 s48, s48, s49
    s_add_u32 s52, s51, 1024
    buffer_load_dwordx4 a[4:7], v2, s[4:7], s52 offen
    s_add_u32 s52, s51, 19456
    buffer_load_dwordx4 a[76:79], v2, s[4:7], s52 offen
    s_mov_b32 m0, s50
    s_nop 0
    buffer_load_dwordx4 v2, s[4:7], s47 offen lds
    s_add_u32 m0, s50, 1024
    s_nop 0
    buffer_load_dwordx4 v2, s[4:7], s48 offen lds
    s_add_u32 s50, s50, 8192
    s_add_u32 s47, s47, 7168
    s_add_u32 s48, s48, s49
    s_add_u32 s52, s51, 2048
    buffer_load_dwordx4 a[8:11], v2, s[4:7], s52 offen
    s_add_u32 s52, s51, 20480
    buffer_load_dwordx4 a[80:83], v2, s[4:7], s52 offen
    s_mov_b32 m0, s50
    s_nop 0
    buffer_load_dwordx4 v2, s[4:7], s47 offen lds
    s_add_u32 m0, s50, 1024
    s_nop 0
    buffer_load_dwordx4 v2, s[4:7], s48 offen lds
    s_add_u32 s50, s50, 8192
    s_add_u32 s47, s47, 7168
    s_add_u32 s48, s48, s49
    s_add_u32 s52, s51, 3072
    buffer_load_dwordx4 a[12:15], v2, s[4:7], s52 offen
    s_add_u32 s52, s51, 21504
    buffer_load_dwordx4 a[84:87], v2, s[4:7], s52 offen
    s_mov_b32 m0, s50
    s_nop 0
    buffer_load_dwordx4 v2, s[4:7], s47 offen lds
    s_add_u32 m0, s50, 1024
    s_nop 0
    buffer_load_dwordx4 v2, s[4:7], s48 offen lds
    s_add_u32 s50, s50, 8192
    s_add_u32 s47, s47, 7168
    s_add_u32 s48, s48, s49
    s_add_u32 s52, s51, 4096
    buffer_load_dwordx4 a[16:19], v2, s[4:7], s52 offen
    s_add_u32 s52, s51, 22528
    buffer_load_dwordx4 a[88:91], v2, s[4:7], s52 offen
    s_mov_b32 m0, s50
    s_nop 0
    buffer_load_dwordx4 v2, s[4:7], s47 offen lds
    s_add_u32 m0, s50, 1024
    s_nop 0
    buffer_load_dwordx4 v2, s[4:7], s48 offen lds
    s_add_u32 s50, s50, 8192
    s_add_u32 s47, s47, 7168
    s_add_u32 s48, s48, s49
    s_add_u32 s52, s51, 5120
    buffer_load_dwordx4 a[20:23], v2, s[4:7], s52 offen
    s_add_u32 s52, s51, 23552
    buffer_load_dwordx4 a[92:95], v2, s[4:7], s52 offen
    s_mov_b32 m0, s50
    s_nop 0
    buffer_load_dwordx4 v2, s[4:7], s47 offen lds
    s_add_u32 m0, s50, 1024
    s_nop 0
    buffer_load_dwordx4 v2, s[4:7], s48 offen lds
    s_add_u32 s50, s50, 8192
    s_add_u32 s47, s47, 7168
    s_add_u32 s48, s48, s49
    s_add_u32 s52, s51, 6144
    buffer_load_dwordx4 a[24:27], v2, s[4:7], s52 offen
    s_add_u32 s52, s51, 24576
    buffer_load_dwordx4 a[96:99], v2, s[4:7], s52 offen
    s_mov_b32 m0, s50
    s_nop 0
    buffer_load_dwordx4 v2, s[4:7], s47 offen lds
    s_add_u32 m0, s50, 1024
    s_nop 0
    buffer_load_dwordx4 v2, s[4:7], s48 offen lds
    s_add_u32 s50, s50, 8192
    s_add_u32 s47, s47, 7168
    s_add_u32 s48, s48, s49
    s_add_u32 s52, s51, 7168
    buffer_load_dwordx4 a[28:31], v2, s[4:7], s52 offen
    s_add_u32 s52, s51, 25600
    buffer_load_dwordx4 a[100:103], v2, s[4:7], s52 offen
    s_mov_b32 m0, s50
    s_nop 0
    buffer_load_dwordx4 v2, s[4:7], s47 offen lds
    s_add_u32 m0, s50, 1024
    s_nop 0
    buffer_load_dwordx4 v2, s[4:7], s48 offen lds
    s_add_u32 s50, s50, 8192
    s_add_u32 s47, s47, 7168
    s_add_u32 s48, s48, s49
    s_add_u32 s52, s51, 8192
    buffer_load_dwordx4 a[32:35], v2, s[4:7], s52 offen
    s_add_u32 s52, s51, 26624
    buffer_load_dwordx4 a[104:107], v2, s[4:7], s52 offen
    s_mov_b32 m0, s50
    s_nop 0
    buffer_load_dwordx4 v2, s[4:7], s47 offen lds
    s_add_u32 m0, s50, 1024
    s_nop 0
    buffer_load_dwordx4 v2, s[4:7], s48 offen lds
    s_add_u32 s50, s50, 8192
    s_add_u32 s47, s47, 7168
    s_add_u32 s48, s48, s49
    s_add_u32 s52, s51, 9216
    buffer_load_dwordx4 a[36:39], v2, s[4:7], s52 offen
    s_add_u32 s52, s51, 27648
    buffer_load_dwordx4 a[108:111], v2, s[4:7], s52 offen
    s_mov_b32 m0, s50
    s_nop 0
    buffer_load_dwordx4 v2, s[4:7], s47 offen lds
    s_add_u32 m0, s50, 1024
    s_nop 0
    buffer_load_dwordx4 v2, s[4:7], s48 offen lds
    s_add_u32 s50, s50, 8192
    s_add_u32 s47, s47, 7168
    s_add_u32 s48, s48, s49
    s_add_u32 s52, s51, 10240
    buffer_load_dwordx4 a[40:43], v2, s[4:7], s52 offen
    s_add_u32 s52, s51, 28672
    buffer_load_dwordx4 a[112:115], v2, s[4:7], s52 offen
    s_mov_b32 m0, s50
    s_nop 0
    buffer_load_dwordx4 v2, s[4:7], s47 offen lds
    s_add_u32 m0, s50, 1024
    s_nop 0
    buffer_load_dwordx4 v2, s[4:7], s48 offen lds
    s_add_u32 s50, s50, 8192
    s_add_u32 s47, s47, 7168
    s_add_u32 s48, s48, s49
    s_add_u32 s52, s51, 11264
    buffer_load_dwordx4 a[44:47], v2, s[4:7], s52 offen
    s_add_u32 s52, s51, 29696
    buffer_load_dwordx4 a[116:119], v2, s[4:7], s52 offen
    s_min_u32 s52, s20, 2
    s_add_u32 s53, s52, 2
    s_add_u32 s54, s52, 4
    s_cmp_ge_u32 s20, 2
    s_cselect_b32 s53, 6, s53
    s_lshl_b32 s53, s53, 10
    s_lshl_b32 s54, s54, 10
    v_mov_b32 v3, v2
    s_waitcnt vmcnt(48)
    v_add_u32 v4, s53, v2
    v_add_u32 v5, s54, v2
    v_and_b32 v6, 15, v1
    v_lshrrev_b32 v7, 4, v1
    v_lshlrev_b32 v7, 2, v7
    v_sub_u32 v6, v6, v7
    v_mov_b32 v8, 0xf149f2ca
    s_or_b32 s52, s44, s20
    s_cmp_eq_u32 s52, 0
    s_cselect_b64 s[56:57], -1, 0
    v_subrev_u32 v7, 0, v6
    v_and_b32 v9, 0xfffffff1, v7
    v_cmp_eq_u32 vcc, 0, v9
    v_add_u32 v7, 16, v7
    v_and_b32 v9, 0xfffffff1, v7
    v_cndmask_b32_e64 v168, v8, 0, vcc
    v_cmp_eq_u32 vcc, 0, v9
    s_nop 1
    v_cndmask_b32_e64 v172, v8, 0, vcc
    v_cndmask_b32_e64 v176, v172, v8, s[56:57]
    v_subrev_u32 v7, 1, v6
    v_and_b32 v9, 0xfffffff1, v7
    v_cmp_eq_u32 vcc, 0, v9
    v_add_u32 v7, 16, v7
    v_and_b32 v9, 0xfffffff1, v7
    v_cndmask_b32_e64 v169, v8, 0, vcc
    v_cmp_eq_u32 vcc, 0, v9
    s_nop 1
    v_cndmask_b32_e64 v173, v8, 0, vcc
    v_cndmask_b32_e64 v177, v173, v8, s[56:57]
    v_subrev_u32 v7, 2, v6
    v_and_b32 v9, 0xfffffff1, v7
    v_cmp_eq_u32 vcc, 0, v9
    v_add_u32 v7, 16, v7
    v_and_b32 v9, 0xfffffff1, v7
    v_cndmask_b32_e64 v170, v8, 0, vcc
    v_cmp_eq_u32 vcc, 0, v9
    s_nop 1
    v_cndmask_b32_e64 v174, v8, 0, vcc
    v_cndmask_b32_e64 v178, v174, v8, s[56:57]
    v_subrev_u32 v7, 3, v6
    v_and_b32 v9, 0xfffffff1, v7
    v_cmp_eq_u32 vcc, 0, v9
    v_add_u32 v7, 16, v7
    v_and_b32 v9, 0xfffffff1, v7
    v_cndmask_b32_e64 v171, v8, 0, vcc
    v_cmp_eq_u32 vcc, 0, v9
    s_nop 1
    v_cndmask_b32_e64 v175, v8, 0, vcc
    v_cndmask_b32_e64 v179, v175, v8, s[56:57]
    s_waitcnt vmcnt(38)
    s_barrier
    ds_read_b128 v[88:91], v3 offset:0
    ds_read_b128 v[92:95], v3 offset:1024
    ds_read_b128 v[96:99], v3 offset:2048
    ds_read_b128 v[100:103], v3 offset:3072
    ds_read_b128 v[112:115], v3 offset:6144
    ds_read_b128 v[104:107], v3 offset:4096
    ds_read_b128 v[108:111], v3 offset:5120
    ds_read_b128 v[144:147], v3 offset:7168
    ds_read_b128 v[148:151], v4 offset:0
    ds_read_b128 v[152:155], v5 offset:0
    s_mov_b32 m0, s50
    s_nop 0
    buffer_load_dwordx4 v2, s[4:7], s47 offen lds
    s_waitcnt lgkmcnt(9)
    v_mfma_f32_16x16x32_bf16 v[16:19], v[88:91], a[0:3], 0
    s_add_u32 m0, s50, 1024
    ds_read_b128 v[116:119], v3 offset:8192
    v_mfma_f32_16x16x32_bf16 v[48:51], v[88:91], a[72:75], 0
    ds_read_b128 v[120:123], v3 offset:9216
    s_waitcnt lgkmcnt(10)
    v_mfma_f32_16x16x32_bf16 v[20:23], v[92:95], a[0:3], 0
    ds_read_b128 v[124:127], v3 offset:10240
    v_mfma_f32_16x16x32_bf16 v[52:55], v[92:95], a[72:75], 0
    buffer_load_dwordx4 v2, s[4:7], s48 offen lds
    s_add_u32 s50, s50, 8192
    s_waitcnt lgkmcnt(10)
    v_mfma_f32_16x16x32_bf16 v[24:27], v[96:99], a[0:3], 0
    s_add_u32 s47, s47, 7168
    s_add_u32 s48, s48, s49
    v_mfma_f32_16x16x32_bf16 v[56:59], v[96:99], a[72:75], 0
    s_add_u32 s52, s51, 12288
    ds_read_b128 v[128:131], v3 offset:11264
    s_waitcnt lgkmcnt(10)
    v_mfma_f32_16x16x32_bf16 v[28:31], v[100:103], a[0:3], 0
    ds_read_b128 v[140:143], v3 offset:14336
    ds_read_b128 v[132:135], v3 offset:12288
    v_mfma_f32_16x16x32_bf16 v[60:63], v[100:103], a[72:75], 0
    buffer_load_dwordx4 a[48:51], v2, s[4:7], s52 offen
    s_add_u32 s52, s51, 30720
    s_waitcnt lgkmcnt(11)
    v_mfma_f32_16x16x32_bf16 v[32:35], v[112:115], a[0:3], 0
    ds_read_b128 v[136:139], v3 offset:13312
    ds_read_b128 v[156:159], v3 offset:15360
    v_mfma_f32_16x16x32_bf16 v[64:67], v[112:115], a[72:75], 0
    ds_read_b128 v[160:163], v4 offset:8192
    ds_read_b128 v[164:167], v5 offset:8192
    v_mfma_f32_16x16x32_bf16 v[44:47], a[0:3], v[112:115], 0
    v_mfma_f32_16x16x32_bf16 v[76:79], a[72:75], v[112:115], 0
    buffer_load_dwordx4 a[120:123], v2, s[4:7], s52 offen
    s_waitcnt lgkmcnt(14)
    v_mfma_f32_16x16x32_bf16 v[36:39], a[0:3], v[104:107], 0
    v_mfma_f32_16x16x32_bf16 v[68:71], a[72:75], v[104:107], 0
    s_waitcnt lgkmcnt(13)
    v_mfma_f32_16x16x32_bf16 v[40:43], a[0:3], v[108:111], 0
    v_mfma_f32_16x16x32_bf16 v[72:75], a[72:75], v[108:111], 0
    s_waitcnt lgkmcnt(11)
    v_mfma_f32_16x16x32_bf16 v[80:83], v[148:151], v[144:147], 0
    s_waitcnt lgkmcnt(10)
    v_mfma_f32_16x16x32_bf16 v[84:87], v[144:147], v[152:155], 0
    s_mov_b32 m0, s50
    s_nop 0
    buffer_load_dwordx4 v2, s[4:7], s47 offen lds
    s_waitcnt lgkmcnt(9)
    v_mfma_f32_16x16x32_bf16 v[16:19], v[116:119], a[4:7], v[16:19]
    s_add_u32 m0, s50, 1024
    ds_read_b128 v[88:91], v3 offset:16384
    v_mfma_f32_16x16x32_bf16 v[48:51], v[116:119], a[76:79], v[48:51]
    ds_read_b128 v[92:95], v3 offset:17408
    s_waitcnt lgkmcnt(10)
    v_mfma_f32_16x16x32_bf16 v[20:23], v[120:123], a[4:7], v[20:23]
    ds_read_b128 v[96:99], v3 offset:18432
    v_mfma_f32_16x16x32_bf16 v[52:55], v[120:123], a[76:79], v[52:55]
    buffer_load_dwordx4 v2, s[4:7], s48 offen lds
    s_add_u32 s50, s50, 8192
    s_waitcnt lgkmcnt(10)
    v_mfma_f32_16x16x32_bf16 v[24:27], v[124:127], a[4:7], v[24:27]
    s_add_u32 s47, s47, 7168
    s_add_u32 s48, s48, s49
    v_mfma_f32_16x16x32_bf16 v[56:59], v[124:127], a[76:79], v[56:59]
    s_add_u32 s52, s51, 13312
    ds_read_b128 v[100:103], v3 offset:19456
    s_waitcnt lgkmcnt(10)
    v_mfma_f32_16x16x32_bf16 v[28:31], v[128:131], a[4:7], v[28:31]
    ds_read_b128 v[112:115], v3 offset:22528
    ds_read_b128 v[104:107], v3 offset:20480
    v_mfma_f32_16x16x32_bf16 v[60:63], v[128:131], a[76:79], v[60:63]
    buffer_load_dwordx4 a[52:55], v2, s[4:7], s52 offen
    s_add_u32 s52, s51, 31744
    s_waitcnt lgkmcnt(11)
    v_mfma_f32_16x16x32_bf16 v[32:35], v[140:143], a[4:7], v[32:35]
    ds_read_b128 v[108:111], v3 offset:21504
    ds_read_b128 v[144:147], v3 offset:23552
    v_mfma_f32_16x16x32_bf16 v[64:67], v[140:143], a[76:79], v[64:67]
    ds_read_b128 v[148:151], v4 offset:16384
    ds_read_b128 v[152:155], v5 offset:16384
    v_mfma_f32_16x16x32_bf16 v[44:47], a[4:7], v[140:143], v[44:47]
    v_mfma_f32_16x16x32_bf16 v[76:79], a[76:79], v[140:143], v[76:79]
    buffer_load_dwordx4 a[124:127], v2, s[4:7], s52 offen
    s_waitcnt lgkmcnt(14)
    v_mfma_f32_16x16x32_bf16 v[36:39], a[4:7], v[132:135], v[36:39]
    v_mfma_f32_16x16x32_bf16 v[68:71], a[76:79], v[132:135], v[68:71]
    s_waitcnt lgkmcnt(13)
    v_mfma_f32_16x16x32_bf16 v[40:43], a[4:7], v[136:139], v[40:43]
    v_mfma_f32_16x16x32_bf16 v[72:75], a[76:79], v[136:139], v[72:75]
    s_waitcnt lgkmcnt(11)
    v_mfma_f32_16x16x32_bf16 v[80:83], v[160:163], v[156:159], v[80:83]
    s_waitcnt lgkmcnt(10)
    v_mfma_f32_16x16x32_bf16 v[84:87], v[156:159], v[164:167], v[84:87]
    s_mov_b32 m0, s50
    s_nop 0
    buffer_load_dwordx4 v2, s[4:7], s47 offen lds
    s_waitcnt vmcnt(46) lgkmcnt(9)
    v_mfma_f32_16x16x32_bf16 v[16:19], v[88:91], a[8:11], v[16:19]
    s_waitcnt vmcnt(35)
    s_barrier
    v_mfma_f32_16x16x32_bf16 v[48:51], v[88:91], a[80:83], v[48:51]
    s_add_u32 m0, s50, 1024
    ds_read_b128 v[116:119], v3 offset:24576
    s_waitcnt lgkmcnt(9)
    v_mfma_f32_16x16x32_bf16 v[20:23], v[92:95], a[8:11], v[20:23]
    ds_read_b128 v[120:123], v3 offset:25600
    ds_read_b128 v[124:127], v3 offset:26624
    v_mfma_f32_16x16x32_bf16 v[52:55], v[92:95], a[80:83], v[52:55]
    buffer_load_dwordx4 v2, s[4:7], s48 offen lds
    s_add_u32 s50, s50, 8192
    s_waitcnt lgkmcnt(10)
    v_mfma_f32_16x16x32_bf16 v[24:27], v[96:99], a[8:11], v[24:27]
    s_add_u32 s47, s47, 7168
    s_add_u32 s48, s48, s49
    v_mfma_f32_16x16x32_bf16 v[56:59], v[96:99], a[80:83], v[56:59]
    s_add_u32 s52, s51, 14336
    ds_read_b128 v[128:131], v3 offset:27648
    s_waitcnt lgkmcnt(10)
    v_mfma_f32_16x16x32_bf16 v[28:31], v[100:103], a[8:11], v[28:31]
    ds_read_b128 v[140:143], v3 offset:30720
    ds_read_b128 v[132:135], v3 offset:28672
    v_mfma_f32_16x16x32_bf16 v[60:63], v[100:103], a[80:83], v[60:63]
    buffer_load_dwordx4 a[56:59], v2, s[4:7], s52 offen
    s_add_u32 s52, s51, 32768
    s_waitcnt lgkmcnt(11)
    v_mfma_f32_16x16x32_bf16 v[32:35], v[112:115], a[8:11], v[32:35]
    ds_read_b128 v[136:139], v3 offset:29696
    ds_read_b128 v[156:159], v3 offset:31744
    v_mfma_f32_16x16x32_bf16 v[64:67], v[112:115], a[80:83], v[64:67]
    ds_read_b128 v[160:163], v4 offset:24576
    ds_read_b128 v[164:167], v5 offset:24576
    v_mfma_f32_16x16x32_bf16 v[44:47], a[8:11], v[112:115], v[44:47]
    v_mfma_f32_16x16x32_bf16 v[76:79], a[80:83], v[112:115], v[76:79]
    buffer_load_dwordx4 a[128:131], v2, s[4:7], s52 offen
    s_waitcnt lgkmcnt(14)
    v_mfma_f32_16x16x32_bf16 v[36:39], a[8:11], v[104:107], v[36:39]
    v_mfma_f32_16x16x32_bf16 v[68:71], a[80:83], v[104:107], v[68:71]
    s_waitcnt lgkmcnt(13)
    v_mfma_f32_16x16x32_bf16 v[40:43], a[8:11], v[108:111], v[40:43]
    v_mfma_f32_16x16x32_bf16 v[72:75], a[80:83], v[108:111], v[72:75]
    s_waitcnt lgkmcnt(11)
    v_mfma_f32_16x16x32_bf16 v[80:83], v[148:151], v[144:147], v[80:83]
    s_waitcnt lgkmcnt(10)
    v_mfma_f32_16x16x32_bf16 v[84:87], v[144:147], v[152:155], v[84:87]
    s_mov_b32 m0, s50
    s_nop 0
    buffer_load_dwordx4 v2, s[4:7], s47 offen lds
    s_waitcnt lgkmcnt(9)
    v_mfma_f32_16x16x32_bf16 v[16:19], v[116:119], a[12:15], v[16:19]
    s_add_u32 m0, s50, 1024
    ds_read_b128 v[88:91], v3 offset:32768
    v_mfma_f32_16x16x32_bf16 v[48:51], v[116:119], a[84:87], v[48:51]
    ds_read_b128 v[92:95], v3 offset:33792
    s_waitcnt lgkmcnt(10)
    v_mfma_f32_16x16x32_bf16 v[20:23], v[120:123], a[12:15], v[20:23]
    ds_read_b128 v[96:99], v3 offset:34816
    v_mfma_f32_16x16x32_bf16 v[52:55], v[120:123], a[84:87], v[52:55]
    buffer_load_dwordx4 v2, s[4:7], s48 offen lds
    s_add_u32 s50, s50, 8192
    s_waitcnt lgkmcnt(10)
    v_mfma_f32_16x16x32_bf16 v[24:27], v[124:127], a[12:15], v[24:27]
    s_add_u32 s47, s47, 7168
    s_add_u32 s48, s48, s49
    v_mfma_f32_16x16x32_bf16 v[56:59], v[124:127], a[84:87], v[56:59]
    s_add_u32 s52, s51, 15360
    ds_read_b128 v[100:103], v3 offset:35840
    s_waitcnt lgkmcnt(10)
    v_mfma_f32_16x16x32_bf16 v[28:31], v[128:131], a[12:15], v[28:31]
    ds_read_b128 v[112:115], v3 offset:38912
    ds_read_b128 v[104:107], v3 offset:36864
    v_mfma_f32_16x16x32_bf16 v[60:63], v[128:131], a[84:87], v[60:63]
    buffer_load_dwordx4 a[60:63], v2, s[4:7], s52 offen
    s_add_u32 s52, s51, 33792
    s_waitcnt lgkmcnt(11)
    v_mfma_f32_16x16x32_bf16 v[32:35], v[140:143], a[12:15], v[32:35]
    ds_read_b128 v[108:111], v3 offset:37888
    ds_read_b128 v[144:147], v3 offset:39936
    v_mfma_f32_16x16x32_bf16 v[64:67], v[140:143], a[84:87], v[64:67]
    ds_read_b128 v[148:151], v4 offset:32768
    ds_read_b128 v[152:155], v5 offset:32768
    v_mfma_f32_16x16x32_bf16 v[44:47], a[12:15], v[140:143], v[44:47]
    v_mfma_f32_16x16x32_bf16 v[76:79], a[84:87], v[140:143], v[76:79]
    buffer_load_dwordx4 a[132:135], v2, s[4:7], s52 offen
    s_waitcnt lgkmcnt(14)
    v_mfma_f32_16x16x32_bf16 v[36:39], a[12:15], v[132:135], v[36:39]
    v_mfma_f32_16x16x32_bf16 v[68:71], a[84:87], v[132:135], v[68:71]
    s_waitcnt lgkmcnt(13)
    v_mfma_f32_16x16x32_bf16 v[40:43], a[12:15], v[136:139], v[40:43]
    v_mfma_f32_16x16x32_bf16 v[72:75], a[84:87], v[136:139], v[72:75]
    s_waitcnt lgkmcnt(11)
    v_mfma_f32_16x16x32_bf16 v[80:83], v[160:163], v[156:159], v[80:83]
    s_waitcnt lgkmcnt(10)
    v_mfma_f32_16x16x32_bf16 v[84:87], v[156:159], v[164:167], v[84:87]
    s_mov_b32 m0, s50
    s_nop 0
    buffer_load_dwordx4 v2, s[4:7], s47 offen lds
    s_waitcnt lgkmcnt(9)
    v_mfma_f32_16x16x32_bf16 v[16:19], v[88:91], a[16:19], v[16:19]
    s_add_u32 m0, s50, 1024
    ds_read_b128 v[116:119], v3 offset:40960
    v_mfma_f32_16x16x32_bf16 v[48:51], v[88:91], a[88:91], v[48:51]
    ds_read_b128 v[120:123], v3 offset:41984
    s_waitcnt lgkmcnt(10)
    v_mfma_f32_16x16x32_bf16 v[20:23], v[92:95], a[16:19], v[20:23]
    ds_read_b128 v[124:127], v3 offset:43008
    v_mfma_f32_16x16x32_bf16 v[52:55], v[92:95], a[88:91], v[52:55]
    buffer_load_dwordx4 v2, s[4:7], s48 offen lds
    s_add_u32 s50, s50, 8192
    s_waitcnt lgkmcnt(10)
    v_mfma_f32_16x16x32_bf16 v[24:27], v[96:99], a[16:19], v[24:27]
    s_add_u32 s47, s47, 7168
    s_add_u32 s48, s48, s49
    v_mfma_f32_16x16x32_bf16 v[56:59], v[96:99], a[88:91], v[56:59]
    s_add_u32 s52, s51, 16384
    ds_read_b128 v[128:131], v3 offset:44032
    s_waitcnt lgkmcnt(10)
    v_mfma_f32_16x16x32_bf16 v[28:31], v[100:103], a[16:19], v[28:31]
    ds_read_b128 v[140:143], v3 offset:47104
    ds_read_b128 v[132:135], v3 offset:45056
    v_mfma_f32_16x16x32_bf16 v[60:63], v[100:103], a[88:91], v[60:63]
    buffer_load_dwordx4 a[64:67], v2, s[4:7], s52 offen
    s_add_u32 s52, s51, 34816
    s_waitcnt lgkmcnt(11)
    v_mfma_f32_16x16x32_bf16 v[32:35], v[112:115], a[16:19], v[32:35]
    ds_read_b128 v[136:139], v3 offset:46080
    ds_read_b128 v[156:159], v3 offset:48128
    v_mfma_f32_16x16x32_bf16 v[64:67], v[112:115], a[88:91], v[64:67]
    ds_read_b128 v[160:163], v4 offset:40960
    ds_read_b128 v[164:167], v5 offset:40960
    v_mfma_f32_16x16x32_bf16 v[44:47], a[16:19], v[112:115], v[44:47]
    v_mfma_f32_16x16x32_bf16 v[76:79], a[88:91], v[112:115], v[76:79]
    buffer_load_dwordx4 a[136:139], v2, s[4:7], s52 offen
    s_waitcnt lgkmcnt(14)
    v_mfma_f32_16x16x32_bf16 v[36:39], a[16:19], v[104:107], v[36:39]
    v_mfma_f32_16x16x32_bf16 v[68:71], a[88:91], v[104:107], v[68:71]
    s_waitcnt lgkmcnt(13)
    v_mfma_f32_16x16x32_bf16 v[40:43], a[16:19], v[108:111], v[40:43]
    v_mfma_f32_16x16x32_bf16 v[72:75], a[88:91], v[108:111], v[72:75]
    s_waitcnt lgkmcnt(11)
    v_mfma_f32_16x16x32_bf16 v[80:83], v[148:151], v[144:147], v[80:83]
    s_waitcnt lgkmcnt(10)
    v_mfma_f32_16x16x32_bf16 v[84:87], v[144:147], v[152:155], v[84:87]
    s_mov_b32 m0, s50
    s_nop 0
    buffer_load_dwordx4 v2, s[4:7], s47 offen lds
    s_waitcnt vmcnt(46) lgkmcnt(9)
    v_mfma_f32_16x16x32_bf16 v[16:19], v[116:119], a[20:23], v[16:19]
    s_waitcnt vmcnt(35)
    s_barrier
    v_mfma_f32_16x16x32_bf16 v[48:51], v[116:119], a[92:95], v[48:51]
    s_add_u32 m0, s50, 1024
    ds_read_b128 v[88:91], v3 offset:49152
    s_waitcnt lgkmcnt(9)
    v_mfma_f32_16x16x32_bf16 v[20:23], v[120:123], a[20:23], v[20:23]
    ds_read_b128 v[92:95], v3 offset:50176
    ds_read_b128 v[96:99], v3 offset:51200
    v_mfma_f32_16x16x32_bf16 v[52:55], v[120:123], a[92:95], v[52:55]
    buffer_load_dwordx4 v2, s[4:7], s48 offen lds
    s_add_u32 s50, s50, 8192
    s_waitcnt lgkmcnt(10)
    v_mfma_f32_16x16x32_bf16 v[24:27], v[124:127], a[20:23], v[24:27]
    s_add_u32 s47, s47, 7168
    s_add_u32 s48, s48, s49
    v_mfma_f32_16x16x32_bf16 v[56:59], v[124:127], a[92:95], v[56:59]
    s_add_u32 s52, s51, 17408
    ds_read_b128 v[100:103], v3 offset:52224
    s_waitcnt lgkmcnt(10)
    v_mfma_f32_16x16x32_bf16 v[28:31], v[128:131], a[20:23], v[28:31]
    ds_read_b128 v[112:115], v3 offset:55296
    ds_read_b128 v[104:107], v3 offset:53248
    v_mfma_f32_16x16x32_bf16 v[60:63], v[128:131], a[92:95], v[60:63]
    buffer_load_dwordx4 a[68:71], v2, s[4:7], s52 offen
    s_add_u32 s52, s51, 35840
    s_waitcnt lgkmcnt(11)
    v_mfma_f32_16x16x32_bf16 v[32:35], v[140:143], a[20:23], v[32:35]
    ds_read_b128 v[108:111], v3 offset:54272
    ds_read_b128 v[144:147], v3 offset:56320
    v_mfma_f32_16x16x32_bf16 v[64:67], v[140:143], a[92:95], v[64:67]
    ds_read_b128 v[148:151], v4 offset:49152
    ds_read_b128 v[152:155], v5 offset:49152
    v_mfma_f32_16x16x32_bf16 v[44:47], a[20:23], v[140:143], v[44:47]
    v_mfma_f32_16x16x32_bf16 v[76:79], a[92:95], v[140:143], v[76:79]
    buffer_load_dwordx4 a[140:143], v2, s[4:7], s52 offen
    s_waitcnt lgkmcnt(14)
    v_mfma_f32_16x16x32_bf16 v[36:39], a[20:23], v[132:135], v[36:39]
    v_mfma_f32_16x16x32_bf16 v[68:71], a[92:95], v[132:135], v[68:71]
    s_waitcnt lgkmcnt(13)
    v_mfma_f32_16x16x32_bf16 v[40:43], a[20:23], v[136:139], v[40:43]
    v_mfma_f32_16x16x32_bf16 v[72:75], a[92:95], v[136:139], v[72:75]
    s_waitcnt lgkmcnt(11)
    v_mfma_f32_16x16x32_bf16 v[80:83], v[160:163], v[156:159], v[80:83]
    s_waitcnt lgkmcnt(10)
    v_mfma_f32_16x16x32_bf16 v[84:87], v[156:159], v[164:167], v[84:87]
    s_waitcnt lgkmcnt(9)
    v_mfma_f32_16x16x32_bf16 v[16:19], v[88:91], a[24:27], v[16:19]
    ds_read_b128 v[116:119], v3 offset:57344
    v_mfma_f32_16x16x32_bf16 v[48:51], v[88:91], a[96:99], v[48:51]
    ds_read_b128 v[120:123], v3 offset:58368
    s_waitcnt lgkmcnt(10)
    v_mfma_f32_16x16x32_bf16 v[20:23], v[92:95], a[24:27], v[20:23]
    ds_read_b128 v[124:127], v3 offset:59392
    v_mfma_f32_16x16x32_bf16 v[52:55], v[92:95], a[96:99], v[52:55]
    ds_read_b128 v[128:131], v3 offset:60416
    s_waitcnt lgkmcnt(11)
    v_mfma_f32_16x16x32_bf16 v[24:27], v[96:99], a[24:27], v[24:27]
    ds_read_b128 v[140:143], v3 offset:63488
    v_mfma_f32_16x16x32_bf16 v[56:59], v[96:99], a[96:99], v[56:59]
    ds_read_b128 v[132:135], v3 offset:61440
    s_waitcnt lgkmcnt(12)
    v_mfma_f32_16x16x32_bf16 v[28:31], v[100:103], a[24:27], v[28:31]
    ds_read_b128 v[136:139], v3 offset:62464
    v_mfma_f32_16x16x32_bf16 v[60:63], v[100:103], a[96:99], v[60:63]
    ds_read_b128 v[156:159], v3 offset:64512
    s_waitcnt lgkmcnt(13)
    v_mfma_f32_16x16x32_bf16 v[32:35], v[112:115], a[24:27], v[32:35]
    ds_read_b128 v[160:163], v4 offset:57344
    v_mfma_f32_16x16x32_bf16 v[64:67], v[112:115], a[96:99], v[64:67]
    ds_read_b128 v[164:167], v5 offset:57344
    v_mfma_f32_16x16x32_bf16 v[44:47], a[24:27], v[112:115], v[44:47]
    v_mfma_f32_16x16x32_bf16 v[76:79], a[96:99], v[112:115], v[76:79]
    s_waitcnt lgkmcnt(14)
    v_mfma_f32_16x16x32_bf16 v[36:39], a[24:27], v[104:107], v[36:39]
    v_mfma_f32_16x16x32_bf16 v[68:71], a[96:99], v[104:107], v[68:71]
    s_waitcnt lgkmcnt(13)
    v_mfma_f32_16x16x32_bf16 v[40:43], a[24:27], v[108:111], v[40:43]
    v_mfma_f32_16x16x32_bf16 v[72:75], a[96:99], v[108:111], v[72:75]
    s_waitcnt lgkmcnt(11)
    v_mfma_f32_16x16x32_bf16 v[80:83], v[148:151], v[144:147], v[80:83]
    s_waitcnt lgkmcnt(10)
    v_mfma_f32_16x16x32_bf16 v[84:87], v[144:147], v[152:155], v[84:87]
    s_waitcnt lgkmcnt(9)
    v_mfma_f32_16x16x32_bf16 v[16:19], v[116:119], a[28:31], v[16:19]
    v_add_u32 v3, 0x10000, v3
    v_mfma_f32_16x16x32_bf16 v[48:51], v[116:119], a[100:103], v[48:51]
    v_add_u32 v4, 0x10000, v4
    s_waitcnt lgkmcnt(8)
    v_mfma_f32_16x16x32_bf16 v[20:23], v[120:123], a[28:31], v[20:23]
    v_add_u32 v5, 0x10000, v5
    v_mfma_f32_16x16x32_bf16 v[52:55], v[120:123], a[100:103], v[52:55]
    ds_read_b128 v[88:91], v3 offset:0
    s_waitcnt lgkmcnt(8)
    v_mfma_f32_16x16x32_bf16 v[24:27], v[124:127], a[28:31], v[24:27]
    ds_read_b128 v[92:95], v3 offset:1024
    v_mfma_f32_16x16x32_bf16 v[56:59], v[124:127], a[100:103], v[56:59]
    ds_read_b128 v[96:99], v3 offset:2048
    s_waitcnt lgkmcnt(9)
    v_mfma_f32_16x16x32_bf16 v[28:31], v[128:131], a[28:31], v[28:31]
    ds_read_b128 v[100:103], v3 offset:3072
    v_mfma_f32_16x16x32_bf16 v[60:63], v[128:131], a[100:103], v[60:63]
    ds_read_b128 v[112:115], v3 offset:6144
    s_waitcnt lgkmcnt(10)
    v_mfma_f32_16x16x32_bf16 v[32:35], v[140:143], a[28:31], v[32:35]
    ds_read_b128 v[104:107], v3 offset:4096
    v_mfma_f32_16x16x32_bf16 v[64:67], v[140:143], a[100:103], v[64:67]
    ds_read_b128 v[108:111], v3 offset:5120
    v_mfma_f32_16x16x32_bf16 v[44:47], a[28:31], v[140:143], v[44:47]
    ds_read_b128 v[144:147], v3 offset:7168
    v_mfma_f32_16x16x32_bf16 v[76:79], a[100:103], v[140:143], v[76:79]
    ds_read_b128 v[148:151], v4 offset:0
    s_waitcnt lgkmcnt(13)
    v_mfma_f32_16x16x32_bf16 v[36:39], a[28:31], v[132:135], v[36:39]
    ds_read_b128 v[152:155], v5 offset:0
    v_mfma_f32_16x16x32_bf16 v[68:71], a[100:103], v[132:135], v[68:71]
    s_waitcnt lgkmcnt(13)
    v_mfma_f32_16x16x32_bf16 v[40:43], a[28:31], v[136:139], v[40:43]
    v_mfma_f32_16x16x32_bf16 v[72:75], a[100:103], v[136:139], v[72:75]
    s_waitcnt lgkmcnt(11)
    v_mfma_f32_16x16x32_bf16 v[80:83], v[160:163], v[156:159], v[80:83]
    s_waitcnt lgkmcnt(10)
    v_mfma_f32_16x16x32_bf16 v[84:87], v[156:159], v[164:167], v[84:87]
    s_waitcnt vmcnt(37) lgkmcnt(9)
    v_mfma_f32_16x16x32_bf16 v[16:19], v[88:91], a[32:35], v[16:19]
    s_waitcnt vmcnt(26)
    s_barrier
    v_mfma_f32_16x16x32_bf16 v[48:51], v[88:91], a[104:107], v[48:51]
    ds_read_b128 v[116:119], v3 offset:8192
    ds_read_b128 v[120:123], v3 offset:9216
    s_waitcnt lgkmcnt(10)
    v_mfma_f32_16x16x32_bf16 v[20:23], v[92:95], a[32:35], v[20:23]
    ds_read_b128 v[124:127], v3 offset:10240
    v_mfma_f32_16x16x32_bf16 v[52:55], v[92:95], a[104:107], v[52:55]
    ds_read_b128 v[128:131], v3 offset:11264
    s_waitcnt lgkmcnt(11)
    v_mfma_f32_16x16x32_bf16 v[24:27], v[96:99], a[32:35], v[24:27]
    ds_read_b128 v[140:143], v3 offset:14336
    v_mfma_f32_16x16x32_bf16 v[56:59], v[96:99], a[104:107], v[56:59]
    ds_read_b128 v[132:135], v3 offset:12288
    s_waitcnt lgkmcnt(12)
    v_mfma_f32_16x16x32_bf16 v[28:31], v[100:103], a[32:35], v[28:31]
    ds_read_b128 v[136:139], v3 offset:13312
    v_mfma_f32_16x16x32_bf16 v[60:63], v[100:103], a[104:107], v[60:63]
    ds_read_b128 v[156:159], v3 offset:15360
    s_waitcnt lgkmcnt(13)
    v_mfma_f32_16x16x32_bf16 v[32:35], v[112:115], a[32:35], v[32:35]
    ds_read_b128 v[160:163], v4 offset:8192
    v_mfma_f32_16x16x32_bf16 v[64:67], v[112:115], a[104:107], v[64:67]
    ds_read_b128 v[164:167], v5 offset:8192
    v_mfma_f32_16x16x32_bf16 v[44:47], a[32:35], v[112:115], v[44:47]
    v_mfma_f32_16x16x32_bf16 v[76:79], a[104:107], v[112:115], v[76:79]
    s_waitcnt lgkmcnt(14)
    v_mfma_f32_16x16x32_bf16 v[36:39], a[32:35], v[104:107], v[36:39]
    v_mfma_f32_16x16x32_bf16 v[68:71], a[104:107], v[104:107], v[68:71]
    s_waitcnt lgkmcnt(13)
    v_mfma_f32_16x16x32_bf16 v[40:43], a[32:35], v[108:111], v[40:43]
    v_mfma_f32_16x16x32_bf16 v[72:75], a[104:107], v[108:111], v[72:75]
    s_waitcnt lgkmcnt(11)
    v_mfma_f32_16x16x32_bf16 v[80:83], v[148:151], v[144:147], v[80:83]
    s_waitcnt lgkmcnt(10)
    v_mfma_f32_16x16x32_bf16 v[84:87], v[144:147], v[152:155], v[84:87]
    s_waitcnt lgkmcnt(9)
    v_mfma_f32_16x16x32_bf16 v[16:19], v[116:119], a[36:39], v[16:19]
    ds_read_b128 v[88:91], v3 offset:16384
    v_mfma_f32_16x16x32_bf16 v[48:51], v[116:119], a[108:111], v[48:51]
    ds_read_b128 v[92:95], v3 offset:17408
    s_waitcnt lgkmcnt(10)
    v_mfma_f32_16x16x32_bf16 v[20:23], v[120:123], a[36:39], v[20:23]
    ds_read_b128 v[96:99], v3 offset:18432
    v_mfma_f32_16x16x32_bf16 v[52:55], v[120:123], a[108:111], v[52:55]
    ds_read_b128 v[100:103], v3 offset:19456
    s_waitcnt lgkmcnt(11)
    v_mfma_f32_16x16x32_bf16 v[24:27], v[124:127], a[36:39], v[24:27]
    ds_read_b128 v[112:115], v3 offset:22528
    v_mfma_f32_16x16x32_bf16 v[56:59], v[124:127], a[108:111], v[56:59]
    ds_read_b128 v[104:107], v3 offset:20480
    s_waitcnt lgkmcnt(12)
    v_mfma_f32_16x16x32_bf16 v[28:31], v[128:131], a[36:39], v[28:31]
    ds_read_b128 v[108:111], v3 offset:21504
    v_mfma_f32_16x16x32_bf16 v[60:63], v[128:131], a[108:111], v[60:63]
    ds_read_b128 v[144:147], v3 offset:23552
    s_waitcnt lgkmcnt(13)
    v_mfma_f32_16x16x32_bf16 v[32:35], v[140:143], a[36:39], v[32:35]
    ds_read_b128 v[148:151], v4 offset:16384
    v_mfma_f32_16x16x32_bf16 v[64:67], v[140:143], a[108:111], v[64:67]
    ds_read_b128 v[152:155], v5 offset:16384
    v_mfma_f32_16x16x32_bf16 v[44:47], a[36:39], v[140:143], v[44:47]
    v_mfma_f32_16x16x32_bf16 v[76:79], a[108:111], v[140:143], v[76:79]
    s_waitcnt lgkmcnt(14)
    v_mfma_f32_16x16x32_bf16 v[36:39], a[36:39], v[132:135], v[36:39]
    v_mfma_f32_16x16x32_bf16 v[68:71], a[108:111], v[132:135], v[68:71]
    s_waitcnt lgkmcnt(13)
    v_mfma_f32_16x16x32_bf16 v[40:43], a[36:39], v[136:139], v[40:43]
    v_mfma_f32_16x16x32_bf16 v[72:75], a[108:111], v[136:139], v[72:75]
    s_waitcnt lgkmcnt(11)
    v_mfma_f32_16x16x32_bf16 v[80:83], v[160:163], v[156:159], v[80:83]
    s_waitcnt lgkmcnt(10)
    v_mfma_f32_16x16x32_bf16 v[84:87], v[156:159], v[164:167], v[84:87]
    s_waitcnt lgkmcnt(9)
    v_mfma_f32_16x16x32_bf16 v[16:19], v[88:91], a[40:43], v[16:19]
    ds_read_b128 v[116:119], v3 offset:24576
    v_mfma_f32_16x16x32_bf16 v[48:51], v[88:91], a[112:115], v[48:51]
    ds_read_b128 v[120:123], v3 offset:25600
    s_waitcnt lgkmcnt(10)
    v_mfma_f32_16x16x32_bf16 v[20:23], v[92:95], a[40:43], v[20:23]
    ds_read_b128 v[124:127], v3 offset:26624
    v_mfma_f32_16x16x32_bf16 v[52:55], v[92:95], a[112:115], v[52:55]
    ds_read_b128 v[128:131], v3 offset:27648
    s_waitcnt lgkmcnt(11)
    v_mfma_f32_16x16x32_bf16 v[24:27], v[96:99], a[40:43], v[24:27]
    ds_read_b128 v[140:143], v3 offset:30720
    v_mfma_f32_16x16x32_bf16 v[56:59], v[96:99], a[112:115], v[56:59]
    ds_read_b128 v[132:135], v3 offset:28672
    s_waitcnt lgkmcnt(12)
    v_mfma_f32_16x16x32_bf16 v[28:31], v[100:103], a[40:43], v[28:31]
    ds_read_b128 v[136:139], v3 offset:29696
    v_mfma_f32_16x16x32_bf16 v[60:63], v[100:103], a[112:115], v[60:63]
    ds_read_b128 v[156:159], v3 offset:31744
    s_waitcnt lgkmcnt(13)
    v_mfma_f32_16x16x32_bf16 v[32:35], v[112:115], a[40:43], v[32:35]
    ds_read_b128 v[160:163], v4 offset:24576
    v_mfma_f32_16x16x32_bf16 v[64:67], v[112:115], a[112:115], v[64:67]
    ds_read_b128 v[164:167], v5 offset:24576
    v_mfma_f32_16x16x32_bf16 v[44:47], a[40:43], v[112:115], v[44:47]
    v_mfma_f32_16x16x32_bf16 v[76:79], a[112:115], v[112:115], v[76:79]
    s_waitcnt lgkmcnt(14)
    v_mfma_f32_16x16x32_bf16 v[36:39], a[40:43], v[104:107], v[36:39]
    v_mfma_f32_16x16x32_bf16 v[68:71], a[112:115], v[104:107], v[68:71]
    s_waitcnt lgkmcnt(13)
    v_mfma_f32_16x16x32_bf16 v[40:43], a[40:43], v[108:111], v[40:43]
    v_mfma_f32_16x16x32_bf16 v[72:75], a[112:115], v[108:111], v[72:75]
    s_waitcnt lgkmcnt(11)
    v_mfma_f32_16x16x32_bf16 v[80:83], v[148:151], v[144:147], v[80:83]
    s_waitcnt lgkmcnt(10)
    v_mfma_f32_16x16x32_bf16 v[84:87], v[144:147], v[152:155], v[84:87]
    s_waitcnt vmcnt(25) lgkmcnt(9)
    v_mfma_f32_16x16x32_bf16 v[16:19], v[116:119], a[44:47], v[16:19]
    s_waitcnt vmcnt(14)
    s_barrier
    v_mfma_f32_16x16x32_bf16 v[48:51], v[116:119], a[116:119], v[48:51]
    ds_read_b128 v[88:91], v3 offset:32768
    ds_read_b128 v[92:95], v3 offset:33792
    s_waitcnt lgkmcnt(10)
    v_mfma_f32_16x16x32_bf16 v[20:23], v[120:123], a[44:47], v[20:23]
    ds_read_b128 v[96:99], v3 offset:34816
    v_mfma_f32_16x16x32_bf16 v[52:55], v[120:123], a[116:119], v[52:55]
    ds_read_b128 v[100:103], v3 offset:35840
    s_waitcnt lgkmcnt(11)
    v_mfma_f32_16x16x32_bf16 v[24:27], v[124:127], a[44:47], v[24:27]
    ds_read_b128 v[112:115], v3 offset:38912
    v_mfma_f32_16x16x32_bf16 v[56:59], v[124:127], a[116:119], v[56:59]
    ds_read_b128 v[104:107], v3 offset:36864
    s_waitcnt lgkmcnt(12)
    v_mfma_f32_16x16x32_bf16 v[28:31], v[128:131], a[44:47], v[28:31]
    ds_read_b128 v[108:111], v3 offset:37888
    v_mfma_f32_16x16x32_bf16 v[60:63], v[128:131], a[116:119], v[60:63]
    ds_read_b128 v[144:147], v3 offset:39936
    s_waitcnt lgkmcnt(13)
    v_mfma_f32_16x16x32_bf16 v[32:35], v[140:143], a[44:47], v[32:35]
    ds_read_b128 v[148:151], v4 offset:32768
    v_mfma_f32_16x16x32_bf16 v[64:67], v[140:143], a[116:119], v[64:67]
    ds_read_b128 v[152:155], v5 offset:32768
    v_mfma_f32_16x16x32_bf16 v[44:47], a[44:47], v[140:143], v[44:47]
    v_mfma_f32_16x16x32_bf16 v[76:79], a[116:119], v[140:143], v[76:79]
    s_waitcnt lgkmcnt(14)
    v_mfma_f32_16x16x32_bf16 v[36:39], a[44:47], v[132:135], v[36:39]
    v_mfma_f32_16x16x32_bf16 v[68:71], a[116:119], v[132:135], v[68:71]
    s_waitcnt lgkmcnt(13)
    v_mfma_f32_16x16x32_bf16 v[40:43], a[44:47], v[136:139], v[40:43]
    v_mfma_f32_16x16x32_bf16 v[72:75], a[116:119], v[136:139], v[72:75]
    s_waitcnt lgkmcnt(11)
    v_mfma_f32_16x16x32_bf16 v[80:83], v[160:163], v[156:159], v[80:83]
    s_waitcnt lgkmcnt(10)
    v_mfma_f32_16x16x32_bf16 v[84:87], v[156:159], v[164:167], v[84:87]
    s_waitcnt lgkmcnt(9)
    v_mfma_f32_16x16x32_bf16 v[16:19], v[88:91], a[48:51], v[16:19]
    ds_read_b128 v[116:119], v3 offset:40960
    v_mfma_f32_16x16x32_bf16 v[48:51], v[88:91], a[120:123], v[48:51]
    ds_read_b128 v[120:123], v3 offset:41984
    s_waitcnt lgkmcnt(10)
    v_mfma_f32_16x16x32_bf16 v[20:23], v[92:95], a[48:51], v[20:23]
    ds_read_b128 v[124:127], v3 offset:43008
    v_mfma_f32_16x16x32_bf16 v[52:55], v[92:95], a[120:123], v[52:55]
    ds_read_b128 v[128:131], v3 offset:44032
    s_waitcnt lgkmcnt(11)
    v_mfma_f32_16x16x32_bf16 v[24:27], v[96:99], a[48:51], v[24:27]
    ds_read_b128 v[140:143], v3 offset:47104
    v_mfma_f32_16x16x32_bf16 v[56:59], v[96:99], a[120:123], v[56:59]
    ds_read_b128 v[132:135], v3 offset:45056
    s_waitcnt lgkmcnt(12)
    v_mfma_f32_16x16x32_bf16 v[28:31], v[100:103], a[48:51], v[28:31]
    ds_read_b128 v[136:139], v3 offset:46080
    v_mfma_f32_16x16x32_bf16 v[60:63], v[100:103], a[120:123], v[60:63]
    ds_read_b128 v[156:159], v3 offset:48128
    s_waitcnt lgkmcnt(13)
    v_mfma_f32_16x16x32_bf16 v[32:35], v[112:115], a[48:51], v[32:35]
    ds_read_b128 v[160:163], v4 offset:40960
    v_mfma_f32_16x16x32_bf16 v[64:67], v[112:115], a[120:123], v[64:67]
    ds_read_b128 v[164:167], v5 offset:40960
    v_mfma_f32_16x16x32_bf16 v[44:47], a[48:51], v[112:115], v[44:47]
    v_mfma_f32_16x16x32_bf16 v[76:79], a[120:123], v[112:115], v[76:79]
    s_waitcnt lgkmcnt(14)
    v_mfma_f32_16x16x32_bf16 v[36:39], a[48:51], v[104:107], v[36:39]
    v_mfma_f32_16x16x32_bf16 v[68:71], a[120:123], v[104:107], v[68:71]
    s_waitcnt lgkmcnt(13)
    v_mfma_f32_16x16x32_bf16 v[40:43], a[48:51], v[108:111], v[40:43]
    v_mfma_f32_16x16x32_bf16 v[72:75], a[120:123], v[108:111], v[72:75]
    s_waitcnt lgkmcnt(11)
    v_mfma_f32_16x16x32_bf16 v[80:83], v[148:151], v[144:147], v[80:83]
    s_waitcnt lgkmcnt(10)
    v_mfma_f32_16x16x32_bf16 v[84:87], v[144:147], v[152:155], v[84:87]
    s_waitcnt lgkmcnt(9)
    v_mfma_f32_16x16x32_bf16 v[16:19], v[116:119], a[52:55], v[16:19]
    ds_read_b128 v[88:91], v3 offset:49152
    v_mfma_f32_16x16x32_bf16 v[48:51], v[116:119], a[124:127], v[48:51]
    ds_read_b128 v[92:95], v3 offset:50176
    s_waitcnt lgkmcnt(10)
    v_mfma_f32_16x16x32_bf16 v[20:23], v[120:123], a[52:55], v[20:23]
    ds_read_b128 v[96:99], v3 offset:51200
    v_mfma_f32_16x16x32_bf16 v[52:55], v[120:123], a[124:127], v[52:55]
    ds_read_b128 v[100:103], v3 offset:52224
    s_waitcnt lgkmcnt(11)
    v_mfma_f32_16x16x32_bf16 v[24:27], v[124:127], a[52:55], v[24:27]
    ds_read_b128 v[112:115], v3 offset:55296
    v_mfma_f32_16x16x32_bf16 v[56:59], v[124:127], a[124:127], v[56:59]
    ds_read_b128 v[104:107], v3 offset:53248
    s_waitcnt lgkmcnt(12)
    v_mfma_f32_16x16x32_bf16 v[28:31], v[128:131], a[52:55], v[28:31]
    ds_read_b128 v[108:111], v3 offset:54272
    v_mfma_f32_16x16x32_bf16 v[60:63], v[128:131], a[124:127], v[60:63]
    ds_read_b128 v[144:147], v3 offset:56320
    s_waitcnt lgkmcnt(13)
    v_mfma_f32_16x16x32_bf16 v[32:35], v[140:143], a[52:55], v[32:35]
    ds_read_b128 v[148:151], v4 offset:49152
    v_mfma_f32_16x16x32_bf16 v[64:67], v[140:143], a[124:127], v[64:67]
    ds_read_b128 v[152:155], v5 offset:49152
    v_mfma_f32_16x16x32_bf16 v[44:47], a[52:55], v[140:143], v[44:47]
    v_mfma_f32_16x16x32_bf16 v[76:79], a[124:127], v[140:143], v[76:79]
    s_waitcnt lgkmcnt(14)
    v_mfma_f32_16x16x32_bf16 v[36:39], a[52:55], v[132:135], v[36:39]
    v_mfma_f32_16x16x32_bf16 v[68:71], a[124:127], v[132:135], v[68:71]
    s_waitcnt lgkmcnt(13)
    v_mfma_f32_16x16x32_bf16 v[40:43], a[52:55], v[136:139], v[40:43]
    v_mfma_f32_16x16x32_bf16 v[72:75], a[124:127], v[136:139], v[72:75]
    s_waitcnt lgkmcnt(11)
    v_mfma_f32_16x16x32_bf16 v[80:83], v[160:163], v[156:159], v[80:83]
    s_waitcnt lgkmcnt(10)
    v_mfma_f32_16x16x32_bf16 v[84:87], v[156:159], v[164:167], v[84:87]
    s_waitcnt vmcnt(13) lgkmcnt(9)
    v_mfma_f32_16x16x32_bf16 v[16:19], v[88:91], a[56:59], v[16:19]
    s_waitcnt vmcnt(2)
    s_barrier
    v_mfma_f32_16x16x32_bf16 v[48:51], v[88:91], a[128:131], v[48:51]
    ds_read_b128 v[116:119], v3 offset:57344
    ds_read_b128 v[120:123], v3 offset:58368
    s_waitcnt lgkmcnt(10)
    v_mfma_f32_16x16x32_bf16 v[20:23], v[92:95], a[56:59], v[20:23]
    ds_read_b128 v[124:127], v3 offset:59392
    v_mfma_f32_16x16x32_bf16 v[52:55], v[92:95], a[128:131], v[52:55]
    ds_read_b128 v[128:131], v3 offset:60416
    s_waitcnt lgkmcnt(11)
    v_mfma_f32_16x16x32_bf16 v[24:27], v[96:99], a[56:59], v[24:27]
    ds_read_b128 v[140:143], v3 offset:63488
    v_mfma_f32_16x16x32_bf16 v[56:59], v[96:99], a[128:131], v[56:59]
    ds_read_b128 v[132:135], v3 offset:61440
    s_waitcnt lgkmcnt(12)
    v_mfma_f32_16x16x32_bf16 v[28:31], v[100:103], a[56:59], v[28:31]
    ds_read_b128 v[136:139], v3 offset:62464
    v_mfma_f32_16x16x32_bf16 v[60:63], v[100:103], a[128:131], v[60:63]
    ds_read_b128 v[156:159], v3 offset:64512
    s_waitcnt lgkmcnt(13)
    v_mfma_f32_16x16x32_bf16 v[32:35], v[112:115], a[56:59], v[32:35]
    ds_read_b128 v[160:163], v4 offset:57344
    v_mfma_f32_16x16x32_bf16 v[64:67], v[112:115], a[128:131], v[64:67]
    ds_read_b128 v[164:167], v5 offset:57344
    v_mfma_f32_16x16x32_bf16 v[44:47], a[56:59], v[112:115], v[44:47]
    v_mfma_f32_16x16x32_bf16 v[76:79], a[128:131], v[112:115], v[76:79]
    s_waitcnt lgkmcnt(14)
    v_mfma_f32_16x16x32_bf16 v[36:39], a[56:59], v[104:107], v[36:39]
    v_mfma_f32_16x16x32_bf16 v[68:71], a[128:131], v[104:107], v[68:71]
    s_waitcnt lgkmcnt(13)
    v_mfma_f32_16x16x32_bf16 v[40:43], a[56:59], v[108:111], v[40:43]
    v_mfma_f32_16x16x32_bf16 v[72:75], a[128:131], v[108:111], v[72:75]
    s_waitcnt lgkmcnt(11)
    v_mfma_f32_16x16x32_bf16 v[80:83], v[148:151], v[144:147], v[80:83]
    s_waitcnt lgkmcnt(10)
    v_mfma_f32_16x16x32_bf16 v[84:87], v[144:147], v[152:155], v[84:87]
    s_waitcnt lgkmcnt(9)
    v_mfma_f32_16x16x32_bf16 v[16:19], v[116:119], a[60:63], v[16:19]
    v_add_u32 v3, 0x10000, v3
    v_mfma_f32_16x16x32_bf16 v[48:51], v[116:119], a[132:135], v[48:51]
    v_add_u32 v4, 0x10000, v4
    s_waitcnt lgkmcnt(8)
    v_mfma_f32_16x16x32_bf16 v[20:23], v[120:123], a[60:63], v[20:23]
    v_add_u32 v5, 0x10000, v5
    v_mfma_f32_16x16x32_bf16 v[52:55], v[120:123], a[132:135], v[52:55]
    ds_read_b128 v[88:91], v3 offset:0
    s_waitcnt lgkmcnt(8)
    v_mfma_f32_16x16x32_bf16 v[24:27], v[124:127], a[60:63], v[24:27]
    ds_read_b128 v[92:95], v3 offset:1024
    v_mfma_f32_16x16x32_bf16 v[56:59], v[124:127], a[132:135], v[56:59]
    ds_read_b128 v[96:99], v3 offset:2048
    s_waitcnt lgkmcnt(9)
    v_mfma_f32_16x16x32_bf16 v[28:31], v[128:131], a[60:63], v[28:31]
    ds_read_b128 v[100:103], v3 offset:3072
    v_mfma_f32_16x16x32_bf16 v[60:63], v[128:131], a[132:135], v[60:63]
    ds_read_b128 v[112:115], v3 offset:6144
    s_waitcnt lgkmcnt(10)
    v_mfma_f32_16x16x32_bf16 v[32:35], v[140:143], a[60:63], v[32:35]
    ds_read_b128 v[104:107], v3 offset:4096
    v_mfma_f32_16x16x32_bf16 v[64:67], v[140:143], a[132:135], v[64:67]
    ds_read_b128 v[108:111], v3 offset:5120
    v_mfma_f32_16x16x32_bf16 v[44:47], a[60:63], v[140:143], v[44:47]
    ds_read_b128 v[144:147], v3 offset:7168
    v_mfma_f32_16x16x32_bf16 v[76:79], a[132:135], v[140:143], v[76:79]
    ds_read_b128 v[148:151], v4 offset:0
    s_waitcnt lgkmcnt(13)
    v_mfma_f32_16x16x32_bf16 v[36:39], a[60:63], v[132:135], v[36:39]
    ds_read_b128 v[152:155], v5 offset:0
    v_mfma_f32_16x16x32_bf16 v[68:71], a[132:135], v[132:135], v[68:71]
    s_waitcnt lgkmcnt(13)
    v_mfma_f32_16x16x32_bf16 v[40:43], a[60:63], v[136:139], v[40:43]
    v_mfma_f32_16x16x32_bf16 v[72:75], a[132:135], v[136:139], v[72:75]
    s_waitcnt lgkmcnt(11)
    v_mfma_f32_16x16x32_bf16 v[80:83], v[160:163], v[156:159], v[80:83]
    s_waitcnt lgkmcnt(10)
    v_mfma_f32_16x16x32_bf16 v[84:87], v[156:159], v[164:167], v[84:87]
    s_waitcnt lgkmcnt(9)
    v_mfma_f32_16x16x32_bf16 v[16:19], v[88:91], a[64:67], v[16:19]
    ds_read_b128 v[116:119], v3 offset:8192
    v_mfma_f32_16x16x32_bf16 v[48:51], v[88:91], a[136:139], v[48:51]
    ds_read_b128 v[120:123], v3 offset:9216
    s_waitcnt lgkmcnt(10)
    v_mfma_f32_16x16x32_bf16 v[20:23], v[92:95], a[64:67], v[20:23]
    ds_read_b128 v[124:127], v3 offset:10240
    v_mfma_f32_16x16x32_bf16 v[52:55], v[92:95], a[136:139], v[52:55]
    ds_read_b128 v[128:131], v3 offset:11264
    s_waitcnt lgkmcnt(11)
    v_mfma_f32_16x16x32_bf16 v[24:27], v[96:99], a[64:67], v[24:27]
    ds_read_b128 v[140:143], v3 offset:14336
    v_mfma_f32_16x16x32_bf16 v[56:59], v[96:99], a[136:139], v[56:59]
    ds_read_b128 v[132:135], v3 offset:12288
    s_waitcnt lgkmcnt(12)
    v_mfma_f32_16x16x32_bf16 v[28:31], v[100:103], a[64:67], v[28:31]
    ds_read_b128 v[136:139], v3 offset:13312
    v_mfma_f32_16x16x32_bf16 v[60:63], v[100:103], a[136:139], v[60:63]
    ds_read_b128 v[156:159], v3 offset:15360
    s_waitcnt lgkmcnt(13)
    v_mfma_f32_16x16x32_bf16 v[32:35], v[112:115], a[64:67], v[32:35]
    ds_read_b128 v[160:163], v4 offset:8192
    v_mfma_f32_16x16x32_bf16 v[64:67], v[112:115], a[136:139], v[64:67]
    ds_read_b128 v[164:167], v5 offset:8192
    v_mfma_f32_16x16x32_bf16 v[44:47], a[64:67], v[112:115], v[44:47]
    v_mfma_f32_16x16x32_bf16 v[76:79], a[136:139], v[112:115], v[76:79]
    s_waitcnt lgkmcnt(14)
    v_mfma_f32_16x16x32_bf16 v[36:39], a[64:67], v[104:107], v[36:39]
    v_mfma_f32_16x16x32_bf16 v[68:71], a[136:139], v[104:107], v[68:71]
    s_waitcnt lgkmcnt(13)
    v_mfma_f32_16x16x32_bf16 v[40:43], a[64:67], v[108:111], v[40:43]
    v_mfma_f32_16x16x32_bf16 v[72:75], a[136:139], v[108:111], v[72:75]
    s_waitcnt lgkmcnt(11)
    v_mfma_f32_16x16x32_bf16 v[80:83], v[148:151], v[144:147], v[80:83]
    s_waitcnt lgkmcnt(10)
    v_mfma_f32_16x16x32_bf16 v[84:87], v[144:147], v[152:155], v[84:87]
    s_waitcnt vmcnt(1) lgkmcnt(9)
    v_mfma_f32_16x16x32_bf16 v[16:19], v[116:119], a[68:71], v[16:19]
    s_waitcnt vmcnt(0)
    v_mfma_f32_16x16x32_bf16 v[48:51], v[116:119], a[140:143], v[48:51]
    s_waitcnt lgkmcnt(8)
    v_mfma_f32_16x16x32_bf16 v[20:23], v[120:123], a[68:71], v[20:23]
    v_mfma_f32_16x16x32_bf16 v[52:55], v[120:123], a[140:143], v[52:55]
    s_waitcnt lgkmcnt(7)
    v_mfma_f32_16x16x32_bf16 v[24:27], v[124:127], a[68:71], v[24:27]
    v_mfma_f32_16x16x32_bf16 v[56:59], v[124:127], a[140:143], v[56:59]
    s_waitcnt lgkmcnt(6)
    v_mfma_f32_16x16x32_bf16 v[28:31], v[128:131], a[68:71], v[28:31]
    v_mfma_f32_16x16x32_bf16 v[60:63], v[128:131], a[140:143], v[60:63]
    s_waitcnt lgkmcnt(5)
    v_mfma_f32_16x16x32_bf16 v[32:35], v[140:143], a[68:71], v[32:35]
    v_mfma_f32_16x16x32_bf16 v[64:67], v[140:143], a[140:143], v[64:67]
    v_mfma_f32_16x16x32_bf16 v[44:47], a[68:71], v[140:143], v[44:47]
    v_mfma_f32_16x16x32_bf16 v[76:79], a[140:143], v[140:143], v[76:79]
    s_waitcnt lgkmcnt(4)
    v_mfma_f32_16x16x32_bf16 v[36:39], a[68:71], v[132:135], v[36:39]
    v_mfma_f32_16x16x32_bf16 v[68:71], a[140:143], v[132:135], v[68:71]
    s_waitcnt lgkmcnt(3)
    v_mfma_f32_16x16x32_bf16 v[40:43], a[68:71], v[136:139], v[40:43]
    v_mfma_f32_16x16x32_bf16 v[72:75], a[140:143], v[136:139], v[72:75]
    s_waitcnt lgkmcnt(1)
    v_mfma_f32_16x16x32_bf16 v[80:83], v[160:163], v[156:159], v[80:83]
    s_waitcnt lgkmcnt(0)
    v_mfma_f32_16x16x32_bf16 v[84:87], v[156:159], v[164:167], v[84:87]
    v_lshlrev_b32 v6, 3, v1
    v_add_u32 v6, 147456, v6
    s_mul_i32 s52, s20, 3072
    v_add_u32 v7, s52, v6
    v_cvt_pk_bf16_f32 v100, v56, v57
    v_cvt_pk_bf16_f32 v101, v58, v59
    v_cvt_pk_bf16_f32 v104, v60, v61
    v_cvt_pk_bf16_f32 v105, v62, v63
    v_cvt_pk_bf16_f32 v134, v64, v65
    v_cvt_pk_bf16_f32 v137, v66, v67
    v_mov_b32 v102, 0
    v_mov_b32 v103, 0
    v_cvt_pk_bf16_f32 v110, v68, v69
    v_cvt_pk_bf16_f32 v111, v70, v71
    v_cvt_pk_bf16_f32 v116, v72, v73
    v_cvt_pk_bf16_f32 v117, v74, v75
    v_cvt_pk_bf16_f32 v122, v76, v77
    v_cvt_pk_bf16_f32 v123, v78, v79
    v_permlane32_swap_b32 v134, v102
    v_permlane32_swap_b32 v137, v103
    ds_write_b64 v7, v[100:101] offset:3072
    ds_write_b64 v7, v[102:103] offset:3584
    ds_write_b64 v7, v[104:105] offset:4096
    ds_write_b64 v7, v[110:111] offset:4608
    ds_write_b64 v7, v[116:117] offset:5120
    ds_write_b64 v7, v[122:123] offset:5632
    v_cvt_pk_bf16_f32 v140, v80, v81
    v_cvt_pk_bf16_f32 v141, v82, v83
    v_cvt_pk_bf16_f32 v142, v84, v85
    v_cvt_pk_bf16_f32 v143, v86, v87
    s_min_u32 s52, s20, 2
    s_lshl_b32 s53, s52, 1
    s_cmp_ge_u32 s20, 2
    s_cselect_b32 s53, 1, s53
    s_lshl_b32 s53, s53, 9
    s_add_u32 s52, s52, 3
    s_lshl_b32 s52, s52, 9
    v_add_u32 v8, s53, v6
    v_add_u32 v9, s52, v6
    s_cmp_lt_u32 s20, 2
    s_cbranch_scc1 L_noswap_42
    v_mov_b32 v10, 0
    v_mov_b32 v11, 0
    s_nop 1
    v_permlane32_swap_b32 v140, v10
    v_permlane32_swap_b32 v141, v11
    v_mov_b32 v140, v10
    v_mov_b32 v141, v11
L_noswap_42:
    ds_write_b64 v8, v[140:141]
    ds_write_b64 v9, v[142:143]
    v_cvt_pk_bf16_f32 v132, v48, v49
    v_cvt_pk_bf16_f32 v133, v50, v51
    v_cvt_pk_bf16_f32 v138, v52, v53
    v_cvt_pk_bf16_f32 v139, v54, v55
    v_mov_b32 v135, 0
    v_mov_b32 v136, 0
    v_cvt_pk_bf16_f32 v94, v24, v25
    v_cvt_pk_bf16_f32 v95, v26, v27
    v_cvt_pk_bf16_f32 v98, v28, v29
    v_cvt_pk_bf16_f32 v99, v30, v31
    v_cvt_pk_bf16_f32 v126, v32, v33
    v_cvt_pk_bf16_f32 v129, v34, v35
    v_mov_b32 v96, 0
    v_mov_b32 v97, 0
    v_cvt_pk_bf16_f32 v108, v36, v37
    v_cvt_pk_bf16_f32 v109, v38, v39
    v_cvt_pk_bf16_f32 v114, v40, v41
    v_cvt_pk_bf16_f32 v115, v42, v43
    v_cvt_pk_bf16_f32 v120, v44, v45
    v_cvt_pk_bf16_f32 v121, v46, v47
    v_permlane32_swap_b32 v126, v96
    v_permlane32_swap_b32 v129, v97
    v_cvt_pk_bf16_f32 v124, v16, v17
    v_cvt_pk_bf16_f32 v125, v18, v19
    v_cvt_pk_bf16_f32 v130, v20, v21
    v_cvt_pk_bf16_f32 v131, v22, v23
    v_mov_b32 v127, 0
    v_mov_b32 v128, 0
    v_mov_b32 v12, 0x3f803f80
    v_mov_b32 v13, 0x3f803f80
    v_mov_b32 v14, 0x3f803f80
    v_mov_b32 v15, 0x3f803f80
    v_mfma_f32_16x16x32_bf16 v[32:35], v[94:97], v[132:135], v[172:175]
    v_mfma_f32_16x16x32_bf16 v[36:39], v[100:103], v[132:135], v[168:171]
    v_mfma_f32_16x16x32_bf16 v[20:23], v[94:97], v[124:127], v[168:171]
    v_mfma_f32_16x16x32_bf16 v[40:43], v[96:99], v[136:139], v[172:175]
    v_mfma_f32_16x16x32_bf16 v[44:47], v[102:105], v[136:139], v[168:171]
    v_mfma_f32_16x16x32_bf16 v[28:31], v[96:99], v[128:131], v[168:171]
    s_waitcnt lgkmcnt(0)
    s_barrier
    ds_read_b64 v[88:89], v7 offset:0
    ds_read_b64 v[90:91], v7 offset:512
    ds_read_b64 v[92:93], v7 offset:1024
    ds_read_b64 v[106:107], v7 offset:1536
    ds_read_b64 v[112:113], v7 offset:2048
    ds_read_b64 v[118:119], v7 offset:2560
    s_mov_b32 s52, 0x3eae1a93
    s_waitcnt lgkmcnt(4)
    v_mfma_f32_16x16x32_bf16 v[16:19], v[88:91], v[124:127], v[176:179]
    s_waitcnt lgkmcnt(3)
    v_mfma_f32_16x16x32_bf16 v[24:27], v[90:93], v[128:131], v[176:179]
    v_max3_f32 v48, v32, v33, v34
    v_max3_f32 v49, v40, v41, v42
    s_nop 3
    v_max3_f32 v50, v16, v17, v18
    s_nop 0
    v_max3_f32 v51, v24, v25, v26
    v_max3_f32 v48, v48, v35, v36
    v_max3_f32 v49, v49, v43, v44
    v_max3_f32 v50, v50, v19, v20
    v_max3_f32 v51, v51, v27, v28
    v_max3_f32 v48, v48, v37, v38
    v_max3_f32 v49, v49, v45, v46
    v_max3_f32 v50, v50, v21, v22
    v_max3_f32 v51, v51, v29, v30
    v_max_f32 v48, v48, v39
    v_max_f32 v49, v49, v47
    v_max_f32 v50, v50, v23
    v_max_f32 v51, v51, v31
    v_mov_b32 v52, v48
    v_mov_b32 v53, v49
    v_mov_b32 v54, v50
    v_mov_b32 v55, v51
    v_permlane16_swap_b32 v48, v52
    v_permlane16_swap_b32 v49, v53
    v_permlane16_swap_b32 v50, v54
    v_permlane16_swap_b32 v51, v55
    v_max_f32 v48, v48, v52
    v_max_f32 v49, v49, v53
    v_max_f32 v50, v50, v54
    v_max_f32 v51, v51, v55
    v_mov_b32 v52, v48
    v_mov_b32 v53, v49
    v_mov_b32 v54, v50
    v_mov_b32 v55, v51
    v_permlane32_swap_b32 v48, v52
    v_permlane32_swap_b32 v49, v53
    v_permlane32_swap_b32 v50, v54
    v_permlane32_swap_b32 v51, v55
    v_max_f32 v48, v48, v52
    v_max_f32 v49, v49, v53
    v_max_f32 v50, v50, v54
    v_max_f32 v51, v51, v55
    v_mul_f32 v48, s52, v48
    v_mul_f32 v49, s52, v49
    v_mul_f32 v50, s52, v50
    v_mul_f32 v51, s52, v51
    v_fma_f32 v32, v32, s52, -v48
    v_fma_f32 v40, v40, s52, -v49
    v_fma_f32 v16, v16, s52, -v50
    v_fma_f32 v24, v24, s52, -v51
    v_fma_f32 v33, v33, s52, -v48
    v_fma_f32 v41, v41, s52, -v49
    v_fma_f32 v17, v17, s52, -v50
    v_fma_f32 v25, v25, s52, -v51
    v_fma_f32 v34, v34, s52, -v48
    v_fma_f32 v42, v42, s52, -v49
    v_fma_f32 v18, v18, s52, -v50
    v_fma_f32 v26, v26, s52, -v51
    v_fma_f32 v35, v35, s52, -v48
    v_fma_f32 v43, v43, s52, -v49
    v_fma_f32 v19, v19, s52, -v50
    v_fma_f32 v27, v27, s52, -v51
    v_fma_f32 v36, v36, s52, -v48
    v_fma_f32 v44, v44, s52, -v49
    v_fma_f32 v20, v20, s52, -v50
    v_fma_f32 v28, v28, s52, -v51
    v_fma_f32 v37, v37, s52, -v48
    v_fma_f32 v45, v45, s52, -v49
    v_fma_f32 v21, v21, s52, -v50
    v_fma_f32 v29, v29, s52, -v51
    v_fma_f32 v38, v38, s52, -v48
    v_fma_f32 v46, v46, s52, -v49
    v_fma_f32 v22, v22, s52, -v50
    v_fma_f32 v30, v30, s52, -v51
    v_fma_f32 v39, v39, s52, -v48
    v_fma_f32 v47, v47, s52, -v49
    v_fma_f32 v23, v23, s52, -v50
    v_fma_f32 v31, v31, s52, -v51
    v_exp_f32 v32, v32
    v_exp_f32 v40, v40
    v_exp_f32 v16, v16
    v_exp_f32 v24, v24
    v_exp_f32 v33, v33
    v_exp_f32 v41, v41
    v_exp_f32 v17, v17
    v_exp_f32 v25, v25
    v_exp_f32 v34, v34
    v_exp_f32 v42, v42
    v_exp_f32 v18, v18
    v_exp_f32 v26, v26
    v_exp_f32 v35, v35
    v_exp_f32 v43, v43
    v_exp_f32 v19, v19
    v_exp_f32 v27, v27
    v_exp_f32 v36, v36
    v_exp_f32 v44, v44
    v_exp_f32 v20, v20
    v_exp_f32 v28, v28
    v_exp_f32 v37, v37
    v_exp_f32 v45, v45
    v_exp_f32 v21, v21
    v_exp_f32 v29, v29
    v_exp_f32 v38, v38
    v_exp_f32 v46, v46
    v_exp_f32 v22, v22
    v_exp_f32 v30, v30
    v_exp_f32 v39, v39
    v_exp_f32 v47, v47
    v_exp_f32 v23, v23
    v_exp_f32 v31, v31
    v_cvt_pk_bf16_f32 v56, v32, v33
    v_cvt_pk_bf16_f32 v60, v40, v41
    v_cvt_pk_bf16_f32 v64, v16, v17
    v_cvt_pk_bf16_f32 v68, v24, v25
    v_cvt_pk_bf16_f32 v57, v34, v35
    v_cvt_pk_bf16_f32 v61, v42, v43
    v_cvt_pk_bf16_f32 v65, v18, v19
    v_cvt_pk_bf16_f32 v69, v26, v27
    v_cvt_pk_bf16_f32 v58, v36, v37
    v_cvt_pk_bf16_f32 v62, v44, v45
    v_cvt_pk_bf16_f32 v66, v20, v21
    v_cvt_pk_bf16_f32 v70, v28, v29
    v_cvt_pk_bf16_f32 v59, v38, v39
    v_cvt_pk_bf16_f32 v63, v46, v47
    v_cvt_pk_bf16_f32 v67, v22, v23
    v_cvt_pk_bf16_f32 v71, v30, v31
    v_mfma_f32_16x16x32_bf16 v[188:191], v[12:15], v[56:59], 0
    v_mfma_f32_16x16x32_bf16 v[180:183], v[108:111], v[56:59], 0
    v_mfma_f32_16x16x32_bf16 v[184:187], v[120:123], v[56:59], 0
    v_mfma_f32_16x16x32_bf16 v[200:203], v[12:15], v[60:63], 0
    v_mfma_f32_16x16x32_bf16 v[192:195], v[114:117], v[60:63], 0
    v_mfma_f32_16x16x32_bf16 v[196:199], v[120:123], v[60:63], 0
    v_mfma_f32_16x16x32_bf16 v[212:215], v[12:15], v[64:67], 0
    s_waitcnt lgkmcnt(2)
    v_mfma_f32_16x16x32_bf16 v[204:207], v[106:109], v[64:67], 0
    s_waitcnt lgkmcnt(0)
    v_mfma_f32_16x16x32_bf16 v[208:211], v[118:121], v[64:67], 0
    v_mfma_f32_16x16x32_bf16 v[224:227], v[12:15], v[68:71], 0
    v_mfma_f32_16x16x32_bf16 v[216:219], v[112:115], v[68:71], 0
    v_mfma_f32_16x16x32_bf16 v[220:223], v[118:121], v[68:71], 0
    s_lshl_b32 s53, s46, 4
    s_add_u32 s53, s53, s45
    s_lshl_b32 s54, s53, 10
    s_add_u32 s54, s54, 73662464
    s_lshl_b32 s55, s53, 7
    s_add_u32 s55, s55, 75759488
    v_lshlrev_b32 v6, 3, v1
    v_rcp_f32 v188, v188
    v_rcp_f32 v200, v200
    v_rcp_f32 v212, v212
    v_rcp_f32 v224, v224
    v_mul_f32 v180, v180, v188
    v_mul_f32 v181, v181, v188
    v_mul_f32 v182, v182, v188
    v_mul_f32 v183, v183, v188
    v_mul_f32 v184, v184, v188
    v_mul_f32 v185, v185, v188
    v_cvt_pk_bf16_f32 v76, v180, v181
    v_cvt_pk_bf16_f32 v77, v182, v183
    v_cvt_pk_bf16_f32 v82, v184, v185
    v_mul_f32 v192, v192, v200
    v_mul_f32 v193, v193, v200
    v_mul_f32 v194, v194, v200
    v_mul_f32 v195, v195, v200
    v_mul_f32 v198, v198, v200
    v_mul_f32 v199, v199, v200
    v_cvt_pk_bf16_f32 v78, v192, v193
    v_cvt_pk_bf16_f32 v79, v194, v195
    v_cvt_pk_bf16_f32 v83, v198, v199
    s_add_u32 s53, s54, 16384
    buffer_store_dwordx4 v[76:79], v2, s[4:7], s53 offen
    v_mul_f32 v204, v204, v212
    v_mul_f32 v205, v205, v212
    v_mul_f32 v206, v206, v212
    v_mul_f32 v207, v207, v212
    v_mul_f32 v208, v208, v212
    v_mul_f32 v209, v209, v212
    v_cvt_pk_bf16_f32 v72, v204, v205
    v_cvt_pk_bf16_f32 v73, v206, v207
    v_cvt_pk_bf16_f32 v80, v208, v209
    v_mul_f32 v216, v216, v224
    v_mul_f32 v217, v217, v224
    v_mul_f32 v218, v218, v224
    v_mul_f32 v219, v219, v224
    v_mul_f32 v222, v222, v224
    v_mul_f32 v223, v223, v224
    v_cvt_pk_bf16_f32 v74, v216, v217
    v_cvt_pk_bf16_f32 v75, v218, v219
    v_cvt_pk_bf16_f32 v81, v222, v223
    s_add_u32 s53, s54, 0
    buffer_store_dwordx4 v[72:75], v2, s[4:7], s53 offen
    s_mov_b32 exec_lo, 0xffff0000
    s_mov_b32 exec_hi, 0
    buffer_store_dwordx2 v[80:81], v6, s[4:7], s55 offen offset:0
    buffer_store_dwordx2 v[82:83], v6, s[4:7], s55 offen offset:2048
    s_mov_b64 exec, -1
    s_waitcnt vmcnt(0) lgkmcnt(0)
qkv1_kernel_end:
    s_endpgm
.section .rodata,"a"
.p2align 6
.amdhsa_kernel qkv1_kernel
  .amdhsa_next_free_vgpr 400
  .amdhsa_next_free_sgpr 102
  .amdhsa_accum_offset 256
  .amdhsa_group_segment_fixed_size 0
  .amdhsa_kernarg_size 80
  .amdhsa_user_sgpr_count 2
  .amdhsa_user_sgpr_kernarg_segment_ptr 1
  .amdhsa_system_sgpr_workgroup_id_x 1
  .amdhsa_float_denorm_mode_32 3
.end_amdhsa_kernel
.text
.globl wo1_kernel
.p2align 8
.type wo1_kernel,@function
wo1_kernel:
    s_cmp_ge_u32 s2, 256
    s_cbranch_scc1 wo1_kernel_end
    s_load_dwordx16 s[24:39], s[0:1], 0
    s_load_dwordx4 s[40:43], s[0:1], 64
    v_lshrrev_b32 v1, 6, v0
    s_and_b32 s21, s2, 7
    v_readfirstlane_b32 s20, v1
    s_lshr_b32 s22, s2, 3
    v_and_b32 v1, 63, v0
    v_lshlrev_b32 v2, 4, v1
    v_lshlrev_b32 v3, 7, v0
    s_getpc_b64 s[16:17]
L_pc_43:
    v_min_u32 v4, wo1_kernel_end-L_pc_43, v3
    global_load_dword v4, v4, s[16:17]
    s_waitcnt lgkmcnt(0)
    s_mov_b32 s4, s42
    s_mov_b32 s5, s43
    s_mov_b32 s6, 0x10000000
    s_mov_b32 s7, 0x20000
    s_cmp_ge_u32 s22, 24
    s_cbranch_scc1 wo1_kernel_end
    s_mul_i32 s44, s22, 10923
    s_lshr_b32 s44, s44, 16
    s_mul_i32 s52, s44, 6
    s_sub_u32 s45, s22, s52
    s_lshl_b32 s52, s21, 2
    s_add_u32 s44, s44, s52
    s_lshl_b32 s46, s44, 2
    s_add_u32 s46, s46, s20
    s_mul_i32 s47, s45, 110592
    s_mul_i32 s48, s20, 3072
    s_add_u32 s47, s47, s48
    s_add_u32 s47, s47, 2097152
    s_lshl_b32 s49, s46, 14
    s_add_u32 s49, s49, 73662464
    s_lshl_b32 s50, s46, 11
    s_add_u32 s50, s50, 75759616
    v_and_b32 v3, 15, v1
    s_waitcnt vmcnt(0)
    v_lshrrev_b32 v4, 4, v1
    v_lshlrev_b32 v5, 3, v3
    v_lshl_add_u32 v5, v4, 8, v5
    s_lshl_b32 s52, s46, 4
    v_add_u32 v6, s52, v3
    v_lshlrev_b32 v7, 3, v6
    v_mul_u32_u24 v6, 1152, v6
    v_lshl_add_u32 v6, v4, 4, v6
    s_mul_i32 s51, s45, 192
    s_add_u32 s8, s42, 28311552
    s_addc_u32 s9, s43, 0
    s_mov_b32 s10, 0x240000
    s_mov_b32 s11, 0x20000
    s_mov_b32 m0, s48
    s_nop 0
    buffer_load_dwordx4 v2, s[4:7], s47 offen offset:0 lds
    buffer_load_dwordx4 v2, s[4:7], s47 offen offset:1024 lds
    buffer_load_dwordx4 v2, s[4:7], s47 offen offset:2048 lds
    s_add_u32 s48, s48, 12288
    s_add_u32 s47, s47, 12288
    buffer_load_dwordx4 v[16:19], v2, s[4:7], s49 offen offset:0
    buffer_load_dwordx4 v[20:23], v2, s[4:7], s49 offen offset:1024
    s_mov_b32 m0, s48
    s_nop 0
    buffer_load_dwordx4 v2, s[4:7], s47 offen offset:0 lds
    buffer_load_dwordx4 v2, s[4:7], s47 offen offset:1024 lds
    buffer_load_dwordx4 v2, s[4:7], s47 offen offset:2048 lds
    s_add_u32 s48, s48, 12288
    s_add_u32 s47, s47, 12288
    buffer_load_dwordx4 v[24:27], v2, s[4:7], s49 offen offset:2048
    buffer_load_dwordx4 v[28:31], v2, s[4:7], s49 offen offset:3072
    s_mov_b32 m0, s48
    s_nop 0
    buffer_load_dwordx4 v2, s[4:7], s47 offen offset:0 lds
    buffer_load_dwordx4 v2, s[4:7], s47 offen offset:1024 lds
    buffer_load_dwordx4 v2, s[4:7], s47 offen offset:2048 lds
    s_add_u32 s48, s48, 12288
    s_add_u32 s47, s47, 12288
    s_add_u32 s49, s49, 4096
    buffer_load_dwordx4 v[32:35], v2, s[4:7], s49 offen offset:0
    buffer_load_dwordx4 v[36:39], v2, s[4:7], s49 offen offset:1024
    s_mov_b32 m0, s48
    s_nop 0
    buffer_load_dwordx4 v2, s[4:7], s47 offen offset:0 lds
    buffer_load_dwordx4 v2, s[4:7], s47 offen offset:1024 lds
    buffer_load_dwordx4 v2, s[4:7], s47 offen offset:2048 lds
    s_add_u32 s48, s48, 12288
    s_add_u32 s47, s47, 12288
    buffer_load_dwordx4 v[40:43], v2, s[4:7], s49 offen offset:2048
    buffer_load_dwordx4 v[44:47], v2, s[4:7], s49 offen offset:3072
    s_mov_b32 m0, s48
    s_nop 0
    buffer_load_dwordx4 v2, s[4:7], s47 offen offset:0 lds
    buffer_load_dwordx4 v2, s[4:7], s47 offen offset:1024 lds
    buffer_load_dwordx4 v2, s[4:7], s47 offen offset:2048 lds
    s_add_u32 s48, s48, 12288
    s_add_u32 s47, s47, 12288
    s_add_u32 s49, s49, 4096
    buffer_load_dwordx4 v[48:51], v2, s[4:7], s49 offen offset:0
    buffer_load_dwordx4 v[52:55], v2, s[4:7], s49 offen offset:1024
    s_mov_b32 m0, s48
    s_nop 0
    buffer_load_dwordx4 v2, s[4:7], s47 offen offset:0 lds
    buffer_load_dwordx4 v2, s[4:7], s47 offen offset:1024 lds
    buffer_load_dwordx4 v2, s[4:7], s47 offen offset:2048 lds
    s_add_u32 s48, s48, 12288
    s_add_u32 s47, s47, 12288
    buffer_load_dwordx4 v[56:59], v2, s[4:7], s49 offen offset:2048
    buffer_load_dwordx4 v[60:63], v2, s[4:7], s49 offen offset:3072
    s_mov_b32 m0, s48
    s_nop 0
    buffer_load_dwordx4 v2, s[4:7], s47 offen offset:0 lds
    buffer_load_dwordx4 v2, s[4:7], s47 offen offset:1024 lds
    buffer_load_dwordx4 v2, s[4:7], s47 offen offset:2048 lds
    s_add_u32 s48, s48, 12288
    s_add_u32 s47, s47, 12288
    s_add_u32 s49, s49, 4096
    buffer_load_dwordx4 v[64:67], v2, s[4:7], s49 offen offset:0
    buffer_load_dwordx4 v[68:71], v2, s[4:7], s49 offen offset:1024
    s_mov_b32 m0, s48
    s_nop 0
    buffer_load_dwordx4 v2, s[4:7], s47 offen offset:0 lds
    buffer_load_dwordx4 v2, s[4:7], s47 offen offset:1024 lds
    buffer_load_dwordx4 v2, s[4:7], s47 offen offset:2048 lds
    s_add_u32 s48, s48, 12288
    s_add_u32 s47, s47, 12288
    buffer_load_dwordx4 v[72:75], v2, s[4:7], s49 offen offset:2048
    buffer_load_dwordx4 v[76:79], v2, s[4:7], s49 offen offset:3072
    s_mov_b32 m0, s48
    s_nop 0
    buffer_load_dwordx4 v2, s[4:7], s47 offen offset:0 lds
    buffer_load_dwordx4 v2, s[4:7], s47 offen offset:1024 lds
    buffer_load_dwordx4 v2, s[4:7], s47 offen offset:2048 lds
    s_add_u32 s48, s48, 12288
    s_add_u32 s47, s47, 12288
    buffer_load_dwordx2 v[80:81], v5, s[4:7], s50 offen offset:0
    buffer_load_dwordx2 v[82:83], v5, s[4:7], s50 offen offset:128
    buffer_load_dwordx2 v[84:85], v5, s[4:7], s50 offen offset:1024
    buffer_load_dwordx2 v[86:87], v5, s[4:7], s50 offen offset:1152
    buffer_load_dwordx4 v[160:163], v6, s[8:11], s51 offen offset:0
    buffer_load_dwordx4 v[164:167], v6, s[8:11], s51 offen offset:64
    buffer_load_dwordx4 v[168:171], v6, s[8:11], s51 offen offset:128
    v_mov_b32 v8, v2
    s_waitcnt vmcnt(37)
    s_barrier
    ds_read_b128 v[112:115], v8 offset:0
    ds_read_b128 v[116:119], v8 offset:1024
    ds_read_b128 v[120:123], v8 offset:2048
    ds_read_b128 v[124:127], v8 offset:3072
    ds_read_b128 v[128:131], v8 offset:4096
    ds_read_b128 v[132:135], v8 offset:5120
    ds_read_b128 v[136:139], v8 offset:6144
    ds_read_b128 v[140:143], v8 offset:7168
    s_waitcnt lgkmcnt(7)
    v_mfma_f32_16x16x32_bf16 v[88:91], v[112:115], v[16:19], 0
    ds_read_b128 v[144:147], v8 offset:8192
    s_waitcnt lgkmcnt(7)
    v_mfma_f32_16x16x32_bf16 v[92:95], v[116:119], v[16:19], 0
    ds_read_b128 v[148:151], v8 offset:9216
    s_waitcnt lgkmcnt(7)
    v_mfma_f32_16x16x32_bf16 v[96:99], v[120:123], v[16:19], 0
    ds_read_b128 v[152:155], v8 offset:10240
    s_waitcnt lgkmcnt(7)
    v_mfma_f32_16x16x32_bf16 v[100:103], v[124:127], v[16:19], 0
    ds_read_b128 v[156:159], v8 offset:11264
    s_waitcnt lgkmcnt(7)
    v_mfma_f32_16x16x32_bf16 v[104:107], v[128:131], v[16:19], 0
    s_waitcnt lgkmcnt(6)
    v_mfma_f32_16x16x32_bf16 v[108:111], v[132:135], v[16:19], 0
    ds_read_b128 v[112:115], v8 offset:12288
    ds_read_b128 v[116:119], v8 offset:13312
    s_waitcnt lgkmcnt(7)
    v_mfma_f32_16x16x32_bf16 v[88:91], v[136:139], v[20:23], v[88:91]
    ds_read_b128 v[120:123], v8 offset:14336
    s_waitcnt lgkmcnt(7)
    v_mfma_f32_16x16x32_bf16 v[92:95], v[140:143], v[20:23], v[92:95]
    ds_read_b128 v[124:127], v8 offset:15360
    s_waitcnt lgkmcnt(7)
    v_mfma_f32_16x16x32_bf16 v[96:99], v[144:147], v[20:23], v[96:99]
    ds_read_b128 v[128:131], v8 offset:16384
    s_waitcnt lgkmcnt(7)
    v_mfma_f32_16x16x32_bf16 v[100:103], v[148:151], v[20:23], v[100:103]
    ds_read_b128 v[132:135], v8 offset:17408
    s_waitcnt lgkmcnt(7)
    v_mfma_f32_16x16x32_bf16 v[104:107], v[152:155], v[20:23], v[104:107]
    s_waitcnt lgkmcnt(6)
    v_mfma_f32_16x16x32_bf16 v[108:111], v[156:159], v[20:23], v[108:111]
    ds_read_b128 v[136:139], v8 offset:18432
    ds_read_b128 v[140:143], v8 offset:19456
    s_waitcnt lgkmcnt(7)
    v_mfma_f32_16x16x32_bf16 v[88:91], v[112:115], v[24:27], v[88:91]
    ds_read_b128 v[144:147], v8 offset:20480
    s_waitcnt lgkmcnt(7)
    v_mfma_f32_16x16x32_bf16 v[92:95], v[116:119], v[24:27], v[92:95]
    ds_read_b128 v[148:151], v8 offset:21504
    s_waitcnt lgkmcnt(7)
    v_mfma_f32_16x16x32_bf16 v[96:99], v[120:123], v[24:27], v[96:99]
    ds_read_b128 v[152:155], v8 offset:22528
    s_waitcnt lgkmcnt(7)
    v_mfma_f32_16x16x32_bf16 v[100:103], v[124:127], v[24:27], v[100:103]
    ds_read_b128 v[156:159], v8 offset:23552
    s_waitcnt lgkmcnt(7)
    v_mfma_f32_16x16x32_bf16 v[104:107], v[128:131], v[24:27], v[104:107]
    s_waitcnt lgkmcnt(6)
    v_mfma_f32_16x16x32_bf16 v[108:111], v[132:135], v[24:27], v[108:111]
    ds_read_b128 v[112:115], v8 offset:24576
    ds_read_b128 v[116:119], v8 offset:25600
    s_waitcnt lgkmcnt(7)
    v_mfma_f32_16x16x32_bf16 v[88:91], v[136:139], v[28:31], v[88:91]
    ds_read_b128 v[120:123], v8 offset:26624
    s_waitcnt lgkmcnt(7)
    v_mfma_f32_16x16x32_bf16 v[92:95], v[140:143], v[28:31], v[92:95]
    ds_read_b128 v[124:127], v8 offset:27648
    s_waitcnt lgkmcnt(7)
    v_mfma_f32_16x16x32_bf16 v[96:99], v[144:147], v[28:31], v[96:99]
    ds_read_b128 v[128:131], v8 offset:28672
    s_waitcnt lgkmcnt(7)
    v_mfma_f32_16x16x32_bf16 v[100:103], v[148:151], v[28:31], v[100:103]
    ds_read_b128 v[132:135], v8 offset:29696
    s_waitcnt lgkmcnt(7)
    v_mfma_f32_16x16x32_bf16 v[104:107], v[152:155], v[28:31], v[104:107]
    s_waitcnt lgkmcnt(6)
    v_mfma_f32_16x16x32_bf16 v[108:111], v[156:159], v[28:31], v[108:111]
    ds_read_b128 v[136:139], v8 offset:30720
    ds_read_b128 v[140:143], v8 offset:31744
    s_waitcnt vmcnt(36) lgkmcnt(7)
    v_mfma_f32_16x16x32_bf16 v[88:91], v[112:115], v[32:35], v[88:91]
    ds_read_b128 v[144:147], v8 offset:32768
    s_waitcnt lgkmcnt(7)
    v_mfma_f32_16x16x32_bf16 v[92:95], v[116:119], v[32:35], v[92:95]
    ds_read_b128 v[148:151], v8 offset:33792
    s_waitcnt lgkmcnt(7)
    v_mfma_f32_16x16x32_bf16 v[96:99], v[120:123], v[32:35], v[96:99]
    ds_read_b128 v[152:155], v8 offset:34816
    s_waitcnt lgkmcnt(7)
    v_mfma_f32_16x16x32_bf16 v[100:103], v[124:127], v[32:35], v[100:103]
    ds_read_b128 v[156:159], v8 offset:35840
    s_waitcnt lgkmcnt(7)
    v_mfma_f32_16x16x32_bf16 v[104:107], v[128:131], v[32:35], v[104:107]
    s_waitcnt lgkmcnt(6)
    v_mfma_f32_16x16x32_bf16 v[108:111], v[132:135], v[32:35], v[108:111]
    s_waitcnt vmcnt(22)
    s_barrier
    s_waitcnt lgkmcnt(5)
    v_mfma_f32_16x16x32_bf16 v[88:91], v[136:139], v[36:39], v[88:91]
    ds_read_b128 v[112:115], v8 offset:36864
    ds_read_b128 v[116:119], v8 offset:37888
    s_waitcnt lgkmcnt(6)
    v_mfma_f32_16x16x32_bf16 v[92:95], v[140:143], v[36:39], v[92:95]
    ds_read_b128 v[120:123], v8 offset:38912
    ds_read_b128 v[124:127], v8 offset:39936
    s_waitcnt lgkmcnt(7)
    v_mfma_f32_16x16x32_bf16 v[96:99], v[144:147], v[36:39], v[96:99]
    ds_read_b128 v[128:131], v8 offset:40960
    s_waitcnt lgkmcnt(7)
    v_mfma_f32_16x16x32_bf16 v[100:103], v[148:151], v[36:39], v[100:103]
    ds_read_b128 v[132:135], v8 offset:41984
    s_waitcnt lgkmcnt(7)
    v_mfma_f32_16x16x32_bf16 v[104:107], v[152:155], v[36:39], v[104:107]
    s_waitcnt lgkmcnt(6)
    v_mfma_f32_16x16x32_bf16 v[108:111], v[156:159], v[36:39], v[108:111]
    ds_read_b128 v[136:139], v8 offset:43008
    ds_read_b128 v[140:143], v8 offset:44032
    s_waitcnt lgkmcnt(7)
    v_mfma_f32_16x16x32_bf16 v[88:91], v[112:115], v[40:43], v[88:91]
    ds_read_b128 v[144:147], v8 offset:45056
    s_waitcnt lgkmcnt(7)
    v_mfma_f32_16x16x32_bf16 v[92:95], v[116:119], v[40:43], v[92:95]
    ds_read_b128 v[148:151], v8 offset:46080
    s_waitcnt lgkmcnt(7)
    v_mfma_f32_16x16x32_bf16 v[96:99], v[120:123], v[40:43], v[96:99]
    ds_read_b128 v[152:155], v8 offset:47104
    s_waitcnt lgkmcnt(7)
    v_mfma_f32_16x16x32_bf16 v[100:103], v[124:127], v[40:43], v[100:103]
    ds_read_b128 v[156:159], v8 offset:48128
    s_waitcnt lgkmcnt(7)
    v_mfma_f32_16x16x32_bf16 v[104:107], v[128:131], v[40:43], v[104:107]
    s_waitcnt lgkmcnt(6)
    v_mfma_f32_16x16x32_bf16 v[108:111], v[132:135], v[40:43], v[108:111]
    ds_read_b128 v[112:115], v8 offset:49152
    ds_read_b128 v[116:119], v8 offset:50176
    s_waitcnt lgkmcnt(7)
    v_mfma_f32_16x16x32_bf16 v[88:91], v[136:139], v[44:47], v[88:91]
    ds_read_b128 v[120:123], v8 offset:51200
    s_waitcnt lgkmcnt(7)
    v_mfma_f32_16x16x32_bf16 v[92:95], v[140:143], v[44:47], v[92:95]
    ds_read_b128 v[124:127], v8 offset:52224
    s_waitcnt lgkmcnt(7)
    v_mfma_f32_16x16x32_bf16 v[96:99], v[144:147], v[44:47], v[96:99]
    ds_read_b128 v[128:131], v8 offset:53248
    s_waitcnt lgkmcnt(7)
    v_mfma_f32_16x16x32_bf16 v[100:103], v[148:151], v[44:47], v[100:103]
    ds_read_b128 v[132:135], v8 offset:54272
    s_waitcnt lgkmcnt(7)
    v_mfma_f32_16x16x32_bf16 v[104:107], v[152:155], v[44:47], v[104:107]
    s_waitcnt lgkmcnt(6)
    v_mfma_f32_16x16x32_bf16 v[108:111], v[156:159], v[44:47], v[108:111]
    ds_read_b128 v[136:139], v8 offset:55296
    ds_read_b128 v[140:143], v8 offset:56320
    s_waitcnt lgkmcnt(7)
    v_mfma_f32_16x16x32_bf16 v[88:91], v[112:115], v[48:51], v[88:91]
    ds_read_b128 v[144:147], v8 offset:57344
    s_waitcnt lgkmcnt(7)
    v_mfma_f32_16x16x32_bf16 v[92:95], v[116:119], v[48:51], v[92:95]
    ds_read_b128 v[148:151], v8 offset:58368
    s_waitcnt lgkmcnt(7)
    v_mfma_f32_16x16x32_bf16 v[96:99], v[120:123], v[48:51], v[96:99]
    ds_read_b128 v[152:155], v8 offset:59392
    s_waitcnt lgkmcnt(7)
    v_mfma_f32_16x16x32_bf16 v[100:103], v[124:127], v[48:51], v[100:103]
    ds_read_b128 v[156:159], v8 offset:60416
    s_waitcnt lgkmcnt(7)
    v_mfma_f32_16x16x32_bf16 v[104:107], v[128:131], v[48:51], v[104:107]
    s_waitcnt lgkmcnt(6)
    v_mfma_f32_16x16x32_bf16 v[108:111], v[132:135], v[48:51], v[108:111]
    v_add_u32 v8, 61440, v8
    ds_read_b128 v[112:115], v8 offset:0
    s_waitcnt lgkmcnt(6)
    v_mfma_f32_16x16x32_bf16 v[88:91], v[136:139], v[52:55], v[88:91]
    ds_read_b128 v[116:119], v8 offset:1024
    s_waitcnt lgkmcnt(6)
    v_mfma_f32_16x16x32_bf16 v[92:95], v[140:143], v[52:55], v[92:95]
    ds_read_b128 v[120:123], v8 offset:2048
    s_waitcnt lgkmcnt(6)
    v_mfma_f32_16x16x32_bf16 v[96:99], v[144:147], v[52:55], v[96:99]
    ds_read_b128 v[124:127], v8 offset:3072
    s_waitcnt lgkmcnt(6)
    v_mfma_f32_16x16x32_bf16 v[100:103], v[148:151], v[52:55], v[100:103]
    ds_read_b128 v[128:131], v8 offset:4096
    s_waitcnt lgkmcnt(6)
    v_mfma_f32_16x16x32_bf16 v[104:107], v[152:155], v[52:55], v[104:107]
    ds_read_b128 v[132:135], v8 offset:5120
    s_waitcnt lgkmcnt(6)
    v_mfma_f32_16x16x32_bf16 v[108:111], v[156:159], v[52:55], v[108:111]
    ds_read_b128 v[136:139], v8 offset:6144
    ds_read_b128 v[140:143], v8 offset:7168
    s_waitcnt vmcnt(21) lgkmcnt(7)
    v_mfma_f32_16x16x32_bf16 v[88:91], v[112:115], v[56:59], v[88:91]
    ds_read_b128 v[144:147], v8 offset:8192
    s_waitcnt lgkmcnt(7)
    v_mfma_f32_16x16x32_bf16 v[92:95], v[116:119], v[56:59], v[92:95]
    ds_read_b128 v[148:151], v8 offset:9216
    s_waitcnt lgkmcnt(7)
    v_mfma_f32_16x16x32_bf16 v[96:99], v[120:123], v[56:59], v[96:99]
    ds_read_b128 v[152:155], v8 offset:10240
    s_waitcnt lgkmcnt(7)
    v_mfma_f32_16x16x32_bf16 v[100:103], v[124:127], v[56:59], v[100:103]
    ds_read_b128 v[156:159], v8 offset:11264
    s_waitcnt lgkmcnt(7)
    v_mfma_f32_16x16x32_bf16 v[104:107], v[128:131], v[56:59], v[104:107]
    s_waitcnt lgkmcnt(6)
    v_mfma_f32_16x16x32_bf16 v[108:111], v[132:135], v[56:59], v[108:111]
    s_waitcnt vmcnt(7)
    s_barrier
    s_waitcnt lgkmcnt(5)
    v_mfma_f32_16x16x32_bf16 v[88:91], v[136:139], v[60:63], v[88:91]
    ds_read_b128 v[112:115], v8 offset:12288
    ds_read_b128 v[116:119], v8 offset:13312
    s_waitcnt lgkmcnt(6)
    v_mfma_f32_16x16x32_bf16 v[92:95], v[140:143], v[60:63], v[92:95]
    ds_read_b128 v[120:123], v8 offset:14336
    ds_read_b128 v[124:127], v8 offset:15360
    s_waitcnt lgkmcnt(7)
    v_mfma_f32_16x16x32_bf16 v[96:99], v[144:147], v[60:63], v[96:99]
    ds_read_b128 v[128:131], v8 offset:16384
    s_waitcnt lgkmcnt(7)
    v_mfma_f32_16x16x32_bf16 v[100:103], v[148:151], v[60:63], v[100:103]
    ds_read_b128 v[132:135], v8 offset:17408
    s_waitcnt lgkmcnt(7)
    v_mfma_f32_16x16x32_bf16 v[104:107], v[152:155], v[60:63], v[104:107]
    s_waitcnt lgkmcnt(6)
    v_mfma_f32_16x16x32_bf16 v[108:111], v[156:159], v[60:63], v[108:111]
    ds_read_b128 v[136:139], v8 offset:18432
    ds_read_b128 v[140:143], v8 offset:19456
    s_waitcnt lgkmcnt(7)
    v_mfma_f32_16x16x32_bf16 v[88:91], v[112:115], v[64:67], v[88:91]
    ds_read_b128 v[144:147], v8 offset:20480
    s_waitcnt lgkmcnt(7)
    v_mfma_f32_16x16x32_bf16 v[92:95], v[116:119], v[64:67], v[92:95]
    ds_read_b128 v[148:151], v8 offset:21504
    s_waitcnt lgkmcnt(7)
    v_mfma_f32_16x16x32_bf16 v[96:99], v[120:123], v[64:67], v[96:99]
    ds_read_b128 v[152:155], v8 offset:22528
    s_waitcnt lgkmcnt(7)
    v_mfma_f32_16x16x32_bf16 v[100:103], v[124:127], v[64:67], v[100:103]
    ds_read_b128 v[156:159], v8 offset:23552
    s_waitcnt lgkmcnt(7)
    v_mfma_f32_16x16x32_bf16 v[104:107], v[128:131], v[64:67], v[104:107]
    s_waitcnt lgkmcnt(6)
    v_mfma_f32_16x16x32_bf16 v[108:111], v[132:135], v[64:67], v[108:111]
    ds_read_b128 v[112:115], v8 offset:24576
    ds_read_b128 v[116:119], v8 offset:25600
    s_waitcnt lgkmcnt(7)
    v_mfma_f32_16x16x32_bf16 v[88:91], v[136:139], v[68:71], v[88:91]
    ds_read_b128 v[120:123], v8 offset:26624
    s_waitcnt lgkmcnt(7)
    v_mfma_f32_16x16x32_bf16 v[92:95], v[140:143], v[68:71], v[92:95]
    ds_read_b128 v[124:127], v8 offset:27648
    s_waitcnt lgkmcnt(7)
    v_mfma_f32_16x16x32_bf16 v[96:99], v[144:147], v[68:71], v[96:99]
    ds_read_b128 v[128:131], v8 offset:28672
    s_waitcnt lgkmcnt(7)
    v_mfma_f32_16x16x32_bf16 v[100:103], v[148:151], v[68:71], v[100:103]
    ds_read_b128 v[132:135], v8 offset:29696
    s_waitcnt lgkmcnt(7)
    v_mfma_f32_16x16x32_bf16 v[104:107], v[152:155], v[68:71], v[104:107]
    s_waitcnt lgkmcnt(6)
    v_mfma_f32_16x16x32_bf16 v[108:111], v[156:159], v[68:71], v[108:111]
    ds_read_b128 v[136:139], v8 offset:30720
    ds_read_b128 v[140:143], v8 offset:31744
    s_waitcnt lgkmcnt(7)
    v_mfma_f32_16x16x32_bf16 v[88:91], v[112:115], v[72:75], v[88:91]
    ds_read_b128 v[144:147], v8 offset:32768
    s_waitcnt lgkmcnt(7)
    v_mfma_f32_16x16x32_bf16 v[92:95], v[116:119], v[72:75], v[92:95]
    ds_read_b128 v[148:151], v8 offset:33792
    s_waitcnt lgkmcnt(7)
    v_mfma_f32_16x16x32_bf16 v[96:99], v[120:123], v[72:75], v[96:99]
    ds_read_b128 v[152:155], v8 offset:34816
    s_waitcnt lgkmcnt(7)
    v_mfma_f32_16x16x32_bf16 v[100:103], v[124:127], v[72:75], v[100:103]
    ds_read_b128 v[156:159], v8 offset:35840
    s_waitcnt lgkmcnt(7)
    v_mfma_f32_16x16x32_bf16 v[104:107], v[128:131], v[72:75], v[104:107]
    s_waitcnt lgkmcnt(6)
    v_mfma_f32_16x16x32_bf16 v[108:111], v[132:135], v[72:75], v[108:111]
    ds_read_b128 v[112:115], v8 offset:36864
    ds_read_b128 v[116:119], v8 offset:37888
    s_waitcnt lgkmcnt(7)
    v_mfma_f32_16x16x32_bf16 v[88:91], v[136:139], v[76:79], v[88:91]
    ds_read_b128 v[120:123], v8 offset:38912
    s_waitcnt lgkmcnt(7)
    v_mfma_f32_16x16x32_bf16 v[92:95], v[140:143], v[76:79], v[92:95]
    ds_read_b128 v[124:127], v8 offset:39936
    s_waitcnt lgkmcnt(7)
    v_mfma_f32_16x16x32_bf16 v[96:99], v[144:147], v[76:79], v[96:99]
    ds_read_b128 v[128:131], v8 offset:40960
    s_waitcnt lgkmcnt(7)
    v_mfma_f32_16x16x32_bf16 v[100:103], v[148:151], v[76:79], v[100:103]
    ds_read_b128 v[132:135], v8 offset:41984
    s_waitcnt lgkmcnt(7)
    v_mfma_f32_16x16x32_bf16 v[104:107], v[152:155], v[76:79], v[104:107]
    s_waitcnt lgkmcnt(6)
    v_mfma_f32_16x16x32_bf16 v[108:111], v[156:159], v[76:79], v[108:111]
    ds_read_b128 v[136:139], v8 offset:43008
    ds_read_b128 v[140:143], v8 offset:44032
    s_waitcnt vmcnt(5) lgkmcnt(7)
    v_mfma_f32_16x16x32_bf16 v[88:91], v[112:115], v[80:83], v[88:91]
    ds_read_b128 v[144:147], v8 offset:45056
    s_waitcnt lgkmcnt(7)
    v_mfma_f32_16x16x32_bf16 v[92:95], v[116:119], v[80:83], v[92:95]
    ds_read_b128 v[148:151], v8 offset:46080
    s_waitcnt lgkmcnt(7)
    v_mfma_f32_16x16x32_bf16 v[96:99], v[120:123], v[80:83], v[96:99]
    ds_read_b128 v[152:155], v8 offset:47104
    s_waitcnt lgkmcnt(7)
    v_mfma_f32_16x16x32_bf16 v[100:103], v[124:127], v[80:83], v[100:103]
    ds_read_b128 v[156:159], v8 offset:48128
    s_waitcnt lgkmcnt(7)
    v_mfma_f32_16x16x32_bf16 v[104:107], v[128:131], v[80:83], v[104:107]
    s_waitcnt lgkmcnt(6)
    v_mfma_f32_16x16x32_bf16 v[108:111], v[132:135], v[80:83], v[108:111]
    s_waitcnt vmcnt(3) lgkmcnt(5)
    v_mfma_f32_16x16x32_bf16 v[88:91], v[136:139], v[84:87], v[88:91]
    s_waitcnt lgkmcnt(4)
    v_mfma_f32_16x16x32_bf16 v[92:95], v[140:143], v[84:87], v[92:95]
    s_waitcnt lgkmcnt(3)
    v_mfma_f32_16x16x32_bf16 v[96:99], v[144:147], v[84:87], v[96:99]
    s_waitcnt lgkmcnt(2)
    v_mfma_f32_16x16x32_bf16 v[100:103], v[148:151], v[84:87], v[100:103]
    s_waitcnt lgkmcnt(1)
    v_mfma_f32_16x16x32_bf16 v[104:107], v[152:155], v[84:87], v[104:107]
    s_waitcnt lgkmcnt(0)
    v_mfma_f32_16x16x32_bf16 v[108:111], v[156:159], v[84:87], v[108:111]
    s_waitcnt vmcnt(2)
    v_lshlrev_b32 v16, 16, v160
    v_and_b32 v17, 0xffff0000, v160
    v_lshlrev_b32 v18, 16, v161
    v_and_b32 v19, 0xffff0000, v161
    v_lshlrev_b32 v20, 16, v162
    v_and_b32 v21, 0xffff0000, v162
    v_lshlrev_b32 v22, 16, v163
    v_and_b32 v23, 0xffff0000, v163
    s_waitcnt vmcnt(1)
    v_lshlrev_b32 v24, 16, v164
    v_and_b32 v25, 0xffff0000, v164
    v_lshlrev_b32 v26, 16, v165
    v_and_b32 v27, 0xffff0000, v165
    v_lshlrev_b32 v28, 16, v166
    v_and_b32 v29, 0xffff0000, v166
    v_lshlrev_b32 v30, 16, v167
    v_and_b32 v31, 0xffff0000, v167
    s_waitcnt vmcnt(0)
    v_lshlrev_b32 v32, 16, v168
    v_and_b32 v33, 0xffff0000, v168
    v_lshlrev_b32 v34, 16, v169
    v_and_b32 v35, 0xffff0000, v169
    v_lshlrev_b32 v36, 16, v170
    v_and_b32 v37, 0xffff0000, v170
    v_lshlrev_b32 v38, 16, v171
    v_and_b32 v39, 0xffff0000, v171
    v_add_f32 v16, v16, v88
    v_add_f32 v17, v17, v89
    v_add_f32 v18, v18, v90
    v_add_f32 v19, v19, v91
    v_add_f32 v20, v20, v92
    v_add_f32 v21, v21, v93
    v_add_f32 v22, v22, v94
    v_add_f32 v23, v23, v95
    v_add_f32 v24, v24, v96
    v_add_f32 v25, v25, v97
    v_add_f32 v26, v26, v98
    v_add_f32 v27, v27, v99
    v_add_f32 v28, v28, v100
    v_add_f32 v29, v29, v101
    v_add_f32 v30, v30, v102
    v_add_f32 v31, v31, v103
    v_add_f32 v32, v32, v104
    v_add_f32 v33, v33, v105
    v_add_f32 v34, v34, v106
    v_add_f32 v35, v35, v107
    v_add_f32 v36, v36, v108
    v_add_f32 v37, v37, v109
    v_add_f32 v38, v38, v110
    v_add_f32 v39, v39, v111
    s_mul_i32 s52, s46, 18
    s_mul_i32 s53, s45, 3
    s_add_u32 s52, s52, s53
    s_lshl_b32 s52, s52, 10
    s_add_u32 s52, s52, 76021760
    v_cvt_pk_bf16_f32 v40, v16, v17
    v_cvt_pk_bf16_f32 v41, v18, v19
    v_cvt_pk_bf16_f32 v42, v20, v21
    v_cvt_pk_bf16_f32 v43, v22, v23
    buffer_store_dwordx4 v[40:43], v2, s[4:7], s52 offen offset:0
    v_cvt_pk_bf16_f32 v44, v24, v25
    v_cvt_pk_bf16_f32 v45, v26, v27
    v_cvt_pk_bf16_f32 v46, v28, v29
    v_cvt_pk_bf16_f32 v47, v30, v31
    buffer_store_dwordx4 v[44:47], v2, s[4:7], s52 offen offset:1024
    v_cvt_pk_bf16_f32 v48, v32, v33
    v_cvt_pk_bf16_f32 v49, v34, v35
    v_cvt_pk_bf16_f32 v50, v36, v37
    v_cvt_pk_bf16_f32 v51, v38, v39
    buffer_store_dwordx4 v[48:51], v2, s[4:7], s52 offen offset:2048
    v_lshlrev_b32 v16, 16, v40
    v_and_b32 v17, 0xffff0000, v40
    v_lshlrev_b32 v18, 16, v41
    v_and_b32 v19, 0xffff0000, v41
    v_lshlrev_b32 v20, 16, v42
    v_and_b32 v21, 0xffff0000, v42
    v_lshlrev_b32 v22, 16, v43
    v_and_b32 v23, 0xffff0000, v43
    v_lshlrev_b32 v24, 16, v44
    v_and_b32 v25, 0xffff0000, v44
    v_lshlrev_b32 v26, 16, v45
    v_and_b32 v27, 0xffff0000, v45
    v_lshlrev_b32 v28, 16, v46
    v_and_b32 v29, 0xffff0000, v46
    v_lshlrev_b32 v30, 16, v47
    v_and_b32 v31, 0xffff0000, v47
    v_lshlrev_b32 v32, 16, v48
    v_and_b32 v33, 0xffff0000, v48
    v_lshlrev_b32 v34, 16, v49
    v_and_b32 v35, 0xffff0000, v49
    v_lshlrev_b32 v36, 16, v50
    v_and_b32 v37, 0xffff0000, v50
    v_lshlrev_b32 v38, 16, v51
    v_and_b32 v39, 0xffff0000, v51
    v_add_f32 v56, v16, v17
    v_add_f32 v58, v18, v19
    v_add_f32 v56, v56, v20
    v_add_f32 v58, v58, v21
    v_add_f32 v56, v56, v22
    v_add_f32 v58, v58, v23
    v_add_f32 v56, v56, v24
    v_add_f32 v58, v58, v25
    v_add_f32 v56, v56, v26
    v_add_f32 v58, v58, v27
    v_add_f32 v56, v56, v28
    v_add_f32 v58, v58, v29
    v_add_f32 v56, v56, v30
    v_add_f32 v58, v58, v31
    v_add_f32 v56, v56, v32
    v_add_f32 v58, v58, v33
    v_add_f32 v56, v56, v34
    v_add_f32 v58, v58, v35
    v_add_f32 v56, v56, v36
    v_add_f32 v58, v58, v37
    v_add_f32 v56, v56, v38
    v_add_f32 v58, v58, v39
    v_add_f32 v56, v56, v58
    v_mov_b32 v58, v56
    s_nop 1
    v_permlane16_swap_b32 v56, v58
    v_add_f32 v56, v56, v58
    v_mov_b32 v58, v56
    s_nop 1
    v_permlane32_swap_b32 v56, v58
    v_add_f32 v56, v56, v58
    v_mul_f32 v59, 0x3c2aaaab, v56
    v_sub_f32 v58, v16, v59
    v_mul_f32 v57, v58, v58
    v_sub_f32 v61, v17, v59
    v_fmac_f32 v57, v61, v61
    v_sub_f32 v60, v18, v59
    v_fmac_f32 v57, v60, v60
    v_sub_f32 v61, v19, v59
    v_fmac_f32 v57, v61, v61
    v_sub_f32 v60, v20, v59
    v_fmac_f32 v57, v60, v60
    v_sub_f32 v61, v21, v59
    v_fmac_f32 v57, v61, v61
    v_sub_f32 v60, v22, v59
    v_fmac_f32 v57, v60, v60
    v_sub_f32 v61, v23, v59
    v_fmac_f32 v57, v61, v61
    v_sub_f32 v60, v24, v59
    v_fmac_f32 v57, v60, v60
    v_sub_f32 v61, v25, v59
    v_fmac_f32 v57, v61, v61
    v_sub_f32 v60, v26, v59
    v_fmac_f32 v57, v60, v60
    v_sub_f32 v61, v27, v59
    v_fmac_f32 v57, v61, v61
    v_sub_f32 v60, v28, v59
    v_fmac_f32 v57, v60, v60
    v_sub_f32 v61, v29, v59
    v_fmac_f32 v57, v61, v61
    v_sub_f32 v60, v30, v59
    v_fmac_f32 v57, v60, v60
    v_sub_f32 v61, v31, v59
    v_fmac_f32 v57, v61, v61
    v_sub_f32 v60, v32, v59
    v_fmac_f32 v57, v60, v60
    v_sub_f32 v61, v33, v59
    v_fmac_f32 v57, v61, v61
    v_sub_f32 v60, v34, v59
    v_fmac_f32 v57, v60, v60
    v_sub_f32 v61, v35, v59
    v_fmac_f32 v57, v61, v61
    v_sub_f32 v60, v36, v59
    v_fmac_f32 v57, v60, v60
    v_sub_f32 v61, v37, v59
    v_fmac_f32 v57, v61, v61
    v_sub_f32 v60, v38, v59
    v_fmac_f32 v57, v60, v60
    v_sub_f32 v61, v39, v59
    v_fmac_f32 v57, v61, v61
    v_mov_b32 v58, v57
    s_nop 1
    v_permlane16_swap_b32 v57, v58
    v_add_f32 v57, v57, v58
    v_mov_b32 v58, v57
    s_nop 1
    v_permlane32_swap_b32 v57, v58
    v_add_f32 v57, v57, v58
    s_lshl_b32 s52, s45, 14
    s_add_u32 s52, s52, 78381056
    s_mov_b32 exec_lo, 0xffff
    s_mov_b32 exec_hi, 0
    buffer_store_dwordx2 v[56:57], v7, s[4:7], s52 offen
    s_mov_b64 exec, -1
    s_waitcnt vmcnt(0) lgkmcnt(0)
wo1_kernel_end:
    s_endpgm
.section .rodata,"a"
.p2align 6
.amdhsa_kernel wo1_kernel
  .amdhsa_next_free_vgpr 176
  .amdhsa_next_free_sgpr 102
  .amdhsa_accum_offset 176
  .amdhsa_group_segment_fixed_size 0
  .amdhsa_kernarg_size 80
  .amdhsa_user_sgpr_count 2
  .amdhsa_user_sgpr_kernarg_segment_ptr 1
  .amdhsa_system_sgpr_workgroup_id_x 1
  .amdhsa_float_denorm_mode_32 3
.end_amdhsa_kernel
.text
.globl ffn1_kernel
.p2align 8
.type ffn1_kernel,@function
ffn1_kernel:
    s_cmp_ge_u32 s2, 256
    s_cbranch_scc1 ffn1_kernel_end
    s_load_dwordx16 s[24:39], s[0:1], 0
    s_load_dwordx4 s[40:43], s[0:1], 64
    v_lshrrev_b32 v1, 6, v0
    s_and_b32 s21, s2, 7
    v_readfirstlane_b32 s20, v1
    s_lshr_b32 s22, s2, 3
    v_and_b32 v1, 63, v0
    v_lshlrev_b32 v2, 4, v1
    v_lshlrev_b32 v3, 7, v0
    s_getpc_b64 s[16:17]
L_pc_45:
    v_min_u32 v4, ffn1_kernel_end-L_pc_45, v3
    global_load_dword v4, v4, s[16:17]
    s_waitcnt lgkmcnt(0)
    s_mov_b32 s4, s42
    s_mov_b32 s5, s43
    s_mov_b32 s6, 0x10000000
    s_mov_b32 s7, 0x20000
    s_lshr_b32 s44, s22, 4
    s_and_b32 s60, s21, 6
    s_add_u32 s44, s44, s60
    s_and_b32 s60, s21, 1
    s_lshl_b32 s60, s60, 4
    s_and_b32 s47, s22, 15
    s_add_u32 s47, s47, s60
    s_lshr_b32 s45, s47, 2
    s_and_b32 s46, s47, 3
    s_mul_i32 s48, s47, 497664
    s_add_u32 s48, s48, 4194304
    s_mul_i32 s63, s20, 9
    s_lshr_b32 s63, s63, 1
    s_lshl_b32 s63, s63, 10
    s_add_u32 s62, s48, s63
    s_mul_i32 s49, s20, 9216
    s_add_u32 s48, s48, s49
    s_lshl_b32 s54, s44, 4
    s_lshl_b32 s60, s20, 2
    s_add_u32 s54, s54, s60
    s_mul_i32 s50, s54, 18432
    s_mul_i32 s53, s45, 2359296
    s_add_u32 s53, s53, s50
    s_add_u32 s50, s50, 76021760
    s_lshr_b32 s60, s46, 1
    s_mul_i32 s60, s60, 9216
    s_add_u32 s53, s53, s60
    s_add_u32 s53, s53, 100663296
    v_lshlrev_b32 v3, 3, v1
    s_waitcnt vmcnt(0)
    v_mov_b32 v4, v2
    s_and_b32 s60, s20, 1
    s_lshl_b32 s60, s60, 10
    s_add_u32 m0, s60, 147456
    s_mul_i32 s61, s47, 1152
    s_add_u32 s61, s61, s60
    s_add_u32 s61, s61, 3670016
    buffer_load_dwordx4 v2, s[4:7], s61 offen lds
    s_add_u32 m0, s49, 0
    s_add_u32 s61, s48, 0
    buffer_load_dwordx4 v2, s[4:7], s61 offen offset:0 lds
    buffer_load_dwordx4 v2, s[4:7], s61 offen offset:1024 lds
    buffer_load_dwordx4 v2, s[4:7], s61 offen offset:2048 lds
    buffer_load_dwordx4 v2, s[4:7], s61 offen offset:3072 lds
    s_add_u32 m0, s49, 4096
    s_add_u32 s61, s48, 4096
    buffer_load_dwordx4 v2, s[4:7], s61 offen offset:0 lds
    buffer_load_dwordx4 v2, s[4:7], s61 offen offset:1024 lds
    buffer_load_dwordx4 v2, s[4:7], s61 offen offset:2048 lds
    buffer_load_dwordx4 v2, s[4:7], s61 offen offset:3072 lds
    s_add_u32 m0, s49, 8192
    s_add_u32 s61, s48, 8192
    buffer_load_dwordx4 v2, s[4:7], s61 offen offset:0 lds
    s_add_u32 m0, s49, 36864
    s_add_u32 s61, s48, 36864
    buffer_load_dwordx4 v2, s[4:7], s61 offen offset:0 lds
    buffer_load_dwordx4 v2, s[4:7], s61 offen offset:1024 lds
    buffer_load_dwordx4 v2, s[4:7], s61 offen offset:2048 lds
    buffer_load_dwordx4 v2, s[4:7], s61 offen offset:3072 lds
    s_add_u32 m0, s49, 40960
    s_add_u32 s61, s48, 40960
    buffer_load_dwordx4 v2, s[4:7], s61 offen offset:0 lds
    buffer_load_dwordx4 v2, s[4:7], s61 offen offset:1024 lds
    buffer_load_dwordx4 v2, s[4:7], s61 offen offset:2048 lds
    buffer_load_dwordx4 v2, s[4:7], s61 offen offset:3072 lds
    s_add_u32 m0, s49, 45056
    s_add_u32 s61, s48, 45056
    buffer_load_dwordx4 v2, s[4:7], s61 offen offset:0 lds
    s_add_u32 s60, s50, 0
    buffer_load_dwordx4 a[0:3], v2, s[4:7], s60 offen offset:0
    buffer_load_dwordx4 a[16:19], v2, s[4:7], s60 offen offset:1024
    buffer_load_dwordx4 a[32:35], v2, s[4:7], s60 offen offset:2048
    buffer_load_dwordx4 a[48:51], v2, s[4:7], s60 offen offset:3072
    s_add_u32 s60, s50, 18432
    buffer_load_dwordx4 a[4:7], v2, s[4:7], s60 offen offset:0
    buffer_load_dwordx4 a[20:23], v2, s[4:7], s60 offen offset:1024
    buffer_load_dwordx4 a[36:39], v2, s[4:7], s60 offen offset:2048
    buffer_load_dwordx4 a[52:55], v2, s[4:7], s60 offen offset:3072
    s_add_u32 s60, s50, 36864
    buffer_load_dwordx4 a[8:11], v2, s[4:7], s60 offen offset:0
    buffer_load_dwordx4 a[24:27], v2, s[4:7], s60 offen offset:1024
    buffer_load_dwordx4 a[40:43], v2, s[4:7], s60 offen offset:2048
    buffer_load_dwordx4 a[56:59], v2, s[4:7], s60 offen offset:3072
    s_add_u32 s60, s50, 55296
    buffer_load_dwordx4 a[12:15], v2, s[4:7], s60 offen offset:0
    buffer_load_dwordx4 a[28:31], v2, s[4:7], s60 offen offset:1024
    buffer_load_dwordx4 a[44:47], v2, s[4:7], s60 offen offset:2048
    buffer_load_dwordx4 a[60:63], v2, s[4:7], s60 offen offset:3072
    s_add_u32 s60, s50, 4096
    buffer_load_dwordx4 a[64:67], v2, s[4:7], s60 offen offset:0
    buffer_load_dwordx4 a[80:83], v2, s[4:7], s60 offen offset:1024
    buffer_load_dwordx4 a[96:99], v2, s[4:7], s60 offen offset:2048
    buffer_load_dwordx4 a[112:115], v2, s[4:7], s60 offen offset:3072
    s_add_u32 s60, s50, 22528
    buffer_load_dwordx4 a[68:71], v2, s[4:7], s60 offen offset:0
    buffer_load_dwordx4 a[84:87], v2, s[4:7], s60 offen offset:1024
    buffer_load_dwordx4 a[100:103], v2, s[4:7], s60 offen offset:2048
    buffer_load_dwordx4 a[116:119], v2, s[4:7], s60 offen offset:3072
    s_add_u32 s60, s50, 40960
    buffer_load_dwordx4 a[72:75], v2, s[4:7], s60 offen offset:0
    buffer_load_dwordx4 a[88:91], v2, s[4:7], s60 offen offset:1024
    buffer_load_dwordx4 a[104:107], v2, s[4:7], s60 offen offset:2048
    buffer_load_dwordx4 a[120:123], v2, s[4:7], s60 offen offset:3072
    s_add_u32 s60, s50, 59392
    buffer_load_dwordx4 a[76:79], v2, s[4:7], s60 offen offset:0
    buffer_load_dwordx4 a[92:95], v2, s[4:7], s60 offen offset:1024
    buffer_load_dwordx4 a[108:111], v2, s[4:7], s60 offen offset:2048
    buffer_load_dwordx4 a[124:127], v2, s[4:7], s60 offen offset:3072
    s_lshl_b32 s60, s44, 5
    s_add_u32 s60, s60, s47
    s_mul_i32 s51, s60, 73728
    s_add_u32 s51, s51, 81002496
    s_xor_b32 s61, s60, 1
    s_mul_i32 s56, s61, 73728
    s_add_u32 s56, s56, 81002496
    s_xor_b32 s61, s60, 2
    s_mul_i32 s57, s61, 73728
    s_add_u32 s57, s57, 81002496
    s_xor_b32 s61, s60, 3
    s_mul_i32 s58, s61, 73728
    s_add_u32 s58, s58, 81002496
    s_lshr_b32 s52, s60, 2
    s_lshl_b32 s52, s52, 2
    s_add_u32 s52, s52, s20
    s_lshl_b32 s52, s52, 7
    s_add_u32 s52, s52, 3997696
    v_lshrrev_b32 v5, 4, v1
    v_lshlrev_b32 v5, 4, v5
    v_add_u32 v5, 147456, v5
    s_lshl_b32 s60, s54, 4
    v_add_u32 v6, s60, v1
    v_lshlrev_b32 v6, 3, v6
    s_lshl_b32 s60, s20, 12
    s_add_u32 s51, s51, s60
    s_add_u32 s56, s56, s60
    s_add_u32 s57, s57, s60
    s_add_u32 s58, s58, s60
    s_lshl_b32 s65, s20, 11
    s_sub_u32 s65, 65536, s65
    s_lshl_b32 s67, s46, 2
    s_add_u32 s67, s67, s52
    v_add_u32 v7, 0x10000, v2
    s_waitcnt vmcnt(32)
    s_barrier
    ds_read_b128 v[8:11], v4 offset:0
    ds_read_b128 v[12:15], v4 offset:1024
    ds_read_b128 v[16:19], v4 offset:36864
    ds_read_b128 v[20:23], v4 offset:37888
    s_add_u32 s60, s50, 8192
    buffer_load_dwordx4 a[128:131], v2, s[4:7], s60 offen offset:0
    s_waitcnt vmcnt(32) lgkmcnt(3)
    v_mfma_f32_16x16x32_bf16 v[208:211], v[8:11], a[0:3], 0
    ds_read_b128 v[24:27], v4 offset:2048
    s_waitcnt vmcnt(28)
    v_mfma_f32_16x16x32_bf16 v[212:215], v[8:11], a[4:7], 0
    s_waitcnt vmcnt(24)
    v_mfma_f32_16x16x32_bf16 v[216:219], v[8:11], a[8:11], 0
    s_waitcnt vmcnt(20)
    v_mfma_f32_16x16x32_bf16 v[220:223], v[8:11], a[12:15], 0
    buffer_load_dwordx4 a[144:147], v2, s[4:7], s60 offen offset:1024
    s_waitcnt lgkmcnt(3)
    v_mfma_f32_16x16x32_bf16 v[224:227], v[12:15], a[0:3], 0
    ds_read_b128 v[28:31], v4 offset:3072
    v_mfma_f32_16x16x32_bf16 v[228:231], v[12:15], a[4:7], 0
    v_mfma_f32_16x16x32_bf16 v[232:235], v[12:15], a[8:11], 0
    v_mfma_f32_16x16x32_bf16 v[236:239], v[12:15], a[12:15], 0
    buffer_load_dwordx4 a[160:163], v2, s[4:7], s60 offen offset:2048
    s_waitcnt lgkmcnt(3)
    v_mfma_f32_16x16x32_bf16 v[64:67], v[16:19], a[0:3], 0
    ds_read_b128 v[8:11], v4 offset:38912
    v_mfma_f32_16x16x32_bf16 v[68:71], v[16:19], a[4:7], 0
    v_mfma_f32_16x16x32_bf16 v[72:75], v[16:19], a[8:11], 0
    v_mfma_f32_16x16x32_bf16 v[76:79], v[16:19], a[12:15], 0
    buffer_load_dwordx4 a[176:179], v2, s[4:7], s60 offen offset:3072
    s_add_u32 s60, s50, 26624
    s_waitcnt lgkmcnt(3)
    v_mfma_f32_16x16x32_bf16 v[80:83], v[20:23], a[0:3], 0
    ds_read_b128 v[12:15], v4 offset:39936
    v_mfma_f32_16x16x32_bf16 v[84:87], v[20:23], a[4:7], 0
    v_mfma_f32_16x16x32_bf16 v[88:91], v[20:23], a[8:11], 0
    v_mfma_f32_16x16x32_bf16 v[92:95], v[20:23], a[12:15], 0
    buffer_load_dwordx4 a[132:135], v2, s[4:7], s60 offen offset:0
    s_waitcnt lgkmcnt(3)
    v_mfma_f32_16x16x32_bf16 v[208:211], v[24:27], a[16:19], v[208:211]
    ds_read_b128 v[16:19], v4 offset:4096
    v_mfma_f32_16x16x32_bf16 v[212:215], v[24:27], a[20:23], v[212:215]
    v_mfma_f32_16x16x32_bf16 v[216:219], v[24:27], a[24:27], v[216:219]
    s_waitcnt vmcnt(23)
    v_mfma_f32_16x16x32_bf16 v[220:223], v[24:27], a[28:31], v[220:223]
    buffer_load_dwordx4 a[148:151], v2, s[4:7], s60 offen offset:1024
    s_waitcnt lgkmcnt(3)
    v_mfma_f32_16x16x32_bf16 v[224:227], v[28:31], a[16:19], v[224:227]
    ds_read_b128 v[20:23], v4 offset:5120
    v_mfma_f32_16x16x32_bf16 v[228:231], v[28:31], a[20:23], v[228:231]
    v_mfma_f32_16x16x32_bf16 v[232:235], v[28:31], a[24:27], v[232:235]
    v_mfma_f32_16x16x32_bf16 v[236:239], v[28:31], a[28:31], v[236:239]
    buffer_load_dwordx4 a[164:167], v2, s[4:7], s60 offen offset:2048
    s_waitcnt lgkmcnt(3)
    v_mfma_f32_16x16x32_bf16 v[64:67], v[8:11], a[16:19], v[64:67]
    ds_read_b128 v[24:27], v4 offset:40960
    v_mfma_f32_16x16x32_bf16 v[68:71], v[8:11], a[20:23], v[68:71]
    v_mfma_f32_16x16x32_bf16 v[72:75], v[8:11], a[24:27], v[72:75]
    v_mfma_f32_16x16x32_bf16 v[76:79], v[8:11], a[28:31], v[76:79]
    buffer_load_dwordx4 a[180:183], v2, s[4:7], s60 offen offset:3072
    s_add_u32 s60, s50, 45056
    s_waitcnt lgkmcnt(3)
    v_mfma_f32_16x16x32_bf16 v[80:83], v[12:15], a[16:19], v[80:83]
    ds_read_b128 v[28:31], v4 offset:41984
    v_mfma_f32_16x16x32_bf16 v[84:87], v[12:15], a[20:23], v[84:87]
    v_mfma_f32_16x16x32_bf16 v[88:91], v[12:15], a[24:27], v[88:91]
    v_mfma_f32_16x16x32_bf16 v[92:95], v[12:15], a[28:31], v[92:95]
    buffer_load_dwordx4 a[136:139], v2, s[4:7], s60 offen offset:0
    s_waitcnt lgkmcnt(3)
    v_mfma_f32_16x16x32_bf16 v[208:211], v[16:19], a[32:35], v[208:211]
    ds_read_b128 v[8:11], v4 offset:6144
    v_mfma_f32_16x16x32_bf16 v[212:215], v[16:19], a[36:39], v[212:215]
    v_mfma_f32_16x16x32_bf16 v[216:219], v[16:19], a[40:43], v[216:219]
    s_waitcnt vmcnt(26)
    v_mfma_f32_16x16x32_bf16 v[220:223], v[16:19], a[44:47], v[220:223]
    buffer_load_dwordx4 a[152:155], v2, s[4:7], s60 offen offset:1024
    s_waitcnt lgkmcnt(3)
    v_mfma_f32_16x16x32_bf16 v[224:227], v[20:23], a[32:35], v[224:227]
    ds_read_b128 v[12:15], v4 offset:7168
    v_mfma_f32_16x16x32_bf16 v[228:231], v[20:23], a[36:39], v[228:231]
    v_mfma_f32_16x16x32_bf16 v[232:235], v[20:23], a[40:43], v[232:235]
    v_mfma_f32_16x16x32_bf16 v[236:239], v[20:23], a[44:47], v[236:239]
    buffer_load_dwordx4 a[168:171], v2, s[4:7], s60 offen offset:2048
    s_waitcnt lgkmcnt(3)
    v_mfma_f32_16x16x32_bf16 v[64:67], v[24:27], a[32:35], v[64:67]
    ds_read_b128 v[16:19], v4 offset:43008
    v_mfma_f32_16x16x32_bf16 v[68:71], v[24:27], a[36:39], v[68:71]
    v_mfma_f32_16x16x32_bf16 v[72:75], v[24:27], a[40:43], v[72:75]
    v_mfma_f32_16x16x32_bf16 v[76:79], v[24:27], a[44:47], v[76:79]
    buffer_load_dwordx4 a[184:187], v2, s[4:7], s60 offen offset:3072
    s_add_u32 s60, s50, 63488
    s_waitcnt lgkmcnt(3)
    v_mfma_f32_16x16x32_bf16 v[80:83], v[28:31], a[32:35], v[80:83]
    ds_read_b128 v[20:23], v4 offset:44032
    v_mfma_f32_16x16x32_bf16 v[84:87], v[28:31], a[36:39], v[84:87]
    v_mfma_f32_16x16x32_bf16 v[88:91], v[28:31], a[40:43], v[88:91]
    v_mfma_f32_16x16x32_bf16 v[92:95], v[28:31], a[44:47], v[92:95]
    buffer_load_dwordx4 a[140:143], v2, s[4:7], s60 offen offset:0
    s_waitcnt lgkmcnt(3)
    v_mfma_f32_16x16x32_bf16 v[208:211], v[8:11], a[48:51], v[208:211]
    ds_read_b128 v[24:27], v4 offset:8192
    v_mfma_f32_16x16x32_bf16 v[212:215], v[8:11], a[52:55], v[212:215]
    v_mfma_f32_16x16x32_bf16 v[216:219], v[8:11], a[56:59], v[216:219]
    s_waitcnt vmcnt(29)
    v_mfma_f32_16x16x32_bf16 v[220:223], v[8:11], a[60:63], v[220:223]
    buffer_load_dwordx4 a[156:159], v2, s[4:7], s60 offen offset:1024
    s_waitcnt lgkmcnt(3)
    v_mfma_f32_16x16x32_bf16 v[224:227], v[12:15], a[48:51], v[224:227]
    ds_read_b128 v[28:31], v4 offset:9216
    v_mfma_f32_16x16x32_bf16 v[228:231], v[12:15], a[52:55], v[228:231]
    v_mfma_f32_16x16x32_bf16 v[232:235], v[12:15], a[56:59], v[232:235]
    v_mfma_f32_16x16x32_bf16 v[236:239], v[12:15], a[60:63], v[236:239]
    buffer_load_dwordx4 a[172:175], v2, s[4:7], s60 offen offset:2048
    s_waitcnt lgkmcnt(3)
    v_mfma_f32_16x16x32_bf16 v[64:67], v[16:19], a[48:51], v[64:67]
    ds_read_b128 v[8:11], v4 offset:45056
    v_mfma_f32_16x16x32_bf16 v[68:71], v[16:19], a[52:55], v[68:71]
    v_mfma_f32_16x16x32_bf16 v[72:75], v[16:19], a[56:59], v[72:75]
    v_mfma_f32_16x16x32_bf16 v[76:79], v[16:19], a[60:63], v[76:79]
    buffer_load_dwordx4 a[188:191], v2, s[4:7], s60 offen offset:3072
    s_add_u32 s60, s50, 12288
    s_waitcnt lgkmcnt(3)
    v_mfma_f32_16x16x32_bf16 v[80:83], v[20:23], a[48:51], v[80:83]
    ds_read_b128 v[12:15], v4 offset:46080
    v_mfma_f32_16x16x32_bf16 v[84:87], v[20:23], a[52:55], v[84:87]
    v_mfma_f32_16x16x32_bf16 v[88:91], v[20:23], a[56:59], v[88:91]
    v_mfma_f32_16x16x32_bf16 v[92:95], v[20:23], a[60:63], v[92:95]
    buffer_load_dwordx4 a[192:195], v2, s[4:7], s60 offen offset:0
    s_waitcnt vmcnt(32) lgkmcnt(3)
    v_mfma_f32_16x16x32_bf16 v[208:211], v[24:27], a[64:67], v[208:211]
    ds_read_b128 v[16:19], v4 offset:10240
    s_waitcnt vmcnt(28)
    v_mfma_f32_16x16x32_bf16 v[212:215], v[24:27], a[68:71], v[212:215]
    s_waitcnt vmcnt(24)
    v_mfma_f32_16x16x32_bf16 v[216:219], v[24:27], a[72:75], v[216:219]
    s_waitcnt vmcnt(20)
    v_mfma_f32_16x16x32_bf16 v[220:223], v[24:27], a[76:79], v[220:223]
    buffer_load_dwordx4 a[208:211], v2, s[4:7], s60 offen offset:1024
    s_waitcnt lgkmcnt(3)
    v_mfma_f32_16x16x32_bf16 v[224:227], v[28:31], a[64:67], v[224:227]
    ds_read_b128 v[20:23], v4 offset:11264
    v_mfma_f32_16x16x32_bf16 v[228:231], v[28:31], a[68:71], v[228:231]
    v_mfma_f32_16x16x32_bf16 v[232:235], v[28:31], a[72:75], v[232:235]
    v_mfma_f32_16x16x32_bf16 v[236:239], v[28:31], a[76:79], v[236:239]
    buffer_load_dwordx4 a[224:227], v2, s[4:7], s60 offen offset:2048
    s_waitcnt lgkmcnt(3)
    v_mfma_f32_16x16x32_bf16 v[64:67], v[8:11], a[64:67], v[64:67]
    ds_read_b128 v[24:27], v4 offset:47104
    v_mfma_f32_16x16x32_bf16 v[68:71], v[8:11], a[68:71], v[68:71]
    v_mfma_f32_16x16x32_bf16 v[72:75], v[8:11], a[72:75], v[72:75]
    v_mfma_f32_16x16x32_bf16 v[76:79], v[8:11], a[76:79], v[76:79]
    buffer_load_dwordx4 a[240:243], v2, s[4:7], s60 offen offset:3072
    s_add_u32 s60, s50, 30720
    s_waitcnt lgkmcnt(3)
    v_mfma_f32_16x16x32_bf16 v[80:83], v[12:15], a[64:67], v[80:83]
    ds_read_b128 v[28:31], v4 offset:48128
    v_mfma_f32_16x16x32_bf16 v[84:87], v[12:15], a[68:71], v[84:87]
    v_mfma_f32_16x16x32_bf16 v[88:91], v[12:15], a[72:75], v[88:91]
    v_mfma_f32_16x16x32_bf16 v[92:95], v[12:15], a[76:79], v[92:95]
    buffer_load_dwordx4 a[196:199], v2, s[4:7], s60 offen offset:0
    s_waitcnt lgkmcnt(3)
    v_mfma_f32_16x16x32_bf16 v[208:211], v[16:19], a[80:83], v[208:211]
    ds_read_b128 v[8:11], v4 offset:12288
    v_mfma_f32_16x16x32_bf16 v[212:215], v[16:19], a[84:87], v[212:215]
    v_mfma_f32_16x16x32_bf16 v[216:219], v[16:19], a[88:91], v[216:219]
    s_waitcnt vmcnt(23)
    v_mfma_f32_16x16x32_bf16 v[220:223], v[16:19], a[92:95], v[220:223]
    buffer_load_dwordx4 a[212:215], v2, s[4:7], s60 offen offset:1024
    s_waitcnt lgkmcnt(3)
    v_mfma_f32_16x16x32_bf16 v[224:227], v[20:23], a[80:83], v[224:227]
    ds_read_b128 v[12:15], v4 offset:13312
    v_mfma_f32_16x16x32_bf16 v[228:231], v[20:23], a[84:87], v[228:231]
    v_mfma_f32_16x16x32_bf16 v[232:235], v[20:23], a[88:91], v[232:235]
    v_mfma_f32_16x16x32_bf16 v[236:239], v[20:23], a[92:95], v[236:239]
    buffer_load_dwordx4 a[228:231], v2, s[4:7], s60 offen offset:2048
    s_waitcnt lgkmcnt(3)
    v_mfma_f32_16x16x32_bf16 v[64:67], v[24:27], a[80:83], v[64:67]
    ds_read_b128 v[16:19], v4 offset:49152
    v_mfma_f32_16x16x32_bf16 v[68:71], v[24:27], a[84:87], v[68:71]
    v_mfma_f32_16x16x32_bf16 v[72:75], v[24:27], a[88:91], v[72:75]
    v_mfma_f32_16x16x32_bf16 v[76:79], v[24:27], a[92:95], v[76:79]
    buffer_load_dwordx4 a[244:247], v2, s[4:7], s60 offen offset:3072
    s_add_u32 s60, s50, 49152
    s_waitcnt lgkmcnt(3)
    v_mfma_f32_16x16x32_bf16 v[80:83], v[28:31], a[80:83], v[80:83]
    ds_read_b128 v[20:23], v4 offset:50176
    v_mfma_f32_16x16x32_bf16 v[84:87], v[28:31], a[84:87], v[84:87]
    v_mfma_f32_16x16x32_bf16 v[88:91], v[28:31], a[88:91], v[88:91]
    v_mfma_f32_16x16x32_bf16 v[92:95], v[28:31], a[92:95], v[92:95]
    buffer_load_dwordx4 a[200:203], v2, s[4:7], s60 offen offset:0
    s_waitcnt lgkmcnt(3)
    v_mfma_f32_16x16x32_bf16 v[208:211], v[8:11], a[96:99], v[208:211]
    ds_read_b128 v[24:27], v4 offset:14336
    v_mfma_f32_16x16x32_bf16 v[212:215], v[8:11], a[100:103], v[212:215]
    v_mfma_f32_16x16x32_bf16 v[216:219], v[8:11], a[104:107], v[216:219]
    s_waitcnt vmcnt(26)
    v_mfma_f32_16x16x32_bf16 v[220:223], v[8:11], a[108:111], v[220:223]
    buffer_load_dwordx4 a[216:219], v2, s[4:7], s60 offen offset:1024
    s_waitcnt lgkmcnt(3)
    v_mfma_f32_16x16x32_bf16 v[224:227], v[12:15], a[96:99], v[224:227]
    ds_read_b128 v[28:31], v4 offset:15360
    v_mfma_f32_16x16x32_bf16 v[228:231], v[12:15], a[100:103], v[228:231]
    v_mfma_f32_16x16x32_bf16 v[232:235], v[12:15], a[104:107], v[232:235]
    v_mfma_f32_16x16x32_bf16 v[236:239], v[12:15], a[108:111], v[236:239]
    buffer_load_dwordx4 a[232:235], v2, s[4:7], s60 offen offset:2048
    s_waitcnt lgkmcnt(3)
    v_mfma_f32_16x16x32_bf16 v[64:67], v[16:19], a[96:99], v[64:67]
    ds_read_b128 v[8:11], v4 offset:51200
    v_mfma_f32_16x16x32_bf16 v[68:71], v[16:19], a[100:103], v[68:71]
    v_mfma_f32_16x16x32_bf16 v[72:75], v[16:19], a[104:107], v[72:75]
    v_mfma_f32_16x16x32_bf16 v[76:79], v[16:19], a[108:111], v[76:79]
    buffer_load_dwordx4 a[248:251], v2, s[4:7], s60 offen offset:3072
    s_add_u32 s60, s50, 67584
    s_waitcnt lgkmcnt(3)
    v_mfma_f32_16x16x32_bf16 v[80:83], v[20:23], a[96:99], v[80:83]
    ds_read_b128 v[12:15], v4 offset:52224
    v_mfma_f32_16x16x32_bf16 v[84:87], v[20:23], a[100:103], v[84:87]
    v_mfma_f32_16x16x32_bf16 v[88:91], v[20:23], a[104:107], v[88:91]
    v_mfma_f32_16x16x32_bf16 v[92:95], v[20:23], a[108:111], v[92:95]
    buffer_load_dwordx4 a[204:207], v2, s[4:7], s60 offen offset:0
    s_waitcnt lgkmcnt(3)
    v_mfma_f32_16x16x32_bf16 v[208:211], v[24:27], a[112:115], v[208:211]
    ds_read_b128 v[16:19], v4 offset:16384
    v_mfma_f32_16x16x32_bf16 v[212:215], v[24:27], a[116:119], v[212:215]
    v_mfma_f32_16x16x32_bf16 v[216:219], v[24:27], a[120:123], v[216:219]
    s_waitcnt vmcnt(29)
    v_mfma_f32_16x16x32_bf16 v[220:223], v[24:27], a[124:127], v[220:223]
    buffer_load_dwordx4 a[220:223], v2, s[4:7], s60 offen offset:1024
    s_waitcnt lgkmcnt(3)
    v_mfma_f32_16x16x32_bf16 v[224:227], v[28:31], a[112:115], v[224:227]
    ds_read_b128 v[20:23], v4 offset:17408
    v_mfma_f32_16x16x32_bf16 v[228:231], v[28:31], a[116:119], v[228:231]
    v_mfma_f32_16x16x32_bf16 v[232:235], v[28:31], a[120:123], v[232:235]
    v_mfma_f32_16x16x32_bf16 v[236:239], v[28:31], a[124:127], v[236:239]
    buffer_load_dwordx4 a[236:239], v2, s[4:7], s60 offen offset:2048
    s_waitcnt lgkmcnt(3)
    v_mfma_f32_16x16x32_bf16 v[64:67], v[8:11], a[112:115], v[64:67]
    ds_read_b128 v[24:27], v4 offset:53248
    v_mfma_f32_16x16x32_bf16 v[68:71], v[8:11], a[116:119], v[68:71]
    v_mfma_f32_16x16x32_bf16 v[72:75], v[8:11], a[120:123], v[72:75]
    v_mfma_f32_16x16x32_bf16 v[76:79], v[8:11], a[124:127], v[76:79]
    buffer_load_dwordx4 a[252:255], v2, s[4:7], s60 offen offset:3072
    s_add_u32 s60, s50, 16384
    s_waitcnt lgkmcnt(3)
    v_mfma_f32_16x16x32_bf16 v[80:83], v[12:15], a[112:115], v[80:83]
    ds_read_b128 v[28:31], v4 offset:54272
    v_mfma_f32_16x16x32_bf16 v[84:87], v[12:15], a[116:119], v[84:87]
    v_mfma_f32_16x16x32_bf16 v[88:91], v[12:15], a[120:123], v[88:91]
    v_mfma_f32_16x16x32_bf16 v[92:95], v[12:15], a[124:127], v[92:95]
    buffer_load_dwordx4 v[32:35], v2, s[4:7], s60 offen offset:0
    s_waitcnt vmcnt(32) lgkmcnt(3)
    v_mfma_f32_16x16x32_bf16 v[208:211], v[16:19], a[128:131], v[208:211]
    ds_read_b128 v[8:11], v4 offset:18432
    s_waitcnt vmcnt(28)
    v_mfma_f32_16x16x32_bf16 v[212:215], v[16:19], a[132:135], v[212:215]
    s_waitcnt vmcnt(24)
    v_mfma_f32_16x16x32_bf16 v[216:219], v[16:19], a[136:139], v[216:219]
    s_waitcnt vmcnt(20)
    v_mfma_f32_16x16x32_bf16 v[220:223], v[16:19], a[140:143], v[220:223]
    buffer_load_dwordx4 v[48:51], v2, s[4:7], s60 offen offset:1024
    s_add_u32 s60, s50, 34816
    s_waitcnt lgkmcnt(3)
    v_mfma_f32_16x16x32_bf16 v[224:227], v[20:23], a[128:131], v[224:227]
    ds_read_b128 v[12:15], v4 offset:19456
    v_mfma_f32_16x16x32_bf16 v[228:231], v[20:23], a[132:135], v[228:231]
    v_mfma_f32_16x16x32_bf16 v[232:235], v[20:23], a[136:139], v[232:235]
    v_mfma_f32_16x16x32_bf16 v[236:239], v[20:23], a[140:143], v[236:239]
    buffer_load_dwordx4 v[36:39], v2, s[4:7], s60 offen offset:0
    s_waitcnt lgkmcnt(3)
    v_mfma_f32_16x16x32_bf16 v[64:67], v[24:27], a[128:131], v[64:67]
    ds_read_b128 v[16:19], v4 offset:55296
    v_mfma_f32_16x16x32_bf16 v[68:71], v[24:27], a[132:135], v[68:71]
    v_mfma_f32_16x16x32_bf16 v[72:75], v[24:27], a[136:139], v[72:75]
    v_mfma_f32_16x16x32_bf16 v[76:79], v[24:27], a[140:143], v[76:79]
    buffer_load_dwordx4 v[52:55], v2, s[4:7], s60 offen offset:1024
    s_add_u32 s60, s50, 53248
    s_waitcnt lgkmcnt(3)
    v_mfma_f32_16x16x32_bf16 v[80:83], v[28:31], a[128:131], v[80:83]
    ds_read_b128 v[20:23], v4 offset:56320
    v_mfma_f32_16x16x32_bf16 v[84:87], v[28:31], a[132:135], v[84:87]
    v_mfma_f32_16x16x32_bf16 v[88:91], v[28:31], a[136:139], v[88:91]
    v_mfma_f32_16x16x32_bf16 v[92:95], v[28:31], a[140:143], v[92:95]
    buffer_load_dwordx4 v[40:43], v2, s[4:7], s60 offen offset:0
    s_waitcnt lgkmcnt(3)
    v_mfma_f32_16x16x32_bf16 v[208:211], v[8:11], a[144:147], v[208:211]
    ds_read_b128 v[24:27], v4 offset:20480
    v_mfma_f32_16x16x32_bf16 v[212:215], v[8:11], a[148:151], v[212:215]
    v_mfma_f32_16x16x32_bf16 v[216:219], v[8:11], a[152:155], v[216:219]
    s_waitcnt vmcnt(23)
    v_mfma_f32_16x16x32_bf16 v[220:223], v[8:11], a[156:159], v[220:223]
    buffer_load_dwordx4 v[56:59], v2, s[4:7], s60 offen offset:1024
    s_add_u32 s60, s50, 71680
    s_waitcnt lgkmcnt(3)
    v_mfma_f32_16x16x32_bf16 v[224:227], v[12:15], a[144:147], v[224:227]
    ds_read_b128 v[28:31], v4 offset:21504
    v_mfma_f32_16x16x32_bf16 v[228:231], v[12:15], a[148:151], v[228:231]
    v_mfma_f32_16x16x32_bf16 v[232:235], v[12:15], a[152:155], v[232:235]
    v_mfma_f32_16x16x32_bf16 v[236:239], v[12:15], a[156:159], v[236:239]
    buffer_load_dwordx4 v[44:47], v2, s[4:7], s60 offen offset:0
    s_waitcnt lgkmcnt(3)
    v_mfma_f32_16x16x32_bf16 v[64:67], v[16:19], a[144:147], v[64:67]
    ds_read_b128 v[8:11], v4 offset:57344
    v_mfma_f32_16x16x32_bf16 v[68:71], v[16:19], a[148:151], v[68:71]
    v_mfma_f32_16x16x32_bf16 v[72:75], v[16:19], a[152:155], v[72:75]
    v_mfma_f32_16x16x32_bf16 v[76:79], v[16:19], a[156:159], v[76:79]
    buffer_load_dwordx4 v[60:63], v2, s[4:7], s60 offen offset:1024
    s_mov_b32 s60, 78381056
    s_waitcnt lgkmcnt(3)
    v_mfma_f32_16x16x32_bf16 v[80:83], v[20:23], a[144:147], v[80:83]
    ds_read_b128 v[12:15], v4 offset:58368
    v_mfma_f32_16x16x32_bf16 v[84:87], v[20:23], a[148:151], v[84:87]
    v_mfma_f32_16x16x32_bf16 v[88:91], v[20:23], a[152:155], v[88:91]
    v_mfma_f32_16x16x32_bf16 v[92:95], v[20:23], a[156:159], v[92:95]
    buffer_load_dwordx2 v[152:153], v6, s[4:7], s60 offen
    s_mov_b32 s60, 78397440
    s_waitcnt lgkmcnt(3)
    v_mfma_f32_16x16x32_bf16 v[208:211], v[24:27], a[160:163], v[208:211]
    ds_read_b128 v[16:19], v4 offset:22528
    v_mfma_f32_16x16x32_bf16 v[212:215], v[24:27], a[164:167], v[212:215]
    v_mfma_f32_16x16x32_bf16 v[216:219], v[24:27], a[168:171], v[216:219]
    s_waitcnt vmcnt(26)
    v_mfma_f32_16x16x32_bf16 v[220:223], v[24:27], a[172:175], v[220:223]
    buffer_load_dwordx2 v[154:155], v6, s[4:7], s60 offen
    s_mov_b32 s60, 78413824
    s_waitcnt lgkmcnt(3)
    v_mfma_f32_16x16x32_bf16 v[224:227], v[28:31], a[160:163], v[224:227]
    ds_read_b128 v[20:23], v4 offset:23552
    v_mfma_f32_16x16x32_bf16 v[228:231], v[28:31], a[164:167], v[228:231]
    v_mfma_f32_16x16x32_bf16 v[232:235], v[28:31], a[168:171], v[232:235]
    v_mfma_f32_16x16x32_bf16 v[236:239], v[28:31], a[172:175], v[236:239]
    buffer_load_dwordx2 v[156:157], v6, s[4:7], s60 offen
    s_mov_b32 s60, 78430208
    s_waitcnt lgkmcnt(3)
    v_mfma_f32_16x16x32_bf16 v[64:67], v[8:11], a[160:163], v[64:67]
    ds_read_b128 v[24:27], v4 offset:59392
    v_mfma_f32_16x16x32_bf16 v[68:71], v[8:11], a[164:167], v[68:71]
    v_mfma_f32_16x16x32_bf16 v[72:75], v[8:11], a[168:171], v[72:75]
    v_mfma_f32_16x16x32_bf16 v[76:79], v[8:11], a[172:175], v[76:79]
    buffer_load_dwordx2 v[158:159], v6, s[4:7], s60 offen
    s_mov_b32 s60, 78446592
    s_waitcnt lgkmcnt(3)
    v_mfma_f32_16x16x32_bf16 v[80:83], v[12:15], a[160:163], v[80:83]
    ds_read_b128 v[28:31], v4 offset:60416
    v_mfma_f32_16x16x32_bf16 v[84:87], v[12:15], a[164:167], v[84:87]
    v_mfma_f32_16x16x32_bf16 v[88:91], v[12:15], a[168:171], v[88:91]
    v_mfma_f32_16x16x32_bf16 v[92:95], v[12:15], a[172:175], v[92:95]
    buffer_load_dwordx2 v[160:161], v6, s[4:7], s60 offen
    s_mov_b32 s60, 78462976
    s_waitcnt lgkmcnt(3)
    v_mfma_f32_16x16x32_bf16 v[208:211], v[16:19], a[176:179], v[208:211]
    ds_read_b128 v[8:11], v4 offset:24576
    v_mfma_f32_16x16x32_bf16 v[212:215], v[16:19], a[180:183], v[212:215]
    v_mfma_f32_16x16x32_bf16 v[216:219], v[16:19], a[184:187], v[216:219]
    s_waitcnt vmcnt(29)
    v_mfma_f32_16x16x32_bf16 v[220:223], v[16:19], a[188:191], v[220:223]
    buffer_load_dwordx2 v[162:163], v6, s[4:7], s60 offen
    s_add_u32 m0, s49, 73728
    s_waitcnt lgkmcnt(3)
    v_mfma_f32_16x16x32_bf16 v[224:227], v[20:23], a[176:179], v[224:227]
    ds_read_b128 v[12:15], v4 offset:25600
    s_add_u32 s61, s48, 73728
    v_mfma_f32_16x16x32_bf16 v[228:231], v[20:23], a[180:183], v[228:231]
    v_mfma_f32_16x16x32_bf16 v[232:235], v[20:23], a[184:187], v[232:235]
    v_mfma_f32_16x16x32_bf16 v[236:239], v[20:23], a[188:191], v[236:239]
    buffer_load_dwordx4 v2, s[4:7], s61 offen offset:0 lds
    s_waitcnt lgkmcnt(3)
    v_mfma_f32_16x16x32_bf16 v[64:67], v[24:27], a[176:179], v[64:67]
    ds_read_b128 v[16:19], v4 offset:61440
    v_mfma_f32_16x16x32_bf16 v[68:71], v[24:27], a[180:183], v[68:71]
    v_mfma_f32_16x16x32_bf16 v[72:75], v[24:27], a[184:187], v[72:75]
    v_mfma_f32_16x16x32_bf16 v[76:79], v[24:27], a[188:191], v[76:79]
    buffer_load_dwordx4 v2, s[4:7], s61 offen offset:1024 lds
    s_waitcnt lgkmcnt(3)
    v_mfma_f32_16x16x32_bf16 v[80:83], v[28:31], a[176:179], v[80:83]
    ds_read_b128 v[20:23], v4 offset:62464
    v_mfma_f32_16x16x32_bf16 v[84:87], v[28:31], a[180:183], v[84:87]
    v_mfma_f32_16x16x32_bf16 v[88:91], v[28:31], a[184:187], v[88:91]
    v_mfma_f32_16x16x32_bf16 v[92:95], v[28:31], a[188:191], v[92:95]
    buffer_load_dwordx4 v2, s[4:7], s61 offen offset:2048 lds
    s_waitcnt vmcnt(32) lgkmcnt(3)
    v_mfma_f32_16x16x32_bf16 v[208:211], v[8:11], a[192:195], v[208:211]
    ds_read_b128 v[24:27], v4 offset:26624
    s_waitcnt vmcnt(28)
    v_mfma_f32_16x16x32_bf16 v[212:215], v[8:11], a[196:199], v[212:215]
    s_waitcnt vmcnt(24)
    v_mfma_f32_16x16x32_bf16 v[216:219], v[8:11], a[200:203], v[216:219]
    s_waitcnt vmcnt(20)
    v_mfma_f32_16x16x32_bf16 v[220:223], v[8:11], a[204:207], v[220:223]
    buffer_load_dwordx4 v2, s[4:7], s61 offen offset:3072 lds
    s_add_u32 m0, s49, 77824
    s_waitcnt lgkmcnt(3)
    v_mfma_f32_16x16x32_bf16 v[224:227], v[12:15], a[192:195], v[224:227]
    ds_read_b128 v[28:31], v4 offset:27648
    s_add_u32 s61, s48, 77824
    v_mfma_f32_16x16x32_bf16 v[228:231], v[12:15], a[196:199], v[228:231]
    v_mfma_f32_16x16x32_bf16 v[232:235], v[12:15], a[200:203], v[232:235]
    v_mfma_f32_16x16x32_bf16 v[236:239], v[12:15], a[204:207], v[236:239]
    buffer_load_dwordx4 v2, s[4:7], s61 offen offset:0 lds
    s_waitcnt lgkmcnt(3)
    v_mfma_f32_16x16x32_bf16 v[64:67], v[16:19], a[192:195], v[64:67]
    ds_read_b128 v[8:11], v4 offset:63488
    v_mfma_f32_16x16x32_bf16 v[68:71], v[16:19], a[196:199], v[68:71]
    v_mfma_f32_16x16x32_bf16 v[72:75], v[16:19], a[200:203], v[72:75]
    v_mfma_f32_16x16x32_bf16 v[76:79], v[16:19], a[204:207], v[76:79]
    buffer_load_dwordx4 v2, s[4:7], s61 offen offset:1024 lds
    s_waitcnt lgkmcnt(3)
    v_mfma_f32_16x16x32_bf16 v[80:83], v[20:23], a[192:195], v[80:83]
    ds_read_b128 v[12:15], v4 offset:64512
    v_mfma_f32_16x16x32_bf16 v[84:87], v[20:23], a[196:199], v[84:87]
    v_mfma_f32_16x16x32_bf16 v[88:91], v[20:23], a[200:203], v[88:91]
    v_mfma_f32_16x16x32_bf16 v[92:95], v[20:23], a[204:207], v[92:95]
    buffer_load_dwordx4 v2, s[4:7], s61 offen offset:2048 lds
    s_waitcnt lgkmcnt(3)
    v_mfma_f32_16x16x32_bf16 v[208:211], v[24:27], a[208:211], v[208:211]
    ds_read_b128 v[16:19], v4 offset:28672
    v_mfma_f32_16x16x32_bf16 v[212:215], v[24:27], a[212:215], v[212:215]
    v_mfma_f32_16x16x32_bf16 v[216:219], v[24:27], a[216:219], v[216:219]
    s_waitcnt vmcnt(23)
    v_mfma_f32_16x16x32_bf16 v[220:223], v[24:27], a[220:223], v[220:223]
    buffer_load_dwordx4 v2, s[4:7], s61 offen offset:3072 lds
    s_add_u32 m0, s49, 81920
    s_waitcnt lgkmcnt(3)
    v_mfma_f32_16x16x32_bf16 v[224:227], v[28:31], a[208:211], v[224:227]
    ds_read_b128 v[20:23], v4 offset:29696
    s_add_u32 s61, s48, 81920
    v_mfma_f32_16x16x32_bf16 v[228:231], v[28:31], a[212:215], v[228:231]
    v_mfma_f32_16x16x32_bf16 v[232:235], v[28:31], a[216:219], v[232:235]
    v_mfma_f32_16x16x32_bf16 v[236:239], v[28:31], a[220:223], v[236:239]
    buffer_load_dwordx4 v2, s[4:7], s61 offen offset:0 lds
    s_add_u32 m0, s49, 110592
    s_waitcnt lgkmcnt(3)
    v_mfma_f32_16x16x32_bf16 v[64:67], v[8:11], a[208:211], v[64:67]
    ds_read_b128 v[24:27], v7 offset:0
    s_add_u32 s61, s48, 110592
    v_mfma_f32_16x16x32_bf16 v[68:71], v[8:11], a[212:215], v[68:71]
    v_mfma_f32_16x16x32_bf16 v[72:75], v[8:11], a[216:219], v[72:75]
    v_mfma_f32_16x16x32_bf16 v[76:79], v[8:11], a[220:223], v[76:79]
    buffer_load_dwordx4 v2, s[4:7], s61 offen offset:0 lds
    s_waitcnt lgkmcnt(3)
    v_mfma_f32_16x16x32_bf16 v[80:83], v[12:15], a[208:211], v[80:83]
    ds_read_b128 v[28:31], v7 offset:1024
    v_mfma_f32_16x16x32_bf16 v[84:87], v[12:15], a[212:215], v[84:87]
    v_mfma_f32_16x16x32_bf16 v[88:91], v[12:15], a[216:219], v[88:91]
    v_mfma_f32_16x16x32_bf16 v[92:95], v[12:15], a[220:223], v[92:95]
    buffer_load_dwordx4 v2, s[4:7], s61 offen offset:1024 lds
    s_waitcnt lgkmcnt(3)
    v_mfma_f32_16x16x32_bf16 v[208:211], v[16:19], a[224:227], v[208:211]
    ds_read_b128 v[8:11], v4 offset:30720
    v_mfma_f32_16x16x32_bf16 v[212:215], v[16:19], a[228:231], v[212:215]
    v_mfma_f32_16x16x32_bf16 v[216:219], v[16:19], a[232:235], v[216:219]
    s_waitcnt vmcnt(26)
    v_mfma_f32_16x16x32_bf16 v[220:223], v[16:19], a[236:239], v[220:223]
    buffer_load_dwordx4 v2, s[4:7], s61 offen offset:2048 lds
    s_waitcnt lgkmcnt(3)
    v_mfma_f32_16x16x32_bf16 v[224:227], v[20:23], a[224:227], v[224:227]
    ds_read_b128 v[12:15], v4 offset:31744
    v_mfma_f32_16x16x32_bf16 v[228:231], v[20:23], a[228:231], v[228:231]
    v_mfma_f32_16x16x32_bf16 v[232:235], v[20:23], a[232:235], v[232:235]
    v_mfma_f32_16x16x32_bf16 v[236:239], v[20:23], a[236:239], v[236:239]
    buffer_load_dwordx4 v2, s[4:7], s61 offen offset:3072 lds
    s_add_u32 m0, s49, 114688
    s_waitcnt lgkmcnt(3)
    v_mfma_f32_16x16x32_bf16 v[64:67], v[24:27], a[224:227], v[64:67]
    ds_read_b128 v[16:19], v7 offset:2048
    s_add_u32 s61, s48, 114688
    v_mfma_f32_16x16x32_bf16 v[68:71], v[24:27], a[228:231], v[68:71]
    v_mfma_f32_16x16x32_bf16 v[72:75], v[24:27], a[232:235], v[72:75]
    v_mfma_f32_16x16x32_bf16 v[76:79], v[24:27], a[236:239], v[76:79]
    buffer_load_dwordx4 v2, s[4:7], s61 offen offset:0 lds
    s_waitcnt lgkmcnt(3)
    v_mfma_f32_16x16x32_bf16 v[80:83], v[28:31], a[224:227], v[80:83]
    ds_read_b128 v[20:23], v7 offset:3072
    v_mfma_f32_16x16x32_bf16 v[84:87], v[28:31], a[228:231], v[84:87]
    s_waitcnt vmcnt(18)
    v_add_f32 v166, v152, v154
    v_add_f32 v167, v153, v155
    v_mfma_f32_16x16x32_bf16 v[88:91], v[28:31], a[232:235], v[88:91]
    s_waitcnt vmcnt(17)
    v_add_f32 v166, v166, v156
    v_add_f32 v167, v167, v157
    v_mfma_f32_16x16x32_bf16 v[92:95], v[28:31], a[236:239], v[92:95]
    buffer_load_dwordx4 v2, s[4:7], s61 offen offset:1024 lds
    s_waitcnt vmcnt(17)
    v_add_f32 v166, v166, v158
    s_waitcnt lgkmcnt(3)
    v_mfma_f32_16x16x32_bf16 v[208:211], v[8:11], a[240:243], v[208:211]
    ds_read_b128 v[24:27], v4 offset:32768
    v_add_f32 v167, v167, v159
    v_mfma_f32_16x16x32_bf16 v[212:215], v[8:11], a[244:247], v[212:215]
    s_waitcnt vmcnt(16)
    v_add_f32 v166, v166, v160
    v_add_f32 v167, v167, v161
    v_mfma_f32_16x16x32_bf16 v[216:219], v[8:11], a[248:251], v[216:219]
    s_waitcnt vmcnt(15)
    v_add_f32 v166, v166, v162
    v_add_f32 v167, v167, v163
    v_mfma_f32_16x16x32_bf16 v[220:223], v[8:11], a[252:255], v[220:223]
    buffer_load_dwordx4 v2, s[4:7], s61 offen offset:2048 lds
    v_mul_f32 v166, 0xbae38e39, v166
    s_waitcnt lgkmcnt(3)
    v_mfma_f32_16x16x32_bf16 v[224:227], v[12:15], a[240:243], v[224:227]
    ds_read_b128 v[28:31], v4 offset:33792
    v_fmamk_f32 v165, v152, 0x3c2aaaab, v166
    v_mfma_f32_16x16x32_bf16 v[228:231], v[12:15], a[244:247], v[228:231]
    v_mul_f32 v164, v165, v165
    v_fmamk_f32 v165, v154, 0x3c2aaaab, v166
    v_mfma_f32_16x16x32_bf16 v[232:235], v[12:15], a[248:251], v[232:235]
    v_fmac_f32 v164, v165, v165
    v_fmamk_f32 v165, v156, 0x3c2aaaab, v166
    v_mfma_f32_16x16x32_bf16 v[236:239], v[12:15], a[252:255], v[236:239]
    buffer_load_dwordx4 v2, s[4:7], s61 offen offset:3072 lds
    s_add_u32 m0, s49, 118784
    s_waitcnt lgkmcnt(3)
    v_mfma_f32_16x16x32_bf16 v[64:67], v[16:19], a[240:243], v[64:67]
    ds_read_b128 v[8:11], v7 offset:4096
    s_add_u32 s61, s48, 118784
    v_mfma_f32_16x16x32_bf16 v[68:71], v[16:19], a[244:247], v[68:71]
    v_fmac_f32 v164, v165, v165
    v_fmamk_f32 v165, v158, 0x3c2aaaab, v166
    v_mfma_f32_16x16x32_bf16 v[72:75], v[16:19], a[248:251], v[72:75]
    v_fmac_f32 v164, v165, v165
    v_fmamk_f32 v165, v160, 0x3c2aaaab, v166
    v_mfma_f32_16x16x32_bf16 v[76:79], v[16:19], a[252:255], v[76:79]
    buffer_load_dwordx4 v2, s[4:7], s61 offen offset:0 lds
    v_fmac_f32 v164, v165, v165
    s_waitcnt lgkmcnt(3)
    v_mfma_f32_16x16x32_bf16 v[80:83], v[20:23], a[240:243], v[80:83]
    ds_read_b128 v[12:15], v7 offset:5120
    v_fmamk_f32 v165, v162, 0x3c2aaaab, v166
    v_mfma_f32_16x16x32_bf16 v[84:87], v[20:23], a[244:247], v[84:87]
    v_fmac_f32 v164, v165, v165
    v_fmac_f32 v167, 0x42c00000, v164
    v_mfma_f32_16x16x32_bf16 v[88:91], v[20:23], a[248:251], v[88:91]
    v_mov_b32 v165, 0x3727c5ac
    v_fmac_f32 v165, 0x3ae38e39, v167
    v_mfma_f32_16x16x32_bf16 v[92:95], v[20:23], a[252:255], v[92:95]
    v_rcp_f32 v167, v165
    v_and_b32 v164, 15, v1
    s_waitcnt lgkmcnt(3)
    v_mfma_f32_16x16x32_bf16 v[208:211], v[24:27], v[32:35], v[208:211]
    ds_read_b128 v[16:19], v4 offset:34816
    v_lshlrev_b32 v164, 2, v164
    v_mfma_f32_16x16x32_bf16 v[212:215], v[24:27], v[36:39], v[212:215]
    ds_bpermute_b32 v128, v164, v166 offset:0
    ds_bpermute_b32 v132, v164, v167 offset:0
    v_mfma_f32_16x16x32_bf16 v[216:219], v[24:27], v[40:43], v[216:219]
    ds_bpermute_b32 v129, v164, v166 offset:64
    ds_bpermute_b32 v133, v164, v167 offset:64
    v_mfma_f32_16x16x32_bf16 v[220:223], v[24:27], v[44:47], v[220:223]
    ds_bpermute_b32 v130, v164, v166 offset:128
    ds_bpermute_b32 v134, v164, v167 offset:128
    s_waitcnt lgkmcnt(9)
    v_mfma_f32_16x16x32_bf16 v[224:227], v[28:31], v[32:35], v[224:227]
    ds_read_b128 v[20:23], v4 offset:35840
    ds_bpermute_b32 v131, v164, v166 offset:192
    v_mfma_f32_16x16x32_bf16 v[228:231], v[28:31], v[36:39], v[228:231]
    ds_bpermute_b32 v135, v164, v167 offset:192
    v_mfma_f32_16x16x32_bf16 v[232:235], v[28:31], v[40:43], v[232:235]
    v_mfma_f32_16x16x32_bf16 v[236:239], v[28:31], v[44:47], v[236:239]
    s_waitcnt lgkmcnt(11)
    v_mfma_f32_16x16x32_bf16 v[64:67], v[8:11], v[32:35], v[64:67]
    ds_read_b128 v[24:27], v7 offset:6144
    v_mfma_f32_16x16x32_bf16 v[68:71], v[8:11], v[36:39], v[68:71]
    v_mfma_f32_16x16x32_bf16 v[72:75], v[8:11], v[40:43], v[72:75]
    v_mfma_f32_16x16x32_bf16 v[76:79], v[8:11], v[44:47], v[76:79]
    ds_read_b128 v[136:139], v5 offset:0
    ds_read_b128 v[140:143], v5 offset:64
    s_waitcnt lgkmcnt(13)
    v_mfma_f32_16x16x32_bf16 v[80:83], v[12:15], v[32:35], v[80:83]
    ds_read_b128 v[28:31], v7 offset:7168
    ds_read_b128 v[144:147], v5 offset:128
    v_mfma_f32_16x16x32_bf16 v[84:87], v[12:15], v[36:39], v[84:87]
    ds_read_b128 v[148:151], v5 offset:192
    v_mfma_f32_16x16x32_bf16 v[88:91], v[12:15], v[40:43], v[88:91]
    v_mfma_f32_16x16x32_bf16 v[92:95], v[12:15], v[44:47], v[92:95]
    s_waitcnt lgkmcnt(15)
    v_mfma_f32_16x16x32_bf16 v[208:211], v[16:19], v[48:51], v[208:211]
    s_waitcnt vmcnt(9)
    s_waitcnt lgkmcnt(0)
    s_barrier
    v_mfma_f32_16x16x32_bf16 v[212:215], v[16:19], v[52:55], v[212:215]
    v_add_u32 v4, 0x12000, v4
    ds_read_b128 v[8:11], v4 offset:0
    v_mfma_f32_16x16x32_bf16 v[216:219], v[16:19], v[56:59], v[216:219]
    s_add_u32 m0, s49, 0
    s_add_u32 s61, s48, 147456
    v_mfma_f32_16x16x32_bf16 v[220:223], v[16:19], v[60:63], v[220:223]
    buffer_load_dwordx4 v2, s[4:7], s61 offen offset:0 lds
    v_mfma_f32_16x16x32_bf16 v[224:227], v[20:23], v[48:51], v[224:227]
    ds_read_b128 v[12:15], v4 offset:1024
    v_mfma_f32_16x16x32_bf16 v[228:231], v[20:23], v[52:55], v[228:231]
    v_mfma_f32_16x16x32_bf16 v[232:235], v[20:23], v[56:59], v[232:235]
    v_mfma_f32_16x16x32_bf16 v[236:239], v[20:23], v[60:63], v[236:239]
    buffer_load_dwordx4 v2, s[4:7], s61 offen offset:1024 lds
    v_mfma_f32_16x16x32_bf16 v[64:67], v[24:27], v[48:51], v[64:67]
    ds_read_b128 v[16:19], v4 offset:2048
    v_mfma_f32_16x16x32_bf16 v[68:71], v[24:27], v[52:55], v[68:71]
    v_mfma_f32_16x16x32_bf16 v[72:75], v[24:27], v[56:59], v[72:75]
    v_mfma_f32_16x16x32_bf16 v[76:79], v[24:27], v[60:63], v[76:79]
    buffer_load_dwordx4 v2, s[4:7], s61 offen offset:2048 lds
    v_mfma_f32_16x16x32_bf16 v[80:83], v[28:31], v[48:51], v[80:83]
    ds_read_b128 v[20:23], v4 offset:3072
    v_mfma_f32_16x16x32_bf16 v[84:87], v[28:31], v[52:55], v[84:87]
    v_mfma_f32_16x16x32_bf16 v[88:91], v[28:31], v[56:59], v[88:91]
    v_mfma_f32_16x16x32_bf16 v[92:95], v[28:31], v[60:63], v[92:95]
    buffer_load_dwordx4 v2, s[4:7], s61 offen offset:3072 lds
    s_add_u32 m0, s49, 4096
    s_waitcnt lgkmcnt(3)
    v_mfma_f32_16x16x32_bf16 v[96:99], v[8:11], a[0:3], 0
    ds_read_b128 v[24:27], v4 offset:4096
    s_add_u32 s61, s48, 151552
    v_mfma_f32_16x16x32_bf16 v[100:103], v[8:11], a[4:7], 0
    v_mfma_f32_16x16x32_bf16 v[104:107], v[8:11], a[8:11], 0
    v_mfma_f32_16x16x32_bf16 v[108:111], v[8:11], a[12:15], 0
    buffer_load_dwordx4 v2, s[4:7], s61 offen offset:0 lds
    s_waitcnt lgkmcnt(3)
    v_mfma_f32_16x16x32_bf16 v[112:115], v[12:15], a[0:3], 0
    ds_read_b128 v[28:31], v4 offset:5120
    v_mfma_f32_16x16x32_bf16 v[116:119], v[12:15], a[4:7], 0
    v_fmac_f32 v64, v144, v128
    v_fmac_f32 v65, v145, v128
    v_mfma_f32_16x16x32_bf16 v[120:123], v[12:15], a[8:11], 0
    v_fmac_f32 v66, v146, v128
    v_fmac_f32 v67, v147, v128
    v_mfma_f32_16x16x32_bf16 v[124:127], v[12:15], a[12:15], 0
    buffer_load_dwordx4 v2, s[4:7], s61 offen offset:1024 lds
    v_fmac_f32 v80, v148, v128
    s_waitcnt lgkmcnt(3)
    v_mfma_f32_16x16x32_bf16 v[96:99], v[16:19], a[16:19], v[96:99]
    ds_read_b128 v[8:11], v4 offset:6144
    v_fmac_f32 v81, v149, v128
    v_mfma_f32_16x16x32_bf16 v[100:103], v[16:19], a[20:23], v[100:103]
    v_fmac_f32 v82, v150, v128
    v_fmac_f32 v83, v151, v128
    v_mfma_f32_16x16x32_bf16 v[104:107], v[16:19], a[24:27], v[104:107]
    v_mul_f32 v64, v64, v132
    v_mul_f32 v65, v65, v132
    v_mfma_f32_16x16x32_bf16 v[108:111], v[16:19], a[28:31], v[108:111]
    buffer_load_dwordx4 v2, s[4:7], s61 offen offset:2048 lds
    v_mul_f32 v66, v66, v132
    s_waitcnt lgkmcnt(3)
    v_mfma_f32_16x16x32_bf16 v[112:115], v[20:23], a[16:19], v[112:115]
    ds_read_b128 v[12:15], v4 offset:7168
    v_mul_f32 v67, v67, v132
    v_mfma_f32_16x16x32_bf16 v[116:119], v[20:23], a[20:23], v[116:119]
    v_mul_f32 v64, v64, v80
    v_mul_f32 v65, v65, v81
    v_mfma_f32_16x16x32_bf16 v[120:123], v[20:23], a[24:27], v[120:123]
    v_mul_f32 v66, v66, v82
    v_mul_f32 v67, v67, v83
    v_mfma_f32_16x16x32_bf16 v[124:127], v[20:23], a[28:31], v[124:127]
    buffer_load_dwordx4 v2, s[4:7], s61 offen offset:3072 lds
    s_add_u32 m0, s49, 8192
    s_waitcnt lgkmcnt(3)
    v_mfma_f32_16x16x32_bf16 v[96:99], v[24:27], a[32:35], v[96:99]
    ds_read_b128 v[16:19], v4 offset:8192
    s_add_u32 s61, s48, 155648
    v_mfma_f32_16x16x32_bf16 v[100:103], v[24:27], a[36:39], v[100:103]
    v_cvt_pk_bf16_f32 v176, v64, v65
    v_cvt_pk_bf16_f32 v177, v66, v67
    v_mfma_f32_16x16x32_bf16 v[104:107], v[24:27], a[40:43], v[104:107]
    v_fmac_f32 v68, v144, v129
    v_fmac_f32 v69, v145, v129
    v_mfma_f32_16x16x32_bf16 v[108:111], v[24:27], a[44:47], v[108:111]
    buffer_load_dwordx4 v2, s[4:7], s61 offen offset:0 lds
    s_add_u32 m0, s49, 36864
    s_waitcnt lgkmcnt(3)
    v_mfma_f32_16x16x32_bf16 v[112:115], v[28:31], a[32:35], v[112:115]
    ds_read_b128 v[20:23], v4 offset:9216
    s_add_u32 s61, s48, 184320
    v_mfma_f32_16x16x32_bf16 v[116:119], v[28:31], a[36:39], v[116:119]
    v_fmac_f32 v70, v146, v129
    v_fmac_f32 v71, v147, v129
    v_mfma_f32_16x16x32_bf16 v[120:123], v[28:31], a[40:43], v[120:123]
    v_fmac_f32 v84, v148, v129
    v_fmac_f32 v85, v149, v129
    v_mfma_f32_16x16x32_bf16 v[124:127], v[28:31], a[44:47], v[124:127]
    buffer_load_dwordx4 v2, s[4:7], s61 offen offset:0 lds
    v_fmac_f32 v86, v150, v129
    s_waitcnt lgkmcnt(3)
    v_mfma_f32_16x16x32_bf16 v[96:99], v[8:11], a[48:51], v[96:99]
    ds_read_b128 v[24:27], v4 offset:10240
    v_fmac_f32 v87, v151, v129
    v_mfma_f32_16x16x32_bf16 v[100:103], v[8:11], a[52:55], v[100:103]
    v_mul_f32 v68, v68, v133
    v_mul_f32 v69, v69, v133
    v_mfma_f32_16x16x32_bf16 v[104:107], v[8:11], a[56:59], v[104:107]
    v_mul_f32 v70, v70, v133
    v_mul_f32 v71, v71, v133
    v_mfma_f32_16x16x32_bf16 v[108:111], v[8:11], a[60:63], v[108:111]
    buffer_load_dwordx4 v2, s[4:7], s61 offen offset:1024 lds
    v_mul_f32 v68, v68, v84
    s_waitcnt lgkmcnt(3)
    v_mfma_f32_16x16x32_bf16 v[112:115], v[12:15], a[48:51], v[112:115]
    ds_read_b128 v[28:31], v4 offset:11264
    v_mul_f32 v69, v69, v85
    v_mfma_f32_16x16x32_bf16 v[116:119], v[12:15], a[52:55], v[116:119]
    v_mul_f32 v70, v70, v86
    v_mul_f32 v71, v71, v87
    v_mfma_f32_16x16x32_bf16 v[120:123], v[12:15], a[56:59], v[120:123]
    v_cvt_pk_bf16_f32 v180, v68, v69
    v_cvt_pk_bf16_f32 v181, v70, v71
    v_mfma_f32_16x16x32_bf16 v[124:127], v[12:15], a[60:63], v[124:127]
    buffer_load_dwordx4 v2, s[4:7], s61 offen offset:2048 lds
    v_fmac_f32 v72, v144, v130
    s_waitcnt lgkmcnt(3)
    v_mfma_f32_16x16x32_bf16 v[96:99], v[16:19], a[64:67], v[96:99]
    ds_read_b128 v[8:11], v4 offset:12288
    v_fmac_f32 v73, v145, v130
    v_mfma_f32_16x16x32_bf16 v[100:103], v[16:19], a[68:71], v[100:103]
    v_fmac_f32 v74, v146, v130
    v_fmac_f32 v75, v147, v130
    v_mfma_f32_16x16x32_bf16 v[104:107], v[16:19], a[72:75], v[104:107]
    v_fmac_f32 v88, v148, v130
    v_fmac_f32 v89, v149, v130
    v_mfma_f32_16x16x32_bf16 v[108:111], v[16:19], a[76:79], v[108:111]
    buffer_load_dwordx4 v2, s[4:7], s61 offen offset:3072 lds
    s_add_u32 m0, s49, 40960
    s_waitcnt lgkmcnt(3)
    v_mfma_f32_16x16x32_bf16 v[112:115], v[20:23], a[64:67], v[112:115]
    ds_read_b128 v[12:15], v4 offset:13312
    s_add_u32 s61, s48, 188416
    v_mfma_f32_16x16x32_bf16 v[116:119], v[20:23], a[68:71], v[116:119]
    v_fmac_f32 v90, v150, v130
    v_fmac_f32 v91, v151, v130
    v_mfma_f32_16x16x32_bf16 v[120:123], v[20:23], a[72:75], v[120:123]
    v_mul_f32 v72, v72, v134
    v_mul_f32 v73, v73, v134
    v_mfma_f32_16x16x32_bf16 v[124:127], v[20:23], a[76:79], v[124:127]
    buffer_load_dwordx4 v2, s[4:7], s61 offen offset:0 lds
    v_mul_f32 v74, v74, v134
    s_waitcnt lgkmcnt(3)
    v_mfma_f32_16x16x32_bf16 v[96:99], v[24:27], a[80:83], v[96:99]
    ds_read_b128 v[16:19], v4 offset:14336
    v_mul_f32 v75, v75, v134
    v_mfma_f32_16x16x32_bf16 v[100:103], v[24:27], a[84:87], v[100:103]
    v_mul_f32 v72, v72, v88
    v_mul_f32 v73, v73, v89
    v_mfma_f32_16x16x32_bf16 v[104:107], v[24:27], a[88:91], v[104:107]
    v_mul_f32 v74, v74, v90
    v_mul_f32 v75, v75, v91
    v_mfma_f32_16x16x32_bf16 v[108:111], v[24:27], a[92:95], v[108:111]
    buffer_load_dwordx4 v2, s[4:7], s61 offen offset:1024 lds
    v_cvt_pk_bf16_f32 v184, v72, v73
    s_waitcnt lgkmcnt(3)
    v_mfma_f32_16x16x32_bf16 v[112:115], v[28:31], a[80:83], v[112:115]
    ds_read_b128 v[20:23], v4 offset:15360
    v_cvt_pk_bf16_f32 v185, v74, v75
    v_mfma_f32_16x16x32_bf16 v[116:119], v[28:31], a[84:87], v[116:119]
    v_fmac_f32 v76, v144, v131
    v_fmac_f32 v77, v145, v131
    v_mfma_f32_16x16x32_bf16 v[120:123], v[28:31], a[88:91], v[120:123]
    v_fmac_f32 v78, v146, v131
    v_fmac_f32 v79, v147, v131
    v_mfma_f32_16x16x32_bf16 v[124:127], v[28:31], a[92:95], v[124:127]
    buffer_load_dwordx4 v2, s[4:7], s61 offen offset:2048 lds
    v_fmac_f32 v92, v148, v131
    s_waitcnt lgkmcnt(3)
    v_mfma_f32_16x16x32_bf16 v[96:99], v[8:11], a[96:99], v[96:99]
    ds_read_b128 v[24:27], v4 offset:16384
    v_fmac_f32 v93, v149, v131
    v_mfma_f32_16x16x32_bf16 v[100:103], v[8:11], a[100:103], v[100:103]
    v_fmac_f32 v94, v150, v131
    v_fmac_f32 v95, v151, v131
    v_mfma_f32_16x16x32_bf16 v[104:107], v[8:11], a[104:107], v[104:107]
    v_mul_f32 v76, v76, v135
    v_mul_f32 v77, v77, v135
    v_mfma_f32_16x16x32_bf16 v[108:111], v[8:11], a[108:111], v[108:111]
    buffer_load_dwordx4 v2, s[4:7], s61 offen offset:3072 lds
    s_add_u32 m0, s49, 45056
    s_waitcnt lgkmcnt(3)
    v_mfma_f32_16x16x32_bf16 v[112:115], v[12:15], a[96:99], v[112:115]
    ds_read_b128 v[28:31], v4 offset:17408
    s_add_u32 s61, s48, 192512
    v_mfma_f32_16x16x32_bf16 v[116:119], v[12:15], a[100:103], v[116:119]
    v_mul_f32 v78, v78, v135
    v_mul_f32 v79, v79, v135
    v_mfma_f32_16x16x32_bf16 v[120:123], v[12:15], a[104:107], v[120:123]
    v_mul_f32 v76, v76, v92
    v_mul_f32 v77, v77, v93
    v_mfma_f32_16x16x32_bf16 v[124:127], v[12:15], a[108:111], v[124:127]
    buffer_load_dwordx4 v2, s[4:7], s61 offen offset:0 lds
    v_mul_f32 v78, v78, v94
    s_waitcnt lgkmcnt(3)
    v_mfma_f32_16x16x32_bf16 v[96:99], v[16:19], a[112:115], v[96:99]
    ds_read_b128 v[8:11], v4 offset:18432
    v_mul_f32 v79, v79, v95
    v_mfma_f32_16x16x32_bf16 v[100:103], v[16:19], a[116:119], v[100:103]
    v_cvt_pk_bf16_f32 v188, v76, v77
    v_cvt_pk_bf16_f32 v189, v78, v79
    v_mfma_f32_16x16x32_bf16 v[104:107], v[16:19], a[120:123], v[104:107]
    v_fmac_f32 v208, v136, v128
    v_fmac_f32 v209, v137, v128
    v_mfma_f32_16x16x32_bf16 v[108:111], v[16:19], a[124:127], v[108:111]
    v_fmac_f32 v210, v138, v128
    v_fmac_f32 v211, v139, v128
    s_waitcnt lgkmcnt(3)
    v_mfma_f32_16x16x32_bf16 v[112:115], v[20:23], a[112:115], v[112:115]
    ds_read_b128 v[12:15], v4 offset:19456
    v_fmac_f32 v224, v140, v128
    v_mfma_f32_16x16x32_bf16 v[116:119], v[20:23], a[116:119], v[116:119]
    v_fmac_f32 v225, v141, v128
    v_fmac_f32 v226, v142, v128
    v_mfma_f32_16x16x32_bf16 v[120:123], v[20:23], a[120:123], v[120:123]
    v_fmac_f32 v227, v143, v128
    v_mul_f32 v208, v208, v132
    v_mfma_f32_16x16x32_bf16 v[124:127], v[20:23], a[124:127], v[124:127]
    v_mul_f32 v209, v209, v132
    v_mul_f32 v210, v210, v132
    s_waitcnt lgkmcnt(3)
    v_mfma_f32_16x16x32_bf16 v[96:99], v[24:27], a[128:131], v[96:99]
    ds_read_b128 v[16:19], v4 offset:20480
    v_mul_f32 v211, v211, v132
    v_mfma_f32_16x16x32_bf16 v[100:103], v[24:27], a[132:135], v[100:103]
    v_mul_f32 v208, v208, v224
    v_mul_f32 v209, v209, v225
    v_mfma_f32_16x16x32_bf16 v[104:107], v[24:27], a[136:139], v[104:107]
    v_mul_f32 v210, v210, v226
    v_mul_f32 v211, v211, v227
    v_mfma_f32_16x16x32_bf16 v[108:111], v[24:27], a[140:143], v[108:111]
    v_cvt_pk_bf16_f32 v240, v208, v209
    v_cvt_pk_bf16_f32 v241, v210, v211
    s_waitcnt lgkmcnt(3)
    v_mfma_f32_16x16x32_bf16 v[112:115], v[28:31], a[128:131], v[112:115]
    ds_read_b128 v[20:23], v4 offset:21504
    s_add_u32 s66, s51, s65
    v_mfma_f32_16x16x32_bf16 v[116:119], v[28:31], a[132:135], v[116:119]
    buffer_store_dwordx2 v[240:241], v3, s[4:7], s66 offen offset:0 sc1
    v_fmac_f32 v212, v136, v129
    v_mfma_f32_16x16x32_bf16 v[120:123], v[28:31], a[136:139], v[120:123]
    v_fmac_f32 v213, v137, v129
    v_fmac_f32 v214, v138, v129
    v_mfma_f32_16x16x32_bf16 v[124:127], v[28:31], a[140:143], v[124:127]
    v_fmac_f32 v215, v139, v129
    v_fmac_f32 v228, v140, v129
    s_waitcnt lgkmcnt(3)
    v_mfma_f32_16x16x32_bf16 v[96:99], v[8:11], a[144:147], v[96:99]
    ds_read_b128 v[24:27], v4 offset:22528
    v_fmac_f32 v229, v141, v129
    v_mfma_f32_16x16x32_bf16 v[100:103], v[8:11], a[148:151], v[100:103]
    v_fmac_f32 v230, v142, v129
    v_fmac_f32 v231, v143, v129
    v_mfma_f32_16x16x32_bf16 v[104:107], v[8:11], a[152:155], v[104:107]
    v_mul_f32 v212, v212, v133
    v_mul_f32 v213, v213, v133
    v_mfma_f32_16x16x32_bf16 v[108:111], v[8:11], a[156:159], v[108:111]
    v_mul_f32 v214, v214, v133
    v_mul_f32 v215, v215, v133
    s_waitcnt lgkmcnt(3)
    v_mfma_f32_16x16x32_bf16 v[112:115], v[12:15], a[144:147], v[112:115]
    ds_read_b128 v[28:31], v4 offset:23552
    v_mul_f32 v212, v212, v228
    v_mfma_f32_16x16x32_bf16 v[116:119], v[12:15], a[148:151], v[116:119]
    v_mul_f32 v213, v213, v229
    v_mul_f32 v214, v214, v230
    v_mfma_f32_16x16x32_bf16 v[120:123], v[12:15], a[152:155], v[120:123]
    v_mul_f32 v215, v215, v231
    v_cvt_pk_bf16_f32 v244, v212, v213
    v_mfma_f32_16x16x32_bf16 v[124:127], v[12:15], a[156:159], v[124:127]
    v_cvt_pk_bf16_f32 v245, v214, v215
    buffer_store_dwordx2 v[244:245], v3, s[4:7], s66 offen offset:512 sc1
    s_waitcnt lgkmcnt(3)
    v_mfma_f32_16x16x32_bf16 v[96:99], v[16:19], a[160:163], v[96:99]
    ds_read_b128 v[8:11], v4 offset:24576
    v_fmac_f32 v216, v136, v130
    v_mfma_f32_16x16x32_bf16 v[100:103], v[16:19], a[164:167], v[100:103]
    v_fmac_f32 v217, v137, v130
    v_fmac_f32 v218, v138, v130
    v_mfma_f32_16x16x32_bf16 v[104:107], v[16:19], a[168:171], v[104:107]
    v_fmac_f32 v219, v139, v130
    v_fmac_f32 v232, v140, v130
    v_mfma_f32_16x16x32_bf16 v[108:111], v[16:19], a[172:175], v[108:111]
    v_fmac_f32 v233, v141, v130
    v_fmac_f32 v234, v142, v130
    s_waitcnt lgkmcnt(3)
    v_mfma_f32_16x16x32_bf16 v[112:115], v[20:23], a[160:163], v[112:115]
    ds_read_b128 v[12:15], v4 offset:25600
    v_fmac_f32 v235, v143, v130
    v_mfma_f32_16x16x32_bf16 v[116:119], v[20:23], a[164:167], v[116:119]
    v_mul_f32 v216, v216, v134
    v_mul_f32 v217, v217, v134
    v_mfma_f32_16x16x32_bf16 v[120:123], v[20:23], a[168:171], v[120:123]
    v_mul_f32 v218, v218, v134
    v_mul_f32 v219, v219, v134
    v_mfma_f32_16x16x32_bf16 v[124:127], v[20:23], a[172:175], v[124:127]
    v_mul_f32 v216, v216, v232
    v_mul_f32 v217, v217, v233
    s_waitcnt lgkmcnt(3)
    v_mfma_f32_16x16x32_bf16 v[96:99], v[24:27], a[176:179], v[96:99]
    ds_read_b128 v[16:19], v4 offset:26624
    v_mul_f32 v218, v218, v234
    v_mfma_f32_16x16x32_bf16 v[100:103], v[24:27], a[180:183], v[100:103]
    v_mul_f32 v219, v219, v235
    v_cvt_pk_bf16_f32 v248, v216, v217
    v_mfma_f32_16x16x32_bf16 v[104:107], v[24:27], a[184:187], v[104:107]
    v_cvt_pk_bf16_f32 v249, v218, v219
    buffer_store_dwordx2 v[248:249], v3, s[4:7], s66 offen offset:1024 sc1
    v_mfma_f32_16x16x32_bf16 v[108:111], v[24:27], a[188:191], v[108:111]
    v_fmac_f32 v220, v136, v131
    v_fmac_f32 v221, v137, v131
    s_waitcnt lgkmcnt(3)
    v_mfma_f32_16x16x32_bf16 v[112:115], v[28:31], a[176:179], v[112:115]
    ds_read_b128 v[20:23], v4 offset:27648
    v_fmac_f32 v222, v138, v131
    v_mfma_f32_16x16x32_bf16 v[116:119], v[28:31], a[180:183], v[116:119]
    v_fmac_f32 v223, v139, v131
    v_fmac_f32 v236, v140, v131
    v_mfma_f32_16x16x32_bf16 v[120:123], v[28:31], a[184:187], v[120:123]
    v_fmac_f32 v237, v141, v131
    v_fmac_f32 v238, v142, v131
    v_mfma_f32_16x16x32_bf16 v[124:127], v[28:31], a[188:191], v[124:127]
    v_fmac_f32 v239, v143, v131
    v_mul_f32 v220, v220, v135
    s_waitcnt lgkmcnt(3)
    v_mfma_f32_16x16x32_bf16 v[96:99], v[8:11], a[192:195], v[96:99]
    ds_read_b128 v[24:27], v4 offset:28672
    v_mul_f32 v221, v221, v135
    v_mfma_f32_16x16x32_bf16 v[100:103], v[8:11], a[196:199], v[100:103]
    v_mul_f32 v222, v222, v135
    v_mul_f32 v223, v223, v135
    v_mfma_f32_16x16x32_bf16 v[104:107], v[8:11], a[200:203], v[104:107]
    v_mul_f32 v220, v220, v236
    v_mul_f32 v221, v221, v237
    v_mfma_f32_16x16x32_bf16 v[108:111], v[8:11], a[204:207], v[108:111]
    v_mul_f32 v222, v222, v238
    v_mul_f32 v223, v223, v239
    s_waitcnt lgkmcnt(3)
    v_mfma_f32_16x16x32_bf16 v[112:115], v[12:15], a[192:195], v[112:115]
    ds_read_b128 v[28:31], v4 offset:29696
    v_cvt_pk_bf16_f32 v252, v220, v221
    v_mfma_f32_16x16x32_bf16 v[116:119], v[12:15], a[196:199], v[116:119]
    v_cvt_pk_bf16_f32 v253, v222, v223
    buffer_store_dwordx2 v[252:253], v3, s[4:7], s66 offen offset:1536 sc1
    v_mfma_f32_16x16x32_bf16 v[120:123], v[12:15], a[200:203], v[120:123]
    v_mfma_f32_16x16x32_bf16 v[124:127], v[12:15], a[204:207], v[124:127]
    s_waitcnt lgkmcnt(3)
    v_mfma_f32_16x16x32_bf16 v[96:99], v[16:19], a[208:211], v[96:99]
    ds_read_b128 v[8:11], v4 offset:30720
    v_mfma_f32_16x16x32_bf16 v[100:103], v[16:19], a[212:215], v[100:103]
    v_mfma_f32_16x16x32_bf16 v[104:107], v[16:19], a[216:219], v[104:107]
    v_mfma_f32_16x16x32_bf16 v[108:111], v[16:19], a[220:223], v[108:111]
    s_waitcnt lgkmcnt(3)
    v_mfma_f32_16x16x32_bf16 v[112:115], v[20:23], a[208:211], v[112:115]
    ds_read_b128 v[12:15], v4 offset:31744
    v_mfma_f32_16x16x32_bf16 v[116:119], v[20:23], a[212:215], v[116:119]
    v_mfma_f32_16x16x32_bf16 v[120:123], v[20:23], a[216:219], v[120:123]
    v_mfma_f32_16x16x32_bf16 v[124:127], v[20:23], a[220:223], v[124:127]
    s_waitcnt lgkmcnt(3)
    v_mfma_f32_16x16x32_bf16 v[96:99], v[24:27], a[224:227], v[96:99]
    ds_read_b128 v[16:19], v4 offset:32768
    v_mfma_f32_16x16x32_bf16 v[100:103], v[24:27], a[228:231], v[100:103]
    v_mfma_f32_16x16x32_bf16 v[104:107], v[24:27], a[232:235], v[104:107]
    v_mfma_f32_16x16x32_bf16 v[108:111], v[24:27], a[236:239], v[108:111]
    s_waitcnt lgkmcnt(3)
    v_mfma_f32_16x16x32_bf16 v[112:115], v[28:31], a[224:227], v[112:115]
    ds_read_b128 v[20:23], v4 offset:33792
    v_mfma_f32_16x16x32_bf16 v[116:119], v[28:31], a[228:231], v[116:119]
    v_mfma_f32_16x16x32_bf16 v[120:123], v[28:31], a[232:235], v[120:123]
    v_mfma_f32_16x16x32_bf16 v[124:127], v[28:31], a[236:239], v[124:127]
    s_waitcnt lgkmcnt(3)
    v_mfma_f32_16x16x32_bf16 v[96:99], v[8:11], a[240:243], v[96:99]
    ds_read_b128 v[24:27], v4 offset:34816
    v_mfma_f32_16x16x32_bf16 v[100:103], v[8:11], a[244:247], v[100:103]
    v_mfma_f32_16x16x32_bf16 v[104:107], v[8:11], a[248:251], v[104:107]
    v_mfma_f32_16x16x32_bf16 v[108:111], v[8:11], a[252:255], v[108:111]
    ds_read_b128 v[136:139], v5 offset:256
    ds_read_b128 v[140:143], v5 offset:320
    s_waitcnt lgkmcnt(5)
    v_mfma_f32_16x16x32_bf16 v[112:115], v[12:15], a[240:243], v[112:115]
    ds_read_b128 v[28:31], v4 offset:35840
    v_mfma_f32_16x16x32_bf16 v[116:119], v[12:15], a[244:247], v[116:119]
    v_mfma_f32_16x16x32_bf16 v[120:123], v[12:15], a[248:251], v[120:123]
    v_mfma_f32_16x16x32_bf16 v[124:127], v[12:15], a[252:255], v[124:127]
    s_waitcnt lgkmcnt(5)
    v_mfma_f32_16x16x32_bf16 v[96:99], v[16:19], v[32:35], v[96:99]
    s_waitcnt vmcnt(22)
    s_barrier
    v_mfma_f32_16x16x32_bf16 v[100:103], v[16:19], v[36:39], v[100:103]
    v_add_u32 v4, 0x9000, v4
    ds_read_b128 v[8:11], v4 offset:0
    v_mfma_f32_16x16x32_bf16 v[104:107], v[16:19], v[40:43], v[104:107]
    v_mfma_f32_16x16x32_bf16 v[108:111], v[16:19], v[44:47], v[108:111]
    s_waitcnt lgkmcnt(5)
    v_mfma_f32_16x16x32_bf16 v[112:115], v[20:23], v[32:35], v[112:115]
    ds_read_b128 v[12:15], v4 offset:1024
    v_mfma_f32_16x16x32_bf16 v[116:119], v[20:23], v[36:39], v[116:119]
    v_mfma_f32_16x16x32_bf16 v[120:123], v[20:23], v[40:43], v[120:123]
    v_mfma_f32_16x16x32_bf16 v[124:127], v[20:23], v[44:47], v[124:127]
    s_waitcnt lgkmcnt(5)
    v_mfma_f32_16x16x32_bf16 v[96:99], v[24:27], v[48:51], v[96:99]
    ds_read_b128 v[16:19], v4 offset:2048
    v_mfma_f32_16x16x32_bf16 v[100:103], v[24:27], v[52:55], v[100:103]
    v_mfma_f32_16x16x32_bf16 v[104:107], v[24:27], v[56:59], v[104:107]
    v_mfma_f32_16x16x32_bf16 v[108:111], v[24:27], v[60:63], v[108:111]
    s_waitcnt lgkmcnt(3)
    v_mfma_f32_16x16x32_bf16 v[112:115], v[28:31], v[48:51], v[112:115]
    ds_read_b128 v[20:23], v4 offset:3072
    v_mfma_f32_16x16x32_bf16 v[116:119], v[28:31], v[52:55], v[116:119]
    v_mfma_f32_16x16x32_bf16 v[120:123], v[28:31], v[56:59], v[120:123]
    v_mfma_f32_16x16x32_bf16 v[124:127], v[28:31], v[60:63], v[124:127]
    s_waitcnt lgkmcnt(3)
    v_mfma_f32_16x16x32_bf16 v[64:67], v[8:11], a[0:3], 0
    ds_read_b128 v[24:27], v4 offset:4096
    v_mfma_f32_16x16x32_bf16 v[68:71], v[8:11], a[4:7], 0
    v_mfma_f32_16x16x32_bf16 v[72:75], v[8:11], a[8:11], 0
    v_mfma_f32_16x16x32_bf16 v[76:79], v[8:11], a[12:15], 0
    s_waitcnt lgkmcnt(3)
    v_mfma_f32_16x16x32_bf16 v[80:83], v[12:15], a[0:3], 0
    ds_read_b128 v[28:31], v4 offset:5120
    v_mfma_f32_16x16x32_bf16 v[84:87], v[12:15], a[4:7], 0
    v_fmac_f32 v96, v136, v128
    v_fmac_f32 v97, v137, v128
    v_mfma_f32_16x16x32_bf16 v[88:91], v[12:15], a[8:11], 0
    v_fmac_f32 v98, v138, v128
    v_fmac_f32 v99, v139, v128
    v_mfma_f32_16x16x32_bf16 v[92:95], v[12:15], a[12:15], 0
    v_fmac_f32 v112, v140, v128
    v_fmac_f32 v113, v141, v128
    s_waitcnt lgkmcnt(3)
    v_mfma_f32_16x16x32_bf16 v[64:67], v[16:19], a[16:19], v[64:67]
    ds_read_b128 v[8:11], v4 offset:6144
    v_fmac_f32 v114, v142, v128
    v_mfma_f32_16x16x32_bf16 v[68:71], v[16:19], a[20:23], v[68:71]
    v_fmac_f32 v115, v143, v128
    v_mul_f32 v96, v96, v132
    v_mfma_f32_16x16x32_bf16 v[72:75], v[16:19], a[24:27], v[72:75]
    v_mul_f32 v97, v97, v132
    v_mul_f32 v98, v98, v132
    v_mfma_f32_16x16x32_bf16 v[76:79], v[16:19], a[28:31], v[76:79]
    v_mul_f32 v99, v99, v132
    v_mul_f32 v96, v96, v112
    s_waitcnt lgkmcnt(3)
    v_mfma_f32_16x16x32_bf16 v[80:83], v[20:23], a[16:19], v[80:83]
    ds_read_b128 v[12:15], v4 offset:7168
    v_mul_f32 v97, v97, v113
    v_mfma_f32_16x16x32_bf16 v[84:87], v[20:23], a[20:23], v[84:87]
    v_mul_f32 v98, v98, v114
    v_mul_f32 v99, v99, v115
    v_mfma_f32_16x16x32_bf16 v[88:91], v[20:23], a[24:27], v[88:91]
    v_cvt_pk_bf16_f32 v178, v96, v97
    v_cvt_pk_bf16_f32 v179, v98, v99
    v_mfma_f32_16x16x32_bf16 v[92:95], v[20:23], a[28:31], v[92:95]
    s_add_u32 s66, s51, 0
    buffer_store_dwordx4 v[176:179], v2, s[4:7], s66 offen offset:0 sc1
    s_waitcnt lgkmcnt(3)
    v_mfma_f32_16x16x32_bf16 v[64:67], v[24:27], a[32:35], v[64:67]
    ds_read_b128 v[16:19], v4 offset:8192
    v_fmac_f32 v100, v136, v129
    v_mfma_f32_16x16x32_bf16 v[68:71], v[24:27], a[36:39], v[68:71]
    v_fmac_f32 v101, v137, v129
    v_fmac_f32 v102, v138, v129
    v_mfma_f32_16x16x32_bf16 v[72:75], v[24:27], a[40:43], v[72:75]
    v_fmac_f32 v103, v139, v129
    v_fmac_f32 v116, v140, v129
    v_mfma_f32_16x16x32_bf16 v[76:79], v[24:27], a[44:47], v[76:79]
    v_fmac_f32 v117, v141, v129
    v_fmac_f32 v118, v142, v129
    s_waitcnt lgkmcnt(3)
    v_mfma_f32_16x16x32_bf16 v[80:83], v[28:31], a[32:35], v[80:83]
    ds_read_b128 v[20:23], v4 offset:9216
    v_fmac_f32 v119, v143, v129
    v_mfma_f32_16x16x32_bf16 v[84:87], v[28:31], a[36:39], v[84:87]
    v_mul_f32 v100, v100, v133
    v_mul_f32 v101, v101, v133
    v_mfma_f32_16x16x32_bf16 v[88:91], v[28:31], a[40:43], v[88:91]
    v_mul_f32 v102, v102, v133
    v_mul_f32 v103, v103, v133
    v_mfma_f32_16x16x32_bf16 v[92:95], v[28:31], a[44:47], v[92:95]
    v_mul_f32 v100, v100, v116
    v_mul_f32 v101, v101, v117
    s_waitcnt lgkmcnt(3)
    v_mfma_f32_16x16x32_bf16 v[64:67], v[8:11], a[48:51], v[64:67]
    ds_read_b128 v[24:27], v4 offset:10240
    v_mul_f32 v102, v102, v118
    v_mfma_f32_16x16x32_bf16 v[68:71], v[8:11], a[52:55], v[68:71]
    v_mul_f32 v103, v103, v119
    v_cvt_pk_bf16_f32 v182, v100, v101
    v_mfma_f32_16x16x32_bf16 v[72:75], v[8:11], a[56:59], v[72:75]
    v_cvt_pk_bf16_f32 v183, v102, v103
    buffer_store_dwordx4 v[180:183], v2, s[4:7], s66 offen offset:1024 sc1
    v_mfma_f32_16x16x32_bf16 v[76:79], v[8:11], a[60:63], v[76:79]
    v_fmac_f32 v104, v136, v130
    v_fmac_f32 v105, v137, v130
    s_waitcnt lgkmcnt(3)
    v_mfma_f32_16x16x32_bf16 v[80:83], v[12:15], a[48:51], v[80:83]
    ds_read_b128 v[28:31], v4 offset:11264
    v_fmac_f32 v106, v138, v130
    v_mfma_f32_16x16x32_bf16 v[84:87], v[12:15], a[52:55], v[84:87]
    v_fmac_f32 v107, v139, v130
    v_fmac_f32 v120, v140, v130
    v_mfma_f32_16x16x32_bf16 v[88:91], v[12:15], a[56:59], v[88:91]
    v_fmac_f32 v121, v141, v130
    v_fmac_f32 v122, v142, v130
    v_mfma_f32_16x16x32_bf16 v[92:95], v[12:15], a[60:63], v[92:95]
    v_fmac_f32 v123, v143, v130
    v_mul_f32 v104, v104, v134
    s_waitcnt lgkmcnt(3)
    v_mfma_f32_16x16x32_bf16 v[64:67], v[16:19], a[64:67], v[64:67]
    ds_read_b128 v[8:11], v4 offset:12288
    v_mul_f32 v105, v105, v134
    v_mfma_f32_16x16x32_bf16 v[68:71], v[16:19], a[68:71], v[68:71]
    v_mul_f32 v106, v106, v134
    v_mul_f32 v107, v107, v134
    v_mfma_f32_16x16x32_bf16 v[72:75], v[16:19], a[72:75], v[72:75]
    v_mul_f32 v104, v104, v120
    v_mul_f32 v105, v105, v121
    v_mfma_f32_16x16x32_bf16 v[76:79], v[16:19], a[76:79], v[76:79]
    v_mul_f32 v106, v106, v122
    v_mul_f32 v107, v107, v123
    s_waitcnt lgkmcnt(3)
    v_mfma_f32_16x16x32_bf16 v[80:83], v[20:23], a[64:67], v[80:83]
    ds_read_b128 v[12:15], v4 offset:13312
    v_cvt_pk_bf16_f32 v186, v104, v105
    v_mfma_f32_16x16x32_bf16 v[84:87], v[20:23], a[68:71], v[84:87]
    v_cvt_pk_bf16_f32 v187, v106, v107
    buffer_store_dwordx4 v[184:187], v2, s[4:7], s66 offen offset:2048 sc1
    v_mfma_f32_16x16x32_bf16 v[88:91], v[20:23], a[72:75], v[88:91]
    v_fmac_f32 v108, v136, v131
    v_fmac_f32 v109, v137, v131
    v_mfma_f32_16x16x32_bf16 v[92:95], v[20:23], a[76:79], v[92:95]
    v_fmac_f32 v110, v138, v131
    v_fmac_f32 v111, v139, v131
    s_waitcnt lgkmcnt(3)
    v_mfma_f32_16x16x32_bf16 v[64:67], v[24:27], a[80:83], v[64:67]
    ds_read_b128 v[16:19], v4 offset:14336
    v_fmac_f32 v124, v140, v131
    v_mfma_f32_16x16x32_bf16 v[68:71], v[24:27], a[84:87], v[68:71]
    v_fmac_f32 v125, v141, v131
    v_fmac_f32 v126, v142, v131
    v_mfma_f32_16x16x32_bf16 v[72:75], v[24:27], a[88:91], v[72:75]
    v_fmac_f32 v127, v143, v131
    v_mul_f32 v108, v108, v135
    v_mfma_f32_16x16x32_bf16 v[76:79], v[24:27], a[92:95], v[76:79]
    v_mul_f32 v109, v109, v135
    v_mul_f32 v110, v110, v135
    s_waitcnt lgkmcnt(3)
    v_mfma_f32_16x16x32_bf16 v[80:83], v[28:31], a[80:83], v[80:83]
    ds_read_b128 v[20:23], v4 offset:15360
    v_mul_f32 v111, v111, v135
    v_mfma_f32_16x16x32_bf16 v[84:87], v[28:31], a[84:87], v[84:87]
    v_mul_f32 v108, v108, v124
    v_mul_f32 v109, v109, v125
    v_mfma_f32_16x16x32_bf16 v[88:91], v[28:31], a[88:91], v[88:91]
    v_mul_f32 v110, v110, v126
    v_mul_f32 v111, v111, v127
    v_mfma_f32_16x16x32_bf16 v[92:95], v[28:31], a[92:95], v[92:95]
    v_cvt_pk_bf16_f32 v190, v108, v109
    v_cvt_pk_bf16_f32 v191, v110, v111
    s_waitcnt lgkmcnt(3)
    v_mfma_f32_16x16x32_bf16 v[64:67], v[8:11], a[96:99], v[64:67]
    ds_read_b128 v[24:27], v4 offset:16384
    buffer_store_dwordx4 v[188:191], v2, s[4:7], s66 offen offset:3072 sc1
    v_mfma_f32_16x16x32_bf16 v[68:71], v[8:11], a[100:103], v[68:71]
    v_mfma_f32_16x16x32_bf16 v[72:75], v[8:11], a[104:107], v[72:75]
    v_mfma_f32_16x16x32_bf16 v[76:79], v[8:11], a[108:111], v[76:79]
    s_waitcnt lgkmcnt(3)
    v_mfma_f32_16x16x32_bf16 v[80:83], v[12:15], a[96:99], v[80:83]
    ds_read_b128 v[28:31], v4 offset:17408
    v_mfma_f32_16x16x32_bf16 v[84:87], v[12:15], a[100:103], v[84:87]
    v_mfma_f32_16x16x32_bf16 v[88:91], v[12:15], a[104:107], v[88:91]
    v_mfma_f32_16x16x32_bf16 v[92:95], v[12:15], a[108:111], v[92:95]
    s_waitcnt lgkmcnt(3)
    v_mfma_f32_16x16x32_bf16 v[64:67], v[16:19], a[112:115], v[64:67]
    ds_read_b128 v[8:11], v4 offset:18432
    v_mfma_f32_16x16x32_bf16 v[68:71], v[16:19], a[116:119], v[68:71]
    v_mfma_f32_16x16x32_bf16 v[72:75], v[16:19], a[120:123], v[72:75]
    v_mfma_f32_16x16x32_bf16 v[76:79], v[16:19], a[124:127], v[76:79]
    s_waitcnt lgkmcnt(3)
    v_mfma_f32_16x16x32_bf16 v[80:83], v[20:23], a[112:115], v[80:83]
    ds_read_b128 v[12:15], v4 offset:19456
    v_mfma_f32_16x16x32_bf16 v[84:87], v[20:23], a[116:119], v[84:87]
    v_mfma_f32_16x16x32_bf16 v[88:91], v[20:23], a[120:123], v[88:91]
    v_mfma_f32_16x16x32_bf16 v[92:95], v[20:23], a[124:127], v[92:95]
    s_waitcnt lgkmcnt(3)
    v_mfma_f32_16x16x32_bf16 v[64:67], v[24:27], a[128:131], v[64:67]
    ds_read_b128 v[16:19], v4 offset:20480
    v_mfma_f32_16x16x32_bf16 v[68:71], v[24:27], a[132:135], v[68:71]
    v_mfma_f32_16x16x32_bf16 v[72:75], v[24:27], a[136:139], v[72:75]
    v_mfma_f32_16x16x32_bf16 v[76:79], v[24:27], a[140:143], v[76:79]
    s_waitcnt lgkmcnt(3)
    v_mfma_f32_16x16x32_bf16 v[80:83], v[28:31], a[128:131], v[80:83]
    ds_read_b128 v[20:23], v4 offset:21504
    v_mfma_f32_16x16x32_bf16 v[84:87], v[28:31], a[132:135], v[84:87]
    v_mfma_f32_16x16x32_bf16 v[88:91], v[28:31], a[136:139], v[88:91]
    v_mfma_f32_16x16x32_bf16 v[92:95], v[28:31], a[140:143], v[92:95]
    s_waitcnt lgkmcnt(3)
    v_mfma_f32_16x16x32_bf16 v[64:67], v[8:11], a[144:147], v[64:67]
    ds_read_b128 v[24:27], v4 offset:22528
    v_mfma_f32_16x16x32_bf16 v[68:71], v[8:11], a[148:151], v[68:71]
    v_mfma_f32_16x16x32_bf16 v[72:75], v[8:11], a[152:155], v[72:75]
    v_mfma_f32_16x16x32_bf16 v[76:79], v[8:11], a[156:159], v[76:79]
    s_waitcnt lgkmcnt(3)
    v_mfma_f32_16x16x32_bf16 v[80:83], v[12:15], a[144:147], v[80:83]
    ds_read_b128 v[28:31], v4 offset:23552
    v_mfma_f32_16x16x32_bf16 v[84:87], v[12:15], a[148:151], v[84:87]
    v_mfma_f32_16x16x32_bf16 v[88:91], v[12:15], a[152:155], v[88:91]
    v_mfma_f32_16x16x32_bf16 v[92:95], v[12:15], a[156:159], v[92:95]
    s_waitcnt lgkmcnt(3)
    v_mfma_f32_16x16x32_bf16 v[64:67], v[16:19], a[160:163], v[64:67]
    ds_read_b128 v[8:11], v4 offset:24576
    v_mfma_f32_16x16x32_bf16 v[68:71], v[16:19], a[164:167], v[68:71]
    v_mfma_f32_16x16x32_bf16 v[72:75], v[16:19], a[168:171], v[72:75]
    v_mfma_f32_16x16x32_bf16 v[76:79], v[16:19], a[172:175], v[76:79]
    s_waitcnt lgkmcnt(3)
    v_mfma_f32_16x16x32_bf16 v[80:83], v[20:23], a[160:163], v[80:83]
    ds_read_b128 v[12:15], v4 offset:25600
    v_mfma_f32_16x16x32_bf16 v[84:87], v[20:23], a[164:167], v[84:87]
    v_mfma_f32_16x16x32_bf16 v[88:91], v[20:23], a[168:171], v[88:91]
    v_mfma_f32_16x16x32_bf16 v[92:95], v[20:23], a[172:175], v[92:95]
    s_waitcnt lgkmcnt(3)
    v_mfma_f32_16x16x32_bf16 v[64:67], v[24:27], a[176:179], v[64:67]
    ds_read_b128 v[16:19], v4 offset:26624
    v_mfma_f32_16x16x32_bf16 v[68:71], v[24:27], a[180:183], v[68:71]
    v_mfma_f32_16x16x32_bf16 v[72:75], v[24:27], a[184:187], v[72:75]
    v_mfma_f32_16x16x32_bf16 v[76:79], v[24:27], a[188:191], v[76:79]
    s_waitcnt lgkmcnt(3)
    v_mfma_f32_16x16x32_bf16 v[80:83], v[28:31], a[176:179], v[80:83]
    ds_read_b128 v[20:23], v4 offset:27648
    v_mfma_f32_16x16x32_bf16 v[84:87], v[28:31], a[180:183], v[84:87]
    v_mfma_f32_16x16x32_bf16 v[88:91], v[28:31], a[184:187], v[88:91]
    v_mfma_f32_16x16x32_bf16 v[92:95], v[28:31], a[188:191], v[92:95]
    s_waitcnt lgkmcnt(3)
    v_mfma_f32_16x16x32_bf16 v[64:67], v[8:11], a[192:195], v[64:67]
    ds_read_b128 v[24:27], v4 offset:28672
    v_mfma_f32_16x16x32_bf16 v[68:71], v[8:11], a[196:199], v[68:71]
    v_mfma_f32_16x16x32_bf16 v[72:75], v[8:11], a[200:203], v[72:75]
    v_mfma_f32_16x16x32_bf16 v[76:79], v[8:11], a[204:207], v[76:79]
    s_waitcnt lgkmcnt(3)
    v_mfma_f32_16x16x32_bf16 v[80:83], v[12:15], a[192:195], v[80:83]
    ds_read_b128 v[28:31], v4 offset:29696
    v_mfma_f32_16x16x32_bf16 v[84:87], v[12:15], a[196:199], v[84:87]
    v_mfma_f32_16x16x32_bf16 v[88:91], v[12:15], a[200:203], v[88:91]
    v_mfma_f32_16x16x32_bf16 v[92:95], v[12:15], a[204:207], v[92:95]
    s_waitcnt lgkmcnt(3)
    v_mfma_f32_16x16x32_bf16 v[64:67], v[16:19], a[208:211], v[64:67]
    ds_read_b128 v[8:11], v4 offset:30720
    v_mfma_f32_16x16x32_bf16 v[68:71], v[16:19], a[212:215], v[68:71]
    v_mfma_f32_16x16x32_bf16 v[72:75], v[16:19], a[216:219], v[72:75]
    v_mfma_f32_16x16x32_bf16 v[76:79], v[16:19], a[220:223], v[76:79]
    s_waitcnt lgkmcnt(3)
    v_mfma_f32_16x16x32_bf16 v[80:83], v[20:23], a[208:211], v[80:83]
    ds_read_b128 v[12:15], v4 offset:31744
    v_mfma_f32_16x16x32_bf16 v[84:87], v[20:23], a[212:215], v[84:87]
    v_mfma_f32_16x16x32_bf16 v[88:91], v[20:23], a[216:219], v[88:91]
    v_mfma_f32_16x16x32_bf16 v[92:95], v[20:23], a[220:223], v[92:95]
    s_waitcnt lgkmcnt(3)
    v_mfma_f32_16x16x32_bf16 v[64:67], v[24:27], a[224:227], v[64:67]
    ds_read_b128 v[16:19], v4 offset:32768
    v_mfma_f32_16x16x32_bf16 v[68:71], v[24:27], a[228:231], v[68:71]
    v_mfma_f32_16x16x32_bf16 v[72:75], v[24:27], a[232:235], v[72:75]
    v_mfma_f32_16x16x32_bf16 v[76:79], v[24:27], a[236:239], v[76:79]
    s_waitcnt lgkmcnt(3)
    v_mfma_f32_16x16x32_bf16 v[80:83], v[28:31], a[224:227], v[80:83]
    ds_read_b128 v[20:23], v4 offset:33792
    v_mfma_f32_16x16x32_bf16 v[84:87], v[28:31], a[228:231], v[84:87]
    v_mfma_f32_16x16x32_bf16 v[88:91], v[28:31], a[232:235], v[88:91]
    v_mfma_f32_16x16x32_bf16 v[92:95], v[28:31], a[236:239], v[92:95]
    s_waitcnt lgkmcnt(3)
    v_mfma_f32_16x16x32_bf16 v[64:67], v[8:11], a[240:243], v[64:67]
    ds_read_b128 v[24:27], v4 offset:34816
    v_mfma_f32_16x16x32_bf16 v[68:71], v[8:11], a[244:247], v[68:71]
    v_mfma_f32_16x16x32_bf16 v[72:75], v[8:11], a[248:251], v[72:75]
    v_mfma_f32_16x16x32_bf16 v[76:79], v[8:11], a[252:255], v[76:79]
    ds_read_b128 v[144:147], v5 offset:384
    ds_read_b128 v[148:151], v5 offset:448
    s_waitcnt lgkmcnt(5)
    v_mfma_f32_16x16x32_bf16 v[80:83], v[12:15], a[240:243], v[80:83]
    ds_read_b128 v[28:31], v4 offset:35840
    v_mfma_f32_16x16x32_bf16 v[84:87], v[12:15], a[244:247], v[84:87]
    v_mfma_f32_16x16x32_bf16 v[88:91], v[12:15], a[248:251], v[88:91]
    v_mfma_f32_16x16x32_bf16 v[92:95], v[12:15], a[252:255], v[92:95]
    s_waitcnt lgkmcnt(5)
    v_mfma_f32_16x16x32_bf16 v[64:67], v[16:19], v[32:35], v[64:67]
    s_waitcnt vmcnt(17)
    s_barrier
    v_mfma_f32_16x16x32_bf16 v[68:71], v[16:19], v[36:39], v[68:71]
    v_add_u32 v4, 0xfffe5000, v4
    ds_read_b128 v[8:11], v4 offset:0
    v_mfma_f32_16x16x32_bf16 v[72:75], v[16:19], v[40:43], v[72:75]
    s_add_u32 m0, s49, 73728
    s_add_u32 s61, s48, 221184
    v_mfma_f32_16x16x32_bf16 v[76:79], v[16:19], v[44:47], v[76:79]
    buffer_load_dwordx4 v2, s[4:7], s61 offen offset:0 lds
    s_waitcnt lgkmcnt(5)
    v_mfma_f32_16x16x32_bf16 v[80:83], v[20:23], v[32:35], v[80:83]
    ds_read_b128 v[12:15], v4 offset:1024
    v_mfma_f32_16x16x32_bf16 v[84:87], v[20:23], v[36:39], v[84:87]
    v_mfma_f32_16x16x32_bf16 v[88:91], v[20:23], v[40:43], v[88:91]
    v_mfma_f32_16x16x32_bf16 v[92:95], v[20:23], v[44:47], v[92:95]
    buffer_load_dwordx4 v2, s[4:7], s61 offen offset:1024 lds
    s_waitcnt lgkmcnt(5)
    v_mfma_f32_16x16x32_bf16 v[64:67], v[24:27], v[48:51], v[64:67]
    ds_read_b128 v[16:19], v4 offset:2048
    v_mfma_f32_16x16x32_bf16 v[68:71], v[24:27], v[52:55], v[68:71]
    v_mfma_f32_16x16x32_bf16 v[72:75], v[24:27], v[56:59], v[72:75]
    v_mfma_f32_16x16x32_bf16 v[76:79], v[24:27], v[60:63], v[76:79]
    buffer_load_dwordx4 v2, s[4:7], s61 offen offset:2048 lds
    s_waitcnt lgkmcnt(3)
    v_mfma_f32_16x16x32_bf16 v[80:83], v[28:31], v[48:51], v[80:83]
    ds_read_b128 v[20:23], v4 offset:3072
    v_mfma_f32_16x16x32_bf16 v[84:87], v[28:31], v[52:55], v[84:87]
    v_mfma_f32_16x16x32_bf16 v[88:91], v[28:31], v[56:59], v[88:91]
    v_mfma_f32_16x16x32_bf16 v[92:95], v[28:31], v[60:63], v[92:95]
    buffer_load_dwordx4 v2, s[4:7], s61 offen offset:3072 lds
    s_add_u32 m0, s49, 77824
    s_waitcnt lgkmcnt(3)
    v_mfma_f32_16x16x32_bf16 v[96:99], v[8:11], a[0:3], 0
    ds_read_b128 v[24:27], v4 offset:4096
    s_add_u32 s61, s48, 225280
    v_mfma_f32_16x16x32_bf16 v[100:103], v[8:11], a[4:7], 0
    v_mfma_f32_16x16x32_bf16 v[104:107], v[8:11], a[8:11], 0
    v_mfma_f32_16x16x32_bf16 v[108:111], v[8:11], a[12:15], 0
    buffer_load_dwordx4 v2, s[4:7], s61 offen offset:0 lds
    s_waitcnt lgkmcnt(3)
    v_mfma_f32_16x16x32_bf16 v[112:115], v[12:15], a[0:3], 0
    ds_read_b128 v[28:31], v4 offset:5120
    v_mfma_f32_16x16x32_bf16 v[116:119], v[12:15], a[4:7], 0
    v_fmac_f32 v64, v144, v128
    v_fmac_f32 v65, v145, v128
    v_mfma_f32_16x16x32_bf16 v[120:123], v[12:15], a[8:11], 0
    v_fmac_f32 v66, v146, v128
    v_fmac_f32 v67, v147, v128
    v_mfma_f32_16x16x32_bf16 v[124:127], v[12:15], a[12:15], 0
    buffer_load_dwordx4 v2, s[4:7], s61 offen offset:1024 lds
    v_fmac_f32 v80, v148, v128
    s_waitcnt lgkmcnt(3)
    v_mfma_f32_16x16x32_bf16 v[96:99], v[16:19], a[16:19], v[96:99]
    ds_read_b128 v[8:11], v4 offset:6144
    v_fmac_f32 v81, v149, v128
    v_mfma_f32_16x16x32_bf16 v[100:103], v[16:19], a[20:23], v[100:103]
    v_fmac_f32 v82, v150, v128
    v_fmac_f32 v83, v151, v128
    v_mfma_f32_16x16x32_bf16 v[104:107], v[16:19], a[24:27], v[104:107]
    v_mul_f32 v64, v64, v132
    v_mul_f32 v65, v65, v132
    v_mfma_f32_16x16x32_bf16 v[108:111], v[16:19], a[28:31], v[108:111]
    buffer_load_dwordx4 v2, s[4:7], s61 offen offset:2048 lds
    v_mul_f32 v66, v66, v132
    s_waitcnt lgkmcnt(3)
    v_mfma_f32_16x16x32_bf16 v[112:115], v[20:23], a[16:19], v[112:115]
    ds_read_b128 v[12:15], v4 offset:7168
    v_mul_f32 v67, v67, v132
    v_mfma_f32_16x16x32_bf16 v[116:119], v[20:23], a[20:23], v[116:119]
    v_mul_f32 v64, v64, v80
    v_mul_f32 v65, v65, v81
    v_mfma_f32_16x16x32_bf16 v[120:123], v[20:23], a[24:27], v[120:123]
    v_mul_f32 v66, v66, v82
    v_mul_f32 v67, v67, v83
    v_mfma_f32_16x16x32_bf16 v[124:127], v[20:23], a[28:31], v[124:127]
    buffer_load_dwordx4 v2, s[4:7], s61 offen offset:3072 lds
    s_add_u32 m0, s49, 81920
    s_waitcnt lgkmcnt(3)
    v_mfma_f32_16x16x32_bf16 v[96:99], v[24:27], a[32:35], v[96:99]
    ds_read_b128 v[16:19], v4 offset:8192
    s_add_u32 s61, s48, 229376
    v_mfma_f32_16x16x32_bf16 v[100:103], v[24:27], a[36:39], v[100:103]
    v_cvt_pk_bf16_f32 v192, v64, v65
    v_cvt_pk_bf16_f32 v193, v66, v67
    v_mfma_f32_16x16x32_bf16 v[104:107], v[24:27], a[40:43], v[104:107]
    v_fmac_f32 v68, v144, v129
    v_fmac_f32 v69, v145, v129
    v_mfma_f32_16x16x32_bf16 v[108:111], v[24:27], a[44:47], v[108:111]
    buffer_load_dwordx4 v2, s[4:7], s61 offen offset:0 lds
    v_fmac_f32 v70, v146, v129
    s_waitcnt lgkmcnt(3)
    v_mfma_f32_16x16x32_bf16 v[112:115], v[28:31], a[32:35], v[112:115]
    ds_read_b128 v[20:23], v4 offset:9216
    v_fmac_f32 v71, v147, v129
    v_mfma_f32_16x16x32_bf16 v[116:119], v[28:31], a[36:39], v[116:119]
    v_fmac_f32 v84, v148, v129
    v_fmac_f32 v85, v149, v129
    v_mfma_f32_16x16x32_bf16 v[120:123], v[28:31], a[40:43], v[120:123]
    v_fmac_f32 v86, v150, v129
    v_fmac_f32 v87, v151, v129
    v_mfma_f32_16x16x32_bf16 v[124:127], v[28:31], a[44:47], v[124:127]
    v_mul_f32 v68, v68, v133
    v_mul_f32 v69, v69, v133
    s_waitcnt lgkmcnt(3)
    v_mfma_f32_16x16x32_bf16 v[96:99], v[8:11], a[48:51], v[96:99]
    ds_read_b128 v[24:27], v4 offset:10240
    v_mul_f32 v70, v70, v133
    v_mfma_f32_16x16x32_bf16 v[100:103], v[8:11], a[52:55], v[100:103]
    v_mul_f32 v71, v71, v133
    v_mul_f32 v68, v68, v84
    v_mfma_f32_16x16x32_bf16 v[104:107], v[8:11], a[56:59], v[104:107]
    v_mul_f32 v69, v69, v85
    v_mul_f32 v70, v70, v86
    v_mfma_f32_16x16x32_bf16 v[108:111], v[8:11], a[60:63], v[108:111]
    v_mul_f32 v71, v71, v87
    v_cvt_pk_bf16_f32 v196, v68, v69
    s_waitcnt lgkmcnt(3)
    v_mfma_f32_16x16x32_bf16 v[112:115], v[12:15], a[48:51], v[112:115]
    ds_read_b128 v[28:31], v4 offset:11264
    v_cvt_pk_bf16_f32 v197, v70, v71
    v_mfma_f32_16x16x32_bf16 v[116:119], v[12:15], a[52:55], v[116:119]
    v_fmac_f32 v72, v144, v130
    v_fmac_f32 v73, v145, v130
    v_mfma_f32_16x16x32_bf16 v[120:123], v[12:15], a[56:59], v[120:123]
    v_fmac_f32 v74, v146, v130
    v_fmac_f32 v75, v147, v130
    v_mfma_f32_16x16x32_bf16 v[124:127], v[12:15], a[60:63], v[124:127]
    v_fmac_f32 v88, v148, v130
    v_fmac_f32 v89, v149, v130
    s_waitcnt lgkmcnt(3)
    v_mfma_f32_16x16x32_bf16 v[96:99], v[16:19], a[64:67], v[96:99]
    ds_read_b128 v[8:11], v4 offset:12288
    v_fmac_f32 v90, v150, v130
    v_mfma_f32_16x16x32_bf16 v[100:103], v[16:19], a[68:71], v[100:103]
    v_fmac_f32 v91, v151, v130
    v_mul_f32 v72, v72, v134
    v_mfma_f32_16x16x32_bf16 v[104:107], v[16:19], a[72:75], v[104:107]
    v_mul_f32 v73, v73, v134
    v_mul_f32 v74, v74, v134
    v_mfma_f32_16x16x32_bf16 v[108:111], v[16:19], a[76:79], v[108:111]
    v_mul_f32 v75, v75, v134
    v_mul_f32 v72, v72, v88
    s_waitcnt lgkmcnt(3)
    v_mfma_f32_16x16x32_bf16 v[112:115], v[20:23], a[64:67], v[112:115]
    ds_read_b128 v[12:15], v4 offset:13312
    v_mul_f32 v73, v73, v89
    v_mfma_f32_16x16x32_bf16 v[116:119], v[20:23], a[68:71], v[116:119]
    v_mul_f32 v74, v74, v90
    v_mul_f32 v75, v75, v91
    v_mfma_f32_16x16x32_bf16 v[120:123], v[20:23], a[72:75], v[120:123]
    v_cvt_pk_bf16_f32 v200, v72, v73
    v_cvt_pk_bf16_f32 v201, v74, v75
    v_mfma_f32_16x16x32_bf16 v[124:127], v[20:23], a[76:79], v[124:127]
    v_fmac_f32 v76, v144, v131
    v_fmac_f32 v77, v145, v131
    s_waitcnt lgkmcnt(3)
    v_mfma_f32_16x16x32_bf16 v[96:99], v[24:27], a[80:83], v[96:99]
    ds_read_b128 v[16:19], v4 offset:14336
    v_fmac_f32 v78, v146, v131
    v_mfma_f32_16x16x32_bf16 v[100:103], v[24:27], a[84:87], v[100:103]
    v_fmac_f32 v79, v147, v131
    v_fmac_f32 v92, v148, v131
    v_mfma_f32_16x16x32_bf16 v[104:107], v[24:27], a[88:91], v[104:107]
    v_fmac_f32 v93, v149, v131
    v_fmac_f32 v94, v150, v131
    v_mfma_f32_16x16x32_bf16 v[108:111], v[24:27], a[92:95], v[108:111]
    v_fmac_f32 v95, v151, v131
    v_mul_f32 v76, v76, v135
    s_waitcnt lgkmcnt(3)
    v_mfma_f32_16x16x32_bf16 v[112:115], v[28:31], a[80:83], v[112:115]
    ds_read_b128 v[20:23], v4 offset:15360
    v_mul_f32 v77, v77, v135
    v_mfma_f32_16x16x32_bf16 v[116:119], v[28:31], a[84:87], v[116:119]
    v_mul_f32 v78, v78, v135
    v_mul_f32 v79, v79, v135
    v_mfma_f32_16x16x32_bf16 v[120:123], v[28:31], a[88:91], v[120:123]
    v_mul_f32 v76, v76, v92
    v_mul_f32 v77, v77, v93
    v_mfma_f32_16x16x32_bf16 v[124:127], v[28:31], a[92:95], v[124:127]
    v_mul_f32 v78, v78, v94
    v_mul_f32 v79, v79, v95
    s_waitcnt lgkmcnt(3)
    v_mfma_f32_16x16x32_bf16 v[96:99], v[8:11], a[96:99], v[96:99]
    ds_read_b128 v[24:27], v4 offset:16384
    v_cvt_pk_bf16_f32 v204, v76, v77
    v_mfma_f32_16x16x32_bf16 v[100:103], v[8:11], a[100:103], v[100:103]
    v_cvt_pk_bf16_f32 v205, v78, v79
    v_mfma_f32_16x16x32_bf16 v[104:107], v[8:11], a[104:107], v[104:107]
    v_mfma_f32_16x16x32_bf16 v[108:111], v[8:11], a[108:111], v[108:111]
    s_waitcnt lgkmcnt(3)
    v_mfma_f32_16x16x32_bf16 v[112:115], v[12:15], a[96:99], v[112:115]
    ds_read_b128 v[28:31], v4 offset:17408
    v_mfma_f32_16x16x32_bf16 v[116:119], v[12:15], a[100:103], v[116:119]
    v_mfma_f32_16x16x32_bf16 v[120:123], v[12:15], a[104:107], v[120:123]
    v_mfma_f32_16x16x32_bf16 v[124:127], v[12:15], a[108:111], v[124:127]
    s_waitcnt lgkmcnt(3)
    v_mfma_f32_16x16x32_bf16 v[96:99], v[16:19], a[112:115], v[96:99]
    ds_read_b128 v[8:11], v4 offset:18432
    v_mfma_f32_16x16x32_bf16 v[100:103], v[16:19], a[116:119], v[100:103]
    v_mfma_f32_16x16x32_bf16 v[104:107], v[16:19], a[120:123], v[104:107]
    v_mfma_f32_16x16x32_bf16 v[108:111], v[16:19], a[124:127], v[108:111]
    s_waitcnt lgkmcnt(3)
    v_mfma_f32_16x16x32_bf16 v[112:115], v[20:23], a[112:115], v[112:115]
    ds_read_b128 v[12:15], v4 offset:19456
    v_mfma_f32_16x16x32_bf16 v[116:119], v[20:23], a[116:119], v[116:119]
    v_mfma_f32_16x16x32_bf16 v[120:123], v[20:23], a[120:123], v[120:123]
    v_mfma_f32_16x16x32_bf16 v[124:127], v[20:23], a[124:127], v[124:127]
    s_waitcnt lgkmcnt(3)
    v_mfma_f32_16x16x32_bf16 v[96:99], v[24:27], a[128:131], v[96:99]
    ds_read_b128 v[16:19], v4 offset:20480
    v_mfma_f32_16x16x32_bf16 v[100:103], v[24:27], a[132:135], v[100:103]
    v_mfma_f32_16x16x32_bf16 v[104:107], v[24:27], a[136:139], v[104:107]
    v_mfma_f32_16x16x32_bf16 v[108:111], v[24:27], a[140:143], v[108:111]
    s_waitcnt lgkmcnt(3)
    v_mfma_f32_16x16x32_bf16 v[112:115], v[28:31], a[128:131], v[112:115]
    ds_read_b128 v[20:23], v4 offset:21504
    v_mfma_f32_16x16x32_bf16 v[116:119], v[28:31], a[132:135], v[116:119]
    v_mfma_f32_16x16x32_bf16 v[120:123], v[28:31], a[136:139], v[120:123]
    v_mfma_f32_16x16x32_bf16 v[124:127], v[28:31], a[140:143], v[124:127]
    s_waitcnt lgkmcnt(3)
    v_mfma_f32_16x16x32_bf16 v[96:99], v[8:11], a[144:147], v[96:99]
    ds_read_b128 v[24:27], v4 offset:22528
    v_mfma_f32_16x16x32_bf16 v[100:103], v[8:11], a[148:151], v[100:103]
    v_mfma_f32_16x16x32_bf16 v[104:107], v[8:11], a[152:155], v[104:107]
    v_mfma_f32_16x16x32_bf16 v[108:111], v[8:11], a[156:159], v[108:111]
    s_waitcnt lgkmcnt(3)
    v_mfma_f32_16x16x32_bf16 v[112:115], v[12:15], a[144:147], v[112:115]
    ds_read_b128 v[28:31], v4 offset:23552
    v_mfma_f32_16x16x32_bf16 v[116:119], v[12:15], a[148:151], v[116:119]
    v_mfma_f32_16x16x32_bf16 v[120:123], v[12:15], a[152:155], v[120:123]
    v_mfma_f32_16x16x32_bf16 v[124:127], v[12:15], a[156:159], v[124:127]
    s_waitcnt lgkmcnt(3)
    v_mfma_f32_16x16x32_bf16 v[96:99], v[16:19], a[160:163], v[96:99]
    ds_read_b128 v[8:11], v4 offset:24576
    v_mfma_f32_16x16x32_bf16 v[100:103], v[16:19], a[164:167], v[100:103]
    v_mfma_f32_16x16x32_bf16 v[104:107], v[16:19], a[168:171], v[104:107]
    v_mfma_f32_16x16x32_bf16 v[108:111], v[16:19], a[172:175], v[108:111]
    s_waitcnt lgkmcnt(3)
    v_mfma_f32_16x16x32_bf16 v[112:115], v[20:23], a[160:163], v[112:115]
    ds_read_b128 v[12:15], v4 offset:25600
    v_mfma_f32_16x16x32_bf16 v[116:119], v[20:23], a[164:167], v[116:119]
    v_mfma_f32_16x16x32_bf16 v[120:123], v[20:23], a[168:171], v[120:123]
    v_mfma_f32_16x16x32_bf16 v[124:127], v[20:23], a[172:175], v[124:127]
    s_waitcnt lgkmcnt(3)
    v_mfma_f32_16x16x32_bf16 v[96:99], v[24:27], a[176:179], v[96:99]
    ds_read_b128 v[16:19], v4 offset:26624
    v_mfma_f32_16x16x32_bf16 v[100:103], v[24:27], a[180:183], v[100:103]
    v_mfma_f32_16x16x32_bf16 v[104:107], v[24:27], a[184:187], v[104:107]
    v_mfma_f32_16x16x32_bf16 v[108:111], v[24:27], a[188:191], v[108:111]
    s_waitcnt lgkmcnt(3)
    v_mfma_f32_16x16x32_bf16 v[112:115], v[28:31], a[176:179], v[112:115]
    ds_read_b128 v[20:23], v4 offset:27648
    v_mfma_f32_16x16x32_bf16 v[116:119], v[28:31], a[180:183], v[116:119]
    v_mfma_f32_16x16x32_bf16 v[120:123], v[28:31], a[184:187], v[120:123]
    v_mfma_f32_16x16x32_bf16 v[124:127], v[28:31], a[188:191], v[124:127]
    s_waitcnt lgkmcnt(3)
    v_mfma_f32_16x16x32_bf16 v[96:99], v[8:11], a[192:195], v[96:99]
    ds_read_b128 v[24:27], v4 offset:28672
    v_mfma_f32_16x16x32_bf16 v[100:103], v[8:11], a[196:199], v[100:103]
    v_mfma_f32_16x16x32_bf16 v[104:107], v[8:11], a[200:203], v[104:107]
    v_mfma_f32_16x16x32_bf16 v[108:111], v[8:11], a[204:207], v[108:111]
    s_waitcnt lgkmcnt(3)
    v_mfma_f32_16x16x32_bf16 v[112:115], v[12:15], a[192:195], v[112:115]
    ds_read_b128 v[28:31], v4 offset:29696
    v_mfma_f32_16x16x32_bf16 v[116:119], v[12:15], a[196:199], v[116:119]
    v_mfma_f32_16x16x32_bf16 v[120:123], v[12:15], a[200:203], v[120:123]
    v_mfma_f32_16x16x32_bf16 v[124:127], v[12:15], a[204:207], v[124:127]
    s_waitcnt lgkmcnt(3)
    v_mfma_f32_16x16x32_bf16 v[96:99], v[16:19], a[208:211], v[96:99]
    ds_read_b128 v[8:11], v4 offset:30720
    v_mfma_f32_16x16x32_bf16 v[100:103], v[16:19], a[212:215], v[100:103]
    v_mfma_f32_16x16x32_bf16 v[104:107], v[16:19], a[216:219], v[104:107]
    v_mfma_f32_16x16x32_bf16 v[108:111], v[16:19], a[220:223], v[108:111]
    s_waitcnt lgkmcnt(3)
    v_mfma_f32_16x16x32_bf16 v[112:115], v[20:23], a[208:211], v[112:115]
    ds_read_b128 v[12:15], v4 offset:31744
    v_mfma_f32_16x16x32_bf16 v[116:119], v[20:23], a[212:215], v[116:119]
    v_mfma_f32_16x16x32_bf16 v[120:123], v[20:23], a[216:219], v[120:123]
    v_mfma_f32_16x16x32_bf16 v[124:127], v[20:23], a[220:223], v[124:127]
    s_waitcnt lgkmcnt(3)
    v_mfma_f32_16x16x32_bf16 v[96:99], v[24:27], a[224:227], v[96:99]
    ds_read_b128 v[16:19], v4 offset:32768
    v_mfma_f32_16x16x32_bf16 v[100:103], v[24:27], a[228:231], v[100:103]
    v_mfma_f32_16x16x32_bf16 v[104:107], v[24:27], a[232:235], v[104:107]
    v_mfma_f32_16x16x32_bf16 v[108:111], v[24:27], a[236:239], v[108:111]
    s_waitcnt lgkmcnt(3)
    v_mfma_f32_16x16x32_bf16 v[112:115], v[28:31], a[224:227], v[112:115]
    ds_read_b128 v[20:23], v4 offset:33792
    v_mfma_f32_16x16x32_bf16 v[116:119], v[28:31], a[228:231], v[116:119]
    v_mfma_f32_16x16x32_bf16 v[120:123], v[28:31], a[232:235], v[120:123]
    v_mfma_f32_16x16x32_bf16 v[124:127], v[28:31], a[236:239], v[124:127]
    s_waitcnt lgkmcnt(3)
    v_mfma_f32_16x16x32_bf16 v[96:99], v[8:11], a[240:243], v[96:99]
    ds_read_b128 v[24:27], v4 offset:34816
    v_mfma_f32_16x16x32_bf16 v[100:103], v[8:11], a[244:247], v[100:103]
    v_mfma_f32_16x16x32_bf16 v[104:107], v[8:11], a[248:251], v[104:107]
    v_mfma_f32_16x16x32_bf16 v[108:111], v[8:11], a[252:255], v[108:111]
    ds_read_b128 v[136:139], v5 offset:512
    ds_read_b128 v[140:143], v5 offset:576
    s_waitcnt lgkmcnt(5)
    v_mfma_f32_16x16x32_bf16 v[112:115], v[12:15], a[240:243], v[112:115]
    ds_read_b128 v[28:31], v4 offset:35840
    v_mfma_f32_16x16x32_bf16 v[116:119], v[12:15], a[244:247], v[116:119]
    v_mfma_f32_16x16x32_bf16 v[120:123], v[12:15], a[248:251], v[120:123]
    v_mfma_f32_16x16x32_bf16 v[124:127], v[12:15], a[252:255], v[124:127]
    s_waitcnt lgkmcnt(5)
    v_mfma_f32_16x16x32_bf16 v[96:99], v[16:19], v[32:35], v[96:99]
    s_waitcnt vmcnt(17)
    s_barrier
    v_mfma_f32_16x16x32_bf16 v[100:103], v[16:19], v[36:39], v[100:103]
    v_add_u32 v4, 0x9000, v4
    ds_read_b128 v[8:11], v4 offset:0
    v_mfma_f32_16x16x32_bf16 v[104:107], v[16:19], v[40:43], v[104:107]
    s_add_u32 m0, s49, 110592
    s_add_u32 s61, s48, 258048
    v_mfma_f32_16x16x32_bf16 v[108:111], v[16:19], v[44:47], v[108:111]
    buffer_load_dwordx4 v2, s[4:7], s61 offen offset:0 lds
    s_waitcnt lgkmcnt(5)
    v_mfma_f32_16x16x32_bf16 v[112:115], v[20:23], v[32:35], v[112:115]
    ds_read_b128 v[12:15], v4 offset:1024
    v_mfma_f32_16x16x32_bf16 v[116:119], v[20:23], v[36:39], v[116:119]
    v_mfma_f32_16x16x32_bf16 v[120:123], v[20:23], v[40:43], v[120:123]
    v_mfma_f32_16x16x32_bf16 v[124:127], v[20:23], v[44:47], v[124:127]
    buffer_load_dwordx4 v2, s[4:7], s61 offen offset:1024 lds
    s_waitcnt lgkmcnt(5)
    v_mfma_f32_16x16x32_bf16 v[96:99], v[24:27], v[48:51], v[96:99]
    ds_read_b128 v[16:19], v4 offset:2048
    v_mfma_f32_16x16x32_bf16 v[100:103], v[24:27], v[52:55], v[100:103]
    v_mfma_f32_16x16x32_bf16 v[104:107], v[24:27], v[56:59], v[104:107]
    v_mfma_f32_16x16x32_bf16 v[108:111], v[24:27], v[60:63], v[108:111]
    buffer_load_dwordx4 v2, s[4:7], s61 offen offset:2048 lds
    s_waitcnt lgkmcnt(3)
    v_mfma_f32_16x16x32_bf16 v[112:115], v[28:31], v[48:51], v[112:115]
    ds_read_b128 v[20:23], v4 offset:3072
    v_mfma_f32_16x16x32_bf16 v[116:119], v[28:31], v[52:55], v[116:119]
    v_mfma_f32_16x16x32_bf16 v[120:123], v[28:31], v[56:59], v[120:123]
    v_mfma_f32_16x16x32_bf16 v[124:127], v[28:31], v[60:63], v[124:127]
    buffer_load_dwordx4 v2, s[4:7], s61 offen offset:3072 lds
    s_add_u32 m0, s49, 114688
    s_waitcnt lgkmcnt(3)
    v_mfma_f32_16x16x32_bf16 v[64:67], v[8:11], a[0:3], 0
    ds_read_b128 v[24:27], v4 offset:4096
    s_add_u32 s61, s48, 262144
    v_mfma_f32_16x16x32_bf16 v[68:71], v[8:11], a[4:7], 0
    v_mfma_f32_16x16x32_bf16 v[72:75], v[8:11], a[8:11], 0
    v_mfma_f32_16x16x32_bf16 v[76:79], v[8:11], a[12:15], 0
    buffer_load_dwordx4 v2, s[4:7], s61 offen offset:0 lds
    s_waitcnt lgkmcnt(3)
    v_mfma_f32_16x16x32_bf16 v[80:83], v[12:15], a[0:3], 0
    ds_read_b128 v[28:31], v4 offset:5120
    v_mfma_f32_16x16x32_bf16 v[84:87], v[12:15], a[4:7], 0
    v_fmac_f32 v96, v136, v128
    v_fmac_f32 v97, v137, v128
    v_mfma_f32_16x16x32_bf16 v[88:91], v[12:15], a[8:11], 0
    v_fmac_f32 v98, v138, v128
    v_fmac_f32 v99, v139, v128
    v_mfma_f32_16x16x32_bf16 v[92:95], v[12:15], a[12:15], 0
    buffer_load_dwordx4 v2, s[4:7], s61 offen offset:1024 lds
    v_fmac_f32 v112, v140, v128
    s_waitcnt lgkmcnt(3)
    v_mfma_f32_16x16x32_bf16 v[64:67], v[16:19], a[16:19], v[64:67]
    ds_read_b128 v[8:11], v4 offset:6144
    v_fmac_f32 v113, v141, v128
    v_mfma_f32_16x16x32_bf16 v[68:71], v[16:19], a[20:23], v[68:71]
    v_fmac_f32 v114, v142, v128
    v_fmac_f32 v115, v143, v128
    v_mfma_f32_16x16x32_bf16 v[72:75], v[16:19], a[24:27], v[72:75]
    v_mul_f32 v96, v96, v132
    v_mul_f32 v97, v97, v132
    v_mfma_f32_16x16x32_bf16 v[76:79], v[16:19], a[28:31], v[76:79]
    buffer_load_dwordx4 v2, s[4:7], s61 offen offset:2048 lds
    v_mul_f32 v98, v98, v132
    s_waitcnt lgkmcnt(3)
    v_mfma_f32_16x16x32_bf16 v[80:83], v[20:23], a[16:19], v[80:83]
    ds_read_b128 v[12:15], v4 offset:7168
    v_mul_f32 v99, v99, v132
    v_mfma_f32_16x16x32_bf16 v[84:87], v[20:23], a[20:23], v[84:87]
    v_mul_f32 v96, v96, v112
    v_mul_f32 v97, v97, v113
    v_mfma_f32_16x16x32_bf16 v[88:91], v[20:23], a[24:27], v[88:91]
    v_mul_f32 v98, v98, v114
    v_mul_f32 v99, v99, v115
    v_mfma_f32_16x16x32_bf16 v[92:95], v[20:23], a[28:31], v[92:95]
    buffer_load_dwordx4 v2, s[4:7], s61 offen offset:3072 lds
    s_add_u32 m0, s49, 118784
    s_waitcnt lgkmcnt(3)
    v_mfma_f32_16x16x32_bf16 v[64:67], v[24:27], a[32:35], v[64:67]
    ds_read_b128 v[16:19], v4 offset:8192
    s_add_u32 s61, s48, 266240
    v_mfma_f32_16x16x32_bf16 v[68:71], v[24:27], a[36:39], v[68:71]
    v_cvt_pk_bf16_f32 v194, v96, v97
    v_cvt_pk_bf16_f32 v195, v98, v99
    v_mfma_f32_16x16x32_bf16 v[72:75], v[24:27], a[40:43], v[72:75]
    s_add_u32 s66, s51, 16384
    v_mfma_f32_16x16x32_bf16 v[76:79], v[24:27], a[44:47], v[76:79]
    buffer_load_dwordx4 v2, s[4:7], s61 offen offset:0 lds
    s_waitcnt lgkmcnt(3)
    v_mfma_f32_16x16x32_bf16 v[80:83], v[28:31], a[32:35], v[80:83]
    ds_read_b128 v[20:23], v4 offset:9216
    v_mfma_f32_16x16x32_bf16 v[84:87], v[28:31], a[36:39], v[84:87]
    v_mfma_f32_16x16x32_bf16 v[88:91], v[28:31], a[40:43], v[88:91]
    v_mfma_f32_16x16x32_bf16 v[92:95], v[28:31], a[44:47], v[92:95]
    buffer_store_dwordx4 v[192:195], v2, s[4:7], s66 offen offset:0 sc1
    v_fmac_f32 v100, v136, v129
    s_waitcnt lgkmcnt(3)
    v_mfma_f32_16x16x32_bf16 v[64:67], v[8:11], a[48:51], v[64:67]
    ds_read_b128 v[24:27], v4 offset:10240
    v_fmac_f32 v101, v137, v129
    v_mfma_f32_16x16x32_bf16 v[68:71], v[8:11], a[52:55], v[68:71]
    v_fmac_f32 v102, v138, v129
    v_fmac_f32 v103, v139, v129
    v_mfma_f32_16x16x32_bf16 v[72:75], v[8:11], a[56:59], v[72:75]
    v_fmac_f32 v116, v140, v129
    v_fmac_f32 v117, v141, v129
    v_mfma_f32_16x16x32_bf16 v[76:79], v[8:11], a[60:63], v[76:79]
    v_fmac_f32 v118, v142, v129
    v_fmac_f32 v119, v143, v129
    s_waitcnt lgkmcnt(3)
    v_mfma_f32_16x16x32_bf16 v[80:83], v[12:15], a[48:51], v[80:83]
    ds_read_b128 v[28:31], v4 offset:11264
    v_mul_f32 v100, v100, v133
    v_mfma_f32_16x16x32_bf16 v[84:87], v[12:15], a[52:55], v[84:87]
    v_mul_f32 v101, v101, v133
    v_mul_f32 v102, v102, v133
    v_mfma_f32_16x16x32_bf16 v[88:91], v[12:15], a[56:59], v[88:91]
    v_mul_f32 v103, v103, v133
    v_mul_f32 v100, v100, v116
    v_mfma_f32_16x16x32_bf16 v[92:95], v[12:15], a[60:63], v[92:95]
    v_mul_f32 v101, v101, v117
    v_mul_f32 v102, v102, v118
    s_waitcnt lgkmcnt(3)
    v_mfma_f32_16x16x32_bf16 v[64:67], v[16:19], a[64:67], v[64:67]
    ds_read_b128 v[8:11], v4 offset:12288
    v_mul_f32 v103, v103, v119
    v_mfma_f32_16x16x32_bf16 v[68:71], v[16:19], a[68:71], v[68:71]
    v_cvt_pk_bf16_f32 v198, v100, v101
    v_cvt_pk_bf16_f32 v199, v102, v103
    v_mfma_f32_16x16x32_bf16 v[72:75], v[16:19], a[72:75], v[72:75]
    buffer_store_dwordx4 v[196:199], v2, s[4:7], s66 offen offset:1024 sc1
    v_fmac_f32 v104, v136, v130
    v_mfma_f32_16x16x32_bf16 v[76:79], v[16:19], a[76:79], v[76:79]
    v_fmac_f32 v105, v137, v130
    v_fmac_f32 v106, v138, v130
    s_waitcnt lgkmcnt(3)
    v_mfma_f32_16x16x32_bf16 v[80:83], v[20:23], a[64:67], v[80:83]
    ds_read_b128 v[12:15], v4 offset:13312
    v_fmac_f32 v107, v139, v130
    v_mfma_f32_16x16x32_bf16 v[84:87], v[20:23], a[68:71], v[84:87]
    v_fmac_f32 v120, v140, v130
    v_fmac_f32 v121, v141, v130
    v_mfma_f32_16x16x32_bf16 v[88:91], v[20:23], a[72:75], v[88:91]
    v_fmac_f32 v122, v142, v130
    v_fmac_f32 v123, v143, v130
    v_mfma_f32_16x16x32_bf16 v[92:95], v[20:23], a[76:79], v[92:95]
    v_mul_f32 v104, v104, v134
    v_mul_f32 v105, v105, v134
    s_waitcnt lgkmcnt(3)
    v_mfma_f32_16x16x32_bf16 v[64:67], v[24:27], a[80:83], v[64:67]
    ds_read_b128 v[16:19], v4 offset:14336
    v_mul_f32 v106, v106, v134
    v_mfma_f32_16x16x32_bf16 v[68:71], v[24:27], a[84:87], v[68:71]
    v_mul_f32 v107, v107, v134
    v_mul_f32 v104, v104, v120
    v_mfma_f32_16x16x32_bf16 v[72:75], v[24:27], a[88:91], v[72:75]
    v_mul_f32 v105, v105, v121
    v_mul_f32 v106, v106, v122
    v_mfma_f32_16x16x32_bf16 v[76:79], v[24:27], a[92:95], v[76:79]
    v_mul_f32 v107, v107, v123
    v_cvt_pk_bf16_f32 v202, v104, v105
    s_waitcnt lgkmcnt(3)
    v_mfma_f32_16x16x32_bf16 v[80:83], v[28:31], a[80:83], v[80:83]
    ds_read_b128 v[20:23], v4 offset:15360
    v_cvt_pk_bf16_f32 v203, v106, v107
    v_mfma_f32_16x16x32_bf16 v[84:87], v[28:31], a[84:87], v[84:87]
    buffer_store_dwordx4 v[200:203], v2, s[4:7], s66 offen offset:2048 sc1
    v_fmac_f32 v108, v136, v131
    v_mfma_f32_16x16x32_bf16 v[88:91], v[28:31], a[88:91], v[88:91]
    v_fmac_f32 v109, v137, v131
    v_fmac_f32 v110, v138, v131
    v_mfma_f32_16x16x32_bf16 v[92:95], v[28:31], a[92:95], v[92:95]
    v_fmac_f32 v111, v139, v131
    v_fmac_f32 v124, v140, v131
    s_waitcnt lgkmcnt(3)
    v_mfma_f32_16x16x32_bf16 v[64:67], v[8:11], a[96:99], v[64:67]
    ds_read_b128 v[24:27], v4 offset:16384
    v_fmac_f32 v125, v141, v131
    v_mfma_f32_16x16x32_bf16 v[68:71], v[8:11], a[100:103], v[68:71]
    v_fmac_f32 v126, v142, v131
    v_fmac_f32 v127, v143, v131
    v_mfma_f32_16x16x32_bf16 v[72:75], v[8:11], a[104:107], v[72:75]
    v_mul_f32 v108, v108, v135
    v_mul_f32 v109, v109, v135
    v_mfma_f32_16x16x32_bf16 v[76:79], v[8:11], a[108:111], v[76:79]
    v_mul_f32 v110, v110, v135
    v_mul_f32 v111, v111, v135
    s_waitcnt lgkmcnt(3)
    v_mfma_f32_16x16x32_bf16 v[80:83], v[12:15], a[96:99], v[80:83]
    ds_read_b128 v[28:31], v4 offset:17408
    v_mul_f32 v108, v108, v124
    v_mfma_f32_16x16x32_bf16 v[84:87], v[12:15], a[100:103], v[84:87]
    v_mul_f32 v109, v109, v125
    v_mul_f32 v110, v110, v126
    v_mfma_f32_16x16x32_bf16 v[88:91], v[12:15], a[104:107], v[88:91]
    v_mul_f32 v111, v111, v127
    v_cvt_pk_bf16_f32 v206, v108, v109
    v_mfma_f32_16x16x32_bf16 v[92:95], v[12:15], a[108:111], v[92:95]
    v_cvt_pk_bf16_f32 v207, v110, v111
    buffer_store_dwordx4 v[204:207], v2, s[4:7], s66 offen offset:3072 sc1
    s_waitcnt lgkmcnt(3)
    v_mfma_f32_16x16x32_bf16 v[64:67], v[16:19], a[112:115], v[64:67]
    ds_read_b128 v[8:11], v4 offset:18432
    v_mfma_f32_16x16x32_bf16 v[68:71], v[16:19], a[116:119], v[68:71]
    v_mfma_f32_16x16x32_bf16 v[72:75], v[16:19], a[120:123], v[72:75]
    v_mfma_f32_16x16x32_bf16 v[76:79], v[16:19], a[124:127], v[76:79]
    s_waitcnt lgkmcnt(3)
    v_mfma_f32_16x16x32_bf16 v[80:83], v[20:23], a[112:115], v[80:83]
    ds_read_b128 v[12:15], v4 offset:19456
    v_mfma_f32_16x16x32_bf16 v[84:87], v[20:23], a[116:119], v[84:87]
    v_mfma_f32_16x16x32_bf16 v[88:91], v[20:23], a[120:123], v[88:91]
    v_mfma_f32_16x16x32_bf16 v[92:95], v[20:23], a[124:127], v[92:95]
    s_waitcnt lgkmcnt(3)
    v_mfma_f32_16x16x32_bf16 v[64:67], v[24:27], a[128:131], v[64:67]
    ds_read_b128 v[16:19], v4 offset:20480
    v_mfma_f32_16x16x32_bf16 v[68:71], v[24:27], a[132:135], v[68:71]
    v_mfma_f32_16x16x32_bf16 v[72:75], v[24:27], a[136:139], v[72:75]
    v_mfma_f32_16x16x32_bf16 v[76:79], v[24:27], a[140:143], v[76:79]
    s_waitcnt lgkmcnt(3)
    v_mfma_f32_16x16x32_bf16 v[80:83], v[28:31], a[128:131], v[80:83]
    ds_read_b128 v[20:23], v4 offset:21504
    v_mfma_f32_16x16x32_bf16 v[84:87], v[28:31], a[132:135], v[84:87]
    v_mfma_f32_16x16x32_bf16 v[88:91], v[28:31], a[136:139], v[88:91]
    v_mfma_f32_16x16x32_bf16 v[92:95], v[28:31], a[140:143], v[92:95]
    s_waitcnt lgkmcnt(3)
    v_mfma_f32_16x16x32_bf16 v[64:67], v[8:11], a[144:147], v[64:67]
    ds_read_b128 v[24:27], v4 offset:22528
    v_mfma_f32_16x16x32_bf16 v[68:71], v[8:11], a[148:151], v[68:71]
    v_mfma_f32_16x16x32_bf16 v[72:75], v[8:11], a[152:155], v[72:75]
    v_mfma_f32_16x16x32_bf16 v[76:79], v[8:11], a[156:159], v[76:79]
    s_waitcnt lgkmcnt(3)
    v_mfma_f32_16x16x32_bf16 v[80:83], v[12:15], a[144:147], v[80:83]
    ds_read_b128 v[28:31], v4 offset:23552
    v_mfma_f32_16x16x32_bf16 v[84:87], v[12:15], a[148:151], v[84:87]
    v_mfma_f32_16x16x32_bf16 v[88:91], v[12:15], a[152:155], v[88:91]
    v_mfma_f32_16x16x32_bf16 v[92:95], v[12:15], a[156:159], v[92:95]
    s_waitcnt lgkmcnt(3)
    v_mfma_f32_16x16x32_bf16 v[64:67], v[16:19], a[160:163], v[64:67]
    ds_read_b128 v[8:11], v4 offset:24576
    v_mfma_f32_16x16x32_bf16 v[68:71], v[16:19], a[164:167], v[68:71]
    v_mfma_f32_16x16x32_bf16 v[72:75], v[16:19], a[168:171], v[72:75]
    v_mfma_f32_16x16x32_bf16 v[76:79], v[16:19], a[172:175], v[76:79]
    s_waitcnt lgkmcnt(3)
    v_mfma_f32_16x16x32_bf16 v[80:83], v[20:23], a[160:163], v[80:83]
    ds_read_b128 v[12:15], v4 offset:25600
    v_mfma_f32_16x16x32_bf16 v[84:87], v[20:23], a[164:167], v[84:87]
    v_mfma_f32_16x16x32_bf16 v[88:91], v[20:23], a[168:171], v[88:91]
    v_mfma_f32_16x16x32_bf16 v[92:95], v[20:23], a[172:175], v[92:95]
    s_waitcnt lgkmcnt(3)
    v_mfma_f32_16x16x32_bf16 v[64:67], v[24:27], a[176:179], v[64:67]
    ds_read_b128 v[16:19], v4 offset:26624
    v_mfma_f32_16x16x32_bf16 v[68:71], v[24:27], a[180:183], v[68:71]
    v_mfma_f32_16x16x32_bf16 v[72:75], v[24:27], a[184:187], v[72:75]
    v_mfma_f32_16x16x32_bf16 v[76:79], v[24:27], a[188:191], v[76:79]
    s_waitcnt lgkmcnt(3)
    v_mfma_f32_16x16x32_bf16 v[80:83], v[28:31], a[176:179], v[80:83]
    ds_read_b128 v[20:23], v4 offset:27648
    v_mfma_f32_16x16x32_bf16 v[84:87], v[28:31], a[180:183], v[84:87]
    v_mfma_f32_16x16x32_bf16 v[88:91], v[28:31], a[184:187], v[88:91]
    v_mfma_f32_16x16x32_bf16 v[92:95], v[28:31], a[188:191], v[92:95]
    s_waitcnt lgkmcnt(3)
    v_mfma_f32_16x16x32_bf16 v[64:67], v[8:11], a[192:195], v[64:67]
    ds_read_b128 v[24:27], v4 offset:28672
    v_mfma_f32_16x16x32_bf16 v[68:71], v[8:11], a[196:199], v[68:71]
    v_mfma_f32_16x16x32_bf16 v[72:75], v[8:11], a[200:203], v[72:75]
    v_mfma_f32_16x16x32_bf16 v[76:79], v[8:11], a[204:207], v[76:79]
    s_waitcnt lgkmcnt(3)
    v_mfma_f32_16x16x32_bf16 v[80:83], v[12:15], a[192:195], v[80:83]
    ds_read_b128 v[28:31], v4 offset:29696
    v_mfma_f32_16x16x32_bf16 v[84:87], v[12:15], a[196:199], v[84:87]
    v_mfma_f32_16x16x32_bf16 v[88:91], v[12:15], a[200:203], v[88:91]
    v_mfma_f32_16x16x32_bf16 v[92:95], v[12:15], a[204:207], v[92:95]
    s_waitcnt lgkmcnt(3)
    v_mfma_f32_16x16x32_bf16 v[64:67], v[16:19], a[208:211], v[64:67]
    ds_read_b128 v[8:11], v4 offset:30720
    v_mfma_f32_16x16x32_bf16 v[68:71], v[16:19], a[212:215], v[68:71]
    v_mfma_f32_16x16x32_bf16 v[72:75], v[16:19], a[216:219], v[72:75]
    v_mfma_f32_16x16x32_bf16 v[76:79], v[16:19], a[220:223], v[76:79]
    s_waitcnt lgkmcnt(3)
    v_mfma_f32_16x16x32_bf16 v[80:83], v[20:23], a[208:211], v[80:83]
    ds_read_b128 v[12:15], v4 offset:31744
    v_mfma_f32_16x16x32_bf16 v[84:87], v[20:23], a[212:215], v[84:87]
    v_mfma_f32_16x16x32_bf16 v[88:91], v[20:23], a[216:219], v[88:91]
    v_mfma_f32_16x16x32_bf16 v[92:95], v[20:23], a[220:223], v[92:95]
    s_waitcnt lgkmcnt(3)
    v_mfma_f32_16x16x32_bf16 v[64:67], v[24:27], a[224:227], v[64:67]
    ds_read_b128 v[16:19], v4 offset:32768
    v_mfma_f32_16x16x32_bf16 v[68:71], v[24:27], a[228:231], v[68:71]
    v_mfma_f32_16x16x32_bf16 v[72:75], v[24:27], a[232:235], v[72:75]
    v_mfma_f32_16x16x32_bf16 v[76:79], v[24:27], a[236:239], v[76:79]
    s_waitcnt lgkmcnt(3)
    v_mfma_f32_16x16x32_bf16 v[80:83], v[28:31], a[224:227], v[80:83]
    ds_read_b128 v[20:23], v4 offset:33792
    v_mfma_f32_16x16x32_bf16 v[84:87], v[28:31], a[228:231], v[84:87]
    v_mfma_f32_16x16x32_bf16 v[88:91], v[28:31], a[232:235], v[88:91]
    v_mfma_f32_16x16x32_bf16 v[92:95], v[28:31], a[236:239], v[92:95]
    s_waitcnt lgkmcnt(3)
    v_mfma_f32_16x16x32_bf16 v[64:67], v[8:11], a[240:243], v[64:67]
    ds_read_b128 v[24:27], v4 offset:34816
    v_mfma_f32_16x16x32_bf16 v[68:71], v[8:11], a[244:247], v[68:71]
    v_mfma_f32_16x16x32_bf16 v[72:75], v[8:11], a[248:251], v[72:75]
    v_mfma_f32_16x16x32_bf16 v[76:79], v[8:11], a[252:255], v[76:79]
    ds_read_b128 v[144:147], v5 offset:640
    ds_read_b128 v[148:151], v5 offset:704
    s_waitcnt lgkmcnt(5)
    v_mfma_f32_16x16x32_bf16 v[80:83], v[12:15], a[240:243], v[80:83]
    ds_read_b128 v[28:31], v4 offset:35840
    v_mfma_f32_16x16x32_bf16 v[84:87], v[12:15], a[244:247], v[84:87]
    v_mfma_f32_16x16x32_bf16 v[88:91], v[12:15], a[248:251], v[88:91]
    v_mfma_f32_16x16x32_bf16 v[92:95], v[12:15], a[252:255], v[92:95]
    s_waitcnt lgkmcnt(5)
    v_mfma_f32_16x16x32_bf16 v[64:67], v[16:19], v[32:35], v[64:67]
    s_waitcnt vmcnt(13)
    s_barrier
    v_mfma_f32_16x16x32_bf16 v[68:71], v[16:19], v[36:39], v[68:71]
    v_add_u32 v4, 0x9000, v4
    ds_read_b128 v[8:11], v4 offset:0
    v_mfma_f32_16x16x32_bf16 v[72:75], v[16:19], v[40:43], v[72:75]
    s_add_u32 m0, s49, 0
    s_add_u32 s61, s48, 294912
    v_mfma_f32_16x16x32_bf16 v[76:79], v[16:19], v[44:47], v[76:79]
    buffer_load_dwordx4 v2, s[4:7], s61 offen offset:0 lds
    s_waitcnt lgkmcnt(5)
    v_mfma_f32_16x16x32_bf16 v[80:83], v[20:23], v[32:35], v[80:83]
    ds_read_b128 v[12:15], v4 offset:1024
    v_mfma_f32_16x16x32_bf16 v[84:87], v[20:23], v[36:39], v[84:87]
    v_mfma_f32_16x16x32_bf16 v[88:91], v[20:23], v[40:43], v[88:91]
    v_mfma_f32_16x16x32_bf16 v[92:95], v[20:23], v[44:47], v[92:95]
    buffer_load_dwordx4 v2, s[4:7], s61 offen offset:1024 lds
    s_waitcnt lgkmcnt(5)
    v_mfma_f32_16x16x32_bf16 v[64:67], v[24:27], v[48:51], v[64:67]
    ds_read_b128 v[16:19], v4 offset:2048
    v_mfma_f32_16x16x32_bf16 v[68:71], v[24:27], v[52:55], v[68:71]
    v_mfma_f32_16x16x32_bf16 v[72:75], v[24:27], v[56:59], v[72:75]
    v_mfma_f32_16x16x32_bf16 v[76:79], v[24:27], v[60:63], v[76:79]
    buffer_load_dwordx4 v2, s[4:7], s61 offen offset:2048 lds
    s_waitcnt lgkmcnt(3)
    v_mfma_f32_16x16x32_bf16 v[80:83], v[28:31], v[48:51], v[80:83]
    ds_read_b128 v[20:23], v4 offset:3072
    v_mfma_f32_16x16x32_bf16 v[84:87], v[28:31], v[52:55], v[84:87]
    v_mfma_f32_16x16x32_bf16 v[88:91], v[28:31], v[56:59], v[88:91]
    v_mfma_f32_16x16x32_bf16 v[92:95], v[28:31], v[60:63], v[92:95]
    buffer_load_dwordx4 v2, s[4:7], s61 offen offset:3072 lds
    s_add_u32 m0, s49, 4096
    s_waitcnt lgkmcnt(3)
    v_mfma_f32_16x16x32_bf16 v[96:99], v[8:11], a[0:3], 0
    ds_read_b128 v[24:27], v4 offset:4096
    s_add_u32 s61, s48, 299008
    v_mfma_f32_16x16x32_bf16 v[100:103], v[8:11], a[4:7], 0
    v_mfma_f32_16x16x32_bf16 v[104:107], v[8:11], a[8:11], 0
    v_mfma_f32_16x16x32_bf16 v[108:111], v[8:11], a[12:15], 0
    buffer_load_dwordx4 v2, s[4:7], s61 offen offset:0 lds
    s_waitcnt lgkmcnt(3)
    v_mfma_f32_16x16x32_bf16 v[112:115], v[12:15], a[0:3], 0
    ds_read_b128 v[28:31], v4 offset:5120
    v_mfma_f32_16x16x32_bf16 v[116:119], v[12:15], a[4:7], 0
    v_fmac_f32 v64, v144, v128
    v_fmac_f32 v65, v145, v128
    v_mfma_f32_16x16x32_bf16 v[120:123], v[12:15], a[8:11], 0
    v_fmac_f32 v66, v146, v128
    v_fmac_f32 v67, v147, v128
    v_mfma_f32_16x16x32_bf16 v[124:127], v[12:15], a[12:15], 0
    buffer_load_dwordx4 v2, s[4:7], s61 offen offset:1024 lds
    v_fmac_f32 v80, v148, v128
    s_waitcnt lgkmcnt(3)
    v_mfma_f32_16x16x32_bf16 v[96:99], v[16:19], a[16:19], v[96:99]
    ds_read_b128 v[8:11], v4 offset:6144
    v_fmac_f32 v81, v149, v128
    v_mfma_f32_16x16x32_bf16 v[100:103], v[16:19], a[20:23], v[100:103]
    v_fmac_f32 v82, v150, v128
    v_fmac_f32 v83, v151, v128
    v_mfma_f32_16x16x32_bf16 v[104:107], v[16:19], a[24:27], v[104:107]
    v_mul_f32 v64, v64, v132
    v_mul_f32 v65, v65, v132
    v_mfma_f32_16x16x32_bf16 v[108:111], v[16:19], a[28:31], v[108:111]
    buffer_load_dwordx4 v2, s[4:7], s61 offen offset:2048 lds
    v_mul_f32 v66, v66, v132
    s_waitcnt lgkmcnt(3)
    v_mfma_f32_16x16x32_bf16 v[112:115], v[20:23], a[16:19], v[112:115]
    ds_read_b128 v[12:15], v4 offset:7168
    v_mul_f32 v67, v67, v132
    v_mfma_f32_16x16x32_bf16 v[116:119], v[20:23], a[20:23], v[116:119]
    v_mul_f32 v64, v64, v80
    v_mul_f32 v65, v65, v81
    v_mfma_f32_16x16x32_bf16 v[120:123], v[20:23], a[24:27], v[120:123]
    v_mul_f32 v66, v66, v82
    v_mul_f32 v67, v67, v83
    v_mfma_f32_16x16x32_bf16 v[124:127], v[20:23], a[28:31], v[124:127]
    buffer_load_dwordx4 v2, s[4:7], s61 offen offset:3072 lds
    s_add_u32 m0, s49, 8192
    s_waitcnt lgkmcnt(3)
    v_mfma_f32_16x16x32_bf16 v[96:99], v[24:27], a[32:35], v[96:99]
    ds_read_b128 v[16:19], v4 offset:8192
    s_add_u32 s61, s48, 303104
    v_mfma_f32_16x16x32_bf16 v[100:103], v[24:27], a[36:39], v[100:103]
    v_cvt_pk_bf16_f32 v208, v64, v65
    v_cvt_pk_bf16_f32 v209, v66, v67
    v_mfma_f32_16x16x32_bf16 v[104:107], v[24:27], a[40:43], v[104:107]
    v_fmac_f32 v68, v144, v129
    v_fmac_f32 v69, v145, v129
    v_mfma_f32_16x16x32_bf16 v[108:111], v[24:27], a[44:47], v[108:111]
    buffer_load_dwordx4 v2, s[4:7], s61 offen offset:0 lds
    v_fmac_f32 v70, v146, v129
    s_waitcnt lgkmcnt(3)
    v_mfma_f32_16x16x32_bf16 v[112:115], v[28:31], a[32:35], v[112:115]
    ds_read_b128 v[20:23], v4 offset:9216
    v_fmac_f32 v71, v147, v129
    v_mfma_f32_16x16x32_bf16 v[116:119], v[28:31], a[36:39], v[116:119]
    v_fmac_f32 v84, v148, v129
    v_fmac_f32 v85, v149, v129
    v_mfma_f32_16x16x32_bf16 v[120:123], v[28:31], a[40:43], v[120:123]
    v_fmac_f32 v86, v150, v129
    v_fmac_f32 v87, v151, v129
    v_mfma_f32_16x16x32_bf16 v[124:127], v[28:31], a[44:47], v[124:127]
    v_mul_f32 v68, v68, v133
    v_mul_f32 v69, v69, v133
    s_waitcnt lgkmcnt(3)
    v_mfma_f32_16x16x32_bf16 v[96:99], v[8:11], a[48:51], v[96:99]
    ds_read_b128 v[24:27], v4 offset:10240
    v_mul_f32 v70, v70, v133
    v_mfma_f32_16x16x32_bf16 v[100:103], v[8:11], a[52:55], v[100:103]
    v_mul_f32 v71, v71, v133
    v_mul_f32 v68, v68, v84
    v_mfma_f32_16x16x32_bf16 v[104:107], v[8:11], a[56:59], v[104:107]
    v_mul_f32 v69, v69, v85
    v_mul_f32 v70, v70, v86
    v_mfma_f32_16x16x32_bf16 v[108:111], v[8:11], a[60:63], v[108:111]
    v_mul_f32 v71, v71, v87
    v_cvt_pk_bf16_f32 v212, v68, v69
    s_waitcnt lgkmcnt(3)
    v_mfma_f32_16x16x32_bf16 v[112:115], v[12:15], a[48:51], v[112:115]
    ds_read_b128 v[28:31], v4 offset:11264
    v_cvt_pk_bf16_f32 v213, v70, v71
    v_mfma_f32_16x16x32_bf16 v[116:119], v[12:15], a[52:55], v[116:119]
    v_fmac_f32 v72, v144, v130
    v_fmac_f32 v73, v145, v130
    v_mfma_f32_16x16x32_bf16 v[120:123], v[12:15], a[56:59], v[120:123]
    v_fmac_f32 v74, v146, v130
    v_fmac_f32 v75, v147, v130
    v_mfma_f32_16x16x32_bf16 v[124:127], v[12:15], a[60:63], v[124:127]
    v_fmac_f32 v88, v148, v130
    v_fmac_f32 v89, v149, v130
    s_waitcnt lgkmcnt(3)
    v_mfma_f32_16x16x32_bf16 v[96:99], v[16:19], a[64:67], v[96:99]
    ds_read_b128 v[8:11], v4 offset:12288
    v_fmac_f32 v90, v150, v130
    v_mfma_f32_16x16x32_bf16 v[100:103], v[16:19], a[68:71], v[100:103]
    v_fmac_f32 v91, v151, v130
    v_mul_f32 v72, v72, v134
    v_mfma_f32_16x16x32_bf16 v[104:107], v[16:19], a[72:75], v[104:107]
    v_mul_f32 v73, v73, v134
    v_mul_f32 v74, v74, v134
    v_mfma_f32_16x16x32_bf16 v[108:111], v[16:19], a[76:79], v[108:111]
    v_mul_f32 v75, v75, v134
    v_mul_f32 v72, v72, v88
    s_waitcnt lgkmcnt(3)
    v_mfma_f32_16x16x32_bf16 v[112:115], v[20:23], a[64:67], v[112:115]
    ds_read_b128 v[12:15], v4 offset:13312
    v_mul_f32 v73, v73, v89
    v_mfma_f32_16x16x32_bf16 v[116:119], v[20:23], a[68:71], v[116:119]
    v_mul_f32 v74, v74, v90
    v_mul_f32 v75, v75, v91
    v_mfma_f32_16x16x32_bf16 v[120:123], v[20:23], a[72:75], v[120:123]
    v_cvt_pk_bf16_f32 v216, v72, v73
    v_cvt_pk_bf16_f32 v217, v74, v75
    v_mfma_f32_16x16x32_bf16 v[124:127], v[20:23], a[76:79], v[124:127]
    v_fmac_f32 v76, v144, v131
    v_fmac_f32 v77, v145, v131
    s_waitcnt lgkmcnt(3)
    v_mfma_f32_16x16x32_bf16 v[96:99], v[24:27], a[80:83], v[96:99]
    ds_read_b128 v[16:19], v4 offset:14336
    v_fmac_f32 v78, v146, v131
    v_mfma_f32_16x16x32_bf16 v[100:103], v[24:27], a[84:87], v[100:103]
    v_fmac_f32 v79, v147, v131
    v_fmac_f32 v92, v148, v131
    v_mfma_f32_16x16x32_bf16 v[104:107], v[24:27], a[88:91], v[104:107]
    v_fmac_f32 v93, v149, v131
    v_fmac_f32 v94, v150, v131
    v_mfma_f32_16x16x32_bf16 v[108:111], v[24:27], a[92:95], v[108:111]
    v_fmac_f32 v95, v151, v131
    v_mul_f32 v76, v76, v135
    s_waitcnt lgkmcnt(3)
    v_mfma_f32_16x16x32_bf16 v[112:115], v[28:31], a[80:83], v[112:115]
    ds_read_b128 v[20:23], v4 offset:15360
    v_mul_f32 v77, v77, v135
    v_mfma_f32_16x16x32_bf16 v[116:119], v[28:31], a[84:87], v[116:119]
    v_mul_f32 v78, v78, v135
    v_mul_f32 v79, v79, v135
    v_mfma_f32_16x16x32_bf16 v[120:123], v[28:31], a[88:91], v[120:123]
    v_mul_f32 v76, v76, v92
    v_mul_f32 v77, v77, v93
    v_mfma_f32_16x16x32_bf16 v[124:127], v[28:31], a[92:95], v[124:127]
    v_mul_f32 v78, v78, v94
    v_mul_f32 v79, v79, v95
    s_waitcnt lgkmcnt(3)
    v_mfma_f32_16x16x32_bf16 v[96:99], v[8:11], a[96:99], v[96:99]
    ds_read_b128 v[24:27], v4 offset:16384
    v_cvt_pk_bf16_f32 v220, v76, v77
    v_mfma_f32_16x16x32_bf16 v[100:103], v[8:11], a[100:103], v[100:103]
    v_cvt_pk_bf16_f32 v221, v78, v79
    v_mfma_f32_16x16x32_bf16 v[104:107], v[8:11], a[104:107], v[104:107]
    v_mfma_f32_16x16x32_bf16 v[108:111], v[8:11], a[108:111], v[108:111]
    s_waitcnt lgkmcnt(3)
    v_mfma_f32_16x16x32_bf16 v[112:115], v[12:15], a[96:99], v[112:115]
    ds_read_b128 v[28:31], v4 offset:17408
    v_mfma_f32_16x16x32_bf16 v[116:119], v[12:15], a[100:103], v[116:119]
    v_mfma_f32_16x16x32_bf16 v[120:123], v[12:15], a[104:107], v[120:123]
    v_mfma_f32_16x16x32_bf16 v[124:127], v[12:15], a[108:111], v[124:127]
    s_waitcnt lgkmcnt(3)
    v_mfma_f32_16x16x32_bf16 v[96:99], v[16:19], a[112:115], v[96:99]
    ds_read_b128 v[8:11], v4 offset:18432
    v_mfma_f32_16x16x32_bf16 v[100:103], v[16:19], a[116:119], v[100:103]
    v_mov_b32 v6, 1
    v_mov_b32 v0, 0
    v_mfma_f32_16x16x32_bf16 v[104:107], v[16:19], a[120:123], v[104:107]
    v_mfma_f32_16x16x32_bf16 v[108:111], v[16:19], a[124:127], v[108:111]
    s_waitcnt vmcnt(9)
    s_waitcnt lgkmcnt(3)
    v_mfma_f32_16x16x32_bf16 v[112:115], v[20:23], a[112:115], v[112:115]
    ds_read_b128 v[12:15], v4 offset:19456
    v_mfma_f32_16x16x32_bf16 v[116:119], v[20:23], a[116:119], v[116:119]
    s_mov_b64 exec, 1
    buffer_store_dword v6, v0, s[4:7], s67 offen sc1
    s_mov_b64 exec, -1
    v_mfma_f32_16x16x32_bf16 v[120:123], v[20:23], a[120:123], v[120:123]
    v_mfma_f32_16x16x32_bf16 v[124:127], v[20:23], a[124:127], v[124:127]
    s_waitcnt lgkmcnt(3)
    v_mfma_f32_16x16x32_bf16 v[96:99], v[24:27], a[128:131], v[96:99]
    ds_read_b128 v[16:19], v4 offset:20480
    v_mfma_f32_16x16x32_bf16 v[100:103], v[24:27], a[132:135], v[100:103]
    v_mfma_f32_16x16x32_bf16 v[104:107], v[24:27], a[136:139], v[104:107]
    v_mfma_f32_16x16x32_bf16 v[108:111], v[24:27], a[140:143], v[108:111]
    s_waitcnt lgkmcnt(3)
    v_mfma_f32_16x16x32_bf16 v[112:115], v[28:31], a[128:131], v[112:115]
    ds_read_b128 v[20:23], v4 offset:21504
    v_mfma_f32_16x16x32_bf16 v[116:119], v[28:31], a[132:135], v[116:119]
    v_mfma_f32_16x16x32_bf16 v[120:123], v[28:31], a[136:139], v[120:123]
    v_mfma_f32_16x16x32_bf16 v[124:127], v[28:31], a[140:143], v[124:127]
    s_waitcnt lgkmcnt(3)
    v_mfma_f32_16x16x32_bf16 v[96:99], v[8:11], a[144:147], v[96:99]
    ds_read_b128 v[24:27], v4 offset:22528
    v_mfma_f32_16x16x32_bf16 v[100:103], v[8:11], a[148:151], v[100:103]
    v_mfma_f32_16x16x32_bf16 v[104:107], v[8:11], a[152:155], v[104:107]
    v_mfma_f32_16x16x32_bf16 v[108:111], v[8:11], a[156:159], v[108:111]
    s_waitcnt lgkmcnt(3)
    v_mfma_f32_16x16x32_bf16 v[112:115], v[12:15], a[144:147], v[112:115]
    ds_read_b128 v[28:31], v4 offset:23552
    v_mfma_f32_16x16x32_bf16 v[116:119], v[12:15], a[148:151], v[116:119]
    v_mfma_f32_16x16x32_bf16 v[120:123], v[12:15], a[152:155], v[120:123]
    v_mfma_f32_16x16x32_bf16 v[124:127], v[12:15], a[156:159], v[124:127]
    s_waitcnt lgkmcnt(3)
    v_mfma_f32_16x16x32_bf16 v[96:99], v[16:19], a[160:163], v[96:99]
    ds_read_b128 v[8:11], v4 offset:24576
    v_mfma_f32_16x16x32_bf16 v[100:103], v[16:19], a[164:167], v[100:103]
    v_mfma_f32_16x16x32_bf16 v[104:107], v[16:19], a[168:171], v[104:107]
    v_mfma_f32_16x16x32_bf16 v[108:111], v[16:19], a[172:175], v[108:111]
    s_waitcnt lgkmcnt(3)
    v_mfma_f32_16x16x32_bf16 v[112:115], v[20:23], a[160:163], v[112:115]
    ds_read_b128 v[12:15], v4 offset:25600
    v_mfma_f32_16x16x32_bf16 v[116:119], v[20:23], a[164:167], v[116:119]
    v_mfma_f32_16x16x32_bf16 v[120:123], v[20:23], a[168:171], v[120:123]
    v_mfma_f32_16x16x32_bf16 v[124:127], v[20:23], a[172:175], v[124:127]
    s_waitcnt lgkmcnt(3)
    v_mfma_f32_16x16x32_bf16 v[96:99], v[24:27], a[176:179], v[96:99]
    ds_read_b128 v[16:19], v4 offset:26624
    v_mfma_f32_16x16x32_bf16 v[100:103], v[24:27], a[180:183], v[100:103]
    v_mfma_f32_16x16x32_bf16 v[104:107], v[24:27], a[184:187], v[104:107]
    v_mfma_f32_16x16x32_bf16 v[108:111], v[24:27], a[188:191], v[108:111]
    s_waitcnt lgkmcnt(3)
    v_mfma_f32_16x16x32_bf16 v[112:115], v[28:31], a[176:179], v[112:115]
    ds_read_b128 v[20:23], v4 offset:27648
    v_mfma_f32_16x16x32_bf16 v[116:119], v[28:31], a[180:183], v[116:119]
    v_mfma_f32_16x16x32_bf16 v[120:123], v[28:31], a[184:187], v[120:123]
    v_mfma_f32_16x16x32_bf16 v[124:127], v[28:31], a[188:191], v[124:127]
    s_waitcnt lgkmcnt(3)
    v_mfma_f32_16x16x32_bf16 v[96:99], v[8:11], a[192:195], v[96:99]
    ds_read_b128 v[24:27], v4 offset:28672
    v_mfma_f32_16x16x32_bf16 v[100:103], v[8:11], a[196:199], v[100:103]
    v_mfma_f32_16x16x32_bf16 v[104:107], v[8:11], a[200:203], v[104:107]
    v_mfma_f32_16x16x32_bf16 v[108:111], v[8:11], a[204:207], v[108:111]
    s_waitcnt lgkmcnt(3)
    v_mfma_f32_16x16x32_bf16 v[112:115], v[12:15], a[192:195], v[112:115]
    ds_read_b128 v[28:31], v4 offset:29696
    v_mfma_f32_16x16x32_bf16 v[116:119], v[12:15], a[196:199], v[116:119]
    v_mfma_f32_16x16x32_bf16 v[120:123], v[12:15], a[200:203], v[120:123]
    v_mfma_f32_16x16x32_bf16 v[124:127], v[12:15], a[204:207], v[124:127]
    s_waitcnt lgkmcnt(3)
    v_mfma_f32_16x16x32_bf16 v[96:99], v[16:19], a[208:211], v[96:99]
    ds_read_b128 v[8:11], v4 offset:30720
    v_mfma_f32_16x16x32_bf16 v[100:103], v[16:19], a[212:215], v[100:103]
    v_mfma_f32_16x16x32_bf16 v[104:107], v[16:19], a[216:219], v[104:107]
    v_mfma_f32_16x16x32_bf16 v[108:111], v[16:19], a[220:223], v[108:111]
    s_waitcnt lgkmcnt(3)
    v_mfma_f32_16x16x32_bf16 v[112:115], v[20:23], a[208:211], v[112:115]
    ds_read_b128 v[12:15], v4 offset:31744
    v_mfma_f32_16x16x32_bf16 v[116:119], v[20:23], a[212:215], v[116:119]
    v_mfma_f32_16x16x32_bf16 v[120:123], v[20:23], a[216:219], v[120:123]
    v_mfma_f32_16x16x32_bf16 v[124:127], v[20:23], a[220:223], v[124:127]
    s_waitcnt lgkmcnt(3)
    v_mfma_f32_16x16x32_bf16 v[96:99], v[24:27], a[224:227], v[96:99]
    ds_read_b128 v[16:19], v4 offset:32768
    v_mfma_f32_16x16x32_bf16 v[100:103], v[24:27], a[228:231], v[100:103]
    v_mfma_f32_16x16x32_bf16 v[104:107], v[24:27], a[232:235], v[104:107]
    v_mfma_f32_16x16x32_bf16 v[108:111], v[24:27], a[236:239], v[108:111]
    s_waitcnt lgkmcnt(3)
    v_mfma_f32_16x16x32_bf16 v[112:115], v[28:31], a[224:227], v[112:115]
    ds_read_b128 v[20:23], v4 offset:33792
    v_mfma_f32_16x16x32_bf16 v[116:119], v[28:31], a[228:231], v[116:119]
    v_mfma_f32_16x16x32_bf16 v[120:123], v[28:31], a[232:235], v[120:123]
    v_mfma_f32_16x16x32_bf16 v[124:127], v[28:31], a[236:239], v[124:127]
    s_waitcnt lgkmcnt(3)
    v_mfma_f32_16x16x32_bf16 v[96:99], v[8:11], a[240:243], v[96:99]
    ds_read_b128 v[24:27], v4 offset:34816
    v_mfma_f32_16x16x32_bf16 v[100:103], v[8:11], a[244:247], v[100:103]
    v_mfma_f32_16x16x32_bf16 v[104:107], v[8:11], a[248:251], v[104:107]
    v_mfma_f32_16x16x32_bf16 v[108:111], v[8:11], a[252:255], v[108:111]
    ds_read_b128 v[136:139], v5 offset:768
    ds_read_b128 v[140:143], v5 offset:832
    s_waitcnt lgkmcnt(5)
    v_mfma_f32_16x16x32_bf16 v[112:115], v[12:15], a[240:243], v[112:115]
    ds_read_b128 v[28:31], v4 offset:35840
    v_mfma_f32_16x16x32_bf16 v[116:119], v[12:15], a[244:247], v[116:119]
    v_mfma_f32_16x16x32_bf16 v[120:123], v[12:15], a[248:251], v[120:123]
    v_mfma_f32_16x16x32_bf16 v[124:127], v[12:15], a[252:255], v[124:127]
    s_waitcnt lgkmcnt(5)
    v_mfma_f32_16x16x32_bf16 v[96:99], v[16:19], v[32:35], v[96:99]
    s_barrier
    v_mfma_f32_16x16x32_bf16 v[100:103], v[16:19], v[36:39], v[100:103]
    v_add_u32 v4, 0x9000, v4
    ds_read_b128 v[8:11], v4 offset:0
    v_mfma_f32_16x16x32_bf16 v[104:107], v[16:19], v[40:43], v[104:107]
    s_add_u32 m0, s49, 36864
    s_add_u32 s61, s48, 331776
    v_mfma_f32_16x16x32_bf16 v[108:111], v[16:19], v[44:47], v[108:111]
    buffer_load_dwordx4 v2, s[4:7], s61 offen offset:0 lds
    s_waitcnt lgkmcnt(5)
    v_mfma_f32_16x16x32_bf16 v[112:115], v[20:23], v[32:35], v[112:115]
    ds_read_b128 v[12:15], v4 offset:1024
    v_mfma_f32_16x16x32_bf16 v[116:119], v[20:23], v[36:39], v[116:119]
    v_mfma_f32_16x16x32_bf16 v[120:123], v[20:23], v[40:43], v[120:123]
    v_mfma_f32_16x16x32_bf16 v[124:127], v[20:23], v[44:47], v[124:127]
    buffer_load_dwordx4 v2, s[4:7], s61 offen offset:1024 lds
    s_waitcnt lgkmcnt(5)
    v_mfma_f32_16x16x32_bf16 v[96:99], v[24:27], v[48:51], v[96:99]
    ds_read_b128 v[16:19], v4 offset:2048
    v_mfma_f32_16x16x32_bf16 v[100:103], v[24:27], v[52:55], v[100:103]
    v_mfma_f32_16x16x32_bf16 v[104:107], v[24:27], v[56:59], v[104:107]
    v_mfma_f32_16x16x32_bf16 v[108:111], v[24:27], v[60:63], v[108:111]
    buffer_load_dwordx4 v2, s[4:7], s61 offen offset:2048 lds
    s_waitcnt lgkmcnt(3)
    v_mfma_f32_16x16x32_bf16 v[112:115], v[28:31], v[48:51], v[112:115]
    ds_read_b128 v[20:23], v4 offset:3072
    v_mfma_f32_16x16x32_bf16 v[116:119], v[28:31], v[52:55], v[116:119]
    v_mfma_f32_16x16x32_bf16 v[120:123], v[28:31], v[56:59], v[120:123]
    v_mfma_f32_16x16x32_bf16 v[124:127], v[28:31], v[60:63], v[124:127]
    buffer_load_dwordx4 v2, s[4:7], s61 offen offset:3072 lds
    s_add_u32 m0, s49, 40960
    s_waitcnt lgkmcnt(3)
    v_mfma_f32_16x16x32_bf16 v[64:67], v[8:11], a[0:3], 0
    ds_read_b128 v[24:27], v4 offset:4096
    s_add_u32 s61, s48, 335872
    v_mfma_f32_16x16x32_bf16 v[68:71], v[8:11], a[4:7], 0
    v_mfma_f32_16x16x32_bf16 v[72:75], v[8:11], a[8:11], 0
    v_mfma_f32_16x16x32_bf16 v[76:79], v[8:11], a[12:15], 0
    buffer_load_dwordx4 v2, s[4:7], s61 offen offset:0 lds
    s_waitcnt lgkmcnt(3)
    v_mfma_f32_16x16x32_bf16 v[80:83], v[12:15], a[0:3], 0
    ds_read_b128 v[28:31], v4 offset:5120
    v_mfma_f32_16x16x32_bf16 v[84:87], v[12:15], a[4:7], 0
    v_fmac_f32 v96, v136, v128
    v_fmac_f32 v97, v137, v128
    v_mfma_f32_16x16x32_bf16 v[88:91], v[12:15], a[8:11], 0
    v_fmac_f32 v98, v138, v128
    v_fmac_f32 v99, v139, v128
    v_mfma_f32_16x16x32_bf16 v[92:95], v[12:15], a[12:15], 0
    buffer_load_dwordx4 v2, s[4:7], s61 offen offset:1024 lds
    v_fmac_f32 v112, v140, v128
    s_waitcnt lgkmcnt(3)
    v_mfma_f32_16x16x32_bf16 v[64:67], v[16:19], a[16:19], v[64:67]
    ds_read_b128 v[8:11], v4 offset:6144
    v_fmac_f32 v113, v141, v128
    v_mfma_f32_16x16x32_bf16 v[68:71], v[16:19], a[20:23], v[68:71]
    v_fmac_f32 v114, v142, v128
    v_fmac_f32 v115, v143, v128
    v_mfma_f32_16x16x32_bf16 v[72:75], v[16:19], a[24:27], v[72:75]
    v_mul_f32 v96, v96, v132
    v_mul_f32 v97, v97, v132
    v_mfma_f32_16x16x32_bf16 v[76:79], v[16:19], a[28:31], v[76:79]
    buffer_load_dwordx4 v2, s[4:7], s61 offen offset:2048 lds
    v_mul_f32 v98, v98, v132
    s_waitcnt lgkmcnt(3)
    v_mfma_f32_16x16x32_bf16 v[80:83], v[20:23], a[16:19], v[80:83]
    ds_read_b128 v[12:15], v4 offset:7168
    v_mul_f32 v99, v99, v132
    v_mfma_f32_16x16x32_bf16 v[84:87], v[20:23], a[20:23], v[84:87]
    v_mul_f32 v96, v96, v112
    v_mul_f32 v97, v97, v113
    v_mfma_f32_16x16x32_bf16 v[88:91], v[20:23], a[24:27], v[88:91]
    v_mul_f32 v98, v98, v114
    v_mul_f32 v99, v99, v115
    v_mfma_f32_16x16x32_bf16 v[92:95], v[20:23], a[28:31], v[92:95]
    buffer_load_dwordx4 v2, s[4:7], s61 offen offset:3072 lds
    s_add_u32 m0, s49, 45056
    s_waitcnt lgkmcnt(3)
    v_mfma_f32_16x16x32_bf16 v[64:67], v[24:27], a[32:35], v[64:67]
    ds_read_b128 v[16:19], v4 offset:8192
    s_add_u32 s61, s48, 339968
    v_mfma_f32_16x16x32_bf16 v[68:71], v[24:27], a[36:39], v[68:71]
    v_cvt_pk_bf16_f32 v210, v96, v97
    v_cvt_pk_bf16_f32 v211, v98, v99
    v_mfma_f32_16x16x32_bf16 v[72:75], v[24:27], a[40:43], v[72:75]
    s_add_u32 s66, s51, 32768
    v_mfma_f32_16x16x32_bf16 v[76:79], v[24:27], a[44:47], v[76:79]
    buffer_load_dwordx4 v2, s[4:7], s61 offen offset:0 lds
    s_waitcnt lgkmcnt(3)
    v_mfma_f32_16x16x32_bf16 v[80:83], v[28:31], a[32:35], v[80:83]
    ds_read_b128 v[20:23], v4 offset:9216
    v_mfma_f32_16x16x32_bf16 v[84:87], v[28:31], a[36:39], v[84:87]
    v_mfma_f32_16x16x32_bf16 v[88:91], v[28:31], a[40:43], v[88:91]
    v_mfma_f32_16x16x32_bf16 v[92:95], v[28:31], a[44:47], v[92:95]
    buffer_store_dwordx4 v[208:211], v2, s[4:7], s66 offen offset:0 sc1
    v_fmac_f32 v100, v136, v129
    s_waitcnt lgkmcnt(3)
    v_mfma_f32_16x16x32_bf16 v[64:67], v[8:11], a[48:51], v[64:67]
    ds_read_b128 v[24:27], v4 offset:10240
    v_fmac_f32 v101, v137, v129
    v_mfma_f32_16x16x32_bf16 v[68:71], v[8:11], a[52:55], v[68:71]
    v_fmac_f32 v102, v138, v129
    v_fmac_f32 v103, v139, v129
    v_mfma_f32_16x16x32_bf16 v[72:75], v[8:11], a[56:59], v[72:75]
    v_fmac_f32 v116, v140, v129
    v_fmac_f32 v117, v141, v129
    v_mfma_f32_16x16x32_bf16 v[76:79], v[8:11], a[60:63], v[76:79]
    v_fmac_f32 v118, v142, v129
    v_fmac_f32 v119, v143, v129
    s_waitcnt lgkmcnt(3)
    v_mfma_f32_16x16x32_bf16 v[80:83], v[12:15], a[48:51], v[80:83]
    ds_read_b128 v[28:31], v4 offset:11264
    v_mul_f32 v100, v100, v133
    v_mfma_f32_16x16x32_bf16 v[84:87], v[12:15], a[52:55], v[84:87]
    v_mul_f32 v101, v101, v133
    v_mul_f32 v102, v102, v133
    v_mfma_f32_16x16x32_bf16 v[88:91], v[12:15], a[56:59], v[88:91]
    v_mul_f32 v103, v103, v133
    v_mul_f32 v100, v100, v116
    v_mfma_f32_16x16x32_bf16 v[92:95], v[12:15], a[60:63], v[92:95]
    v_mul_f32 v101, v101, v117
    v_mul_f32 v102, v102, v118
    s_waitcnt lgkmcnt(3)
    v_mfma_f32_16x16x32_bf16 v[64:67], v[16:19], a[64:67], v[64:67]
    ds_read_b128 v[8:11], v4 offset:12288
    v_mul_f32 v103, v103, v119
    v_mfma_f32_16x16x32_bf16 v[68:71], v[16:19], a[68:71], v[68:71]
    v_cvt_pk_bf16_f32 v214, v100, v101
    v_cvt_pk_bf16_f32 v215, v102, v103
    v_mfma_f32_16x16x32_bf16 v[72:75], v[16:19], a[72:75], v[72:75]
    buffer_store_dwordx4 v[212:215], v2, s[4:7], s66 offen offset:1024 sc1
    v_fmac_f32 v104, v136, v130
    v_mfma_f32_16x16x32_bf16 v[76:79], v[16:19], a[76:79], v[76:79]
    v_fmac_f32 v105, v137, v130
    v_fmac_f32 v106, v138, v130
    s_waitcnt lgkmcnt(3)
    v_mfma_f32_16x16x32_bf16 v[80:83], v[20:23], a[64:67], v[80:83]
    ds_read_b128 v[12:15], v4 offset:13312
    v_fmac_f32 v107, v139, v130
    v_mfma_f32_16x16x32_bf16 v[84:87], v[20:23], a[68:71], v[84:87]
    v_fmac_f32 v120, v140, v130
    v_fmac_f32 v121, v141, v130
    v_mfma_f32_16x16x32_bf16 v[88:91], v[20:23], a[72:75], v[88:91]
    v_fmac_f32 v122, v142, v130
    v_fmac_f32 v123, v143, v130
    v_mfma_f32_16x16x32_bf16 v[92:95], v[20:23], a[76:79], v[92:95]
    v_mul_f32 v104, v104, v134
    v_mul_f32 v105, v105, v134
    s_waitcnt lgkmcnt(3)
    v_mfma_f32_16x16x32_bf16 v[64:67], v[24:27], a[80:83], v[64:67]
    ds_read_b128 v[16:19], v4 offset:14336
    v_mul_f32 v106, v106, v134
    v_mfma_f32_16x16x32_bf16 v[68:71], v[24:27], a[84:87], v[68:71]
    v_mul_f32 v107, v107, v134
    v_mul_f32 v104, v104, v120
    v_mfma_f32_16x16x32_bf16 v[72:75], v[24:27], a[88:91], v[72:75]
    v_mul_f32 v105, v105, v121
    v_mul_f32 v106, v106, v122
    v_mfma_f32_16x16x32_bf16 v[76:79], v[24:27], a[92:95], v[76:79]
    v_mul_f32 v107, v107, v123
    v_cvt_pk_bf16_f32 v218, v104, v105
    s_waitcnt lgkmcnt(3)
    v_mfma_f32_16x16x32_bf16 v[80:83], v[28:31], a[80:83], v[80:83]
    ds_read_b128 v[20:23], v4 offset:15360
    v_cvt_pk_bf16_f32 v219, v106, v107
    v_mfma_f32_16x16x32_bf16 v[84:87], v[28:31], a[84:87], v[84:87]
    buffer_store_dwordx4 v[216:219], v2, s[4:7], s66 offen offset:2048 sc1
    v_fmac_f32 v108, v136, v131
    v_mfma_f32_16x16x32_bf16 v[88:91], v[28:31], a[88:91], v[88:91]
    v_fmac_f32 v109, v137, v131
    v_fmac_f32 v110, v138, v131
    v_mfma_f32_16x16x32_bf16 v[92:95], v[28:31], a[92:95], v[92:95]
    v_fmac_f32 v111, v139, v131
    v_fmac_f32 v124, v140, v131
    s_waitcnt lgkmcnt(3)
    v_mfma_f32_16x16x32_bf16 v[64:67], v[8:11], a[96:99], v[64:67]
    ds_read_b128 v[24:27], v4 offset:16384
    v_fmac_f32 v125, v141, v131
    v_mfma_f32_16x16x32_bf16 v[68:71], v[8:11], a[100:103], v[68:71]
    v_fmac_f32 v126, v142, v131
    v_fmac_f32 v127, v143, v131
    v_mfma_f32_16x16x32_bf16 v[72:75], v[8:11], a[104:107], v[72:75]
    v_mul_f32 v108, v108, v135
    v_mul_f32 v109, v109, v135
    v_mfma_f32_16x16x32_bf16 v[76:79], v[8:11], a[108:111], v[76:79]
    v_mul_f32 v110, v110, v135
    v_mul_f32 v111, v111, v135
    s_waitcnt lgkmcnt(3)
    v_mfma_f32_16x16x32_bf16 v[80:83], v[12:15], a[96:99], v[80:83]
    ds_read_b128 v[28:31], v4 offset:17408
    v_mul_f32 v108, v108, v124
    v_mfma_f32_16x16x32_bf16 v[84:87], v[12:15], a[100:103], v[84:87]
    v_mul_f32 v109, v109, v125
    v_mul_f32 v110, v110, v126
    v_mfma_f32_16x16x32_bf16 v[88:91], v[12:15], a[104:107], v[88:91]
    v_mul_f32 v111, v111, v127
    v_cvt_pk_bf16_f32 v222, v108, v109
    v_mfma_f32_16x16x32_bf16 v[92:95], v[12:15], a[108:111], v[92:95]
    v_cvt_pk_bf16_f32 v223, v110, v111
    buffer_store_dwordx4 v[220:223], v2, s[4:7], s66 offen offset:3072 sc1
    s_waitcnt lgkmcnt(3)
    v_mfma_f32_16x16x32_bf16 v[64:67], v[16:19], a[112:115], v[64:67]
    ds_read_b128 v[8:11], v4 offset:18432
    v_mfma_f32_16x16x32_bf16 v[68:71], v[16:19], a[116:119], v[68:71]
    v_mfma_f32_16x16x32_bf16 v[72:75], v[16:19], a[120:123], v[72:75]
    v_mfma_f32_16x16x32_bf16 v[76:79], v[16:19], a[124:127], v[76:79]
    s_waitcnt lgkmcnt(3)
    v_mfma_f32_16x16x32_bf16 v[80:83], v[20:23], a[112:115], v[80:83]
    ds_read_b128 v[12:15], v4 offset:19456
    v_mfma_f32_16x16x32_bf16 v[84:87], v[20:23], a[116:119], v[84:87]
    v_mfma_f32_16x16x32_bf16 v[88:91], v[20:23], a[120:123], v[88:91]
    v_mfma_f32_16x16x32_bf16 v[92:95], v[20:23], a[124:127], v[92:95]
    v_and_b32 v7, 3, v1
    v_lshlrev_b32 v7, 2, v7
    s_waitcnt lgkmcnt(3)
    v_mfma_f32_16x16x32_bf16 v[64:67], v[24:27], a[128:131], v[64:67]
    ds_read_b128 v[16:19], v4 offset:20480
    v_mfma_f32_16x16x32_bf16 v[68:71], v[24:27], a[132:135], v[68:71]
    v_mfma_f32_16x16x32_bf16 v[72:75], v[24:27], a[136:139], v[72:75]
    v_mfma_f32_16x16x32_bf16 v[76:79], v[24:27], a[140:143], v[76:79]
    s_waitcnt lgkmcnt(3)
    v_mfma_f32_16x16x32_bf16 v[80:83], v[28:31], a[128:131], v[80:83]
    ds_read_b128 v[20:23], v4 offset:21504
    v_mfma_f32_16x16x32_bf16 v[84:87], v[28:31], a[132:135], v[84:87]
    v_mfma_f32_16x16x32_bf16 v[88:91], v[28:31], a[136:139], v[88:91]
    v_mfma_f32_16x16x32_bf16 v[92:95], v[28:31], a[140:143], v[92:95]
    s_waitcnt lgkmcnt(3)
    v_mfma_f32_16x16x32_bf16 v[64:67], v[8:11], a[144:147], v[64:67]
    ds_read_b128 v[24:27], v4 offset:22528
    v_mfma_f32_16x16x32_bf16 v[68:71], v[8:11], a[148:151], v[68:71]
    v_mfma_f32_16x16x32_bf16 v[72:75], v[8:11], a[152:155], v[72:75]
    v_mfma_f32_16x16x32_bf16 v[76:79], v[8:11], a[156:159], v[76:79]
    s_waitcnt lgkmcnt(3)
    v_mfma_f32_16x16x32_bf16 v[80:83], v[12:15], a[144:147], v[80:83]
    ds_read_b128 v[28:31], v4 offset:23552
    v_mfma_f32_16x16x32_bf16 v[84:87], v[12:15], a[148:151], v[84:87]
    v_mfma_f32_16x16x32_bf16 v[88:91], v[12:15], a[152:155], v[88:91]
    v_mfma_f32_16x16x32_bf16 v[92:95], v[12:15], a[156:159], v[92:95]
    s_waitcnt lgkmcnt(3)
    v_mfma_f32_16x16x32_bf16 v[64:67], v[16:19], a[160:163], v[64:67]
    ds_read_b128 v[8:11], v4 offset:24576
    v_mfma_f32_16x16x32_bf16 v[68:71], v[16:19], a[164:167], v[68:71]
    v_mfma_f32_16x16x32_bf16 v[72:75], v[16:19], a[168:171], v[72:75]
    v_mfma_f32_16x16x32_bf16 v[76:79], v[16:19], a[172:175], v[76:79]
    buffer_load_dword v168, v7, s[4:7], s52 offen sc1
    s_waitcnt lgkmcnt(3)
    v_mfma_f32_16x16x32_bf16 v[80:83], v[20:23], a[160:163], v[80:83]
    ds_read_b128 v[12:15], v4 offset:25600
    v_mfma_f32_16x16x32_bf16 v[84:87], v[20:23], a[164:167], v[84:87]
    v_mfma_f32_16x16x32_bf16 v[88:91], v[20:23], a[168:171], v[88:91]
    v_mfma_f32_16x16x32_bf16 v[92:95], v[20:23], a[172:175], v[92:95]
    s_waitcnt lgkmcnt(3)
    v_mfma_f32_16x16x32_bf16 v[64:67], v[24:27], a[176:179], v[64:67]
    ds_read_b128 v[16:19], v4 offset:26624
    v_mfma_f32_16x16x32_bf16 v[68:71], v[24:27], a[180:183], v[68:71]
    v_mfma_f32_16x16x32_bf16 v[72:75], v[24:27], a[184:187], v[72:75]
    v_mfma_f32_16x16x32_bf16 v[76:79], v[24:27], a[188:191], v[76:79]
    s_waitcnt lgkmcnt(3)
    v_mfma_f32_16x16x32_bf16 v[80:83], v[28:31], a[176:179], v[80:83]
    ds_read_b128 v[20:23], v4 offset:27648
    v_mfma_f32_16x16x32_bf16 v[84:87], v[28:31], a[180:183], v[84:87]
    v_mfma_f32_16x16x32_bf16 v[88:91], v[28:31], a[184:187], v[88:91]
    v_mfma_f32_16x16x32_bf16 v[92:95], v[28:31], a[188:191], v[92:95]
    s_waitcnt lgkmcnt(3)
    v_mfma_f32_16x16x32_bf16 v[64:67], v[8:11], a[192:195], v[64:67]
    ds_read_b128 v[24:27], v4 offset:28672
    v_mfma_f32_16x16x32_bf16 v[68:71], v[8:11], a[196:199], v[68:71]
    v_mfma_f32_16x16x32_bf16 v[72:75], v[8:11], a[200:203], v[72:75]
    v_mfma_f32_16x16x32_bf16 v[76:79], v[8:11], a[204:207], v[76:79]
    s_waitcnt lgkmcnt(3)
    v_mfma_f32_16x16x32_bf16 v[80:83], v[12:15], a[192:195], v[80:83]
    ds_read_b128 v[28:31], v4 offset:29696
    v_mfma_f32_16x16x32_bf16 v[84:87], v[12:15], a[196:199], v[84:87]
    v_mfma_f32_16x16x32_bf16 v[88:91], v[12:15], a[200:203], v[88:91]
    v_mfma_f32_16x16x32_bf16 v[92:95], v[12:15], a[204:207], v[92:95]
    s_waitcnt lgkmcnt(3)
    v_mfma_f32_16x16x32_bf16 v[64:67], v[16:19], a[208:211], v[64:67]
    ds_read_b128 v[8:11], v4 offset:30720
    v_mfma_f32_16x16x32_bf16 v[68:71], v[16:19], a[212:215], v[68:71]
    v_mfma_f32_16x16x32_bf16 v[72:75], v[16:19], a[216:219], v[72:75]
    v_mfma_f32_16x16x32_bf16 v[76:79], v[16:19], a[220:223], v[76:79]
    s_waitcnt lgkmcnt(3)
    v_mfma_f32_16x16x32_bf16 v[80:83], v[20:23], a[208:211], v[80:83]
    ds_read_b128 v[12:15], v4 offset:31744
    v_mfma_f32_16x16x32_bf16 v[84:87], v[20:23], a[212:215], v[84:87]
    v_mfma_f32_16x16x32_bf16 v[88:91], v[20:23], a[216:219], v[88:91]
    v_mfma_f32_16x16x32_bf16 v[92:95], v[20:23], a[220:223], v[92:95]
    s_waitcnt lgkmcnt(3)
    v_mfma_f32_16x16x32_bf16 v[64:67], v[24:27], a[224:227], v[64:67]
    ds_read_b128 v[16:19], v4 offset:32768
    v_mfma_f32_16x16x32_bf16 v[68:71], v[24:27], a[228:231], v[68:71]
    v_mfma_f32_16x16x32_bf16 v[72:75], v[24:27], a[232:235], v[72:75]
    v_mfma_f32_16x16x32_bf16 v[76:79], v[24:27], a[236:239], v[76:79]
    s_waitcnt lgkmcnt(3)
    v_mfma_f32_16x16x32_bf16 v[80:83], v[28:31], a[224:227], v[80:83]
    ds_read_b128 v[20:23], v4 offset:33792
    v_mfma_f32_16x16x32_bf16 v[84:87], v[28:31], a[228:231], v[84:87]
    v_mfma_f32_16x16x32_bf16 v[88:91], v[28:31], a[232:235], v[88:91]
    v_mfma_f32_16x16x32_bf16 v[92:95], v[28:31], a[236:239], v[92:95]
    s_waitcnt lgkmcnt(3)
    v_mfma_f32_16x16x32_bf16 v[64:67], v[8:11], a[240:243], v[64:67]
    ds_read_b128 v[24:27], v4 offset:34816
    v_mfma_f32_16x16x32_bf16 v[68:71], v[8:11], a[244:247], v[68:71]
    v_mfma_f32_16x16x32_bf16 v[72:75], v[8:11], a[248:251], v[72:75]
    v_mfma_f32_16x16x32_bf16 v[76:79], v[8:11], a[252:255], v[76:79]
    s_waitcnt vmcnt(0)
    v_cmp_le_u32 vcc, 1, v168
    s_nop 0
    s_cmp_eq_u64 vcc, exec
    s_cbranch_scc0 L_p0_slow_46
L_p0_back_47:
    s_waitcnt lgkmcnt(3)
    v_mfma_f32_16x16x32_bf16 v[80:83], v[12:15], a[240:243], v[80:83]
    ds_read_b128 v[28:31], v4 offset:35840
    ds_read_b128 v[144:147], v5 offset:896
    v_mfma_f32_16x16x32_bf16 v[84:87], v[12:15], a[244:247], v[84:87]
    s_add_u32 s60, s56, s65
    buffer_load_dwordx2 v[242:243], v3, s[4:7], s60 offen offset:0 sc1
    v_mfma_f32_16x16x32_bf16 v[88:91], v[12:15], a[248:251], v[88:91]
    ds_read_b128 v[148:151], v5 offset:960
    v_mfma_f32_16x16x32_bf16 v[92:95], v[12:15], a[252:255], v[92:95]
    s_waitcnt lgkmcnt(5)
    v_mfma_f32_16x16x32_bf16 v[64:67], v[16:19], v[32:35], v[64:67]
    s_barrier
    v_mfma_f32_16x16x32_bf16 v[68:71], v[16:19], v[36:39], v[68:71]
    v_add_u32 v4, 0xfffe5000, v4
    ds_read_b128 v[8:11], v4 offset:0
    v_mfma_f32_16x16x32_bf16 v[72:75], v[16:19], v[40:43], v[72:75]
    s_add_u32 m0, s49, 73728
    s_add_u32 s61, s48, 368640
    v_mfma_f32_16x16x32_bf16 v[76:79], v[16:19], v[44:47], v[76:79]
    buffer_load_dwordx4 v2, s[4:7], s61 offen offset:0 lds
    s_waitcnt lgkmcnt(5)
    v_mfma_f32_16x16x32_bf16 v[80:83], v[20:23], v[32:35], v[80:83]
    ds_read_b128 v[12:15], v4 offset:1024
    v_mfma_f32_16x16x32_bf16 v[84:87], v[20:23], v[36:39], v[84:87]
    v_mfma_f32_16x16x32_bf16 v[88:91], v[20:23], v[40:43], v[88:91]
    v_mfma_f32_16x16x32_bf16 v[92:95], v[20:23], v[44:47], v[92:95]
    buffer_load_dwordx4 v2, s[4:7], s61 offen offset:1024 lds
    s_waitcnt lgkmcnt(5)
    v_mfma_f32_16x16x32_bf16 v[64:67], v[24:27], v[48:51], v[64:67]
    ds_read_b128 v[16:19], v4 offset:2048
    v_mfma_f32_16x16x32_bf16 v[68:71], v[24:27], v[52:55], v[68:71]
    v_mov_b32 v6, 2
    v_mov_b32 v0, 0
    v_mfma_f32_16x16x32_bf16 v[72:75], v[24:27], v[56:59], v[72:75]
    v_mfma_f32_16x16x32_bf16 v[76:79], v[24:27], v[60:63], v[76:79]
    buffer_load_dwordx4 v2, s[4:7], s61 offen offset:2048 lds
    s_waitcnt lgkmcnt(5)
    v_mfma_f32_16x16x32_bf16 v[80:83], v[28:31], v[48:51], v[80:83]
    ds_read_b128 v[20:23], v4 offset:3072
    v_mfma_f32_16x16x32_bf16 v[84:87], v[28:31], v[52:55], v[84:87]
    v_mfma_f32_16x16x32_bf16 v[88:91], v[28:31], v[56:59], v[88:91]
    s_mov_b64 exec, 1
    buffer_store_dword v6, v0, s[4:7], s67 offen sc1
    s_mov_b64 exec, -1
    v_mfma_f32_16x16x32_bf16 v[92:95], v[28:31], v[60:63], v[92:95]
    s_waitcnt lgkmcnt(3)
    v_mfma_f32_16x16x32_bf16 v[96:99], v[8:11], a[0:3], 0
    ds_read_b128 v[24:27], v4 offset:4096
    v_mfma_f32_16x16x32_bf16 v[100:103], v[8:11], a[4:7], 0
    v_mfma_f32_16x16x32_bf16 v[104:107], v[8:11], a[8:11], 0
    buffer_load_dwordx4 v2, s[4:7], s61 offen offset:3072 lds
    s_add_u32 m0, s49, 77824
    v_mfma_f32_16x16x32_bf16 v[108:111], v[8:11], a[12:15], 0
    s_add_u32 s61, s48, 372736
    s_waitcnt lgkmcnt(3)
    v_mfma_f32_16x16x32_bf16 v[112:115], v[12:15], a[0:3], 0
    ds_read_b128 v[28:31], v4 offset:5120
    v_mfma_f32_16x16x32_bf16 v[116:119], v[12:15], a[4:7], 0
    v_fmac_f32 v64, v144, v128
    v_fmac_f32 v65, v145, v128
    v_mfma_f32_16x16x32_bf16 v[120:123], v[12:15], a[8:11], 0
    buffer_load_dwordx4 v2, s[4:7], s61 offen offset:0 lds
    v_fmac_f32 v66, v146, v128
    v_mfma_f32_16x16x32_bf16 v[124:127], v[12:15], a[12:15], 0
    v_fmac_f32 v67, v147, v128
    v_fmac_f32 v80, v148, v128
    s_waitcnt lgkmcnt(3)
    v_mfma_f32_16x16x32_bf16 v[96:99], v[16:19], a[16:19], v[96:99]
    ds_read_b128 v[8:11], v4 offset:6144
    v_fmac_f32 v81, v149, v128
    v_mfma_f32_16x16x32_bf16 v[100:103], v[16:19], a[20:23], v[100:103]
    v_fmac_f32 v82, v150, v128
    v_fmac_f32 v83, v151, v128
    v_mfma_f32_16x16x32_bf16 v[104:107], v[16:19], a[24:27], v[104:107]
    buffer_load_dwordx4 v2, s[4:7], s61 offen offset:1024 lds
    v_mul_f32 v64, v64, v132
    v_mfma_f32_16x16x32_bf16 v[108:111], v[16:19], a[28:31], v[108:111]
    v_mul_f32 v65, v65, v132
    v_mul_f32 v66, v66, v132
    s_waitcnt lgkmcnt(3)
    v_mfma_f32_16x16x32_bf16 v[112:115], v[20:23], a[16:19], v[112:115]
    ds_read_b128 v[12:15], v4 offset:7168
    v_mul_f32 v67, v67, v132
    v_mfma_f32_16x16x32_bf16 v[116:119], v[20:23], a[20:23], v[116:119]
    v_mul_f32 v64, v64, v80
    v_mul_f32 v65, v65, v81
    v_mfma_f32_16x16x32_bf16 v[120:123], v[20:23], a[24:27], v[120:123]
    buffer_load_dwordx4 v2, s[4:7], s61 offen offset:2048 lds
    v_mul_f32 v66, v66, v82
    v_mfma_f32_16x16x32_bf16 v[124:127], v[20:23], a[28:31], v[124:127]
    v_mul_f32 v67, v67, v83
    v_cvt_pk_bf16_f32 v224, v64, v65
    s_waitcnt lgkmcnt(3)
    v_mfma_f32_16x16x32_bf16 v[96:99], v[24:27], a[32:35], v[96:99]
    ds_read_b128 v[16:19], v4 offset:8192
    v_cvt_pk_bf16_f32 v225, v66, v67
    v_mfma_f32_16x16x32_bf16 v[100:103], v[24:27], a[36:39], v[100:103]
    v_fmac_f32 v68, v144, v129
    v_fmac_f32 v69, v145, v129
    v_mfma_f32_16x16x32_bf16 v[104:107], v[24:27], a[40:43], v[104:107]
    buffer_load_dwordx4 v2, s[4:7], s61 offen offset:3072 lds
    s_add_u32 m0, s49, 81920
    v_mfma_f32_16x16x32_bf16 v[108:111], v[24:27], a[44:47], v[108:111]
    s_add_u32 s61, s48, 376832
    v_fmac_f32 v70, v146, v129
    s_waitcnt lgkmcnt(3)
    v_mfma_f32_16x16x32_bf16 v[112:115], v[28:31], a[32:35], v[112:115]
    ds_read_b128 v[20:23], v4 offset:9216
    v_fmac_f32 v71, v147, v129
    v_mfma_f32_16x16x32_bf16 v[116:119], v[28:31], a[36:39], v[116:119]
    v_fmac_f32 v84, v148, v129
    v_fmac_f32 v85, v149, v129
    v_mfma_f32_16x16x32_bf16 v[120:123], v[28:31], a[40:43], v[120:123]
    buffer_load_dwordx4 v2, s[4:7], s61 offen offset:0 lds
    v_fmac_f32 v86, v150, v129
    v_mfma_f32_16x16x32_bf16 v[124:127], v[28:31], a[44:47], v[124:127]
    v_fmac_f32 v87, v151, v129
    v_mul_f32 v68, v68, v133
    s_waitcnt lgkmcnt(3)
    v_mfma_f32_16x16x32_bf16 v[96:99], v[8:11], a[48:51], v[96:99]
    ds_read_b128 v[24:27], v4 offset:10240
    v_mul_f32 v69, v69, v133
    v_mfma_f32_16x16x32_bf16 v[100:103], v[8:11], a[52:55], v[100:103]
    v_mul_f32 v70, v70, v133
    v_mul_f32 v71, v71, v133
    v_mfma_f32_16x16x32_bf16 v[104:107], v[8:11], a[56:59], v[104:107]
    buffer_load_dwordx2 v[246:247], v3, s[4:7], s60 offen offset:512 sc1
    v_mul_f32 v68, v68, v84
    v_mfma_f32_16x16x32_bf16 v[108:111], v[8:11], a[60:63], v[108:111]
    v_mul_f32 v69, v69, v85
    v_mul_f32 v70, v70, v86
    s_waitcnt lgkmcnt(3)
    v_mfma_f32_16x16x32_bf16 v[112:115], v[12:15], a[48:51], v[112:115]
    ds_read_b128 v[28:31], v4 offset:11264
    v_mul_f32 v71, v71, v87
    v_mfma_f32_16x16x32_bf16 v[116:119], v[12:15], a[52:55], v[116:119]
    v_cvt_pk_bf16_f32 v228, v68, v69
    v_cvt_pk_bf16_f32 v229, v70, v71
    v_mfma_f32_16x16x32_bf16 v[120:123], v[12:15], a[56:59], v[120:123]
    buffer_load_dwordx2 v[250:251], v3, s[4:7], s60 offen offset:1024 sc1
    v_fmac_f32 v72, v144, v130
    v_mfma_f32_16x16x32_bf16 v[124:127], v[12:15], a[60:63], v[124:127]
    v_fmac_f32 v73, v145, v130
    v_fmac_f32 v74, v146, v130
    s_waitcnt lgkmcnt(3)
    v_mfma_f32_16x16x32_bf16 v[96:99], v[16:19], a[64:67], v[96:99]
    ds_read_b128 v[8:11], v4 offset:12288
    v_fmac_f32 v75, v147, v130
    v_mfma_f32_16x16x32_bf16 v[100:103], v[16:19], a[68:71], v[100:103]
    v_fmac_f32 v88, v148, v130
    v_fmac_f32 v89, v149, v130
    v_mfma_f32_16x16x32_bf16 v[104:107], v[16:19], a[72:75], v[104:107]
    buffer_load_dwordx2 v[254:255], v3, s[4:7], s60 offen offset:1536 sc1
    s_add_u32 s60, s57, s65
    v_mfma_f32_16x16x32_bf16 v[108:111], v[16:19], a[76:79], v[108:111]
    v_fmac_f32 v90, v150, v130
    v_fmac_f32 v91, v151, v130
    s_waitcnt lgkmcnt(3)
    v_mfma_f32_16x16x32_bf16 v[112:115], v[20:23], a[64:67], v[112:115]
    ds_read_b128 v[12:15], v4 offset:13312
    v_mul_f32 v72, v72, v134
    v_mfma_f32_16x16x32_bf16 v[116:119], v[20:23], a[68:71], v[116:119]
    v_mul_f32 v73, v73, v134
    v_mul_f32 v74, v74, v134
    v_mfma_f32_16x16x32_bf16 v[120:123], v[20:23], a[72:75], v[120:123]
    buffer_load_dwordx2 a[0:1], v3, s[4:7], s60 offen offset:0 sc1
    v_mul_f32 v75, v75, v134
    v_mfma_f32_16x16x32_bf16 v[124:127], v[20:23], a[76:79], v[124:127]
    v_mul_f32 v72, v72, v88
    v_mul_f32 v73, v73, v89
    s_waitcnt lgkmcnt(3)
    v_mfma_f32_16x16x32_bf16 v[96:99], v[24:27], a[80:83], v[96:99]
    ds_read_b128 v[16:19], v4 offset:14336
    v_mul_f32 v74, v74, v90
    v_mfma_f32_16x16x32_bf16 v[100:103], v[24:27], a[84:87], v[100:103]
    v_mul_f32 v75, v75, v91
    v_cvt_pk_bf16_f32 v232, v72, v73
    v_mfma_f32_16x16x32_bf16 v[104:107], v[24:27], a[88:91], v[104:107]
    buffer_load_dwordx2 a[4:5], v3, s[4:7], s60 offen offset:512 sc1
    v_cvt_pk_bf16_f32 v233, v74, v75
    v_mfma_f32_16x16x32_bf16 v[108:111], v[24:27], a[92:95], v[108:111]
    v_fmac_f32 v76, v144, v131
    v_fmac_f32 v77, v145, v131
    s_waitcnt lgkmcnt(3)
    v_mfma_f32_16x16x32_bf16 v[112:115], v[28:31], a[80:83], v[112:115]
    ds_read_b128 v[20:23], v4 offset:15360
    v_fmac_f32 v78, v146, v131
    v_mfma_f32_16x16x32_bf16 v[116:119], v[28:31], a[84:87], v[116:119]
    v_fmac_f32 v79, v147, v131
    v_fmac_f32 v92, v148, v131
    v_mfma_f32_16x16x32_bf16 v[120:123], v[28:31], a[88:91], v[120:123]
    buffer_load_dwordx2 a[8:9], v3, s[4:7], s60 offen offset:1024 sc1
    v_fmac_f32 v93, v149, v131
    v_mfma_f32_16x16x32_bf16 v[124:127], v[28:31], a[92:95], v[124:127]
    v_fmac_f32 v94, v150, v131
    v_fmac_f32 v95, v151, v131
    s_waitcnt lgkmcnt(3)
    v_mfma_f32_16x16x32_bf16 v[96:99], v[8:11], a[96:99], v[96:99]
    ds_read_b128 v[24:27], v4 offset:16384
    v_mul_f32 v76, v76, v135
    v_mfma_f32_16x16x32_bf16 v[100:103], v[8:11], a[100:103], v[100:103]
    v_mul_f32 v77, v77, v135
    v_mul_f32 v78, v78, v135
    v_mfma_f32_16x16x32_bf16 v[104:107], v[8:11], a[104:107], v[104:107]
    buffer_load_dwordx2 a[12:13], v3, s[4:7], s60 offen offset:1536 sc1
    s_add_u32 s60, s58, s65
    v_mfma_f32_16x16x32_bf16 v[108:111], v[8:11], a[108:111], v[108:111]
    v_mul_f32 v79, v79, v135
    v_mul_f32 v76, v76, v92
    s_waitcnt lgkmcnt(3)
    v_mfma_f32_16x16x32_bf16 v[112:115], v[12:15], a[96:99], v[112:115]
    ds_read_b128 v[28:31], v4 offset:17408
    v_mul_f32 v77, v77, v93
    v_mfma_f32_16x16x32_bf16 v[116:119], v[12:15], a[100:103], v[116:119]
    v_mul_f32 v78, v78, v94
    v_mul_f32 v79, v79, v95
    v_mfma_f32_16x16x32_bf16 v[120:123], v[12:15], a[104:107], v[120:123]
    buffer_load_dwordx2 a[2:3], v3, s[4:7], s60 offen offset:0 sc1
    v_cvt_pk_bf16_f32 v236, v76, v77
    v_mfma_f32_16x16x32_bf16 v[124:127], v[12:15], a[108:111], v[124:127]
    v_cvt_pk_bf16_f32 v237, v78, v79
    s_waitcnt lgkmcnt(3)
    v_mfma_f32_16x16x32_bf16 v[96:99], v[16:19], a[112:115], v[96:99]
    ds_read_b128 v[8:11], v4 offset:18432
    v_mfma_f32_16x16x32_bf16 v[100:103], v[16:19], a[116:119], v[100:103]
    v_mfma_f32_16x16x32_bf16 v[104:107], v[16:19], a[120:123], v[104:107]
    buffer_load_dwordx2 a[6:7], v3, s[4:7], s60 offen offset:512 sc1
    v_mfma_f32_16x16x32_bf16 v[108:111], v[16:19], a[124:127], v[108:111]
    s_waitcnt lgkmcnt(3)
    v_mfma_f32_16x16x32_bf16 v[112:115], v[20:23], a[112:115], v[112:115]
    ds_read_b128 v[12:15], v4 offset:19456
    v_mfma_f32_16x16x32_bf16 v[116:119], v[20:23], a[116:119], v[116:119]
    v_mfma_f32_16x16x32_bf16 v[120:123], v[20:23], a[120:123], v[120:123]
    buffer_load_dwordx2 a[10:11], v3, s[4:7], s60 offen offset:1024 sc1
    v_mfma_f32_16x16x32_bf16 v[124:127], v[20:23], a[124:127], v[124:127]
    s_waitcnt lgkmcnt(3)
    v_mfma_f32_16x16x32_bf16 v[96:99], v[24:27], a[128:131], v[96:99]
    ds_read_b128 v[16:19], v4 offset:20480
    v_mfma_f32_16x16x32_bf16 v[100:103], v[24:27], a[132:135], v[100:103]
    v_mfma_f32_16x16x32_bf16 v[104:107], v[24:27], a[136:139], v[104:107]
    buffer_load_dwordx2 a[14:15], v3, s[4:7], s60 offen offset:1536 sc1
    s_add_u32 s60, s56, 0
    v_mfma_f32_16x16x32_bf16 v[108:111], v[24:27], a[140:143], v[108:111]
    s_waitcnt lgkmcnt(3)
    v_mfma_f32_16x16x32_bf16 v[112:115], v[28:31], a[128:131], v[112:115]
    ds_read_b128 v[20:23], v4 offset:21504
    v_mfma_f32_16x16x32_bf16 v[116:119], v[28:31], a[132:135], v[116:119]
    v_mfma_f32_16x16x32_bf16 v[120:123], v[28:31], a[136:139], v[120:123]
    buffer_load_dwordx4 a[16:19], v2, s[4:7], s60 offen offset:0 sc1
    v_mfma_f32_16x16x32_bf16 v[124:127], v[28:31], a[140:143], v[124:127]
    s_waitcnt lgkmcnt(3)
    v_mfma_f32_16x16x32_bf16 v[96:99], v[8:11], a[144:147], v[96:99]
    ds_read_b128 v[24:27], v4 offset:22528
    v_mfma_f32_16x16x32_bf16 v[100:103], v[8:11], a[148:151], v[100:103]
    v_mfma_f32_16x16x32_bf16 v[104:107], v[8:11], a[152:155], v[104:107]
    buffer_load_dwordx4 a[20:23], v2, s[4:7], s60 offen offset:1024 sc1
    v_mfma_f32_16x16x32_bf16 v[108:111], v[8:11], a[156:159], v[108:111]
    s_waitcnt lgkmcnt(3)
    v_mfma_f32_16x16x32_bf16 v[112:115], v[12:15], a[144:147], v[112:115]
    ds_read_b128 v[28:31], v4 offset:23552
    v_mfma_f32_16x16x32_bf16 v[116:119], v[12:15], a[148:151], v[116:119]
    v_mfma_f32_16x16x32_bf16 v[120:123], v[12:15], a[152:155], v[120:123]
    buffer_load_dwordx4 a[24:27], v2, s[4:7], s60 offen offset:2048 sc1
    v_mfma_f32_16x16x32_bf16 v[124:127], v[12:15], a[156:159], v[124:127]
    s_waitcnt lgkmcnt(3)
    v_mfma_f32_16x16x32_bf16 v[96:99], v[16:19], a[160:163], v[96:99]
    ds_read_b128 v[8:11], v4 offset:24576
    v_mfma_f32_16x16x32_bf16 v[100:103], v[16:19], a[164:167], v[100:103]
    v_mfma_f32_16x16x32_bf16 v[104:107], v[16:19], a[168:171], v[104:107]
    buffer_load_dwordx4 a[28:31], v2, s[4:7], s60 offen offset:3072 sc1
    s_add_u32 s60, s57, 0
    v_mfma_f32_16x16x32_bf16 v[108:111], v[16:19], a[172:175], v[108:111]
    s_waitcnt lgkmcnt(3)
    v_mfma_f32_16x16x32_bf16 v[112:115], v[20:23], a[160:163], v[112:115]
    ds_read_b128 v[12:15], v4 offset:25600
    v_mfma_f32_16x16x32_bf16 v[116:119], v[20:23], a[164:167], v[116:119]
    v_mfma_f32_16x16x32_bf16 v[120:123], v[20:23], a[168:171], v[120:123]
    buffer_load_dwordx4 a[32:35], v2, s[4:7], s60 offen offset:0 sc1
    v_mfma_f32_16x16x32_bf16 v[124:127], v[20:23], a[172:175], v[124:127]
    s_waitcnt lgkmcnt(3)
    v_mfma_f32_16x16x32_bf16 v[96:99], v[24:27], a[176:179], v[96:99]
    ds_read_b128 v[16:19], v4 offset:26624
    v_mfma_f32_16x16x32_bf16 v[100:103], v[24:27], a[180:183], v[100:103]
    v_mfma_f32_16x16x32_bf16 v[104:107], v[24:27], a[184:187], v[104:107]
    buffer_load_dwordx4 a[36:39], v2, s[4:7], s60 offen offset:1024 sc1
    v_mfma_f32_16x16x32_bf16 v[108:111], v[24:27], a[188:191], v[108:111]
    s_waitcnt lgkmcnt(3)
    v_mfma_f32_16x16x32_bf16 v[112:115], v[28:31], a[176:179], v[112:115]
    ds_read_b128 v[20:23], v4 offset:27648
    v_mfma_f32_16x16x32_bf16 v[116:119], v[28:31], a[180:183], v[116:119]
    v_mfma_f32_16x16x32_bf16 v[120:123], v[28:31], a[184:187], v[120:123]
    buffer_load_dwordx4 a[40:43], v2, s[4:7], s60 offen offset:2048 sc1
    v_mfma_f32_16x16x32_bf16 v[124:127], v[28:31], a[188:191], v[124:127]
    s_waitcnt lgkmcnt(3)
    v_mfma_f32_16x16x32_bf16 v[96:99], v[8:11], a[192:195], v[96:99]
    ds_read_b128 v[24:27], v4 offset:28672
    v_mfma_f32_16x16x32_bf16 v[100:103], v[8:11], a[196:199], v[100:103]
    v_mfma_f32_16x16x32_bf16 v[104:107], v[8:11], a[200:203], v[104:107]
    buffer_load_dwordx4 a[44:47], v2, s[4:7], s60 offen offset:3072 sc1
    s_add_u32 s60, s58, 0
    v_mfma_f32_16x16x32_bf16 v[108:111], v[8:11], a[204:207], v[108:111]
    s_waitcnt lgkmcnt(3)
    v_mfma_f32_16x16x32_bf16 v[112:115], v[12:15], a[192:195], v[112:115]
    ds_read_b128 v[28:31], v4 offset:29696
    v_mfma_f32_16x16x32_bf16 v[116:119], v[12:15], a[196:199], v[116:119]
    v_mfma_f32_16x16x32_bf16 v[120:123], v[12:15], a[200:203], v[120:123]
    buffer_load_dwordx4 a[48:51], v2, s[4:7], s60 offen offset:0 sc1
    v_mfma_f32_16x16x32_bf16 v[124:127], v[12:15], a[204:207], v[124:127]
    s_waitcnt lgkmcnt(3)
    v_mfma_f32_16x16x32_bf16 v[96:99], v[16:19], a[208:211], v[96:99]
    ds_read_b128 v[8:11], v4 offset:30720
    v_mfma_f32_16x16x32_bf16 v[100:103], v[16:19], a[212:215], v[100:103]
    v_mfma_f32_16x16x32_bf16 v[104:107], v[16:19], a[216:219], v[104:107]
    buffer_load_dwordx4 a[52:55], v2, s[4:7], s60 offen offset:1024 sc1
    v_mfma_f32_16x16x32_bf16 v[108:111], v[16:19], a[220:223], v[108:111]
    s_waitcnt lgkmcnt(3)
    v_mfma_f32_16x16x32_bf16 v[112:115], v[20:23], a[208:211], v[112:115]
    ds_read_b128 v[12:15], v4 offset:31744
    v_mfma_f32_16x16x32_bf16 v[116:119], v[20:23], a[212:215], v[116:119]
    v_mfma_f32_16x16x32_bf16 v[120:123], v[20:23], a[216:219], v[120:123]
    buffer_load_dwordx4 a[56:59], v2, s[4:7], s60 offen offset:2048 sc1
    v_mfma_f32_16x16x32_bf16 v[124:127], v[20:23], a[220:223], v[124:127]
    s_waitcnt lgkmcnt(3)
    v_mfma_f32_16x16x32_bf16 v[96:99], v[24:27], a[224:227], v[96:99]
    ds_read_b128 v[16:19], v4 offset:32768
    v_mfma_f32_16x16x32_bf16 v[100:103], v[24:27], a[228:231], v[100:103]
    v_mfma_f32_16x16x32_bf16 v[104:107], v[24:27], a[232:235], v[104:107]
    buffer_load_dwordx4 a[60:63], v2, s[4:7], s60 offen offset:3072 sc1
    s_add_u32 s60, s56, 16384
    v_mfma_f32_16x16x32_bf16 v[108:111], v[24:27], a[236:239], v[108:111]
    s_waitcnt lgkmcnt(3)
    v_mfma_f32_16x16x32_bf16 v[112:115], v[28:31], a[224:227], v[112:115]
    ds_read_b128 v[20:23], v4 offset:33792
    v_mfma_f32_16x16x32_bf16 v[116:119], v[28:31], a[228:231], v[116:119]
    v_mfma_f32_16x16x32_bf16 v[120:123], v[28:31], a[232:235], v[120:123]
    buffer_load_dwordx4 a[64:67], v2, s[4:7], s60 offen offset:0 sc1
    v_mfma_f32_16x16x32_bf16 v[124:127], v[28:31], a[236:239], v[124:127]
    s_waitcnt lgkmcnt(3)
    v_mfma_f32_16x16x32_bf16 v[96:99], v[8:11], a[240:243], v[96:99]
    ds_read_b128 v[24:27], v4 offset:34816
    v_mfma_f32_16x16x32_bf16 v[100:103], v[8:11], a[244:247], v[100:103]
    v_mfma_f32_16x16x32_bf16 v[104:107], v[8:11], a[248:251], v[104:107]
    buffer_load_dwordx4 a[68:71], v2, s[4:7], s60 offen offset:1024 sc1
    v_mfma_f32_16x16x32_bf16 v[108:111], v[8:11], a[252:255], v[108:111]
    ds_read_b128 v[136:139], v5 offset:1024
    ds_read_b128 v[140:143], v5 offset:1088
    s_waitcnt lgkmcnt(5)
    v_mfma_f32_16x16x32_bf16 v[112:115], v[12:15], a[240:243], v[112:115]
    ds_read_b128 v[28:31], v4 offset:35840
    v_mfma_f32_16x16x32_bf16 v[116:119], v[12:15], a[244:247], v[116:119]
    v_mfma_f32_16x16x32_bf16 v[120:123], v[12:15], a[248:251], v[120:123]
    buffer_load_dwordx4 a[72:75], v2, s[4:7], s60 offen offset:2048 sc1
    v_mfma_f32_16x16x32_bf16 v[124:127], v[12:15], a[252:255], v[124:127]
    s_waitcnt lgkmcnt(5)
    v_mfma_f32_16x16x32_bf16 v[96:99], v[16:19], v[32:35], v[96:99]
    s_barrier
    v_mfma_f32_16x16x32_bf16 v[100:103], v[16:19], v[36:39], v[100:103]
    v_add_u32 v4, 0x9000, v4
    ds_read_b128 v[8:11], v4 offset:0
    v_mfma_f32_16x16x32_bf16 v[104:107], v[16:19], v[40:43], v[104:107]
    buffer_load_dwordx4 a[76:79], v2, s[4:7], s60 offen offset:3072 sc1
    s_add_u32 s60, s57, 16384
    v_mfma_f32_16x16x32_bf16 v[108:111], v[16:19], v[44:47], v[108:111]
    s_add_u32 m0, s49, 110592
    s_add_u32 s61, s48, 405504
    s_waitcnt lgkmcnt(5)
    v_mfma_f32_16x16x32_bf16 v[112:115], v[20:23], v[32:35], v[112:115]
    ds_read_b128 v[12:15], v4 offset:1024
    v_mfma_f32_16x16x32_bf16 v[116:119], v[20:23], v[36:39], v[116:119]
    v_mfma_f32_16x16x32_bf16 v[120:123], v[20:23], v[40:43], v[120:123]
    buffer_load_dwordx4 a[80:83], v2, s[4:7], s60 offen offset:0 sc1
    v_mfma_f32_16x16x32_bf16 v[124:127], v[20:23], v[44:47], v[124:127]
    s_waitcnt lgkmcnt(5)
    v_mfma_f32_16x16x32_bf16 v[96:99], v[24:27], v[48:51], v[96:99]
    ds_read_b128 v[16:19], v4 offset:2048
    v_mfma_f32_16x16x32_bf16 v[100:103], v[24:27], v[52:55], v[100:103]
    v_mfma_f32_16x16x32_bf16 v[104:107], v[24:27], v[56:59], v[104:107]
    buffer_load_dwordx4 a[84:87], v2, s[4:7], s60 offen offset:1024 sc1
    v_mfma_f32_16x16x32_bf16 v[108:111], v[24:27], v[60:63], v[108:111]
    s_waitcnt lgkmcnt(3)
    v_mfma_f32_16x16x32_bf16 v[112:115], v[28:31], v[48:51], v[112:115]
    ds_read_b128 v[20:23], v4 offset:3072
    v_mfma_f32_16x16x32_bf16 v[116:119], v[28:31], v[52:55], v[116:119]
    v_mfma_f32_16x16x32_bf16 v[120:123], v[28:31], v[56:59], v[120:123]
    buffer_load_dwordx4 a[88:91], v2, s[4:7], s60 offen offset:2048 sc1
    v_mfma_f32_16x16x32_bf16 v[124:127], v[28:31], v[60:63], v[124:127]
    s_waitcnt lgkmcnt(3)
    v_mfma_f32_16x16x32_bf16 v[32:35], v[8:11], v[176:179], 0
    ds_read_b128 v[24:27], v4 offset:4096
    v_mfma_f32_16x16x32_bf16 v[40:43], v[8:11], v[180:183], 0
    v_mfma_f32_16x16x32_bf16 v[48:51], v[8:11], v[184:187], 0
    buffer_load_dwordx4 a[92:95], v2, s[4:7], s60 offen offset:3072 sc1
    s_add_u32 s60, s58, 16384
    v_mfma_f32_16x16x32_bf16 v[56:59], v[8:11], v[188:191], 0
    s_waitcnt lgkmcnt(3)
    v_mfma_f32_16x16x32_bf16 v[36:39], v[12:15], v[176:179], 0
    ds_read_b128 v[28:31], v4 offset:5120
    v_mfma_f32_16x16x32_bf16 v[44:47], v[12:15], v[180:183], 0
    v_fmac_f32 v96, v136, v128
    v_fmac_f32 v97, v137, v128
    v_mfma_f32_16x16x32_bf16 v[52:55], v[12:15], v[184:187], 0
    buffer_load_dwordx4 a[96:99], v2, s[4:7], s60 offen offset:0 sc1
    v_fmac_f32 v98, v138, v128
    v_mfma_f32_16x16x32_bf16 v[60:63], v[12:15], v[188:191], 0
    v_fmac_f32 v99, v139, v128
    v_fmac_f32 v112, v140, v128
    s_waitcnt lgkmcnt(3)
    v_mfma_f32_16x16x32_bf16 v[64:67], v[16:19], v[176:179], 0
    ds_read_b128 v[8:11], v4 offset:6144
    v_fmac_f32 v113, v141, v128
    v_mfma_f32_16x16x32_bf16 v[72:75], v[16:19], v[180:183], 0
    v_fmac_f32 v114, v142, v128
    v_fmac_f32 v115, v143, v128
    v_mfma_f32_16x16x32_bf16 v[80:83], v[16:19], v[184:187], 0
    buffer_load_dwordx4 a[100:103], v2, s[4:7], s60 offen offset:1024 sc1
    v_mul_f32 v96, v96, v132
    v_mfma_f32_16x16x32_bf16 v[88:91], v[16:19], v[188:191], 0
    v_mul_f32 v97, v97, v132
    v_mul_f32 v98, v98, v132
    s_waitcnt lgkmcnt(3)
    v_mfma_f32_16x16x32_bf16 v[68:71], v[20:23], v[176:179], 0
    ds_read_b128 v[12:15], v4 offset:7168
    v_mul_f32 v99, v99, v132
    v_mfma_f32_16x16x32_bf16 v[76:79], v[20:23], v[180:183], 0
    v_mul_f32 v96, v96, v112
    v_mul_f32 v97, v97, v113
    v_mfma_f32_16x16x32_bf16 v[84:87], v[20:23], v[184:187], 0
    buffer_load_dwordx4 a[104:107], v2, s[4:7], s60 offen offset:2048 sc1
    v_mul_f32 v98, v98, v114
    v_mfma_f32_16x16x32_bf16 v[92:95], v[20:23], v[188:191], 0
    v_mul_f32 v99, v99, v115
    v_cvt_pk_bf16_f32 v226, v96, v97
    s_waitcnt lgkmcnt(3)
    v_mfma_f32_16x16x32_bf16 v[32:35], v[24:27], v[192:195], v[32:35]
    ds_read_b128 v[16:19], v4 offset:8192
    v_cvt_pk_bf16_f32 v227, v98, v99
    v_mfma_f32_16x16x32_bf16 v[40:43], v[24:27], v[196:199], v[40:43]
    s_add_u32 s66, s51, 49152
    v_mfma_f32_16x16x32_bf16 v[48:51], v[24:27], v[200:203], v[48:51]
    buffer_store_dwordx4 v[224:227], v2, s[4:7], s66 offen offset:0 sc1
    v_fmac_f32 v100, v136, v129
    v_mfma_f32_16x16x32_bf16 v[56:59], v[24:27], v[204:207], v[56:59]
    v_fmac_f32 v101, v137, v129
    v_fmac_f32 v102, v138, v129
    s_waitcnt lgkmcnt(3)
    v_mfma_f32_16x16x32_bf16 v[36:39], v[28:31], v[192:195], v[36:39]
    ds_read_b128 v[20:23], v4 offset:9216
    v_fmac_f32 v103, v139, v129
    v_mfma_f32_16x16x32_bf16 v[44:47], v[28:31], v[196:199], v[44:47]
    v_fmac_f32 v116, v140, v129
    v_fmac_f32 v117, v141, v129
    v_mfma_f32_16x16x32_bf16 v[52:55], v[28:31], v[200:203], v[52:55]
    buffer_load_dwordx4 a[108:111], v2, s[4:7], s60 offen offset:3072 sc1
    v_fmac_f32 v118, v142, v129
    v_mfma_f32_16x16x32_bf16 v[60:63], v[28:31], v[204:207], v[60:63]
    v_fmac_f32 v119, v143, v129
    v_mul_f32 v100, v100, v133
    s_waitcnt lgkmcnt(3)
    v_mfma_f32_16x16x32_bf16 v[64:67], v[8:11], v[192:195], v[64:67]
    ds_read_b128 v[24:27], v4 offset:10240
    v_mul_f32 v101, v101, v133
    v_mfma_f32_16x16x32_bf16 v[72:75], v[8:11], v[196:199], v[72:75]
    v_mul_f32 v102, v102, v133
    v_mul_f32 v103, v103, v133
    v_mfma_f32_16x16x32_bf16 v[80:83], v[8:11], v[200:203], v[80:83]
    buffer_load_dwordx4 v2, s[4:7], s61 offen offset:0 lds
    v_mul_f32 v100, v100, v116
    v_mfma_f32_16x16x32_bf16 v[88:91], v[8:11], v[204:207], v[88:91]
    v_mul_f32 v101, v101, v117
    v_mul_f32 v102, v102, v118
    s_waitcnt lgkmcnt(3)
    v_mfma_f32_16x16x32_bf16 v[68:71], v[12:15], v[192:195], v[68:71]
    ds_read_b128 v[28:31], v4 offset:11264
    v_mul_f32 v103, v103, v119
    v_mfma_f32_16x16x32_bf16 v[76:79], v[12:15], v[196:199], v[76:79]
    v_cvt_pk_bf16_f32 v230, v100, v101
    v_cvt_pk_bf16_f32 v231, v102, v103
    v_mfma_f32_16x16x32_bf16 v[84:87], v[12:15], v[200:203], v[84:87]
    buffer_store_dwordx4 v[228:231], v2, s[4:7], s66 offen offset:1024 sc1
    v_fmac_f32 v104, v136, v130
    v_mfma_f32_16x16x32_bf16 v[92:95], v[12:15], v[204:207], v[92:95]
    v_fmac_f32 v105, v137, v130
    v_fmac_f32 v106, v138, v130
    s_waitcnt lgkmcnt(3)
    v_mfma_f32_16x16x32_bf16 v[32:35], v[16:19], v[208:211], v[32:35]
    ds_read_b128 v[8:11], v4 offset:12288
    v_fmac_f32 v107, v139, v130
    v_mfma_f32_16x16x32_bf16 v[40:43], v[16:19], v[212:215], v[40:43]
    v_fmac_f32 v120, v140, v130
    v_fmac_f32 v121, v141, v130
    v_mfma_f32_16x16x32_bf16 v[48:51], v[16:19], v[216:219], v[48:51]
    buffer_load_dwordx4 v2, s[4:7], s61 offen offset:1024 lds
    v_fmac_f32 v122, v142, v130
    v_mfma_f32_16x16x32_bf16 v[56:59], v[16:19], v[220:223], v[56:59]
    v_fmac_f32 v123, v143, v130
    v_mul_f32 v104, v104, v134
    s_waitcnt lgkmcnt(3)
    v_mfma_f32_16x16x32_bf16 v[36:39], v[20:23], v[208:211], v[36:39]
    ds_read_b128 v[12:15], v4 offset:13312
    v_mul_f32 v105, v105, v134
    v_mfma_f32_16x16x32_bf16 v[44:47], v[20:23], v[212:215], v[44:47]
    v_mul_f32 v106, v106, v134
    v_mul_f32 v107, v107, v134
    v_mfma_f32_16x16x32_bf16 v[52:55], v[20:23], v[216:219], v[52:55]
    buffer_load_dwordx4 v2, s[4:7], s61 offen offset:2048 lds
    v_mul_f32 v104, v104, v120
    v_mfma_f32_16x16x32_bf16 v[60:63], v[20:23], v[220:223], v[60:63]
    v_mul_f32 v105, v105, v121
    v_mul_f32 v106, v106, v122
    s_waitcnt lgkmcnt(3)
    v_mfma_f32_16x16x32_bf16 v[64:67], v[24:27], v[208:211], v[64:67]
    ds_read_b128 v[16:19], v4 offset:14336
    v_mul_f32 v107, v107, v123
    v_mfma_f32_16x16x32_bf16 v[72:75], v[24:27], v[212:215], v[72:75]
    v_cvt_pk_bf16_f32 v234, v104, v105
    v_cvt_pk_bf16_f32 v235, v106, v107
    v_mfma_f32_16x16x32_bf16 v[80:83], v[24:27], v[216:219], v[80:83]
    buffer_store_dwordx4 v[232:235], v2, s[4:7], s66 offen offset:2048 sc1
    v_fmac_f32 v108, v136, v131
    v_mfma_f32_16x16x32_bf16 v[88:91], v[24:27], v[220:223], v[88:91]
    v_fmac_f32 v109, v137, v131
    v_fmac_f32 v110, v138, v131
    s_waitcnt lgkmcnt(3)
    v_mfma_f32_16x16x32_bf16 v[68:71], v[28:31], v[208:211], v[68:71]
    ds_read_b128 v[20:23], v4 offset:15360
    v_fmac_f32 v111, v139, v131
    v_mfma_f32_16x16x32_bf16 v[76:79], v[28:31], v[212:215], v[76:79]
    v_fmac_f32 v124, v140, v131
    v_fmac_f32 v125, v141, v131
    v_mfma_f32_16x16x32_bf16 v[84:87], v[28:31], v[216:219], v[84:87]
    v_fmac_f32 v126, v142, v131
    v_fmac_f32 v127, v143, v131
    v_mfma_f32_16x16x32_bf16 v[92:95], v[28:31], v[220:223], v[92:95]
    v_mul_f32 v108, v108, v135
    v_mul_f32 v109, v109, v135
    v_mul_f32 v110, v110, v135
    v_mul_f32 v111, v111, v135
    v_mul_f32 v108, v108, v124
    v_mul_f32 v109, v109, v125
    v_mul_f32 v110, v110, v126
    v_mul_f32 v111, v111, v127
    v_cvt_pk_bf16_f32 v238, v108, v109
    v_cvt_pk_bf16_f32 v239, v110, v111
    buffer_store_dwordx4 v[236:239], v2, s[4:7], s66 offen offset:3072 sc1
    s_waitcnt lgkmcnt(3)
    v_mfma_f32_16x16x32_bf16 v[96:99], v[8:11], v[176:179], 0
    ds_read_b128 v[24:27], v4 offset:16384
    v_mfma_f32_16x16x32_bf16 v[104:107], v[8:11], v[180:183], 0
    v_mfma_f32_16x16x32_bf16 v[112:115], v[8:11], v[184:187], 0
    v_mfma_f32_16x16x32_bf16 v[120:123], v[8:11], v[188:191], 0
    buffer_load_dwordx4 v2, s[4:7], s61 offen offset:3072 lds
    s_add_u32 m0, s49, 114688
    s_waitcnt lgkmcnt(3)
    v_mfma_f32_16x16x32_bf16 v[100:103], v[12:15], v[176:179], 0
    ds_read_b128 v[28:31], v4 offset:17408
    s_add_u32 s61, s48, 409600
    v_mfma_f32_16x16x32_bf16 v[108:111], v[12:15], v[180:183], 0
    v_mfma_f32_16x16x32_bf16 v[116:119], v[12:15], v[184:187], 0
    v_mfma_f32_16x16x32_bf16 v[124:127], v[12:15], v[188:191], 0
    buffer_load_dwordx4 v2, s[4:7], s61 offen offset:0 lds
    s_waitcnt lgkmcnt(3)
    v_mfma_f32_16x16x32_bf16 v[128:131], v[16:19], v[176:179], 0
    ds_read_b128 v[8:11], v4 offset:18432
    v_mfma_f32_16x16x32_bf16 v[136:139], v[16:19], v[180:183], 0
    v_mfma_f32_16x16x32_bf16 v[144:147], v[16:19], v[184:187], 0
    v_mfma_f32_16x16x32_bf16 v[152:155], v[16:19], v[188:191], 0
    buffer_load_dword v5, v7, s[4:7], s52 offen sc1
    s_waitcnt lgkmcnt(3)
    v_mfma_f32_16x16x32_bf16 v[132:135], v[20:23], v[176:179], 0
    ds_read_b128 v[12:15], v4 offset:19456
    v_mfma_f32_16x16x32_bf16 v[140:143], v[20:23], v[180:183], 0
    v_mfma_f32_16x16x32_bf16 v[148:151], v[20:23], v[184:187], 0
    v_mfma_f32_16x16x32_bf16 v[156:159], v[20:23], v[188:191], 0
    buffer_load_dwordx4 v2, s[4:7], s61 offen offset:1024 lds
    s_waitcnt lgkmcnt(3)
    v_mfma_f32_16x16x32_bf16 v[160:163], v[24:27], v[176:179], 0
    ds_read_b128 v[16:19], v4 offset:20480
    v_mfma_f32_16x16x32_bf16 v[164:167], v[24:27], v[180:183], 0
    v_mfma_f32_16x16x32_bf16 v[168:171], v[24:27], v[184:187], 0
    v_mfma_f32_16x16x32_bf16 v[172:175], v[24:27], v[188:191], 0
    buffer_load_dwordx4 v2, s[4:7], s61 offen offset:2048 lds
    s_waitcnt lgkmcnt(3)
    v_mfma_f32_16x16x32_bf16 v[96:99], v[28:31], v[192:195], v[96:99]
    ds_read_b128 v[20:23], v4 offset:21504
    v_mfma_f32_16x16x32_bf16 v[104:107], v[28:31], v[196:199], v[104:107]
    v_mfma_f32_16x16x32_bf16 v[112:115], v[28:31], v[200:203], v[112:115]
    v_mfma_f32_16x16x32_bf16 v[120:123], v[28:31], v[204:207], v[120:123]
    buffer_load_dwordx4 v2, s[4:7], s61 offen offset:3072 lds
    s_add_u32 m0, s49, 118784
    s_waitcnt lgkmcnt(3)
    v_mfma_f32_16x16x32_bf16 v[100:103], v[8:11], v[192:195], v[100:103]
    ds_read_b128 v[24:27], v4 offset:22528
    s_add_u32 s61, s48, 413696
    v_mfma_f32_16x16x32_bf16 v[108:111], v[8:11], v[196:199], v[108:111]
    v_mfma_f32_16x16x32_bf16 v[116:119], v[8:11], v[200:203], v[116:119]
    v_mfma_f32_16x16x32_bf16 v[124:127], v[8:11], v[204:207], v[124:127]
    buffer_load_dwordx4 v2, s[4:7], s61 offen offset:0 lds
    s_waitcnt lgkmcnt(3)
    v_mfma_f32_16x16x32_bf16 v[128:131], v[12:15], v[192:195], v[128:131]
    ds_read_b128 v[28:31], v4 offset:23552
    v_mfma_f32_16x16x32_bf16 v[136:139], v[12:15], v[196:199], v[136:139]
    v_mfma_f32_16x16x32_bf16 v[144:147], v[12:15], v[200:203], v[144:147]
    v_mfma_f32_16x16x32_bf16 v[152:155], v[12:15], v[204:207], v[152:155]
    s_waitcnt lgkmcnt(3)
    v_mfma_f32_16x16x32_bf16 v[132:135], v[16:19], v[192:195], v[132:135]
    ds_read_b128 v[8:11], v4 offset:24576
    v_mfma_f32_16x16x32_bf16 v[140:143], v[16:19], v[196:199], v[140:143]
    v_mfma_f32_16x16x32_bf16 v[148:151], v[16:19], v[200:203], v[148:151]
    v_mfma_f32_16x16x32_bf16 v[156:159], v[16:19], v[204:207], v[156:159]
    s_waitcnt lgkmcnt(3)
    v_mfma_f32_16x16x32_bf16 v[160:163], v[20:23], v[192:195], v[160:163]
    ds_read_b128 v[12:15], v4 offset:25600
    v_mfma_f32_16x16x32_bf16 v[164:167], v[20:23], v[196:199], v[164:167]
    v_mfma_f32_16x16x32_bf16 v[168:171], v[20:23], v[200:203], v[168:171]
    v_mfma_f32_16x16x32_bf16 v[172:175], v[20:23], v[204:207], v[172:175]
    s_waitcnt lgkmcnt(3)
    v_mfma_f32_16x16x32_bf16 v[96:99], v[24:27], v[208:211], v[96:99]
    ds_read_b128 v[16:19], v4 offset:26624
    v_mfma_f32_16x16x32_bf16 v[104:107], v[24:27], v[212:215], v[104:107]
    v_mfma_f32_16x16x32_bf16 v[112:115], v[24:27], v[216:219], v[112:115]
    v_mfma_f32_16x16x32_bf16 v[120:123], v[24:27], v[220:223], v[120:123]
    s_waitcnt lgkmcnt(3)
    v_mfma_f32_16x16x32_bf16 v[100:103], v[28:31], v[208:211], v[100:103]
    ds_read_b128 v[20:23], v4 offset:27648
    v_mfma_f32_16x16x32_bf16 v[108:111], v[28:31], v[212:215], v[108:111]
    v_mfma_f32_16x16x32_bf16 v[116:119], v[28:31], v[216:219], v[116:119]
    v_mfma_f32_16x16x32_bf16 v[124:127], v[28:31], v[220:223], v[124:127]
    s_waitcnt lgkmcnt(3)
    v_mfma_f32_16x16x32_bf16 v[128:131], v[8:11], v[208:211], v[128:131]
    ds_read_b128 v[24:27], v4 offset:28672
    v_mfma_f32_16x16x32_bf16 v[136:139], v[8:11], v[212:215], v[136:139]
    v_mfma_f32_16x16x32_bf16 v[144:147], v[8:11], v[216:219], v[144:147]
    v_mfma_f32_16x16x32_bf16 v[152:155], v[8:11], v[220:223], v[152:155]
    s_waitcnt vmcnt(4)
    v_cmp_le_u32 vcc, 2, v5
    s_nop 0
    s_cmp_eq_u64 vcc, exec
    s_cbranch_scc0 L_p1_slow_48
L_p1_back_49:
    s_waitcnt lgkmcnt(3)
    v_mfma_f32_16x16x32_bf16 v[132:135], v[12:15], v[208:211], v[132:135]
    ds_read_b128 v[28:31], v4 offset:29696
    s_add_u32 s60, s56, 32768
    v_mfma_f32_16x16x32_bf16 v[140:143], v[12:15], v[212:215], v[140:143]
    buffer_load_dwordx4 a[112:115], v2, s[4:7], s60 offen offset:0 sc1
    v_mfma_f32_16x16x32_bf16 v[148:151], v[12:15], v[216:219], v[148:151]
    v_mfma_f32_16x16x32_bf16 v[156:159], v[12:15], v[220:223], v[156:159]
    s_waitcnt lgkmcnt(3)
    v_mfma_f32_16x16x32_bf16 v[160:163], v[16:19], v[208:211], v[160:163]
    ds_read_b128 v[8:11], v4 offset:30720
    v_mfma_f32_16x16x32_bf16 v[164:167], v[16:19], v[212:215], v[164:167]
    buffer_load_dwordx4 a[116:119], v2, s[4:7], s60 offen offset:1024 sc1
    v_mfma_f32_16x16x32_bf16 v[168:171], v[16:19], v[216:219], v[168:171]
    v_mfma_f32_16x16x32_bf16 v[172:175], v[16:19], v[220:223], v[172:175]
    s_waitcnt lgkmcnt(3)
    v_mfma_f32_16x16x32_bf16 v[32:35], v[20:23], v[224:227], v[32:35]
    ds_read_b128 v[12:15], v4 offset:31744
    v_mfma_f32_16x16x32_bf16 v[40:43], v[20:23], v[228:231], v[40:43]
    buffer_load_dwordx4 a[120:123], v2, s[4:7], s60 offen offset:2048 sc1
    v_mfma_f32_16x16x32_bf16 v[48:51], v[20:23], v[232:235], v[48:51]
    v_mfma_f32_16x16x32_bf16 v[56:59], v[20:23], v[236:239], v[56:59]
    s_waitcnt lgkmcnt(3)
    v_mfma_f32_16x16x32_bf16 v[36:39], v[24:27], v[224:227], v[36:39]
    ds_read_b128 v[16:19], v4 offset:32768
    v_mfma_f32_16x16x32_bf16 v[44:47], v[24:27], v[228:231], v[44:47]
    buffer_load_dwordx4 a[124:127], v2, s[4:7], s60 offen offset:3072 sc1
    s_add_u32 s60, s57, 32768
    v_mfma_f32_16x16x32_bf16 v[52:55], v[24:27], v[232:235], v[52:55]
    v_mov_b32 v6, 3
    v_mov_b32 v0, 0
    v_mfma_f32_16x16x32_bf16 v[60:63], v[24:27], v[236:239], v[60:63]
    s_waitcnt lgkmcnt(3)
    v_mfma_f32_16x16x32_bf16 v[64:67], v[28:31], v[224:227], v[64:67]
    ds_read_b128 v[20:23], v4 offset:33792
    v_mfma_f32_16x16x32_bf16 v[72:75], v[28:31], v[228:231], v[72:75]
    s_mov_b64 exec, 1
    buffer_store_dword v6, v0, s[4:7], s67 offen sc1
    s_mov_b64 exec, -1
    v_mfma_f32_16x16x32_bf16 v[80:83], v[28:31], v[232:235], v[80:83]
    v_mfma_f32_16x16x32_bf16 v[88:91], v[28:31], v[236:239], v[88:91]
    s_waitcnt lgkmcnt(3)
    v_mfma_f32_16x16x32_bf16 v[68:71], v[8:11], v[224:227], v[68:71]
    ds_read_b128 v[24:27], v4 offset:34816
    v_mfma_f32_16x16x32_bf16 v[76:79], v[8:11], v[228:231], v[76:79]
    buffer_load_dwordx4 a[128:131], v2, s[4:7], s60 offen offset:0 sc1
    v_mfma_f32_16x16x32_bf16 v[84:87], v[8:11], v[232:235], v[84:87]
    v_mfma_f32_16x16x32_bf16 v[92:95], v[8:11], v[236:239], v[92:95]
    s_waitcnt lgkmcnt(3)
    v_mfma_f32_16x16x32_bf16 v[96:99], v[12:15], v[224:227], v[96:99]
    ds_read_b128 v[28:31], v4 offset:35840
    v_mfma_f32_16x16x32_bf16 v[104:107], v[12:15], v[228:231], v[104:107]
    buffer_load_dwordx4 a[132:135], v2, s[4:7], s60 offen offset:1024 sc1
    v_mfma_f32_16x16x32_bf16 v[112:115], v[12:15], v[232:235], v[112:115]
    v_mfma_f32_16x16x32_bf16 v[120:123], v[12:15], v[236:239], v[120:123]
    s_waitcnt lgkmcnt(3)
    v_mfma_f32_16x16x32_bf16 v[100:103], v[16:19], v[224:227], v[100:103]
    s_barrier
    v_mfma_f32_16x16x32_bf16 v[108:111], v[16:19], v[228:231], v[108:111]
    v_add_u32 v4, 0x9000, v4
    ds_read_b128 v[8:11], v4 offset:0
    v_mfma_f32_16x16x32_bf16 v[116:119], v[16:19], v[232:235], v[116:119]
    buffer_load_dwordx4 a[136:139], v2, s[4:7], s60 offen offset:2048 sc1
    s_add_u32 m0, s49, 0
    v_mfma_f32_16x16x32_bf16 v[124:127], v[16:19], v[236:239], v[124:127]
    s_add_u32 s61, s48, 442368
    s_waitcnt lgkmcnt(3)
    v_mfma_f32_16x16x32_bf16 v[128:131], v[20:23], v[224:227], v[128:131]
    ds_read_b128 v[12:15], v4 offset:1024
    v_mfma_f32_16x16x32_bf16 v[136:139], v[20:23], v[228:231], v[136:139]
    v_mfma_f32_16x16x32_bf16 v[144:147], v[20:23], v[232:235], v[144:147]
    buffer_load_dwordx4 a[140:143], v2, s[4:7], s60 offen offset:3072 sc1
    s_add_u32 s60, s58, 32768
    v_mfma_f32_16x16x32_bf16 v[152:155], v[20:23], v[236:239], v[152:155]
    s_waitcnt lgkmcnt(3)
    v_mfma_f32_16x16x32_bf16 v[132:135], v[24:27], v[224:227], v[132:135]
    ds_read_b128 v[16:19], v4 offset:2048
    v_mfma_f32_16x16x32_bf16 v[140:143], v[24:27], v[228:231], v[140:143]
    v_mfma_f32_16x16x32_bf16 v[148:151], v[24:27], v[232:235], v[148:151]
    buffer_load_dwordx4 a[144:147], v2, s[4:7], s60 offen offset:0 sc1
    v_mfma_f32_16x16x32_bf16 v[156:159], v[24:27], v[236:239], v[156:159]
    s_waitcnt lgkmcnt(3)
    v_mfma_f32_16x16x32_bf16 v[160:163], v[28:31], v[224:227], v[160:163]
    ds_read_b128 v[20:23], v4 offset:3072
    v_mfma_f32_16x16x32_bf16 v[164:167], v[28:31], v[228:231], v[164:167]
    v_mfma_f32_16x16x32_bf16 v[168:171], v[28:31], v[232:235], v[168:171]
    buffer_load_dwordx4 a[148:151], v2, s[4:7], s60 offen offset:1024 sc1
    v_mfma_f32_16x16x32_bf16 v[172:175], v[28:31], v[236:239], v[172:175]
    s_waitcnt lgkmcnt(3)
    v_mfma_f32_16x16x32_bf16 v[32:35], v[8:11], v[240:243], v[32:35]
    ds_read_b128 v[24:27], v4 offset:4096
    v_mfma_f32_16x16x32_bf16 v[40:43], v[8:11], v[244:247], v[40:43]
    v_mfma_f32_16x16x32_bf16 v[48:51], v[8:11], v[248:251], v[48:51]
    buffer_load_dwordx4 a[152:155], v2, s[4:7], s60 offen offset:2048 sc1
    v_mfma_f32_16x16x32_bf16 v[56:59], v[8:11], v[252:255], v[56:59]
    s_waitcnt lgkmcnt(3)
    v_mfma_f32_16x16x32_bf16 v[36:39], v[12:15], v[240:243], v[36:39]
    ds_read_b128 v[28:31], v4 offset:5120
    v_mfma_f32_16x16x32_bf16 v[44:47], v[12:15], v[244:247], v[44:47]
    v_mfma_f32_16x16x32_bf16 v[52:55], v[12:15], v[248:251], v[52:55]
    buffer_load_dwordx4 a[156:159], v2, s[4:7], s60 offen offset:3072 sc1
    v_mfma_f32_16x16x32_bf16 v[60:63], v[12:15], v[252:255], v[60:63]
    s_waitcnt lgkmcnt(3)
    v_mfma_f32_16x16x32_bf16 v[64:67], v[16:19], v[240:243], v[64:67]
    ds_read_b128 v[8:11], v4 offset:6144
    v_mfma_f32_16x16x32_bf16 v[72:75], v[16:19], v[244:247], v[72:75]
    v_mfma_f32_16x16x32_bf16 v[80:83], v[16:19], v[248:251], v[80:83]
    buffer_load_dwordx4 v2, s[4:7], s61 offen offset:0 lds
    v_mfma_f32_16x16x32_bf16 v[88:91], v[16:19], v[252:255], v[88:91]
    s_waitcnt lgkmcnt(3)
    v_mfma_f32_16x16x32_bf16 v[68:71], v[20:23], v[240:243], v[68:71]
    ds_read_b128 v[12:15], v4 offset:7168
    v_mfma_f32_16x16x32_bf16 v[76:79], v[20:23], v[244:247], v[76:79]
    v_mfma_f32_16x16x32_bf16 v[84:87], v[20:23], v[248:251], v[84:87]
    buffer_load_dwordx4 v2, s[4:7], s61 offen offset:1024 lds
    v_mfma_f32_16x16x32_bf16 v[92:95], v[20:23], v[252:255], v[92:95]
    s_waitcnt lgkmcnt(3)
    v_mfma_f32_16x16x32_bf16 v[96:99], v[24:27], v[240:243], v[96:99]
    ds_read_b128 v[16:19], v4 offset:8192
    v_mfma_f32_16x16x32_bf16 v[104:107], v[24:27], v[244:247], v[104:107]
    v_mfma_f32_16x16x32_bf16 v[112:115], v[24:27], v[248:251], v[112:115]
    buffer_load_dwordx4 v2, s[4:7], s61 offen offset:2048 lds
    v_mfma_f32_16x16x32_bf16 v[120:123], v[24:27], v[252:255], v[120:123]
    s_waitcnt lgkmcnt(3)
    v_mfma_f32_16x16x32_bf16 v[100:103], v[28:31], v[240:243], v[100:103]
    ds_read_b128 v[20:23], v4 offset:9216
    v_mfma_f32_16x16x32_bf16 v[108:111], v[28:31], v[244:247], v[108:111]
    v_mfma_f32_16x16x32_bf16 v[116:119], v[28:31], v[248:251], v[116:119]
    buffer_load_dwordx4 v2, s[4:7], s61 offen offset:3072 lds
    s_add_u32 m0, s49, 4096
    v_mfma_f32_16x16x32_bf16 v[124:127], v[28:31], v[252:255], v[124:127]
    s_add_u32 s61, s48, 446464
    s_waitcnt lgkmcnt(3)
    v_mfma_f32_16x16x32_bf16 v[128:131], v[8:11], v[240:243], v[128:131]
    ds_read_b128 v[24:27], v4 offset:10240
    v_mfma_f32_16x16x32_bf16 v[136:139], v[8:11], v[244:247], v[136:139]
    v_mfma_f32_16x16x32_bf16 v[144:147], v[8:11], v[248:251], v[144:147]
    buffer_load_dwordx4 v2, s[4:7], s61 offen offset:0 lds
    v_mfma_f32_16x16x32_bf16 v[152:155], v[8:11], v[252:255], v[152:155]
    s_waitcnt lgkmcnt(3)
    v_mfma_f32_16x16x32_bf16 v[132:135], v[12:15], v[240:243], v[132:135]
    ds_read_b128 v[28:31], v4 offset:11264
    v_mfma_f32_16x16x32_bf16 v[140:143], v[12:15], v[244:247], v[140:143]
    v_mfma_f32_16x16x32_bf16 v[148:151], v[12:15], v[248:251], v[148:151]
    buffer_load_dwordx4 v2, s[4:7], s61 offen offset:1024 lds
    v_mfma_f32_16x16x32_bf16 v[156:159], v[12:15], v[252:255], v[156:159]
    s_waitcnt lgkmcnt(3)
    v_mfma_f32_16x16x32_bf16 v[160:163], v[16:19], v[240:243], v[160:163]
    ds_read_b128 v[8:11], v4 offset:12288
    v_mfma_f32_16x16x32_bf16 v[164:167], v[16:19], v[244:247], v[164:167]
    v_mfma_f32_16x16x32_bf16 v[168:171], v[16:19], v[248:251], v[168:171]
    buffer_load_dwordx4 v2, s[4:7], s61 offen offset:2048 lds
    v_mfma_f32_16x16x32_bf16 v[172:175], v[16:19], v[252:255], v[172:175]
    s_waitcnt lgkmcnt(3)
    v_mfma_f32_16x16x32_bf16 v[32:35], v[20:23], a[0:3], v[32:35]
    ds_read_b128 v[12:15], v4 offset:13312
    v_mfma_f32_16x16x32_bf16 v[40:43], v[20:23], a[4:7], v[40:43]
    v_mfma_f32_16x16x32_bf16 v[48:51], v[20:23], a[8:11], v[48:51]
    buffer_load_dwordx4 v2, s[4:7], s61 offen offset:3072 lds
    s_add_u32 m0, s49, 8192
    v_mfma_f32_16x16x32_bf16 v[56:59], v[20:23], a[12:15], v[56:59]
    s_add_u32 s61, s48, 450560
    s_waitcnt lgkmcnt(3)
    v_mfma_f32_16x16x32_bf16 v[36:39], v[24:27], a[0:3], v[36:39]
    ds_read_b128 v[16:19], v4 offset:14336
    v_mfma_f32_16x16x32_bf16 v[44:47], v[24:27], a[4:7], v[44:47]
    v_mfma_f32_16x16x32_bf16 v[52:55], v[24:27], a[8:11], v[52:55]
    buffer_load_dwordx4 v2, s[4:7], s61 offen offset:0 lds
    v_mfma_f32_16x16x32_bf16 v[60:63], v[24:27], a[12:15], v[60:63]
    s_waitcnt lgkmcnt(3)
    v_mfma_f32_16x16x32_bf16 v[64:67], v[28:31], a[0:3], v[64:67]
    ds_read_b128 v[20:23], v4 offset:15360
    v_mfma_f32_16x16x32_bf16 v[72:75], v[28:31], a[4:7], v[72:75]
    v_mfma_f32_16x16x32_bf16 v[80:83], v[28:31], a[8:11], v[80:83]
    v_mfma_f32_16x16x32_bf16 v[88:91], v[28:31], a[12:15], v[88:91]
    s_waitcnt lgkmcnt(3)
    v_mfma_f32_16x16x32_bf16 v[68:71], v[8:11], a[0:3], v[68:71]
    ds_read_b128 v[24:27], v4 offset:16384
    v_mfma_f32_16x16x32_bf16 v[76:79], v[8:11], a[4:7], v[76:79]
    v_mfma_f32_16x16x32_bf16 v[84:87], v[8:11], a[8:11], v[84:87]
    v_mfma_f32_16x16x32_bf16 v[92:95], v[8:11], a[12:15], v[92:95]
    s_waitcnt lgkmcnt(3)
    v_mfma_f32_16x16x32_bf16 v[96:99], v[12:15], a[0:3], v[96:99]
    ds_read_b128 v[28:31], v4 offset:17408
    v_mfma_f32_16x16x32_bf16 v[104:107], v[12:15], a[4:7], v[104:107]
    v_mfma_f32_16x16x32_bf16 v[112:115], v[12:15], a[8:11], v[112:115]
    v_mfma_f32_16x16x32_bf16 v[120:123], v[12:15], a[12:15], v[120:123]
    s_waitcnt lgkmcnt(3)
    v_mfma_f32_16x16x32_bf16 v[100:103], v[16:19], a[0:3], v[100:103]
    ds_read_b128 v[8:11], v4 offset:18432
    v_mfma_f32_16x16x32_bf16 v[108:111], v[16:19], a[4:7], v[108:111]
    v_mfma_f32_16x16x32_bf16 v[116:119], v[16:19], a[8:11], v[116:119]
    v_mfma_f32_16x16x32_bf16 v[124:127], v[16:19], a[12:15], v[124:127]
    s_waitcnt lgkmcnt(3)
    v_mfma_f32_16x16x32_bf16 v[128:131], v[20:23], a[0:3], v[128:131]
    ds_read_b128 v[12:15], v4 offset:19456
    v_mfma_f32_16x16x32_bf16 v[136:139], v[20:23], a[4:7], v[136:139]
    v_mfma_f32_16x16x32_bf16 v[144:147], v[20:23], a[8:11], v[144:147]
    v_mfma_f32_16x16x32_bf16 v[152:155], v[20:23], a[12:15], v[152:155]
    s_waitcnt lgkmcnt(3)
    v_mfma_f32_16x16x32_bf16 v[132:135], v[24:27], a[0:3], v[132:135]
    ds_read_b128 v[16:19], v4 offset:20480
    v_mfma_f32_16x16x32_bf16 v[140:143], v[24:27], a[4:7], v[140:143]
    v_mfma_f32_16x16x32_bf16 v[148:151], v[24:27], a[8:11], v[148:151]
    v_mfma_f32_16x16x32_bf16 v[156:159], v[24:27], a[12:15], v[156:159]
    buffer_load_dword v5, v7, s[4:7], s52 offen sc1
    s_waitcnt lgkmcnt(3)
    v_mfma_f32_16x16x32_bf16 v[160:163], v[28:31], a[0:3], v[160:163]
    ds_read_b128 v[20:23], v4 offset:21504
    v_mfma_f32_16x16x32_bf16 v[164:167], v[28:31], a[4:7], v[164:167]
    v_mfma_f32_16x16x32_bf16 v[168:171], v[28:31], a[8:11], v[168:171]
    v_mfma_f32_16x16x32_bf16 v[172:175], v[28:31], a[12:15], v[172:175]
    s_waitcnt lgkmcnt(3)
    v_mfma_f32_16x16x32_bf16 v[32:35], v[8:11], a[16:19], v[32:35]
    ds_read_b128 v[24:27], v4 offset:22528
    v_mfma_f32_16x16x32_bf16 v[40:43], v[8:11], a[20:23], v[40:43]
    v_mfma_f32_16x16x32_bf16 v[48:51], v[8:11], a[24:27], v[48:51]
    v_mfma_f32_16x16x32_bf16 v[56:59], v[8:11], a[28:31], v[56:59]
    s_waitcnt lgkmcnt(3)
    v_mfma_f32_16x16x32_bf16 v[36:39], v[12:15], a[16:19], v[36:39]
    ds_read_b128 v[28:31], v4 offset:23552
    v_mfma_f32_16x16x32_bf16 v[44:47], v[12:15], a[20:23], v[44:47]
    v_mfma_f32_16x16x32_bf16 v[52:55], v[12:15], a[24:27], v[52:55]
    v_mfma_f32_16x16x32_bf16 v[60:63], v[12:15], a[28:31], v[60:63]
    s_waitcnt lgkmcnt(3)
    v_mfma_f32_16x16x32_bf16 v[64:67], v[16:19], a[16:19], v[64:67]
    ds_read_b128 v[8:11], v4 offset:24576
    v_mfma_f32_16x16x32_bf16 v[72:75], v[16:19], a[20:23], v[72:75]
    v_mfma_f32_16x16x32_bf16 v[80:83], v[16:19], a[24:27], v[80:83]
    v_mfma_f32_16x16x32_bf16 v[88:91], v[16:19], a[28:31], v[88:91]
    s_waitcnt lgkmcnt(3)
    v_mfma_f32_16x16x32_bf16 v[68:71], v[20:23], a[16:19], v[68:71]
    ds_read_b128 v[12:15], v4 offset:25600
    v_mfma_f32_16x16x32_bf16 v[76:79], v[20:23], a[20:23], v[76:79]
    v_mfma_f32_16x16x32_bf16 v[84:87], v[20:23], a[24:27], v[84:87]
    v_mfma_f32_16x16x32_bf16 v[92:95], v[20:23], a[28:31], v[92:95]
    s_waitcnt lgkmcnt(3)
    v_mfma_f32_16x16x32_bf16 v[96:99], v[24:27], a[16:19], v[96:99]
    ds_read_b128 v[16:19], v4 offset:26624
    v_mfma_f32_16x16x32_bf16 v[104:107], v[24:27], a[20:23], v[104:107]
    v_mfma_f32_16x16x32_bf16 v[112:115], v[24:27], a[24:27], v[112:115]
    v_mfma_f32_16x16x32_bf16 v[120:123], v[24:27], a[28:31], v[120:123]
    s_waitcnt lgkmcnt(3)
    v_mfma_f32_16x16x32_bf16 v[100:103], v[28:31], a[16:19], v[100:103]
    ds_read_b128 v[20:23], v4 offset:27648
    v_mfma_f32_16x16x32_bf16 v[108:111], v[28:31], a[20:23], v[108:111]
    v_mfma_f32_16x16x32_bf16 v[116:119], v[28:31], a[24:27], v[116:119]
    v_mfma_f32_16x16x32_bf16 v[124:127], v[28:31], a[28:31], v[124:127]
    s_waitcnt lgkmcnt(3)
    v_mfma_f32_16x16x32_bf16 v[128:131], v[8:11], a[16:19], v[128:131]
    ds_read_b128 v[24:27], v4 offset:28672
    v_mfma_f32_16x16x32_bf16 v[136:139], v[8:11], a[20:23], v[136:139]
    v_mfma_f32_16x16x32_bf16 v[144:147], v[8:11], a[24:27], v[144:147]
    v_mfma_f32_16x16x32_bf16 v[152:155], v[8:11], a[28:31], v[152:155]
    s_waitcnt lgkmcnt(3)
    v_mfma_f32_16x16x32_bf16 v[132:135], v[12:15], a[16:19], v[132:135]
    ds_read_b128 v[28:31], v4 offset:29696
    v_mfma_f32_16x16x32_bf16 v[140:143], v[12:15], a[20:23], v[140:143]
    v_mfma_f32_16x16x32_bf16 v[148:151], v[12:15], a[24:27], v[148:151]
    v_mfma_f32_16x16x32_bf16 v[156:159], v[12:15], a[28:31], v[156:159]
    s_waitcnt lgkmcnt(3)
    v_mfma_f32_16x16x32_bf16 v[160:163], v[16:19], a[16:19], v[160:163]
    ds_read_b128 v[8:11], v4 offset:30720
    v_mfma_f32_16x16x32_bf16 v[164:167], v[16:19], a[20:23], v[164:167]
    v_mfma_f32_16x16x32_bf16 v[168:171], v[16:19], a[24:27], v[168:171]
    v_mfma_f32_16x16x32_bf16 v[172:175], v[16:19], a[28:31], v[172:175]
    s_waitcnt vmcnt(0)
    v_cmp_le_u32 vcc, 3, v5
    s_nop 0
    s_cmp_eq_u64 vcc, exec
    s_cbranch_scc0 L_p2_slow_50
L_p2_back_51:
    s_waitcnt lgkmcnt(3)
    v_mfma_f32_16x16x32_bf16 v[32:35], v[20:23], a[32:35], v[32:35]
    ds_read_b128 v[12:15], v4 offset:31744
    s_add_u32 s60, s56, 49152
    v_mfma_f32_16x16x32_bf16 v[40:43], v[20:23], a[36:39], v[40:43]
    buffer_load_dwordx4 a[160:163], v2, s[4:7], s60 offen offset:0 sc1
    v_mfma_f32_16x16x32_bf16 v[48:51], v[20:23], a[40:43], v[48:51]
    v_mfma_f32_16x16x32_bf16 v[56:59], v[20:23], a[44:47], v[56:59]
    s_and_b32 s68, s46, 1
    s_mul_i32 s69, s68, 5120
    s_waitcnt lgkmcnt(3)
    v_mfma_f32_16x16x32_bf16 v[36:39], v[24:27], a[32:35], v[36:39]
    ds_read_b128 v[16:19], v4 offset:32768
    s_add_u32 s69, s69, s53
    v_mfma_f32_16x16x32_bf16 v[44:47], v[24:27], a[36:39], v[44:47]
    buffer_load_dwordx4 a[164:167], v2, s[4:7], s60 offen offset:1024 sc1
    s_lshl_b32 s68, s68, 9
    v_mfma_f32_16x16x32_bf16 v[52:55], v[24:27], a[40:43], v[52:55]
    s_add_u32 s68, s68, s53
    v_and_b32 v0, 15, v1
    v_mfma_f32_16x16x32_bf16 v[60:63], v[24:27], a[44:47], v[60:63]
    v_lshlrev_b32 v0, 5, v0
    v_lshrrev_b32 v5, 4, v1
    s_waitcnt lgkmcnt(3)
    v_mfma_f32_16x16x32_bf16 v[64:67], v[28:31], a[32:35], v[64:67]
    ds_read_b128 v[20:23], v4 offset:33792
    v_lshl_add_u32 v0, v5, 3, v0
    v_mfma_f32_16x16x32_bf16 v[72:75], v[28:31], a[36:39], v[72:75]
    buffer_load_dwordx4 a[168:171], v2, s[4:7], s60 offen offset:2048 sc1
    v_mfma_f32_16x16x32_bf16 v[80:83], v[28:31], a[40:43], v[80:83]
    v_mfma_f32_16x16x32_bf16 v[88:91], v[28:31], a[44:47], v[88:91]
    s_waitcnt lgkmcnt(3)
    v_mfma_f32_16x16x32_bf16 v[68:71], v[8:11], a[32:35], v[68:71]
    ds_read_b128 v[24:27], v4 offset:34816
    v_mfma_f32_16x16x32_bf16 v[76:79], v[8:11], a[36:39], v[76:79]
    buffer_load_dwordx4 a[172:175], v2, s[4:7], s60 offen offset:3072 sc1
    s_add_u32 s60, s57, 49152
    v_mfma_f32_16x16x32_bf16 v[84:87], v[8:11], a[40:43], v[84:87]
    v_mfma_f32_16x16x32_bf16 v[92:95], v[8:11], a[44:47], v[92:95]
    s_waitcnt lgkmcnt(3)
    v_mfma_f32_16x16x32_bf16 v[96:99], v[12:15], a[32:35], v[96:99]
    ds_read_b128 v[28:31], v4 offset:35840
    v_mfma_f32_16x16x32_bf16 v[104:107], v[12:15], a[36:39], v[104:107]
    buffer_load_dwordx4 a[176:179], v2, s[4:7], s60 offen offset:0 sc1
    v_mfma_f32_16x16x32_bf16 v[112:115], v[12:15], a[40:43], v[112:115]
    v_mfma_f32_16x16x32_bf16 v[120:123], v[12:15], a[44:47], v[120:123]
    s_waitcnt lgkmcnt(3)
    v_mfma_f32_16x16x32_bf16 v[100:103], v[16:19], a[32:35], v[100:103]
    s_barrier
    v_mfma_f32_16x16x32_bf16 v[108:111], v[16:19], a[36:39], v[108:111]
    v_add_u32 v4, 0x9000, v4
    ds_read_b128 v[8:11], v4 offset:0
    v_mfma_f32_16x16x32_bf16 v[116:119], v[16:19], a[40:43], v[116:119]
    buffer_load_dwordx4 a[180:183], v2, s[4:7], s60 offen offset:1024 sc1
    s_add_u32 m0, s63, 36864
    v_mfma_f32_16x16x32_bf16 v[124:127], v[16:19], a[44:47], v[124:127]
    s_add_u32 s61, s62, 479232
    s_waitcnt lgkmcnt(3)
    v_mfma_f32_16x16x32_bf16 v[128:131], v[20:23], a[32:35], v[128:131]
    ds_read_b128 v[12:15], v4 offset:1024
    v_mfma_f32_16x16x32_bf16 v[136:139], v[20:23], a[36:39], v[136:139]
    v_mfma_f32_16x16x32_bf16 v[144:147], v[20:23], a[40:43], v[144:147]
    buffer_load_dwordx4 a[184:187], v2, s[4:7], s60 offen offset:2048 sc1
    v_mfma_f32_16x16x32_bf16 v[152:155], v[20:23], a[44:47], v[152:155]
    s_waitcnt lgkmcnt(3)
    v_mfma_f32_16x16x32_bf16 v[132:135], v[24:27], a[32:35], v[132:135]
    ds_read_b128 v[16:19], v4 offset:2048
    v_mfma_f32_16x16x32_bf16 v[140:143], v[24:27], a[36:39], v[140:143]
    v_mfma_f32_16x16x32_bf16 v[148:151], v[24:27], a[40:43], v[148:151]
    buffer_load_dwordx4 a[188:191], v2, s[4:7], s60 offen offset:3072 sc1
    s_add_u32 s60, s58, 49152
    v_mfma_f32_16x16x32_bf16 v[156:159], v[24:27], a[44:47], v[156:159]
    s_waitcnt lgkmcnt(3)
    v_mfma_f32_16x16x32_bf16 v[160:163], v[28:31], a[32:35], v[160:163]
    ds_read_b128 v[20:23], v4 offset:3072
    v_mfma_f32_16x16x32_bf16 v[164:167], v[28:31], a[36:39], v[164:167]
    v_mfma_f32_16x16x32_bf16 v[168:171], v[28:31], a[40:43], v[168:171]
    buffer_load_dwordx4 a[192:195], v2, s[4:7], s60 offen offset:0 sc1
    v_mfma_f32_16x16x32_bf16 v[172:175], v[28:31], a[44:47], v[172:175]
    s_waitcnt lgkmcnt(3)
    v_mfma_f32_16x16x32_bf16 v[32:35], v[8:11], a[48:51], v[32:35]
    ds_read_b128 v[24:27], v4 offset:4096
    v_mfma_f32_16x16x32_bf16 v[40:43], v[8:11], a[52:55], v[40:43]
    v_mfma_f32_16x16x32_bf16 v[48:51], v[8:11], a[56:59], v[48:51]
    buffer_load_dwordx4 a[196:199], v2, s[4:7], s60 offen offset:1024 sc1
    v_mfma_f32_16x16x32_bf16 v[56:59], v[8:11], a[60:63], v[56:59]
    s_waitcnt lgkmcnt(3)
    v_mfma_f32_16x16x32_bf16 v[36:39], v[12:15], a[48:51], v[36:39]
    ds_read_b128 v[28:31], v4 offset:5120
    v_mfma_f32_16x16x32_bf16 v[44:47], v[12:15], a[52:55], v[44:47]
    v_mfma_f32_16x16x32_bf16 v[52:55], v[12:15], a[56:59], v[52:55]
    buffer_load_dwordx4 a[200:203], v2, s[4:7], s60 offen offset:2048 sc1
    v_mfma_f32_16x16x32_bf16 v[60:63], v[12:15], a[60:63], v[60:63]
    s_waitcnt lgkmcnt(3)
    v_mfma_f32_16x16x32_bf16 v[64:67], v[16:19], a[48:51], v[64:67]
    ds_read_b128 v[8:11], v4 offset:6144
    v_mfma_f32_16x16x32_bf16 v[72:75], v[16:19], a[52:55], v[72:75]
    v_mfma_f32_16x16x32_bf16 v[80:83], v[16:19], a[56:59], v[80:83]
    buffer_load_dwordx4 a[204:207], v2, s[4:7], s60 offen offset:3072 sc1
    v_mfma_f32_16x16x32_bf16 v[88:91], v[16:19], a[60:63], v[88:91]
    s_waitcnt lgkmcnt(3)
    v_mfma_f32_16x16x32_bf16 v[68:71], v[20:23], a[48:51], v[68:71]
    ds_read_b128 v[12:15], v4 offset:7168
    v_mfma_f32_16x16x32_bf16 v[76:79], v[20:23], a[52:55], v[76:79]
    v_mfma_f32_16x16x32_bf16 v[84:87], v[20:23], a[56:59], v[84:87]
    buffer_load_dwordx4 v2, s[4:7], s61 offen offset:0 lds
    v_mfma_f32_16x16x32_bf16 v[92:95], v[20:23], a[60:63], v[92:95]
    s_waitcnt lgkmcnt(3)
    v_mfma_f32_16x16x32_bf16 v[96:99], v[24:27], a[48:51], v[96:99]
    ds_read_b128 v[16:19], v4 offset:8192
    v_mfma_f32_16x16x32_bf16 v[104:107], v[24:27], a[52:55], v[104:107]
    v_mfma_f32_16x16x32_bf16 v[112:115], v[24:27], a[56:59], v[112:115]
    buffer_load_dwordx4 v2, s[4:7], s61 offen offset:1024 lds
    v_mfma_f32_16x16x32_bf16 v[120:123], v[24:27], a[60:63], v[120:123]
    s_waitcnt lgkmcnt(3)
    v_mfma_f32_16x16x32_bf16 v[100:103], v[28:31], a[48:51], v[100:103]
    ds_read_b128 v[20:23], v4 offset:9216
    v_mfma_f32_16x16x32_bf16 v[108:111], v[28:31], a[52:55], v[108:111]
    v_mfma_f32_16x16x32_bf16 v[116:119], v[28:31], a[56:59], v[116:119]
    buffer_load_dwordx4 v2, s[4:7], s61 offen offset:2048 lds
    v_mfma_f32_16x16x32_bf16 v[124:127], v[28:31], a[60:63], v[124:127]
    s_waitcnt lgkmcnt(3)
    v_mfma_f32_16x16x32_bf16 v[128:131], v[8:11], a[48:51], v[128:131]
    ds_read_b128 v[24:27], v4 offset:10240
    v_mfma_f32_16x16x32_bf16 v[136:139], v[8:11], a[52:55], v[136:139]
    v_mfma_f32_16x16x32_bf16 v[144:147], v[8:11], a[56:59], v[144:147]
    buffer_load_dwordx4 v2, s[4:7], s61 offen offset:3072 lds
    s_add_u32 m0, s63, 40960
    v_mfma_f32_16x16x32_bf16 v[152:155], v[8:11], a[60:63], v[152:155]
    s_add_u32 s61, s62, 483328
    s_waitcnt lgkmcnt(3)
    v_mfma_f32_16x16x32_bf16 v[132:135], v[12:15], a[48:51], v[132:135]
    ds_read_b128 v[28:31], v4 offset:11264
    v_mfma_f32_16x16x32_bf16 v[140:143], v[12:15], a[52:55], v[140:143]
    v_mfma_f32_16x16x32_bf16 v[148:151], v[12:15], a[56:59], v[148:151]
    buffer_load_dwordx4 v2, s[4:7], s61 offen offset:0 lds
    v_mfma_f32_16x16x32_bf16 v[156:159], v[12:15], a[60:63], v[156:159]
    s_waitcnt lgkmcnt(3)
    v_mfma_f32_16x16x32_bf16 v[160:163], v[16:19], a[48:51], v[160:163]
    ds_read_b128 v[8:11], v4 offset:12288
    v_mfma_f32_16x16x32_bf16 v[164:167], v[16:19], a[52:55], v[164:167]
    v_mfma_f32_16x16x32_bf16 v[168:171], v[16:19], a[56:59], v[168:171]
    v_mfma_f32_16x16x32_bf16 v[172:175], v[16:19], a[60:63], v[172:175]
    s_waitcnt lgkmcnt(3)
    v_mfma_f32_16x16x32_bf16 v[32:35], v[20:23], a[64:67], v[32:35]
    ds_read_b128 v[12:15], v4 offset:13312
    v_mfma_f32_16x16x32_bf16 v[40:43], v[20:23], a[68:71], v[40:43]
    v_mfma_f32_16x16x32_bf16 v[48:51], v[20:23], a[72:75], v[48:51]
    v_mfma_f32_16x16x32_bf16 v[56:59], v[20:23], a[76:79], v[56:59]
    s_waitcnt lgkmcnt(3)
    v_mfma_f32_16x16x32_bf16 v[36:39], v[24:27], a[64:67], v[36:39]
    ds_read_b128 v[16:19], v4 offset:14336
    v_mfma_f32_16x16x32_bf16 v[44:47], v[24:27], a[68:71], v[44:47]
    v_mfma_f32_16x16x32_bf16 v[52:55], v[24:27], a[72:75], v[52:55]
    v_mfma_f32_16x16x32_bf16 v[60:63], v[24:27], a[76:79], v[60:63]
    s_waitcnt lgkmcnt(3)
    v_mfma_f32_16x16x32_bf16 v[32:35], v[28:31], a[80:83], v[32:35]
    ds_read_b128 v[20:23], v4 offset:15360
    v_mfma_f32_16x16x32_bf16 v[40:43], v[28:31], a[84:87], v[40:43]
    v_mfma_f32_16x16x32_bf16 v[48:51], v[28:31], a[88:91], v[48:51]
    v_mfma_f32_16x16x32_bf16 v[56:59], v[28:31], a[92:95], v[56:59]
    s_waitcnt lgkmcnt(3)
    v_mfma_f32_16x16x32_bf16 v[36:39], v[8:11], a[80:83], v[36:39]
    ds_read_b128 v[24:27], v4 offset:16384
    v_mfma_f32_16x16x32_bf16 v[44:47], v[8:11], a[84:87], v[44:47]
    v_mfma_f32_16x16x32_bf16 v[52:55], v[8:11], a[88:91], v[52:55]
    v_mfma_f32_16x16x32_bf16 v[60:63], v[8:11], a[92:95], v[60:63]
    s_waitcnt lgkmcnt(3)
    v_mfma_f32_16x16x32_bf16 v[32:35], v[12:15], a[96:99], v[32:35]
    ds_read_b128 v[28:31], v4 offset:17408
    v_mfma_f32_16x16x32_bf16 v[40:43], v[12:15], a[100:103], v[40:43]
    v_mfma_f32_16x16x32_bf16 v[48:51], v[12:15], a[104:107], v[48:51]
    v_mfma_f32_16x16x32_bf16 v[56:59], v[12:15], a[108:111], v[56:59]
    s_waitcnt lgkmcnt(3)
    v_mfma_f32_16x16x32_bf16 v[36:39], v[16:19], a[96:99], v[36:39]
    ds_read_b128 v[8:11], v4 offset:18432
    v_mfma_f32_16x16x32_bf16 v[44:47], v[16:19], a[100:103], v[44:47]
    v_mfma_f32_16x16x32_bf16 v[52:55], v[16:19], a[104:107], v[52:55]
    v_mfma_f32_16x16x32_bf16 v[60:63], v[16:19], a[108:111], v[60:63]
    s_waitcnt lgkmcnt(3)
    v_mfma_f32_16x16x32_bf16 v[32:35], v[20:23], a[112:115], v[32:35]
    ds_read_b128 v[12:15], v4 offset:19456
    v_mfma_f32_16x16x32_bf16 v[40:43], v[20:23], a[116:119], v[40:43]
    v_mfma_f32_16x16x32_bf16 v[48:51], v[20:23], a[120:123], v[48:51]
    v_mfma_f32_16x16x32_bf16 v[56:59], v[20:23], a[124:127], v[56:59]
    s_waitcnt lgkmcnt(3)
    v_mfma_f32_16x16x32_bf16 v[36:39], v[24:27], a[112:115], v[36:39]
    ds_read_b128 v[16:19], v4 offset:20480
    v_mfma_f32_16x16x32_bf16 v[44:47], v[24:27], a[116:119], v[44:47]
    v_mfma_f32_16x16x32_bf16 v[52:55], v[24:27], a[120:123], v[52:55]
    v_mfma_f32_16x16x32_bf16 v[60:63], v[24:27], a[124:127], v[60:63]
    s_waitcnt lgkmcnt(3)
    v_mfma_f32_16x16x32_bf16 v[32:35], v[28:31], a[128:131], v[32:35]
    ds_read_b128 v[20:23], v4 offset:21504
    v_mfma_f32_16x16x32_bf16 v[40:43], v[28:31], a[132:135], v[40:43]
    v_mfma_f32_16x16x32_bf16 v[48:51], v[28:31], a[136:139], v[48:51]
    v_mfma_f32_16x16x32_bf16 v[56:59], v[28:31], a[140:143], v[56:59]
    s_waitcnt lgkmcnt(3)
    v_mfma_f32_16x16x32_bf16 v[36:39], v[8:11], a[128:131], v[36:39]
    ds_read_b128 v[24:27], v4 offset:22528
    v_mfma_f32_16x16x32_bf16 v[44:47], v[8:11], a[132:135], v[44:47]
    v_mfma_f32_16x16x32_bf16 v[52:55], v[8:11], a[136:139], v[52:55]
    v_mfma_f32_16x16x32_bf16 v[60:63], v[8:11], a[140:143], v[60:63]
    s_waitcnt lgkmcnt(3)
    v_mfma_f32_16x16x32_bf16 v[32:35], v[12:15], a[144:147], v[32:35]
    ds_read_b128 v[28:31], v4 offset:23552
    v_mfma_f32_16x16x32_bf16 v[40:43], v[12:15], a[148:151], v[40:43]
    v_mfma_f32_16x16x32_bf16 v[48:51], v[12:15], a[152:155], v[48:51]
    v_mfma_f32_16x16x32_bf16 v[56:59], v[12:15], a[156:159], v[56:59]
    s_waitcnt lgkmcnt(3)
    v_mfma_f32_16x16x32_bf16 v[36:39], v[16:19], a[144:147], v[36:39]
    ds_read_b128 v[8:11], v4 offset:24576
    v_mfma_f32_16x16x32_bf16 v[44:47], v[16:19], a[148:151], v[44:47]
    v_mfma_f32_16x16x32_bf16 v[52:55], v[16:19], a[152:155], v[52:55]
    v_mfma_f32_16x16x32_bf16 v[60:63], v[16:19], a[156:159], v[60:63]
    s_waitcnt vmcnt(16) lgkmcnt(3)
    v_mfma_f32_16x16x32_bf16 v[32:35], v[20:23], a[160:163], v[32:35]
    ds_read_b128 v[12:15], v4 offset:25600
    s_waitcnt vmcnt(15)
    v_mfma_f32_16x16x32_bf16 v[40:43], v[20:23], a[164:167], v[40:43]
    s_waitcnt vmcnt(14)
    v_mfma_f32_16x16x32_bf16 v[48:51], v[20:23], a[168:171], v[48:51]
    s_waitcnt vmcnt(13)
    v_mfma_f32_16x16x32_bf16 v[56:59], v[20:23], a[172:175], v[56:59]
    s_waitcnt lgkmcnt(3)
    v_mfma_f32_16x16x32_bf16 v[36:39], v[24:27], a[160:163], v[36:39]
    ds_read_b128 v[16:19], v4 offset:26624
    v_mfma_f32_16x16x32_bf16 v[44:47], v[24:27], a[164:167], v[44:47]
    v_mfma_f32_16x16x32_bf16 v[52:55], v[24:27], a[168:171], v[52:55]
    v_mfma_f32_16x16x32_bf16 v[60:63], v[24:27], a[172:175], v[60:63]
    s_waitcnt vmcnt(12) lgkmcnt(3)
    v_mfma_f32_16x16x32_bf16 v[32:35], v[28:31], a[176:179], v[32:35]
    ds_read_b128 v[20:23], v4 offset:27648
    s_waitcnt vmcnt(11)
    v_mfma_f32_16x16x32_bf16 v[40:43], v[28:31], a[180:183], v[40:43]
    s_waitcnt vmcnt(10)
    v_mfma_f32_16x16x32_bf16 v[48:51], v[28:31], a[184:187], v[48:51]
    s_waitcnt vmcnt(9)
    v_mfma_f32_16x16x32_bf16 v[56:59], v[28:31], a[188:191], v[56:59]
    s_waitcnt lgkmcnt(3)
    v_mfma_f32_16x16x32_bf16 v[36:39], v[8:11], a[176:179], v[36:39]
    ds_read_b128 v[24:27], v4 offset:28672
    v_mfma_f32_16x16x32_bf16 v[44:47], v[8:11], a[180:183], v[44:47]
    v_mfma_f32_16x16x32_bf16 v[52:55], v[8:11], a[184:187], v[52:55]
    v_mfma_f32_16x16x32_bf16 v[60:63], v[8:11], a[188:191], v[60:63]
    s_waitcnt vmcnt(8) lgkmcnt(3)
    v_mfma_f32_16x16x32_bf16 v[32:35], v[12:15], a[192:195], v[32:35]
    ds_read_b128 v[28:31], v4 offset:29696
    s_waitcnt vmcnt(7)
    v_mfma_f32_16x16x32_bf16 v[40:43], v[12:15], a[196:199], v[40:43]
    s_waitcnt vmcnt(6)
    v_mfma_f32_16x16x32_bf16 v[48:51], v[12:15], a[200:203], v[48:51]
    s_waitcnt vmcnt(5)
    v_mfma_f32_16x16x32_bf16 v[56:59], v[12:15], a[204:207], v[56:59]
    s_waitcnt lgkmcnt(3)
    v_mfma_f32_16x16x32_bf16 v[36:39], v[16:19], a[192:195], v[36:39]
    ds_read_b128 v[8:11], v4 offset:30720
    v_mfma_f32_16x16x32_bf16 v[44:47], v[16:19], a[196:199], v[44:47]
    v_mfma_f32_16x16x32_bf16 v[52:55], v[16:19], a[200:203], v[52:55]
    v_mfma_f32_16x16x32_bf16 v[60:63], v[16:19], a[204:207], v[60:63]
    s_waitcnt lgkmcnt(3)
    v_mfma_f32_16x16x32_bf16 v[64:67], v[20:23], a[64:67], v[64:67]
    ds_read_b128 v[12:15], v4 offset:31744
    v_mfma_f32_16x16x32_bf16 v[72:75], v[20:23], a[68:71], v[72:75]
    v_mfma_f32_16x16x32_bf16 v[80:83], v[20:23], a[72:75], v[80:83]
    v_mfma_f32_16x16x32_bf16 v[88:91], v[20:23], a[76:79], v[88:91]
    v_cvt_pk_bf16_f32 v32, v32, v33
    v_cvt_pk_bf16_f32 v33, v34, v35
    s_waitcnt lgkmcnt(3)
    v_mfma_f32_16x16x32_bf16 v[68:71], v[24:27], a[64:67], v[68:71]
    ds_read_b128 v[16:19], v4 offset:32768
    v_cvt_pk_bf16_f32 v34, v36, v37
    v_mfma_f32_16x16x32_bf16 v[76:79], v[24:27], a[68:71], v[76:79]
    v_cvt_pk_bf16_f32 v35, v38, v39
    s_add_u32 s70, s69, 0
    v_mfma_f32_16x16x32_bf16 v[84:87], v[24:27], a[72:75], v[84:87]
    buffer_store_dwordx4 v[32:35], v2, s[4:7], s70 offen sc1
    v_cvt_pk_bf16_f32 v40, v40, v41
    v_mfma_f32_16x16x32_bf16 v[92:95], v[24:27], a[76:79], v[92:95]
    v_cvt_pk_bf16_f32 v41, v42, v43
    v_cvt_pk_bf16_f32 v42, v44, v45
    s_waitcnt lgkmcnt(3)
    v_mfma_f32_16x16x32_bf16 v[64:67], v[28:31], a[80:83], v[64:67]
    ds_read_b128 v[20:23], v4 offset:33792
    v_cvt_pk_bf16_f32 v43, v46, v47
    v_mfma_f32_16x16x32_bf16 v[72:75], v[28:31], a[84:87], v[72:75]
    s_add_u32 s70, s69, 18432
    v_mfma_f32_16x16x32_bf16 v[80:83], v[28:31], a[88:91], v[80:83]
    buffer_store_dwordx4 v[40:43], v2, s[4:7], s70 offen sc1
    v_cvt_pk_bf16_f32 v48, v48, v49
    v_mfma_f32_16x16x32_bf16 v[88:91], v[28:31], a[92:95], v[88:91]
    v_cvt_pk_bf16_f32 v49, v50, v51
    v_cvt_pk_bf16_f32 v50, v52, v53
    s_waitcnt lgkmcnt(3)
    v_mfma_f32_16x16x32_bf16 v[68:71], v[8:11], a[80:83], v[68:71]
    ds_read_b128 v[24:27], v4 offset:34816
    v_cvt_pk_bf16_f32 v51, v54, v55
    v_mfma_f32_16x16x32_bf16 v[76:79], v[8:11], a[84:87], v[76:79]
    s_add_u32 s70, s69, 36864
    v_mfma_f32_16x16x32_bf16 v[84:87], v[8:11], a[88:91], v[84:87]
    buffer_store_dwordx4 v[48:51], v2, s[4:7], s70 offen sc1
    v_cvt_pk_bf16_f32 v56, v56, v57
    v_mfma_f32_16x16x32_bf16 v[92:95], v[8:11], a[92:95], v[92:95]
    v_cvt_pk_bf16_f32 v57, v58, v59
    v_cvt_pk_bf16_f32 v58, v60, v61
    s_waitcnt lgkmcnt(3)
    v_mfma_f32_16x16x32_bf16 v[64:67], v[12:15], a[96:99], v[64:67]
    ds_read_b128 v[28:31], v4 offset:35840
    v_cvt_pk_bf16_f32 v59, v62, v63
    v_mfma_f32_16x16x32_bf16 v[72:75], v[12:15], a[100:103], v[72:75]
    s_add_u32 s70, s69, 55296
    v_mfma_f32_16x16x32_bf16 v[80:83], v[12:15], a[104:107], v[80:83]
    buffer_store_dwordx4 v[56:59], v2, s[4:7], s70 offen sc1
    v_mfma_f32_16x16x32_bf16 v[88:91], v[12:15], a[108:111], v[88:91]
    s_waitcnt lgkmcnt(3)
    v_mfma_f32_16x16x32_bf16 v[68:71], v[16:19], a[96:99], v[68:71]
    s_barrier
    v_mfma_f32_16x16x32_bf16 v[76:79], v[16:19], a[100:103], v[76:79]
    v_add_u32 v4, 0xfffe5000, v4
    ds_read_b128 v[8:11], v4 offset:0
    v_mfma_f32_16x16x32_bf16 v[84:87], v[16:19], a[104:107], v[84:87]
    v_mfma_f32_16x16x32_bf16 v[92:95], v[16:19], a[108:111], v[92:95]
    s_waitcnt lgkmcnt(3)
    v_mfma_f32_16x16x32_bf16 v[64:67], v[20:23], a[112:115], v[64:67]
    ds_read_b128 v[12:15], v4 offset:1024
    v_mfma_f32_16x16x32_bf16 v[72:75], v[20:23], a[116:119], v[72:75]
    v_mfma_f32_16x16x32_bf16 v[80:83], v[20:23], a[120:123], v[80:83]
    v_mfma_f32_16x16x32_bf16 v[88:91], v[20:23], a[124:127], v[88:91]
    s_waitcnt lgkmcnt(3)
    v_mfma_f32_16x16x32_bf16 v[68:71], v[24:27], a[112:115], v[68:71]
    ds_read_b128 v[16:19], v4 offset:2048
    v_mfma_f32_16x16x32_bf16 v[76:79], v[24:27], a[116:119], v[76:79]
    v_mfma_f32_16x16x32_bf16 v[84:87], v[24:27], a[120:123], v[84:87]
    v_mfma_f32_16x16x32_bf16 v[92:95], v[24:27], a[124:127], v[92:95]
    s_waitcnt lgkmcnt(3)
    v_mfma_f32_16x16x32_bf16 v[64:67], v[28:31], a[128:131], v[64:67]
    ds_read_b128 v[20:23], v4 offset:3072
    v_mfma_f32_16x16x32_bf16 v[72:75], v[28:31], a[132:135], v[72:75]
    v_mfma_f32_16x16x32_bf16 v[80:83], v[28:31], a[136:139], v[80:83]
    v_mfma_f32_16x16x32_bf16 v[88:91], v[28:31], a[140:143], v[88:91]
    s_waitcnt lgkmcnt(3)
    v_mfma_f32_16x16x32_bf16 v[68:71], v[8:11], a[128:131], v[68:71]
    ds_read_b128 v[24:27], v4 offset:4096
    v_mfma_f32_16x16x32_bf16 v[76:79], v[8:11], a[132:135], v[76:79]
    v_mfma_f32_16x16x32_bf16 v[84:87], v[8:11], a[136:139], v[84:87]
    v_mfma_f32_16x16x32_bf16 v[92:95], v[8:11], a[140:143], v[92:95]
    s_waitcnt lgkmcnt(3)
    v_mfma_f32_16x16x32_bf16 v[64:67], v[12:15], a[144:147], v[64:67]
    ds_read_b128 v[28:31], v4 offset:5120
    v_mfma_f32_16x16x32_bf16 v[72:75], v[12:15], a[148:151], v[72:75]
    v_mfma_f32_16x16x32_bf16 v[80:83], v[12:15], a[152:155], v[80:83]
    v_mfma_f32_16x16x32_bf16 v[88:91], v[12:15], a[156:159], v[88:91]
    s_waitcnt lgkmcnt(3)
    v_mfma_f32_16x16x32_bf16 v[68:71], v[16:19], a[144:147], v[68:71]
    ds_read_b128 v[8:11], v4 offset:6144
    v_mfma_f32_16x16x32_bf16 v[76:79], v[16:19], a[148:151], v[76:79]
    v_mfma_f32_16x16x32_bf16 v[84:87], v[16:19], a[152:155], v[84:87]
    v_mfma_f32_16x16x32_bf16 v[92:95], v[16:19], a[156:159], v[92:95]
    s_waitcnt lgkmcnt(3)
    v_mfma_f32_16x16x32_bf16 v[64:67], v[20:23], a[160:163], v[64:67]
    ds_read_b128 v[12:15], v4 offset:7168
    v_mfma_f32_16x16x32_bf16 v[72:75], v[20:23], a[164:167], v[72:75]
    v_mfma_f32_16x16x32_bf16 v[80:83], v[20:23], a[168:171], v[80:83]
    v_mfma_f32_16x16x32_bf16 v[88:91], v[20:23], a[172:175], v[88:91]
    s_waitcnt lgkmcnt(3)
    v_mfma_f32_16x16x32_bf16 v[68:71], v[24:27], a[160:163], v[68:71]
    ds_read_b128 v[16:19], v4 offset:8192
    v_mfma_f32_16x16x32_bf16 v[76:79], v[24:27], a[164:167], v[76:79]
    v_mfma_f32_16x16x32_bf16 v[84:87], v[24:27], a[168:171], v[84:87]
    v_mfma_f32_16x16x32_bf16 v[92:95], v[24:27], a[172:175], v[92:95]
    s_waitcnt lgkmcnt(3)
    v_mfma_f32_16x16x32_bf16 v[64:67], v[28:31], a[176:179], v[64:67]
    ds_read_b128 v[20:23], v4 offset:9216
    v_mfma_f32_16x16x32_bf16 v[72:75], v[28:31], a[180:183], v[72:75]
    v_mfma_f32_16x16x32_bf16 v[80:83], v[28:31], a[184:187], v[80:83]
    v_mfma_f32_16x16x32_bf16 v[88:91], v[28:31], a[188:191], v[88:91]
    s_waitcnt lgkmcnt(3)
    v_mfma_f32_16x16x32_bf16 v[68:71], v[8:11], a[176:179], v[68:71]
    ds_read_b128 v[24:27], v4 offset:10240
    v_mfma_f32_16x16x32_bf16 v[76:79], v[8:11], a[180:183], v[76:79]
    v_mfma_f32_16x16x32_bf16 v[84:87], v[8:11], a[184:187], v[84:87]
    v_mfma_f32_16x16x32_bf16 v[92:95], v[8:11], a[188:191], v[92:95]
    s_waitcnt lgkmcnt(3)
    v_mfma_f32_16x16x32_bf16 v[64:67], v[12:15], a[192:195], v[64:67]
    ds_read_b128 v[28:31], v4 offset:11264
    v_mfma_f32_16x16x32_bf16 v[72:75], v[12:15], a[196:199], v[72:75]
    v_mfma_f32_16x16x32_bf16 v[80:83], v[12:15], a[200:203], v[80:83]
    v_mfma_f32_16x16x32_bf16 v[88:91], v[12:15], a[204:207], v[88:91]
    s_waitcnt lgkmcnt(3)
    v_mfma_f32_16x16x32_bf16 v[68:71], v[16:19], a[192:195], v[68:71]
    ds_read_b128 v[8:11], v4 offset:12288
    v_mfma_f32_16x16x32_bf16 v[76:79], v[16:19], a[196:199], v[76:79]
    v_mfma_f32_16x16x32_bf16 v[84:87], v[16:19], a[200:203], v[84:87]
    v_mfma_f32_16x16x32_bf16 v[92:95], v[16:19], a[204:207], v[92:95]
    s_waitcnt lgkmcnt(3)
    v_mfma_f32_16x16x32_bf16 v[96:99], v[20:23], a[64:67], v[96:99]
    ds_read_b128 v[12:15], v4 offset:13312
    v_mfma_f32_16x16x32_bf16 v[104:107], v[20:23], a[68:71], v[104:107]
    v_mfma_f32_16x16x32_bf16 v[112:115], v[20:23], a[72:75], v[112:115]
    v_mfma_f32_16x16x32_bf16 v[120:123], v[20:23], a[76:79], v[120:123]
    v_cvt_pk_bf16_f32 v64, v64, v65
    v_cvt_pk_bf16_f32 v65, v66, v67
    s_waitcnt lgkmcnt(3)
    v_mfma_f32_16x16x32_bf16 v[100:103], v[24:27], a[64:67], v[100:103]
    ds_read_b128 v[16:19], v4 offset:14336
    v_cvt_pk_bf16_f32 v66, v68, v69
    v_mfma_f32_16x16x32_bf16 v[108:111], v[24:27], a[68:71], v[108:111]
    v_cvt_pk_bf16_f32 v67, v70, v71
    s_add_u32 s70, s69, 1024
    v_mfma_f32_16x16x32_bf16 v[116:119], v[24:27], a[72:75], v[116:119]
    buffer_store_dwordx4 v[64:67], v2, s[4:7], s70 offen sc1
    v_cvt_pk_bf16_f32 v72, v72, v73
    v_mfma_f32_16x16x32_bf16 v[124:127], v[24:27], a[76:79], v[124:127]
    v_cvt_pk_bf16_f32 v73, v74, v75
    v_cvt_pk_bf16_f32 v74, v76, v77
    s_waitcnt lgkmcnt(3)
    v_mfma_f32_16x16x32_bf16 v[96:99], v[28:31], a[80:83], v[96:99]
    ds_read_b128 v[20:23], v4 offset:15360
    v_cvt_pk_bf16_f32 v75, v78, v79
    v_mfma_f32_16x16x32_bf16 v[104:107], v[28:31], a[84:87], v[104:107]
    s_add_u32 s70, s69, 19456
    v_mfma_f32_16x16x32_bf16 v[112:115], v[28:31], a[88:91], v[112:115]
    buffer_store_dwordx4 v[72:75], v2, s[4:7], s70 offen sc1
    v_cvt_pk_bf16_f32 v80, v80, v81
    v_mfma_f32_16x16x32_bf16 v[120:123], v[28:31], a[92:95], v[120:123]
    v_cvt_pk_bf16_f32 v81, v82, v83
    v_cvt_pk_bf16_f32 v82, v84, v85
    s_waitcnt lgkmcnt(3)
    v_mfma_f32_16x16x32_bf16 v[100:103], v[8:11], a[80:83], v[100:103]
    ds_read_b128 v[24:27], v4 offset:16384
    v_cvt_pk_bf16_f32 v83, v86, v87
    v_mfma_f32_16x16x32_bf16 v[108:111], v[8:11], a[84:87], v[108:111]
    s_add_u32 s70, s69, 37888
    v_mfma_f32_16x16x32_bf16 v[116:119], v[8:11], a[88:91], v[116:119]
    buffer_store_dwordx4 v[80:83], v2, s[4:7], s70 offen sc1
    v_cvt_pk_bf16_f32 v88, v88, v89
    v_mfma_f32_16x16x32_bf16 v[124:127], v[8:11], a[92:95], v[124:127]
    v_cvt_pk_bf16_f32 v89, v90, v91
    v_cvt_pk_bf16_f32 v90, v92, v93
    s_waitcnt lgkmcnt(3)
    v_mfma_f32_16x16x32_bf16 v[96:99], v[12:15], a[96:99], v[96:99]
    ds_read_b128 v[28:31], v4 offset:17408
    v_cvt_pk_bf16_f32 v91, v94, v95
    v_mfma_f32_16x16x32_bf16 v[104:107], v[12:15], a[100:103], v[104:107]
    s_add_u32 s70, s69, 56320
    v_mfma_f32_16x16x32_bf16 v[112:115], v[12:15], a[104:107], v[112:115]
    buffer_store_dwordx4 v[88:91], v2, s[4:7], s70 offen sc1
    v_mfma_f32_16x16x32_bf16 v[120:123], v[12:15], a[108:111], v[120:123]
    s_waitcnt lgkmcnt(3)
    v_mfma_f32_16x16x32_bf16 v[100:103], v[16:19], a[96:99], v[100:103]
    ds_read_b128 v[8:11], v4 offset:18432
    v_mfma_f32_16x16x32_bf16 v[108:111], v[16:19], a[100:103], v[108:111]
    v_mfma_f32_16x16x32_bf16 v[116:119], v[16:19], a[104:107], v[116:119]
    v_mfma_f32_16x16x32_bf16 v[124:127], v[16:19], a[108:111], v[124:127]
    s_waitcnt lgkmcnt(3)
    v_mfma_f32_16x16x32_bf16 v[96:99], v[20:23], a[112:115], v[96:99]
    ds_read_b128 v[12:15], v4 offset:19456
    v_mfma_f32_16x16x32_bf16 v[104:107], v[20:23], a[116:119], v[104:107]
    v_mfma_f32_16x16x32_bf16 v[112:115], v[20:23], a[120:123], v[112:115]
    v_mfma_f32_16x16x32_bf16 v[120:123], v[20:23], a[124:127], v[120:123]
    s_waitcnt lgkmcnt(3)
    v_mfma_f32_16x16x32_bf16 v[100:103], v[24:27], a[112:115], v[100:103]
    ds_read_b128 v[16:19], v4 offset:20480
    v_mfma_f32_16x16x32_bf16 v[108:111], v[24:27], a[116:119], v[108:111]
    v_mfma_f32_16x16x32_bf16 v[116:119], v[24:27], a[120:123], v[116:119]
    v_mfma_f32_16x16x32_bf16 v[124:127], v[24:27], a[124:127], v[124:127]
    s_waitcnt lgkmcnt(3)
    v_mfma_f32_16x16x32_bf16 v[96:99], v[28:31], a[128:131], v[96:99]
    ds_read_b128 v[20:23], v4 offset:21504
    v_mfma_f32_16x16x32_bf16 v[104:107], v[28:31], a[132:135], v[104:107]
    v_mfma_f32_16x16x32_bf16 v[112:115], v[28:31], a[136:139], v[112:115]
    v_mfma_f32_16x16x32_bf16 v[120:123], v[28:31], a[140:143], v[120:123]
    s_waitcnt lgkmcnt(3)
    v_mfma_f32_16x16x32_bf16 v[100:103], v[8:11], a[128:131], v[100:103]
    ds_read_b128 v[24:27], v4 offset:22528
    v_mfma_f32_16x16x32_bf16 v[108:111], v[8:11], a[132:135], v[108:111]
    v_mfma_f32_16x16x32_bf16 v[116:119], v[8:11], a[136:139], v[116:119]
    v_mfma_f32_16x16x32_bf16 v[124:127], v[8:11], a[140:143], v[124:127]
    s_waitcnt lgkmcnt(3)
    v_mfma_f32_16x16x32_bf16 v[96:99], v[12:15], a[144:147], v[96:99]
    ds_read_b128 v[28:31], v4 offset:23552
    v_mfma_f32_16x16x32_bf16 v[104:107], v[12:15], a[148:151], v[104:107]
    v_mfma_f32_16x16x32_bf16 v[112:115], v[12:15], a[152:155], v[112:115]
    v_mfma_f32_16x16x32_bf16 v[120:123], v[12:15], a[156:159], v[120:123]
    s_waitcnt lgkmcnt(3)
    v_mfma_f32_16x16x32_bf16 v[100:103], v[16:19], a[144:147], v[100:103]
    ds_read_b128 v[8:11], v4 offset:24576
    v_mfma_f32_16x16x32_bf16 v[108:111], v[16:19], a[148:151], v[108:111]
    v_mfma_f32_16x16x32_bf16 v[116:119], v[16:19], a[152:155], v[116:119]
    v_mfma_f32_16x16x32_bf16 v[124:127], v[16:19], a[156:159], v[124:127]
    s_waitcnt lgkmcnt(3)
    v_mfma_f32_16x16x32_bf16 v[96:99], v[20:23], a[160:163], v[96:99]
    ds_read_b128 v[12:15], v4 offset:25600
    v_mfma_f32_16x16x32_bf16 v[104:107], v[20:23], a[164:167], v[104:107]
    v_mfma_f32_16x16x32_bf16 v[112:115], v[20:23], a[168:171], v[112:115]
    v_mfma_f32_16x16x32_bf16 v[120:123], v[20:23], a[172:175], v[120:123]
    s_waitcnt lgkmcnt(3)
    v_mfma_f32_16x16x32_bf16 v[100:103], v[24:27], a[160:163], v[100:103]
    ds_read_b128 v[16:19], v4 offset:26624
    v_mfma_f32_16x16x32_bf16 v[108:111], v[24:27], a[164:167], v[108:111]
    v_mfma_f32_16x16x32_bf16 v[116:119], v[24:27], a[168:171], v[116:119]
    v_mfma_f32_16x16x32_bf16 v[124:127], v[24:27], a[172:175], v[124:127]
    s_waitcnt lgkmcnt(3)
    v_mfma_f32_16x16x32_bf16 v[96:99], v[28:31], a[176:179], v[96:99]
    ds_read_b128 v[20:23], v4 offset:27648
    v_mfma_f32_16x16x32_bf16 v[104:107], v[28:31], a[180:183], v[104:107]
    v_mfma_f32_16x16x32_bf16 v[112:115], v[28:31], a[184:187], v[112:115]
    v_mfma_f32_16x16x32_bf16 v[120:123], v[28:31], a[188:191], v[120:123]
    s_waitcnt lgkmcnt(3)
    v_mfma_f32_16x16x32_bf16 v[100:103], v[8:11], a[176:179], v[100:103]
    ds_read_b128 v[24:27], v4 offset:28672
    v_mfma_f32_16x16x32_bf16 v[108:111], v[8:11], a[180:183], v[108:111]
    v_mfma_f32_16x16x32_bf16 v[116:119], v[8:11], a[184:187], v[116:119]
    v_mfma_f32_16x16x32_bf16 v[124:127], v[8:11], a[188:191], v[124:127]
    s_waitcnt lgkmcnt(3)
    v_mfma_f32_16x16x32_bf16 v[96:99], v[12:15], a[192:195], v[96:99]
    ds_read_b128 v[28:31], v4 offset:29696
    v_mfma_f32_16x16x32_bf16 v[104:107], v[12:15], a[196:199], v[104:107]
    v_mfma_f32_16x16x32_bf16 v[112:115], v[12:15], a[200:203], v[112:115]
    v_mfma_f32_16x16x32_bf16 v[120:123], v[12:15], a[204:207], v[120:123]
    s_waitcnt lgkmcnt(3)
    v_mfma_f32_16x16x32_bf16 v[100:103], v[16:19], a[192:195], v[100:103]
    ds_read_b128 v[8:11], v4 offset:30720
    v_mfma_f32_16x16x32_bf16 v[108:111], v[16:19], a[196:199], v[108:111]
    v_mfma_f32_16x16x32_bf16 v[116:119], v[16:19], a[200:203], v[116:119]
    v_mfma_f32_16x16x32_bf16 v[124:127], v[16:19], a[204:207], v[124:127]
    s_waitcnt lgkmcnt(3)
    v_mfma_f32_16x16x32_bf16 v[128:131], v[20:23], a[64:67], v[128:131]
    ds_read_b128 v[12:15], v4 offset:31744
    v_mfma_f32_16x16x32_bf16 v[136:139], v[20:23], a[68:71], v[136:139]
    v_mfma_f32_16x16x32_bf16 v[144:147], v[20:23], a[72:75], v[144:147]
    v_mfma_f32_16x16x32_bf16 v[152:155], v[20:23], a[76:79], v[152:155]
    v_cvt_pk_bf16_f32 v96, v96, v97
    v_cvt_pk_bf16_f32 v97, v98, v99
    s_waitcnt lgkmcnt(3)
    v_mfma_f32_16x16x32_bf16 v[132:135], v[24:27], a[64:67], v[132:135]
    ds_read_b128 v[16:19], v4 offset:32768
    v_cvt_pk_bf16_f32 v98, v100, v101
    v_mfma_f32_16x16x32_bf16 v[140:143], v[24:27], a[68:71], v[140:143]
    v_cvt_pk_bf16_f32 v99, v102, v103
    s_add_u32 s70, s69, 2048
    v_mfma_f32_16x16x32_bf16 v[148:151], v[24:27], a[72:75], v[148:151]
    buffer_store_dwordx4 v[96:99], v2, s[4:7], s70 offen sc1
    v_cvt_pk_bf16_f32 v104, v104, v105
    v_mfma_f32_16x16x32_bf16 v[156:159], v[24:27], a[76:79], v[156:159]
    v_cvt_pk_bf16_f32 v105, v106, v107
    v_cvt_pk_bf16_f32 v106, v108, v109
    s_waitcnt lgkmcnt(3)
    v_mfma_f32_16x16x32_bf16 v[128:131], v[28:31], a[80:83], v[128:131]
    ds_read_b128 v[20:23], v4 offset:33792
    v_cvt_pk_bf16_f32 v107, v110, v111
    v_mfma_f32_16x16x32_bf16 v[136:139], v[28:31], a[84:87], v[136:139]
    s_add_u32 s70, s69, 20480
    v_mfma_f32_16x16x32_bf16 v[144:147], v[28:31], a[88:91], v[144:147]
    buffer_store_dwordx4 v[104:107], v2, s[4:7], s70 offen sc1
    v_cvt_pk_bf16_f32 v112, v112, v113
    v_mfma_f32_16x16x32_bf16 v[152:155], v[28:31], a[92:95], v[152:155]
    v_cvt_pk_bf16_f32 v113, v114, v115
    v_cvt_pk_bf16_f32 v114, v116, v117
    s_waitcnt lgkmcnt(3)
    v_mfma_f32_16x16x32_bf16 v[132:135], v[8:11], a[80:83], v[132:135]
    ds_read_b128 v[24:27], v4 offset:34816
    v_cvt_pk_bf16_f32 v115, v118, v119
    v_mfma_f32_16x16x32_bf16 v[140:143], v[8:11], a[84:87], v[140:143]
    s_add_u32 s70, s69, 38912
    v_mfma_f32_16x16x32_bf16 v[148:151], v[8:11], a[88:91], v[148:151]
    buffer_store_dwordx4 v[112:115], v2, s[4:7], s70 offen sc1
    v_cvt_pk_bf16_f32 v120, v120, v121
    v_mfma_f32_16x16x32_bf16 v[156:159], v[8:11], a[92:95], v[156:159]
    v_cvt_pk_bf16_f32 v121, v122, v123
    v_cvt_pk_bf16_f32 v122, v124, v125
    s_waitcnt lgkmcnt(3)
    v_mfma_f32_16x16x32_bf16 v[128:131], v[12:15], a[96:99], v[128:131]
    ds_read_b128 v[28:31], v4 offset:35840
    v_cvt_pk_bf16_f32 v123, v126, v127
    v_mfma_f32_16x16x32_bf16 v[136:139], v[12:15], a[100:103], v[136:139]
    s_add_u32 s70, s69, 57344
    v_mfma_f32_16x16x32_bf16 v[144:147], v[12:15], a[104:107], v[144:147]
    buffer_store_dwordx4 v[120:123], v2, s[4:7], s70 offen sc1
    v_mfma_f32_16x16x32_bf16 v[152:155], v[12:15], a[108:111], v[152:155]
    s_waitcnt lgkmcnt(3)
    v_mfma_f32_16x16x32_bf16 v[132:135], v[16:19], a[96:99], v[132:135]
    s_waitcnt vmcnt(12)
    s_barrier
    v_mfma_f32_16x16x32_bf16 v[140:143], v[16:19], a[100:103], v[140:143]
    v_add_u32 v4, 0x9000, v4
    ds_read_b128 v[8:11], v4 offset:0
    v_mfma_f32_16x16x32_bf16 v[148:151], v[16:19], a[104:107], v[148:151]
    v_mfma_f32_16x16x32_bf16 v[156:159], v[16:19], a[108:111], v[156:159]
    s_waitcnt lgkmcnt(3)
    v_mfma_f32_16x16x32_bf16 v[128:131], v[20:23], a[112:115], v[128:131]
    ds_read_b128 v[12:15], v4 offset:1024
    v_mfma_f32_16x16x32_bf16 v[136:139], v[20:23], a[116:119], v[136:139]
    v_mfma_f32_16x16x32_bf16 v[144:147], v[20:23], a[120:123], v[144:147]
    v_mfma_f32_16x16x32_bf16 v[152:155], v[20:23], a[124:127], v[152:155]
    s_waitcnt lgkmcnt(3)
    v_mfma_f32_16x16x32_bf16 v[132:135], v[24:27], a[112:115], v[132:135]
    ds_read_b128 v[16:19], v4 offset:2048
    v_mfma_f32_16x16x32_bf16 v[140:143], v[24:27], a[116:119], v[140:143]
    v_mfma_f32_16x16x32_bf16 v[148:151], v[24:27], a[120:123], v[148:151]
    v_mfma_f32_16x16x32_bf16 v[156:159], v[24:27], a[124:127], v[156:159]
    s_waitcnt lgkmcnt(3)
    v_mfma_f32_16x16x32_bf16 v[128:131], v[28:31], a[128:131], v[128:131]
    ds_read_b128 v[20:23], v4 offset:3072
    v_mfma_f32_16x16x32_bf16 v[136:139], v[28:31], a[132:135], v[136:139]
    v_mfma_f32_16x16x32_bf16 v[144:147], v[28:31], a[136:139], v[144:147]
    v_mfma_f32_16x16x32_bf16 v[152:155], v[28:31], a[140:143], v[152:155]
    s_waitcnt lgkmcnt(3)
    v_mfma_f32_16x16x32_bf16 v[132:135], v[8:11], a[128:131], v[132:135]
    ds_read_b128 v[24:27], v4 offset:4096
    v_mfma_f32_16x16x32_bf16 v[140:143], v[8:11], a[132:135], v[140:143]
    v_mfma_f32_16x16x32_bf16 v[148:151], v[8:11], a[136:139], v[148:151]
    v_mfma_f32_16x16x32_bf16 v[156:159], v[8:11], a[140:143], v[156:159]
    s_waitcnt lgkmcnt(3)
    v_mfma_f32_16x16x32_bf16 v[128:131], v[12:15], a[144:147], v[128:131]
    ds_read_b128 v[28:31], v4 offset:5120
    v_mfma_f32_16x16x32_bf16 v[136:139], v[12:15], a[148:151], v[136:139]
    v_mfma_f32_16x16x32_bf16 v[144:147], v[12:15], a[152:155], v[144:147]
    v_mfma_f32_16x16x32_bf16 v[152:155], v[12:15], a[156:159], v[152:155]
    s_waitcnt lgkmcnt(3)
    v_mfma_f32_16x16x32_bf16 v[132:135], v[16:19], a[144:147], v[132:135]
    ds_read_b128 v[8:11], v4 offset:6144
    v_mfma_f32_16x16x32_bf16 v[140:143], v[16:19], a[148:151], v[140:143]
    v_mfma_f32_16x16x32_bf16 v[148:151], v[16:19], a[152:155], v[148:151]
    v_mfma_f32_16x16x32_bf16 v[156:159], v[16:19], a[156:159], v[156:159]
    s_waitcnt lgkmcnt(3)
    v_mfma_f32_16x16x32_bf16 v[128:131], v[20:23], a[160:163], v[128:131]
    ds_read_b128 v[12:15], v4 offset:7168
    v_mfma_f32_16x16x32_bf16 v[136:139], v[20:23], a[164:167], v[136:139]
    v_mfma_f32_16x16x32_bf16 v[144:147], v[20:23], a[168:171], v[144:147]
    v_mfma_f32_16x16x32_bf16 v[152:155], v[20:23], a[172:175], v[152:155]
    s_waitcnt lgkmcnt(3)
    v_mfma_f32_16x16x32_bf16 v[132:135], v[24:27], a[160:163], v[132:135]
    ds_read_b128 v[16:19], v4 offset:8192
    v_mfma_f32_16x16x32_bf16 v[140:143], v[24:27], a[164:167], v[140:143]
    v_mfma_f32_16x16x32_bf16 v[148:151], v[24:27], a[168:171], v[148:151]
    v_mfma_f32_16x16x32_bf16 v[156:159], v[24:27], a[172:175], v[156:159]
    s_waitcnt lgkmcnt(3)
    v_mfma_f32_16x16x32_bf16 v[128:131], v[28:31], a[176:179], v[128:131]
    ds_read_b128 v[20:23], v4 offset:9216
    v_mfma_f32_16x16x32_bf16 v[136:139], v[28:31], a[180:183], v[136:139]
    v_mfma_f32_16x16x32_bf16 v[144:147], v[28:31], a[184:187], v[144:147]
    v_mfma_f32_16x16x32_bf16 v[152:155], v[28:31], a[188:191], v[152:155]
    s_waitcnt lgkmcnt(3)
    v_mfma_f32_16x16x32_bf16 v[132:135], v[8:11], a[176:179], v[132:135]
    ds_read_b128 v[24:27], v4 offset:10240
    v_mfma_f32_16x16x32_bf16 v[140:143], v[8:11], a[180:183], v[140:143]
    v_mfma_f32_16x16x32_bf16 v[148:151], v[8:11], a[184:187], v[148:151]
    v_mfma_f32_16x16x32_bf16 v[156:159], v[8:11], a[188:191], v[156:159]
    s_waitcnt lgkmcnt(3)
    v_mfma_f32_16x16x32_bf16 v[128:131], v[12:15], a[192:195], v[128:131]
    ds_read_b128 v[28:31], v4 offset:11264
    v_mfma_f32_16x16x32_bf16 v[136:139], v[12:15], a[196:199], v[136:139]
    v_mfma_f32_16x16x32_bf16 v[144:147], v[12:15], a[200:203], v[144:147]
    v_mfma_f32_16x16x32_bf16 v[152:155], v[12:15], a[204:207], v[152:155]
    s_waitcnt lgkmcnt(3)
    v_mfma_f32_16x16x32_bf16 v[132:135], v[16:19], a[192:195], v[132:135]
    ds_read_b128 v[8:11], v4 offset:12288
    v_mfma_f32_16x16x32_bf16 v[140:143], v[16:19], a[196:199], v[140:143]
    v_mfma_f32_16x16x32_bf16 v[148:151], v[16:19], a[200:203], v[148:151]
    v_mfma_f32_16x16x32_bf16 v[156:159], v[16:19], a[204:207], v[156:159]
    s_waitcnt lgkmcnt(3)
    v_mfma_f32_16x16x32_bf16 v[160:163], v[20:23], a[64:67], v[160:163]
    ds_read_b128 v[12:15], v4 offset:13312
    v_mfma_f32_16x16x32_bf16 v[164:167], v[20:23], a[68:71], v[164:167]
    v_mfma_f32_16x16x32_bf16 v[168:171], v[20:23], a[72:75], v[168:171]
    v_mfma_f32_16x16x32_bf16 v[172:175], v[20:23], a[76:79], v[172:175]
    v_cvt_pk_bf16_f32 v128, v128, v129
    v_cvt_pk_bf16_f32 v129, v130, v131
    s_waitcnt lgkmcnt(3)
    v_mfma_f32_16x16x32_bf16 v[160:163], v[24:27], a[80:83], v[160:163]
    ds_read_b128 v[16:19], v4 offset:14336
    v_cvt_pk_bf16_f32 v130, v132, v133
    v_mfma_f32_16x16x32_bf16 v[164:167], v[24:27], a[84:87], v[164:167]
    v_cvt_pk_bf16_f32 v131, v134, v135
    s_add_u32 s70, s69, 3072
    v_mfma_f32_16x16x32_bf16 v[168:171], v[24:27], a[88:91], v[168:171]
    buffer_store_dwordx4 v[128:131], v2, s[4:7], s70 offen sc1
    v_cvt_pk_bf16_f32 v136, v136, v137
    v_mfma_f32_16x16x32_bf16 v[172:175], v[24:27], a[92:95], v[172:175]
    v_cvt_pk_bf16_f32 v137, v138, v139
    v_cvt_pk_bf16_f32 v138, v140, v141
    s_waitcnt lgkmcnt(3)
    v_mfma_f32_16x16x32_bf16 v[160:163], v[28:31], a[96:99], v[160:163]
    ds_read_b128 v[20:23], v4 offset:15360
    v_cvt_pk_bf16_f32 v139, v142, v143
    v_mfma_f32_16x16x32_bf16 v[164:167], v[28:31], a[100:103], v[164:167]
    s_add_u32 s70, s69, 21504
    v_mfma_f32_16x16x32_bf16 v[168:171], v[28:31], a[104:107], v[168:171]
    buffer_store_dwordx4 v[136:139], v2, s[4:7], s70 offen sc1
    v_cvt_pk_bf16_f32 v144, v144, v145
    v_mfma_f32_16x16x32_bf16 v[172:175], v[28:31], a[108:111], v[172:175]
    v_cvt_pk_bf16_f32 v145, v146, v147
    v_cvt_pk_bf16_f32 v146, v148, v149
    s_waitcnt lgkmcnt(3)
    v_mfma_f32_16x16x32_bf16 v[160:163], v[8:11], a[112:115], v[160:163]
    ds_read_b128 v[24:27], v4 offset:16384
    v_cvt_pk_bf16_f32 v147, v150, v151
    v_mfma_f32_16x16x32_bf16 v[164:167], v[8:11], a[116:119], v[164:167]
    s_add_u32 s70, s69, 39936
    v_mfma_f32_16x16x32_bf16 v[168:171], v[8:11], a[120:123], v[168:171]
    buffer_store_dwordx4 v[144:147], v2, s[4:7], s70 offen sc1
    v_cvt_pk_bf16_f32 v152, v152, v153
    v_mfma_f32_16x16x32_bf16 v[172:175], v[8:11], a[124:127], v[172:175]
    v_cvt_pk_bf16_f32 v153, v154, v155
    v_cvt_pk_bf16_f32 v154, v156, v157
    s_waitcnt lgkmcnt(3)
    v_mfma_f32_16x16x32_bf16 v[160:163], v[12:15], a[128:131], v[160:163]
    ds_read_b128 v[28:31], v4 offset:17408
    v_cvt_pk_bf16_f32 v155, v158, v159
    v_mfma_f32_16x16x32_bf16 v[164:167], v[12:15], a[132:135], v[164:167]
    s_add_u32 s70, s69, 58368
    v_mfma_f32_16x16x32_bf16 v[168:171], v[12:15], a[136:139], v[168:171]
    buffer_store_dwordx4 v[152:155], v2, s[4:7], s70 offen sc1
    v_mfma_f32_16x16x32_bf16 v[172:175], v[12:15], a[140:143], v[172:175]
    s_waitcnt lgkmcnt(3)
    v_mfma_f32_16x16x32_bf16 v[160:163], v[16:19], a[144:147], v[160:163]
    v_mfma_f32_16x16x32_bf16 v[164:167], v[16:19], a[148:151], v[164:167]
    v_mfma_f32_16x16x32_bf16 v[168:171], v[16:19], a[152:155], v[168:171]
    v_mfma_f32_16x16x32_bf16 v[172:175], v[16:19], a[156:159], v[172:175]
    s_waitcnt lgkmcnt(2)
    v_mfma_f32_16x16x32_bf16 v[160:163], v[20:23], a[160:163], v[160:163]
    v_mfma_f32_16x16x32_bf16 v[164:167], v[20:23], a[164:167], v[164:167]
    v_mfma_f32_16x16x32_bf16 v[168:171], v[20:23], a[168:171], v[168:171]
    v_mfma_f32_16x16x32_bf16 v[172:175], v[20:23], a[172:175], v[172:175]
    s_waitcnt lgkmcnt(1)
    v_mfma_f32_16x16x32_bf16 v[160:163], v[24:27], a[176:179], v[160:163]
    v_mfma_f32_16x16x32_bf16 v[164:167], v[24:27], a[180:183], v[164:167]
    v_mfma_f32_16x16x32_bf16 v[168:171], v[24:27], a[184:187], v[168:171]
    v_mfma_f32_16x16x32_bf16 v[172:175], v[24:27], a[188:191], v[172:175]
    s_waitcnt lgkmcnt(0)
    v_mfma_f32_16x16x32_bf16 v[160:163], v[28:31], a[192:195], v[160:163]
    v_mfma_f32_16x16x32_bf16 v[164:167], v[28:31], a[196:199], v[164:167]
    v_mfma_f32_16x16x32_bf16 v[168:171], v[28:31], a[200:203], v[168:171]
    v_mfma_f32_16x16x32_bf16 v[172:175], v[28:31], a[204:207], v[172:175]
    s_nop 4
    v_cvt_pk_bf16_f32 v160, v160, v161
    v_cvt_pk_bf16_f32 v161, v162, v163
    s_add_u32 s70, s68, 4096
    buffer_store_dwordx2 v[160:161], v0, s[4:7], s70 offen sc1
    v_cvt_pk_bf16_f32 v164, v164, v165
    v_cvt_pk_bf16_f32 v165, v166, v167
    s_add_u32 s70, s68, 22528
    buffer_store_dwordx2 v[164:165], v0, s[4:7], s70 offen sc1
    v_cvt_pk_bf16_f32 v168, v168, v169
    v_cvt_pk_bf16_f32 v169, v170, v171
    s_add_u32 s70, s68, 40960
    buffer_store_dwordx2 v[168:169], v0, s[4:7], s70 offen sc1
    v_cvt_pk_bf16_f32 v172, v172, v173
    v_cvt_pk_bf16_f32 v173, v174, v175
    s_add_u32 s70, s68, 59392
    buffer_store_dwordx2 v[172:173], v0, s[4:7], s70 offen sc1
    s_waitcnt vmcnt(0) lgkmcnt(0)
ffn1_kernel_end:
    s_endpgm
L_p0_slow_46:
    s_mov_b32 s64, 0x40000
L_spin_52:
    buffer_load_dword v168, v7, s[4:7], s52 offen sc1
    s_waitcnt vmcnt(0)
    v_cmp_le_u32 vcc, 1, v168
    s_sub_u32 s64, s64, 1
    s_cbranch_scc1 L_p0_back_47
    s_cmp_eq_u64 vcc, exec
    s_cbranch_scc1 L_p0_back_47
    s_branch L_spin_52
L_p1_slow_48:
    s_mov_b32 s64, 0x40000
L_spin_53:
    buffer_load_dword v5, v7, s[4:7], s52 offen sc1
    s_waitcnt vmcnt(0)
    v_cmp_le_u32 vcc, 2, v5
    s_sub_u32 s64, s64, 1
    s_cbranch_scc1 L_p1_back_49
    s_cmp_eq_u64 vcc, exec
    s_cbranch_scc1 L_p1_back_49
    s_branch L_spin_53
L_p2_slow_50:
    s_mov_b32 s64, 0x40000
L_spin_54:
    buffer_load_dword v5, v7, s[4:7], s52 offen sc1
    s_waitcnt vmcnt(0)
    v_cmp_le_u32 vcc, 3, v5
    s_sub_u32 s64, s64, 1
    s_cbranch_scc1 L_p2_back_51
    s_cmp_eq_u64 vcc, exec
    s_cbranch_scc1 L_p2_back_51
    s_branch L_spin_54
.section .rodata,"a"
.p2align 6
.amdhsa_kernel ffn1_kernel
  .amdhsa_next_free_vgpr 512
  .amdhsa_next_free_sgpr 102
  .amdhsa_accum_offset 256
  .amdhsa_group_segment_fixed_size 0
  .amdhsa_kernarg_size 80
  .amdhsa_user_sgpr_count 2
  .amdhsa_user_sgpr_kernarg_segment_ptr 1
  .amdhsa_system_sgpr_workgroup_id_x 1
  .amdhsa_float_denorm_mode_32 3
.end_amdhsa_kernel
.text
.globl red1_kernel
.p2align 8
.type red1_kernel,@function
red1_kernel:
    s_cmp_ge_u32 s2, 256
    s_cbranch_scc1 red1_kernel_end
    s_load_dwordx16 s[24:39], s[0:1], 0
    s_load_dwordx4 s[40:43], s[0:1], 64
    v_lshrrev_b32 v1, 6, v0
    s_and_b32 s21, s2, 7
    v_readfirstlane_b32 s20, v1
    s_lshr_b32 s22, s2, 3
    v_and_b32 v1, 63, v0
    v_lshlrev_b32 v2, 4, v1
    v_lshlrev_b32 v3, 7, v0
    s_getpc_b64 s[16:17]
L_pc_55:
    v_min_u32 v4, red1_kernel_end-L_pc_55, v3
    global_load_dword v4, v4, s[16:17]
    s_waitcnt lgkmcnt(0)
    s_mov_b32 s4, s42
    s_mov_b32 s5, s43
    s_mov_b32 s6, 0x10000000
    s_mov_b32 s7, 0x20000
    s_lshl_b32 s47, s21, 5
    s_add_u32 s47, s47, s22
    v_and_b32 v8, 7, v1
    v_lshrrev_b32 v9, 3, v1
    s_lshl_b32 s48, s47, 3
    v_add_u32 v3, s48, v8
    v_mul_u32_u24 v3, 1152, v3
    s_mul_i32 s48, s20, 384
    v_lshl_add_u32 v3, v9, 4, v3
    v_add_u32 v3, s48, v3
    s_lshr_b32 s48, s47, 1
    s_mul_i32 s48, s48, 18432
    s_and_b32 s49, s47, 1
    s_lshl_b32 s49, s49, 7
    s_add_u32 s48, s48, s49
    s_mul_i32 s49, s20, 6144
    s_add_u32 s48, s48, s49
    v_lshlrev_b32 v8, 4, v8
    v_lshl_add_u32 v8, v9, 8, v8
    s_waitcnt vmcnt(0)
    v_add_u32 v4, s48, v8
    v_lshrrev_b32 v8, 3, v1
    v_and_b32 v9, 7, v1
    s_and_b32 s48, s47, 1
    s_lshl_b32 s48, s48, 3
    v_add_u32 v9, s48, v9
    v_lshlrev_b32 v9, 4, v9
    v_bfe_u32 v10, v8, 1, 1
    v_and_b32 v11, 1, v8
    v_lshl_add_u32 v9, v11, 4, v9
    v_lshl_add_u32 v9, v10, 9, v9
    v_and_b32 v10, 3, v8
    v_lshlrev_b32 v10, 8, v10
    v_sub_u32 v9, v9, v10
    s_mul_i32 s48, s20, 6
    v_lshrrev_b32 v8, 2, v8
    v_add_u32 v8, s48, v8
    v_add_u32 v10, 0, v8
    v_cmp_eq_u32 vcc, 4, v10
    v_cmp_eq_u32 s[56:57], 13, v10
    s_nop 0
    s_or_b64 vcc, vcc, s[56:57]
    v_cndmask_b32 v10, 0, v9, vcc
    v_add3_u32 v5, v4, v10, 0
    v_add_u32 v5, 0, v5
    v_add_u32 v10, 2, v8
    v_cmp_eq_u32 vcc, 4, v10
    v_cmp_eq_u32 s[56:57], 13, v10
    s_nop 0
    s_or_b64 vcc, vcc, s[56:57]
    v_cndmask_b32 v10, 0, v9, vcc
    v_add3_u32 v6, v4, v10, 0
    v_add_u32 v6, 2048, v6
    v_add_u32 v10, 4, v8
    v_cmp_eq_u32 vcc, 4, v10
    v_cmp_eq_u32 s[56:57], 13, v10
    s_nop 0
    s_or_b64 vcc, vcc, s[56:57]
    v_cndmask_b32 v10, 0, v9, vcc
    v_add3_u32 v7, v4, v10, 0
    v_add_u32 v7, 4096, v7
    s_cmp_eq_u32 s20, 3
    s_cbranch_scc1 L_w3a_56
    s_mov_b32 s48, 76021760
    buffer_load_dwordx4 v[16:19], v4, s[4:7], s48 offen offset:0
    buffer_load_dwordx4 v[52:55], v4, s[4:7], s48 offen offset:2048
    s_add_u32 s48, s48, 4096
    buffer_load_dwordx4 v[88:91], v4, s[4:7], s48 offen offset:0
    s_mov_b32 s48, 100663296
    buffer_load_dwordx4 v[20:23], v5, s[4:7], s48 offen
    buffer_load_dwordx4 v[56:59], v6, s[4:7], s48 offen
    buffer_load_dwordx4 v[92:95], v7, s[4:7], s48 offen
    s_mov_b32 s48, 103022592
    buffer_load_dwordx4 v[24:27], v5, s[4:7], s48 offen
    buffer_load_dwordx4 v[60:63], v6, s[4:7], s48 offen
    buffer_load_dwordx4 v[96:99], v7, s[4:7], s48 offen
    s_mov_b32 s48, 105381888
    buffer_load_dwordx4 v[28:31], v5, s[4:7], s48 offen
    buffer_load_dwordx4 v[64:67], v6, s[4:7], s48 offen
    buffer_load_dwordx4 v[100:103], v7, s[4:7], s48 offen
    s_mov_b32 s48, 107741184
    buffer_load_dwordx4 v[32:35], v5, s[4:7], s48 offen
    buffer_load_dwordx4 v[68:71], v6, s[4:7], s48 offen
    buffer_load_dwordx4 v[104:107], v7, s[4:7], s48 offen
    s_mov_b32 s48, 110100480
    buffer_load_dwordx4 v[36:39], v5, s[4:7], s48 offen
    buffer_load_dwordx4 v[72:75], v6, s[4:7], s48 offen
    buffer_load_dwordx4 v[108:111], v7, s[4:7], s48 offen
    s_mov_b32 s48, 112459776
    buffer_load_dwordx4 v[40:43], v5, s[4:7], s48 offen
    buffer_load_dwordx4 v[76:79], v6, s[4:7], s48 offen
    buffer_load_dwordx4 v[112:115], v7, s[4:7], s48 offen
    s_mov_b32 s48, 114819072
    buffer_load_dwordx4 v[44:47], v5, s[4:7], s48 offen
    buffer_load_dwordx4 v[80:83], v6, s[4:7], s48 offen
    buffer_load_dwordx4 v[116:119], v7, s[4:7], s48 offen
    s_mov_b32 s48, 117178368
    buffer_load_dwordx4 v[48:51], v5, s[4:7], s48 offen
    buffer_load_dwordx4 v[84:87], v6, s[4:7], s48 offen
    buffer_load_dwordx4 v[120:123], v7, s[4:7], s48 offen
    s_waitcnt vmcnt(26)
    v_lshlrev_b32 v128, 16, v16
    v_and_b32 v129, 0xffff0000, v16
    v_lshlrev_b32 v130, 16, v17
    v_and_b32 v131, 0xffff0000, v17
    v_lshlrev_b32 v132, 16, v18
    v_and_b32 v133, 0xffff0000, v18
    v_lshlrev_b32 v134, 16, v19
    v_and_b32 v135, 0xffff0000, v19
    s_waitcnt vmcnt(25)
    v_lshlrev_b32 v136, 16, v52
    v_and_b32 v137, 0xffff0000, v52
    v_lshlrev_b32 v138, 16, v53
    v_and_b32 v139, 0xffff0000, v53
    v_lshlrev_b32 v140, 16, v54
    v_and_b32 v141, 0xffff0000, v54
    v_lshlrev_b32 v142, 16, v55
    v_and_b32 v143, 0xffff0000, v55
    s_waitcnt vmcnt(24)
    v_lshlrev_b32 v144, 16, v88
    v_and_b32 v145, 0xffff0000, v88
    v_lshlrev_b32 v146, 16, v89
    v_and_b32 v147, 0xffff0000, v89
    v_lshlrev_b32 v148, 16, v90
    v_and_b32 v149, 0xffff0000, v90
    v_lshlrev_b32 v150, 16, v91
    v_and_b32 v151, 0xffff0000, v91
    s_waitcnt vmcnt(23)
    v_lshlrev_b32 v8, 16, v20
    v_and_b32 v9, 0xffff0000, v20
    v_add_f32 v128, v128, v8
    v_add_f32 v129, v129, v9
    v_lshlrev_b32 v10, 16, v21
    v_and_b32 v11, 0xffff0000, v21
    v_add_f32 v130, v130, v10
    v_add_f32 v131, v131, v11
    v_lshlrev_b32 v8, 16, v22
    v_and_b32 v9, 0xffff0000, v22
    v_add_f32 v132, v132, v8
    v_add_f32 v133, v133, v9
    v_lshlrev_b32 v10, 16, v23
    v_and_b32 v11, 0xffff0000, v23
    v_add_f32 v134, v134, v10
    v_add_f32 v135, v135, v11
    s_waitcnt vmcnt(22)
    v_lshlrev_b32 v8, 16, v56
    v_and_b32 v9, 0xffff0000, v56
    v_add_f32 v136, v136, v8
    v_add_f32 v137, v137, v9
    v_lshlrev_b32 v10, 16, v57
    v_and_b32 v11, 0xffff0000, v57
    v_add_f32 v138, v138, v10
    v_add_f32 v139, v139, v11
    v_lshlrev_b32 v8, 16, v58
    v_and_b32 v9, 0xffff0000, v58
    v_add_f32 v140, v140, v8
    v_add_f32 v141, v141, v9
    v_lshlrev_b32 v10, 16, v59
    v_and_b32 v11, 0xffff0000, v59
    v_add_f32 v142, v142, v10
    v_add_f32 v143, v143, v11
    s_waitcnt vmcnt(21)
    v_lshlrev_b32 v8, 16, v92
    v_and_b32 v9, 0xffff0000, v92
    v_add_f32 v144, v144, v8
    v_add_f32 v145, v145, v9
    v_lshlrev_b32 v10, 16, v93
    v_and_b32 v11, 0xffff0000, v93
    v_add_f32 v146, v146, v10
    v_add_f32 v147, v147, v11
    v_lshlrev_b32 v8, 16, v94
    v_and_b32 v9, 0xffff0000, v94
    v_add_f32 v148, v148, v8
    v_add_f32 v149, v149, v9
    v_lshlrev_b32 v10, 16, v95
    v_and_b32 v11, 0xffff0000, v95
    v_add_f32 v150, v150, v10
    v_add_f32 v151, v151, v11
    s_waitcnt vmcnt(20)
    v_lshlrev_b32 v8, 16, v24
    v_and_b32 v9, 0xffff0000, v24
    v_add_f32 v128, v128, v8
    v_add_f32 v129, v129, v9
    v_lshlrev_b32 v10, 16, v25
    v_and_b32 v11, 0xffff0000, v25
    v_add_f32 v130, v130, v10
    v_add_f32 v131, v131, v11
    v_lshlrev_b32 v8, 16, v26
    v_and_b32 v9, 0xffff0000, v26
    v_add_f32 v132, v132, v8
    v_add_f32 v133, v133, v9
    v_lshlrev_b32 v10, 16, v27
    v_and_b32 v11, 0xffff0000, v27
    v_add_f32 v134, v134, v10
    v_add_f32 v135, v135, v11
    s_waitcnt vmcnt(19)
    v_lshlrev_b32 v8, 16, v60
    v_and_b32 v9, 0xffff0000, v60
    v_add_f32 v136, v136, v8
    v_add_f32 v137, v137, v9
    v_lshlrev_b32 v10, 16, v61
    v_and_b32 v11, 0xffff0000, v61
    v_add_f32 v138, v138, v10
    v_add_f32 v139, v139, v11
    v_lshlrev_b32 v8, 16, v62
    v_and_b32 v9, 0xffff0000, v62
    v_add_f32 v140, v140, v8
    v_add_f32 v141, v141, v9
    v_lshlrev_b32 v10, 16, v63
    v_and_b32 v11, 0xffff0000, v63
    v_add_f32 v142, v142, v10
    v_add_f32 v143, v143, v11
    s_waitcnt vmcnt(18)
    v_lshlrev_b32 v8, 16, v96
    v_and_b32 v9, 0xffff0000, v96
    v_add_f32 v144, v144, v8
    v_add_f32 v145, v145, v9
    v_lshlrev_b32 v10, 16, v97
    v_and_b32 v11, 0xffff0000, v97
    v_add_f32 v146, v146, v10
    v_add_f32 v147, v147, v11
    v_lshlrev_b32 v8, 16, v98
    v_and_b32 v9, 0xffff0000, v98
    v_add_f32 v148, v148, v8
    v_add_f32 v149, v149, v9
    v_lshlrev_b32 v10, 16, v99
    v_and_b32 v11, 0xffff0000, v99
    v_add_f32 v150, v150, v10
    v_add_f32 v151, v151, v11
    s_waitcnt vmcnt(17)
    v_lshlrev_b32 v8, 16, v28
    v_and_b32 v9, 0xffff0000, v28
    v_add_f32 v128, v128, v8
    v_add_f32 v129, v129, v9
    v_lshlrev_b32 v10, 16, v29
    v_and_b32 v11, 0xffff0000, v29
    v_add_f32 v130, v130, v10
    v_add_f32 v131, v131, v11
    v_lshlrev_b32 v8, 16, v30
    v_and_b32 v9, 0xffff0000, v30
    v_add_f32 v132, v132, v8
    v_add_f32 v133, v133, v9
    v_lshlrev_b32 v10, 16, v31
    v_and_b32 v11, 0xffff0000, v31
    v_add_f32 v134, v134, v10
    v_add_f32 v135, v135, v11
    s_waitcnt vmcnt(16)
    v_lshlrev_b32 v8, 16, v64
    v_and_b32 v9, 0xffff0000, v64
    v_add_f32 v136, v136, v8
    v_add_f32 v137, v137, v9
    v_lshlrev_b32 v10, 16, v65
    v_and_b32 v11, 0xffff0000, v65
    v_add_f32 v138, v138, v10
    v_add_f32 v139, v139, v11
    v_lshlrev_b32 v8, 16, v66
    v_and_b32 v9, 0xffff0000, v66
    v_add_f32 v140, v140, v8
    v_add_f32 v141, v141, v9
    v_lshlrev_b32 v10, 16, v67
    v_and_b32 v11, 0xffff0000, v67
    v_add_f32 v142, v142, v10
    v_add_f32 v143, v143, v11
    s_waitcnt vmcnt(15)
    v_lshlrev_b32 v8, 16, v100
    v_and_b32 v9, 0xffff0000, v100
    v_add_f32 v144, v144, v8
    v_add_f32 v145, v145, v9
    v_lshlrev_b32 v10, 16, v101
    v_and_b32 v11, 0xffff0000, v101
    v_add_f32 v146, v146, v10
    v_add_f32 v147, v147, v11
    v_lshlrev_b32 v8, 16, v102
    v_and_b32 v9, 0xffff0000, v102
    v_add_f32 v148, v148, v8
    v_add_f32 v149, v149, v9
    v_lshlrev_b32 v10, 16, v103
    v_and_b32 v11, 0xffff0000, v103
    v_add_f32 v150, v150, v10
    v_add_f32 v151, v151, v11
    s_waitcnt vmcnt(14)
    v_lshlrev_b32 v8, 16, v32
    v_and_b32 v9, 0xffff0000, v32
    v_add_f32 v128, v128, v8
    v_add_f32 v129, v129, v9
    v_lshlrev_b32 v10, 16, v33
    v_and_b32 v11, 0xffff0000, v33
    v_add_f32 v130, v130, v10
    v_add_f32 v131, v131, v11
    v_lshlrev_b32 v8, 16, v34
    v_and_b32 v9, 0xffff0000, v34
    v_add_f32 v132, v132, v8
    v_add_f32 v133, v133, v9
    v_lshlrev_b32 v10, 16, v35
    v_and_b32 v11, 0xffff0000, v35
    v_add_f32 v134, v134, v10
    v_add_f32 v135, v135, v11
    s_waitcnt vmcnt(13)
    v_lshlrev_b32 v8, 16, v68
    v_and_b32 v9, 0xffff0000, v68
    v_add_f32 v136, v136, v8
    v_add_f32 v137, v137, v9
    v_lshlrev_b32 v10, 16, v69
    v_and_b32 v11, 0xffff0000, v69
    v_add_f32 v138, v138, v10
    v_add_f32 v139, v139, v11
    v_lshlrev_b32 v8, 16, v70
    v_and_b32 v9, 0xffff0000, v70
    v_add_f32 v140, v140, v8
    v_add_f32 v141, v141, v9
    v_lshlrev_b32 v10, 16, v71
    v_and_b32 v11, 0xffff0000, v71
    v_add_f32 v142, v142, v10
    v_add_f32 v143, v143, v11
    s_waitcnt vmcnt(12)
    v_lshlrev_b32 v8, 16, v104
    v_and_b32 v9, 0xffff0000, v104
    v_add_f32 v144, v144, v8
    v_add_f32 v145, v145, v9
    v_lshlrev_b32 v10, 16, v105
    v_and_b32 v11, 0xffff0000, v105
    v_add_f32 v146, v146, v10
    v_add_f32 v147, v147, v11
    v_lshlrev_b32 v8, 16, v106
    v_and_b32 v9, 0xffff0000, v106
    v_add_f32 v148, v148, v8
    v_add_f32 v149, v149, v9
    v_lshlrev_b32 v10, 16, v107
    v_and_b32 v11, 0xffff0000, v107
    v_add_f32 v150, v150, v10
    v_add_f32 v151, v151, v11
    s_waitcnt vmcnt(11)
    v_lshlrev_b32 v8, 16, v36
    v_and_b32 v9, 0xffff0000, v36
    v_add_f32 v128, v128, v8
    v_add_f32 v129, v129, v9
    v_lshlrev_b32 v10, 16, v37
    v_and_b32 v11, 0xffff0000, v37
    v_add_f32 v130, v130, v10
    v_add_f32 v131, v131, v11
    v_lshlrev_b32 v8, 16, v38
    v_and_b32 v9, 0xffff0000, v38
    v_add_f32 v132, v132, v8
    v_add_f32 v133, v133, v9
    v_lshlrev_b32 v10, 16, v39
    v_and_b32 v11, 0xffff0000, v39
    v_add_f32 v134, v134, v10
    v_add_f32 v135, v135, v11
    s_waitcnt vmcnt(10)
    v_lshlrev_b32 v8, 16, v72
    v_and_b32 v9, 0xffff0000, v72
    v_add_f32 v136, v136, v8
    v_add_f32 v137, v137, v9
    v_lshlrev_b32 v10, 16, v73
    v_and_b32 v11, 0xffff0000, v73
    v_add_f32 v138, v138, v10
    v_add_f32 v139, v139, v11
    v_lshlrev_b32 v8, 16, v74
    v_and_b32 v9, 0xffff0000, v74
    v_add_f32 v140, v140, v8
    v_add_f32 v141, v141, v9
    v_lshlrev_b32 v10, 16, v75
    v_and_b32 v11, 0xffff0000, v75
    v_add_f32 v142, v142, v10
    v_add_f32 v143, v143, v11
    s_waitcnt vmcnt(9)
    v_lshlrev_b32 v8, 16, v108
    v_and_b32 v9, 0xffff0000, v108
    v_add_f32 v144, v144, v8
    v_add_f32 v145, v145, v9
    v_lshlrev_b32 v10, 16, v109
    v_and_b32 v11, 0xffff0000, v109
    v_add_f32 v146, v146, v10
    v_add_f32 v147, v147, v11
    v_lshlrev_b32 v8, 16, v110
    v_and_b32 v9, 0xffff0000, v110
    v_add_f32 v148, v148, v8
    v_add_f32 v149, v149, v9
    v_lshlrev_b32 v10, 16, v111
    v_and_b32 v11, 0xffff0000, v111
    v_add_f32 v150, v150, v10
    v_add_f32 v151, v151, v11
    s_waitcnt vmcnt(8)
    v_lshlrev_b32 v8, 16, v40
    v_and_b32 v9, 0xffff0000, v40
    v_add_f32 v128, v128, v8
    v_add_f32 v129, v129, v9
    v_lshlrev_b32 v10, 16, v41
    v_and_b32 v11, 0xffff0000, v41
    v_add_f32 v130, v130, v10
    v_add_f32 v131, v131, v11
    v_lshlrev_b32 v8, 16, v42
    v_and_b32 v9, 0xffff0000, v42
    v_add_f32 v132, v132, v8
    v_add_f32 v133, v133, v9
    v_lshlrev_b32 v10, 16, v43
    v_and_b32 v11, 0xffff0000, v43
    v_add_f32 v134, v134, v10
    v_add_f32 v135, v135, v11
    s_waitcnt vmcnt(7)
    v_lshlrev_b32 v8, 16, v76
    v_and_b32 v9, 0xffff0000, v76
    v_add_f32 v136, v136, v8
    v_add_f32 v137, v137, v9
    v_lshlrev_b32 v10, 16, v77
    v_and_b32 v11, 0xffff0000, v77
    v_add_f32 v138, v138, v10
    v_add_f32 v139, v139, v11
    v_lshlrev_b32 v8, 16, v78
    v_and_b32 v9, 0xffff0000, v78
    v_add_f32 v140, v140, v8
    v_add_f32 v141, v141, v9
    v_lshlrev_b32 v10, 16, v79
    v_and_b32 v11, 0xffff0000, v79
    v_add_f32 v142, v142, v10
    v_add_f32 v143, v143, v11
    s_waitcnt vmcnt(6)
    v_lshlrev_b32 v8, 16, v112
    v_and_b32 v9, 0xffff0000, v112
    v_add_f32 v144, v144, v8
    v_add_f32 v145, v145, v9
    v_lshlrev_b32 v10, 16, v113
    v_and_b32 v11, 0xffff0000, v113
    v_add_f32 v146, v146, v10
    v_add_f32 v147, v147, v11
    v_lshlrev_b32 v8, 16, v114
    v_and_b32 v9, 0xffff0000, v114
    v_add_f32 v148, v148, v8
    v_add_f32 v149, v149, v9
    v_lshlrev_b32 v10, 16, v115
    v_and_b32 v11, 0xffff0000, v115
    v_add_f32 v150, v150, v10
    v_add_f32 v151, v151, v11
    s_waitcnt vmcnt(5)
    v_lshlrev_b32 v8, 16, v44
    v_and_b32 v9, 0xffff0000, v44
    v_add_f32 v128, v128, v8
    v_add_f32 v129, v129, v9
    v_lshlrev_b32 v10, 16, v45
    v_and_b32 v11, 0xffff0000, v45
    v_add_f32 v130, v130, v10
    v_add_f32 v131, v131, v11
    v_lshlrev_b32 v8, 16, v46
    v_and_b32 v9, 0xffff0000, v46
    v_add_f32 v132, v132, v8
    v_add_f32 v133, v133, v9
    v_lshlrev_b32 v10, 16, v47
    v_and_b32 v11, 0xffff0000, v47
    v_add_f32 v134, v134, v10
    v_add_f32 v135, v135, v11
    s_waitcnt vmcnt(4)
    v_lshlrev_b32 v8, 16, v80
    v_and_b32 v9, 0xffff0000, v80
    v_add_f32 v136, v136, v8
    v_add_f32 v137, v137, v9
    v_lshlrev_b32 v10, 16, v81
    v_and_b32 v11, 0xffff0000, v81
    v_add_f32 v138, v138, v10
    v_add_f32 v139, v139, v11
    v_lshlrev_b32 v8, 16, v82
    v_and_b32 v9, 0xffff0000, v82
    v_add_f32 v140, v140, v8
    v_add_f32 v141, v141, v9
    v_lshlrev_b32 v10, 16, v83
    v_and_b32 v11, 0xffff0000, v83
    v_add_f32 v142, v142, v10
    v_add_f32 v143, v143, v11
    s_waitcnt vmcnt(3)
    v_lshlrev_b32 v8, 16, v116
    v_and_b32 v9, 0xffff0000, v116
    v_add_f32 v144, v144, v8
    v_add_f32 v145, v145, v9
    v_lshlrev_b32 v10, 16, v117
    v_and_b32 v11, 0xffff0000, v117
    v_add_f32 v146, v146, v10
    v_add_f32 v147, v147, v11
    v_lshlrev_b32 v8, 16, v118
    v_and_b32 v9, 0xffff0000, v118
    v_add_f32 v148, v148, v8
    v_add_f32 v149, v149, v9
    v_lshlrev_b32 v10, 16, v119
    v_and_b32 v11, 0xffff0000, v119
    v_add_f32 v150, v150, v10
    v_add_f32 v151, v151, v11
    s_waitcnt vmcnt(2)
    v_lshlrev_b32 v8, 16, v48
    v_and_b32 v9, 0xffff0000, v48
    v_add_f32 v128, v128, v8
    v_add_f32 v129, v129, v9
    v_lshlrev_b32 v10, 16, v49
    v_and_b32 v11, 0xffff0000, v49
    v_add_f32 v130, v130, v10
    v_add_f32 v131, v131, v11
    v_lshlrev_b32 v8, 16, v50
    v_and_b32 v9, 0xffff0000, v50
    v_add_f32 v132, v132, v8
    v_add_f32 v133, v133, v9
    v_lshlrev_b32 v10, 16, v51
    v_and_b32 v11, 0xffff0000, v51
    v_add_f32 v134, v134, v10
    v_add_f32 v135, v135, v11
    s_waitcnt vmcnt(1)
    v_lshlrev_b32 v8, 16, v84
    v_and_b32 v9, 0xffff0000, v84
    v_add_f32 v136, v136, v8
    v_add_f32 v137, v137, v9
    v_lshlrev_b32 v10, 16, v85
    v_and_b32 v11, 0xffff0000, v85
    v_add_f32 v138, v138, v10
    v_add_f32 v139, v139, v11
    v_lshlrev_b32 v8, 16, v86
    v_and_b32 v9, 0xffff0000, v86
    v_add_f32 v140, v140, v8
    v_add_f32 v141, v141, v9
    v_lshlrev_b32 v10, 16, v87
    v_and_b32 v11, 0xffff0000, v87
    v_add_f32 v142, v142, v10
    v_add_f32 v143, v143, v11
    s_waitcnt vmcnt(0)
    v_lshlrev_b32 v8, 16, v120
    v_and_b32 v9, 0xffff0000, v120
    v_add_f32 v144, v144, v8
    v_add_f32 v145, v145, v9
    v_lshlrev_b32 v10, 16, v121
    v_and_b32 v11, 0xffff0000, v121
    v_add_f32 v146, v146, v10
    v_add_f32 v147, v147, v11
    v_lshlrev_b32 v8, 16, v122
    v_and_b32 v9, 0xffff0000, v122
    v_add_f32 v148, v148, v8
    v_add_f32 v149, v149, v9
    v_lshlrev_b32 v10, 16, v123
    v_and_b32 v11, 0xffff0000, v123
    v_add_f32 v150, v150, v10
    v_add_f32 v151, v151, v11
    s_mov_b32 s16, s38
    s_mov_b32 s17, s39
    s_mov_b32 s18, 0x240000
    s_mov_b32 s19, 0x20000
    v_cvt_pk_bf16_f32 v160, v128, v129
    v_cvt_pk_bf16_f32 v161, v130, v131
    v_cvt_pk_bf16_f32 v162, v132, v133
    v_cvt_pk_bf16_f32 v163, v134, v135
    buffer_store_dwordx4 v[160:163], v3, s[16:19], 0 offen offset:0
    v_cvt_pk_bf16_f32 v164, v136, v137
    v_cvt_pk_bf16_f32 v165, v138, v139
    v_cvt_pk_bf16_f32 v166, v140, v141
    v_cvt_pk_bf16_f32 v167, v142, v143
    buffer_store_dwordx4 v[164:167], v3, s[16:19], 0 offen offset:128
    v_cvt_pk_bf16_f32 v168, v144, v145
    v_cvt_pk_bf16_f32 v169, v146, v147
    v_cvt_pk_bf16_f32 v170, v148, v149
    v_cvt_pk_bf16_f32 v171, v150, v151
    buffer_store_dwordx4 v[168:171], v3, s[16:19], 0 offen offset:256
L_w3a_56:
    s_waitcnt vmcnt(0) lgkmcnt(0)
red1_kernel_end:
    s_endpgm
.section .rodata,"a"
.p2align 6
.amdhsa_kernel red1_kernel
  .amdhsa_next_free_vgpr 176
  .amdhsa_next_free_sgpr 102
  .amdhsa_accum_offset 176
  .amdhsa_group_segment_fixed_size 0
  .amdhsa_kernarg_size 80
  .amdhsa_user_sgpr_count 2
  .amdhsa_user_sgpr_kernarg_segment_ptr 1
  .amdhsa_system_sgpr_workgroup_id_x 1
  .amdhsa_float_denorm_mode_32 3
.end_amdhsa_kernel
```

```asm
; @launch grid=(256,1,1) block=(256,1,1) lds=163840
.amdgcn_target "amdgcn-amd-amdhsa--gfx950"
.text
.globl interleave_layers__sliding_local_dilated__glu_gated_bilinear__prompt_kernel
.p2align 8
.type interleave_layers__sliding_local_dilated__glu_gated_bilinear__prompt_kernel,@function
interleave_layers__sliding_local_dilated__glu_gated_bilinear__prompt_kernel:
    s_cmp_ge_u32 s2, 256
    s_cbranch_scc1 interleave_layers__sliding_local_dilated__glu_gated_bilinear__prompt_kernel_end
    s_load_dwordx16 s[24:39], s[0:1], 0
    s_load_dwordx4 s[40:43], s[0:1], 64
    v_lshrrev_b32 v1, 6, v0
    s_and_b32 s21, s2, 7
    v_readfirstlane_b32 s20, v1
    s_lshr_b32 s22, s2, 3
    v_and_b32 v1, 63, v0
    v_lshlrev_b32 v2, 4, v1
    s_lshl_b32 s23, s22, 2
    s_add_u32 s23, s23, s20
    s_mul_i32 s23, s23, 5
    v_add_lshl_u32 v250, v1, s23, 7
    s_getpc_b64 s[16:17]
L_pc_1:
    v_min_u32 v250, interleave_layers__sliding_local_dilated__glu_gated_bilinear__prompt_kernel_last-L_pc_1, v250
    s_mov_b64 exec, 31
    global_load_dword v250, v250, s[16:17]
    s_mov_b64 exec, -1
    s_waitcnt lgkmcnt(0)
    s_mov_b32 s4, s42
    s_mov_b32 s5, s43
    s_mov_b32 s6, 0x10000000
    s_mov_b32 s7, 0x20000
    s_mov_b32 s100, 20971520
    s_mov_b32 s101, 0
    s_mov_b32 s8, s24
    s_mov_b32 s9, s25
    s_mov_b32 s10, 0x240000
    s_mov_b32 s11, 0x20000
    v_mov_b32 v5, 0
    s_or_b32 s44, s2, s20
    s_cmp_lg_u32 s44, 0
    s_cbranch_scc1 L_nonce_2
    s_memrealtime s[44:45]
    s_waitcnt lgkmcnt(0)
    v_mov_b32 v6, s44
    v_mov_b32 v7, s45
    s_mov_b64 exec, 1
    global_store_dwordx2 v5, v[6:7], s[40:41] sc1
    s_mov_b64 exec, -1
L_nonce_2:
    s_lshl_b32 s47, s21, 5
    s_add_u32 s47, s47, s22
    v_and_b32 v6, 7, v1
    v_lshrrev_b32 v7, 3, v1
    s_lshl_b32 s48, s47, 3
    v_add_u32 v3, s48, v6
    v_mul_u32_u24 v3, 1152, v3
    s_mul_i32 s48, s20, 384
    v_lshl_add_u32 v3, v7, 4, v3
    v_add_u32 v3, s48, v3
    s_lshr_b32 s48, s47, 1
    s_mul_i32 s48, s48, 18432
    s_and_b32 s49, s47, 1
    s_lshl_b32 s49, s49, 7
    s_add_u32 s48, s48, s49
    s_mul_i32 s49, s20, 6144
    s_add_u32 s48, s48, s49
    v_lshlrev_b32 v6, 4, v6
    v_lshl_add_u32 v6, v7, 8, v6
    v_add_u32 v4, s48, v6
    s_cmp_eq_u32 s20, 3
    s_cbranch_scc1 L_w3_3
    buffer_load_dwordx4 v[8:11], v3, s[8:11], 0 offen offset:0
    buffer_load_dwordx4 v[12:15], v3, s[8:11], 0 offen offset:128
    buffer_load_dwordx4 v[16:19], v3, s[8:11], 0 offen offset:256
L_w3_3:
    s_mov_b32 s66, 0
    s_and_b32 s68, s20, 1
    s_lshl_b32 s68, s68, 13
    s_mul_i32 s67, s21, 36
    s_add_u32 s67, s67, s22
    s_cmp_eq_u32 s20, 3
    s_cbranch_scc1 L_uq_4
    s_cmp_lg_u32 s20, 2
    s_cbranch_scc1 L_uend_6
    s_add_u32 s67, s67, 32
    s_cmp_lt_u32 s22, 4
    s_cbranch_scc1 L_uq_4
    s_cmp_ge_u32 s22, 18
    s_cbranch_scc1 L_uend_6
    s_mul_i32 s67, s21, 14
    s_add_u32 s67, s67, s22
    s_sub_u32 s67, s67, 4
    s_cmp_ge_u32 s67, 108
    s_cbranch_scc1 L_uend_6
    s_mov_b32 s66, 2
    s_mul_i32 s84, s67, 3641
    s_lshr_b32 s84, s84, 16
    s_mul_i32 s85, s84, 18
    s_sub_u32 s85, s67, s85
    s_mul_i32 s86, s85, 41472
    s_sub_u32 s87, s85, 16
    s_mul_i32 s87, s87, 331776
    s_add_u32 s87, s87, 18432
    s_cmp_lt_u32 s85, 16
    s_cselect_b32 s86, s86, s87
    s_mov_b32 s88, 82944
    s_mov_b32 s89, 41472
    s_cselect_b32 s88, 4608, s88
    s_cselect_b32 s89, 23040, s89
    s_mul_i32 s87, s84, 192
    s_add_u32 s86, s86, s87
    s_mov_b32 s90, 1152
    s_mul_i32 s91, s67, 6144
    s_mov_b32 s12, s28
    s_mov_b32 s13, s29
    s_mov_b32 s14, 0xa2000
    s_mov_b32 s15, 0x20000
    v_add_u32 v64, 0, v1
    v_mul_u32_u24 v65, 5462, v64
    v_lshrrev_b32 v65, 16, v65
    v_mul_u32_u24 v66, 12, v65
    v_sub_u32 v64, v64, v66
    v_lshlrev_b32 v64, 4, v64
    v_lshrrev_b32 v66, 3, v65
    v_mul_lo_u32 v66, v66, s88
    v_bfe_u32 v67, v65, 2, 1
    v_mul_lo_u32 v67, v67, s89
    v_and_b32 v65, 3, v65
    v_mul_lo_u32 v65, v65, s90
    v_add3_u32 v64, v64, v66, v67
    v_add3_u32 v64, v64, v65, s86
    s_add_u32 m0, s68, 0
    s_nop 0
    buffer_load_dwordx4 v64, s[12:15], 0 offen lds
    v_add_u32 v64, 64, v1
    v_mul_u32_u24 v65, 5462, v64
    v_lshrrev_b32 v65, 16, v65
    v_mul_u32_u24 v66, 12, v65
    v_sub_u32 v64, v64, v66
    v_lshlrev_b32 v64, 4, v64
    v_lshrrev_b32 v66, 3, v65
    v_mul_lo_u32 v66, v66, s88
    v_bfe_u32 v67, v65, 2, 1
    v_mul_lo_u32 v67, v67, s89
    v_and_b32 v65, 3, v65
    v_mul_lo_u32 v65, v65, s90
    v_add3_u32 v64, v64, v66, v67
    v_add3_u32 v64, v64, v65, s86
    s_add_u32 m0, s68, 1024
    s_nop 0
    buffer_load_dwordx4 v64, s[12:15], 0 offen lds
    v_add_u32 v64, 128, v1
    v_mul_u32_u24 v65, 5462, v64
    v_lshrrev_b32 v65, 16, v65
    v_mul_u32_u24 v66, 12, v65
    v_sub_u32 v64, v64, v66
    v_lshlrev_b32 v64, 4, v64
    v_lshrrev_b32 v66, 3, v65
    v_mul_lo_u32 v66, v66, s88
    v_bfe_u32 v67, v65, 2, 1
    v_mul_lo_u32 v67, v67, s89
    v_and_b32 v65, 3, v65
    v_mul_lo_u32 v65, v65, s90
    v_add3_u32 v64, v64, v66, v67
    v_add3_u32 v64, v64, v65, s86
    s_add_u32 m0, s68, 2048
    s_nop 0
    buffer_load_dwordx4 v64, s[12:15], 0 offen lds
    v_add_u32 v64, 192, v1
    v_mul_u32_u24 v65, 5462, v64
    v_lshrrev_b32 v65, 16, v65
    v_mul_u32_u24 v66, 12, v65
    v_sub_u32 v64, v64, v66
    v_lshlrev_b32 v64, 4, v64
    v_lshrrev_b32 v66, 3, v65
    v_mul_lo_u32 v66, v66, s88
    v_bfe_u32 v67, v65, 2, 1
    v_mul_lo_u32 v67, v67, s89
    v_and_b32 v65, 3, v65
    v_mul_lo_u32 v65, v65, s90
    v_add3_u32 v64, v64, v66, v67
    v_add3_u32 v64, v64, v65, s86
    s_add_u32 m0, s68, 3072
    s_nop 0
    buffer_load_dwordx4 v64, s[12:15], 0 offen lds
    v_add_u32 v64, 256, v1
    v_mul_u32_u24 v65, 5462, v64
    v_lshrrev_b32 v65, 16, v65
    v_mul_u32_u24 v66, 12, v65
    v_sub_u32 v64, v64, v66
    v_lshlrev_b32 v64, 4, v64
    v_lshrrev_b32 v66, 3, v65
    v_mul_lo_u32 v66, v66, s88
    v_bfe_u32 v67, v65, 2, 1
    v_mul_lo_u32 v67, v67, s89
    v_and_b32 v65, 3, v65
    v_mul_lo_u32 v65, v65, s90
    v_add3_u32 v64, v64, v66, v67
    v_add3_u32 v64, v64, v65, s86
    s_add_u32 m0, s68, 4096
    s_nop 0
    buffer_load_dwordx4 v64, s[12:15], 0 offen lds
    v_add_u32 v64, 320, v1
    v_mul_u32_u24 v65, 5462, v64
    v_lshrrev_b32 v65, 16, v65
    v_mul_u32_u24 v66, 12, v65
    v_sub_u32 v64, v64, v66
    v_lshlrev_b32 v64, 4, v64
    v_lshrrev_b32 v66, 3, v65
    v_mul_lo_u32 v66, v66, s88
    v_bfe_u32 v67, v65, 2, 1
    v_mul_lo_u32 v67, v67, s89
    v_and_b32 v65, 3, v65
    v_mul_lo_u32 v65, v65, s90
    v_add3_u32 v64, v64, v66, v67
    v_add3_u32 v64, v64, v65, s86
    s_add_u32 m0, s68, 5120
    s_nop 0
    buffer_load_dwordx4 v64, s[12:15], 0 offen lds
    s_lshl_b32 s69, s84, 5
    s_add_u32 s69, s69, s85
    s_lshl_b32 s69, s69, 3
    s_add_u32 s69, s69, 4067328
    s_branch L_uend_6
L_uq_4:
    s_mov_b32 s66, 1
    s_lshr_b32 s69, s67, 4
    s_and_b32 s67, s67, 15
    s_mul_i32 s67, s67, 18
    s_add_u32 s67, s67, s69
    s_mul_i32 s84, s67, 3641
    s_lshr_b32 s84, s84, 16
    s_mul_i32 s85, s84, 18
    s_sub_u32 s85, s67, s85
    s_mul_i32 s86, s84, 72
    s_and_b32 s87, s86, 8
    s_and_b32 s86, s86, -16
    s_mul_i32 s88, s85, 110592
    s_add_u32 s86, s86, s88
    s_mov_b32 s88, 27648
    s_mov_b32 s89, 13824
    s_mov_b32 s90, 3456
    s_mul_i32 s91, s67, 7168
    s_mov_b32 s12, s26
    s_mov_b32 s13, s27
    s_mov_b32 s14, 0x1e6000
    s_mov_b32 s15, 0x20000
    v_add_u32 v64, 0, v1
    v_mul_u32_u24 v65, 4370, v64
    v_lshrrev_b32 v65, 16, v65
    v_mul_u32_u24 v66, 15, v65
    v_sub_u32 v64, v64, v66
    v_mul_u32_u24 v66, 13108, v64
    v_lshrrev_b32 v66, 16, v66
    v_mul_u32_u24 v66, 1072, v66
    v_lshl_add_u32 v64, v64, 4, v66
    v_lshrrev_b32 v66, 3, v65
    v_mul_lo_u32 v66, v66, s88
    v_bfe_u32 v67, v65, 2, 1
    v_mul_lo_u32 v67, v67, s89
    v_and_b32 v65, 3, v65
    v_mul_lo_u32 v65, v65, s90
    v_add3_u32 v64, v64, v66, v67
    v_add3_u32 v64, v64, v65, s86
    s_add_u32 m0, s68, 0
    s_nop 0
    buffer_load_dwordx4 v64, s[12:15], 0 offen lds
    v_add_u32 v64, 64, v1
    v_mul_u32_u24 v65, 4370, v64
    v_lshrrev_b32 v65, 16, v65
    v_mul_u32_u24 v66, 15, v65
    v_sub_u32 v64, v64, v66
    v_mul_u32_u24 v66, 13108, v64
    v_lshrrev_b32 v66, 16, v66
    v_mul_u32_u24 v66, 1072, v66
    v_lshl_add_u32 v64, v64, 4, v66
    v_lshrrev_b32 v66, 3, v65
    v_mul_lo_u32 v66, v66, s88
    v_bfe_u32 v67, v65, 2, 1
    v_mul_lo_u32 v67, v67, s89
    v_and_b32 v65, 3, v65
    v_mul_lo_u32 v65, v65, s90
    v_add3_u32 v64, v64, v66, v67
    v_add3_u32 v64, v64, v65, s86
    s_add_u32 m0, s68, 1024
    s_nop 0
    buffer_load_dwordx4 v64, s[12:15], 0 offen lds
    v_add_u32 v64, 128, v1
    v_mul_u32_u24 v65, 4370, v64
    v_lshrrev_b32 v65, 16, v65
    v_mul_u32_u24 v66, 15, v65
    v_sub_u32 v64, v64, v66
    v_mul_u32_u24 v66, 13108, v64
    v_lshrrev_b32 v66, 16, v66
    v_mul_u32_u24 v66, 1072, v66
    v_lshl_add_u32 v64, v64, 4, v66
    v_lshrrev_b32 v66, 3, v65
    v_mul_lo_u32 v66, v66, s88
    v_bfe_u32 v67, v65, 2, 1
    v_mul_lo_u32 v67, v67, s89
    v_and_b32 v65, 3, v65
    v_mul_lo_u32 v65, v65, s90
    v_add3_u32 v64, v64, v66, v67
    v_add3_u32 v64, v64, v65, s86
    s_add_u32 m0, s68, 2048
    s_nop 0
    buffer_load_dwordx4 v64, s[12:15], 0 offen lds
    v_add_u32 v64, 192, v1
    v_mul_u32_u24 v65, 4370, v64
    v_lshrrev_b32 v65, 16, v65
    v_mul_u32_u24 v66, 15, v65
    v_sub_u32 v64, v64, v66
    v_mul_u32_u24 v66, 13108, v64
    v_lshrrev_b32 v66, 16, v66
    v_mul_u32_u24 v66, 1072, v66
    v_lshl_add_u32 v64, v64, 4, v66
    v_lshrrev_b32 v66, 3, v65
    v_mul_lo_u32 v66, v66, s88
    v_bfe_u32 v67, v65, 2, 1
    v_mul_lo_u32 v67, v67, s89
    v_and_b32 v65, 3, v65
    v_mul_lo_u32 v65, v65, s90
    v_add3_u32 v64, v64, v66, v67
    v_add3_u32 v64, v64, v65, s86
    s_add_u32 m0, s68, 3072
    s_nop 0
    buffer_load_dwordx4 v64, s[12:15], 0 offen lds
    v_add_u32 v64, 256, v1
    v_mul_u32_u24 v65, 4370, v64
    v_lshrrev_b32 v65, 16, v65
    v_mul_u32_u24 v66, 15, v65
    v_sub_u32 v64, v64, v66
    v_mul_u32_u24 v66, 13108, v64
    v_lshrrev_b32 v66, 16, v66
    v_mul_u32_u24 v66, 1072, v66
    v_lshl_add_u32 v64, v64, 4, v66
    v_lshrrev_b32 v66, 3, v65
    v_mul_lo_u32 v66, v66, s88
    v_bfe_u32 v67, v65, 2, 1
    v_mul_lo_u32 v67, v67, s89
    v_and_b32 v65, 3, v65
    v_mul_lo_u32 v65, v65, s90
    v_add3_u32 v64, v64, v66, v67
    v_add3_u32 v64, v64, v65, s86
    s_add_u32 m0, s68, 4096
    s_nop 0
    buffer_load_dwordx4 v64, s[12:15], 0 offen lds
    v_add_u32 v64, 320, v1
    v_mul_u32_u24 v65, 4370, v64
    v_lshrrev_b32 v65, 16, v65
    v_mul_u32_u24 v66, 15, v65
    v_sub_u32 v64, v64, v66
    v_mul_u32_u24 v66, 13108, v64
    v_lshrrev_b32 v66, 16, v66
    v_mul_u32_u24 v66, 1072, v66
    v_lshl_add_u32 v64, v64, 4, v66
    v_lshrrev_b32 v66, 3, v65
    v_mul_lo_u32 v66, v66, s88
    v_bfe_u32 v67, v65, 2, 1
    v_mul_lo_u32 v67, v67, s89
    v_and_b32 v65, 3, v65
    v_mul_lo_u32 v65, v65, s90
    v_add3_u32 v64, v64, v66, v67
    v_add3_u32 v64, v64, v65, s86
    s_add_u32 m0, s68, 5120
    s_nop 0
    buffer_load_dwordx4 v64, s[12:15], 0 offen lds
    v_add_u32 v64, 384, v1
    v_mul_u32_u24 v65, 4370, v64
    v_lshrrev_b32 v65, 16, v65
    v_mul_u32_u24 v66, 15, v65
    v_sub_u32 v64, v64, v66
    v_mul_u32_u24 v66, 13108, v64
    v_lshrrev_b32 v66, 16, v66
    v_mul_u32_u24 v66, 1072, v66
    v_lshl_add_u32 v64, v64, 4, v66
    v_lshrrev_b32 v66, 3, v65
    v_mul_lo_u32 v66, v66, s88
    v_bfe_u32 v67, v65, 2, 1
    v_mul_lo_u32 v67, v67, s89
    v_and_b32 v65, 3, v65
    v_mul_lo_u32 v65, v65, s90
    v_add3_u32 v64, v64, v66, v67
    v_add3_u32 v64, v64, v65, s86
    s_add_u32 m0, s68, 6144
    s_nop 0
    buffer_load_dwordx4 v64, s[12:15], 0 offen lds
    v_add_u32 v64, 448, v1
    v_mul_u32_u24 v65, 4370, v64
    v_lshrrev_b32 v65, 16, v65
    v_mul_u32_u24 v66, 15, v65
    v_sub_u32 v64, v64, v66
    v_mul_u32_u24 v66, 13108, v64
    v_lshrrev_b32 v66, 16, v66
    v_mul_u32_u24 v66, 1072, v66
    v_lshl_add_u32 v64, v64, 4, v66
    v_lshrrev_b32 v66, 3, v65
    v_mul_lo_u32 v66, v66, s88
    v_bfe_u32 v67, v65, 2, 1
    v_mul_lo_u32 v67, v67, s89
    v_and_b32 v65, 3, v65
    v_mul_lo_u32 v65, v65, s90
    v_add3_u32 v64, v64, v66, v67
    v_add3_u32 v64, v64, v65, s86
    s_add_u32 m0, s68, 7168
    s_nop 0
    buffer_load_dwordx4 v64, s[12:15], 0 offen lds
    s_lshl_b32 s69, s84, 5
    s_add_u32 s69, s69, s85
    s_lshl_b32 s69, s69, 3
    s_add_u32 s69, s69, 4063232
L_uend_6:
    v_add_u32 v64, 0, v1
    v_mul_u32_u24 v65, 3641, v64
    v_lshrrev_b32 v65, 16, v65
    v_mul_u32_u24 v65, 8928, v65
    v_lshl_add_u32 v232, v64, 4, v65
    v_add_u32 v64, 64, v1
    v_mul_u32_u24 v65, 3641, v64
    v_lshrrev_b32 v65, 16, v65
    v_mul_u32_u24 v65, 8928, v65
    v_lshl_add_u32 v233, v64, 4, v65
    v_add_u32 v64, 128, v1
    v_mul_u32_u24 v65, 3641, v64
    v_lshrrev_b32 v65, 16, v65
    v_mul_u32_u24 v65, 8928, v65
    v_lshl_add_u32 v234, v64, 4, v65
    v_add_u32 v64, 192, v1
    v_mul_u32_u24 v65, 3641, v64
    v_lshrrev_b32 v65, 16, v65
    v_mul_u32_u24 v65, 8928, v65
    v_lshl_add_u32 v235, v64, 4, v65
    v_add_u32 v64, 256, v1
    v_mul_u32_u24 v65, 3641, v64
    v_lshrrev_b32 v65, 16, v65
    v_mul_u32_u24 v65, 8928, v65
    v_lshl_add_u32 v236, v64, 4, v65
    v_add_u32 v64, 320, v1
    v_mul_u32_u24 v65, 3641, v64
    v_lshrrev_b32 v65, 16, v65
    v_mul_u32_u24 v65, 8928, v65
    v_lshl_add_u32 v237, v64, 4, v65
    v_add_u32 v64, 384, v1
    v_mul_u32_u24 v65, 3641, v64
    v_lshrrev_b32 v65, 16, v65
    v_mul_u32_u24 v65, 8928, v65
    v_lshl_add_u32 v238, v64, 4, v65
    v_add_u32 v64, 448, v1
    v_mul_u32_u24 v65, 3641, v64
    v_lshrrev_b32 v65, 16, v65
    v_mul_u32_u24 v65, 8928, v65
    v_lshl_add_u32 v239, v64, 4, v65
    v_add_u32 v64, 512, v1
    v_mul_u32_u24 v65, 3641, v64
    v_lshrrev_b32 v65, 16, v65
    v_mul_u32_u24 v65, 8928, v65
    v_lshl_add_u32 v240, v64, 4, v65
    s_lshl_b32 s70, s21, 7
    s_lshl_b32 s71, s22, 2
    s_add_u32 s70, s70, s71
    s_add_u32 s70, s70, s20
    s_lshr_b32 s92, s70, 5
    s_and_b32 s93, s70, 31
    s_and_b32 s94, s92, 1
    s_cmp_eq_u32 s94, 0
    s_cselect_b32 s16, s32, s34
    s_cselect_b32 s17, s33, s35
    s_mov_b32 s18, 0x510000
    s_mov_b32 s19, 0x20000
    s_lshr_b32 s95, s92, 1
    s_mul_i32 s58, s95, 294912
    s_mul_i32 s96, s93, 288
    s_add_u32 s58, s58, s96
    s_mul_i32 s96, s93, 486
    s_add_u32 s96, s96, s92
    s_lshl_b32 s96, s96, 10
    s_add_u32 s59, s96, 4194304
    s_lshl_b32 s96, s93, 1
    s_add_u32 s96, s96, s94
    s_mul_i32 s96, s96, 18
    s_add_u32 s96, s96, s95
    s_mul_i32 s96, s96, 576
    s_add_u32 s60, s96, 2883584
    s_lshl_b32 s96, s93, 6
    s_add_u32 s96, s96, s92
    s_lshl_b32 s96, s96, 3
    s_add_u32 s61, s96, 4071424
    global_load_dwordx2 v[6:7], v5, s[40:41] sc1
    s_cmp_eq_u32 s20, 3
    s_cbranch_scc1 L_w3_10
    s_waitcnt vmcnt(1)
    v_lshlrev_b32 v20, 16, v8
    v_and_b32 v21, 0xffff0000, v8
    v_lshlrev_b32 v22, 16, v9
    v_and_b32 v23, 0xffff0000, v9
    v_lshlrev_b32 v24, 16, v10
    v_and_b32 v25, 0xffff0000, v10
    v_lshlrev_b32 v26, 16, v11
    v_and_b32 v27, 0xffff0000, v11
    s_waitcnt vmcnt(1)
    v_lshlrev_b32 v28, 16, v12
    v_and_b32 v29, 0xffff0000, v12
    v_lshlrev_b32 v30, 16, v13
    v_and_b32 v31, 0xffff0000, v13
    v_lshlrev_b32 v32, 16, v14
    v_and_b32 v33, 0xffff0000, v14
    v_lshlrev_b32 v34, 16, v15
    v_and_b32 v35, 0xffff0000, v15
    s_waitcnt vmcnt(1)
    v_lshlrev_b32 v36, 16, v16
    v_and_b32 v37, 0xffff0000, v16
    v_lshlrev_b32 v38, 16, v17
    v_and_b32 v39, 0xffff0000, v17
    v_lshlrev_b32 v40, 16, v18
    v_and_b32 v41, 0xffff0000, v18
    v_lshlrev_b32 v42, 16, v19
    v_and_b32 v43, 0xffff0000, v19
    v_add_f32 v44, v20, v21
    v_add_f32 v64, v22, v23
    v_add_f32 v44, v44, v24
    v_add_f32 v64, v64, v25
    v_add_f32 v44, v44, v26
    v_add_f32 v64, v64, v27
    v_add_f32 v44, v44, v28
    v_add_f32 v64, v64, v29
    v_add_f32 v44, v44, v30
    v_add_f32 v64, v64, v31
    v_add_f32 v44, v44, v32
    v_add_f32 v64, v64, v33
    v_add_f32 v44, v44, v34
    v_add_f32 v64, v64, v35
    v_add_f32 v44, v44, v36
    v_add_f32 v64, v64, v37
    v_add_f32 v44, v44, v38
    v_add_f32 v64, v64, v39
    v_add_f32 v44, v44, v40
    v_add_f32 v64, v64, v41
    v_add_f32 v44, v44, v42
    v_add_f32 v64, v64, v43
    v_add_f32 v44, v44, v64
    s_nop 1
    v_add_f32_dpp v44, v44, v44 row_ror:8 row_mask:0xf bank_mask:0xf
    v_mov_b32 v64, v44
    s_nop 1
    v_permlane16_swap_b32 v44, v64
    v_add_f32 v44, v44, v64
    v_mov_b32 v64, v44
    s_nop 1
    v_permlane32_swap_b32 v44, v64
    v_add_f32 v44, v44, v64
    v_mul_f32 v65, 0x3baaaaab, v44
    v_sub_f32 v64, v20, v65
    v_mul_f32 v45, v64, v64
    v_sub_f32 v67, v21, v65
    v_fmac_f32 v45, v67, v67
    v_sub_f32 v66, v22, v65
    v_fmac_f32 v45, v66, v66
    v_sub_f32 v67, v23, v65
    v_fmac_f32 v45, v67, v67
    v_sub_f32 v66, v24, v65
    v_fmac_f32 v45, v66, v66
    v_sub_f32 v67, v25, v65
    v_fmac_f32 v45, v67, v67
    v_sub_f32 v66, v26, v65
    v_fmac_f32 v45, v66, v66
    v_sub_f32 v67, v27, v65
    v_fmac_f32 v45, v67, v67
    v_sub_f32 v66, v28, v65
    v_fmac_f32 v45, v66, v66
    v_sub_f32 v67, v29, v65
    v_fmac_f32 v45, v67, v67
    v_sub_f32 v66, v30, v65
    v_fmac_f32 v45, v66, v66
    v_sub_f32 v67, v31, v65
    v_fmac_f32 v45, v67, v67
    v_sub_f32 v66, v32, v65
    v_fmac_f32 v45, v66, v66
    v_sub_f32 v67, v33, v65
    v_fmac_f32 v45, v67, v67
    v_sub_f32 v66, v34, v65
    v_fmac_f32 v45, v66, v66
    v_sub_f32 v67, v35, v65
    v_fmac_f32 v45, v67, v67
    v_sub_f32 v66, v36, v65
    v_fmac_f32 v45, v66, v66
    v_sub_f32 v67, v37, v65
    v_fmac_f32 v45, v67, v67
    v_sub_f32 v66, v38, v65
    v_fmac_f32 v45, v66, v66
    v_sub_f32 v67, v39, v65
    v_fmac_f32 v45, v67, v67
    v_sub_f32 v66, v40, v65
    v_fmac_f32 v45, v66, v66
    v_sub_f32 v67, v41, v65
    v_fmac_f32 v45, v67, v67
    v_sub_f32 v66, v42, v65
    v_fmac_f32 v45, v66, v66
    v_sub_f32 v67, v43, v65
    v_fmac_f32 v45, v67, v67
    s_nop 1
    v_add_f32_dpp v45, v45, v45 row_ror:8 row_mask:0xf bank_mask:0xf
    v_mov_b32 v64, v45
    s_nop 1
    v_permlane16_swap_b32 v45, v64
    v_add_f32 v45, v45, v64
    v_mov_b32 v64, v45
    s_nop 1
    v_permlane32_swap_b32 v45, v64
    v_add_f32 v45, v45, v64
    v_and_b32 v64, 7, v1
    s_mul_i32 s46, s20, 64
    s_add_u32 s46, s46, 160896
    v_lshl_add_u32 v64, v64, 3, s46
    ds_write_b64 v64, v[44:45]
    s_waitcnt lgkmcnt(0)
L_w3_10:
    s_barrier
    s_cmp_eq_u32 s20, 3
    s_cbranch_scc1 L_w3_11
    v_and_b32 v64, 7, v1
    v_lshlrev_b32 v64, 3, v64
    v_add_u32 v64, 160896, v64
    ds_read_b64 v[44:45], v64 offset:0
    ds_read_b64 v[46:47], v64 offset:64
    ds_read_b64 v[48:49], v64 offset:128
    s_waitcnt lgkmcnt(1)
    v_add_f32 v64, v44, v46
    s_waitcnt lgkmcnt(0)
    v_add_f32 v64, v64, v48
    v_mul_f32 v64, 0x3ae38e39, v64
    v_add_f32 v65, v45, v47
    v_add_f32 v65, v65, v49
    v_mul_f32 v66, 0x3baaaaab, v44
    v_sub_f32 v66, v66, v64
    v_mul_f32 v66, v66, v66
    v_fmac_f32 v65, 0x43400000, v66
    v_mul_f32 v66, 0x3baaaaab, v46
    v_sub_f32 v66, v66, v64
    v_mul_f32 v66, v66, v66
    v_fmac_f32 v65, 0x43400000, v66
    v_mul_f32 v66, 0x3baaaaab, v48
    v_sub_f32 v66, v66, v64
    v_mul_f32 v66, v66, v66
    v_fmac_f32 v65, 0x43400000, v66
    v_mul_f32 v65, 0x3ae38e39, v65
    v_cvt_pk_bf16_f32 v65, v65, v65
    v_lshlrev_b32 v65, 16, v65
    v_add_f32 v65, 0x3727c5ac, v65
    v_cvt_pk_bf16_f32 v65, v65, v65
    v_lshlrev_b32 v65, 16, v65
    v_sqrt_f32 v65, v65
    s_nop 0
    v_cvt_pk_bf16_f32 v65, v65, v65
    v_lshlrev_b32 v65, 16, v65
    v_rcp_f32 v65, v65
    v_cvt_pk_bf16_f32 v64, v64, v64
    v_lshlrev_b32 v64, 16, v64
    v_sub_f32 v20, v20, v64
    v_sub_f32 v21, v21, v64
    v_cvt_pk_bf16_f32 v66, v20, v21
    v_lshlrev_b32 v20, 16, v66
    v_and_b32 v21, 0xffff0000, v66
    v_mul_f32 v20, v20, v65
    v_mul_f32 v21, v21, v65
    v_cvt_pk_bf16_f32 v52, v20, v21
    v_sub_f32 v22, v22, v64
    v_sub_f32 v23, v23, v64
    v_cvt_pk_bf16_f32 v66, v22, v23
    v_lshlrev_b32 v22, 16, v66
    v_and_b32 v23, 0xffff0000, v66
    v_mul_f32 v22, v22, v65
    v_mul_f32 v23, v23, v65
    v_cvt_pk_bf16_f32 v53, v22, v23
    v_sub_f32 v24, v24, v64
    v_sub_f32 v25, v25, v64
    v_cvt_pk_bf16_f32 v66, v24, v25
    v_lshlrev_b32 v24, 16, v66
    v_and_b32 v25, 0xffff0000, v66
    v_mul_f32 v24, v24, v65
    v_mul_f32 v25, v25, v65
    v_cvt_pk_bf16_f32 v54, v24, v25
    v_sub_f32 v26, v26, v64
    v_sub_f32 v27, v27, v64
    v_cvt_pk_bf16_f32 v66, v26, v27
    v_lshlrev_b32 v26, 16, v66
    v_and_b32 v27, 0xffff0000, v66
    v_mul_f32 v26, v26, v65
    v_mul_f32 v27, v27, v65
    v_cvt_pk_bf16_f32 v55, v26, v27
    v_sub_f32 v28, v28, v64
    v_sub_f32 v29, v29, v64
    v_cvt_pk_bf16_f32 v66, v28, v29
    v_lshlrev_b32 v28, 16, v66
    v_and_b32 v29, 0xffff0000, v66
    v_mul_f32 v28, v28, v65
    v_mul_f32 v29, v29, v65
    v_cvt_pk_bf16_f32 v56, v28, v29
    v_sub_f32 v30, v30, v64
    v_sub_f32 v31, v31, v64
    v_cvt_pk_bf16_f32 v66, v30, v31
    v_lshlrev_b32 v30, 16, v66
    v_and_b32 v31, 0xffff0000, v66
    v_mul_f32 v30, v30, v65
    v_mul_f32 v31, v31, v65
    v_cvt_pk_bf16_f32 v57, v30, v31
    v_sub_f32 v32, v32, v64
    v_sub_f32 v33, v33, v64
    v_cvt_pk_bf16_f32 v66, v32, v33
    v_lshlrev_b32 v32, 16, v66
    v_and_b32 v33, 0xffff0000, v66
    v_mul_f32 v32, v32, v65
    v_mul_f32 v33, v33, v65
    v_cvt_pk_bf16_f32 v58, v32, v33
    v_sub_f32 v34, v34, v64
    v_sub_f32 v35, v35, v64
    v_cvt_pk_bf16_f32 v66, v34, v35
    v_lshlrev_b32 v34, 16, v66
    v_and_b32 v35, 0xffff0000, v66
    v_mul_f32 v34, v34, v65
    v_mul_f32 v35, v35, v65
    v_cvt_pk_bf16_f32 v59, v34, v35
    v_sub_f32 v36, v36, v64
    v_sub_f32 v37, v37, v64
    v_cvt_pk_bf16_f32 v66, v36, v37
    v_lshlrev_b32 v36, 16, v66
    v_and_b32 v37, 0xffff0000, v66
    v_mul_f32 v36, v36, v65
    v_mul_f32 v37, v37, v65
    v_cvt_pk_bf16_f32 v60, v36, v37
    v_sub_f32 v38, v38, v64
    v_sub_f32 v39, v39, v64
    v_cvt_pk_bf16_f32 v66, v38, v39
    v_lshlrev_b32 v38, 16, v66
    v_and_b32 v39, 0xffff0000, v66
    v_mul_f32 v38, v38, v65
    v_mul_f32 v39, v39, v65
    v_cvt_pk_bf16_f32 v61, v38, v39
    v_sub_f32 v40, v40, v64
    v_sub_f32 v41, v41, v64
    v_cvt_pk_bf16_f32 v66, v40, v41
    v_lshlrev_b32 v40, 16, v66
    v_and_b32 v41, 0xffff0000, v66
    v_mul_f32 v40, v40, v65
    v_mul_f32 v41, v41, v65
    v_cvt_pk_bf16_f32 v62, v40, v41
    v_sub_f32 v42, v42, v64
    v_sub_f32 v43, v43, v64
    v_cvt_pk_bf16_f32 v66, v42, v43
    v_lshlrev_b32 v42, 16, v66
    v_and_b32 v43, 0xffff0000, v66
    v_mul_f32 v42, v42, v65
    v_mul_f32 v43, v43, v65
    v_cvt_pk_bf16_f32 v63, v42, v43
    s_mov_b32 s46, 20971520
    buffer_store_dwordx4 v[52:55], v4, s[4:7], s46 offen offset:0 sc1
    buffer_store_dwordx4 v[56:59], v4, s[4:7], s46 offen offset:2048 sc1
    s_add_u32 s46, s46, 4096
    buffer_store_dwordx4 v[60:63], v4, s[4:7], s46 offen offset:0 sc1
L_w3_11:
    s_cmp_eq_u32 s66, 0
    s_cbranch_scc1 L_fe_13
    s_cmp_eq_u32 s66, 2
    s_cbranch_scc1 L_fw_12
    v_lshrrev_b32 v64, 4, v1
    v_bfe_u32 v66, v1, 2, 2
    v_lshl_add_u32 v64, v64, 3, v66
    v_mul_u32_u24 v64, 240, v64
    v_add_u32 v64, s68, v64
    v_and_b32 v66, 3, v1
    v_add_u32 v64, s87, v64
    v_and_b32 v67, 1, v66
    v_mul_u32_u24 v67, 160, v67
    v_lshrrev_b32 v65, 1, v66
    v_mul_u32_u24 v65, 80, v65
    v_add3_u32 v65, v65, v67, v64
    v_cmp_eq_u32 vcc, 3, v66
    s_nop 1
    v_cndmask_b32 v65, v65, v64, vcc
    v_lshl_add_u32 v64, v66, 3, v64
    s_waitcnt vmcnt(1)
    ds_read_b64_tr_b16 v[72:73], v64 offset:0
    ds_read_b64_tr_b16 v[74:75], v64 offset:960
    ds_read_b64_tr_b16 v[76:77], v64 offset:40
    ds_read_b64_tr_b16 v[78:79], v64 offset:1000
    ds_read_b64_tr_b16 v[80:81], v64 offset:80
    ds_read_b64_tr_b16 v[82:83], v64 offset:1040
    ds_read_b64_tr_b16 v[84:85], v64 offset:120
    ds_read_b64_tr_b16 v[86:87], v64 offset:1080
    ds_read_b64_tr_b16 v[88:89], v64 offset:160
    ds_read_b64_tr_b16 v[90:91], v64 offset:1120
    ds_read_b64_tr_b16 v[92:93], v64 offset:200
    ds_read_b64_tr_b16 v[94:95], v64 offset:1160
    ds_read_b64_tr_b16 v[96:97], v65 offset:32
    ds_read_b64_tr_b16 v[98:99], v65 offset:992
    v_and_b32 v66, 15, v1
    v_cmp_gt_u32 vcc, 12, v66
    s_waitcnt lgkmcnt(1)
    s_nop 0
    v_cndmask_b32 v96, 0, v96, vcc
    v_cndmask_b32 v97, 0, v97, vcc
    s_waitcnt lgkmcnt(0)
    v_cndmask_b32 v98, 0, v98, vcc
    v_cndmask_b32 v99, 0, v99, vcc
    s_add_u32 s91, s91, 0
    buffer_store_dwordx4 v[72:75], v2, s[4:7], s91 offen offset:0 sc1
    buffer_store_dwordx4 v[76:79], v2, s[4:7], s91 offen offset:1024 sc1
    buffer_store_dwordx4 v[80:83], v2, s[4:7], s91 offen offset:2048 sc1
    buffer_store_dwordx4 v[84:87], v2, s[4:7], s91 offen offset:3072 sc1
    s_add_u32 s91, s91, 4096
    buffer_store_dwordx4 v[88:91], v2, s[4:7], s91 offen offset:0 sc1
    buffer_store_dwordx4 v[92:95], v2, s[4:7], s91 offen offset:1024 sc1
    buffer_store_dwordx4 v[96:99], v2, s[4:7], s91 offen offset:2048 sc1
    s_branch L_fe_13
L_fw_12:
    v_lshrrev_b32 v64, 4, v1
    v_bfe_u32 v66, v1, 2, 2
    v_lshl_add_u32 v64, v64, 3, v66
    v_mul_u32_u24 v64, 192, v64
    v_add_u32 v64, s68, v64
    v_and_b32 v66, 3, v1
    v_lshl_add_u32 v64, v66, 4, v64
    s_waitcnt vmcnt(1)
    ds_read_b64_tr_b16 v[72:73], v64 offset:0
    ds_read_b64_tr_b16 v[74:75], v64 offset:768
    ds_read_b64_tr_b16 v[76:77], v64 offset:8
    ds_read_b64_tr_b16 v[78:79], v64 offset:776
    ds_read_b64_tr_b16 v[80:81], v64 offset:64
    ds_read_b64_tr_b16 v[82:83], v64 offset:832
    ds_read_b64_tr_b16 v[84:85], v64 offset:72
    ds_read_b64_tr_b16 v[86:87], v64 offset:840
    ds_read_b64_tr_b16 v[88:89], v64 offset:128
    ds_read_b64_tr_b16 v[90:91], v64 offset:896
    ds_read_b64_tr_b16 v[92:93], v64 offset:136
    ds_read_b64_tr_b16 v[94:95], v64 offset:904
    s_add_u32 s91, s91, 2097152
    s_waitcnt lgkmcnt(10)
    buffer_store_dwordx4 v[72:75], v2, s[4:7], s91 offen offset:0 sc1
    s_waitcnt lgkmcnt(8)
    buffer_store_dwordx4 v[76:79], v2, s[4:7], s91 offen offset:1024 sc1
    s_waitcnt lgkmcnt(6)
    buffer_store_dwordx4 v[80:83], v2, s[4:7], s91 offen offset:2048 sc1
    s_waitcnt lgkmcnt(4)
    buffer_store_dwordx4 v[84:87], v2, s[4:7], s91 offen offset:3072 sc1
    s_add_u32 s91, s91, 4096
    s_waitcnt lgkmcnt(2)
    buffer_store_dwordx4 v[88:91], v2, s[4:7], s91 offen offset:0 sc1
    s_waitcnt lgkmcnt(0)
    buffer_store_dwordx4 v[92:95], v2, s[4:7], s91 offen offset:1024 sc1
L_fe_13:
    s_waitcnt vmcnt(0)
    v_cmp_ne_u64 vcc, 0, v[6:7]
    s_nop 0
    s_cmp_eq_u64 vcc, exec
    s_cbranch_scc0 L_pn_slow_7
L_pn_back_8:
    v_readfirstlane_b32 s98, v6
    v_readfirstlane_b32 s99, v7
    s_waitcnt vmcnt(0)
    s_cmp_eq_u32 s20, 3
    s_cbranch_scc1 L_w3_14
    s_lshl_b32 s46, s47, 2
    s_add_u32 s46, s46, s20
    s_lshl_b32 s46, s46, 3
    s_add_u32 s46, s46, 3932160
    v_mov_b32 v6, s98
    v_mov_b32 v7, s99
    s_mov_b64 exec, 1
    buffer_store_dwordx2 v[6:7], off, s[4:7], s46 sc1
    s_mov_b64 exec, -1
L_w3_14:
    s_cmp_eq_u32 s66, 0
    s_cbranch_scc1 L_norole_15
    v_mov_b32 v6, s98
    v_mov_b32 v7, s99
    s_mov_b64 exec, 1
    buffer_store_dwordx2 v[6:7], off, s[4:7], s69 sc1
    s_mov_b64 exec, -1
L_norole_15:
    s_sub_u32 s70, s22, 24
    s_lshl_b32 s70, s70, 1
    s_add_u32 s70, s70, s20
    s_lshl_b32 s71, s21, 4
    s_add_u32 s70, s70, s71
    s_add_u32 s70, s70, 1024
    s_lshr_b32 s92, s70, 5
    s_and_b32 s93, s70, 31
    s_and_b32 s94, s92, 1
    s_cmp_eq_u32 s94, 0
    s_cselect_b32 s12, s32, s34
    s_cselect_b32 s13, s33, s35
    s_mov_b32 s14, 0x510000
    s_mov_b32 s15, 0x20000
    s_lshr_b32 s95, s92, 1
    s_mul_i32 s62, s95, 294912
    s_mul_i32 s96, s93, 288
    s_add_u32 s62, s62, s96
    s_mul_i32 s96, s93, 486
    s_add_u32 s96, s96, s92
    s_lshl_b32 s96, s96, 10
    s_add_u32 s63, s96, 4194304
    s_lshl_b32 s96, s93, 1
    s_add_u32 s96, s96, s94
    s_mul_i32 s96, s96, 18
    s_add_u32 s96, s96, s95
    s_mul_i32 s96, s96, 576
    s_add_u32 s64, s96, 2883584
    s_lshl_b32 s96, s93, 6
    s_add_u32 s96, s96, s92
    s_lshl_b32 s96, s96, 3
    s_add_u32 s65, s96, 4071424
    s_lshr_b32 s44, s22, 4
    s_lshl_b32 s52, s21, 1
    s_add_u32 s44, s44, s52
    s_and_b32 s45, s22, 15
    s_mul_i32 s48, s20, 21
    s_lshr_b32 s48, s48, 1
    s_lshl_b32 s48, s48, 10
    s_mul_i32 s47, s45, 129024
    s_add_u32 s47, s47, s48
    s_add_u32 s47, s47, 0
    s_lshl_b32 s46, s44, 3
    s_max_u32 s52, s46, 1
    s_sub_u32 s52, s52, 1
    s_mul_i32 s49, s52, 18432
    s_mul_i32 s50, s20, 9
    s_lshr_b32 s50, s50, 1
    s_lshl_b32 s50, s50, 10
    s_add_u32 s49, s49, s50
    s_add_u32 s49, s49, 20971520
    s_add_u32 s50, s50, 129024
    s_lshl_b32 s54, s52, 6
    s_lshl_b32 s52, s20, 1
    s_add_u32 s46, s46, s52
    s_mul_i32 s51, s46, 18432
    s_add_u32 s51, s51, 20971520
    s_lshl_b32 s55, s46, 6
    v_and_b32 v6, 3, v1
    v_min_u32 v6, 2, v6
    v_and_b32 v7, 12, v1
    v_add_lshl_u32 v8, v6, v7, 3
    v_add_u32 v8, s55, v8
    v_and_b32 v7, 4, v1
    v_add_lshl_u32 v9, v6, v7, 3
    v_add_u32 v9, s54, v9
    v_and_b32 v7, 16, v1
    v_cmp_eq_u32 vcc, 0, v7
    s_nop 1
    v_cndmask_b32 v8, v9, v8, vcc
    v_subrev_u32 v7, 32, v1
    v_min_u32 v7, 17, v7
    s_lshl_b32 s52, s45, 8
    s_add_u32 s52, s52, 131072
    v_lshl_add_u32 v7, v7, 3, s52
    v_cmp_gt_u32 vcc, 32, v1
    s_nop 1
    v_cndmask_b32 v8, v7, v8, vcc
    s_mov_b32 s52, 3932160
    buffer_load_dwordx2 v[6:7], v8, s[4:7], s52 offen sc1
    s_min_u32 s56, s20, 2
    s_add_u32 s57, s56, 2
    s_add_u32 s56, s56, 4
    s_cmp_ge_u32 s20, 2
    s_cselect_b32 s57, 6, s57
    s_lshl_b32 s57, s57, 10
    s_lshl_b32 s56, s56, 10
    v_mov_b32 v3, v2
    v_add_u32 v4, s57, v2
    v_add_u32 v5, s56, v2
    v_add_u32 v10, 129024, v2
    s_waitcnt vmcnt(0)
    v_cmp_eq_u64 vcc, s[98:99], v[6:7]
    s_nop 0
    s_cmp_eq_u64 vcc, exec
    s_cbranch_scc0 L_px_slow_17
L_px_back_18:
    s_barrier
    s_add_u32 m0, s48, 0
    s_add_u32 s53, s47, 0
    buffer_load_dwordx4 v2, s[4:7], s53 offen offset:0 lds
    buffer_load_dwordx4 v2, s[4:7], s53 offen offset:1024 lds
    buffer_load_dwordx4 v2, s[4:7], s53 offen offset:2048 lds
    buffer_load_dwordx4 v2, s[4:7], s53 offen offset:3072 lds
    s_add_u32 m0, s48, 4096
    s_add_u32 s53, s47, 4096
    buffer_load_dwordx4 v2, s[4:7], s53 offen offset:0 lds
    buffer_load_dwordx4 v2, s[4:7], s53 offen offset:1024 lds
    buffer_load_dwordx4 v2, s[4:7], s53 offen offset:2048 lds
    buffer_load_dwordx4 v2, s[4:7], s53 offen offset:3072 lds
    s_add_u32 m0, s48, 8192
    s_add_u32 s53, s47, 8192
    buffer_load_dwordx4 v2, s[4:7], s53 offen offset:0 lds
    buffer_load_dwordx4 v2, s[4:7], s53 offen offset:1024 lds
    buffer_load_dwordx4 v2, s[4:7], s53 offen offset:2048 lds
    s_add_u32 s54, s51, 0
    buffer_load_dwordx4 a[0:3], v2, s[4:7], s54 offen offset:0 sc1
    s_add_u32 s55, s51, 18432
    buffer_load_dwordx4 a[72:75], v2, s[4:7], s55 offen offset:0 sc1
    buffer_load_dwordx4 a[4:7], v2, s[4:7], s54 offen offset:1024 sc1
    buffer_load_dwordx4 a[76:79], v2, s[4:7], s55 offen offset:1024 sc1
    buffer_load_dwordx4 a[8:11], v2, s[4:7], s54 offen offset:2048 sc1
    buffer_load_dwordx4 a[80:83], v2, s[4:7], s55 offen offset:2048 sc1
    buffer_load_dwordx4 a[12:15], v2, s[4:7], s54 offen offset:3072 sc1
    buffer_load_dwordx4 a[84:87], v2, s[4:7], s55 offen offset:3072 sc1
    s_add_u32 s54, s51, 4096
    buffer_load_dwordx4 a[16:19], v2, s[4:7], s54 offen offset:0 sc1
    s_add_u32 s55, s51, 22528
    buffer_load_dwordx4 a[88:91], v2, s[4:7], s55 offen offset:0 sc1
    buffer_load_dwordx4 a[20:23], v2, s[4:7], s54 offen offset:1024 sc1
    buffer_load_dwordx4 a[92:95], v2, s[4:7], s55 offen offset:1024 sc1
    s_add_u32 m0, s48, 43008
    s_add_u32 s53, s47, 43008
    buffer_load_dwordx4 v2, s[4:7], s53 offen offset:0 lds
    buffer_load_dwordx4 v2, s[4:7], s53 offen offset:1024 lds
    buffer_load_dwordx4 v2, s[4:7], s53 offen offset:2048 lds
    buffer_load_dwordx4 v2, s[4:7], s53 offen offset:3072 lds
    s_add_u32 m0, s48, 47104
    s_add_u32 s53, s47, 47104
    buffer_load_dwordx4 v2, s[4:7], s53 offen offset:0 lds
    buffer_load_dwordx4 v2, s[4:7], s53 offen offset:1024 lds
    buffer_load_dwordx4 v2, s[4:7], s53 offen offset:2048 lds
    buffer_load_dwordx4 v2, s[4:7], s53 offen offset:3072 lds
    s_add_u32 m0, s48, 51200
    s_add_u32 s53, s47, 51200
    buffer_load_dwordx4 v2, s[4:7], s53 offen offset:0 lds
    buffer_load_dwordx4 v2, s[4:7], s53 offen offset:1024 lds
    buffer_load_dwordx4 v2, s[4:7], s53 offen offset:2048 lds
    v_and_b32 v6, 15, v1
    v_lshrrev_b32 v7, 4, v1
    v_lshlrev_b32 v7, 2, v7
    v_sub_u32 v6, v6, v7
    v_mov_b32 v8, 0xf149f2ca
    s_or_b32 s52, s44, s20
    s_cmp_eq_u32 s52, 0
    s_cselect_b64 s[56:57], -1, 0
    v_subrev_u32 v7, 0, v6
    v_and_b32 v9, 0xfffffff1, v7
    v_cmp_eq_u32 vcc, 0, v9
    v_add_u32 v7, 16, v7
    v_and_b32 v9, 0xfffffff1, v7
    v_cndmask_b32_e64 v168, v8, 0, vcc
    v_cmp_eq_u32 vcc, 0, v9
    s_nop 1
    v_cndmask_b32_e64 v172, v8, 0, vcc
    v_cndmask_b32_e64 v176, v172, v8, s[56:57]
    v_subrev_u32 v7, 1, v6
    v_and_b32 v9, 0xfffffff1, v7
    v_cmp_eq_u32 vcc, 0, v9
    v_add_u32 v7, 16, v7
    v_and_b32 v9, 0xfffffff1, v7
    v_cndmask_b32_e64 v169, v8, 0, vcc
    v_cmp_eq_u32 vcc, 0, v9
    s_nop 1
    v_cndmask_b32_e64 v173, v8, 0, vcc
    v_cndmask_b32_e64 v177, v173, v8, s[56:57]
    v_subrev_u32 v7, 2, v6
    v_and_b32 v9, 0xfffffff1, v7
    v_cmp_eq_u32 vcc, 0, v9
    v_add_u32 v7, 16, v7
    v_and_b32 v9, 0xfffffff1, v7
    v_cndmask_b32_e64 v170, v8, 0, vcc
    v_cmp_eq_u32 vcc, 0, v9
    s_nop 1
    v_cndmask_b32_e64 v174, v8, 0, vcc
    v_cndmask_b32_e64 v178, v174, v8, s[56:57]
    v_subrev_u32 v7, 3, v6
    v_and_b32 v9, 0xfffffff1, v7
    v_cmp_eq_u32 vcc, 0, v9
    v_add_u32 v7, 16, v7
    v_and_b32 v9, 0xfffffff1, v7
    v_cndmask_b32_e64 v171, v8, 0, vcc
    v_cmp_eq_u32 vcc, 0, v9
    s_nop 1
    v_cndmask_b32_e64 v175, v8, 0, vcc
    v_cndmask_b32_e64 v179, v175, v8, s[56:57]
    s_waitcnt vmcnt(23)
    s_barrier
    ds_read_b128 v[88:91], v3 offset:0
    ds_read_b128 v[92:95], v3 offset:1024
    ds_read_b128 v[96:99], v3 offset:2048
    ds_read_b128 v[100:103], v3 offset:3072
    ds_read_b128 v[112:115], v3 offset:6144
    ds_read_b128 v[104:107], v3 offset:4096
    ds_read_b128 v[108:111], v3 offset:5120
    s_add_u32 m0, s50, 0
    s_add_u32 s53, s49, 0
    s_waitcnt vmcnt(22) lgkmcnt(6)
    v_mfma_f32_16x16x32_bf16 v[16:19], v[88:91], a[0:3], 0
    buffer_load_dwordx4 v2, s[4:7], s53 offen offset:0 sc1 lds
    ds_read_b128 v[116:119], v3 offset:7168
    s_waitcnt vmcnt(22)
    v_mfma_f32_16x16x32_bf16 v[48:51], v[88:91], a[72:75], 0
    ds_read_b128 v[120:123], v3 offset:8192
    s_waitcnt lgkmcnt(7)
    v_mfma_f32_16x16x32_bf16 v[20:23], v[92:95], a[0:3], 0
    v_mfma_f32_16x16x32_bf16 v[52:55], v[92:95], a[72:75], 0
    ds_read_b128 v[124:127], v3 offset:9216
    s_waitcnt lgkmcnt(7)
    v_mfma_f32_16x16x32_bf16 v[24:27], v[96:99], a[0:3], 0
    buffer_load_dwordx4 v2, s[4:7], s53 offen offset:1024 sc1 lds
    v_mfma_f32_16x16x32_bf16 v[56:59], v[96:99], a[72:75], 0
    ds_read_b128 v[128:131], v3 offset:10240
    s_waitcnt lgkmcnt(7)
    v_mfma_f32_16x16x32_bf16 v[28:31], v[100:103], a[0:3], 0
    v_mfma_f32_16x16x32_bf16 v[60:63], v[100:103], a[72:75], 0
    ds_read_b128 v[140:143], v3 offset:13312
    s_waitcnt lgkmcnt(7)
    v_mfma_f32_16x16x32_bf16 v[32:35], v[112:115], a[0:3], 0
    buffer_load_dwordx4 v2, s[4:7], s53 offen offset:2048 sc1 lds
    v_mfma_f32_16x16x32_bf16 v[64:67], v[112:115], a[72:75], 0
    ds_read_b128 v[132:135], v3 offset:11264
    v_mfma_f32_16x16x32_bf16 v[44:47], a[0:3], v[112:115], 0
    v_mfma_f32_16x16x32_bf16 v[76:79], a[72:75], v[112:115], 0
    ds_read_b128 v[136:139], v3 offset:12288
    s_waitcnt lgkmcnt(8)
    v_mfma_f32_16x16x32_bf16 v[36:39], a[0:3], v[104:107], 0
    buffer_load_dwordx4 v2, s[4:7], s53 offen offset:3072 sc1 lds
    s_add_u32 m0, s50, 4096
    v_mfma_f32_16x16x32_bf16 v[68:71], a[72:75], v[104:107], 0
    s_add_u32 s53, s49, 4096
    s_waitcnt lgkmcnt(7)
    v_mfma_f32_16x16x32_bf16 v[40:43], a[0:3], v[108:111], 0
    v_mfma_f32_16x16x32_bf16 v[72:75], a[72:75], v[108:111], 0
    s_waitcnt vmcnt(24) lgkmcnt(6)
    v_mfma_f32_16x16x32_bf16 v[16:19], v[116:119], a[4:7], v[16:19]
    buffer_load_dwordx4 v2, s[4:7], s53 offen offset:0 sc1 lds
    ds_read_b128 v[88:91], v3 offset:14336
    s_waitcnt vmcnt(24)
    v_mfma_f32_16x16x32_bf16 v[48:51], v[116:119], a[76:79], v[48:51]
    ds_read_b128 v[92:95], v3 offset:15360
    s_waitcnt lgkmcnt(7)
    v_mfma_f32_16x16x32_bf16 v[20:23], v[120:123], a[4:7], v[20:23]
    v_mfma_f32_16x16x32_bf16 v[52:55], v[120:123], a[76:79], v[52:55]
    ds_read_b128 v[96:99], v3 offset:16384
    s_waitcnt lgkmcnt(7)
    v_mfma_f32_16x16x32_bf16 v[24:27], v[124:127], a[4:7], v[24:27]
    buffer_load_dwordx4 a[24:27], v2, s[4:7], s54 offen offset:2048 sc1
    v_mfma_f32_16x16x32_bf16 v[56:59], v[124:127], a[76:79], v[56:59]
    ds_read_b128 v[100:103], v3 offset:17408
    s_waitcnt lgkmcnt(7)
    v_mfma_f32_16x16x32_bf16 v[28:31], v[128:131], a[4:7], v[28:31]
    v_mfma_f32_16x16x32_bf16 v[60:63], v[128:131], a[76:79], v[60:63]
    ds_read_b128 v[112:115], v3 offset:20480
    s_waitcnt lgkmcnt(7)
    v_mfma_f32_16x16x32_bf16 v[32:35], v[140:143], a[4:7], v[32:35]
    buffer_load_dwordx4 a[96:99], v2, s[4:7], s55 offen offset:2048 sc1
    v_mfma_f32_16x16x32_bf16 v[64:67], v[140:143], a[76:79], v[64:67]
    ds_read_b128 v[104:107], v3 offset:18432
    v_mfma_f32_16x16x32_bf16 v[44:47], a[4:7], v[140:143], v[44:47]
    v_mfma_f32_16x16x32_bf16 v[76:79], a[76:79], v[140:143], v[76:79]
    ds_read_b128 v[108:111], v3 offset:19456
    s_waitcnt lgkmcnt(8)
    v_mfma_f32_16x16x32_bf16 v[36:39], a[4:7], v[132:135], v[36:39]
    buffer_load_dwordx4 a[28:31], v2, s[4:7], s54 offen offset:3072 sc1
    v_mfma_f32_16x16x32_bf16 v[68:71], a[76:79], v[132:135], v[68:71]
    s_waitcnt lgkmcnt(7)
    v_mfma_f32_16x16x32_bf16 v[40:43], a[4:7], v[136:139], v[40:43]
    v_mfma_f32_16x16x32_bf16 v[72:75], a[76:79], v[136:139], v[72:75]
    s_waitcnt vmcnt(26) lgkmcnt(6)
    v_mfma_f32_16x16x32_bf16 v[16:19], v[88:91], a[8:11], v[16:19]
    buffer_load_dwordx4 a[100:103], v2, s[4:7], s55 offen offset:3072 sc1
    s_add_u32 s54, s51, 8192
    s_waitcnt vmcnt(26)
    v_mfma_f32_16x16x32_bf16 v[48:51], v[88:91], a[80:83], v[48:51]
    ds_read_b128 v[116:119], v3 offset:21504
    ds_read_b128 v[120:123], v3 offset:22528
    s_waitcnt lgkmcnt(7)
    v_mfma_f32_16x16x32_bf16 v[20:23], v[92:95], a[8:11], v[20:23]
    v_mfma_f32_16x16x32_bf16 v[52:55], v[92:95], a[80:83], v[52:55]
    ds_read_b128 v[124:127], v3 offset:23552
    s_waitcnt lgkmcnt(7)
    v_mfma_f32_16x16x32_bf16 v[24:27], v[96:99], a[8:11], v[24:27]
    buffer_load_dwordx4 a[32:35], v2, s[4:7], s54 offen offset:0 sc1
    s_add_u32 s55, s51, 26624
    v_mfma_f32_16x16x32_bf16 v[56:59], v[96:99], a[80:83], v[56:59]
    ds_read_b128 v[128:131], v3 offset:24576
    s_waitcnt lgkmcnt(7)
    v_mfma_f32_16x16x32_bf16 v[28:31], v[100:103], a[8:11], v[28:31]
    v_mfma_f32_16x16x32_bf16 v[60:63], v[100:103], a[80:83], v[60:63]
    ds_read_b128 v[140:143], v3 offset:27648
    s_waitcnt lgkmcnt(7)
    v_mfma_f32_16x16x32_bf16 v[32:35], v[112:115], a[8:11], v[32:35]
    buffer_load_dwordx4 a[104:107], v2, s[4:7], s55 offen offset:0 sc1
    v_mfma_f32_16x16x32_bf16 v[64:67], v[112:115], a[80:83], v[64:67]
    ds_read_b128 v[132:135], v3 offset:25600
    v_mfma_f32_16x16x32_bf16 v[44:47], a[8:11], v[112:115], v[44:47]
    v_mfma_f32_16x16x32_bf16 v[76:79], a[80:83], v[112:115], v[76:79]
    ds_read_b128 v[136:139], v3 offset:26624
    s_waitcnt lgkmcnt(8)
    v_mfma_f32_16x16x32_bf16 v[36:39], a[8:11], v[104:107], v[36:39]
    buffer_load_dwordx4 a[36:39], v2, s[4:7], s54 offen offset:1024 sc1
    v_mfma_f32_16x16x32_bf16 v[68:71], a[80:83], v[104:107], v[68:71]
    s_waitcnt lgkmcnt(7)
    v_mfma_f32_16x16x32_bf16 v[40:43], a[8:11], v[108:111], v[40:43]
    v_mfma_f32_16x16x32_bf16 v[72:75], a[80:83], v[108:111], v[72:75]
    s_waitcnt vmcnt(28) lgkmcnt(6)
    v_mfma_f32_16x16x32_bf16 v[16:19], v[116:119], a[12:15], v[16:19]
    buffer_load_dwordx4 a[108:111], v2, s[4:7], s55 offen offset:1024 sc1
    ds_read_b128 v[88:91], v3 offset:28672
    s_waitcnt vmcnt(28)
    v_mfma_f32_16x16x32_bf16 v[48:51], v[116:119], a[84:87], v[48:51]
    ds_read_b128 v[92:95], v3 offset:29696
    s_waitcnt lgkmcnt(7)
    v_mfma_f32_16x16x32_bf16 v[20:23], v[120:123], a[12:15], v[20:23]
    v_mfma_f32_16x16x32_bf16 v[52:55], v[120:123], a[84:87], v[52:55]
    ds_read_b128 v[96:99], v3 offset:30720
    s_waitcnt lgkmcnt(7)
    v_mfma_f32_16x16x32_bf16 v[24:27], v[124:127], a[12:15], v[24:27]
    buffer_load_dwordx4 a[40:43], v2, s[4:7], s54 offen offset:2048 sc1
    v_mfma_f32_16x16x32_bf16 v[56:59], v[124:127], a[84:87], v[56:59]
    ds_read_b128 v[100:103], v3 offset:31744
    s_waitcnt lgkmcnt(7)
    v_mfma_f32_16x16x32_bf16 v[28:31], v[128:131], a[12:15], v[28:31]
    v_mfma_f32_16x16x32_bf16 v[60:63], v[128:131], a[84:87], v[60:63]
    ds_read_b128 v[112:115], v3 offset:34816
    s_waitcnt lgkmcnt(7)
    v_mfma_f32_16x16x32_bf16 v[32:35], v[140:143], a[12:15], v[32:35]
    buffer_load_dwordx4 a[112:115], v2, s[4:7], s55 offen offset:2048 sc1
    v_mfma_f32_16x16x32_bf16 v[64:67], v[140:143], a[84:87], v[64:67]
    ds_read_b128 v[104:107], v3 offset:32768
    v_mfma_f32_16x16x32_bf16 v[44:47], a[12:15], v[140:143], v[44:47]
    v_mfma_f32_16x16x32_bf16 v[76:79], a[84:87], v[140:143], v[76:79]
    ds_read_b128 v[108:111], v3 offset:33792
    s_waitcnt lgkmcnt(8)
    v_mfma_f32_16x16x32_bf16 v[36:39], a[12:15], v[132:135], v[36:39]
    buffer_load_dwordx4 a[44:47], v2, s[4:7], s54 offen offset:3072 sc1
    v_mfma_f32_16x16x32_bf16 v[68:71], a[84:87], v[132:135], v[68:71]
    s_waitcnt lgkmcnt(7)
    v_mfma_f32_16x16x32_bf16 v[40:43], a[12:15], v[136:139], v[40:43]
    v_mfma_f32_16x16x32_bf16 v[72:75], a[84:87], v[136:139], v[72:75]
    s_waitcnt vmcnt(30) lgkmcnt(6)
    v_mfma_f32_16x16x32_bf16 v[16:19], v[88:91], a[16:19], v[16:19]
    buffer_load_dwordx4 a[116:119], v2, s[4:7], s55 offen offset:3072 sc1
    s_add_u32 m0, s48, 86016
    s_waitcnt vmcnt(30)
    v_mfma_f32_16x16x32_bf16 v[48:51], v[88:91], a[88:91], v[48:51]
    s_add_u32 s53, s47, 86016
    ds_read_b128 v[116:119], v3 offset:35840
    s_waitcnt lgkmcnt(6)
    v_mfma_f32_16x16x32_bf16 v[20:23], v[92:95], a[16:19], v[20:23]
    ds_read_b128 v[120:123], v3 offset:36864
    v_mfma_f32_16x16x32_bf16 v[52:55], v[92:95], a[88:91], v[52:55]
    ds_read_b128 v[124:127], v3 offset:37888
    s_waitcnt lgkmcnt(7)
    v_mfma_f32_16x16x32_bf16 v[24:27], v[96:99], a[16:19], v[24:27]
    buffer_load_dwordx4 v2, s[4:7], s53 offen offset:0 lds
    v_mfma_f32_16x16x32_bf16 v[56:59], v[96:99], a[88:91], v[56:59]
    ds_read_b128 v[128:131], v3 offset:38912
    s_waitcnt lgkmcnt(7)
    v_mfma_f32_16x16x32_bf16 v[28:31], v[100:103], a[16:19], v[28:31]
    v_mfma_f32_16x16x32_bf16 v[60:63], v[100:103], a[88:91], v[60:63]
    ds_read_b128 v[140:143], v3 offset:41984
    s_waitcnt lgkmcnt(7)
    v_mfma_f32_16x16x32_bf16 v[32:35], v[112:115], a[16:19], v[32:35]
    buffer_load_dwordx4 v2, s[4:7], s53 offen offset:1024 lds
    v_mfma_f32_16x16x32_bf16 v[64:67], v[112:115], a[88:91], v[64:67]
    ds_read_b128 v[132:135], v3 offset:39936
    v_mfma_f32_16x16x32_bf16 v[44:47], a[16:19], v[112:115], v[44:47]
    v_mfma_f32_16x16x32_bf16 v[76:79], a[88:91], v[112:115], v[76:79]
    ds_read_b128 v[136:139], v3 offset:40960
    s_waitcnt lgkmcnt(8)
    v_mfma_f32_16x16x32_bf16 v[36:39], a[16:19], v[104:107], v[36:39]
    buffer_load_dwordx4 v2, s[4:7], s53 offen offset:2048 lds
    v_mfma_f32_16x16x32_bf16 v[68:71], a[88:91], v[104:107], v[68:71]
    s_waitcnt lgkmcnt(7)
    v_mfma_f32_16x16x32_bf16 v[40:43], a[16:19], v[108:111], v[40:43]
    v_mfma_f32_16x16x32_bf16 v[72:75], a[88:91], v[108:111], v[72:75]
    s_waitcnt vmcnt(32) lgkmcnt(6)
    v_mfma_f32_16x16x32_bf16 v[16:19], v[116:119], a[20:23], v[16:19]
    s_waitcnt vmcnt(20)
    s_waitcnt vmcnt(15)
    s_barrier
    v_mfma_f32_16x16x32_bf16 v[48:51], v[116:119], a[92:95], v[48:51]
    buffer_load_dwordx4 v2, s[4:7], s53 offen offset:3072 lds
    s_add_u32 m0, s48, 90112
    s_waitcnt lgkmcnt(5)
    v_mfma_f32_16x16x32_bf16 v[20:23], v[120:123], a[20:23], v[20:23]
    s_add_u32 s53, s47, 90112
    ds_read_b128 v[88:91], v3 offset:43008
    v_mfma_f32_16x16x32_bf16 v[52:55], v[120:123], a[92:95], v[52:55]
    ds_read_b128 v[92:95], v3 offset:44032
    ds_read_b128 v[96:99], v3 offset:45056
    s_waitcnt lgkmcnt(7)
    v_mfma_f32_16x16x32_bf16 v[24:27], v[124:127], a[20:23], v[24:27]
    ds_read_b128 v[144:147], v10 offset:0
    ds_read_b128 v[148:151], v4 offset:0
    v_mfma_f32_16x16x32_bf16 v[56:59], v[124:127], a[92:95], v[56:59]
    buffer_load_dwordx4 v2, s[4:7], s53 offen offset:0 lds
    ds_read_b128 v[100:103], v3 offset:46080
    s_waitcnt lgkmcnt(9)
    v_mfma_f32_16x16x32_bf16 v[28:31], v[128:131], a[20:23], v[28:31]
    ds_read_b128 v[152:155], v5 offset:0
    ds_read_b128 v[156:159], v10 offset:1024
    v_mfma_f32_16x16x32_bf16 v[60:63], v[128:131], a[92:95], v[60:63]
    ds_read_b128 v[112:115], v3 offset:49152
    ds_read_b128 v[160:163], v4 offset:7168
    s_waitcnt lgkmcnt(12)
    v_mfma_f32_16x16x32_bf16 v[32:35], v[140:143], a[20:23], v[32:35]
    ds_read_b128 v[164:167], v5 offset:7168
    v_mfma_f32_16x16x32_bf16 v[64:67], v[140:143], a[92:95], v[64:67]
    buffer_load_dwordx4 v2, s[4:7], s53 offen offset:1024 lds
    ds_read_b128 v[104:107], v3 offset:47104
    v_mfma_f32_16x16x32_bf16 v[44:47], a[20:23], v[140:143], v[44:47]
    v_mfma_f32_16x16x32_bf16 v[76:79], a[92:95], v[140:143], v[76:79]
    ds_read_b128 v[108:111], v3 offset:48128
    s_waitcnt lgkmcnt(14)
    v_mfma_f32_16x16x32_bf16 v[36:39], a[20:23], v[132:135], v[36:39]
    v_mfma_f32_16x16x32_bf16 v[68:71], a[92:95], v[132:135], v[68:71]
    buffer_load_dwordx4 v2, s[4:7], s53 offen offset:2048 lds
    s_waitcnt lgkmcnt(13)
    v_mfma_f32_16x16x32_bf16 v[40:43], a[20:23], v[136:139], v[40:43]
    v_mfma_f32_16x16x32_bf16 v[72:75], a[92:95], v[136:139], v[72:75]
    s_waitcnt vmcnt(18) lgkmcnt(12)
    v_mfma_f32_16x16x32_bf16 v[16:19], v[88:91], a[24:27], v[16:19]
    ds_read_b128 v[116:119], v3 offset:50176
    s_waitcnt vmcnt(17)
    v_mfma_f32_16x16x32_bf16 v[48:51], v[88:91], a[96:99], v[48:51]
    buffer_load_dwordx4 v2, s[4:7], s53 offen offset:3072 lds
    s_add_u32 m0, s48, 94208
    s_waitcnt lgkmcnt(12)
    v_mfma_f32_16x16x32_bf16 v[20:23], v[92:95], a[24:27], v[20:23]
    s_add_u32 s53, s47, 94208
    ds_read_b128 v[120:123], v3 offset:51200
    v_mfma_f32_16x16x32_bf16 v[52:55], v[92:95], a[96:99], v[52:55]
    ds_read_b128 v[124:127], v3 offset:52224
    s_waitcnt lgkmcnt(13)
    v_mfma_f32_16x16x32_bf16 v[24:27], v[96:99], a[24:27], v[24:27]
    v_mfma_f32_16x16x32_bf16 v[56:59], v[96:99], a[96:99], v[56:59]
    buffer_load_dwordx4 v2, s[4:7], s53 offen offset:0 lds
    ds_read_b128 v[128:131], v3 offset:53248
    s_waitcnt lgkmcnt(11)
    v_mfma_f32_16x16x32_bf16 v[28:31], v[100:103], a[24:27], v[28:31]
    v_mfma_f32_16x16x32_bf16 v[60:63], v[100:103], a[96:99], v[60:63]
    ds_read_b128 v[140:143], v3 offset:56320
    s_waitcnt lgkmcnt(9)
    v_mfma_f32_16x16x32_bf16 v[32:35], v[112:115], a[24:27], v[32:35]
    v_mfma_f32_16x16x32_bf16 v[64:67], v[112:115], a[96:99], v[64:67]
    buffer_load_dwordx4 v2, s[4:7], s53 offen offset:1024 lds
    ds_read_b128 v[132:135], v3 offset:54272
    v_mfma_f32_16x16x32_bf16 v[44:47], a[24:27], v[112:115], v[44:47]
    v_mfma_f32_16x16x32_bf16 v[76:79], a[96:99], v[112:115], v[76:79]
    ds_read_b128 v[136:139], v3 offset:55296
    s_waitcnt lgkmcnt(8)
    v_mfma_f32_16x16x32_bf16 v[36:39], a[24:27], v[104:107], v[36:39]
    v_mfma_f32_16x16x32_bf16 v[68:71], a[96:99], v[104:107], v[68:71]
    buffer_load_dwordx4 v2, s[4:7], s53 offen offset:2048 lds
    s_add_u32 s54, s51, 12288
    s_waitcnt lgkmcnt(7)
    v_mfma_f32_16x16x32_bf16 v[40:43], a[24:27], v[108:111], v[40:43]
    v_mfma_f32_16x16x32_bf16 v[72:75], a[96:99], v[108:111], v[72:75]
    v_mfma_f32_16x16x32_bf16 v[80:83], v[148:151], v[144:147], 0
    v_mfma_f32_16x16x32_bf16 v[84:87], v[144:147], v[152:155], 0
    buffer_load_dwordx4 a[48:51], v2, s[4:7], s54 offen offset:0 sc1
    s_add_u32 s55, s51, 30720
    s_waitcnt vmcnt(21) lgkmcnt(6)
    v_mfma_f32_16x16x32_bf16 v[16:19], v[116:119], a[28:31], v[16:19]
    ds_read_b128 v[88:91], v3 offset:57344
    ds_read_b128 v[144:147], v10 offset:2048
    s_waitcnt vmcnt(20)
    v_mfma_f32_16x16x32_bf16 v[48:51], v[116:119], a[100:103], v[48:51]
    ds_read_b128 v[92:95], v3 offset:58368
    ds_read_b128 v[148:151], v4 offset:14336
    s_waitcnt lgkmcnt(9)
    v_mfma_f32_16x16x32_bf16 v[20:23], v[120:123], a[28:31], v[20:23]
    ds_read_b128 v[152:155], v5 offset:14336
    v_mfma_f32_16x16x32_bf16 v[52:55], v[120:123], a[100:103], v[52:55]
    buffer_load_dwordx4 a[120:123], v2, s[4:7], s55 offen offset:0 sc1
    ds_read_b128 v[96:99], v3 offset:59392
    s_waitcnt lgkmcnt(10)
    v_mfma_f32_16x16x32_bf16 v[24:27], v[124:127], a[28:31], v[24:27]
    v_mfma_f32_16x16x32_bf16 v[56:59], v[124:127], a[100:103], v[56:59]
    ds_read_b128 v[100:103], v3 offset:60416
    s_waitcnt lgkmcnt(10)
    v_mfma_f32_16x16x32_bf16 v[28:31], v[128:131], a[28:31], v[28:31]
    v_mfma_f32_16x16x32_bf16 v[60:63], v[128:131], a[100:103], v[60:63]
    buffer_load_dwordx4 a[52:55], v2, s[4:7], s54 offen offset:1024 sc1
    ds_read_b128 v[112:115], v3 offset:63488
    s_waitcnt lgkmcnt(10)
    v_mfma_f32_16x16x32_bf16 v[32:35], v[140:143], a[28:31], v[32:35]
    v_mfma_f32_16x16x32_bf16 v[64:67], v[140:143], a[100:103], v[64:67]
    ds_read_b128 v[104:107], v3 offset:61440
    v_mfma_f32_16x16x32_bf16 v[44:47], a[28:31], v[140:143], v[44:47]
    v_mfma_f32_16x16x32_bf16 v[76:79], a[100:103], v[140:143], v[76:79]
    buffer_load_dwordx4 a[124:127], v2, s[4:7], s55 offen offset:1024 sc1
    ds_read_b128 v[108:111], v3 offset:62464
    s_waitcnt lgkmcnt(11)
    v_mfma_f32_16x16x32_bf16 v[36:39], a[28:31], v[132:135], v[36:39]
    v_mfma_f32_16x16x32_bf16 v[68:71], a[100:103], v[132:135], v[68:71]
    s_waitcnt lgkmcnt(10)
    v_mfma_f32_16x16x32_bf16 v[40:43], a[28:31], v[136:139], v[40:43]
    v_mfma_f32_16x16x32_bf16 v[72:75], a[100:103], v[136:139], v[72:75]
    buffer_load_dwordx4 a[56:59], v2, s[4:7], s54 offen offset:2048 sc1
    v_mfma_f32_16x16x32_bf16 v[80:83], v[160:163], v[156:159], v[80:83]
    v_mfma_f32_16x16x32_bf16 v[84:87], v[156:159], v[164:167], v[84:87]
    ds_read_b128 v[156:159], v10 offset:3072
    ds_read_b128 v[160:163], v4 offset:21504
    s_waitcnt vmcnt(23) lgkmcnt(11)
    v_mfma_f32_16x16x32_bf16 v[16:19], v[88:91], a[32:35], v[16:19]
    v_add_u32 v3, 64512, v3
    ds_read_b128 v[164:167], v5 offset:21504
    s_waitcnt vmcnt(22)
    v_mfma_f32_16x16x32_bf16 v[48:51], v[88:91], a[104:107], v[48:51]
    buffer_load_dwordx4 a[128:131], v2, s[4:7], s55 offen offset:2048 sc1
    ds_read_b128 v[116:119], v3 offset:0
    s_waitcnt lgkmcnt(11)
    v_mfma_f32_16x16x32_bf16 v[20:23], v[92:95], a[32:35], v[20:23]
    v_mfma_f32_16x16x32_bf16 v[52:55], v[92:95], a[104:107], v[52:55]
    ds_read_b128 v[120:123], v3 offset:1024
    s_waitcnt lgkmcnt(9)
    v_mfma_f32_16x16x32_bf16 v[24:27], v[96:99], a[32:35], v[24:27]
    v_mfma_f32_16x16x32_bf16 v[56:59], v[96:99], a[104:107], v[56:59]
    buffer_load_dwordx4 a[60:63], v2, s[4:7], s54 offen offset:3072 sc1
    ds_read_b128 v[124:127], v3 offset:2048
    s_waitcnt lgkmcnt(9)
    v_mfma_f32_16x16x32_bf16 v[28:31], v[100:103], a[32:35], v[28:31]
    v_mfma_f32_16x16x32_bf16 v[60:63], v[100:103], a[104:107], v[60:63]
    ds_read_b128 v[128:131], v3 offset:3072
    s_waitcnt lgkmcnt(9)
    v_mfma_f32_16x16x32_bf16 v[32:35], v[112:115], a[32:35], v[32:35]
    v_mfma_f32_16x16x32_bf16 v[64:67], v[112:115], a[104:107], v[64:67]
    buffer_load_dwordx4 a[132:135], v2, s[4:7], s55 offen offset:3072 sc1
    s_add_u32 s54, s51, 16384
    v_mfma_f32_16x16x32_bf16 v[44:47], a[32:35], v[112:115], v[44:47]
    ds_read_b128 v[140:143], v3 offset:6144
    v_mfma_f32_16x16x32_bf16 v[76:79], a[104:107], v[112:115], v[76:79]
    ds_read_b128 v[132:135], v3 offset:4096
    s_waitcnt lgkmcnt(10)
    v_mfma_f32_16x16x32_bf16 v[36:39], a[32:35], v[104:107], v[36:39]
    v_mfma_f32_16x16x32_bf16 v[68:71], a[104:107], v[104:107], v[68:71]
    ds_read_b128 v[136:139], v3 offset:5120
    buffer_load_dwordx4 a[64:67], v2, s[4:7], s54 offen offset:0 sc1
    s_waitcnt lgkmcnt(10)
    v_mfma_f32_16x16x32_bf16 v[40:43], a[32:35], v[108:111], v[40:43]
    s_add_u32 s55, s51, 34816
    v_mfma_f32_16x16x32_bf16 v[72:75], a[104:107], v[108:111], v[72:75]
    v_mfma_f32_16x16x32_bf16 v[80:83], v[148:151], v[144:147], v[80:83]
    v_mfma_f32_16x16x32_bf16 v[84:87], v[144:147], v[152:155], v[84:87]
    buffer_load_dwordx4 a[136:139], v2, s[4:7], s55 offen offset:0 sc1
    ds_read_b128 v[144:147], v10 offset:4096
    s_waitcnt vmcnt(26) lgkmcnt(7)
    v_mfma_f32_16x16x32_bf16 v[16:19], v[116:119], a[36:39], v[16:19]
    ds_read_b128 v[88:91], v3 offset:7168
    ds_read_b128 v[148:151], v4 offset:28672
    s_waitcnt vmcnt(25)
    v_mfma_f32_16x16x32_bf16 v[48:51], v[116:119], a[108:111], v[48:51]
    ds_read_b128 v[92:95], v3 offset:8192
    ds_read_b128 v[152:155], v5 offset:28672
    s_waitcnt lgkmcnt(10)
    v_mfma_f32_16x16x32_bf16 v[20:23], v[120:123], a[36:39], v[20:23]
    v_mfma_f32_16x16x32_bf16 v[52:55], v[120:123], a[108:111], v[52:55]
    buffer_load_dwordx4 a[68:71], v2, s[4:7], s54 offen offset:1024 sc1
    ds_read_b128 v[96:99], v3 offset:9216
    s_waitcnt lgkmcnt(10)
    v_mfma_f32_16x16x32_bf16 v[24:27], v[124:127], a[36:39], v[24:27]
    v_mfma_f32_16x16x32_bf16 v[56:59], v[124:127], a[108:111], v[56:59]
    ds_read_b128 v[100:103], v3 offset:10240
    s_waitcnt lgkmcnt(10)
    v_mfma_f32_16x16x32_bf16 v[28:31], v[128:131], a[36:39], v[28:31]
    v_mfma_f32_16x16x32_bf16 v[60:63], v[128:131], a[108:111], v[60:63]
    buffer_load_dwordx4 a[140:143], v2, s[4:7], s55 offen offset:1024 sc1
    ds_read_b128 v[112:115], v3 offset:13312
    s_waitcnt lgkmcnt(10)
    v_mfma_f32_16x16x32_bf16 v[32:35], v[140:143], a[36:39], v[32:35]
    v_mfma_f32_16x16x32_bf16 v[64:67], v[140:143], a[108:111], v[64:67]
    ds_read_b128 v[104:107], v3 offset:11264
    v_mfma_f32_16x16x32_bf16 v[44:47], a[36:39], v[140:143], v[44:47]
    v_mfma_f32_16x16x32_bf16 v[76:79], a[108:111], v[140:143], v[76:79]
    buffer_load_dwordx4 a[144:147], v232, s[16:19], s58 offen
    ds_read_b128 v[108:111], v3 offset:12288
    s_waitcnt lgkmcnt(11)
    v_mfma_f32_16x16x32_bf16 v[36:39], a[36:39], v[132:135], v[36:39]
    v_mfma_f32_16x16x32_bf16 v[68:71], a[108:111], v[132:135], v[68:71]
    s_waitcnt lgkmcnt(10)
    v_mfma_f32_16x16x32_bf16 v[40:43], a[36:39], v[136:139], v[40:43]
    v_mfma_f32_16x16x32_bf16 v[72:75], a[108:111], v[136:139], v[72:75]
    buffer_load_dwordx4 a[148:151], v233, s[16:19], s58 offen
    v_mfma_f32_16x16x32_bf16 v[80:83], v[160:163], v[156:159], v[80:83]
    v_mfma_f32_16x16x32_bf16 v[84:87], v[156:159], v[164:167], v[84:87]
    ds_read_b128 v[156:159], v10 offset:5120
    ds_read_b128 v[160:163], v4 offset:35840
    s_waitcnt vmcnt(28) lgkmcnt(10)
    v_mfma_f32_16x16x32_bf16 v[16:19], v[88:91], a[40:43], v[16:19]
    ds_read_b128 v[116:119], v3 offset:14336
    ds_read_b128 v[164:167], v5 offset:35840
    s_waitcnt vmcnt(27)
    v_mfma_f32_16x16x32_bf16 v[48:51], v[88:91], a[112:115], v[48:51]
    buffer_load_dwordx4 a[152:155], v234, s[16:19], s58 offen
    ds_read_b128 v[120:123], v3 offset:15360
    s_waitcnt lgkmcnt(11)
    v_mfma_f32_16x16x32_bf16 v[20:23], v[92:95], a[40:43], v[20:23]
    v_mfma_f32_16x16x32_bf16 v[52:55], v[92:95], a[112:115], v[52:55]
    ds_read_b128 v[124:127], v3 offset:16384
    s_waitcnt lgkmcnt(10)
    v_mfma_f32_16x16x32_bf16 v[24:27], v[96:99], a[40:43], v[24:27]
    v_mfma_f32_16x16x32_bf16 v[56:59], v[96:99], a[112:115], v[56:59]
    buffer_load_dwordx4 a[156:159], v235, s[16:19], s58 offen
    ds_read_b128 v[128:131], v3 offset:17408
    s_waitcnt lgkmcnt(10)
    v_mfma_f32_16x16x32_bf16 v[28:31], v[100:103], a[40:43], v[28:31]
    v_mfma_f32_16x16x32_bf16 v[60:63], v[100:103], a[112:115], v[60:63]
    ds_read_b128 v[140:143], v3 offset:20480
    s_waitcnt lgkmcnt(10)
    v_mfma_f32_16x16x32_bf16 v[32:35], v[112:115], a[40:43], v[32:35]
    v_mfma_f32_16x16x32_bf16 v[64:67], v[112:115], a[112:115], v[64:67]
    buffer_load_dwordx4 a[160:163], v236, s[16:19], s58 offen
    ds_read_b128 v[132:135], v3 offset:18432
    v_mfma_f32_16x16x32_bf16 v[44:47], a[40:43], v[112:115], v[44:47]
    v_mfma_f32_16x16x32_bf16 v[76:79], a[112:115], v[112:115], v[76:79]
    ds_read_b128 v[136:139], v3 offset:19456
    s_waitcnt lgkmcnt(11)
    v_mfma_f32_16x16x32_bf16 v[36:39], a[40:43], v[104:107], v[36:39]
    v_mfma_f32_16x16x32_bf16 v[68:71], a[112:115], v[104:107], v[68:71]
    buffer_load_dwordx4 a[164:167], v237, s[16:19], s58 offen
    s_waitcnt lgkmcnt(10)
    v_mfma_f32_16x16x32_bf16 v[40:43], a[40:43], v[108:111], v[40:43]
    v_mfma_f32_16x16x32_bf16 v[72:75], a[112:115], v[108:111], v[72:75]
    v_mfma_f32_16x16x32_bf16 v[80:83], v[148:151], v[144:147], v[80:83]
    v_mfma_f32_16x16x32_bf16 v[84:87], v[144:147], v[152:155], v[84:87]
    buffer_load_dwordx4 a[168:171], v238, s[16:19], s58 offen
    ds_read_b128 v[144:147], v10 offset:6144
    s_waitcnt vmcnt(31) lgkmcnt(8)
    v_mfma_f32_16x16x32_bf16 v[16:19], v[116:119], a[44:47], v[16:19]
    s_waitcnt vmcnt(19)
    s_barrier
    v_mfma_f32_16x16x32_bf16 v[48:51], v[116:119], a[116:119], v[48:51]
    ds_read_b128 v[88:91], v3 offset:21504
    ds_read_b128 v[92:95], v3 offset:22528
    s_waitcnt lgkmcnt(8)
    v_mfma_f32_16x16x32_bf16 v[20:23], v[120:123], a[44:47], v[20:23]
    ds_read_b128 v[148:151], v4 offset:43008
    ds_read_b128 v[152:155], v5 offset:43008
    v_mfma_f32_16x16x32_bf16 v[52:55], v[120:123], a[116:119], v[52:55]
    buffer_load_dwordx4 a[172:175], v239, s[16:19], s58 offen
    ds_read_b128 v[96:99], v3 offset:23552
    s_waitcnt lgkmcnt(10)
    v_mfma_f32_16x16x32_bf16 v[24:27], v[124:127], a[44:47], v[24:27]
    v_mfma_f32_16x16x32_bf16 v[56:59], v[124:127], a[116:119], v[56:59]
    ds_read_b128 v[100:103], v3 offset:24576
    s_waitcnt lgkmcnt(10)
    v_mfma_f32_16x16x32_bf16 v[28:31], v[128:131], a[44:47], v[28:31]
    v_mfma_f32_16x16x32_bf16 v[60:63], v[128:131], a[116:119], v[60:63]
    buffer_load_dwordx4 a[176:179], v240, s[16:19], s58 offen
    ds_read_b128 v[112:115], v3 offset:27648
    s_waitcnt lgkmcnt(10)
    v_mfma_f32_16x16x32_bf16 v[32:35], v[140:143], a[44:47], v[32:35]
    v_mfma_f32_16x16x32_bf16 v[64:67], v[140:143], a[116:119], v[64:67]
    ds_read_b128 v[104:107], v3 offset:25600
    v_mfma_f32_16x16x32_bf16 v[44:47], a[44:47], v[140:143], v[44:47]
    v_mfma_f32_16x16x32_bf16 v[76:79], a[116:119], v[140:143], v[76:79]
    s_cmp_lt_u32 s22, 24
    s_cbranch_scc1 L_no2_16
    s_cmp_ge_u32 s20, 2
    s_cbranch_scc1 L_no2_16
    buffer_load_dwordx4 a[180:183], v232, s[12:15], s62 offen
    buffer_load_dwordx4 a[184:187], v233, s[12:15], s62 offen
    buffer_load_dwordx4 a[188:191], v234, s[12:15], s62 offen
    buffer_load_dwordx4 a[192:195], v235, s[12:15], s62 offen
    buffer_load_dwordx4 a[196:199], v236, s[12:15], s62 offen
    buffer_load_dwordx4 a[200:203], v237, s[12:15], s62 offen
    buffer_load_dwordx4 a[204:207], v238, s[12:15], s62 offen
    buffer_load_dwordx4 a[208:211], v239, s[12:15], s62 offen
    buffer_load_dwordx4 a[212:215], v240, s[12:15], s62 offen
L_no2_16:
    ds_read_b128 v[108:111], v3 offset:26624
    s_waitcnt lgkmcnt(11)
    v_mfma_f32_16x16x32_bf16 v[36:39], a[44:47], v[132:135], v[36:39]
    v_mfma_f32_16x16x32_bf16 v[68:71], a[116:119], v[132:135], v[68:71]
    s_waitcnt lgkmcnt(10)
    v_mfma_f32_16x16x32_bf16 v[40:43], a[44:47], v[136:139], v[40:43]
    v_mfma_f32_16x16x32_bf16 v[72:75], a[116:119], v[136:139], v[72:75]
    v_mfma_f32_16x16x32_bf16 v[80:83], v[160:163], v[156:159], v[80:83]
    v_mfma_f32_16x16x32_bf16 v[84:87], v[156:159], v[164:167], v[84:87]
    ds_read_b128 v[156:159], v10 offset:7168
    ds_read_b128 v[160:163], v4 offset:50176
    s_waitcnt vmcnt(20) lgkmcnt(10)
    v_mfma_f32_16x16x32_bf16 v[16:19], v[88:91], a[48:51], v[16:19]
    ds_read_b128 v[164:167], v5 offset:50176
    ds_read_b128 v[116:119], v3 offset:28672
    s_waitcnt vmcnt(19)
    v_mfma_f32_16x16x32_bf16 v[48:51], v[88:91], a[120:123], v[48:51]
    ds_read_b128 v[120:123], v3 offset:29696
    s_waitcnt lgkmcnt(12)
    v_mfma_f32_16x16x32_bf16 v[20:23], v[92:95], a[48:51], v[20:23]
    v_mfma_f32_16x16x32_bf16 v[52:55], v[92:95], a[120:123], v[52:55]
    ds_read_b128 v[124:127], v3 offset:30720
    s_waitcnt lgkmcnt(10)
    v_mfma_f32_16x16x32_bf16 v[24:27], v[96:99], a[48:51], v[24:27]
    v_mfma_f32_16x16x32_bf16 v[56:59], v[96:99], a[120:123], v[56:59]
    ds_read_b128 v[128:131], v3 offset:31744
    s_waitcnt lgkmcnt(10)
    v_mfma_f32_16x16x32_bf16 v[28:31], v[100:103], a[48:51], v[28:31]
    v_mfma_f32_16x16x32_bf16 v[60:63], v[100:103], a[120:123], v[60:63]
    ds_read_b128 v[140:143], v3 offset:34816
    v_mfma_f32_16x16x32_bf16 v[80:83], v[148:151], v[144:147], v[80:83]
    v_mfma_f32_16x16x32_bf16 v[84:87], v[144:147], v[152:155], v[84:87]
    ds_read_b128 v[132:135], v3 offset:32768
    ds_read_b128 v[144:147], v10 offset:8192
    s_waitcnt lgkmcnt(12)
    v_mfma_f32_16x16x32_bf16 v[32:35], v[112:115], a[48:51], v[32:35]
    ds_read_b128 v[148:151], v4 offset:57344
    ds_read_b128 v[152:155], v5 offset:57344
    v_mfma_f32_16x16x32_bf16 v[64:67], v[112:115], a[120:123], v[64:67]
    ds_read_b128 v[136:139], v3 offset:33792
    v_mfma_f32_16x16x32_bf16 v[44:47], a[48:51], v[112:115], v[44:47]
    v_mfma_f32_16x16x32_bf16 v[76:79], a[120:123], v[112:115], v[76:79]
    s_waitcnt lgkmcnt(14)
    v_mfma_f32_16x16x32_bf16 v[36:39], a[48:51], v[104:107], v[36:39]
    v_mfma_f32_16x16x32_bf16 v[68:71], a[120:123], v[104:107], v[68:71]
    s_waitcnt lgkmcnt(13)
    v_mfma_f32_16x16x32_bf16 v[40:43], a[48:51], v[108:111], v[40:43]
    v_mfma_f32_16x16x32_bf16 v[72:75], a[120:123], v[108:111], v[72:75]
    s_waitcnt lgkmcnt(11)
    v_mfma_f32_16x16x32_bf16 v[80:83], v[160:163], v[156:159], v[80:83]
    s_waitcnt lgkmcnt(10)
    v_mfma_f32_16x16x32_bf16 v[84:87], v[156:159], v[164:167], v[84:87]
    v_add_u32 v4, 64512, v4
    v_add_u32 v5, 64512, v5
    s_waitcnt vmcnt(18) lgkmcnt(9)
    v_mfma_f32_16x16x32_bf16 v[16:19], v[116:119], a[52:55], v[16:19]
    ds_read_b128 v[156:159], v10 offset:9216
    ds_read_b128 v[160:163], v4 offset:0
    s_waitcnt vmcnt(17)
    v_mfma_f32_16x16x32_bf16 v[48:51], v[116:119], a[124:127], v[48:51]
    ds_read_b128 v[164:167], v5 offset:0
    ds_read_b128 v[88:91], v3 offset:35840
    s_waitcnt lgkmcnt(12)
    v_mfma_f32_16x16x32_bf16 v[20:23], v[120:123], a[52:55], v[20:23]
    ds_read_b128 v[92:95], v3 offset:36864
    v_mfma_f32_16x16x32_bf16 v[52:55], v[120:123], a[124:127], v[52:55]
    ds_read_b128 v[96:99], v3 offset:37888
    s_waitcnt lgkmcnt(13)
    v_mfma_f32_16x16x32_bf16 v[24:27], v[124:127], a[52:55], v[24:27]
    v_mfma_f32_16x16x32_bf16 v[56:59], v[124:127], a[124:127], v[56:59]
    ds_read_b128 v[100:103], v3 offset:38912
    s_waitcnt lgkmcnt(13)
    v_mfma_f32_16x16x32_bf16 v[28:31], v[128:131], a[52:55], v[28:31]
    v_mfma_f32_16x16x32_bf16 v[60:63], v[128:131], a[124:127], v[60:63]
    ds_read_b128 v[112:115], v3 offset:41984
    s_waitcnt lgkmcnt(10)
    v_mfma_f32_16x16x32_bf16 v[80:83], v[148:151], v[144:147], v[80:83]
    s_waitcnt lgkmcnt(9)
    v_mfma_f32_16x16x32_bf16 v[84:87], v[144:147], v[152:155], v[84:87]
    ds_read_b128 v[104:107], v3 offset:39936
    ds_read_b128 v[144:147], v10 offset:10240
    v_mfma_f32_16x16x32_bf16 v[32:35], v[140:143], a[52:55], v[32:35]
    ds_read_b128 v[148:151], v4 offset:7168
    ds_read_b128 v[152:155], v5 offset:7168
    v_mfma_f32_16x16x32_bf16 v[64:67], v[140:143], a[124:127], v[64:67]
    ds_read_b128 v[108:111], v3 offset:40960
    v_mfma_f32_16x16x32_bf16 v[44:47], a[52:55], v[140:143], v[44:47]
    v_mfma_f32_16x16x32_bf16 v[76:79], a[124:127], v[140:143], v[76:79]
    v_mfma_f32_16x16x32_bf16 v[36:39], a[52:55], v[132:135], v[36:39]
    v_mfma_f32_16x16x32_bf16 v[68:71], a[124:127], v[132:135], v[68:71]
    s_waitcnt lgkmcnt(13)
    v_mfma_f32_16x16x32_bf16 v[40:43], a[52:55], v[136:139], v[40:43]
    v_mfma_f32_16x16x32_bf16 v[72:75], a[124:127], v[136:139], v[72:75]
    s_waitcnt lgkmcnt(11)
    v_mfma_f32_16x16x32_bf16 v[80:83], v[160:163], v[156:159], v[80:83]
    s_waitcnt lgkmcnt(10)
    v_mfma_f32_16x16x32_bf16 v[84:87], v[156:159], v[164:167], v[84:87]
    ds_read_b128 v[156:159], v10 offset:11264
    ds_read_b128 v[160:163], v4 offset:14336
    s_waitcnt vmcnt(16) lgkmcnt(11)
    v_mfma_f32_16x16x32_bf16 v[16:19], v[88:91], a[56:59], v[16:19]
    ds_read_b128 v[164:167], v5 offset:14336
    ds_read_b128 v[116:119], v3 offset:43008
    s_waitcnt vmcnt(15)
    v_mfma_f32_16x16x32_bf16 v[48:51], v[88:91], a[128:131], v[48:51]
    ds_read_b128 v[120:123], v3 offset:44032
    s_waitcnt lgkmcnt(13)
    v_mfma_f32_16x16x32_bf16 v[20:23], v[92:95], a[56:59], v[20:23]
    v_mfma_f32_16x16x32_bf16 v[52:55], v[92:95], a[128:131], v[52:55]
    ds_read_b128 v[124:127], v3 offset:45056
    s_waitcnt lgkmcnt(13)
    v_mfma_f32_16x16x32_bf16 v[24:27], v[96:99], a[56:59], v[24:27]
    v_mfma_f32_16x16x32_bf16 v[56:59], v[96:99], a[128:131], v[56:59]
    ds_read_b128 v[128:131], v3 offset:46080
    s_waitcnt lgkmcnt(13)
    v_mfma_f32_16x16x32_bf16 v[28:31], v[100:103], a[56:59], v[28:31]
    v_mfma_f32_16x16x32_bf16 v[60:63], v[100:103], a[128:131], v[60:63]
    ds_read_b128 v[140:143], v3 offset:49152
    s_waitcnt lgkmcnt(10)
    v_mfma_f32_16x16x32_bf16 v[80:83], v[148:151], v[144:147], v[80:83]
    s_waitcnt lgkmcnt(9)
    v_mfma_f32_16x16x32_bf16 v[84:87], v[144:147], v[152:155], v[84:87]
    ds_read_b128 v[132:135], v3 offset:47104
    ds_read_b128 v[144:147], v10 offset:12288
    v_mfma_f32_16x16x32_bf16 v[32:35], v[112:115], a[56:59], v[32:35]
    ds_read_b128 v[148:151], v4 offset:21504
    ds_read_b128 v[152:155], v5 offset:21504
    v_mfma_f32_16x16x32_bf16 v[64:67], v[112:115], a[128:131], v[64:67]
    ds_read_b128 v[136:139], v3 offset:48128
    v_mfma_f32_16x16x32_bf16 v[44:47], a[56:59], v[112:115], v[44:47]
    v_mfma_f32_16x16x32_bf16 v[76:79], a[128:131], v[112:115], v[76:79]
    v_mfma_f32_16x16x32_bf16 v[36:39], a[56:59], v[104:107], v[36:39]
    v_mfma_f32_16x16x32_bf16 v[68:71], a[128:131], v[104:107], v[68:71]
    s_waitcnt lgkmcnt(13)
    v_mfma_f32_16x16x32_bf16 v[40:43], a[56:59], v[108:111], v[40:43]
    v_mfma_f32_16x16x32_bf16 v[72:75], a[128:131], v[108:111], v[72:75]
    s_waitcnt lgkmcnt(11)
    v_mfma_f32_16x16x32_bf16 v[80:83], v[160:163], v[156:159], v[80:83]
    s_waitcnt lgkmcnt(10)
    v_mfma_f32_16x16x32_bf16 v[84:87], v[156:159], v[164:167], v[84:87]
    ds_read_b128 v[156:159], v10 offset:13312
    ds_read_b128 v[160:163], v4 offset:28672
    s_waitcnt vmcnt(14) lgkmcnt(11)
    v_mfma_f32_16x16x32_bf16 v[16:19], v[116:119], a[60:63], v[16:19]
    ds_read_b128 v[164:167], v5 offset:28672
    ds_read_b128 v[88:91], v3 offset:50176
    s_waitcnt vmcnt(13)
    v_mfma_f32_16x16x32_bf16 v[48:51], v[116:119], a[132:135], v[48:51]
    ds_read_b128 v[92:95], v3 offset:51200
    s_waitcnt lgkmcnt(13)
    v_mfma_f32_16x16x32_bf16 v[20:23], v[120:123], a[60:63], v[20:23]
    v_mfma_f32_16x16x32_bf16 v[52:55], v[120:123], a[132:135], v[52:55]
    ds_read_b128 v[96:99], v3 offset:52224
    s_waitcnt lgkmcnt(13)
    v_mfma_f32_16x16x32_bf16 v[24:27], v[124:127], a[60:63], v[24:27]
    v_mfma_f32_16x16x32_bf16 v[56:59], v[124:127], a[132:135], v[56:59]
    ds_read_b128 v[100:103], v3 offset:53248
    s_waitcnt lgkmcnt(13)
    v_mfma_f32_16x16x32_bf16 v[28:31], v[128:131], a[60:63], v[28:31]
    v_mfma_f32_16x16x32_bf16 v[60:63], v[128:131], a[132:135], v[60:63]
    ds_read_b128 v[112:115], v3 offset:56320
    s_waitcnt lgkmcnt(10)
    v_mfma_f32_16x16x32_bf16 v[80:83], v[148:151], v[144:147], v[80:83]
    s_waitcnt lgkmcnt(9)
    v_mfma_f32_16x16x32_bf16 v[84:87], v[144:147], v[152:155], v[84:87]
    ds_read_b128 v[104:107], v3 offset:54272
    ds_read_b128 v[144:147], v10 offset:14336
    v_mfma_f32_16x16x32_bf16 v[32:35], v[140:143], a[60:63], v[32:35]
    ds_read_b128 v[148:151], v4 offset:35840
    ds_read_b128 v[152:155], v5 offset:35840
    v_mfma_f32_16x16x32_bf16 v[64:67], v[140:143], a[132:135], v[64:67]
    ds_read_b128 v[108:111], v3 offset:55296
    v_mfma_f32_16x16x32_bf16 v[44:47], a[60:63], v[140:143], v[44:47]
    v_mfma_f32_16x16x32_bf16 v[76:79], a[132:135], v[140:143], v[76:79]
    v_mfma_f32_16x16x32_bf16 v[36:39], a[60:63], v[132:135], v[36:39]
    v_mfma_f32_16x16x32_bf16 v[68:71], a[132:135], v[132:135], v[68:71]
    s_waitcnt lgkmcnt(13)
    v_mfma_f32_16x16x32_bf16 v[40:43], a[60:63], v[136:139], v[40:43]
    v_mfma_f32_16x16x32_bf16 v[72:75], a[132:135], v[136:139], v[72:75]
    s_waitcnt lgkmcnt(11)
    v_mfma_f32_16x16x32_bf16 v[80:83], v[160:163], v[156:159], v[80:83]
    s_waitcnt lgkmcnt(10)
    v_mfma_f32_16x16x32_bf16 v[84:87], v[156:159], v[164:167], v[84:87]
    ds_read_b128 v[156:159], v10 offset:15360
    ds_read_b128 v[160:163], v4 offset:43008
    s_waitcnt vmcnt(12) lgkmcnt(11)
    v_mfma_f32_16x16x32_bf16 v[16:19], v[88:91], a[64:67], v[16:19]
    ds_read_b128 v[164:167], v5 offset:43008
    ds_read_b128 v[116:119], v3 offset:57344
    s_waitcnt vmcnt(11)
    v_mfma_f32_16x16x32_bf16 v[48:51], v[88:91], a[136:139], v[48:51]
    ds_read_b128 v[120:123], v3 offset:58368
    s_waitcnt lgkmcnt(13)
    v_mfma_f32_16x16x32_bf16 v[20:23], v[92:95], a[64:67], v[20:23]
    v_mfma_f32_16x16x32_bf16 v[52:55], v[92:95], a[136:139], v[52:55]
    ds_read_b128 v[124:127], v3 offset:59392
    s_waitcnt lgkmcnt(13)
    v_mfma_f32_16x16x32_bf16 v[24:27], v[96:99], a[64:67], v[24:27]
    v_mfma_f32_16x16x32_bf16 v[56:59], v[96:99], a[136:139], v[56:59]
    ds_read_b128 v[128:131], v3 offset:60416
    s_waitcnt lgkmcnt(13)
    v_mfma_f32_16x16x32_bf16 v[28:31], v[100:103], a[64:67], v[28:31]
    v_mfma_f32_16x16x32_bf16 v[60:63], v[100:103], a[136:139], v[60:63]
    ds_read_b128 v[140:143], v3 offset:63488
    s_waitcnt lgkmcnt(10)
    v_mfma_f32_16x16x32_bf16 v[80:83], v[148:151], v[144:147], v[80:83]
    s_waitcnt lgkmcnt(9)
    v_mfma_f32_16x16x32_bf16 v[84:87], v[144:147], v[152:155], v[84:87]
    ds_read_b128 v[132:135], v3 offset:61440
    ds_read_b128 v[144:147], v10 offset:16384
    v_mfma_f32_16x16x32_bf16 v[32:35], v[112:115], a[64:67], v[32:35]
    ds_read_b128 v[148:151], v4 offset:50176
    ds_read_b128 v[152:155], v5 offset:50176
    v_mfma_f32_16x16x32_bf16 v[64:67], v[112:115], a[136:139], v[64:67]
    ds_read_b128 v[136:139], v3 offset:62464
    v_mfma_f32_16x16x32_bf16 v[44:47], a[64:67], v[112:115], v[44:47]
    v_mfma_f32_16x16x32_bf16 v[76:79], a[136:139], v[112:115], v[76:79]
    v_mfma_f32_16x16x32_bf16 v[36:39], a[64:67], v[104:107], v[36:39]
    v_mfma_f32_16x16x32_bf16 v[68:71], a[136:139], v[104:107], v[68:71]
    s_waitcnt lgkmcnt(13)
    v_mfma_f32_16x16x32_bf16 v[40:43], a[64:67], v[108:111], v[40:43]
    v_mfma_f32_16x16x32_bf16 v[72:75], a[136:139], v[108:111], v[72:75]
    s_waitcnt lgkmcnt(11)
    v_mfma_f32_16x16x32_bf16 v[80:83], v[160:163], v[156:159], v[80:83]
    s_waitcnt lgkmcnt(10)
    v_mfma_f32_16x16x32_bf16 v[84:87], v[156:159], v[164:167], v[84:87]
    ds_read_b128 v[156:159], v10 offset:17408
    ds_read_b128 v[160:163], v4 offset:57344
    s_waitcnt vmcnt(10) lgkmcnt(11)
    v_mfma_f32_16x16x32_bf16 v[16:19], v[116:119], a[68:71], v[16:19]
    ds_read_b128 v[164:167], v5 offset:57344
    s_waitcnt vmcnt(9)
    v_mfma_f32_16x16x32_bf16 v[48:51], v[116:119], a[140:143], v[48:51]
    s_waitcnt lgkmcnt(11)
    v_mfma_f32_16x16x32_bf16 v[20:23], v[120:123], a[68:71], v[20:23]
    v_mfma_f32_16x16x32_bf16 v[52:55], v[120:123], a[140:143], v[52:55]
    s_waitcnt lgkmcnt(10)
    v_mfma_f32_16x16x32_bf16 v[24:27], v[124:127], a[68:71], v[24:27]
    v_mfma_f32_16x16x32_bf16 v[56:59], v[124:127], a[140:143], v[56:59]
    s_waitcnt lgkmcnt(9)
    v_mfma_f32_16x16x32_bf16 v[28:31], v[128:131], a[68:71], v[28:31]
    v_mfma_f32_16x16x32_bf16 v[60:63], v[128:131], a[140:143], v[60:63]
    s_waitcnt lgkmcnt(5)
    v_mfma_f32_16x16x32_bf16 v[80:83], v[148:151], v[144:147], v[80:83]
    s_waitcnt lgkmcnt(4)
    v_mfma_f32_16x16x32_bf16 v[84:87], v[144:147], v[152:155], v[84:87]
    v_mfma_f32_16x16x32_bf16 v[32:35], v[140:143], a[68:71], v[32:35]
    v_mfma_f32_16x16x32_bf16 v[64:67], v[140:143], a[140:143], v[64:67]
    v_mfma_f32_16x16x32_bf16 v[44:47], a[68:71], v[140:143], v[44:47]
    v_mfma_f32_16x16x32_bf16 v[76:79], a[140:143], v[140:143], v[76:79]
    v_mfma_f32_16x16x32_bf16 v[36:39], a[68:71], v[132:135], v[36:39]
    v_mfma_f32_16x16x32_bf16 v[68:71], a[140:143], v[132:135], v[68:71]
    s_waitcnt lgkmcnt(3)
    v_mfma_f32_16x16x32_bf16 v[40:43], a[68:71], v[136:139], v[40:43]
    v_mfma_f32_16x16x32_bf16 v[72:75], a[140:143], v[136:139], v[72:75]
    s_waitcnt lgkmcnt(1)
    v_mfma_f32_16x16x32_bf16 v[80:83], v[160:163], v[156:159], v[80:83]
    s_waitcnt lgkmcnt(0)
    v_mfma_f32_16x16x32_bf16 v[84:87], v[156:159], v[164:167], v[84:87]
    v_lshlrev_b32 v6, 3, v1
    v_add_u32 v6, 148608, v6
    s_mul_i32 s52, s20, 3072
    v_add_u32 v7, s52, v6
    v_cvt_pk_bf16_f32 v100, v56, v57
    v_cvt_pk_bf16_f32 v101, v58, v59
    v_cvt_pk_bf16_f32 v104, v60, v61
    v_cvt_pk_bf16_f32 v105, v62, v63
    v_cvt_pk_bf16_f32 v134, v64, v65
    v_cvt_pk_bf16_f32 v137, v66, v67
    v_mov_b32 v102, 0
    v_mov_b32 v103, 0
    v_cvt_pk_bf16_f32 v110, v68, v69
    v_cvt_pk_bf16_f32 v111, v70, v71
    v_cvt_pk_bf16_f32 v116, v72, v73
    v_cvt_pk_bf16_f32 v117, v74, v75
    v_cvt_pk_bf16_f32 v122, v76, v77
    v_cvt_pk_bf16_f32 v123, v78, v79
    v_permlane32_swap_b32 v134, v102
    v_permlane32_swap_b32 v137, v103
    s_cmp_eq_u32 s20, 3
    s_cbranch_scc1 L_w3_20
    ds_write_b64 v7, v[100:101] offset:3072
    ds_write_b64 v7, v[102:103] offset:3584
    ds_write_b64 v7, v[104:105] offset:4096
    ds_write_b64 v7, v[110:111] offset:4608
    ds_write_b64 v7, v[116:117] offset:5120
    ds_write_b64 v7, v[122:123] offset:5632
L_w3_20:
    v_cvt_pk_bf16_f32 v140, v80, v81
    v_cvt_pk_bf16_f32 v141, v82, v83
    v_cvt_pk_bf16_f32 v142, v84, v85
    v_cvt_pk_bf16_f32 v143, v86, v87
    s_min_u32 s52, s20, 2
    s_lshl_b32 s53, s52, 1
    s_cmp_ge_u32 s20, 2
    s_cselect_b32 s53, 1, s53
    s_lshl_b32 s53, s53, 9
    s_add_u32 s52, s52, 3
    s_lshl_b32 s52, s52, 9
    v_add_u32 v8, s53, v6
    v_add_u32 v9, s52, v6
    s_cmp_lt_u32 s20, 2
    s_cbranch_scc1 L_noswap_21
    v_mov_b32 v10, 0
    v_mov_b32 v11, 0
    s_nop 1
    v_permlane32_swap_b32 v140, v10
    v_permlane32_swap_b32 v141, v11
    v_mov_b32 v140, v10
    v_mov_b32 v141, v11
L_noswap_21:
    ds_write_b64 v8, v[140:141]
    ds_write_b64 v9, v[142:143]
    v_cvt_pk_bf16_f32 v132, v48, v49
    v_cvt_pk_bf16_f32 v133, v50, v51
    v_cvt_pk_bf16_f32 v138, v52, v53
    v_cvt_pk_bf16_f32 v139, v54, v55
    v_mov_b32 v135, 0
    v_mov_b32 v136, 0
    v_cvt_pk_bf16_f32 v94, v24, v25
    v_cvt_pk_bf16_f32 v95, v26, v27
    v_cvt_pk_bf16_f32 v98, v28, v29
    v_cvt_pk_bf16_f32 v99, v30, v31
    v_cvt_pk_bf16_f32 v126, v32, v33
    v_cvt_pk_bf16_f32 v129, v34, v35
    v_mov_b32 v96, 0
    v_mov_b32 v97, 0
    v_cvt_pk_bf16_f32 v108, v36, v37
    v_cvt_pk_bf16_f32 v109, v38, v39
    v_cvt_pk_bf16_f32 v114, v40, v41
    v_cvt_pk_bf16_f32 v115, v42, v43
    v_cvt_pk_bf16_f32 v120, v44, v45
    v_cvt_pk_bf16_f32 v121, v46, v47
    v_permlane32_swap_b32 v126, v96
    v_permlane32_swap_b32 v129, v97
    v_cvt_pk_bf16_f32 v124, v16, v17
    v_cvt_pk_bf16_f32 v125, v18, v19
    v_cvt_pk_bf16_f32 v130, v20, v21
    v_cvt_pk_bf16_f32 v131, v22, v23
    v_mov_b32 v127, 0
    v_mov_b32 v128, 0
    v_mov_b32 v12, 0x3f803f80
    v_mov_b32 v13, 0x3f803f80
    v_mov_b32 v14, 0x3f803f80
    v_mov_b32 v15, 0x3f803f80
    v_mfma_f32_16x16x32_bf16 v[32:35], v[94:97], v[132:135], v[172:175]
    v_mfma_f32_16x16x32_bf16 v[36:39], v[100:103], v[132:135], v[168:171]
    v_mfma_f32_16x16x32_bf16 v[20:23], v[94:97], v[124:127], v[168:171]
    v_mfma_f32_16x16x32_bf16 v[40:43], v[96:99], v[136:139], v[172:175]
    v_mfma_f32_16x16x32_bf16 v[44:47], v[102:105], v[136:139], v[168:171]
    v_mfma_f32_16x16x32_bf16 v[28:31], v[96:99], v[128:131], v[168:171]
    s_waitcnt lgkmcnt(0)
    s_barrier
    ds_read_b64 v[88:89], v7 offset:0
    ds_read_b64 v[90:91], v7 offset:512
    ds_read_b64 v[92:93], v7 offset:1024
    ds_read_b64 v[106:107], v7 offset:1536
    ds_read_b64 v[112:113], v7 offset:2048
    ds_read_b64 v[118:119], v7 offset:2560
    s_mov_b32 s52, 0x3eae1a93
    s_waitcnt lgkmcnt(4)
    v_mfma_f32_16x16x32_bf16 v[16:19], v[88:91], v[124:127], v[176:179]
    s_waitcnt lgkmcnt(3)
    v_mfma_f32_16x16x32_bf16 v[24:27], v[90:93], v[128:131], v[176:179]
    v_max3_f32 v48, v32, v33, v34
    v_max3_f32 v49, v40, v41, v42
    s_nop 3
    v_max3_f32 v50, v16, v17, v18
    s_nop 0
    v_max3_f32 v51, v24, v25, v26
    v_max3_f32 v48, v48, v35, v36
    v_max3_f32 v49, v49, v43, v44
    v_max3_f32 v50, v50, v19, v20
    v_max3_f32 v51, v51, v27, v28
    v_max3_f32 v48, v48, v37, v38
    v_max3_f32 v49, v49, v45, v46
    v_max3_f32 v50, v50, v21, v22
    v_max3_f32 v51, v51, v29, v30
    v_max_f32 v48, v48, v39
    v_max_f32 v49, v49, v47
    v_max_f32 v50, v50, v23
    v_max_f32 v51, v51, v31
    v_mov_b32 v52, v48
    v_mov_b32 v53, v49
    v_mov_b32 v54, v50
    v_mov_b32 v55, v51
    v_permlane16_swap_b32 v48, v52
    v_permlane16_swap_b32 v49, v53
    v_permlane16_swap_b32 v50, v54
    v_permlane16_swap_b32 v51, v55
    v_max_f32 v48, v48, v52
    v_max_f32 v49, v49, v53
    v_max_f32 v50, v50, v54
    v_max_f32 v51, v51, v55
    v_mov_b32 v52, v48
    v_mov_b32 v53, v49
    v_mov_b32 v54, v50
    v_mov_b32 v55, v51
    v_permlane32_swap_b32 v48, v52
    v_permlane32_swap_b32 v49, v53
    v_permlane32_swap_b32 v50, v54
    v_permlane32_swap_b32 v51, v55
    v_max_f32 v48, v48, v52
    v_max_f32 v49, v49, v53
    v_max_f32 v50, v50, v54
    v_max_f32 v51, v51, v55
    v_mul_f32 v48, s52, v48
    v_mul_f32 v49, s52, v49
    v_mul_f32 v50, s52, v50
    v_mul_f32 v51, s52, v51
    v_fma_f32 v32, v32, s52, -v48
    v_fma_f32 v40, v40, s52, -v49
    v_fma_f32 v16, v16, s52, -v50
    v_fma_f32 v24, v24, s52, -v51
    v_fma_f32 v33, v33, s52, -v48
    v_fma_f32 v41, v41, s52, -v49
    v_fma_f32 v17, v17, s52, -v50
    v_fma_f32 v25, v25, s52, -v51
    v_fma_f32 v34, v34, s52, -v48
    v_fma_f32 v42, v42, s52, -v49
    v_fma_f32 v18, v18, s52, -v50
    v_fma_f32 v26, v26, s52, -v51
    v_fma_f32 v35, v35, s52, -v48
    v_fma_f32 v43, v43, s52, -v49
    v_fma_f32 v19, v19, s52, -v50
    v_fma_f32 v27, v27, s52, -v51
    v_fma_f32 v36, v36, s52, -v48
    v_fma_f32 v44, v44, s52, -v49
    v_fma_f32 v20, v20, s52, -v50
    v_fma_f32 v28, v28, s52, -v51
    v_fma_f32 v37, v37, s52, -v48
    v_fma_f32 v45, v45, s52, -v49
    v_fma_f32 v21, v21, s52, -v50
    v_fma_f32 v29, v29, s52, -v51
    v_fma_f32 v38, v38, s52, -v48
    v_fma_f32 v46, v46, s52, -v49
    v_fma_f32 v22, v22, s52, -v50
    v_fma_f32 v30, v30, s52, -v51
    v_fma_f32 v39, v39, s52, -v48
    v_fma_f32 v47, v47, s52, -v49
    v_fma_f32 v23, v23, s52, -v50
    v_fma_f32 v31, v31, s52, -v51
    v_exp_f32 v32, v32
    v_exp_f32 v40, v40
    v_exp_f32 v16, v16
    v_exp_f32 v24, v24
    v_exp_f32 v33, v33
    v_exp_f32 v41, v41
    v_exp_f32 v17, v17
    v_exp_f32 v25, v25
    v_exp_f32 v34, v34
    v_exp_f32 v42, v42
    v_exp_f32 v18, v18
    v_exp_f32 v26, v26
    v_exp_f32 v35, v35
    v_exp_f32 v43, v43
    v_exp_f32 v19, v19
    v_exp_f32 v27, v27
    v_exp_f32 v36, v36
    v_exp_f32 v44, v44
    v_exp_f32 v20, v20
    v_exp_f32 v28, v28
    v_exp_f32 v37, v37
    v_exp_f32 v45, v45
    v_exp_f32 v21, v21
    v_exp_f32 v29, v29
    v_exp_f32 v38, v38
    v_exp_f32 v46, v46
    v_exp_f32 v22, v22
    v_exp_f32 v30, v30
    v_exp_f32 v39, v39
    v_exp_f32 v47, v47
    v_exp_f32 v23, v23
    v_exp_f32 v31, v31
    v_cvt_pk_bf16_f32 v56, v32, v33
    v_cvt_pk_bf16_f32 v60, v40, v41
    v_cvt_pk_bf16_f32 v64, v16, v17
    v_cvt_pk_bf16_f32 v68, v24, v25
    v_cvt_pk_bf16_f32 v57, v34, v35
    v_cvt_pk_bf16_f32 v61, v42, v43
    v_cvt_pk_bf16_f32 v65, v18, v19
    v_cvt_pk_bf16_f32 v69, v26, v27
    v_cvt_pk_bf16_f32 v58, v36, v37
    v_cvt_pk_bf16_f32 v62, v44, v45
    v_cvt_pk_bf16_f32 v66, v20, v21
    v_cvt_pk_bf16_f32 v70, v28, v29
    v_cvt_pk_bf16_f32 v59, v38, v39
    v_cvt_pk_bf16_f32 v63, v46, v47
    v_cvt_pk_bf16_f32 v67, v22, v23
    v_cvt_pk_bf16_f32 v71, v30, v31
    v_mfma_f32_16x16x32_bf16 v[188:191], v[12:15], v[56:59], 0
    v_mfma_f32_16x16x32_bf16 v[180:183], v[108:111], v[56:59], 0
    v_mfma_f32_16x16x32_bf16 v[184:187], v[120:123], v[56:59], 0
    v_mfma_f32_16x16x32_bf16 v[200:203], v[12:15], v[60:63], 0
    v_mfma_f32_16x16x32_bf16 v[192:195], v[114:117], v[60:63], 0
    v_mfma_f32_16x16x32_bf16 v[196:199], v[120:123], v[60:63], 0
    v_mfma_f32_16x16x32_bf16 v[212:215], v[12:15], v[64:67], 0
    s_waitcnt lgkmcnt(2)
    v_mfma_f32_16x16x32_bf16 v[204:207], v[106:109], v[64:67], 0
    s_waitcnt lgkmcnt(0)
    v_mfma_f32_16x16x32_bf16 v[208:211], v[118:121], v[64:67], 0
    v_mfma_f32_16x16x32_bf16 v[224:227], v[12:15], v[68:71], 0
    v_mfma_f32_16x16x32_bf16 v[216:219], v[112:115], v[68:71], 0
    v_mfma_f32_16x16x32_bf16 v[220:223], v[118:121], v[68:71], 0
    s_lshl_b32 s53, s46, 4
    s_add_u32 s53, s53, s45
    s_lshl_b32 s54, s53, 10
    s_add_u32 s54, s54, 23330816
    s_lshl_b32 s55, s53, 7
    s_add_u32 s55, s55, 25427840
    v_lshlrev_b32 v6, 3, v1
    v_rcp_f32 v188, v188
    v_rcp_f32 v200, v200
    v_rcp_f32 v212, v212
    v_rcp_f32 v224, v224
    v_mul_f32 v180, v180, v188
    v_mul_f32 v181, v181, v188
    v_mul_f32 v182, v182, v188
    v_mul_f32 v183, v183, v188
    v_mul_f32 v184, v184, v188
    v_mul_f32 v185, v185, v188
    v_cvt_pk_bf16_f32 v76, v180, v181
    v_cvt_pk_bf16_f32 v77, v182, v183
    v_cvt_pk_bf16_f32 v82, v184, v185
    v_mul_f32 v192, v192, v200
    v_mul_f32 v193, v193, v200
    v_mul_f32 v194, v194, v200
    v_mul_f32 v195, v195, v200
    v_mul_f32 v198, v198, v200
    v_mul_f32 v199, v199, v200
    v_cvt_pk_bf16_f32 v78, v192, v193
    v_cvt_pk_bf16_f32 v79, v194, v195
    v_cvt_pk_bf16_f32 v83, v198, v199
    s_add_u32 s53, s54, 16384
    buffer_store_dwordx4 v[76:79], v2, s[4:7], s53 offen sc1
    v_mul_f32 v204, v204, v212
    v_mul_f32 v205, v205, v212
    v_mul_f32 v206, v206, v212
    v_mul_f32 v207, v207, v212
    v_mul_f32 v208, v208, v212
    v_mul_f32 v209, v209, v212
    v_cvt_pk_bf16_f32 v72, v204, v205
    v_cvt_pk_bf16_f32 v73, v206, v207
    v_cvt_pk_bf16_f32 v80, v208, v209
    v_mul_f32 v216, v216, v224
    v_mul_f32 v217, v217, v224
    v_mul_f32 v218, v218, v224
    v_mul_f32 v219, v219, v224
    v_mul_f32 v222, v222, v224
    v_mul_f32 v223, v223, v224
    v_cvt_pk_bf16_f32 v74, v216, v217
    v_cvt_pk_bf16_f32 v75, v218, v219
    v_cvt_pk_bf16_f32 v81, v222, v223
    s_add_u32 s53, s54, 0
    buffer_store_dwordx4 v[72:75], v2, s[4:7], s53 offen sc1
    s_mov_b32 exec_lo, 0xffff0000
    s_mov_b32 exec_hi, 0
    buffer_store_dwordx2 v[80:81], v6, s[4:7], s55 offen offset:0 sc1
    buffer_store_dwordx2 v[82:83], v6, s[4:7], s55 offen offset:2048 sc1
    s_mov_b64 exec, -1
    s_lshl_b32 s52, s44, 2
    s_add_u32 s52, s52, s20
    s_lshl_b32 s52, s52, 4
    s_add_u32 s52, s52, s45
    s_lshl_b32 s52, s52, 3
    s_add_u32 s52, s52, 3948544
    v_mov_b32 v8, s98
    v_mov_b32 v9, s99
    s_waitcnt vmcnt(0)
    s_mov_b64 exec, 1
    buffer_store_dwordx2 v[8:9], off, s[4:7], s52 sc1
    s_mov_b64 exec, -1
    s_cmp_ge_u32 s22, 24
    s_cbranch_scc1 L_idle0_22
    s_mul_i32 s44, s22, 10923
    s_lshr_b32 s44, s44, 16
    s_mul_i32 s52, s44, 6
    s_sub_u32 s45, s22, s52
    s_lshl_b32 s52, s21, 2
    s_add_u32 s44, s44, s52
    s_lshl_b32 s46, s44, 2
    s_add_u32 s46, s46, s20
    s_mul_i32 s47, s45, 110592
    s_mul_i32 s48, s20, 3072
    s_add_u32 s47, s47, s48
    s_add_u32 s47, s47, 2097152
    s_lshl_b32 s49, s46, 14
    s_add_u32 s49, s49, 23330816
    s_lshl_b32 s50, s46, 11
    s_add_u32 s50, s50, 25427968
    v_and_b32 v3, 15, v1
    v_lshrrev_b32 v4, 4, v1
    v_lshlrev_b32 v5, 3, v3
    v_lshl_add_u32 v5, v4, 8, v5
    s_lshl_b32 s52, s46, 4
    v_add_u32 v6, s52, v3
    v_lshlrev_b32 v7, 3, v6
    v_mul_u32_u24 v6, 1152, v6
    v_lshl_add_u32 v6, v4, 4, v6
    s_mul_i32 s51, s45, 192
    s_mov_b32 s8, s24
    s_mov_b32 s9, s25
    s_mov_b32 s10, 0x240000
    s_mov_b32 s11, 0x20000
    v_min_u32 v10, 17, v1
    v_lshlrev_b32 v10, 3, v10
    s_lshl_b32 s52, s45, 8
    s_add_u32 s52, s52, 4067328
    buffer_load_dwordx2 v[8:9], v10, s[4:7], s52 offen sc1
    s_waitcnt vmcnt(0)
    v_cmp_eq_u64 vcc, s[98:99], v[8:9]
    s_nop 0
    s_cmp_eq_u64 vcc, exec
    s_cbranch_scc0 L_pwo_slow_26
L_pwo_back_27:
    s_mov_b32 m0, s48
    s_nop 0
    buffer_load_dwordx4 v2, s[4:7], s47 offen offset:0 lds
    buffer_load_dwordx4 v2, s[4:7], s47 offen offset:1024 lds
    buffer_load_dwordx4 v2, s[4:7], s47 offen offset:2048 lds
    s_add_u32 s48, s48, 12288
    s_add_u32 s47, s47, 12288
    s_mov_b32 m0, s48
    s_nop 0
    buffer_load_dwordx4 v2, s[4:7], s47 offen offset:0 lds
    buffer_load_dwordx4 v2, s[4:7], s47 offen offset:1024 lds
    buffer_load_dwordx4 v2, s[4:7], s47 offen offset:2048 lds
    s_add_u32 s48, s48, 12288
    s_add_u32 s47, s47, 12288
    s_mov_b32 m0, s48
    s_nop 0
    buffer_load_dwordx4 v2, s[4:7], s47 offen offset:0 lds
    buffer_load_dwordx4 v2, s[4:7], s47 offen offset:1024 lds
    buffer_load_dwordx4 v2, s[4:7], s47 offen offset:2048 lds
    s_add_u32 s48, s48, 12288
    s_add_u32 s47, s47, 12288
    s_mov_b32 m0, s48
    s_nop 0
    buffer_load_dwordx4 v2, s[4:7], s47 offen offset:0 lds
    buffer_load_dwordx4 v2, s[4:7], s47 offen offset:1024 lds
    buffer_load_dwordx4 v2, s[4:7], s47 offen offset:2048 lds
    s_add_u32 s48, s48, 12288
    s_add_u32 s47, s47, 12288
    s_mov_b32 m0, s48
    s_nop 0
    buffer_load_dwordx4 v2, s[4:7], s47 offen offset:0 lds
    buffer_load_dwordx4 v2, s[4:7], s47 offen offset:1024 lds
    buffer_load_dwordx4 v2, s[4:7], s47 offen offset:2048 lds
    s_add_u32 s48, s48, 12288
    s_add_u32 s47, s47, 12288
    s_mov_b32 m0, s48
    s_nop 0
    buffer_load_dwordx4 v2, s[4:7], s47 offen offset:0 lds
    buffer_load_dwordx4 v2, s[4:7], s47 offen offset:1024 lds
    buffer_load_dwordx4 v2, s[4:7], s47 offen offset:2048 lds
    s_add_u32 s48, s48, 12288
    s_add_u32 s47, s47, 12288
    s_mov_b32 m0, s48
    s_nop 0
    buffer_load_dwordx4 v2, s[4:7], s47 offen offset:0 lds
    buffer_load_dwordx4 v2, s[4:7], s47 offen offset:1024 lds
    buffer_load_dwordx4 v2, s[4:7], s47 offen offset:2048 lds
    s_add_u32 s48, s48, 12288
    s_add_u32 s47, s47, 12288
    s_mov_b32 m0, s48
    s_nop 0
    buffer_load_dwordx4 v2, s[4:7], s47 offen offset:0 lds
    buffer_load_dwordx4 v2, s[4:7], s47 offen offset:1024 lds
    buffer_load_dwordx4 v2, s[4:7], s47 offen offset:2048 lds
    s_add_u32 s48, s48, 12288
    s_add_u32 s47, s47, 12288
    s_mov_b32 m0, s48
    s_nop 0
    buffer_load_dwordx4 v2, s[4:7], s47 offen offset:0 lds
    buffer_load_dwordx4 v2, s[4:7], s47 offen offset:1024 lds
    buffer_load_dwordx4 v2, s[4:7], s47 offen offset:2048 lds
    s_add_u32 s48, s48, 12288
    s_add_u32 s47, s47, 12288
    s_mul_i32 s70, s20, 9216
    s_add_u32 s70, s70, 110592
    v_add_u32 v64, s70, v2
    ds_write_b128 v64, a[144:147] offset:0
    ds_write_b128 v64, a[148:151] offset:1024
    ds_write_b128 v64, a[152:155] offset:2048
    ds_write_b128 v64, a[156:159] offset:3072
    ds_write_b128 v64, a[160:163] offset:4096
    ds_write_b128 v64, a[164:167] offset:5120
    ds_write_b128 v64, a[168:171] offset:6144
    ds_write_b128 v64, a[172:175] offset:7168
    ds_write_b128 v64, a[176:179] offset:8192
    v_lshrrev_b32 v65, 4, v1
    v_bfe_u32 v66, v1, 2, 2
    v_lshl_add_u32 v65, v65, 3, v66
    v_mul_u32_u24 v65, 288, v65
    v_add_u32 v65, s70, v65
    v_and_b32 v66, 3, v1
    v_lshl_add_u32 v64, v66, 4, v65
    v_lshl_add_u32 v65, v66, 3, v65
    v_mov_b32 v68, 0x3f803f80
    v_mov_b32 v69, 0x3f803f80
    v_mov_b32 v70, 0x3f803f80
    v_mov_b32 v71, 0x3f803f80
    ds_read_b64_tr_b16 v[72:73], v64 offset:0
    ds_read_b64_tr_b16 v[74:75], v64 offset:1152
    ds_read_b64_tr_b16 v[76:77], v64 offset:8
    ds_read_b64_tr_b16 v[78:79], v64 offset:1160
    ds_read_b64_tr_b16 v[80:81], v64 offset:64
    ds_read_b64_tr_b16 v[82:83], v64 offset:1216
    ds_read_b64_tr_b16 v[84:85], v64 offset:72
    ds_read_b64_tr_b16 v[86:87], v64 offset:1224
    ds_read_b64_tr_b16 v[88:89], v64 offset:128
    ds_read_b64_tr_b16 v[90:91], v64 offset:1280
    ds_read_b64_tr_b16 v[92:93], v64 offset:136
    ds_read_b64_tr_b16 v[94:95], v64 offset:1288
    ds_read_b64_tr_b16 v[96:97], v64 offset:192
    ds_read_b64_tr_b16 v[98:99], v64 offset:1344
    ds_read_b64_tr_b16 v[100:101], v64 offset:200
    ds_read_b64_tr_b16 v[102:103], v64 offset:1352
    ds_read_b64_tr_b16 v[104:105], v65 offset:256
    ds_read_b64_tr_b16 v[106:107], v65 offset:1408
    s_add_u32 s71, s59, 36864
    s_waitcnt lgkmcnt(15)
    buffer_store_dwordx4 v[72:75], v2, s[4:7], s71 offen sc1
    v_mfma_f32_16x16x32_bf16 v[108:111], v[72:75], v[68:71], 0
    s_add_u32 s71, s59, 73728
    s_waitcnt lgkmcnt(14)
    buffer_store_dwordx4 v[76:79], v2, s[4:7], s71 offen sc1
    v_mfma_f32_16x16x32_bf16 v[112:115], v[76:79], v[68:71], 0
    s_add_u32 s71, s59, 110592
    s_waitcnt lgkmcnt(12)
    buffer_store_dwordx4 v[80:83], v2, s[4:7], s71 offen sc1
    v_mfma_f32_16x16x32_bf16 v[116:119], v[80:83], v[68:71], 0
    s_add_u32 s71, s59, 147456
    s_waitcnt lgkmcnt(10)
    buffer_store_dwordx4 v[84:87], v2, s[4:7], s71 offen sc1
    v_mfma_f32_16x16x32_bf16 v[120:123], v[84:87], v[68:71], 0
    s_add_u32 s71, s59, 184320
    s_waitcnt lgkmcnt(8)
    buffer_store_dwordx4 v[88:91], v2, s[4:7], s71 offen sc1
    v_mfma_f32_16x16x32_bf16 v[124:127], v[88:91], v[68:71], 0
    s_add_u32 s71, s59, 221184
    s_waitcnt lgkmcnt(6)
    buffer_store_dwordx4 v[92:95], v2, s[4:7], s71 offen sc1
    v_mfma_f32_16x16x32_bf16 v[128:131], v[92:95], v[68:71], 0
    s_add_u32 s71, s59, 258048
    s_waitcnt lgkmcnt(4)
    buffer_store_dwordx4 v[96:99], v2, s[4:7], s71 offen sc1
    v_mfma_f32_16x16x32_bf16 v[132:135], v[96:99], v[68:71], 0
    s_add_u32 s71, s59, 294912
    s_waitcnt lgkmcnt(2)
    buffer_store_dwordx4 v[100:103], v2, s[4:7], s71 offen sc1
    v_mfma_f32_16x16x32_bf16 v[136:139], v[100:103], v[68:71], 0
    s_add_u32 s71, s59, 0
    s_waitcnt lgkmcnt(0)
    buffer_store_dwordx4 v[104:107], v2, s[4:7], s71 offen sc1
    v_mfma_f32_16x16x32_bf16 v[140:143], v[104:107], v[68:71], 0
    v_and_b32 v66, 15, v1
    v_cmp_eq_u32 vcc, 1, v66
    s_nop 1
    v_cndmask_b32 v108, v108, v112, vcc
    v_cndmask_b32 v109, v109, v113, vcc
    v_cndmask_b32 v110, v110, v114, vcc
    v_cndmask_b32 v111, v111, v115, vcc
    v_cmp_eq_u32 vcc, 2, v66
    s_nop 1
    v_cndmask_b32 v108, v108, v116, vcc
    v_cndmask_b32 v109, v109, v117, vcc
    v_cndmask_b32 v110, v110, v118, vcc
    v_cndmask_b32 v111, v111, v119, vcc
    v_cmp_eq_u32 vcc, 3, v66
    s_nop 1
    v_cndmask_b32 v108, v108, v120, vcc
    v_cndmask_b32 v109, v109, v121, vcc
    v_cndmask_b32 v110, v110, v122, vcc
    v_cndmask_b32 v111, v111, v123, vcc
    v_cmp_eq_u32 vcc, 4, v66
    s_nop 1
    v_cndmask_b32 v108, v108, v124, vcc
    v_cndmask_b32 v109, v109, v125, vcc
    v_cndmask_b32 v110, v110, v126, vcc
    v_cndmask_b32 v111, v111, v127, vcc
    v_cmp_eq_u32 vcc, 5, v66
    s_nop 1
    v_cndmask_b32 v108, v108, v128, vcc
    v_cndmask_b32 v109, v109, v129, vcc
    v_cndmask_b32 v110, v110, v130, vcc
    v_cndmask_b32 v111, v111, v131, vcc
    v_cmp_eq_u32 vcc, 6, v66
    s_nop 1
    v_cndmask_b32 v108, v108, v132, vcc
    v_cndmask_b32 v109, v109, v133, vcc
    v_cndmask_b32 v110, v110, v134, vcc
    v_cndmask_b32 v111, v111, v135, vcc
    v_cmp_eq_u32 vcc, 7, v66
    s_nop 1
    v_cndmask_b32 v108, v108, v136, vcc
    v_cndmask_b32 v109, v109, v137, vcc
    v_cndmask_b32 v110, v110, v138, vcc
    v_cndmask_b32 v111, v111, v139, vcc
    v_cmp_eq_u32 vcc, 8, v66
    s_nop 1
    v_cndmask_b32 v108, v108, v140, vcc
    v_cndmask_b32 v109, v109, v141, vcc
    v_cndmask_b32 v110, v110, v142, vcc
    v_cndmask_b32 v111, v111, v143, vcc
    v_add_u32 v67, 1, v66
    v_cmp_gt_u32 vcc, 8, v66
    s_nop 1
    v_cndmask_b32 v67, 0, v67, vcc
    v_lshlrev_b32 v67, 6, v67
    v_and_b32 v64, 48, v1
    v_add_u32 v67, v67, v64
    s_mov_b32 exec_lo, 0x01ff01ff
    s_mov_b32 exec_hi, 0x01ff01ff
    buffer_store_dwordx4 v[108:111], v67, s[4:7], s60 offen sc1
    s_mov_b64 exec, -1
    s_lshr_b32 s52, s46, 1
    s_lshl_b32 s52, s52, 7
    s_add_u32 s52, s52, 3948544
    v_and_b32 v10, 15, v1
    v_lshlrev_b32 v10, 3, v10
    buffer_load_dwordx2 v[8:9], v10, s[4:7], s52 offen sc1
    s_waitcnt vmcnt(0)
    v_cmp_eq_u64 vcc, s[98:99], v[8:9]
    s_nop 0
    s_cmp_eq_u64 vcc, exec
    s_cbranch_scc0 L_po_slow_29
L_po_back_30:
    v_mov_b32 v8, s98
    v_mov_b32 v9, s99
    s_mov_b64 exec, 1
    buffer_store_dwordx2 v[8:9], off, s[4:7], s61 sc1
    s_mov_b64 exec, -1
    buffer_load_dwordx4 v[16:19], v2, s[4:7], s49 offen offset:0 sc1
    buffer_load_dwordx4 v[20:23], v2, s[4:7], s49 offen offset:1024 sc1
    buffer_load_dwordx4 v[24:27], v2, s[4:7], s49 offen offset:2048 sc1
    buffer_load_dwordx4 v[28:31], v2, s[4:7], s49 offen offset:3072 sc1
    s_add_u32 s49, s49, 4096
    buffer_load_dwordx4 v[32:35], v2, s[4:7], s49 offen offset:0 sc1
    buffer_load_dwordx4 v[36:39], v2, s[4:7], s49 offen offset:1024 sc1
    buffer_load_dwordx4 v[40:43], v2, s[4:7], s49 offen offset:2048 sc1
    buffer_load_dwordx4 v[44:47], v2, s[4:7], s49 offen offset:3072 sc1
    s_add_u32 s49, s49, 4096
    buffer_load_dwordx4 v[48:51], v2, s[4:7], s49 offen offset:0 sc1
    buffer_load_dwordx4 v[52:55], v2, s[4:7], s49 offen offset:1024 sc1
    buffer_load_dwordx4 v[56:59], v2, s[4:7], s49 offen offset:2048 sc1
    buffer_load_dwordx4 v[60:63], v2, s[4:7], s49 offen offset:3072 sc1
    s_add_u32 s49, s49, 4096
    buffer_load_dwordx4 v[64:67], v2, s[4:7], s49 offen offset:0 sc1
    buffer_load_dwordx4 v[68:71], v2, s[4:7], s49 offen offset:1024 sc1
    buffer_load_dwordx4 v[72:75], v2, s[4:7], s49 offen offset:2048 sc1
    buffer_load_dwordx4 v[76:79], v2, s[4:7], s49 offen offset:3072 sc1
    buffer_load_dwordx2 v[80:81], v5, s[4:7], s50 offen offset:0 sc1
    buffer_load_dwordx2 v[82:83], v5, s[4:7], s50 offen offset:128 sc1
    buffer_load_dwordx2 v[84:85], v5, s[4:7], s50 offen offset:1024 sc1
    buffer_load_dwordx2 v[86:87], v5, s[4:7], s50 offen offset:1152 sc1
    buffer_load_dwordx4 v[160:163], v6, s[8:11], s51 offen offset:0
    buffer_load_dwordx4 v[164:167], v6, s[8:11], s51 offen offset:64
    buffer_load_dwordx4 v[168:171], v6, s[8:11], s51 offen offset:128
    v_mov_b32 v8, v2
    s_barrier
    ds_read_b128 v[112:115], v8 offset:0
    ds_read_b128 v[116:119], v8 offset:1024
    ds_read_b128 v[120:123], v8 offset:2048
    ds_read_b128 v[124:127], v8 offset:3072
    ds_read_b128 v[128:131], v8 offset:4096
    ds_read_b128 v[132:135], v8 offset:5120
    ds_read_b128 v[136:139], v8 offset:6144
    ds_read_b128 v[140:143], v8 offset:7168
    ds_read_b128 v[144:147], v8 offset:8192
    ds_read_b128 v[148:151], v8 offset:9216
    s_waitcnt vmcnt(22) lgkmcnt(9)
    v_mfma_f32_16x16x32_bf16 v[88:91], v[112:115], v[16:19], 0
    ds_read_b128 v[152:155], v8 offset:10240
    s_waitcnt lgkmcnt(9)
    v_mfma_f32_16x16x32_bf16 v[92:95], v[116:119], v[16:19], 0
    ds_read_b128 v[156:159], v8 offset:11264
    s_waitcnt lgkmcnt(9)
    v_mfma_f32_16x16x32_bf16 v[96:99], v[120:123], v[16:19], 0
    ds_read_b128 v[112:115], v8 offset:12288
    s_waitcnt lgkmcnt(9)
    v_mfma_f32_16x16x32_bf16 v[100:103], v[124:127], v[16:19], 0
    ds_read_b128 v[116:119], v8 offset:13312
    s_waitcnt lgkmcnt(9)
    v_mfma_f32_16x16x32_bf16 v[104:107], v[128:131], v[16:19], 0
    ds_read_b128 v[120:123], v8 offset:14336
    s_waitcnt lgkmcnt(9)
    v_mfma_f32_16x16x32_bf16 v[108:111], v[132:135], v[16:19], 0
    ds_read_b128 v[124:127], v8 offset:15360
    s_waitcnt vmcnt(21) lgkmcnt(9)
    v_mfma_f32_16x16x32_bf16 v[88:91], v[136:139], v[20:23], v[88:91]
    ds_read_b128 v[128:131], v8 offset:16384
    s_waitcnt lgkmcnt(9)
    v_mfma_f32_16x16x32_bf16 v[92:95], v[140:143], v[20:23], v[92:95]
    ds_read_b128 v[132:135], v8 offset:17408
    s_waitcnt lgkmcnt(9)
    v_mfma_f32_16x16x32_bf16 v[96:99], v[144:147], v[20:23], v[96:99]
    ds_read_b128 v[136:139], v8 offset:18432
    s_waitcnt lgkmcnt(9)
    v_mfma_f32_16x16x32_bf16 v[100:103], v[148:151], v[20:23], v[100:103]
    ds_read_b128 v[140:143], v8 offset:19456
    s_waitcnt lgkmcnt(9)
    v_mfma_f32_16x16x32_bf16 v[104:107], v[152:155], v[20:23], v[104:107]
    ds_read_b128 v[144:147], v8 offset:20480
    s_waitcnt lgkmcnt(9)
    v_mfma_f32_16x16x32_bf16 v[108:111], v[156:159], v[20:23], v[108:111]
    ds_read_b128 v[148:151], v8 offset:21504
    s_waitcnt vmcnt(20) lgkmcnt(9)
    v_mfma_f32_16x16x32_bf16 v[88:91], v[112:115], v[24:27], v[88:91]
    ds_read_b128 v[152:155], v8 offset:22528
    s_waitcnt lgkmcnt(9)
    v_mfma_f32_16x16x32_bf16 v[92:95], v[116:119], v[24:27], v[92:95]
    ds_read_b128 v[156:159], v8 offset:23552
    s_waitcnt lgkmcnt(9)
    v_mfma_f32_16x16x32_bf16 v[96:99], v[120:123], v[24:27], v[96:99]
    ds_read_b128 v[112:115], v8 offset:24576
    s_waitcnt lgkmcnt(9)
    v_mfma_f32_16x16x32_bf16 v[100:103], v[124:127], v[24:27], v[100:103]
    ds_read_b128 v[116:119], v8 offset:25600
    s_waitcnt lgkmcnt(9)
    v_mfma_f32_16x16x32_bf16 v[104:107], v[128:131], v[24:27], v[104:107]
    ds_read_b128 v[120:123], v8 offset:26624
    s_waitcnt lgkmcnt(9)
    v_mfma_f32_16x16x32_bf16 v[108:111], v[132:135], v[24:27], v[108:111]
    ds_read_b128 v[124:127], v8 offset:27648
    s_waitcnt vmcnt(19) lgkmcnt(9)
    v_mfma_f32_16x16x32_bf16 v[88:91], v[136:139], v[28:31], v[88:91]
    ds_read_b128 v[128:131], v8 offset:28672
    s_waitcnt lgkmcnt(9)
    v_mfma_f32_16x16x32_bf16 v[92:95], v[140:143], v[28:31], v[92:95]
    ds_read_b128 v[132:135], v8 offset:29696
    s_waitcnt lgkmcnt(9)
    v_mfma_f32_16x16x32_bf16 v[96:99], v[144:147], v[28:31], v[96:99]
    ds_read_b128 v[136:139], v8 offset:30720
    s_waitcnt lgkmcnt(9)
    v_mfma_f32_16x16x32_bf16 v[100:103], v[148:151], v[28:31], v[100:103]
    ds_read_b128 v[140:143], v8 offset:31744
    s_waitcnt lgkmcnt(9)
    v_mfma_f32_16x16x32_bf16 v[104:107], v[152:155], v[28:31], v[104:107]
    ds_read_b128 v[144:147], v8 offset:32768
    s_waitcnt lgkmcnt(9)
    v_mfma_f32_16x16x32_bf16 v[108:111], v[156:159], v[28:31], v[108:111]
    ds_read_b128 v[148:151], v8 offset:33792
    s_waitcnt vmcnt(18) lgkmcnt(9)
    v_mfma_f32_16x16x32_bf16 v[88:91], v[112:115], v[32:35], v[88:91]
    ds_read_b128 v[152:155], v8 offset:34816
    s_waitcnt lgkmcnt(9)
    v_mfma_f32_16x16x32_bf16 v[92:95], v[116:119], v[32:35], v[92:95]
    ds_read_b128 v[156:159], v8 offset:35840
    s_waitcnt lgkmcnt(9)
    v_mfma_f32_16x16x32_bf16 v[96:99], v[120:123], v[32:35], v[96:99]
    ds_read_b128 v[112:115], v8 offset:36864
    s_waitcnt lgkmcnt(9)
    v_mfma_f32_16x16x32_bf16 v[100:103], v[124:127], v[32:35], v[100:103]
    ds_read_b128 v[116:119], v8 offset:37888
    s_waitcnt lgkmcnt(9)
    v_mfma_f32_16x16x32_bf16 v[104:107], v[128:131], v[32:35], v[104:107]
    ds_read_b128 v[120:123], v8 offset:38912
    s_waitcnt lgkmcnt(9)
    v_mfma_f32_16x16x32_bf16 v[108:111], v[132:135], v[32:35], v[108:111]
    ds_read_b128 v[124:127], v8 offset:39936
    s_waitcnt vmcnt(17) lgkmcnt(9)
    v_mfma_f32_16x16x32_bf16 v[88:91], v[136:139], v[36:39], v[88:91]
    ds_read_b128 v[128:131], v8 offset:40960
    s_waitcnt lgkmcnt(9)
    v_mfma_f32_16x16x32_bf16 v[92:95], v[140:143], v[36:39], v[92:95]
    ds_read_b128 v[132:135], v8 offset:41984
    s_waitcnt lgkmcnt(9)
    v_mfma_f32_16x16x32_bf16 v[96:99], v[144:147], v[36:39], v[96:99]
    ds_read_b128 v[136:139], v8 offset:43008
    s_waitcnt lgkmcnt(9)
    v_mfma_f32_16x16x32_bf16 v[100:103], v[148:151], v[36:39], v[100:103]
    ds_read_b128 v[140:143], v8 offset:44032
    s_waitcnt lgkmcnt(9)
    v_mfma_f32_16x16x32_bf16 v[104:107], v[152:155], v[36:39], v[104:107]
    ds_read_b128 v[144:147], v8 offset:45056
    s_waitcnt lgkmcnt(9)
    v_mfma_f32_16x16x32_bf16 v[108:111], v[156:159], v[36:39], v[108:111]
    ds_read_b128 v[148:151], v8 offset:46080
    s_waitcnt vmcnt(16) lgkmcnt(9)
    v_mfma_f32_16x16x32_bf16 v[88:91], v[112:115], v[40:43], v[88:91]
    ds_read_b128 v[152:155], v8 offset:47104
    s_waitcnt lgkmcnt(9)
    v_mfma_f32_16x16x32_bf16 v[92:95], v[116:119], v[40:43], v[92:95]
    ds_read_b128 v[156:159], v8 offset:48128
    s_waitcnt lgkmcnt(9)
    v_mfma_f32_16x16x32_bf16 v[96:99], v[120:123], v[40:43], v[96:99]
    ds_read_b128 v[112:115], v8 offset:49152
    s_waitcnt lgkmcnt(9)
    v_mfma_f32_16x16x32_bf16 v[100:103], v[124:127], v[40:43], v[100:103]
    ds_read_b128 v[116:119], v8 offset:50176
    s_waitcnt lgkmcnt(9)
    v_mfma_f32_16x16x32_bf16 v[104:107], v[128:131], v[40:43], v[104:107]
    ds_read_b128 v[120:123], v8 offset:51200
    s_waitcnt lgkmcnt(9)
    v_mfma_f32_16x16x32_bf16 v[108:111], v[132:135], v[40:43], v[108:111]
    ds_read_b128 v[124:127], v8 offset:52224
    s_waitcnt vmcnt(15) lgkmcnt(9)
    v_mfma_f32_16x16x32_bf16 v[88:91], v[136:139], v[44:47], v[88:91]
    ds_read_b128 v[128:131], v8 offset:53248
    s_waitcnt lgkmcnt(9)
    v_mfma_f32_16x16x32_bf16 v[92:95], v[140:143], v[44:47], v[92:95]
    ds_read_b128 v[132:135], v8 offset:54272
    s_waitcnt lgkmcnt(9)
    v_mfma_f32_16x16x32_bf16 v[96:99], v[144:147], v[44:47], v[96:99]
    ds_read_b128 v[136:139], v8 offset:55296
    s_waitcnt lgkmcnt(9)
    v_mfma_f32_16x16x32_bf16 v[100:103], v[148:151], v[44:47], v[100:103]
    ds_read_b128 v[140:143], v8 offset:56320
    s_waitcnt lgkmcnt(9)
    v_mfma_f32_16x16x32_bf16 v[104:107], v[152:155], v[44:47], v[104:107]
    ds_read_b128 v[144:147], v8 offset:57344
    s_waitcnt lgkmcnt(9)
    v_mfma_f32_16x16x32_bf16 v[108:111], v[156:159], v[44:47], v[108:111]
    ds_read_b128 v[148:151], v8 offset:58368
    s_waitcnt vmcnt(14) lgkmcnt(9)
    v_mfma_f32_16x16x32_bf16 v[88:91], v[112:115], v[48:51], v[88:91]
    ds_read_b128 v[152:155], v8 offset:59392
    s_waitcnt lgkmcnt(9)
    v_mfma_f32_16x16x32_bf16 v[92:95], v[116:119], v[48:51], v[92:95]
    ds_read_b128 v[156:159], v8 offset:60416
    s_waitcnt lgkmcnt(9)
    v_mfma_f32_16x16x32_bf16 v[96:99], v[120:123], v[48:51], v[96:99]
    v_add_u32 v8, 61440, v8
    ds_read_b128 v[112:115], v8 offset:0
    s_waitcnt lgkmcnt(9)
    v_mfma_f32_16x16x32_bf16 v[100:103], v[124:127], v[48:51], v[100:103]
    ds_read_b128 v[116:119], v8 offset:1024
    s_waitcnt lgkmcnt(9)
    v_mfma_f32_16x16x32_bf16 v[104:107], v[128:131], v[48:51], v[104:107]
    ds_read_b128 v[120:123], v8 offset:2048
    s_waitcnt lgkmcnt(9)
    v_mfma_f32_16x16x32_bf16 v[108:111], v[132:135], v[48:51], v[108:111]
    ds_read_b128 v[124:127], v8 offset:3072
    s_waitcnt vmcnt(13) lgkmcnt(9)
    v_mfma_f32_16x16x32_bf16 v[88:91], v[136:139], v[52:55], v[88:91]
    ds_read_b128 v[128:131], v8 offset:4096
    s_waitcnt lgkmcnt(9)
    v_mfma_f32_16x16x32_bf16 v[92:95], v[140:143], v[52:55], v[92:95]
    ds_read_b128 v[132:135], v8 offset:5120
    s_waitcnt lgkmcnt(9)
    v_mfma_f32_16x16x32_bf16 v[96:99], v[144:147], v[52:55], v[96:99]
    ds_read_b128 v[136:139], v8 offset:6144
    s_waitcnt lgkmcnt(9)
    v_mfma_f32_16x16x32_bf16 v[100:103], v[148:151], v[52:55], v[100:103]
    ds_read_b128 v[140:143], v8 offset:7168
    s_waitcnt lgkmcnt(9)
    v_mfma_f32_16x16x32_bf16 v[104:107], v[152:155], v[52:55], v[104:107]
    ds_read_b128 v[144:147], v8 offset:8192
    s_waitcnt lgkmcnt(9)
    v_mfma_f32_16x16x32_bf16 v[108:111], v[156:159], v[52:55], v[108:111]
    ds_read_b128 v[148:151], v8 offset:9216
    s_waitcnt vmcnt(12) lgkmcnt(9)
    v_mfma_f32_16x16x32_bf16 v[88:91], v[112:115], v[56:59], v[88:91]
    ds_read_b128 v[152:155], v8 offset:10240
    s_waitcnt lgkmcnt(9)
    v_mfma_f32_16x16x32_bf16 v[92:95], v[116:119], v[56:59], v[92:95]
    ds_read_b128 v[156:159], v8 offset:11264
    s_waitcnt lgkmcnt(9)
    v_mfma_f32_16x16x32_bf16 v[96:99], v[120:123], v[56:59], v[96:99]
    ds_read_b128 v[112:115], v8 offset:12288
    s_waitcnt lgkmcnt(9)
    v_mfma_f32_16x16x32_bf16 v[100:103], v[124:127], v[56:59], v[100:103]
    ds_read_b128 v[116:119], v8 offset:13312
    s_waitcnt lgkmcnt(9)
    v_mfma_f32_16x16x32_bf16 v[104:107], v[128:131], v[56:59], v[104:107]
    ds_read_b128 v[120:123], v8 offset:14336
    s_waitcnt lgkmcnt(9)
    v_mfma_f32_16x16x32_bf16 v[108:111], v[132:135], v[56:59], v[108:111]
    ds_read_b128 v[124:127], v8 offset:15360
    s_waitcnt vmcnt(11) lgkmcnt(9)
    v_mfma_f32_16x16x32_bf16 v[88:91], v[136:139], v[60:63], v[88:91]
    ds_read_b128 v[128:131], v8 offset:16384
    s_waitcnt lgkmcnt(9)
    v_mfma_f32_16x16x32_bf16 v[92:95], v[140:143], v[60:63], v[92:95]
    ds_read_b128 v[132:135], v8 offset:17408
    s_waitcnt lgkmcnt(9)
    v_mfma_f32_16x16x32_bf16 v[96:99], v[144:147], v[60:63], v[96:99]
    ds_read_b128 v[136:139], v8 offset:18432
    s_waitcnt lgkmcnt(9)
    v_mfma_f32_16x16x32_bf16 v[100:103], v[148:151], v[60:63], v[100:103]
    ds_read_b128 v[140:143], v8 offset:19456
    s_waitcnt lgkmcnt(9)
    v_mfma_f32_16x16x32_bf16 v[104:107], v[152:155], v[60:63], v[104:107]
    ds_read_b128 v[144:147], v8 offset:20480
    s_waitcnt lgkmcnt(9)
    v_mfma_f32_16x16x32_bf16 v[108:111], v[156:159], v[60:63], v[108:111]
    ds_read_b128 v[148:151], v8 offset:21504
    s_waitcnt vmcnt(10) lgkmcnt(9)
    v_mfma_f32_16x16x32_bf16 v[88:91], v[112:115], v[64:67], v[88:91]
    ds_read_b128 v[152:155], v8 offset:22528
    s_waitcnt lgkmcnt(9)
    v_mfma_f32_16x16x32_bf16 v[92:95], v[116:119], v[64:67], v[92:95]
    ds_read_b128 v[156:159], v8 offset:23552
    s_waitcnt lgkmcnt(9)
    v_mfma_f32_16x16x32_bf16 v[96:99], v[120:123], v[64:67], v[96:99]
    ds_read_b128 v[112:115], v8 offset:24576
    s_waitcnt lgkmcnt(9)
    v_mfma_f32_16x16x32_bf16 v[100:103], v[124:127], v[64:67], v[100:103]
    ds_read_b128 v[116:119], v8 offset:25600
    s_waitcnt lgkmcnt(9)
    v_mfma_f32_16x16x32_bf16 v[104:107], v[128:131], v[64:67], v[104:107]
    ds_read_b128 v[120:123], v8 offset:26624
    s_waitcnt lgkmcnt(9)
    v_mfma_f32_16x16x32_bf16 v[108:111], v[132:135], v[64:67], v[108:111]
    ds_read_b128 v[124:127], v8 offset:27648
    s_waitcnt vmcnt(9) lgkmcnt(9)
    v_mfma_f32_16x16x32_bf16 v[88:91], v[136:139], v[68:71], v[88:91]
    ds_read_b128 v[128:131], v8 offset:28672
    s_waitcnt lgkmcnt(9)
    v_mfma_f32_16x16x32_bf16 v[92:95], v[140:143], v[68:71], v[92:95]
    ds_read_b128 v[132:135], v8 offset:29696
    s_waitcnt lgkmcnt(9)
    v_mfma_f32_16x16x32_bf16 v[96:99], v[144:147], v[68:71], v[96:99]
    ds_read_b128 v[136:139], v8 offset:30720
    s_waitcnt lgkmcnt(9)
    v_mfma_f32_16x16x32_bf16 v[100:103], v[148:151], v[68:71], v[100:103]
    ds_read_b128 v[140:143], v8 offset:31744
    s_waitcnt lgkmcnt(9)
    v_mfma_f32_16x16x32_bf16 v[104:107], v[152:155], v[68:71], v[104:107]
    ds_read_b128 v[144:147], v8 offset:32768
    s_waitcnt lgkmcnt(9)
    v_mfma_f32_16x16x32_bf16 v[108:111], v[156:159], v[68:71], v[108:111]
    ds_read_b128 v[148:151], v8 offset:33792
    s_waitcnt vmcnt(8) lgkmcnt(9)
    v_mfma_f32_16x16x32_bf16 v[88:91], v[112:115], v[72:75], v[88:91]
    ds_read_b128 v[152:155], v8 offset:34816
    s_waitcnt lgkmcnt(9)
    v_mfma_f32_16x16x32_bf16 v[92:95], v[116:119], v[72:75], v[92:95]
    ds_read_b128 v[156:159], v8 offset:35840
    s_waitcnt lgkmcnt(9)
    v_mfma_f32_16x16x32_bf16 v[96:99], v[120:123], v[72:75], v[96:99]
    ds_read_b128 v[112:115], v8 offset:36864
    s_waitcnt lgkmcnt(9)
    v_mfma_f32_16x16x32_bf16 v[100:103], v[124:127], v[72:75], v[100:103]
    ds_read_b128 v[116:119], v8 offset:37888
    s_waitcnt lgkmcnt(9)
    v_mfma_f32_16x16x32_bf16 v[104:107], v[128:131], v[72:75], v[104:107]
    ds_read_b128 v[120:123], v8 offset:38912
    s_waitcnt lgkmcnt(9)
    v_mfma_f32_16x16x32_bf16 v[108:111], v[132:135], v[72:75], v[108:111]
    ds_read_b128 v[124:127], v8 offset:39936
    s_waitcnt vmcnt(7) lgkmcnt(9)
    v_mfma_f32_16x16x32_bf16 v[88:91], v[136:139], v[76:79], v[88:91]
    ds_read_b128 v[128:131], v8 offset:40960
    s_waitcnt lgkmcnt(9)
    v_mfma_f32_16x16x32_bf16 v[92:95], v[140:143], v[76:79], v[92:95]
    ds_read_b128 v[132:135], v8 offset:41984
    s_waitcnt lgkmcnt(9)
    v_mfma_f32_16x16x32_bf16 v[96:99], v[144:147], v[76:79], v[96:99]
    ds_read_b128 v[136:139], v8 offset:43008
    s_waitcnt lgkmcnt(9)
    v_mfma_f32_16x16x32_bf16 v[100:103], v[148:151], v[76:79], v[100:103]
    ds_read_b128 v[140:143], v8 offset:44032
    s_waitcnt lgkmcnt(9)
    v_mfma_f32_16x16x32_bf16 v[104:107], v[152:155], v[76:79], v[104:107]
    ds_read_b128 v[144:147], v8 offset:45056
    s_waitcnt lgkmcnt(9)
    v_mfma_f32_16x16x32_bf16 v[108:111], v[156:159], v[76:79], v[108:111]
    ds_read_b128 v[148:151], v8 offset:46080
    s_waitcnt vmcnt(5) lgkmcnt(9)
    v_mfma_f32_16x16x32_bf16 v[88:91], v[112:115], v[80:83], v[88:91]
    ds_read_b128 v[152:155], v8 offset:47104
    s_waitcnt lgkmcnt(9)
    v_mfma_f32_16x16x32_bf16 v[92:95], v[116:119], v[80:83], v[92:95]
    ds_read_b128 v[156:159], v8 offset:48128
    s_waitcnt lgkmcnt(9)
    v_mfma_f32_16x16x32_bf16 v[96:99], v[120:123], v[80:83], v[96:99]
    s_waitcnt lgkmcnt(8)
    v_mfma_f32_16x16x32_bf16 v[100:103], v[124:127], v[80:83], v[100:103]
    s_waitcnt lgkmcnt(7)
    v_mfma_f32_16x16x32_bf16 v[104:107], v[128:131], v[80:83], v[104:107]
    s_waitcnt lgkmcnt(6)
    v_mfma_f32_16x16x32_bf16 v[108:111], v[132:135], v[80:83], v[108:111]
    s_waitcnt vmcnt(3) lgkmcnt(5)
    v_mfma_f32_16x16x32_bf16 v[88:91], v[136:139], v[84:87], v[88:91]
    s_waitcnt lgkmcnt(4)
    v_mfma_f32_16x16x32_bf16 v[92:95], v[140:143], v[84:87], v[92:95]
    s_waitcnt lgkmcnt(3)
    v_mfma_f32_16x16x32_bf16 v[96:99], v[144:147], v[84:87], v[96:99]
    s_waitcnt lgkmcnt(2)
    v_mfma_f32_16x16x32_bf16 v[100:103], v[148:151], v[84:87], v[100:103]
    s_waitcnt lgkmcnt(1)
    v_mfma_f32_16x16x32_bf16 v[104:107], v[152:155], v[84:87], v[104:107]
    s_waitcnt lgkmcnt(0)
    v_mfma_f32_16x16x32_bf16 v[108:111], v[156:159], v[84:87], v[108:111]
    s_waitcnt vmcnt(2)
    v_lshlrev_b32 v16, 16, v160
    v_and_b32 v17, 0xffff0000, v160
    v_lshlrev_b32 v18, 16, v161
    v_and_b32 v19, 0xffff0000, v161
    v_lshlrev_b32 v20, 16, v162
    v_and_b32 v21, 0xffff0000, v162
    v_lshlrev_b32 v22, 16, v163
    v_and_b32 v23, 0xffff0000, v163
    s_waitcnt vmcnt(1)
    v_lshlrev_b32 v24, 16, v164
    v_and_b32 v25, 0xffff0000, v164
    v_lshlrev_b32 v26, 16, v165
    v_and_b32 v27, 0xffff0000, v165
    v_lshlrev_b32 v28, 16, v166
    v_and_b32 v29, 0xffff0000, v166
    v_lshlrev_b32 v30, 16, v167
    v_and_b32 v31, 0xffff0000, v167
    s_waitcnt vmcnt(0)
    v_lshlrev_b32 v32, 16, v168
    v_and_b32 v33, 0xffff0000, v168
    v_lshlrev_b32 v34, 16, v169
    v_and_b32 v35, 0xffff0000, v169
    v_lshlrev_b32 v36, 16, v170
    v_and_b32 v37, 0xffff0000, v170
    v_lshlrev_b32 v38, 16, v171
    v_and_b32 v39, 0xffff0000, v171
    v_add_f32 v16, v16, v88
    v_add_f32 v17, v17, v89
    v_add_f32 v18, v18, v90
    v_add_f32 v19, v19, v91
    v_add_f32 v20, v20, v92
    v_add_f32 v21, v21, v93
    v_add_f32 v22, v22, v94
    v_add_f32 v23, v23, v95
    v_add_f32 v24, v24, v96
    v_add_f32 v25, v25, v97
    v_add_f32 v26, v26, v98
    v_add_f32 v27, v27, v99
    v_add_f32 v28, v28, v100
    v_add_f32 v29, v29, v101
    v_add_f32 v30, v30, v102
    v_add_f32 v31, v31, v103
    v_add_f32 v32, v32, v104
    v_add_f32 v33, v33, v105
    v_add_f32 v34, v34, v106
    v_add_f32 v35, v35, v107
    v_add_f32 v36, v36, v108
    v_add_f32 v37, v37, v109
    v_add_f32 v38, v38, v110
    v_add_f32 v39, v39, v111
    s_mul_i32 s52, s46, 18
    s_mul_i32 s53, s45, 3
    s_add_u32 s52, s52, s53
    s_lshl_b32 s52, s52, 10
    s_add_u32 s52, s52, 25690112
    v_cvt_pk_bf16_f32 v40, v16, v17
    v_cvt_pk_bf16_f32 v41, v18, v19
    v_cvt_pk_bf16_f32 v42, v20, v21
    v_cvt_pk_bf16_f32 v43, v22, v23
    buffer_store_dwordx4 v[40:43], v2, s[4:7], s52 offen offset:0 sc1
    v_cvt_pk_bf16_f32 v44, v24, v25
    v_cvt_pk_bf16_f32 v45, v26, v27
    v_cvt_pk_bf16_f32 v46, v28, v29
    v_cvt_pk_bf16_f32 v47, v30, v31
    buffer_store_dwordx4 v[44:47], v2, s[4:7], s52 offen offset:1024 sc1
    v_cvt_pk_bf16_f32 v48, v32, v33
    v_cvt_pk_bf16_f32 v49, v34, v35
    v_cvt_pk_bf16_f32 v50, v36, v37
    v_cvt_pk_bf16_f32 v51, v38, v39
    buffer_store_dwordx4 v[48:51], v2, s[4:7], s52 offen offset:2048 sc1
    v_lshlrev_b32 v16, 16, v40
    v_and_b32 v17, 0xffff0000, v40
    v_lshlrev_b32 v18, 16, v41
    v_and_b32 v19, 0xffff0000, v41
    v_lshlrev_b32 v20, 16, v42
    v_and_b32 v21, 0xffff0000, v42
    v_lshlrev_b32 v22, 16, v43
    v_and_b32 v23, 0xffff0000, v43
    v_lshlrev_b32 v24, 16, v44
    v_and_b32 v25, 0xffff0000, v44
    v_lshlrev_b32 v26, 16, v45
    v_and_b32 v27, 0xffff0000, v45
    v_lshlrev_b32 v28, 16, v46
    v_and_b32 v29, 0xffff0000, v46
    v_lshlrev_b32 v30, 16, v47
    v_and_b32 v31, 0xffff0000, v47
    v_lshlrev_b32 v32, 16, v48
    v_and_b32 v33, 0xffff0000, v48
    v_lshlrev_b32 v34, 16, v49
    v_and_b32 v35, 0xffff0000, v49
    v_lshlrev_b32 v36, 16, v50
    v_and_b32 v37, 0xffff0000, v50
    v_lshlrev_b32 v38, 16, v51
    v_and_b32 v39, 0xffff0000, v51
    v_add_f32 v56, v16, v17
    v_add_f32 v58, v18, v19
    v_add_f32 v56, v56, v20
    v_add_f32 v58, v58, v21
    v_add_f32 v56, v56, v22
    v_add_f32 v58, v58, v23
    v_add_f32 v56, v56, v24
    v_add_f32 v58, v58, v25
    v_add_f32 v56, v56, v26
    v_add_f32 v58, v58, v27
    v_add_f32 v56, v56, v28
    v_add_f32 v58, v58, v29
    v_add_f32 v56, v56, v30
    v_add_f32 v58, v58, v31
    v_add_f32 v56, v56, v32
    v_add_f32 v58, v58, v33
    v_add_f32 v56, v56, v34
    v_add_f32 v58, v58, v35
    v_add_f32 v56, v56, v36
    v_add_f32 v58, v58, v37
    v_add_f32 v56, v56, v38
    v_add_f32 v58, v58, v39
    v_add_f32 v56, v56, v58
    v_mov_b32 v58, v56
    s_nop 1
    v_permlane16_swap_b32 v56, v58
    v_add_f32 v56, v56, v58
    v_mov_b32 v58, v56
    s_nop 1
    v_permlane32_swap_b32 v56, v58
    v_add_f32 v56, v56, v58
    v_mul_f32 v59, 0x3c2aaaab, v56
    v_sub_f32 v58, v16, v59
    v_mul_f32 v57, v58, v58
    v_sub_f32 v61, v17, v59
    v_fmac_f32 v57, v61, v61
    v_sub_f32 v60, v18, v59
    v_fmac_f32 v57, v60, v60
    v_sub_f32 v61, v19, v59
    v_fmac_f32 v57, v61, v61
    v_sub_f32 v60, v20, v59
    v_fmac_f32 v57, v60, v60
    v_sub_f32 v61, v21, v59
    v_fmac_f32 v57, v61, v61
    v_sub_f32 v60, v22, v59
    v_fmac_f32 v57, v60, v60
    v_sub_f32 v61, v23, v59
    v_fmac_f32 v57, v61, v61
    v_sub_f32 v60, v24, v59
    v_fmac_f32 v57, v60, v60
    v_sub_f32 v61, v25, v59
    v_fmac_f32 v57, v61, v61
    v_sub_f32 v60, v26, v59
    v_fmac_f32 v57, v60, v60
    v_sub_f32 v61, v27, v59
    v_fmac_f32 v57, v61, v61
    v_sub_f32 v60, v28, v59
    v_fmac_f32 v57, v60, v60
    v_sub_f32 v61, v29, v59
    v_fmac_f32 v57, v61, v61
    v_sub_f32 v60, v30, v59
    v_fmac_f32 v57, v60, v60
    v_sub_f32 v61, v31, v59
    v_fmac_f32 v57, v61, v61
    v_sub_f32 v60, v32, v59
    v_fmac_f32 v57, v60, v60
    v_sub_f32 v61, v33, v59
    v_fmac_f32 v57, v61, v61
    v_sub_f32 v60, v34, v59
    v_fmac_f32 v57, v60, v60
    v_sub_f32 v61, v35, v59
    v_fmac_f32 v57, v61, v61
    v_sub_f32 v60, v36, v59
    v_fmac_f32 v57, v60, v60
    v_sub_f32 v61, v37, v59
    v_fmac_f32 v57, v61, v61
    v_sub_f32 v60, v38, v59
    v_fmac_f32 v57, v60, v60
    v_sub_f32 v61, v39, v59
    v_fmac_f32 v57, v61, v61
    v_mov_b32 v58, v57
    s_nop 1
    v_permlane16_swap_b32 v57, v58
    v_add_f32 v57, v57, v58
    v_mov_b32 v58, v57
    s_nop 1
    v_permlane32_swap_b32 v57, v58
    v_add_f32 v57, v57, v58
    s_lshl_b32 s52, s45, 14
    s_add_u32 s52, s52, 28049408
    s_mov_b32 exec_lo, 0xffff
    s_mov_b32 exec_hi, 0
    buffer_store_dwordx2 v[56:57], v7, s[4:7], s52 offen sc1
    s_mov_b64 exec, -1
    s_lshl_b32 s52, s46, 3
    s_add_u32 s52, s52, s45
    s_lshl_b32 s52, s52, 3
    s_add_u32 s52, s52, 3964928
    v_mov_b32 v8, s98
    v_mov_b32 v9, s99
    s_waitcnt vmcnt(0)
    s_mov_b64 exec, 1
    buffer_store_dwordx2 v[8:9], off, s[4:7], s52 sc1
    s_mov_b64 exec, -1
    s_branch L_ffn_23
L_idle0_22:
    s_mul_i32 s66, s20, 27648
    s_add_u32 s67, s66, 9216
    s_add_u32 s68, s67, 9216
    s_sub_u32 s23, s22, 24
    s_lshl_b32 s23, s23, 2
    s_add_u32 s23, s23, s20
    s_mul_i32 s69, s21, 72
    s_add_u32 s69, s69, s23
    s_add_u32 s69, s69, 1152
    s_mul_i32 s70, s20, 9216
    s_add_u32 s70, s70, 110592
    v_add_u32 v64, s70, v2
    ds_write_b128 v64, a[144:147] offset:0
    ds_write_b128 v64, a[148:151] offset:1024
    ds_write_b128 v64, a[152:155] offset:2048
    ds_write_b128 v64, a[156:159] offset:3072
    ds_write_b128 v64, a[160:163] offset:4096
    ds_write_b128 v64, a[164:167] offset:5120
    ds_write_b128 v64, a[168:171] offset:6144
    ds_write_b128 v64, a[172:175] offset:7168
    ds_write_b128 v64, a[176:179] offset:8192
    v_lshrrev_b32 v65, 4, v1
    v_bfe_u32 v66, v1, 2, 2
    v_lshl_add_u32 v65, v65, 3, v66
    v_mul_u32_u24 v65, 288, v65
    v_add_u32 v65, s70, v65
    v_and_b32 v66, 3, v1
    v_lshl_add_u32 v64, v66, 4, v65
    v_lshl_add_u32 v65, v66, 3, v65
    v_mov_b32 v68, 0x3f803f80
    v_mov_b32 v69, 0x3f803f80
    v_mov_b32 v70, 0x3f803f80
    v_mov_b32 v71, 0x3f803f80
    ds_read_b64_tr_b16 v[72:73], v64 offset:0
    ds_read_b64_tr_b16 v[74:75], v64 offset:1152
    ds_read_b64_tr_b16 v[76:77], v64 offset:8
    ds_read_b64_tr_b16 v[78:79], v64 offset:1160
    ds_read_b64_tr_b16 v[80:81], v64 offset:64
    ds_read_b64_tr_b16 v[82:83], v64 offset:1216
    ds_read_b64_tr_b16 v[84:85], v64 offset:72
    ds_read_b64_tr_b16 v[86:87], v64 offset:1224
    ds_read_b64_tr_b16 v[88:89], v64 offset:128
    ds_read_b64_tr_b16 v[90:91], v64 offset:1280
    ds_read_b64_tr_b16 v[92:93], v64 offset:136
    ds_read_b64_tr_b16 v[94:95], v64 offset:1288
    ds_read_b64_tr_b16 v[96:97], v64 offset:192
    ds_read_b64_tr_b16 v[98:99], v64 offset:1344
    ds_read_b64_tr_b16 v[100:101], v64 offset:200
    ds_read_b64_tr_b16 v[102:103], v64 offset:1352
    ds_read_b64_tr_b16 v[104:105], v65 offset:256
    ds_read_b64_tr_b16 v[106:107], v65 offset:1408
    s_add_u32 s71, s59, 36864
    s_waitcnt lgkmcnt(15)
    buffer_store_dwordx4 v[72:75], v2, s[4:7], s71 offen sc1
    v_mfma_f32_16x16x32_bf16 v[108:111], v[72:75], v[68:71], 0
    s_add_u32 s71, s59, 73728
    s_waitcnt lgkmcnt(14)
    buffer_store_dwordx4 v[76:79], v2, s[4:7], s71 offen sc1
    v_mfma_f32_16x16x32_bf16 v[112:115], v[76:79], v[68:71], 0
    s_add_u32 s71, s59, 110592
    s_waitcnt lgkmcnt(12)
    buffer_store_dwordx4 v[80:83], v2, s[4:7], s71 offen sc1
    v_mfma_f32_16x16x32_bf16 v[116:119], v[80:83], v[68:71], 0
    s_add_u32 s71, s59, 147456
    s_waitcnt lgkmcnt(10)
    buffer_store_dwordx4 v[84:87], v2, s[4:7], s71 offen sc1
    v_mfma_f32_16x16x32_bf16 v[120:123], v[84:87], v[68:71], 0
    s_add_u32 s71, s59, 184320
    s_waitcnt lgkmcnt(8)
    buffer_store_dwordx4 v[88:91], v2, s[4:7], s71 offen sc1
    v_mfma_f32_16x16x32_bf16 v[124:127], v[88:91], v[68:71], 0
    s_add_u32 s71, s59, 221184
    s_waitcnt lgkmcnt(6)
    buffer_store_dwordx4 v[92:95], v2, s[4:7], s71 offen sc1
    v_mfma_f32_16x16x32_bf16 v[128:131], v[92:95], v[68:71], 0
    s_add_u32 s71, s59, 258048
    s_waitcnt lgkmcnt(4)
    buffer_store_dwordx4 v[96:99], v2, s[4:7], s71 offen sc1
    v_mfma_f32_16x16x32_bf16 v[132:135], v[96:99], v[68:71], 0
    s_add_u32 s71, s59, 294912
    s_waitcnt lgkmcnt(2)
    buffer_store_dwordx4 v[100:103], v2, s[4:7], s71 offen sc1
    v_mfma_f32_16x16x32_bf16 v[136:139], v[100:103], v[68:71], 0
    s_add_u32 s71, s59, 0
    s_waitcnt lgkmcnt(0)
    buffer_store_dwordx4 v[104:107], v2, s[4:7], s71 offen sc1
    v_mfma_f32_16x16x32_bf16 v[140:143], v[104:107], v[68:71], 0
    v_and_b32 v66, 15, v1
    v_cmp_eq_u32 vcc, 1, v66
    s_nop 1
    v_cndmask_b32 v108, v108, v112, vcc
    v_cndmask_b32 v109, v109, v113, vcc
    v_cndmask_b32 v110, v110, v114, vcc
    v_cndmask_b32 v111, v111, v115, vcc
    v_cmp_eq_u32 vcc, 2, v66
    s_nop 1
    v_cndmask_b32 v108, v108, v116, vcc
    v_cndmask_b32 v109, v109, v117, vcc
    v_cndmask_b32 v110, v110, v118, vcc
    v_cndmask_b32 v111, v111, v119, vcc
    v_cmp_eq_u32 vcc, 3, v66
    s_nop 1
    v_cndmask_b32 v108, v108, v120, vcc
    v_cndmask_b32 v109, v109, v121, vcc
    v_cndmask_b32 v110, v110, v122, vcc
    v_cndmask_b32 v111, v111, v123, vcc
    v_cmp_eq_u32 vcc, 4, v66
    s_nop 1
    v_cndmask_b32 v108, v108, v124, vcc
    v_cndmask_b32 v109, v109, v125, vcc
    v_cndmask_b32 v110, v110, v126, vcc
    v_cndmask_b32 v111, v111, v127, vcc
    v_cmp_eq_u32 vcc, 5, v66
    s_nop 1
    v_cndmask_b32 v108, v108, v128, vcc
    v_cndmask_b32 v109, v109, v129, vcc
    v_cndmask_b32 v110, v110, v130, vcc
    v_cndmask_b32 v111, v111, v131, vcc
    v_cmp_eq_u32 vcc, 6, v66
    s_nop 1
    v_cndmask_b32 v108, v108, v132, vcc
    v_cndmask_b32 v109, v109, v133, vcc
    v_cndmask_b32 v110, v110, v134, vcc
    v_cndmask_b32 v111, v111, v135, vcc
    v_cmp_eq_u32 vcc, 7, v66
    s_nop 1
    v_cndmask_b32 v108, v108, v136, vcc
    v_cndmask_b32 v109, v109, v137, vcc
    v_cndmask_b32 v110, v110, v138, vcc
    v_cndmask_b32 v111, v111, v139, vcc
    v_cmp_eq_u32 vcc, 8, v66
    s_nop 1
    v_cndmask_b32 v108, v108, v140, vcc
    v_cndmask_b32 v109, v109, v141, vcc
    v_cndmask_b32 v110, v110, v142, vcc
    v_cndmask_b32 v111, v111, v143, vcc
    v_add_u32 v67, 1, v66
    v_cmp_gt_u32 vcc, 8, v66
    s_nop 1
    v_cndmask_b32 v67, 0, v67, vcc
    v_lshlrev_b32 v67, 6, v67
    v_and_b32 v64, 48, v1
    v_add_u32 v67, v67, v64
    s_mov_b32 exec_lo, 0x01ff01ff
    s_mov_b32 exec_hi, 0x01ff01ff
    buffer_store_dwordx4 v[108:111], v67, s[4:7], s60 offen sc1
    s_mov_b64 exec, -1
    s_cmp_ge_u32 s20, 2
    s_cbranch_scc1 L_one_32
    v_add_u32 v64, s70, v2
    ds_write_b128 v64, a[180:183] offset:0
    ds_write_b128 v64, a[184:187] offset:1024
    ds_write_b128 v64, a[188:191] offset:2048
    ds_write_b128 v64, a[192:195] offset:3072
    ds_write_b128 v64, a[196:199] offset:4096
    ds_write_b128 v64, a[200:203] offset:5120
    ds_write_b128 v64, a[204:207] offset:6144
    ds_write_b128 v64, a[208:211] offset:7168
    ds_write_b128 v64, a[212:215] offset:8192
    v_lshrrev_b32 v65, 4, v1
    v_bfe_u32 v66, v1, 2, 2
    v_lshl_add_u32 v65, v65, 3, v66
    v_mul_u32_u24 v65, 288, v65
    v_add_u32 v65, s70, v65
    v_and_b32 v66, 3, v1
    v_lshl_add_u32 v64, v66, 4, v65
    v_lshl_add_u32 v65, v66, 3, v65
    v_mov_b32 v68, 0x3f803f80
    v_mov_b32 v69, 0x3f803f80
    v_mov_b32 v70, 0x3f803f80
    v_mov_b32 v71, 0x3f803f80
    ds_read_b64_tr_b16 v[72:73], v64 offset:0
    ds_read_b64_tr_b16 v[74:75], v64 offset:1152
    ds_read_b64_tr_b16 v[76:77], v64 offset:8
    ds_read_b64_tr_b16 v[78:79], v64 offset:1160
    ds_read_b64_tr_b16 v[80:81], v64 offset:64
    ds_read_b64_tr_b16 v[82:83], v64 offset:1216
    ds_read_b64_tr_b16 v[84:85], v64 offset:72
    ds_read_b64_tr_b16 v[86:87], v64 offset:1224
    ds_read_b64_tr_b16 v[88:89], v64 offset:128
    ds_read_b64_tr_b16 v[90:91], v64 offset:1280
    ds_read_b64_tr_b16 v[92:93], v64 offset:136
    ds_read_b64_tr_b16 v[94:95], v64 offset:1288
    ds_read_b64_tr_b16 v[96:97], v64 offset:192
    ds_read_b64_tr_b16 v[98:99], v64 offset:1344
    ds_read_b64_tr_b16 v[100:101], v64 offset:200
    ds_read_b64_tr_b16 v[102:103], v64 offset:1352
    ds_read_b64_tr_b16 v[104:105], v65 offset:256
    ds_read_b64_tr_b16 v[106:107], v65 offset:1408
    s_add_u32 s71, s63, 36864
    s_waitcnt lgkmcnt(15)
    buffer_store_dwordx4 v[72:75], v2, s[4:7], s71 offen sc1
    v_mfma_f32_16x16x32_bf16 v[108:111], v[72:75], v[68:71], 0
    s_add_u32 s71, s63, 73728
    s_waitcnt lgkmcnt(14)
    buffer_store_dwordx4 v[76:79], v2, s[4:7], s71 offen sc1
    v_mfma_f32_16x16x32_bf16 v[112:115], v[76:79], v[68:71], 0
    s_add_u32 s71, s63, 110592
    s_waitcnt lgkmcnt(12)
    buffer_store_dwordx4 v[80:83], v2, s[4:7], s71 offen sc1
    v_mfma_f32_16x16x32_bf16 v[116:119], v[80:83], v[68:71], 0
    s_add_u32 s71, s63, 147456
    s_waitcnt lgkmcnt(10)
    buffer_store_dwordx4 v[84:87], v2, s[4:7], s71 offen sc1
    v_mfma_f32_16x16x32_bf16 v[120:123], v[84:87], v[68:71], 0
    s_add_u32 s71, s63, 184320
    s_waitcnt lgkmcnt(8)
    buffer_store_dwordx4 v[88:91], v2, s[4:7], s71 offen sc1
    v_mfma_f32_16x16x32_bf16 v[124:127], v[88:91], v[68:71], 0
    s_add_u32 s71, s63, 221184
    s_waitcnt lgkmcnt(6)
    buffer_store_dwordx4 v[92:95], v2, s[4:7], s71 offen sc1
    v_mfma_f32_16x16x32_bf16 v[128:131], v[92:95], v[68:71], 0
    s_add_u32 s71, s63, 258048
    s_waitcnt lgkmcnt(4)
    buffer_store_dwordx4 v[96:99], v2, s[4:7], s71 offen sc1
    v_mfma_f32_16x16x32_bf16 v[132:135], v[96:99], v[68:71], 0
    s_add_u32 s71, s63, 294912
    s_waitcnt lgkmcnt(2)
    buffer_store_dwordx4 v[100:103], v2, s[4:7], s71 offen sc1
    v_mfma_f32_16x16x32_bf16 v[136:139], v[100:103], v[68:71], 0
    s_add_u32 s71, s63, 0
    s_waitcnt lgkmcnt(0)
    buffer_store_dwordx4 v[104:107], v2, s[4:7], s71 offen sc1
    v_mfma_f32_16x16x32_bf16 v[140:143], v[104:107], v[68:71], 0
    v_and_b32 v66, 15, v1
    v_cmp_eq_u32 vcc, 1, v66
    s_nop 1
    v_cndmask_b32 v108, v108, v112, vcc
    v_cndmask_b32 v109, v109, v113, vcc
    v_cndmask_b32 v110, v110, v114, vcc
    v_cndmask_b32 v111, v111, v115, vcc
    v_cmp_eq_u32 vcc, 2, v66
    s_nop 1
    v_cndmask_b32 v108, v108, v116, vcc
    v_cndmask_b32 v109, v109, v117, vcc
    v_cndmask_b32 v110, v110, v118, vcc
    v_cndmask_b32 v111, v111, v119, vcc
    v_cmp_eq_u32 vcc, 3, v66
    s_nop 1
    v_cndmask_b32 v108, v108, v120, vcc
    v_cndmask_b32 v109, v109, v121, vcc
    v_cndmask_b32 v110, v110, v122, vcc
    v_cndmask_b32 v111, v111, v123, vcc
    v_cmp_eq_u32 vcc, 4, v66
    s_nop 1
    v_cndmask_b32 v108, v108, v124, vcc
    v_cndmask_b32 v109, v109, v125, vcc
    v_cndmask_b32 v110, v110, v126, vcc
    v_cndmask_b32 v111, v111, v127, vcc
    v_cmp_eq_u32 vcc, 5, v66
    s_nop 1
    v_cndmask_b32 v108, v108, v128, vcc
    v_cndmask_b32 v109, v109, v129, vcc
    v_cndmask_b32 v110, v110, v130, vcc
    v_cndmask_b32 v111, v111, v131, vcc
    v_cmp_eq_u32 vcc, 6, v66
    s_nop 1
    v_cndmask_b32 v108, v108, v132, vcc
    v_cndmask_b32 v109, v109, v133, vcc
    v_cndmask_b32 v110, v110, v134, vcc
    v_cndmask_b32 v111, v111, v135, vcc
    v_cmp_eq_u32 vcc, 7, v66
    s_nop 1
    v_cndmask_b32 v108, v108, v136, vcc
    v_cndmask_b32 v109, v109, v137, vcc
    v_cndmask_b32 v110, v110, v138, vcc
    v_cndmask_b32 v111, v111, v139, vcc
    v_cmp_eq_u32 vcc, 8, v66
    s_nop 1
    v_cndmask_b32 v108, v108, v140, vcc
    v_cndmask_b32 v109, v109, v141, vcc
    v_cndmask_b32 v110, v110, v142, vcc
    v_cndmask_b32 v111, v111, v143, vcc
    v_add_u32 v67, 1, v66
    v_cmp_gt_u32 vcc, 8, v66
    s_nop 1
    v_cndmask_b32 v67, 0, v67, vcc
    v_lshlrev_b32 v67, 6, v67
    v_and_b32 v64, 48, v1
    v_add_u32 v67, v67, v64
    s_mov_b32 exec_lo, 0x01ff01ff
    s_mov_b32 exec_hi, 0x01ff01ff
    buffer_store_dwordx4 v[108:111], v67, s[4:7], s64 offen sc1
    s_mov_b64 exec, -1
    v_mov_b32 v8, s98
    v_mov_b32 v9, s99
    s_waitcnt vmcnt(0)
    s_mov_b64 exec, 1
    buffer_store_dwordx2 v[8:9], off, s[4:7], s65 sc1
    s_mov_b64 exec, -1
L_one_32:
    v_mov_b32 v8, s98
    v_mov_b32 v9, s99
    s_waitcnt vmcnt(0)
    s_mov_b64 exec, 1
    buffer_store_dwordx2 v[8:9], off, s[4:7], s61 sc1
    s_mov_b64 exec, -1
L_ud_33:
    s_sub_u32 s90, s69, 1152
    s_mul_i32 s50, s90, 3641
    s_lshr_b32 s50, s50, 16
    s_mul_i32 s91, s50, 18
    s_sub_u32 s90, s90, s91
    s_mov_b32 s12, s36
    s_mov_b32 s13, s37
    s_mov_b32 s51, 0
    s_mov_b32 s47, 1152
    s_and_b32 s91, s50, 3
    s_and_b32 s92, s91, 1
    s_lshl_b32 s48, s92, 5
    s_cmp_eq_u32 s92, 0
    s_cselect_b32 s49, 256, 0
    s_mov_b32 s95, -165888
    s_cselect_b32 s95, 165888, s95
    s_mov_b32 s45, 9216
    s_mov_b32 s46, 4608
    s_cmp_ge_u32 s90, 4
    s_cbranch_scc1 L_ush_35
    s_mov_b32 s93, s91
    s_lshl_b32 s94, s90, 5
    s_branch L_urows_37
L_ush_35:
    s_cmp_ge_u32 s90, 6
    s_cbranch_scc1 L_urm_36
    s_sub_u32 s93, s90, 4
    s_lshl_b32 s93, s93, 1
    s_xor_b32 s93, s93, s91
    s_mov_b32 s94, 128
    s_mov_b32 s45, 4608
    s_mov_b32 s46, s95
    s_branch L_urows_37
L_urm_36:
    s_sub_u32 s93, s90, 6
    s_mul_i32 s94, s93, 21846
    s_lshr_b32 s94, s94, 16
    s_mul_i32 s95, s94, 3
    s_sub_u32 s93, s93, s95
    s_add_u32 s93, s93, 1
    s_xor_b32 s93, s93, s91
    s_lshl_b32 s94, s94, 5
L_urows_37:
    s_mul_i32 s93, s93, 144
    s_add_u32 s93, s93, s94
    s_lshr_b32 s94, s50, 2
    s_mul_i32 s94, s94, 576
    s_add_u32 s93, s93, s94
    s_mul_i32 s93, s93, 1152
    s_mul_i32 s94, s91, 288
    s_add_u32 s44, s93, s94
    s_mul_i32 s93, s50, 486
    s_add_u32 s93, s93, 324
    s_lshl_b32 s93, s93, 10
    s_add_u32 s93, s93, 4194304
    s_cmp_ge_u32 s90, 3
    s_cbranch_scc1 L_ub_38
    s_sub_u32 s94, s90, 0
    s_mul_i32 s95, s94, 4096
    s_add_u32 s95, s95, 0
    s_add_u32 s52, s95, s93
    s_mul_i32 s95, s94, 4096
    s_add_u32 s95, s95, 1024
    s_add_u32 s53, s95, s93
    s_mul_i32 s95, s94, 4096
    s_add_u32 s95, s95, 2048
    s_add_u32 s54, s95, s93
    s_mul_i32 s95, s94, 4096
    s_add_u32 s95, s95, 3072
    s_add_u32 s55, s95, s93
    s_mul_i32 s95, s94, 5120
    s_add_u32 s95, s95, 12288
    s_add_u32 s56, s95, s93
    s_mul_i32 s95, s94, 5120
    s_add_u32 s95, s95, 13312
    s_add_u32 s57, s95, s93
    s_mul_i32 s95, s94, 5120
    s_add_u32 s95, s95, 14336
    s_add_u32 s58, s95, s93
    s_mul_i32 s95, s94, 5120
    s_add_u32 s95, s95, 15360
    s_add_u32 s59, s95, s93
    s_mul_i32 s95, s94, 5120
    s_add_u32 s95, s95, 16384
    s_add_u32 s60, s95, s93
    s_branch L_udone_34
L_ub_38:
    s_cmp_ge_u32 s90, 9
    s_cbranch_scc1 L_uc_39
    s_sub_u32 s94, s90, 3
    s_mul_i32 s95, s94, 9216
    s_add_u32 s95, s95, 27648
    s_add_u32 s52, s95, s93
    s_mul_i32 s95, s94, 9216
    s_add_u32 s95, s95, 28672
    s_add_u32 s53, s95, s93
    s_mul_i32 s95, s94, 9216
    s_add_u32 s95, s95, 29696
    s_add_u32 s54, s95, s93
    s_mul_i32 s95, s94, 9216
    s_add_u32 s95, s95, 30720
    s_add_u32 s55, s95, s93
    s_mul_i32 s95, s94, 9216
    s_add_u32 s95, s95, 31744
    s_add_u32 s56, s95, s93
    s_mul_i32 s95, s94, 9216
    s_add_u32 s95, s95, 32768
    s_add_u32 s57, s95, s93
    s_mul_i32 s95, s94, 9216
    s_add_u32 s95, s95, 33792
    s_add_u32 s58, s95, s93
    s_mul_i32 s95, s94, 9216
    s_add_u32 s95, s95, 34816
    s_add_u32 s59, s95, s93
    s_mul_i32 s95, s94, 9216
    s_add_u32 s95, s95, 35840
    s_add_u32 s60, s95, s93
    s_branch L_udone_34
L_uc_39:
    s_sub_u32 s94, s90, 9
    s_mul_i32 s95, s94, 2048
    s_add_u32 s95, s95, 82944
    s_add_u32 s52, s95, s93
    s_mul_i32 s95, s94, 2048
    s_add_u32 s95, s95, 83968
    s_add_u32 s53, s95, s93
    s_mul_i32 s95, s94, 2048
    s_add_u32 s95, s95, 101376
    s_add_u32 s54, s95, s93
    s_mul_i32 s95, s94, 2048
    s_add_u32 s95, s95, 102400
    s_add_u32 s55, s95, s93
    s_mul_i32 s95, s94, 2048
    s_add_u32 s95, s95, 119808
    s_add_u32 s56, s95, s93
    s_mul_i32 s95, s94, 2048
    s_add_u32 s95, s95, 120832
    s_add_u32 s57, s95, s93
    s_mul_i32 s95, s94, 2048
    s_add_u32 s95, s95, 138240
    s_add_u32 s58, s95, s93
    s_mul_i32 s95, s94, 2048
    s_add_u32 s95, s95, 139264
    s_add_u32 s59, s95, s93
    s_mul_i32 s95, s94, 1024
    s_add_u32 s95, s95, 156672
    s_add_u32 s60, s95, s93
L_udone_34:
    s_mov_b32 s14, 0x510000
    s_mov_b32 s15, 0x20000
    s_lshl_b32 s51, s50, 6
    s_add_u32 s51, s51, s90
    s_lshl_b32 s51, s51, 3
    s_add_u32 s51, s51, 4071712
    v_add_u32 v64, 0, v1
    v_mul_u32_u24 v65, 3641, v64
    v_lshrrev_b32 v65, 16, v65
    v_mul_u32_u24 v66, 18, v65
    v_sub_u32 v64, v64, v66
    v_lshlrev_b32 v64, 4, v64
    v_lshrrev_b32 v66, 3, v65
    v_mul_lo_u32 v66, v66, s45
    v_bfe_u32 v67, v65, 2, 1
    v_mul_lo_u32 v67, v67, s46
    v_and_b32 v65, 3, v65
    v_mul_lo_u32 v65, v65, s47
    v_add3_u32 v64, v64, v66, v67
    v_add3_u32 v64, v64, v65, s44
    s_add_u32 m0, s66, 0
    s_nop 0
    buffer_load_dwordx4 v64, s[12:15], 0 offen lds
    v_add_u32 v64, 64, v1
    v_mul_u32_u24 v65, 3641, v64
    v_lshrrev_b32 v65, 16, v65
    v_mul_u32_u24 v66, 18, v65
    v_sub_u32 v64, v64, v66
    v_lshlrev_b32 v64, 4, v64
    v_lshrrev_b32 v66, 3, v65
    v_mul_lo_u32 v66, v66, s45
    v_bfe_u32 v67, v65, 2, 1
    v_mul_lo_u32 v67, v67, s46
    v_and_b32 v65, 3, v65
    v_mul_lo_u32 v65, v65, s47
    v_add3_u32 v64, v64, v66, v67
    v_add3_u32 v64, v64, v65, s44
    s_add_u32 m0, s66, 1024
    s_nop 0
    buffer_load_dwordx4 v64, s[12:15], 0 offen lds
    v_add_u32 v64, 128, v1
    v_mul_u32_u24 v65, 3641, v64
    v_lshrrev_b32 v65, 16, v65
    v_mul_u32_u24 v66, 18, v65
    v_sub_u32 v64, v64, v66
    v_lshlrev_b32 v64, 4, v64
    v_lshrrev_b32 v66, 3, v65
    v_mul_lo_u32 v66, v66, s45
    v_bfe_u32 v67, v65, 2, 1
    v_mul_lo_u32 v67, v67, s46
    v_and_b32 v65, 3, v65
    v_mul_lo_u32 v65, v65, s47
    v_add3_u32 v64, v64, v66, v67
    v_add3_u32 v64, v64, v65, s44
    s_add_u32 m0, s66, 2048
    s_nop 0
    buffer_load_dwordx4 v64, s[12:15], 0 offen lds
    v_add_u32 v64, 192, v1
    v_mul_u32_u24 v65, 3641, v64
    v_lshrrev_b32 v65, 16, v65
    v_mul_u32_u24 v66, 18, v65
    v_sub_u32 v64, v64, v66
    v_lshlrev_b32 v64, 4, v64
    v_lshrrev_b32 v66, 3, v65
    v_mul_lo_u32 v66, v66, s45
    v_bfe_u32 v67, v65, 2, 1
    v_mul_lo_u32 v67, v67, s46
    v_and_b32 v65, 3, v65
    v_mul_lo_u32 v65, v65, s47
    v_add3_u32 v64, v64, v66, v67
    v_add3_u32 v64, v64, v65, s44
    s_add_u32 m0, s66, 3072
    s_nop 0
    buffer_load_dwordx4 v64, s[12:15], 0 offen lds
    v_add_u32 v64, 256, v1
    v_mul_u32_u24 v65, 3641, v64
    v_lshrrev_b32 v65, 16, v65
    v_mul_u32_u24 v66, 18, v65
    v_sub_u32 v64, v64, v66
    v_lshlrev_b32 v64, 4, v64
    v_lshrrev_b32 v66, 3, v65
    v_mul_lo_u32 v66, v66, s45
    v_bfe_u32 v67, v65, 2, 1
    v_mul_lo_u32 v67, v67, s46
    v_and_b32 v65, 3, v65
    v_mul_lo_u32 v65, v65, s47
    v_add3_u32 v64, v64, v66, v67
    v_add3_u32 v64, v64, v65, s44
    s_add_u32 m0, s66, 4096
    s_nop 0
    buffer_load_dwordx4 v64, s[12:15], 0 offen lds
    v_add_u32 v64, 320, v1
    v_mul_u32_u24 v65, 3641, v64
    v_lshrrev_b32 v65, 16, v65
    v_mul_u32_u24 v66, 18, v65
    v_sub_u32 v64, v64, v66
    v_lshlrev_b32 v64, 4, v64
    v_lshrrev_b32 v66, 3, v65
    v_mul_lo_u32 v66, v66, s45
    v_bfe_u32 v67, v65, 2, 1
    v_mul_lo_u32 v67, v67, s46
    v_and_b32 v65, 3, v65
    v_mul_lo_u32 v65, v65, s47
    v_add3_u32 v64, v64, v66, v67
    v_add3_u32 v64, v64, v65, s44
    s_add_u32 m0, s66, 5120
    s_nop 0
    buffer_load_dwordx4 v64, s[12:15], 0 offen lds
    v_add_u32 v64, 384, v1
    v_mul_u32_u24 v65, 3641, v64
    v_lshrrev_b32 v65, 16, v65
    v_mul_u32_u24 v66, 18, v65
    v_sub_u32 v64, v64, v66
    v_lshlrev_b32 v64, 4, v64
    v_lshrrev_b32 v66, 3, v65
    v_mul_lo_u32 v66, v66, s45
    v_bfe_u32 v67, v65, 2, 1
    v_mul_lo_u32 v67, v67, s46
    v_and_b32 v65, 3, v65
    v_mul_lo_u32 v65, v65, s47
    v_add3_u32 v64, v64, v66, v67
    v_add3_u32 v64, v64, v65, s44
    s_add_u32 m0, s66, 6144
    s_nop 0
    buffer_load_dwordx4 v64, s[12:15], 0 offen lds
    v_add_u32 v64, 448, v1
    v_mul_u32_u24 v65, 3641, v64
    v_lshrrev_b32 v65, 16, v65
    v_mul_u32_u24 v66, 18, v65
    v_sub_u32 v64, v64, v66
    v_lshlrev_b32 v64, 4, v64
    v_lshrrev_b32 v66, 3, v65
    v_mul_lo_u32 v66, v66, s45
    v_bfe_u32 v67, v65, 2, 1
    v_mul_lo_u32 v67, v67, s46
    v_and_b32 v65, 3, v65
    v_mul_lo_u32 v65, v65, s47
    v_add3_u32 v64, v64, v66, v67
    v_add3_u32 v64, v64, v65, s44
    s_add_u32 m0, s66, 7168
    s_nop 0
    buffer_load_dwordx4 v64, s[12:15], 0 offen lds
    v_add_u32 v64, 512, v1
    v_mul_u32_u24 v65, 3641, v64
    v_lshrrev_b32 v65, 16, v65
    v_mul_u32_u24 v66, 18, v65
    v_sub_u32 v64, v64, v66
    v_lshlrev_b32 v64, 4, v64
    v_lshrrev_b32 v66, 3, v65
    v_mul_lo_u32 v66, v66, s45
    v_bfe_u32 v67, v65, 2, 1
    v_mul_lo_u32 v67, v67, s46
    v_and_b32 v65, 3, v65
    v_mul_lo_u32 v65, v65, s47
    v_add3_u32 v64, v64, v66, v67
    v_add3_u32 v64, v64, v65, s44
    s_add_u32 m0, s66, 8192
    s_nop 0
    buffer_load_dwordx4 v64, s[12:15], 0 offen lds
    s_add_u32 s69, s69, 32
L_ud_40:
    s_sub_u32 s90, s69, 1152
    s_mul_i32 s78, s90, 3641
    s_lshr_b32 s78, s78, 16
    s_mul_i32 s91, s78, 18
    s_sub_u32 s90, s90, s91
    s_mov_b32 s16, s36
    s_mov_b32 s17, s37
    s_mov_b32 s79, 0
    s_mov_b32 s75, 1152
    s_and_b32 s91, s78, 3
    s_and_b32 s92, s91, 1
    s_lshl_b32 s76, s92, 5
    s_cmp_eq_u32 s92, 0
    s_cselect_b32 s77, 256, 0
    s_mov_b32 s95, -165888
    s_cselect_b32 s95, 165888, s95
    s_mov_b32 s73, 9216
    s_mov_b32 s74, 4608
    s_cmp_ge_u32 s90, 4
    s_cbranch_scc1 L_ush_42
    s_mov_b32 s93, s91
    s_lshl_b32 s94, s90, 5
    s_branch L_urows_44
L_ush_42:
    s_cmp_ge_u32 s90, 6
    s_cbranch_scc1 L_urm_43
    s_sub_u32 s93, s90, 4
    s_lshl_b32 s93, s93, 1
    s_xor_b32 s93, s93, s91
    s_mov_b32 s94, 128
    s_mov_b32 s73, 4608
    s_mov_b32 s74, s95
    s_branch L_urows_44
L_urm_43:
    s_sub_u32 s93, s90, 6
    s_mul_i32 s94, s93, 21846
    s_lshr_b32 s94, s94, 16
    s_mul_i32 s95, s94, 3
    s_sub_u32 s93, s93, s95
    s_add_u32 s93, s93, 1
    s_xor_b32 s93, s93, s91
    s_lshl_b32 s94, s94, 5
L_urows_44:
    s_mul_i32 s93, s93, 144
    s_add_u32 s93, s93, s94
    s_lshr_b32 s94, s78, 2
    s_mul_i32 s94, s94, 576
    s_add_u32 s93, s93, s94
    s_mul_i32 s93, s93, 1152
    s_mul_i32 s94, s91, 288
    s_add_u32 s72, s93, s94
    s_mul_i32 s93, s78, 486
    s_add_u32 s93, s93, 324
    s_lshl_b32 s93, s93, 10
    s_add_u32 s93, s93, 4194304
    s_cmp_ge_u32 s90, 3
    s_cbranch_scc1 L_ub_45
    s_sub_u32 s94, s90, 0
    s_mul_i32 s95, s94, 4096
    s_add_u32 s95, s95, 0
    s_add_u32 s80, s95, s93
    s_mul_i32 s95, s94, 4096
    s_add_u32 s95, s95, 1024
    s_add_u32 s81, s95, s93
    s_mul_i32 s95, s94, 4096
    s_add_u32 s95, s95, 2048
    s_add_u32 s82, s95, s93
    s_mul_i32 s95, s94, 4096
    s_add_u32 s95, s95, 3072
    s_add_u32 s83, s95, s93
    s_mul_i32 s95, s94, 5120
    s_add_u32 s95, s95, 12288
    s_add_u32 s84, s95, s93
    s_mul_i32 s95, s94, 5120
    s_add_u32 s95, s95, 13312
    s_add_u32 s85, s95, s93
    s_mul_i32 s95, s94, 5120
    s_add_u32 s95, s95, 14336
    s_add_u32 s86, s95, s93
    s_mul_i32 s95, s94, 5120
    s_add_u32 s95, s95, 15360
    s_add_u32 s87, s95, s93
    s_mul_i32 s95, s94, 5120
    s_add_u32 s95, s95, 16384
    s_add_u32 s88, s95, s93
    s_branch L_udone_41
L_ub_45:
    s_cmp_ge_u32 s90, 9
    s_cbranch_scc1 L_uc_46
    s_sub_u32 s94, s90, 3
    s_mul_i32 s95, s94, 9216
    s_add_u32 s95, s95, 27648
    s_add_u32 s80, s95, s93
    s_mul_i32 s95, s94, 9216
    s_add_u32 s95, s95, 28672
    s_add_u32 s81, s95, s93
    s_mul_i32 s95, s94, 9216
    s_add_u32 s95, s95, 29696
    s_add_u32 s82, s95, s93
    s_mul_i32 s95, s94, 9216
    s_add_u32 s95, s95, 30720
    s_add_u32 s83, s95, s93
    s_mul_i32 s95, s94, 9216
    s_add_u32 s95, s95, 31744
    s_add_u32 s84, s95, s93
    s_mul_i32 s95, s94, 9216
    s_add_u32 s95, s95, 32768
    s_add_u32 s85, s95, s93
    s_mul_i32 s95, s94, 9216
    s_add_u32 s95, s95, 33792
    s_add_u32 s86, s95, s93
    s_mul_i32 s95, s94, 9216
    s_add_u32 s95, s95, 34816
    s_add_u32 s87, s95, s93
    s_mul_i32 s95, s94, 9216
    s_add_u32 s95, s95, 35840
    s_add_u32 s88, s95, s93
    s_branch L_udone_41
L_uc_46:
    s_sub_u32 s94, s90, 9
    s_mul_i32 s95, s94, 2048
    s_add_u32 s95, s95, 82944
    s_add_u32 s80, s95, s93
    s_mul_i32 s95, s94, 2048
    s_add_u32 s95, s95, 83968
    s_add_u32 s81, s95, s93
    s_mul_i32 s95, s94, 2048
    s_add_u32 s95, s95, 101376
    s_add_u32 s82, s95, s93
    s_mul_i32 s95, s94, 2048
    s_add_u32 s95, s95, 102400
    s_add_u32 s83, s95, s93
    s_mul_i32 s95, s94, 2048
    s_add_u32 s95, s95, 119808
    s_add_u32 s84, s95, s93
    s_mul_i32 s95, s94, 2048
    s_add_u32 s95, s95, 120832
    s_add_u32 s85, s95, s93
    s_mul_i32 s95, s94, 2048
    s_add_u32 s95, s95, 138240
    s_add_u32 s86, s95, s93
    s_mul_i32 s95, s94, 2048
    s_add_u32 s95, s95, 139264
    s_add_u32 s87, s95, s93
    s_mul_i32 s95, s94, 1024
    s_add_u32 s95, s95, 156672
    s_add_u32 s88, s95, s93
L_udone_41:
    s_mov_b32 s18, 0x510000
    s_mov_b32 s19, 0x20000
    s_lshl_b32 s79, s78, 6
    s_add_u32 s79, s79, s90
    s_lshl_b32 s79, s79, 3
    s_add_u32 s79, s79, 4071712
    v_add_u32 v64, 0, v1
    v_mul_u32_u24 v65, 3641, v64
    v_lshrrev_b32 v65, 16, v65
    v_mul_u32_u24 v66, 18, v65
    v_sub_u32 v64, v64, v66
    v_lshlrev_b32 v64, 4, v64
    v_lshrrev_b32 v66, 3, v65
    v_mul_lo_u32 v66, v66, s73
    v_bfe_u32 v67, v65, 2, 1
    v_mul_lo_u32 v67, v67, s74
    v_and_b32 v65, 3, v65
    v_mul_lo_u32 v65, v65, s75
    v_add3_u32 v64, v64, v66, v67
    v_add3_u32 v64, v64, v65, s72
    s_add_u32 m0, s67, 0
    s_nop 0
    buffer_load_dwordx4 v64, s[16:19], 0 offen lds
    v_add_u32 v64, 64, v1
    v_mul_u32_u24 v65, 3641, v64
    v_lshrrev_b32 v65, 16, v65
    v_mul_u32_u24 v66, 18, v65
    v_sub_u32 v64, v64, v66
    v_lshlrev_b32 v64, 4, v64
    v_lshrrev_b32 v66, 3, v65
    v_mul_lo_u32 v66, v66, s73
    v_bfe_u32 v67, v65, 2, 1
    v_mul_lo_u32 v67, v67, s74
    v_and_b32 v65, 3, v65
    v_mul_lo_u32 v65, v65, s75
    v_add3_u32 v64, v64, v66, v67
    v_add3_u32 v64, v64, v65, s72
    s_add_u32 m0, s67, 1024
    s_nop 0
    buffer_load_dwordx4 v64, s[16:19], 0 offen lds
    v_add_u32 v64, 128, v1
    v_mul_u32_u24 v65, 3641, v64
    v_lshrrev_b32 v65, 16, v65
    v_mul_u32_u24 v66, 18, v65
    v_sub_u32 v64, v64, v66
    v_lshlrev_b32 v64, 4, v64
    v_lshrrev_b32 v66, 3, v65
    v_mul_lo_u32 v66, v66, s73
    v_bfe_u32 v67, v65, 2, 1
    v_mul_lo_u32 v67, v67, s74
    v_and_b32 v65, 3, v65
    v_mul_lo_u32 v65, v65, s75
    v_add3_u32 v64, v64, v66, v67
    v_add3_u32 v64, v64, v65, s72
    s_add_u32 m0, s67, 2048
    s_nop 0
    buffer_load_dwordx4 v64, s[16:19], 0 offen lds
    v_add_u32 v64, 192, v1
    v_mul_u32_u24 v65, 3641, v64
    v_lshrrev_b32 v65, 16, v65
    v_mul_u32_u24 v66, 18, v65
    v_sub_u32 v64, v64, v66
    v_lshlrev_b32 v64, 4, v64
    v_lshrrev_b32 v66, 3, v65
    v_mul_lo_u32 v66, v66, s73
    v_bfe_u32 v67, v65, 2, 1
    v_mul_lo_u32 v67, v67, s74
    v_and_b32 v65, 3, v65
    v_mul_lo_u32 v65, v65, s75
    v_add3_u32 v64, v64, v66, v67
    v_add3_u32 v64, v64, v65, s72
    s_add_u32 m0, s67, 3072
    s_nop 0
    buffer_load_dwordx4 v64, s[16:19], 0 offen lds
    v_add_u32 v64, 256, v1
    v_mul_u32_u24 v65, 3641, v64
    v_lshrrev_b32 v65, 16, v65
    v_mul_u32_u24 v66, 18, v65
    v_sub_u32 v64, v64, v66
    v_lshlrev_b32 v64, 4, v64
    v_lshrrev_b32 v66, 3, v65
    v_mul_lo_u32 v66, v66, s73
    v_bfe_u32 v67, v65, 2, 1
    v_mul_lo_u32 v67, v67, s74
    v_and_b32 v65, 3, v65
    v_mul_lo_u32 v65, v65, s75
    v_add3_u32 v64, v64, v66, v67
    v_add3_u32 v64, v64, v65, s72
    s_add_u32 m0, s67, 4096
    s_nop 0
    buffer_load_dwordx4 v64, s[16:19], 0 offen lds
    v_add_u32 v64, 320, v1
    v_mul_u32_u24 v65, 3641, v64
    v_lshrrev_b32 v65, 16, v65
    v_mul_u32_u24 v66, 18, v65
    v_sub_u32 v64, v64, v66
    v_lshlrev_b32 v64, 4, v64
    v_lshrrev_b32 v66, 3, v65
    v_mul_lo_u32 v66, v66, s73
    v_bfe_u32 v67, v65, 2, 1
    v_mul_lo_u32 v67, v67, s74
    v_and_b32 v65, 3, v65
    v_mul_lo_u32 v65, v65, s75
    v_add3_u32 v64, v64, v66, v67
    v_add3_u32 v64, v64, v65, s72
    s_add_u32 m0, s67, 5120
    s_nop 0
    buffer_load_dwordx4 v64, s[16:19], 0 offen lds
    v_add_u32 v64, 384, v1
    v_mul_u32_u24 v65, 3641, v64
    v_lshrrev_b32 v65, 16, v65
    v_mul_u32_u24 v66, 18, v65
    v_sub_u32 v64, v64, v66
    v_lshlrev_b32 v64, 4, v64
    v_lshrrev_b32 v66, 3, v65
    v_mul_lo_u32 v66, v66, s73
    v_bfe_u32 v67, v65, 2, 1
    v_mul_lo_u32 v67, v67, s74
    v_and_b32 v65, 3, v65
    v_mul_lo_u32 v65, v65, s75
    v_add3_u32 v64, v64, v66, v67
    v_add3_u32 v64, v64, v65, s72
    s_add_u32 m0, s67, 6144
    s_nop 0
    buffer_load_dwordx4 v64, s[16:19], 0 offen lds
    v_add_u32 v64, 448, v1
    v_mul_u32_u24 v65, 3641, v64
    v_lshrrev_b32 v65, 16, v65
    v_mul_u32_u24 v66, 18, v65
    v_sub_u32 v64, v64, v66
    v_lshlrev_b32 v64, 4, v64
    v_lshrrev_b32 v66, 3, v65
    v_mul_lo_u32 v66, v66, s73
    v_bfe_u32 v67, v65, 2, 1
    v_mul_lo_u32 v67, v67, s74
    v_and_b32 v65, 3, v65
    v_mul_lo_u32 v65, v65, s75
    v_add3_u32 v64, v64, v66, v67
    v_add3_u32 v64, v64, v65, s72
    s_add_u32 m0, s67, 7168
    s_nop 0
    buffer_load_dwordx4 v64, s[16:19], 0 offen lds
    v_add_u32 v64, 512, v1
    v_mul_u32_u24 v65, 3641, v64
    v_lshrrev_b32 v65, 16, v65
    v_mul_u32_u24 v66, 18, v65
    v_sub_u32 v64, v64, v66
    v_lshlrev_b32 v64, 4, v64
    v_lshrrev_b32 v66, 3, v65
    v_mul_lo_u32 v66, v66, s73
    v_bfe_u32 v67, v65, 2, 1
    v_mul_lo_u32 v67, v67, s74
    v_and_b32 v65, 3, v65
    v_mul_lo_u32 v65, v65, s75
    v_add3_u32 v64, v64, v66, v67
    v_add3_u32 v64, v64, v65, s72
    s_add_u32 m0, s67, 8192
    s_nop 0
    buffer_load_dwordx4 v64, s[16:19], 0 offen lds
    v_lshrrev_b32 v64, 4, v1
    v_bfe_u32 v66, v1, 2, 2
    v_lshl_add_u32 v64, v64, 3, v66
    v_mul_u32_u24 v64, 288, v64
    v_add_u32 v64, s66, v64
    v_and_b32 v66, 3, v1
    v_lshl_add_u32 v65, v66, 3, v64
    v_add_u32 v65, s49, v65
    v_lshl_add_u32 v64, v66, 4, v64
    v_add_u32 v64, s48, v64
    s_waitcnt vmcnt(9)
    ds_read_b64_tr_b16 v[72:73], v64 offset:0
    ds_read_b64_tr_b16 v[74:75], v64 offset:1152
    ds_read_b64_tr_b16 v[76:77], v64 offset:8
    ds_read_b64_tr_b16 v[78:79], v64 offset:1160
    ds_read_b64_tr_b16 v[80:81], v64 offset:64
    ds_read_b64_tr_b16 v[82:83], v64 offset:1216
    ds_read_b64_tr_b16 v[84:85], v64 offset:72
    ds_read_b64_tr_b16 v[86:87], v64 offset:1224
    ds_read_b64_tr_b16 v[88:89], v64 offset:128
    ds_read_b64_tr_b16 v[90:91], v64 offset:1280
    ds_read_b64_tr_b16 v[92:93], v64 offset:136
    ds_read_b64_tr_b16 v[94:95], v64 offset:1288
    ds_read_b64_tr_b16 v[96:97], v64 offset:192
    ds_read_b64_tr_b16 v[98:99], v64 offset:1344
    ds_read_b64_tr_b16 v[100:101], v64 offset:200
    ds_read_b64_tr_b16 v[102:103], v64 offset:1352
    ds_read_b64_tr_b16 v[104:105], v65 offset:0
    ds_read_b64_tr_b16 v[106:107], v65 offset:1152
    s_waitcnt lgkmcnt(15)
    buffer_store_dwordx4 v[72:75], v2, s[4:7], s52 offen sc1
    s_waitcnt lgkmcnt(14)
    buffer_store_dwordx4 v[76:79], v2, s[4:7], s53 offen sc1
    s_waitcnt lgkmcnt(12)
    buffer_store_dwordx4 v[80:83], v2, s[4:7], s54 offen sc1
    s_waitcnt lgkmcnt(10)
    buffer_store_dwordx4 v[84:87], v2, s[4:7], s55 offen sc1
    s_waitcnt lgkmcnt(8)
    buffer_store_dwordx4 v[88:91], v2, s[4:7], s56 offen sc1
    s_waitcnt lgkmcnt(6)
    buffer_store_dwordx4 v[92:95], v2, s[4:7], s57 offen sc1
    s_waitcnt lgkmcnt(4)
    buffer_store_dwordx4 v[96:99], v2, s[4:7], s58 offen sc1
    s_waitcnt lgkmcnt(2)
    buffer_store_dwordx4 v[100:103], v2, s[4:7], s59 offen sc1
    s_waitcnt lgkmcnt(0)
    buffer_store_dwordx4 v[104:107], v2, s[4:7], s60 offen sc1
    s_mov_b32 s61, s51
    s_cmp_ge_u32 s23, 8
    s_cbranch_scc1 L_no3_47
    s_add_u32 s69, s69, 32
L_ud_49:
    s_sub_u32 s90, s69, 1152
    s_mul_i32 s50, s90, 3641
    s_lshr_b32 s50, s50, 16
    s_mul_i32 s91, s50, 18
    s_sub_u32 s90, s90, s91
    s_mov_b32 s12, s36
    s_mov_b32 s13, s37
    s_mov_b32 s51, 0
    s_mov_b32 s47, 1152
    s_and_b32 s91, s50, 3
    s_and_b32 s92, s91, 1
    s_lshl_b32 s48, s92, 5
    s_cmp_eq_u32 s92, 0
    s_cselect_b32 s49, 256, 0
    s_mov_b32 s95, -165888
    s_cselect_b32 s95, 165888, s95
    s_mov_b32 s45, 9216
    s_mov_b32 s46, 4608
    s_cmp_ge_u32 s90, 4
    s_cbranch_scc1 L_ush_51
    s_mov_b32 s93, s91
    s_lshl_b32 s94, s90, 5
    s_branch L_urows_53
L_ush_51:
    s_cmp_ge_u32 s90, 6
    s_cbranch_scc1 L_urm_52
    s_sub_u32 s93, s90, 4
    s_lshl_b32 s93, s93, 1
    s_xor_b32 s93, s93, s91
    s_mov_b32 s94, 128
    s_mov_b32 s45, 4608
    s_mov_b32 s46, s95
    s_branch L_urows_53
L_urm_52:
    s_sub_u32 s93, s90, 6
    s_mul_i32 s94, s93, 21846
    s_lshr_b32 s94, s94, 16
    s_mul_i32 s95, s94, 3
    s_sub_u32 s93, s93, s95
    s_add_u32 s93, s93, 1
    s_xor_b32 s93, s93, s91
    s_lshl_b32 s94, s94, 5
L_urows_53:
    s_mul_i32 s93, s93, 144
    s_add_u32 s93, s93, s94
    s_lshr_b32 s94, s50, 2
    s_mul_i32 s94, s94, 576
    s_add_u32 s93, s93, s94
    s_mul_i32 s93, s93, 1152
    s_mul_i32 s94, s91, 288
    s_add_u32 s44, s93, s94
    s_mul_i32 s93, s50, 486
    s_add_u32 s93, s93, 324
    s_lshl_b32 s93, s93, 10
    s_add_u32 s93, s93, 4194304
    s_cmp_ge_u32 s90, 3
    s_cbranch_scc1 L_ub_54
    s_sub_u32 s94, s90, 0
    s_mul_i32 s95, s94, 4096
    s_add_u32 s95, s95, 0
    s_add_u32 s52, s95, s93
    s_mul_i32 s95, s94, 4096
    s_add_u32 s95, s95, 1024
    s_add_u32 s53, s95, s93
    s_mul_i32 s95, s94, 4096
    s_add_u32 s95, s95, 2048
    s_add_u32 s54, s95, s93
    s_mul_i32 s95, s94, 4096
    s_add_u32 s95, s95, 3072
    s_add_u32 s55, s95, s93
    s_mul_i32 s95, s94, 5120
    s_add_u32 s95, s95, 12288
    s_add_u32 s56, s95, s93
    s_mul_i32 s95, s94, 5120
    s_add_u32 s95, s95, 13312
    s_add_u32 s57, s95, s93
    s_mul_i32 s95, s94, 5120
    s_add_u32 s95, s95, 14336
    s_add_u32 s58, s95, s93
    s_mul_i32 s95, s94, 5120
    s_add_u32 s95, s95, 15360
    s_add_u32 s59, s95, s93
    s_mul_i32 s95, s94, 5120
    s_add_u32 s95, s95, 16384
    s_add_u32 s60, s95, s93
    s_branch L_udone_50
L_ub_54:
    s_cmp_ge_u32 s90, 9
    s_cbranch_scc1 L_uc_55
    s_sub_u32 s94, s90, 3
    s_mul_i32 s95, s94, 9216
    s_add_u32 s95, s95, 27648
    s_add_u32 s52, s95, s93
    s_mul_i32 s95, s94, 9216
    s_add_u32 s95, s95, 28672
    s_add_u32 s53, s95, s93
    s_mul_i32 s95, s94, 9216
    s_add_u32 s95, s95, 29696
    s_add_u32 s54, s95, s93
    s_mul_i32 s95, s94, 9216
    s_add_u32 s95, s95, 30720
    s_add_u32 s55, s95, s93
    s_mul_i32 s95, s94, 9216
    s_add_u32 s95, s95, 31744
    s_add_u32 s56, s95, s93
    s_mul_i32 s95, s94, 9216
    s_add_u32 s95, s95, 32768
    s_add_u32 s57, s95, s93
    s_mul_i32 s95, s94, 9216
    s_add_u32 s95, s95, 33792
    s_add_u32 s58, s95, s93
    s_mul_i32 s95, s94, 9216
    s_add_u32 s95, s95, 34816
    s_add_u32 s59, s95, s93
    s_mul_i32 s95, s94, 9216
    s_add_u32 s95, s95, 35840
    s_add_u32 s60, s95, s93
    s_branch L_udone_50
L_uc_55:
    s_sub_u32 s94, s90, 9
    s_mul_i32 s95, s94, 2048
    s_add_u32 s95, s95, 82944
    s_add_u32 s52, s95, s93
    s_mul_i32 s95, s94, 2048
    s_add_u32 s95, s95, 83968
    s_add_u32 s53, s95, s93
    s_mul_i32 s95, s94, 2048
    s_add_u32 s95, s95, 101376
    s_add_u32 s54, s95, s93
    s_mul_i32 s95, s94, 2048
    s_add_u32 s95, s95, 102400
    s_add_u32 s55, s95, s93
    s_mul_i32 s95, s94, 2048
    s_add_u32 s95, s95, 119808
    s_add_u32 s56, s95, s93
    s_mul_i32 s95, s94, 2048
    s_add_u32 s95, s95, 120832
    s_add_u32 s57, s95, s93
    s_mul_i32 s95, s94, 2048
    s_add_u32 s95, s95, 138240
    s_add_u32 s58, s95, s93
    s_mul_i32 s95, s94, 2048
    s_add_u32 s95, s95, 139264
    s_add_u32 s59, s95, s93
    s_mul_i32 s95, s94, 1024
    s_add_u32 s95, s95, 156672
    s_add_u32 s60, s95, s93
L_udone_50:
    s_mov_b32 s14, 0x510000
    s_mov_b32 s15, 0x20000
    s_lshl_b32 s51, s50, 6
    s_add_u32 s51, s51, s90
    s_lshl_b32 s51, s51, 3
    s_add_u32 s51, s51, 4071712
    v_add_u32 v64, 0, v1
    v_mul_u32_u24 v65, 3641, v64
    v_lshrrev_b32 v65, 16, v65
    v_mul_u32_u24 v66, 18, v65
    v_sub_u32 v64, v64, v66
    v_lshlrev_b32 v64, 4, v64
    v_lshrrev_b32 v66, 3, v65
    v_mul_lo_u32 v66, v66, s45
    v_bfe_u32 v67, v65, 2, 1
    v_mul_lo_u32 v67, v67, s46
    v_and_b32 v65, 3, v65
    v_mul_lo_u32 v65, v65, s47
    v_add3_u32 v64, v64, v66, v67
    v_add3_u32 v64, v64, v65, s44
    s_add_u32 m0, s68, 0
    s_nop 0
    buffer_load_dwordx4 v64, s[12:15], 0 offen lds
    v_add_u32 v64, 64, v1
    v_mul_u32_u24 v65, 3641, v64
    v_lshrrev_b32 v65, 16, v65
    v_mul_u32_u24 v66, 18, v65
    v_sub_u32 v64, v64, v66
    v_lshlrev_b32 v64, 4, v64
    v_lshrrev_b32 v66, 3, v65
    v_mul_lo_u32 v66, v66, s45
    v_bfe_u32 v67, v65, 2, 1
    v_mul_lo_u32 v67, v67, s46
    v_and_b32 v65, 3, v65
    v_mul_lo_u32 v65, v65, s47
    v_add3_u32 v64, v64, v66, v67
    v_add3_u32 v64, v64, v65, s44
    s_add_u32 m0, s68, 1024
    s_nop 0
    buffer_load_dwordx4 v64, s[12:15], 0 offen lds
    v_add_u32 v64, 128, v1
    v_mul_u32_u24 v65, 3641, v64
    v_lshrrev_b32 v65, 16, v65
    v_mul_u32_u24 v66, 18, v65
    v_sub_u32 v64, v64, v66
    v_lshlrev_b32 v64, 4, v64
    v_lshrrev_b32 v66, 3, v65
    v_mul_lo_u32 v66, v66, s45
    v_bfe_u32 v67, v65, 2, 1
    v_mul_lo_u32 v67, v67, s46
    v_and_b32 v65, 3, v65
    v_mul_lo_u32 v65, v65, s47
    v_add3_u32 v64, v64, v66, v67
    v_add3_u32 v64, v64, v65, s44
    s_add_u32 m0, s68, 2048
    s_nop 0
    buffer_load_dwordx4 v64, s[12:15], 0 offen lds
    v_add_u32 v64, 192, v1
    v_mul_u32_u24 v65, 3641, v64
    v_lshrrev_b32 v65, 16, v65
    v_mul_u32_u24 v66, 18, v65
    v_sub_u32 v64, v64, v66
    v_lshlrev_b32 v64, 4, v64
    v_lshrrev_b32 v66, 3, v65
    v_mul_lo_u32 v66, v66, s45
    v_bfe_u32 v67, v65, 2, 1
    v_mul_lo_u32 v67, v67, s46
    v_and_b32 v65, 3, v65
    v_mul_lo_u32 v65, v65, s47
    v_add3_u32 v64, v64, v66, v67
    v_add3_u32 v64, v64, v65, s44
    s_add_u32 m0, s68, 3072
    s_nop 0
    buffer_load_dwordx4 v64, s[12:15], 0 offen lds
    v_add_u32 v64, 256, v1
    v_mul_u32_u24 v65, 3641, v64
    v_lshrrev_b32 v65, 16, v65
    v_mul_u32_u24 v66, 18, v65
    v_sub_u32 v64, v64, v66
    v_lshlrev_b32 v64, 4, v64
    v_lshrrev_b32 v66, 3, v65
    v_mul_lo_u32 v66, v66, s45
    v_bfe_u32 v67, v65, 2, 1
    v_mul_lo_u32 v67, v67, s46
    v_and_b32 v65, 3, v65
    v_mul_lo_u32 v65, v65, s47
    v_add3_u32 v64, v64, v66, v67
    v_add3_u32 v64, v64, v65, s44
    s_add_u32 m0, s68, 4096
    s_nop 0
    buffer_load_dwordx4 v64, s[12:15], 0 offen lds
    v_add_u32 v64, 320, v1
    v_mul_u32_u24 v65, 3641, v64
    v_lshrrev_b32 v65, 16, v65
    v_mul_u32_u24 v66, 18, v65
    v_sub_u32 v64, v64, v66
    v_lshlrev_b32 v64, 4, v64
    v_lshrrev_b32 v66, 3, v65
    v_mul_lo_u32 v66, v66, s45
    v_bfe_u32 v67, v65, 2, 1
    v_mul_lo_u32 v67, v67, s46
    v_and_b32 v65, 3, v65
    v_mul_lo_u32 v65, v65, s47
    v_add3_u32 v64, v64, v66, v67
    v_add3_u32 v64, v64, v65, s44
    s_add_u32 m0, s68, 5120
    s_nop 0
    buffer_load_dwordx4 v64, s[12:15], 0 offen lds
    v_add_u32 v64, 384, v1
    v_mul_u32_u24 v65, 3641, v64
    v_lshrrev_b32 v65, 16, v65
    v_mul_u32_u24 v66, 18, v65
    v_sub_u32 v64, v64, v66
    v_lshlrev_b32 v64, 4, v64
    v_lshrrev_b32 v66, 3, v65
    v_mul_lo_u32 v66, v66, s45
    v_bfe_u32 v67, v65, 2, 1
    v_mul_lo_u32 v67, v67, s46
    v_and_b32 v65, 3, v65
    v_mul_lo_u32 v65, v65, s47
    v_add3_u32 v64, v64, v66, v67
    v_add3_u32 v64, v64, v65, s44
    s_add_u32 m0, s68, 6144
    s_nop 0
    buffer_load_dwordx4 v64, s[12:15], 0 offen lds
    v_add_u32 v64, 448, v1
    v_mul_u32_u24 v65, 3641, v64
    v_lshrrev_b32 v65, 16, v65
    v_mul_u32_u24 v66, 18, v65
    v_sub_u32 v64, v64, v66
    v_lshlrev_b32 v64, 4, v64
    v_lshrrev_b32 v66, 3, v65
    v_mul_lo_u32 v66, v66, s45
    v_bfe_u32 v67, v65, 2, 1
    v_mul_lo_u32 v67, v67, s46
    v_and_b32 v65, 3, v65
    v_mul_lo_u32 v65, v65, s47
    v_add3_u32 v64, v64, v66, v67
    v_add3_u32 v64, v64, v65, s44
    s_add_u32 m0, s68, 7168
    s_nop 0
    buffer_load_dwordx4 v64, s[12:15], 0 offen lds
    v_add_u32 v64, 512, v1
    v_mul_u32_u24 v65, 3641, v64
    v_lshrrev_b32 v65, 16, v65
    v_mul_u32_u24 v66, 18, v65
    v_sub_u32 v64, v64, v66
    v_lshlrev_b32 v64, 4, v64
    v_lshrrev_b32 v66, 3, v65
    v_mul_lo_u32 v66, v66, s45
    v_bfe_u32 v67, v65, 2, 1
    v_mul_lo_u32 v67, v67, s46
    v_and_b32 v65, 3, v65
    v_mul_lo_u32 v65, v65, s47
    v_add3_u32 v64, v64, v66, v67
    v_add3_u32 v64, v64, v65, s44
    s_add_u32 m0, s68, 8192
    s_nop 0
    buffer_load_dwordx4 v64, s[12:15], 0 offen lds
L_no3_47:
    v_lshrrev_b32 v64, 4, v1
    v_bfe_u32 v66, v1, 2, 2
    v_lshl_add_u32 v64, v64, 3, v66
    v_mul_u32_u24 v64, 288, v64
    v_add_u32 v64, s67, v64
    v_and_b32 v66, 3, v1
    v_lshl_add_u32 v65, v66, 3, v64
    v_add_u32 v65, s77, v65
    v_lshl_add_u32 v64, v66, 4, v64
    v_add_u32 v64, s76, v64
    s_waitcnt vmcnt(9)
    ds_read_b64_tr_b16 v[72:73], v64 offset:0
    ds_read_b64_tr_b16 v[74:75], v64 offset:1152
    ds_read_b64_tr_b16 v[76:77], v64 offset:8
    ds_read_b64_tr_b16 v[78:79], v64 offset:1160
    ds_read_b64_tr_b16 v[80:81], v64 offset:64
    ds_read_b64_tr_b16 v[82:83], v64 offset:1216
    ds_read_b64_tr_b16 v[84:85], v64 offset:72
    ds_read_b64_tr_b16 v[86:87], v64 offset:1224
    ds_read_b64_tr_b16 v[88:89], v64 offset:128
    ds_read_b64_tr_b16 v[90:91], v64 offset:1280
    ds_read_b64_tr_b16 v[92:93], v64 offset:136
    ds_read_b64_tr_b16 v[94:95], v64 offset:1288
    ds_read_b64_tr_b16 v[96:97], v64 offset:192
    ds_read_b64_tr_b16 v[98:99], v64 offset:1344
    ds_read_b64_tr_b16 v[100:101], v64 offset:200
    ds_read_b64_tr_b16 v[102:103], v64 offset:1352
    ds_read_b64_tr_b16 v[104:105], v65 offset:0
    ds_read_b64_tr_b16 v[106:107], v65 offset:1152
    s_waitcnt lgkmcnt(15)
    buffer_store_dwordx4 v[72:75], v2, s[4:7], s80 offen sc1
    s_waitcnt lgkmcnt(14)
    buffer_store_dwordx4 v[76:79], v2, s[4:7], s81 offen sc1
    s_waitcnt lgkmcnt(12)
    buffer_store_dwordx4 v[80:83], v2, s[4:7], s82 offen sc1
    s_waitcnt lgkmcnt(10)
    buffer_store_dwordx4 v[84:87], v2, s[4:7], s83 offen sc1
    s_waitcnt lgkmcnt(8)
    buffer_store_dwordx4 v[88:91], v2, s[4:7], s84 offen sc1
    s_waitcnt lgkmcnt(6)
    buffer_store_dwordx4 v[92:95], v2, s[4:7], s85 offen sc1
    s_waitcnt lgkmcnt(4)
    buffer_store_dwordx4 v[96:99], v2, s[4:7], s86 offen sc1
    s_waitcnt lgkmcnt(2)
    buffer_store_dwordx4 v[100:103], v2, s[4:7], s87 offen sc1
    s_waitcnt lgkmcnt(0)
    buffer_store_dwordx4 v[104:107], v2, s[4:7], s88 offen sc1
    s_cmp_ge_u32 s23, 8
    s_cbranch_scc1 L_no3b_48
    v_lshrrev_b32 v64, 4, v1
    v_bfe_u32 v66, v1, 2, 2
    v_lshl_add_u32 v64, v64, 3, v66
    v_mul_u32_u24 v64, 288, v64
    v_add_u32 v64, s68, v64
    v_and_b32 v66, 3, v1
    v_lshl_add_u32 v65, v66, 3, v64
    v_add_u32 v65, s49, v65
    v_lshl_add_u32 v64, v66, 4, v64
    v_add_u32 v64, s48, v64
    s_waitcnt vmcnt(9)
    ds_read_b64_tr_b16 v[72:73], v64 offset:0
    ds_read_b64_tr_b16 v[74:75], v64 offset:1152
    ds_read_b64_tr_b16 v[76:77], v64 offset:8
    ds_read_b64_tr_b16 v[78:79], v64 offset:1160
    ds_read_b64_tr_b16 v[80:81], v64 offset:64
    ds_read_b64_tr_b16 v[82:83], v64 offset:1216
    ds_read_b64_tr_b16 v[84:85], v64 offset:72
    ds_read_b64_tr_b16 v[86:87], v64 offset:1224
    ds_read_b64_tr_b16 v[88:89], v64 offset:128
    ds_read_b64_tr_b16 v[90:91], v64 offset:1280
    ds_read_b64_tr_b16 v[92:93], v64 offset:136
    ds_read_b64_tr_b16 v[94:95], v64 offset:1288
    ds_read_b64_tr_b16 v[96:97], v64 offset:192
    ds_read_b64_tr_b16 v[98:99], v64 offset:1344
    ds_read_b64_tr_b16 v[100:101], v64 offset:200
    ds_read_b64_tr_b16 v[102:103], v64 offset:1352
    ds_read_b64_tr_b16 v[104:105], v65 offset:0
    ds_read_b64_tr_b16 v[106:107], v65 offset:1152
    s_waitcnt lgkmcnt(15)
    buffer_store_dwordx4 v[72:75], v2, s[4:7], s52 offen sc1
    s_waitcnt lgkmcnt(14)
    buffer_store_dwordx4 v[76:79], v2, s[4:7], s53 offen sc1
    s_waitcnt lgkmcnt(12)
    buffer_store_dwordx4 v[80:83], v2, s[4:7], s54 offen sc1
    s_waitcnt lgkmcnt(10)
    buffer_store_dwordx4 v[84:87], v2, s[4:7], s55 offen sc1
    s_waitcnt lgkmcnt(8)
    buffer_store_dwordx4 v[88:91], v2, s[4:7], s56 offen sc1
    s_waitcnt lgkmcnt(6)
    buffer_store_dwordx4 v[92:95], v2, s[4:7], s57 offen sc1
    s_waitcnt lgkmcnt(4)
    buffer_store_dwordx4 v[96:99], v2, s[4:7], s58 offen sc1
    s_waitcnt lgkmcnt(2)
    buffer_store_dwordx4 v[100:103], v2, s[4:7], s59 offen sc1
    s_waitcnt lgkmcnt(0)
    buffer_store_dwordx4 v[104:107], v2, s[4:7], s60 offen sc1
    v_mov_b32 v8, s98
    v_mov_b32 v9, s99
    s_waitcnt vmcnt(0)
    s_mov_b64 exec, 1
    buffer_store_dwordx2 v[8:9], off, s[4:7], s51 sc1
    s_mov_b64 exec, -1
L_no3b_48:
    v_mov_b32 v8, s98
    v_mov_b32 v9, s99
    s_waitcnt vmcnt(0)
    s_mov_b64 exec, 1
    buffer_store_dwordx2 v[8:9], off, s[4:7], s61 sc1
    s_mov_b64 exec, -1
    v_mov_b32 v8, s98
    v_mov_b32 v9, s99
    s_mov_b64 exec, 1
    buffer_store_dwordx2 v[8:9], off, s[4:7], s79 sc1
    s_mov_b64 exec, -1
L_ffn_23:
    s_barrier
    s_lshr_b32 s44, s22, 4
    s_and_b32 s60, s21, 6
    s_add_u32 s44, s44, s60
    s_and_b32 s60, s21, 1
    s_lshl_b32 s60, s60, 4
    s_and_b32 s47, s22, 15
    s_add_u32 s47, s47, s60
    s_lshl_b32 s64, s47, 9
    s_add_u32 s64, s64, 4071424
    v_min_u32 v0, 35, v1
    v_lshlrev_b32 v0, 3, v0
    buffer_load_dwordx2 v[6:7], v0, s[4:7], s64 offen sc1
    s_lshr_b32 s45, s47, 2
    s_and_b32 s46, s47, 3
    s_mul_i32 s48, s47, 497664
    s_add_u32 s48, s48, 4194304
    s_mul_i32 s63, s20, 9
    s_lshr_b32 s63, s63, 1
    s_lshl_b32 s63, s63, 10
    s_add_u32 s62, s48, s63
    s_mul_i32 s49, s20, 9216
    s_add_u32 s48, s48, s49
    s_lshl_b32 s54, s44, 4
    s_lshl_b32 s60, s20, 2
    s_add_u32 s54, s54, s60
    s_mul_i32 s50, s54, 18432
    s_mul_i32 s53, s45, 2359296
    s_add_u32 s53, s53, s50
    s_add_u32 s50, s50, 4718592
    s_add_u32 s50, s50, s100
    s_lshr_b32 s60, s46, 1
    s_mul_i32 s60, s60, 9216
    s_add_u32 s53, s53, s60
    s_add_u32 s53, s53, 29360128
    s_add_u32 s53, s53, s100
    v_lshlrev_b32 v3, 3, v1
    v_mov_b32 v4, v2
    s_waitcnt vmcnt(0)
    v_cmp_eq_u64 vcc, s[98:99], v[6:7]
    s_nop 0
    s_cmp_eq_u64 vcc, exec
    s_cbranch_scc0 L_pw_slow_56
L_pw_back_57:
    s_add_u32 m0, s49, 0
    s_add_u32 s61, s48, 0
    buffer_load_dwordx4 v2, s[4:7], s61 offen offset:0 lds
    buffer_load_dwordx4 v2, s[4:7], s61 offen offset:1024 lds
    buffer_load_dwordx4 v2, s[4:7], s61 offen offset:2048 lds
    buffer_load_dwordx4 v2, s[4:7], s61 offen offset:3072 lds
    s_add_u32 m0, s49, 4096
    s_add_u32 s61, s48, 4096
    buffer_load_dwordx4 v2, s[4:7], s61 offen offset:0 lds
    buffer_load_dwordx4 v2, s[4:7], s61 offen offset:1024 lds
    buffer_load_dwordx4 v2, s[4:7], s61 offen offset:2048 lds
    buffer_load_dwordx4 v2, s[4:7], s61 offen offset:3072 lds
    s_add_u32 m0, s49, 8192
    s_add_u32 s61, s48, 8192
    buffer_load_dwordx4 v2, s[4:7], s61 offen offset:0 lds
    s_add_u32 m0, s49, 36864
    s_add_u32 s61, s48, 36864
    buffer_load_dwordx4 v2, s[4:7], s61 offen offset:0 lds
    buffer_load_dwordx4 v2, s[4:7], s61 offen offset:1024 lds
    buffer_load_dwordx4 v2, s[4:7], s61 offen offset:2048 lds
    buffer_load_dwordx4 v2, s[4:7], s61 offen offset:3072 lds
    s_add_u32 m0, s49, 40960
    s_add_u32 s61, s48, 40960
    buffer_load_dwordx4 v2, s[4:7], s61 offen offset:0 lds
    buffer_load_dwordx4 v2, s[4:7], s61 offen offset:1024 lds
    buffer_load_dwordx4 v2, s[4:7], s61 offen offset:2048 lds
    buffer_load_dwordx4 v2, s[4:7], s61 offen offset:3072 lds
    s_add_u32 m0, s49, 45056
    s_add_u32 s61, s48, 45056
    buffer_load_dwordx4 v2, s[4:7], s61 offen offset:0 lds
    s_add_u32 m0, s49, 73728
    s_add_u32 s61, s48, 73728
    buffer_load_dwordx4 v2, s[4:7], s61 offen offset:0 lds
    buffer_load_dwordx4 v2, s[4:7], s61 offen offset:1024 lds
    buffer_load_dwordx4 v2, s[4:7], s61 offen offset:2048 lds
    buffer_load_dwordx4 v2, s[4:7], s61 offen offset:3072 lds
    s_add_u32 m0, s49, 77824
    s_add_u32 s61, s48, 77824
    buffer_load_dwordx4 v2, s[4:7], s61 offen offset:0 lds
    buffer_load_dwordx4 v2, s[4:7], s61 offen offset:1024 lds
    buffer_load_dwordx4 v2, s[4:7], s61 offen offset:2048 lds
    buffer_load_dwordx4 v2, s[4:7], s61 offen offset:3072 lds
    s_add_u32 m0, s49, 81920
    s_add_u32 s61, s48, 81920
    buffer_load_dwordx4 v2, s[4:7], s61 offen offset:0 lds
    s_add_u32 m0, s49, 110592
    s_add_u32 s61, s48, 110592
    buffer_load_dwordx4 v2, s[4:7], s61 offen offset:0 lds
    buffer_load_dwordx4 v2, s[4:7], s61 offen offset:1024 lds
    buffer_load_dwordx4 v2, s[4:7], s61 offen offset:2048 lds
    buffer_load_dwordx4 v2, s[4:7], s61 offen offset:3072 lds
    s_add_u32 m0, s49, 114688
    s_add_u32 s61, s48, 114688
    buffer_load_dwordx4 v2, s[4:7], s61 offen offset:0 lds
    buffer_load_dwordx4 v2, s[4:7], s61 offen offset:1024 lds
    buffer_load_dwordx4 v2, s[4:7], s61 offen offset:2048 lds
    buffer_load_dwordx4 v2, s[4:7], s61 offen offset:3072 lds
    s_add_u32 m0, s49, 118784
    s_add_u32 s61, s48, 118784
    buffer_load_dwordx4 v2, s[4:7], s61 offen offset:0 lds
    s_cmp_lg_u32 s101, 0
    s_cbranch_scc1 L_nocs_59
    s_cmp_ge_u32 s20, 2
    s_cbranch_scc1 L_nocs_59
    s_lshl_b32 s60, s47, 1
    s_add_u32 s60, s60, s20
    s_mul_i32 s60, s60, 10368
    s_add_u32 s60, s60, 2883584
    v_lshrrev_b32 v6, 2, v1
    v_lshlrev_b32 v6, 7, v6
    v_and_b32 v7, 3, v1
    v_lshl_add_u32 v6, v7, 4, v6
    s_lshl_b32 s61, s20, 6
    s_add_u32 s61, s61, 147456
    v_add_u32 v6, s61, v6
    s_mov_b32 exec_hi, 15
    buffer_load_dwordx4 v[64:67], v2, s[4:7], s60 offen offset:0 sc1
    buffer_load_dwordx4 v[68:71], v2, s[4:7], s60 offen offset:576 sc1
    buffer_load_dwordx4 v[72:75], v2, s[4:7], s60 offen offset:1152 sc1
    buffer_load_dwordx4 v[76:79], v2, s[4:7], s60 offen offset:1728 sc1
    buffer_load_dwordx4 v[80:83], v2, s[4:7], s60 offen offset:2304 sc1
    buffer_load_dwordx4 v[84:87], v2, s[4:7], s60 offen offset:2880 sc1
    s_add_u32 s60, s60, 3456
    buffer_load_dwordx4 v[88:91], v2, s[4:7], s60 offen offset:0 sc1
    buffer_load_dwordx4 v[92:95], v2, s[4:7], s60 offen offset:576 sc1
    buffer_load_dwordx4 v[96:99], v2, s[4:7], s60 offen offset:1152 sc1
    buffer_load_dwordx4 v[100:103], v2, s[4:7], s60 offen offset:1728 sc1
    buffer_load_dwordx4 v[104:107], v2, s[4:7], s60 offen offset:2304 sc1
    buffer_load_dwordx4 v[108:111], v2, s[4:7], s60 offen offset:2880 sc1
    s_add_u32 s60, s60, 3456
    buffer_load_dwordx4 v[112:115], v2, s[4:7], s60 offen offset:0 sc1
    buffer_load_dwordx4 v[116:119], v2, s[4:7], s60 offen offset:576 sc1
    buffer_load_dwordx4 v[120:123], v2, s[4:7], s60 offen offset:1152 sc1
    buffer_load_dwordx4 v[124:127], v2, s[4:7], s60 offen offset:1728 sc1
    buffer_load_dwordx4 v[128:131], v2, s[4:7], s60 offen offset:2304 sc1
    buffer_load_dwordx4 v[132:135], v2, s[4:7], s60 offen offset:2880 sc1
    s_waitcnt vmcnt(16)
    v_add_f32 v64, v64, v68
    v_add_f32 v65, v65, v69
    v_add_f32 v66, v66, v70
    v_add_f32 v67, v67, v71
    s_waitcnt vmcnt(15)
    v_add_f32 v64, v64, v72
    v_add_f32 v65, v65, v73
    v_add_f32 v66, v66, v74
    v_add_f32 v67, v67, v75
    s_waitcnt vmcnt(14)
    v_add_f32 v64, v64, v76
    v_add_f32 v65, v65, v77
    v_add_f32 v66, v66, v78
    v_add_f32 v67, v67, v79
    s_waitcnt vmcnt(13)
    v_add_f32 v64, v64, v80
    v_add_f32 v65, v65, v81
    v_add_f32 v66, v66, v82
    v_add_f32 v67, v67, v83
    s_waitcnt vmcnt(12)
    v_add_f32 v64, v64, v84
    v_add_f32 v65, v65, v85
    v_add_f32 v66, v66, v86
    v_add_f32 v67, v67, v87
    s_waitcnt vmcnt(11)
    v_add_f32 v64, v64, v88
    v_add_f32 v65, v65, v89
    v_add_f32 v66, v66, v90
    v_add_f32 v67, v67, v91
    s_waitcnt vmcnt(10)
    v_add_f32 v64, v64, v92
    v_add_f32 v65, v65, v93
    v_add_f32 v66, v66, v94
    v_add_f32 v67, v67, v95
    s_waitcnt vmcnt(9)
    v_add_f32 v64, v64, v96
    v_add_f32 v65, v65, v97
    v_add_f32 v66, v66, v98
    v_add_f32 v67, v67, v99
    s_waitcnt vmcnt(8)
    v_add_f32 v64, v64, v100
    v_add_f32 v65, v65, v101
    v_add_f32 v66, v66, v102
    v_add_f32 v67, v67, v103
    s_waitcnt vmcnt(7)
    v_add_f32 v64, v64, v104
    v_add_f32 v65, v65, v105
    v_add_f32 v66, v66, v106
    v_add_f32 v67, v67, v107
    s_waitcnt vmcnt(6)
    v_add_f32 v64, v64, v108
    v_add_f32 v65, v65, v109
    v_add_f32 v66, v66, v110
    v_add_f32 v67, v67, v111
    s_waitcnt vmcnt(5)
    v_add_f32 v64, v64, v112
    v_add_f32 v65, v65, v113
    v_add_f32 v66, v66, v114
    v_add_f32 v67, v67, v115
    s_waitcnt vmcnt(4)
    v_add_f32 v64, v64, v116
    v_add_f32 v65, v65, v117
    v_add_f32 v66, v66, v118
    v_add_f32 v67, v67, v119
    s_waitcnt vmcnt(3)
    v_add_f32 v64, v64, v120
    v_add_f32 v65, v65, v121
    v_add_f32 v66, v66, v122
    v_add_f32 v67, v67, v123
    s_waitcnt vmcnt(2)
    v_add_f32 v64, v64, v124
    v_add_f32 v65, v65, v125
    v_add_f32 v66, v66, v126
    v_add_f32 v67, v67, v127
    s_waitcnt vmcnt(1)
    v_add_f32 v64, v64, v128
    v_add_f32 v65, v65, v129
    v_add_f32 v66, v66, v130
    v_add_f32 v67, v67, v131
    s_waitcnt vmcnt(0)
    v_add_f32 v64, v64, v132
    v_add_f32 v65, v65, v133
    v_add_f32 v66, v66, v134
    v_add_f32 v67, v67, v135
    ds_write_b128 v6, v[64:67]
    s_mov_b64 exec, -1
    s_waitcnt lgkmcnt(0)
L_nocs_59:
    s_lshr_b32 s60, s54, 2
    s_lshl_b32 s60, s60, 8
    s_add_u32 s60, s60, s101
    s_add_u32 s55, s60, 3964928
    v_and_b32 v0, 7, v1
    v_min_u32 v0, 5, v0
    v_and_b32 v6, 24, v1
    v_add_lshl_u32 v0, v0, v6, 3
    buffer_load_dwordx2 v[6:7], v0, s[4:7], s55 offen sc1
    s_lshl_b32 s60, s44, 5
    s_add_u32 s60, s60, s47
    s_mul_i32 s51, s60, 73728
    s_add_u32 s51, s51, 9699328
    s_add_u32 s51, s51, s100
    s_xor_b32 s61, s60, 1
    s_mul_i32 s56, s61, 73728
    s_add_u32 s56, s56, 9699328
    s_add_u32 s56, s56, s100
    s_xor_b32 s61, s60, 2
    s_mul_i32 s57, s61, 73728
    s_add_u32 s57, s57, 9699328
    s_add_u32 s57, s57, s100
    s_xor_b32 s61, s60, 3
    s_mul_i32 s58, s61, 73728
    s_add_u32 s58, s58, 9699328
    s_add_u32 s58, s58, s100
    s_lshr_b32 s52, s60, 2
    s_lshl_b32 s52, s52, 2
    s_add_u32 s52, s52, s20
    s_lshl_b32 s52, s52, 7
    s_lshl_b32 s61, s101, 2
    s_add_u32 s52, s52, s61
    s_add_u32 s52, s52, 3981312
    v_lshrrev_b32 v5, 4, v1
    v_lshlrev_b32 v5, 4, v5
    v_add_u32 v5, 147456, v5
    s_lshl_b32 s60, s20, 12
    s_add_u32 s51, s51, s60
    s_add_u32 s56, s56, s60
    s_add_u32 s57, s57, s60
    s_add_u32 s58, s58, s60
    s_lshl_b32 s65, s20, 11
    s_sub_u32 s65, 65536, s65
    s_lshl_b32 s67, s46, 3
    s_add_u32 s67, s67, s52
    s_waitcnt vmcnt(0)
    v_cmp_eq_u64 vcc, s[98:99], v[6:7]
    s_nop 0
    s_cmp_eq_u64 vcc, exec
    s_cbranch_scc0 L_p1_slow_60
L_p1_back_61:
    s_add_u32 s59, s50, 0
    buffer_load_dwordx4 a[0:3], v2, s[4:7], s59 offen offset:0 sc1
    s_add_u32 s66, s50, 18432
    buffer_load_dwordx4 a[4:7], v2, s[4:7], s66 offen offset:0 sc1
    s_add_u32 s68, s50, 36864
    buffer_load_dwordx4 a[8:11], v2, s[4:7], s68 offen offset:0 sc1
    s_add_u32 s69, s50, 55296
    buffer_load_dwordx4 a[12:15], v2, s[4:7], s69 offen offset:0 sc1
    buffer_load_dwordx4 a[16:19], v2, s[4:7], s59 offen offset:1024 sc1
    buffer_load_dwordx4 a[20:23], v2, s[4:7], s66 offen offset:1024 sc1
    buffer_load_dwordx4 a[24:27], v2, s[4:7], s68 offen offset:1024 sc1
    buffer_load_dwordx4 a[28:31], v2, s[4:7], s69 offen offset:1024 sc1
    buffer_load_dwordx4 a[32:35], v2, s[4:7], s59 offen offset:2048 sc1
    buffer_load_dwordx4 a[36:39], v2, s[4:7], s66 offen offset:2048 sc1
    buffer_load_dwordx4 a[40:43], v2, s[4:7], s68 offen offset:2048 sc1
    buffer_load_dwordx4 a[44:47], v2, s[4:7], s69 offen offset:2048 sc1
    buffer_load_dwordx4 a[48:51], v2, s[4:7], s59 offen offset:3072 sc1
    buffer_load_dwordx4 a[52:55], v2, s[4:7], s66 offen offset:3072 sc1
    buffer_load_dwordx4 a[56:59], v2, s[4:7], s68 offen offset:3072 sc1
    buffer_load_dwordx4 a[60:63], v2, s[4:7], s69 offen offset:3072 sc1
    s_lshl_b32 s60, s54, 4
    v_add_u32 v6, s60, v1
    v_lshlrev_b32 v6, 3, v6
    s_add_u32 s55, s100, 7077888
    s_add_u32 s60, s55, 0
    buffer_load_dwordx2 v[152:153], v6, s[4:7], s60 offen sc1
    s_add_u32 s60, s55, 16384
    buffer_load_dwordx2 v[154:155], v6, s[4:7], s60 offen sc1
    s_add_u32 s60, s55, 32768
    buffer_load_dwordx2 v[156:157], v6, s[4:7], s60 offen sc1
    s_add_u32 s60, s55, 49152
    buffer_load_dwordx2 v[158:159], v6, s[4:7], s60 offen sc1
    s_add_u32 s60, s55, 65536
    buffer_load_dwordx2 v[160:161], v6, s[4:7], s60 offen sc1
    s_add_u32 s60, s55, 81920
    buffer_load_dwordx2 v[162:163], v6, s[4:7], s60 offen sc1
    v_add_u32 v7, 0x10000, v2
    s_barrier
    ds_read_b128 v[8:11], v4 offset:0
    ds_read_b128 v[12:15], v4 offset:1024
    ds_read_b128 v[16:19], v4 offset:36864
    ds_read_b128 v[20:23], v4 offset:37888
    s_add_u32 s59, s50, 4096
    buffer_load_dwordx4 a[64:67], v2, s[4:7], s59 offen offset:0 sc1
    s_waitcnt vmcnt(22) lgkmcnt(3)
    v_mfma_f32_16x16x32_bf16 v[208:211], v[8:11], a[0:3], 0
    ds_read_b128 v[24:27], v4 offset:2048
    s_add_u32 s66, s50, 22528
    s_waitcnt vmcnt(21)
    v_mfma_f32_16x16x32_bf16 v[212:215], v[8:11], a[4:7], 0
    s_waitcnt vmcnt(20)
    v_mfma_f32_16x16x32_bf16 v[216:219], v[8:11], a[8:11], 0
    s_waitcnt vmcnt(19)
    v_mfma_f32_16x16x32_bf16 v[220:223], v[8:11], a[12:15], 0
    buffer_load_dwordx4 a[68:71], v2, s[4:7], s66 offen offset:0 sc1
    s_add_u32 s68, s50, 40960
    s_waitcnt lgkmcnt(3)
    v_mfma_f32_16x16x32_bf16 v[224:227], v[12:15], a[0:3], 0
    ds_read_b128 v[28:31], v4 offset:3072
    v_mfma_f32_16x16x32_bf16 v[228:231], v[12:15], a[4:7], 0
    v_mfma_f32_16x16x32_bf16 v[232:235], v[12:15], a[8:11], 0
    v_mfma_f32_16x16x32_bf16 v[236:239], v[12:15], a[12:15], 0
    buffer_load_dwordx4 a[72:75], v2, s[4:7], s68 offen offset:0 sc1
    s_add_u32 s69, s50, 59392
    s_waitcnt lgkmcnt(3)
    v_mfma_f32_16x16x32_bf16 v[64:67], v[16:19], a[0:3], 0
    ds_read_b128 v[8:11], v4 offset:38912
    v_mfma_f32_16x16x32_bf16 v[68:71], v[16:19], a[4:7], 0
    v_mfma_f32_16x16x32_bf16 v[72:75], v[16:19], a[8:11], 0
    v_mfma_f32_16x16x32_bf16 v[76:79], v[16:19], a[12:15], 0
    buffer_load_dwordx4 a[76:79], v2, s[4:7], s69 offen offset:0 sc1
    s_waitcnt lgkmcnt(3)
    v_mfma_f32_16x16x32_bf16 v[80:83], v[20:23], a[0:3], 0
    ds_read_b128 v[12:15], v4 offset:39936
    v_mfma_f32_16x16x32_bf16 v[84:87], v[20:23], a[4:7], 0
    v_mfma_f32_16x16x32_bf16 v[88:91], v[20:23], a[8:11], 0
    v_mfma_f32_16x16x32_bf16 v[92:95], v[20:23], a[12:15], 0
    buffer_load_dwordx4 a[80:83], v2, s[4:7], s59 offen offset:1024 sc1
    s_waitcnt vmcnt(22) lgkmcnt(3)
    v_mfma_f32_16x16x32_bf16 v[208:211], v[24:27], a[16:19], v[208:211]
    ds_read_b128 v[16:19], v4 offset:4096
    s_waitcnt vmcnt(21)
    v_mfma_f32_16x16x32_bf16 v[212:215], v[24:27], a[20:23], v[212:215]
    s_waitcnt vmcnt(20)
    v_mfma_f32_16x16x32_bf16 v[216:219], v[24:27], a[24:27], v[216:219]
    s_waitcnt vmcnt(19)
    v_mfma_f32_16x16x32_bf16 v[220:223], v[24:27], a[28:31], v[220:223]
    buffer_load_dwordx4 a[84:87], v2, s[4:7], s66 offen offset:1024 sc1
    s_waitcnt lgkmcnt(3)
    v_mfma_f32_16x16x32_bf16 v[224:227], v[28:31], a[16:19], v[224:227]
    ds_read_b128 v[20:23], v4 offset:5120
    v_mfma_f32_16x16x32_bf16 v[228:231], v[28:31], a[20:23], v[228:231]
    v_mfma_f32_16x16x32_bf16 v[232:235], v[28:31], a[24:27], v[232:235]
    v_mfma_f32_16x16x32_bf16 v[236:239], v[28:31], a[28:31], v[236:239]
    buffer_load_dwordx4 a[88:91], v2, s[4:7], s68 offen offset:1024 sc1
    s_waitcnt lgkmcnt(3)
    v_mfma_f32_16x16x32_bf16 v[64:67], v[8:11], a[16:19], v[64:67]
    ds_read_b128 v[24:27], v4 offset:40960
    v_mfma_f32_16x16x32_bf16 v[68:71], v[8:11], a[20:23], v[68:71]
    v_mfma_f32_16x16x32_bf16 v[72:75], v[8:11], a[24:27], v[72:75]
    v_mfma_f32_16x16x32_bf16 v[76:79], v[8:11], a[28:31], v[76:79]
    buffer_load_dwordx4 a[92:95], v2, s[4:7], s69 offen offset:1024 sc1
    s_waitcnt lgkmcnt(3)
    v_mfma_f32_16x16x32_bf16 v[80:83], v[12:15], a[16:19], v[80:83]
    ds_read_b128 v[28:31], v4 offset:41984
    v_mfma_f32_16x16x32_bf16 v[84:87], v[12:15], a[20:23], v[84:87]
    v_mfma_f32_16x16x32_bf16 v[88:91], v[12:15], a[24:27], v[88:91]
    v_mfma_f32_16x16x32_bf16 v[92:95], v[12:15], a[28:31], v[92:95]
    buffer_load_dwordx4 a[96:99], v2, s[4:7], s59 offen offset:2048 sc1
    s_waitcnt vmcnt(22) lgkmcnt(3)
    v_mfma_f32_16x16x32_bf16 v[208:211], v[16:19], a[32:35], v[208:211]
    ds_read_b128 v[8:11], v4 offset:6144
    s_waitcnt vmcnt(21)
    v_mfma_f32_16x16x32_bf16 v[212:215], v[16:19], a[36:39], v[212:215]
    s_waitcnt vmcnt(20)
    v_mfma_f32_16x16x32_bf16 v[216:219], v[16:19], a[40:43], v[216:219]
    s_waitcnt vmcnt(19)
    v_mfma_f32_16x16x32_bf16 v[220:223], v[16:19], a[44:47], v[220:223]
    buffer_load_dwordx4 a[100:103], v2, s[4:7], s66 offen offset:2048 sc1
    s_waitcnt lgkmcnt(3)
    v_mfma_f32_16x16x32_bf16 v[224:227], v[20:23], a[32:35], v[224:227]
    ds_read_b128 v[12:15], v4 offset:7168
    v_mfma_f32_16x16x32_bf16 v[228:231], v[20:23], a[36:39], v[228:231]
    v_mfma_f32_16x16x32_bf16 v[232:235], v[20:23], a[40:43], v[232:235]
    v_mfma_f32_16x16x32_bf16 v[236:239], v[20:23], a[44:47], v[236:239]
    buffer_load_dwordx4 a[104:107], v2, s[4:7], s68 offen offset:2048 sc1
    s_waitcnt lgkmcnt(3)
    v_mfma_f32_16x16x32_bf16 v[64:67], v[24:27], a[32:35], v[64:67]
    ds_read_b128 v[16:19], v4 offset:43008
    v_mfma_f32_16x16x32_bf16 v[68:71], v[24:27], a[36:39], v[68:71]
    v_mfma_f32_16x16x32_bf16 v[72:75], v[24:27], a[40:43], v[72:75]
    v_mfma_f32_16x16x32_bf16 v[76:79], v[24:27], a[44:47], v[76:79]
    buffer_load_dwordx4 a[108:111], v2, s[4:7], s69 offen offset:2048 sc1
    s_waitcnt lgkmcnt(3)
    v_mfma_f32_16x16x32_bf16 v[80:83], v[28:31], a[32:35], v[80:83]
    ds_read_b128 v[20:23], v4 offset:44032
    v_mfma_f32_16x16x32_bf16 v[84:87], v[28:31], a[36:39], v[84:87]
    v_mfma_f32_16x16x32_bf16 v[88:91], v[28:31], a[40:43], v[88:91]
    v_mfma_f32_16x16x32_bf16 v[92:95], v[28:31], a[44:47], v[92:95]
    buffer_load_dwordx4 a[112:115], v2, s[4:7], s59 offen offset:3072 sc1
    s_waitcnt vmcnt(22) lgkmcnt(3)
    v_mfma_f32_16x16x32_bf16 v[208:211], v[8:11], a[48:51], v[208:211]
    ds_read_b128 v[24:27], v4 offset:8192
    s_waitcnt vmcnt(21)
    v_mfma_f32_16x16x32_bf16 v[212:215], v[8:11], a[52:55], v[212:215]
    s_waitcnt vmcnt(20)
    v_mfma_f32_16x16x32_bf16 v[216:219], v[8:11], a[56:59], v[216:219]
    s_waitcnt vmcnt(19)
    v_mfma_f32_16x16x32_bf16 v[220:223], v[8:11], a[60:63], v[220:223]
    buffer_load_dwordx4 a[116:119], v2, s[4:7], s66 offen offset:3072 sc1
    s_waitcnt lgkmcnt(3)
    v_mfma_f32_16x16x32_bf16 v[224:227], v[12:15], a[48:51], v[224:227]
    ds_read_b128 v[28:31], v4 offset:9216
    v_mfma_f32_16x16x32_bf16 v[228:231], v[12:15], a[52:55], v[228:231]
    v_mfma_f32_16x16x32_bf16 v[232:235], v[12:15], a[56:59], v[232:235]
    v_mfma_f32_16x16x32_bf16 v[236:239], v[12:15], a[60:63], v[236:239]
    buffer_load_dwordx4 a[120:123], v2, s[4:7], s68 offen offset:3072 sc1
    s_waitcnt lgkmcnt(3)
    v_mfma_f32_16x16x32_bf16 v[64:67], v[16:19], a[48:51], v[64:67]
    ds_read_b128 v[8:11], v4 offset:45056
    v_mfma_f32_16x16x32_bf16 v[68:71], v[16:19], a[52:55], v[68:71]
    v_mfma_f32_16x16x32_bf16 v[72:75], v[16:19], a[56:59], v[72:75]
    v_mfma_f32_16x16x32_bf16 v[76:79], v[16:19], a[60:63], v[76:79]
    buffer_load_dwordx4 a[124:127], v2, s[4:7], s69 offen offset:3072 sc1
    s_add_u32 s59, s50, 8192
    s_waitcnt lgkmcnt(3)
    v_mfma_f32_16x16x32_bf16 v[80:83], v[20:23], a[48:51], v[80:83]
    ds_read_b128 v[12:15], v4 offset:46080
    v_mfma_f32_16x16x32_bf16 v[84:87], v[20:23], a[52:55], v[84:87]
    v_mfma_f32_16x16x32_bf16 v[88:91], v[20:23], a[56:59], v[88:91]
    v_mfma_f32_16x16x32_bf16 v[92:95], v[20:23], a[60:63], v[92:95]
    buffer_load_dwordx4 a[128:131], v2, s[4:7], s59 offen offset:0 sc1
    s_add_u32 s66, s50, 26624
    s_waitcnt vmcnt(16) lgkmcnt(3)
    v_mfma_f32_16x16x32_bf16 v[208:211], v[24:27], a[64:67], v[208:211]
    ds_read_b128 v[16:19], v4 offset:10240
    s_waitcnt vmcnt(15)
    v_mfma_f32_16x16x32_bf16 v[212:215], v[24:27], a[68:71], v[212:215]
    s_waitcnt vmcnt(14)
    v_mfma_f32_16x16x32_bf16 v[216:219], v[24:27], a[72:75], v[216:219]
    s_waitcnt vmcnt(13)
    v_mfma_f32_16x16x32_bf16 v[220:223], v[24:27], a[76:79], v[220:223]
    buffer_load_dwordx4 a[132:135], v2, s[4:7], s66 offen offset:0 sc1
    s_add_u32 s68, s50, 45056
    s_waitcnt lgkmcnt(3)
    v_mfma_f32_16x16x32_bf16 v[224:227], v[28:31], a[64:67], v[224:227]
    ds_read_b128 v[20:23], v4 offset:11264
    v_mfma_f32_16x16x32_bf16 v[228:231], v[28:31], a[68:71], v[228:231]
    v_mfma_f32_16x16x32_bf16 v[232:235], v[28:31], a[72:75], v[232:235]
    v_mfma_f32_16x16x32_bf16 v[236:239], v[28:31], a[76:79], v[236:239]
    buffer_load_dwordx4 a[136:139], v2, s[4:7], s68 offen offset:0 sc1
    s_add_u32 s69, s50, 63488
    s_waitcnt lgkmcnt(3)
    v_mfma_f32_16x16x32_bf16 v[64:67], v[8:11], a[64:67], v[64:67]
    ds_read_b128 v[24:27], v4 offset:47104
    v_mfma_f32_16x16x32_bf16 v[68:71], v[8:11], a[68:71], v[68:71]
    v_mfma_f32_16x16x32_bf16 v[72:75], v[8:11], a[72:75], v[72:75]
    v_mfma_f32_16x16x32_bf16 v[76:79], v[8:11], a[76:79], v[76:79]
    buffer_load_dwordx4 a[140:143], v2, s[4:7], s69 offen offset:0 sc1
    s_waitcnt lgkmcnt(3)
    v_mfma_f32_16x16x32_bf16 v[80:83], v[12:15], a[64:67], v[80:83]
    ds_read_b128 v[28:31], v4 offset:48128
    v_mfma_f32_16x16x32_bf16 v[84:87], v[12:15], a[68:71], v[84:87]
    v_mfma_f32_16x16x32_bf16 v[88:91], v[12:15], a[72:75], v[88:91]
    v_mfma_f32_16x16x32_bf16 v[92:95], v[12:15], a[76:79], v[92:95]
    buffer_load_dwordx4 a[144:147], v2, s[4:7], s59 offen offset:1024 sc1
    s_waitcnt vmcnt(16) lgkmcnt(3)
    v_mfma_f32_16x16x32_bf16 v[208:211], v[16:19], a[80:83], v[208:211]
    ds_read_b128 v[8:11], v4 offset:12288
    s_waitcnt vmcnt(15)
    v_mfma_f32_16x16x32_bf16 v[212:215], v[16:19], a[84:87], v[212:215]
    s_waitcnt vmcnt(14)
    v_mfma_f32_16x16x32_bf16 v[216:219], v[16:19], a[88:91], v[216:219]
    s_waitcnt vmcnt(13)
    v_mfma_f32_16x16x32_bf16 v[220:223], v[16:19], a[92:95], v[220:223]
    buffer_load_dwordx4 a[148:151], v2, s[4:7], s66 offen offset:1024 sc1
    s_waitcnt lgkmcnt(3)
    v_mfma_f32_16x16x32_bf16 v[224:227], v[20:23], a[80:83], v[224:227]
    ds_read_b128 v[12:15], v4 offset:13312
    v_mfma_f32_16x16x32_bf16 v[228:231], v[20:23], a[84:87], v[228:231]
    v_mfma_f32_16x16x32_bf16 v[232:235], v[20:23], a[88:91], v[232:235]
    v_mfma_f32_16x16x32_bf16 v[236:239], v[20:23], a[92:95], v[236:239]
    buffer_load_dwordx4 a[152:155], v2, s[4:7], s68 offen offset:1024 sc1
    s_waitcnt lgkmcnt(3)
    v_mfma_f32_16x16x32_bf16 v[64:67], v[24:27], a[80:83], v[64:67]
    ds_read_b128 v[16:19], v4 offset:49152
    v_mfma_f32_16x16x32_bf16 v[68:71], v[24:27], a[84:87], v[68:71]
    v_mfma_f32_16x16x32_bf16 v[72:75], v[24:27], a[88:91], v[72:75]
    v_mfma_f32_16x16x32_bf16 v[76:79], v[24:27], a[92:95], v[76:79]
    buffer_load_dwordx4 a[156:159], v2, s[4:7], s69 offen offset:1024 sc1
    s_waitcnt lgkmcnt(3)
    v_mfma_f32_16x16x32_bf16 v[80:83], v[28:31], a[80:83], v[80:83]
    ds_read_b128 v[20:23], v4 offset:50176
    v_mfma_f32_16x16x32_bf16 v[84:87], v[28:31], a[84:87], v[84:87]
    v_mfma_f32_16x16x32_bf16 v[88:91], v[28:31], a[88:91], v[88:91]
    v_mfma_f32_16x16x32_bf16 v[92:95], v[28:31], a[92:95], v[92:95]
    buffer_load_dwordx4 a[160:163], v2, s[4:7], s59 offen offset:2048 sc1
    s_waitcnt vmcnt(16) lgkmcnt(3)
    v_mfma_f32_16x16x32_bf16 v[208:211], v[8:11], a[96:99], v[208:211]
    ds_read_b128 v[24:27], v4 offset:14336
    s_waitcnt vmcnt(15)
    v_mfma_f32_16x16x32_bf16 v[212:215], v[8:11], a[100:103], v[212:215]
    s_waitcnt vmcnt(14)
    v_mfma_f32_16x16x32_bf16 v[216:219], v[8:11], a[104:107], v[216:219]
    s_waitcnt vmcnt(13)
    v_mfma_f32_16x16x32_bf16 v[220:223], v[8:11], a[108:111], v[220:223]
    buffer_load_dwordx4 a[164:167], v2, s[4:7], s66 offen offset:2048 sc1
    s_waitcnt lgkmcnt(3)
    v_mfma_f32_16x16x32_bf16 v[224:227], v[12:15], a[96:99], v[224:227]
    ds_read_b128 v[28:31], v4 offset:15360
    v_mfma_f32_16x16x32_bf16 v[228:231], v[12:15], a[100:103], v[228:231]
    v_mfma_f32_16x16x32_bf16 v[232:235], v[12:15], a[104:107], v[232:235]
    v_mfma_f32_16x16x32_bf16 v[236:239], v[12:15], a[108:111], v[236:239]
    buffer_load_dwordx4 a[168:171], v2, s[4:7], s68 offen offset:2048 sc1
    s_waitcnt lgkmcnt(3)
    v_mfma_f32_16x16x32_bf16 v[64:67], v[16:19], a[96:99], v[64:67]
    ds_read_b128 v[8:11], v4 offset:51200
    v_mfma_f32_16x16x32_bf16 v[68:71], v[16:19], a[100:103], v[68:71]
    v_mfma_f32_16x16x32_bf16 v[72:75], v[16:19], a[104:107], v[72:75]
    v_mfma_f32_16x16x32_bf16 v[76:79], v[16:19], a[108:111], v[76:79]
    buffer_load_dwordx4 a[172:175], v2, s[4:7], s69 offen offset:2048 sc1
    s_waitcnt lgkmcnt(3)
    v_mfma_f32_16x16x32_bf16 v[80:83], v[20:23], a[96:99], v[80:83]
    ds_read_b128 v[12:15], v4 offset:52224
    v_mfma_f32_16x16x32_bf16 v[84:87], v[20:23], a[100:103], v[84:87]
    v_mfma_f32_16x16x32_bf16 v[88:91], v[20:23], a[104:107], v[88:91]
    v_mfma_f32_16x16x32_bf16 v[92:95], v[20:23], a[108:111], v[92:95]
    buffer_load_dwordx4 a[176:179], v2, s[4:7], s59 offen offset:3072 sc1
    s_waitcnt vmcnt(16) lgkmcnt(3)
    v_mfma_f32_16x16x32_bf16 v[208:211], v[24:27], a[112:115], v[208:211]
    ds_read_b128 v[16:19], v4 offset:16384
    s_waitcnt vmcnt(15)
    v_mfma_f32_16x16x32_bf16 v[212:215], v[24:27], a[116:119], v[212:215]
    s_waitcnt vmcnt(14)
    v_mfma_f32_16x16x32_bf16 v[216:219], v[24:27], a[120:123], v[216:219]
    s_waitcnt vmcnt(13)
    v_mfma_f32_16x16x32_bf16 v[220:223], v[24:27], a[124:127], v[220:223]
    buffer_load_dwordx4 a[180:183], v2, s[4:7], s66 offen offset:3072 sc1
    s_waitcnt lgkmcnt(3)
    v_mfma_f32_16x16x32_bf16 v[224:227], v[28:31], a[112:115], v[224:227]
    ds_read_b128 v[20:23], v4 offset:17408
    v_mfma_f32_16x16x32_bf16 v[228:231], v[28:31], a[116:119], v[228:231]
    v_mfma_f32_16x16x32_bf16 v[232:235], v[28:31], a[120:123], v[232:235]
    v_mfma_f32_16x16x32_bf16 v[236:239], v[28:31], a[124:127], v[236:239]
    buffer_load_dwordx4 a[184:187], v2, s[4:7], s68 offen offset:3072 sc1
    s_waitcnt lgkmcnt(3)
    v_mfma_f32_16x16x32_bf16 v[64:67], v[8:11], a[112:115], v[64:67]
    ds_read_b128 v[24:27], v4 offset:53248
    v_mfma_f32_16x16x32_bf16 v[68:71], v[8:11], a[116:119], v[68:71]
    v_mfma_f32_16x16x32_bf16 v[72:75], v[8:11], a[120:123], v[72:75]
    v_mfma_f32_16x16x32_bf16 v[76:79], v[8:11], a[124:127], v[76:79]
    buffer_load_dwordx4 a[188:191], v2, s[4:7], s69 offen offset:3072 sc1
    s_add_u32 s59, s50, 12288
    s_waitcnt lgkmcnt(3)
    v_mfma_f32_16x16x32_bf16 v[80:83], v[12:15], a[112:115], v[80:83]
    ds_read_b128 v[28:31], v4 offset:54272
    v_mfma_f32_16x16x32_bf16 v[84:87], v[12:15], a[116:119], v[84:87]
    v_mfma_f32_16x16x32_bf16 v[88:91], v[12:15], a[120:123], v[88:91]
    v_mfma_f32_16x16x32_bf16 v[92:95], v[12:15], a[124:127], v[92:95]
    buffer_load_dwordx4 a[192:195], v2, s[4:7], s59 offen offset:0 sc1
    s_add_u32 s66, s50, 30720
    s_waitcnt vmcnt(16) lgkmcnt(3)
    v_mfma_f32_16x16x32_bf16 v[208:211], v[16:19], a[128:131], v[208:211]
    ds_read_b128 v[8:11], v4 offset:18432
    s_waitcnt vmcnt(15)
    v_mfma_f32_16x16x32_bf16 v[212:215], v[16:19], a[132:135], v[212:215]
    s_waitcnt vmcnt(14)
    v_mfma_f32_16x16x32_bf16 v[216:219], v[16:19], a[136:139], v[216:219]
    s_waitcnt vmcnt(13)
    v_mfma_f32_16x16x32_bf16 v[220:223], v[16:19], a[140:143], v[220:223]
    buffer_load_dwordx4 a[196:199], v2, s[4:7], s66 offen offset:0 sc1
    s_add_u32 s68, s50, 49152
    s_waitcnt lgkmcnt(3)
    v_mfma_f32_16x16x32_bf16 v[224:227], v[20:23], a[128:131], v[224:227]
    ds_read_b128 v[12:15], v4 offset:19456
    v_mfma_f32_16x16x32_bf16 v[228:231], v[20:23], a[132:135], v[228:231]
    v_mfma_f32_16x16x32_bf16 v[232:235], v[20:23], a[136:139], v[232:235]
    v_mfma_f32_16x16x32_bf16 v[236:239], v[20:23], a[140:143], v[236:239]
    buffer_load_dwordx4 a[200:203], v2, s[4:7], s68 offen offset:0 sc1
    s_add_u32 s69, s50, 67584
    s_waitcnt lgkmcnt(3)
    v_mfma_f32_16x16x32_bf16 v[64:67], v[24:27], a[128:131], v[64:67]
    ds_read_b128 v[16:19], v4 offset:55296
    v_mfma_f32_16x16x32_bf16 v[68:71], v[24:27], a[132:135], v[68:71]
    v_mfma_f32_16x16x32_bf16 v[72:75], v[24:27], a[136:139], v[72:75]
    v_mfma_f32_16x16x32_bf16 v[76:79], v[24:27], a[140:143], v[76:79]
    buffer_load_dwordx4 a[204:207], v2, s[4:7], s69 offen offset:0 sc1
    s_waitcnt lgkmcnt(3)
    v_mfma_f32_16x16x32_bf16 v[80:83], v[28:31], a[128:131], v[80:83]
    ds_read_b128 v[20:23], v4 offset:56320
    v_mfma_f32_16x16x32_bf16 v[84:87], v[28:31], a[132:135], v[84:87]
    v_mfma_f32_16x16x32_bf16 v[88:91], v[28:31], a[136:139], v[88:91]
    v_mfma_f32_16x16x32_bf16 v[92:95], v[28:31], a[140:143], v[92:95]
    buffer_load_dwordx4 a[208:211], v2, s[4:7], s59 offen offset:1024 sc1
    s_waitcnt vmcnt(16) lgkmcnt(3)
    v_mfma_f32_16x16x32_bf16 v[208:211], v[8:11], a[144:147], v[208:211]
    ds_read_b128 v[24:27], v4 offset:20480
    s_waitcnt vmcnt(15)
    v_mfma_f32_16x16x32_bf16 v[212:215], v[8:11], a[148:151], v[212:215]
    s_waitcnt vmcnt(14)
    v_mfma_f32_16x16x32_bf16 v[216:219], v[8:11], a[152:155], v[216:219]
    s_waitcnt vmcnt(13)
    v_mfma_f32_16x16x32_bf16 v[220:223], v[8:11], a[156:159], v[220:223]
    buffer_load_dwordx4 a[212:215], v2, s[4:7], s66 offen offset:1024 sc1
    s_waitcnt lgkmcnt(3)
    v_mfma_f32_16x16x32_bf16 v[224:227], v[12:15], a[144:147], v[224:227]
    ds_read_b128 v[28:31], v4 offset:21504
    v_mfma_f32_16x16x32_bf16 v[228:231], v[12:15], a[148:151], v[228:231]
    v_mfma_f32_16x16x32_bf16 v[232:235], v[12:15], a[152:155], v[232:235]
    v_mfma_f32_16x16x32_bf16 v[236:239], v[12:15], a[156:159], v[236:239]
    buffer_load_dwordx4 a[216:219], v2, s[4:7], s68 offen offset:1024 sc1
    s_waitcnt lgkmcnt(3)
    v_mfma_f32_16x16x32_bf16 v[64:67], v[16:19], a[144:147], v[64:67]
    ds_read_b128 v[8:11], v4 offset:57344
    v_mfma_f32_16x16x32_bf16 v[68:71], v[16:19], a[148:151], v[68:71]
    v_mfma_f32_16x16x32_bf16 v[72:75], v[16:19], a[152:155], v[72:75]
    v_mfma_f32_16x16x32_bf16 v[76:79], v[16:19], a[156:159], v[76:79]
    buffer_load_dwordx4 a[220:223], v2, s[4:7], s69 offen offset:1024 sc1
    s_waitcnt lgkmcnt(3)
    v_mfma_f32_16x16x32_bf16 v[80:83], v[20:23], a[144:147], v[80:83]
    ds_read_b128 v[12:15], v4 offset:58368
    v_mfma_f32_16x16x32_bf16 v[84:87], v[20:23], a[148:151], v[84:87]
    v_mfma_f32_16x16x32_bf16 v[88:91], v[20:23], a[152:155], v[88:91]
    v_mfma_f32_16x16x32_bf16 v[92:95], v[20:23], a[156:159], v[92:95]
    buffer_load_dwordx4 a[224:227], v2, s[4:7], s59 offen offset:2048 sc1
    s_waitcnt vmcnt(16) lgkmcnt(3)
    v_mfma_f32_16x16x32_bf16 v[208:211], v[24:27], a[160:163], v[208:211]
    ds_read_b128 v[16:19], v4 offset:22528
    s_waitcnt vmcnt(15)
    v_mfma_f32_16x16x32_bf16 v[212:215], v[24:27], a[164:167], v[212:215]
    s_waitcnt vmcnt(14)
    v_mfma_f32_16x16x32_bf16 v[216:219], v[24:27], a[168:171], v[216:219]
    s_waitcnt vmcnt(13)
    v_mfma_f32_16x16x32_bf16 v[220:223], v[24:27], a[172:175], v[220:223]
    buffer_load_dwordx4 a[228:231], v2, s[4:7], s66 offen offset:2048 sc1
    s_waitcnt lgkmcnt(3)
    v_mfma_f32_16x16x32_bf16 v[224:227], v[28:31], a[160:163], v[224:227]
    ds_read_b128 v[20:23], v4 offset:23552
    v_mfma_f32_16x16x32_bf16 v[228:231], v[28:31], a[164:167], v[228:231]
    v_mfma_f32_16x16x32_bf16 v[232:235], v[28:31], a[168:171], v[232:235]
    v_mfma_f32_16x16x32_bf16 v[236:239], v[28:31], a[172:175], v[236:239]
    buffer_load_dwordx4 a[232:235], v2, s[4:7], s68 offen offset:2048 sc1
    s_waitcnt lgkmcnt(3)
    v_mfma_f32_16x16x32_bf16 v[64:67], v[8:11], a[160:163], v[64:67]
    ds_read_b128 v[24:27], v4 offset:59392
    v_mfma_f32_16x16x32_bf16 v[68:71], v[8:11], a[164:167], v[68:71]
    v_mfma_f32_16x16x32_bf16 v[72:75], v[8:11], a[168:171], v[72:75]
    v_mfma_f32_16x16x32_bf16 v[76:79], v[8:11], a[172:175], v[76:79]
    buffer_load_dwordx4 a[236:239], v2, s[4:7], s69 offen offset:2048 sc1
    s_waitcnt lgkmcnt(3)
    v_mfma_f32_16x16x32_bf16 v[80:83], v[12:15], a[160:163], v[80:83]
    ds_read_b128 v[28:31], v4 offset:60416
    v_mfma_f32_16x16x32_bf16 v[84:87], v[12:15], a[164:167], v[84:87]
    v_mfma_f32_16x16x32_bf16 v[88:91], v[12:15], a[168:171], v[88:91]
    v_mfma_f32_16x16x32_bf16 v[92:95], v[12:15], a[172:175], v[92:95]
    buffer_load_dwordx4 a[240:243], v2, s[4:7], s59 offen offset:3072 sc1
    s_waitcnt vmcnt(16) lgkmcnt(3)
    v_mfma_f32_16x16x32_bf16 v[208:211], v[16:19], a[176:179], v[208:211]
    ds_read_b128 v[8:11], v4 offset:24576
    s_waitcnt vmcnt(15)
    v_mfma_f32_16x16x32_bf16 v[212:215], v[16:19], a[180:183], v[212:215]
    s_waitcnt vmcnt(14)
    v_mfma_f32_16x16x32_bf16 v[216:219], v[16:19], a[184:187], v[216:219]
    s_waitcnt vmcnt(13)
    v_mfma_f32_16x16x32_bf16 v[220:223], v[16:19], a[188:191], v[220:223]
    buffer_load_dwordx4 a[244:247], v2, s[4:7], s66 offen offset:3072 sc1
    s_waitcnt lgkmcnt(3)
    v_mfma_f32_16x16x32_bf16 v[224:227], v[20:23], a[176:179], v[224:227]
    ds_read_b128 v[12:15], v4 offset:25600
    v_mfma_f32_16x16x32_bf16 v[228:231], v[20:23], a[180:183], v[228:231]
    v_mfma_f32_16x16x32_bf16 v[232:235], v[20:23], a[184:187], v[232:235]
    v_mfma_f32_16x16x32_bf16 v[236:239], v[20:23], a[188:191], v[236:239]
    buffer_load_dwordx4 a[248:251], v2, s[4:7], s68 offen offset:3072 sc1
    s_waitcnt lgkmcnt(3)
    v_mfma_f32_16x16x32_bf16 v[64:67], v[24:27], a[176:179], v[64:67]
    ds_read_b128 v[16:19], v4 offset:61440
    v_mfma_f32_16x16x32_bf16 v[68:71], v[24:27], a[180:183], v[68:71]
    v_mfma_f32_16x16x32_bf16 v[72:75], v[24:27], a[184:187], v[72:75]
    v_mfma_f32_16x16x32_bf16 v[76:79], v[24:27], a[188:191], v[76:79]
    buffer_load_dwordx4 a[252:255], v2, s[4:7], s69 offen offset:3072 sc1
    s_add_u32 s59, s50, 16384
    s_waitcnt lgkmcnt(3)
    v_mfma_f32_16x16x32_bf16 v[80:83], v[28:31], a[176:179], v[80:83]
    ds_read_b128 v[20:23], v4 offset:62464
    v_mfma_f32_16x16x32_bf16 v[84:87], v[28:31], a[180:183], v[84:87]
    v_mfma_f32_16x16x32_bf16 v[88:91], v[28:31], a[184:187], v[88:91]
    v_mfma_f32_16x16x32_bf16 v[92:95], v[28:31], a[188:191], v[92:95]
    buffer_load_dwordx4 v[32:35], v2, s[4:7], s59 offen offset:0 sc1
    s_add_u32 s66, s50, 34816
    s_waitcnt vmcnt(16) lgkmcnt(3)
    v_mfma_f32_16x16x32_bf16 v[208:211], v[8:11], a[192:195], v[208:211]
    ds_read_b128 v[24:27], v4 offset:26624
    s_waitcnt vmcnt(15)
    v_mfma_f32_16x16x32_bf16 v[212:215], v[8:11], a[196:199], v[212:215]
    s_waitcnt vmcnt(14)
    v_mfma_f32_16x16x32_bf16 v[216:219], v[8:11], a[200:203], v[216:219]
    s_waitcnt vmcnt(13)
    v_mfma_f32_16x16x32_bf16 v[220:223], v[8:11], a[204:207], v[220:223]
    buffer_load_dwordx4 v[36:39], v2, s[4:7], s66 offen offset:0 sc1
    s_add_u32 s68, s50, 53248
    s_waitcnt lgkmcnt(3)
    v_mfma_f32_16x16x32_bf16 v[224:227], v[12:15], a[192:195], v[224:227]
    ds_read_b128 v[28:31], v4 offset:27648
    v_mfma_f32_16x16x32_bf16 v[228:231], v[12:15], a[196:199], v[228:231]
    v_mfma_f32_16x16x32_bf16 v[232:235], v[12:15], a[200:203], v[232:235]
    v_mfma_f32_16x16x32_bf16 v[236:239], v[12:15], a[204:207], v[236:239]
    buffer_load_dwordx4 v[40:43], v2, s[4:7], s68 offen offset:0 sc1
    s_add_u32 s69, s50, 71680
    s_waitcnt lgkmcnt(3)
    v_mfma_f32_16x16x32_bf16 v[64:67], v[16:19], a[192:195], v[64:67]
    ds_read_b128 v[8:11], v4 offset:63488
    v_mfma_f32_16x16x32_bf16 v[68:71], v[16:19], a[196:199], v[68:71]
    v_mfma_f32_16x16x32_bf16 v[72:75], v[16:19], a[200:203], v[72:75]
    v_mfma_f32_16x16x32_bf16 v[76:79], v[16:19], a[204:207], v[76:79]
    buffer_load_dwordx4 v[44:47], v2, s[4:7], s69 offen offset:0 sc1
    s_waitcnt lgkmcnt(3)
    v_mfma_f32_16x16x32_bf16 v[80:83], v[20:23], a[192:195], v[80:83]
    ds_read_b128 v[12:15], v4 offset:64512
    v_mfma_f32_16x16x32_bf16 v[84:87], v[20:23], a[196:199], v[84:87]
    v_mfma_f32_16x16x32_bf16 v[88:91], v[20:23], a[200:203], v[88:91]
    v_mfma_f32_16x16x32_bf16 v[92:95], v[20:23], a[204:207], v[92:95]
    buffer_load_dwordx4 v[48:51], v2, s[4:7], s59 offen offset:1024 sc1
    s_waitcnt vmcnt(16) lgkmcnt(3)
    v_mfma_f32_16x16x32_bf16 v[208:211], v[24:27], a[208:211], v[208:211]
    ds_read_b128 v[16:19], v4 offset:28672
    s_waitcnt vmcnt(15)
    v_mfma_f32_16x16x32_bf16 v[212:215], v[24:27], a[212:215], v[212:215]
    s_waitcnt vmcnt(14)
    v_mfma_f32_16x16x32_bf16 v[216:219], v[24:27], a[216:219], v[216:219]
    s_waitcnt vmcnt(13)
    v_mfma_f32_16x16x32_bf16 v[220:223], v[24:27], a[220:223], v[220:223]
    buffer_load_dwordx4 v[52:55], v2, s[4:7], s66 offen offset:1024 sc1
    s_waitcnt lgkmcnt(3)
    v_mfma_f32_16x16x32_bf16 v[224:227], v[28:31], a[208:211], v[224:227]
    ds_read_b128 v[20:23], v4 offset:29696
    v_mfma_f32_16x16x32_bf16 v[228:231], v[28:31], a[212:215], v[228:231]
    v_mfma_f32_16x16x32_bf16 v[232:235], v[28:31], a[216:219], v[232:235]
    v_mfma_f32_16x16x32_bf16 v[236:239], v[28:31], a[220:223], v[236:239]
    buffer_load_dwordx4 v[56:59], v2, s[4:7], s68 offen offset:1024 sc1
    s_waitcnt lgkmcnt(3)
    v_mfma_f32_16x16x32_bf16 v[64:67], v[8:11], a[208:211], v[64:67]
    ds_read_b128 v[24:27], v7 offset:0
    v_mfma_f32_16x16x32_bf16 v[68:71], v[8:11], a[212:215], v[68:71]
    v_mfma_f32_16x16x32_bf16 v[72:75], v[8:11], a[216:219], v[72:75]
    v_mfma_f32_16x16x32_bf16 v[76:79], v[8:11], a[220:223], v[76:79]
    buffer_load_dwordx4 v[60:63], v2, s[4:7], s69 offen offset:1024 sc1
    s_waitcnt lgkmcnt(3)
    v_mfma_f32_16x16x32_bf16 v[80:83], v[12:15], a[208:211], v[80:83]
    ds_read_b128 v[28:31], v7 offset:1024
    v_mfma_f32_16x16x32_bf16 v[84:87], v[12:15], a[212:215], v[84:87]
    v_mfma_f32_16x16x32_bf16 v[88:91], v[12:15], a[216:219], v[88:91]
    v_mfma_f32_16x16x32_bf16 v[92:95], v[12:15], a[220:223], v[92:95]
    s_waitcnt vmcnt(15) lgkmcnt(3)
    v_mfma_f32_16x16x32_bf16 v[208:211], v[16:19], a[224:227], v[208:211]
    ds_read_b128 v[8:11], v4 offset:30720
    s_waitcnt vmcnt(14)
    v_mfma_f32_16x16x32_bf16 v[212:215], v[16:19], a[228:231], v[212:215]
    s_waitcnt vmcnt(13)
    v_mfma_f32_16x16x32_bf16 v[216:219], v[16:19], a[232:235], v[216:219]
    s_waitcnt vmcnt(12)
    v_mfma_f32_16x16x32_bf16 v[220:223], v[16:19], a[236:239], v[220:223]
    s_waitcnt lgkmcnt(3)
    v_mfma_f32_16x16x32_bf16 v[224:227], v[20:23], a[224:227], v[224:227]
    ds_read_b128 v[12:15], v4 offset:31744
    v_mfma_f32_16x16x32_bf16 v[228:231], v[20:23], a[228:231], v[228:231]
    v_mfma_f32_16x16x32_bf16 v[232:235], v[20:23], a[232:235], v[232:235]
    v_mfma_f32_16x16x32_bf16 v[236:239], v[20:23], a[236:239], v[236:239]
    s_waitcnt lgkmcnt(3)
    v_mfma_f32_16x16x32_bf16 v[64:67], v[24:27], a[224:227], v[64:67]
    ds_read_b128 v[16:19], v7 offset:2048
    v_mfma_f32_16x16x32_bf16 v[68:71], v[24:27], a[228:231], v[68:71]
    v_mfma_f32_16x16x32_bf16 v[72:75], v[24:27], a[232:235], v[72:75]
    v_mfma_f32_16x16x32_bf16 v[76:79], v[24:27], a[236:239], v[76:79]
    s_waitcnt lgkmcnt(3)
    v_mfma_f32_16x16x32_bf16 v[80:83], v[28:31], a[224:227], v[80:83]
    ds_read_b128 v[20:23], v7 offset:3072
    v_mfma_f32_16x16x32_bf16 v[84:87], v[28:31], a[228:231], v[84:87]
    v_add_f32 v166, v152, v154
    v_add_f32 v167, v153, v155
    v_mfma_f32_16x16x32_bf16 v[88:91], v[28:31], a[232:235], v[88:91]
    v_add_f32 v166, v166, v156
    v_add_f32 v167, v167, v157
    v_mfma_f32_16x16x32_bf16 v[92:95], v[28:31], a[236:239], v[92:95]
    v_add_f32 v166, v166, v158
    v_add_f32 v167, v167, v159
    s_waitcnt vmcnt(11) lgkmcnt(3)
    v_mfma_f32_16x16x32_bf16 v[208:211], v[8:11], a[240:243], v[208:211]
    ds_read_b128 v[24:27], v4 offset:32768
    v_add_f32 v166, v166, v160
    s_waitcnt vmcnt(10)
    v_mfma_f32_16x16x32_bf16 v[212:215], v[8:11], a[244:247], v[212:215]
    v_add_f32 v167, v167, v161
    v_add_f32 v166, v166, v162
    s_waitcnt vmcnt(9)
    v_mfma_f32_16x16x32_bf16 v[216:219], v[8:11], a[248:251], v[216:219]
    v_add_f32 v167, v167, v163
    v_mul_f32 v166, 0xbae38e39, v166
    s_waitcnt vmcnt(8)
    v_mfma_f32_16x16x32_bf16 v[220:223], v[8:11], a[252:255], v[220:223]
    v_fmamk_f32 v165, v152, 0x3c2aaaab, v166
    v_mul_f32 v164, v165, v165
    s_waitcnt lgkmcnt(3)
    v_mfma_f32_16x16x32_bf16 v[224:227], v[12:15], a[240:243], v[224:227]
    ds_read_b128 v[28:31], v4 offset:33792
    v_fmamk_f32 v165, v154, 0x3c2aaaab, v166
    v_mfma_f32_16x16x32_bf16 v[228:231], v[12:15], a[244:247], v[228:231]
    v_fmac_f32 v164, v165, v165
    v_fmamk_f32 v165, v156, 0x3c2aaaab, v166
    v_mfma_f32_16x16x32_bf16 v[232:235], v[12:15], a[248:251], v[232:235]
    v_fmac_f32 v164, v165, v165
    v_fmamk_f32 v165, v158, 0x3c2aaaab, v166
    v_mfma_f32_16x16x32_bf16 v[236:239], v[12:15], a[252:255], v[236:239]
    v_fmac_f32 v164, v165, v165
    v_fmamk_f32 v165, v160, 0x3c2aaaab, v166
    s_waitcnt lgkmcnt(3)
    v_mfma_f32_16x16x32_bf16 v[64:67], v[16:19], a[240:243], v[64:67]
    ds_read_b128 v[8:11], v7 offset:4096
    v_fmac_f32 v164, v165, v165
    v_mfma_f32_16x16x32_bf16 v[68:71], v[16:19], a[244:247], v[68:71]
    v_fmamk_f32 v165, v162, 0x3c2aaaab, v166
    v_fmac_f32 v164, v165, v165
    v_mfma_f32_16x16x32_bf16 v[72:75], v[16:19], a[248:251], v[72:75]
    v_fmac_f32 v167, 0x42c00000, v164
    v_mov_b32 v165, 0x3727c5ac
    v_mfma_f32_16x16x32_bf16 v[76:79], v[16:19], a[252:255], v[76:79]
    v_fmac_f32 v165, 0x3ae38e39, v167
    v_rcp_f32 v167, v165
    s_waitcnt lgkmcnt(3)
    v_mfma_f32_16x16x32_bf16 v[80:83], v[20:23], a[240:243], v[80:83]
    ds_read_b128 v[12:15], v7 offset:5120
    v_and_b32 v164, 15, v1
    v_mfma_f32_16x16x32_bf16 v[84:87], v[20:23], a[244:247], v[84:87]
    v_lshlrev_b32 v164, 2, v164
    ds_bpermute_b32 v128, v164, v166 offset:0
    v_mfma_f32_16x16x32_bf16 v[88:91], v[20:23], a[248:251], v[88:91]
    ds_bpermute_b32 v132, v164, v167 offset:0
    ds_bpermute_b32 v129, v164, v166 offset:64
    v_mfma_f32_16x16x32_bf16 v[92:95], v[20:23], a[252:255], v[92:95]
    ds_bpermute_b32 v133, v164, v167 offset:64
    ds_bpermute_b32 v130, v164, v166 offset:128
    s_waitcnt vmcnt(7) lgkmcnt(8)
    v_mfma_f32_16x16x32_bf16 v[208:211], v[24:27], v[32:35], v[208:211]
    ds_read_b128 v[16:19], v4 offset:34816
    ds_bpermute_b32 v134, v164, v167 offset:128
    s_waitcnt vmcnt(6)
    v_mfma_f32_16x16x32_bf16 v[212:215], v[24:27], v[36:39], v[212:215]
    ds_bpermute_b32 v131, v164, v166 offset:192
    ds_bpermute_b32 v135, v164, v167 offset:192
    s_waitcnt vmcnt(5)
    v_mfma_f32_16x16x32_bf16 v[216:219], v[24:27], v[40:43], v[216:219]
    s_waitcnt vmcnt(4)
    v_mfma_f32_16x16x32_bf16 v[220:223], v[24:27], v[44:47], v[220:223]
    s_waitcnt lgkmcnt(11)
    v_mfma_f32_16x16x32_bf16 v[224:227], v[28:31], v[32:35], v[224:227]
    ds_read_b128 v[20:23], v4 offset:35840
    v_mfma_f32_16x16x32_bf16 v[228:231], v[28:31], v[36:39], v[228:231]
    v_mfma_f32_16x16x32_bf16 v[232:235], v[28:31], v[40:43], v[232:235]
    v_mfma_f32_16x16x32_bf16 v[236:239], v[28:31], v[44:47], v[236:239]
    s_waitcnt lgkmcnt(11)
    v_mfma_f32_16x16x32_bf16 v[64:67], v[8:11], v[32:35], v[64:67]
    ds_read_b128 v[24:27], v7 offset:6144
    v_mfma_f32_16x16x32_bf16 v[68:71], v[8:11], v[36:39], v[68:71]
    v_mfma_f32_16x16x32_bf16 v[72:75], v[8:11], v[40:43], v[72:75]
    v_mfma_f32_16x16x32_bf16 v[76:79], v[8:11], v[44:47], v[76:79]
    ds_read_b128 v[136:139], v5 offset:0
    ds_read_b128 v[140:143], v5 offset:64
    s_waitcnt lgkmcnt(13)
    v_mfma_f32_16x16x32_bf16 v[80:83], v[12:15], v[32:35], v[80:83]
    ds_read_b128 v[28:31], v7 offset:7168
    ds_read_b128 v[144:147], v5 offset:128
    v_mfma_f32_16x16x32_bf16 v[84:87], v[12:15], v[36:39], v[84:87]
    ds_read_b128 v[148:151], v5 offset:192
    v_mfma_f32_16x16x32_bf16 v[88:91], v[12:15], v[40:43], v[88:91]
    v_mfma_f32_16x16x32_bf16 v[92:95], v[12:15], v[44:47], v[92:95]
    s_waitcnt vmcnt(3) lgkmcnt(10)
    v_mfma_f32_16x16x32_bf16 v[208:211], v[16:19], v[48:51], v[208:211]
    s_waitcnt lgkmcnt(0)
    s_barrier
    s_waitcnt vmcnt(2)
    v_mfma_f32_16x16x32_bf16 v[212:215], v[16:19], v[52:55], v[212:215]
    v_add_u32 v4, 0x12000, v4
    ds_read_b128 v[8:11], v4 offset:0
    s_waitcnt vmcnt(1)
    v_mfma_f32_16x16x32_bf16 v[216:219], v[16:19], v[56:59], v[216:219]
    s_add_u32 m0, s49, 0
    s_add_u32 s61, s48, 147456
    s_waitcnt vmcnt(0)
    v_mfma_f32_16x16x32_bf16 v[220:223], v[16:19], v[60:63], v[220:223]
    buffer_load_dwordx4 v2, s[4:7], s61 offen offset:0 lds
    v_mfma_f32_16x16x32_bf16 v[224:227], v[20:23], v[48:51], v[224:227]
    ds_read_b128 v[12:15], v4 offset:1024
    v_mfma_f32_16x16x32_bf16 v[228:231], v[20:23], v[52:55], v[228:231]
    v_mfma_f32_16x16x32_bf16 v[232:235], v[20:23], v[56:59], v[232:235]
    v_mfma_f32_16x16x32_bf16 v[236:239], v[20:23], v[60:63], v[236:239]
    buffer_load_dwordx4 v2, s[4:7], s61 offen offset:1024 lds
    v_mfma_f32_16x16x32_bf16 v[64:67], v[24:27], v[48:51], v[64:67]
    ds_read_b128 v[16:19], v4 offset:2048
    v_mfma_f32_16x16x32_bf16 v[68:71], v[24:27], v[52:55], v[68:71]
    v_mfma_f32_16x16x32_bf16 v[72:75], v[24:27], v[56:59], v[72:75]
    v_mfma_f32_16x16x32_bf16 v[76:79], v[24:27], v[60:63], v[76:79]
    buffer_load_dwordx4 v2, s[4:7], s61 offen offset:2048 lds
    v_mfma_f32_16x16x32_bf16 v[80:83], v[28:31], v[48:51], v[80:83]
    ds_read_b128 v[20:23], v4 offset:3072
    v_mfma_f32_16x16x32_bf16 v[84:87], v[28:31], v[52:55], v[84:87]
    v_mfma_f32_16x16x32_bf16 v[88:91], v[28:31], v[56:59], v[88:91]
    v_mfma_f32_16x16x32_bf16 v[92:95], v[28:31], v[60:63], v[92:95]
    buffer_load_dwordx4 v2, s[4:7], s61 offen offset:3072 lds
    s_add_u32 m0, s49, 4096
    s_waitcnt lgkmcnt(3)
    v_mfma_f32_16x16x32_bf16 v[96:99], v[8:11], a[0:3], 0
    ds_read_b128 v[24:27], v4 offset:4096
    s_add_u32 s61, s48, 151552
    v_mfma_f32_16x16x32_bf16 v[100:103], v[8:11], a[4:7], 0
    v_mfma_f32_16x16x32_bf16 v[104:107], v[8:11], a[8:11], 0
    v_mfma_f32_16x16x32_bf16 v[108:111], v[8:11], a[12:15], 0
    buffer_load_dwordx4 v2, s[4:7], s61 offen offset:0 lds
    s_waitcnt lgkmcnt(3)
    v_mfma_f32_16x16x32_bf16 v[112:115], v[12:15], a[0:3], 0
    ds_read_b128 v[28:31], v4 offset:5120
    v_mfma_f32_16x16x32_bf16 v[116:119], v[12:15], a[4:7], 0
    v_fmac_f32 v64, v144, v128
    v_fmac_f32 v65, v145, v128
    v_mfma_f32_16x16x32_bf16 v[120:123], v[12:15], a[8:11], 0
    v_fmac_f32 v66, v146, v128
    v_fmac_f32 v67, v147, v128
    v_mfma_f32_16x16x32_bf16 v[124:127], v[12:15], a[12:15], 0
    buffer_load_dwordx4 v2, s[4:7], s61 offen offset:1024 lds
    v_fmac_f32 v80, v148, v128
    s_waitcnt lgkmcnt(3)
    v_mfma_f32_16x16x32_bf16 v[96:99], v[16:19], a[16:19], v[96:99]
    ds_read_b128 v[8:11], v4 offset:6144
    v_fmac_f32 v81, v149, v128
    v_mfma_f32_16x16x32_bf16 v[100:103], v[16:19], a[20:23], v[100:103]
    v_fmac_f32 v82, v150, v128
    v_fmac_f32 v83, v151, v128
    v_mfma_f32_16x16x32_bf16 v[104:107], v[16:19], a[24:27], v[104:107]
    v_mul_f32 v64, v64, v132
    v_mul_f32 v65, v65, v132
    v_mfma_f32_16x16x32_bf16 v[108:111], v[16:19], a[28:31], v[108:111]
    buffer_load_dwordx4 v2, s[4:7], s61 offen offset:2048 lds
    v_mul_f32 v66, v66, v132
    s_waitcnt lgkmcnt(3)
    v_mfma_f32_16x16x32_bf16 v[112:115], v[20:23], a[16:19], v[112:115]
    ds_read_b128 v[12:15], v4 offset:7168
    v_mul_f32 v67, v67, v132
    v_mfma_f32_16x16x32_bf16 v[116:119], v[20:23], a[20:23], v[116:119]
    v_mul_f32 v64, v64, v80
    v_mul_f32 v65, v65, v81
    v_mfma_f32_16x16x32_bf16 v[120:123], v[20:23], a[24:27], v[120:123]
    v_mul_f32 v66, v66, v82
    v_mul_f32 v67, v67, v83
    v_mfma_f32_16x16x32_bf16 v[124:127], v[20:23], a[28:31], v[124:127]
    buffer_load_dwordx4 v2, s[4:7], s61 offen offset:3072 lds
    s_add_u32 m0, s49, 8192
    s_waitcnt lgkmcnt(3)
    v_mfma_f32_16x16x32_bf16 v[96:99], v[24:27], a[32:35], v[96:99]
    ds_read_b128 v[16:19], v4 offset:8192
    s_add_u32 s61, s48, 155648
    v_mfma_f32_16x16x32_bf16 v[100:103], v[24:27], a[36:39], v[100:103]
    v_cvt_pk_bf16_f32 v176, v64, v65
    v_cvt_pk_bf16_f32 v177, v66, v67
    v_mfma_f32_16x16x32_bf16 v[104:107], v[24:27], a[40:43], v[104:107]
    v_fmac_f32 v68, v144, v129
    v_fmac_f32 v69, v145, v129
    v_mfma_f32_16x16x32_bf16 v[108:111], v[24:27], a[44:47], v[108:111]
    buffer_load_dwordx4 v2, s[4:7], s61 offen offset:0 lds
    s_add_u32 m0, s49, 36864
    s_waitcnt lgkmcnt(3)
    v_mfma_f32_16x16x32_bf16 v[112:115], v[28:31], a[32:35], v[112:115]
    ds_read_b128 v[20:23], v4 offset:9216
    s_add_u32 s61, s48, 184320
    v_mfma_f32_16x16x32_bf16 v[116:119], v[28:31], a[36:39], v[116:119]
    v_fmac_f32 v70, v146, v129
    v_fmac_f32 v71, v147, v129
    v_mfma_f32_16x16x32_bf16 v[120:123], v[28:31], a[40:43], v[120:123]
    v_fmac_f32 v84, v148, v129
    v_fmac_f32 v85, v149, v129
    v_mfma_f32_16x16x32_bf16 v[124:127], v[28:31], a[44:47], v[124:127]
    buffer_load_dwordx4 v2, s[4:7], s61 offen offset:0 lds
    v_fmac_f32 v86, v150, v129
    s_waitcnt lgkmcnt(3)
    v_mfma_f32_16x16x32_bf16 v[96:99], v[8:11], a[48:51], v[96:99]
    ds_read_b128 v[24:27], v4 offset:10240
    v_fmac_f32 v87, v151, v129
    v_mfma_f32_16x16x32_bf16 v[100:103], v[8:11], a[52:55], v[100:103]
    v_mul_f32 v68, v68, v133
    v_mul_f32 v69, v69, v133
    v_mfma_f32_16x16x32_bf16 v[104:107], v[8:11], a[56:59], v[104:107]
    v_mul_f32 v70, v70, v133
    v_mul_f32 v71, v71, v133
    v_mfma_f32_16x16x32_bf16 v[108:111], v[8:11], a[60:63], v[108:111]
    buffer_load_dwordx4 v2, s[4:7], s61 offen offset:1024 lds
    v_mul_f32 v68, v68, v84
    s_waitcnt lgkmcnt(3)
    v_mfma_f32_16x16x32_bf16 v[112:115], v[12:15], a[48:51], v[112:115]
    ds_read_b128 v[28:31], v4 offset:11264
    v_mul_f32 v69, v69, v85
    v_mfma_f32_16x16x32_bf16 v[116:119], v[12:15], a[52:55], v[116:119]
    v_mul_f32 v70, v70, v86
    v_mul_f32 v71, v71, v87
    v_mfma_f32_16x16x32_bf16 v[120:123], v[12:15], a[56:59], v[120:123]
    v_cvt_pk_bf16_f32 v180, v68, v69
    v_cvt_pk_bf16_f32 v181, v70, v71
    v_mfma_f32_16x16x32_bf16 v[124:127], v[12:15], a[60:63], v[124:127]
    buffer_load_dwordx4 v2, s[4:7], s61 offen offset:2048 lds
    v_fmac_f32 v72, v144, v130
    s_waitcnt lgkmcnt(3)
    v_mfma_f32_16x16x32_bf16 v[96:99], v[16:19], a[64:67], v[96:99]
    ds_read_b128 v[8:11], v4 offset:12288
    v_fmac_f32 v73, v145, v130
    v_mfma_f32_16x16x32_bf16 v[100:103], v[16:19], a[68:71], v[100:103]
    v_fmac_f32 v74, v146, v130
    v_fmac_f32 v75, v147, v130
    v_mfma_f32_16x16x32_bf16 v[104:107], v[16:19], a[72:75], v[104:107]
    v_fmac_f32 v88, v148, v130
    v_fmac_f32 v89, v149, v130
    v_mfma_f32_16x16x32_bf16 v[108:111], v[16:19], a[76:79], v[108:111]
    buffer_load_dwordx4 v2, s[4:7], s61 offen offset:3072 lds
    s_add_u32 m0, s49, 40960
    s_waitcnt lgkmcnt(3)
    v_mfma_f32_16x16x32_bf16 v[112:115], v[20:23], a[64:67], v[112:115]
    ds_read_b128 v[12:15], v4 offset:13312
    s_add_u32 s61, s48, 188416
    v_mfma_f32_16x16x32_bf16 v[116:119], v[20:23], a[68:71], v[116:119]
    v_fmac_f32 v90, v150, v130
    v_fmac_f32 v91, v151, v130
    v_mfma_f32_16x16x32_bf16 v[120:123], v[20:23], a[72:75], v[120:123]
    v_mul_f32 v72, v72, v134
    v_mul_f32 v73, v73, v134
    v_mfma_f32_16x16x32_bf16 v[124:127], v[20:23], a[76:79], v[124:127]
    buffer_load_dwordx4 v2, s[4:7], s61 offen offset:0 lds
    v_mul_f32 v74, v74, v134
    s_waitcnt lgkmcnt(3)
    v_mfma_f32_16x16x32_bf16 v[96:99], v[24:27], a[80:83], v[96:99]
    ds_read_b128 v[16:19], v4 offset:14336
    v_mul_f32 v75, v75, v134
    v_mfma_f32_16x16x32_bf16 v[100:103], v[24:27], a[84:87], v[100:103]
    v_mul_f32 v72, v72, v88
    v_mul_f32 v73, v73, v89
    v_mfma_f32_16x16x32_bf16 v[104:107], v[24:27], a[88:91], v[104:107]
    v_mul_f32 v74, v74, v90
    v_mul_f32 v75, v75, v91
    v_mfma_f32_16x16x32_bf16 v[108:111], v[24:27], a[92:95], v[108:111]
    buffer_load_dwordx4 v2, s[4:7], s61 offen offset:1024 lds
    v_cvt_pk_bf16_f32 v184, v72, v73
    s_waitcnt lgkmcnt(3)
    v_mfma_f32_16x16x32_bf16 v[112:115], v[28:31], a[80:83], v[112:115]
    ds_read_b128 v[20:23], v4 offset:15360
    v_cvt_pk_bf16_f32 v185, v74, v75
    v_mfma_f32_16x16x32_bf16 v[116:119], v[28:31], a[84:87], v[116:119]
    v_fmac_f32 v76, v144, v131
    v_fmac_f32 v77, v145, v131
    v_mfma_f32_16x16x32_bf16 v[120:123], v[28:31], a[88:91], v[120:123]
    v_fmac_f32 v78, v146, v131
    v_fmac_f32 v79, v147, v131
    v_mfma_f32_16x16x32_bf16 v[124:127], v[28:31], a[92:95], v[124:127]
    buffer_load_dwordx4 v2, s[4:7], s61 offen offset:2048 lds
    v_fmac_f32 v92, v148, v131
    s_waitcnt lgkmcnt(3)
    v_mfma_f32_16x16x32_bf16 v[96:99], v[8:11], a[96:99], v[96:99]
    ds_read_b128 v[24:27], v4 offset:16384
    v_fmac_f32 v93, v149, v131
    v_mfma_f32_16x16x32_bf16 v[100:103], v[8:11], a[100:103], v[100:103]
    v_fmac_f32 v94, v150, v131
    v_fmac_f32 v95, v151, v131
    v_mfma_f32_16x16x32_bf16 v[104:107], v[8:11], a[104:107], v[104:107]
    v_mul_f32 v76, v76, v135
    v_mul_f32 v77, v77, v135
    v_mfma_f32_16x16x32_bf16 v[108:111], v[8:11], a[108:111], v[108:111]
    buffer_load_dwordx4 v2, s[4:7], s61 offen offset:3072 lds
    s_add_u32 m0, s49, 45056
    s_waitcnt lgkmcnt(3)
    v_mfma_f32_16x16x32_bf16 v[112:115], v[12:15], a[96:99], v[112:115]
    ds_read_b128 v[28:31], v4 offset:17408
    s_add_u32 s61, s48, 192512
    v_mfma_f32_16x16x32_bf16 v[116:119], v[12:15], a[100:103], v[116:119]
    v_mul_f32 v78, v78, v135
    v_mul_f32 v79, v79, v135
    v_mfma_f32_16x16x32_bf16 v[120:123], v[12:15], a[104:107], v[120:123]
    v_mul_f32 v76, v76, v92
    v_mul_f32 v77, v77, v93
    v_mfma_f32_16x16x32_bf16 v[124:127], v[12:15], a[108:111], v[124:127]
    buffer_load_dwordx4 v2, s[4:7], s61 offen offset:0 lds
    v_mul_f32 v78, v78, v94
    s_waitcnt lgkmcnt(3)
    v_mfma_f32_16x16x32_bf16 v[96:99], v[16:19], a[112:115], v[96:99]
    ds_read_b128 v[8:11], v4 offset:18432
    v_mul_f32 v79, v79, v95
    v_mfma_f32_16x16x32_bf16 v[100:103], v[16:19], a[116:119], v[100:103]
    v_cvt_pk_bf16_f32 v188, v76, v77
    v_cvt_pk_bf16_f32 v189, v78, v79
    v_mfma_f32_16x16x32_bf16 v[104:107], v[16:19], a[120:123], v[104:107]
    v_fmac_f32 v208, v136, v128
    v_fmac_f32 v209, v137, v128
    v_mfma_f32_16x16x32_bf16 v[108:111], v[16:19], a[124:127], v[108:111]
    v_fmac_f32 v210, v138, v128
    v_fmac_f32 v211, v139, v128
    s_waitcnt lgkmcnt(3)
    v_mfma_f32_16x16x32_bf16 v[112:115], v[20:23], a[112:115], v[112:115]
    ds_read_b128 v[12:15], v4 offset:19456
    v_fmac_f32 v224, v140, v128
    v_mfma_f32_16x16x32_bf16 v[116:119], v[20:23], a[116:119], v[116:119]
    v_fmac_f32 v225, v141, v128
    v_fmac_f32 v226, v142, v128
    v_mfma_f32_16x16x32_bf16 v[120:123], v[20:23], a[120:123], v[120:123]
    v_fmac_f32 v227, v143, v128
    v_mul_f32 v208, v208, v132
    v_mfma_f32_16x16x32_bf16 v[124:127], v[20:23], a[124:127], v[124:127]
    v_mul_f32 v209, v209, v132
    v_mul_f32 v210, v210, v132
    s_waitcnt lgkmcnt(3)
    v_mfma_f32_16x16x32_bf16 v[96:99], v[24:27], a[128:131], v[96:99]
    ds_read_b128 v[16:19], v4 offset:20480
    v_mul_f32 v211, v211, v132
    v_mfma_f32_16x16x32_bf16 v[100:103], v[24:27], a[132:135], v[100:103]
    v_mul_f32 v208, v208, v224
    v_mul_f32 v209, v209, v225
    v_mfma_f32_16x16x32_bf16 v[104:107], v[24:27], a[136:139], v[104:107]
    v_mul_f32 v210, v210, v226
    v_mul_f32 v211, v211, v227
    v_mfma_f32_16x16x32_bf16 v[108:111], v[24:27], a[140:143], v[108:111]
    v_cvt_pk_bf16_f32 v240, v208, v209
    v_cvt_pk_bf16_f32 v241, v210, v211
    s_waitcnt lgkmcnt(3)
    v_mfma_f32_16x16x32_bf16 v[112:115], v[28:31], a[128:131], v[112:115]
    ds_read_b128 v[20:23], v4 offset:21504
    s_add_u32 s66, s51, s65
    v_mfma_f32_16x16x32_bf16 v[116:119], v[28:31], a[132:135], v[116:119]
    buffer_store_dwordx2 v[240:241], v3, s[4:7], s66 offen offset:0 sc1
    v_fmac_f32 v212, v136, v129
    v_mfma_f32_16x16x32_bf16 v[120:123], v[28:31], a[136:139], v[120:123]
    v_fmac_f32 v213, v137, v129
    v_fmac_f32 v214, v138, v129
    v_mfma_f32_16x16x32_bf16 v[124:127], v[28:31], a[140:143], v[124:127]
    v_fmac_f32 v215, v139, v129
    v_fmac_f32 v228, v140, v129
    s_waitcnt lgkmcnt(3)
    v_mfma_f32_16x16x32_bf16 v[96:99], v[8:11], a[144:147], v[96:99]
    ds_read_b128 v[24:27], v4 offset:22528
    v_fmac_f32 v229, v141, v129
    v_mfma_f32_16x16x32_bf16 v[100:103], v[8:11], a[148:151], v[100:103]
    v_fmac_f32 v230, v142, v129
    v_fmac_f32 v231, v143, v129
    v_mfma_f32_16x16x32_bf16 v[104:107], v[8:11], a[152:155], v[104:107]
    v_mul_f32 v212, v212, v133
    v_mul_f32 v213, v213, v133
    v_mfma_f32_16x16x32_bf16 v[108:111], v[8:11], a[156:159], v[108:111]
    v_mul_f32 v214, v214, v133
    v_mul_f32 v215, v215, v133
    s_waitcnt lgkmcnt(3)
    v_mfma_f32_16x16x32_bf16 v[112:115], v[12:15], a[144:147], v[112:115]
    ds_read_b128 v[28:31], v4 offset:23552
    v_mul_f32 v212, v212, v228
    v_mfma_f32_16x16x32_bf16 v[116:119], v[12:15], a[148:151], v[116:119]
    v_mul_f32 v213, v213, v229
    v_mul_f32 v214, v214, v230
    v_mfma_f32_16x16x32_bf16 v[120:123], v[12:15], a[152:155], v[120:123]
    v_mul_f32 v215, v215, v231
    v_cvt_pk_bf16_f32 v244, v212, v213
    v_mfma_f32_16x16x32_bf16 v[124:127], v[12:15], a[156:159], v[124:127]
    v_cvt_pk_bf16_f32 v245, v214, v215
    buffer_store_dwordx2 v[244:245], v3, s[4:7], s66 offen offset:512 sc1
    s_waitcnt lgkmcnt(3)
    v_mfma_f32_16x16x32_bf16 v[96:99], v[16:19], a[160:163], v[96:99]
    ds_read_b128 v[8:11], v4 offset:24576
    v_fmac_f32 v216, v136, v130
    v_mfma_f32_16x16x32_bf16 v[100:103], v[16:19], a[164:167], v[100:103]
    v_fmac_f32 v217, v137, v130
    v_fmac_f32 v218, v138, v130
    v_mfma_f32_16x16x32_bf16 v[104:107], v[16:19], a[168:171], v[104:107]
    v_fmac_f32 v219, v139, v130
    v_fmac_f32 v232, v140, v130
    v_mfma_f32_16x16x32_bf16 v[108:111], v[16:19], a[172:175], v[108:111]
    v_fmac_f32 v233, v141, v130
    v_fmac_f32 v234, v142, v130
    s_waitcnt lgkmcnt(3)
    v_mfma_f32_16x16x32_bf16 v[112:115], v[20:23], a[160:163], v[112:115]
    ds_read_b128 v[12:15], v4 offset:25600
    v_fmac_f32 v235, v143, v130
    v_mfma_f32_16x16x32_bf16 v[116:119], v[20:23], a[164:167], v[116:119]
    v_mul_f32 v216, v216, v134
    v_mul_f32 v217, v217, v134
    v_mfma_f32_16x16x32_bf16 v[120:123], v[20:23], a[168:171], v[120:123]
    v_mul_f32 v218, v218, v134
    v_mul_f32 v219, v219, v134
    v_mfma_f32_16x16x32_bf16 v[124:127], v[20:23], a[172:175], v[124:127]
    v_mul_f32 v216, v216, v232
    v_mul_f32 v217, v217, v233
    s_waitcnt lgkmcnt(3)
    v_mfma_f32_16x16x32_bf16 v[96:99], v[24:27], a[176:179], v[96:99]
    ds_read_b128 v[16:19], v4 offset:26624
    v_mul_f32 v218, v218, v234
    v_mfma_f32_16x16x32_bf16 v[100:103], v[24:27], a[180:183], v[100:103]
    v_mul_f32 v219, v219, v235
    v_cvt_pk_bf16_f32 v248, v216, v217
    v_mfma_f32_16x16x32_bf16 v[104:107], v[24:27], a[184:187], v[104:107]
    v_cvt_pk_bf16_f32 v249, v218, v219
    buffer_store_dwordx2 v[248:249], v3, s[4:7], s66 offen offset:1024 sc1
    v_mfma_f32_16x16x32_bf16 v[108:111], v[24:27], a[188:191], v[108:111]
    v_fmac_f32 v220, v136, v131
    v_fmac_f32 v221, v137, v131
    s_waitcnt lgkmcnt(3)
    v_mfma_f32_16x16x32_bf16 v[112:115], v[28:31], a[176:179], v[112:115]
    ds_read_b128 v[20:23], v4 offset:27648
    v_fmac_f32 v222, v138, v131
    v_mfma_f32_16x16x32_bf16 v[116:119], v[28:31], a[180:183], v[116:119]
    v_fmac_f32 v223, v139, v131
    v_fmac_f32 v236, v140, v131
    v_mfma_f32_16x16x32_bf16 v[120:123], v[28:31], a[184:187], v[120:123]
    v_fmac_f32 v237, v141, v131
    v_fmac_f32 v238, v142, v131
    v_mfma_f32_16x16x32_bf16 v[124:127], v[28:31], a[188:191], v[124:127]
    v_fmac_f32 v239, v143, v131
    v_mul_f32 v220, v220, v135
    s_waitcnt lgkmcnt(3)
    v_mfma_f32_16x16x32_bf16 v[96:99], v[8:11], a[192:195], v[96:99]
    ds_read_b128 v[24:27], v4 offset:28672
    v_mul_f32 v221, v221, v135
    v_mfma_f32_16x16x32_bf16 v[100:103], v[8:11], a[196:199], v[100:103]
    v_mul_f32 v222, v222, v135
    v_mul_f32 v223, v223, v135
    v_mfma_f32_16x16x32_bf16 v[104:107], v[8:11], a[200:203], v[104:107]
    v_mul_f32 v220, v220, v236
    v_mul_f32 v221, v221, v237
    v_mfma_f32_16x16x32_bf16 v[108:111], v[8:11], a[204:207], v[108:111]
    v_mul_f32 v222, v222, v238
    v_mul_f32 v223, v223, v239
    s_waitcnt lgkmcnt(3)
    v_mfma_f32_16x16x32_bf16 v[112:115], v[12:15], a[192:195], v[112:115]
    ds_read_b128 v[28:31], v4 offset:29696
    v_cvt_pk_bf16_f32 v252, v220, v221
    v_mfma_f32_16x16x32_bf16 v[116:119], v[12:15], a[196:199], v[116:119]
    v_cvt_pk_bf16_f32 v253, v222, v223
    buffer_store_dwordx2 v[252:253], v3, s[4:7], s66 offen offset:1536 sc1
    v_mfma_f32_16x16x32_bf16 v[120:123], v[12:15], a[200:203], v[120:123]
    v_mfma_f32_16x16x32_bf16 v[124:127], v[12:15], a[204:207], v[124:127]
    s_waitcnt lgkmcnt(3)
    v_mfma_f32_16x16x32_bf16 v[96:99], v[16:19], a[208:211], v[96:99]
    ds_read_b128 v[8:11], v4 offset:30720
    v_mfma_f32_16x16x32_bf16 v[100:103], v[16:19], a[212:215], v[100:103]
    v_mfma_f32_16x16x32_bf16 v[104:107], v[16:19], a[216:219], v[104:107]
    v_mfma_f32_16x16x32_bf16 v[108:111], v[16:19], a[220:223], v[108:111]
    s_waitcnt lgkmcnt(3)
    v_mfma_f32_16x16x32_bf16 v[112:115], v[20:23], a[208:211], v[112:115]
    ds_read_b128 v[12:15], v4 offset:31744
    v_mfma_f32_16x16x32_bf16 v[116:119], v[20:23], a[212:215], v[116:119]
    v_mfma_f32_16x16x32_bf16 v[120:123], v[20:23], a[216:219], v[120:123]
    v_mfma_f32_16x16x32_bf16 v[124:127], v[20:23], a[220:223], v[124:127]
    s_waitcnt lgkmcnt(3)
    v_mfma_f32_16x16x32_bf16 v[96:99], v[24:27], a[224:227], v[96:99]
    ds_read_b128 v[16:19], v4 offset:32768
    v_mfma_f32_16x16x32_bf16 v[100:103], v[24:27], a[228:231], v[100:103]
    v_mfma_f32_16x16x32_bf16 v[104:107], v[24:27], a[232:235], v[104:107]
    v_mfma_f32_16x16x32_bf16 v[108:111], v[24:27], a[236:239], v[108:111]
    s_waitcnt lgkmcnt(3)
    v_mfma_f32_16x16x32_bf16 v[112:115], v[28:31], a[224:227], v[112:115]
    ds_read_b128 v[20:23], v4 offset:33792
    v_mfma_f32_16x16x32_bf16 v[116:119], v[28:31], a[228:231], v[116:119]
    v_mfma_f32_16x16x32_bf16 v[120:123], v[28:31], a[232:235], v[120:123]
    v_mfma_f32_16x16x32_bf16 v[124:127], v[28:31], a[236:239], v[124:127]
    s_waitcnt lgkmcnt(3)
    v_mfma_f32_16x16x32_bf16 v[96:99], v[8:11], a[240:243], v[96:99]
    ds_read_b128 v[24:27], v4 offset:34816
    v_mfma_f32_16x16x32_bf16 v[100:103], v[8:11], a[244:247], v[100:103]
    v_mfma_f32_16x16x32_bf16 v[104:107], v[8:11], a[248:251], v[104:107]
    v_mfma_f32_16x16x32_bf16 v[108:111], v[8:11], a[252:255], v[108:111]
    ds_read_b128 v[136:139], v5 offset:256
    ds_read_b128 v[140:143], v5 offset:320
    s_waitcnt lgkmcnt(5)
    v_mfma_f32_16x16x32_bf16 v[112:115], v[12:15], a[240:243], v[112:115]
    ds_read_b128 v[28:31], v4 offset:35840
    v_mfma_f32_16x16x32_bf16 v[116:119], v[12:15], a[244:247], v[116:119]
    v_mfma_f32_16x16x32_bf16 v[120:123], v[12:15], a[248:251], v[120:123]
    v_mfma_f32_16x16x32_bf16 v[124:127], v[12:15], a[252:255], v[124:127]
    s_waitcnt lgkmcnt(5)
    v_mfma_f32_16x16x32_bf16 v[96:99], v[16:19], v[32:35], v[96:99]
    s_barrier
    v_mfma_f32_16x16x32_bf16 v[100:103], v[16:19], v[36:39], v[100:103]
    v_add_u32 v4, 0x9000, v4
    ds_read_b128 v[8:11], v4 offset:0
    v_mfma_f32_16x16x32_bf16 v[104:107], v[16:19], v[40:43], v[104:107]
    v_mfma_f32_16x16x32_bf16 v[108:111], v[16:19], v[44:47], v[108:111]
    s_waitcnt lgkmcnt(5)
    v_mfma_f32_16x16x32_bf16 v[112:115], v[20:23], v[32:35], v[112:115]
    ds_read_b128 v[12:15], v4 offset:1024
    v_mfma_f32_16x16x32_bf16 v[116:119], v[20:23], v[36:39], v[116:119]
    v_mfma_f32_16x16x32_bf16 v[120:123], v[20:23], v[40:43], v[120:123]
    v_mfma_f32_16x16x32_bf16 v[124:127], v[20:23], v[44:47], v[124:127]
    s_waitcnt lgkmcnt(5)
    v_mfma_f32_16x16x32_bf16 v[96:99], v[24:27], v[48:51], v[96:99]
    ds_read_b128 v[16:19], v4 offset:2048
    v_mfma_f32_16x16x32_bf16 v[100:103], v[24:27], v[52:55], v[100:103]
    v_mfma_f32_16x16x32_bf16 v[104:107], v[24:27], v[56:59], v[104:107]
    v_mfma_f32_16x16x32_bf16 v[108:111], v[24:27], v[60:63], v[108:111]
    s_waitcnt lgkmcnt(3)
    v_mfma_f32_16x16x32_bf16 v[112:115], v[28:31], v[48:51], v[112:115]
    ds_read_b128 v[20:23], v4 offset:3072
    v_mfma_f32_16x16x32_bf16 v[116:119], v[28:31], v[52:55], v[116:119]
    v_mfma_f32_16x16x32_bf16 v[120:123], v[28:31], v[56:59], v[120:123]
    v_mfma_f32_16x16x32_bf16 v[124:127], v[28:31], v[60:63], v[124:127]
    s_waitcnt lgkmcnt(3)
    v_mfma_f32_16x16x32_bf16 v[64:67], v[8:11], a[0:3], 0
    ds_read_b128 v[24:27], v4 offset:4096
    v_mfma_f32_16x16x32_bf16 v[68:71], v[8:11], a[4:7], 0
    v_mfma_f32_16x16x32_bf16 v[72:75], v[8:11], a[8:11], 0
    v_mfma_f32_16x16x32_bf16 v[76:79], v[8:11], a[12:15], 0
    s_waitcnt lgkmcnt(3)
    v_mfma_f32_16x16x32_bf16 v[80:83], v[12:15], a[0:3], 0
    ds_read_b128 v[28:31], v4 offset:5120
    v_mfma_f32_16x16x32_bf16 v[84:87], v[12:15], a[4:7], 0
    v_fmac_f32 v96, v136, v128
    v_fmac_f32 v97, v137, v128
    v_mfma_f32_16x16x32_bf16 v[88:91], v[12:15], a[8:11], 0
    v_fmac_f32 v98, v138, v128
    v_fmac_f32 v99, v139, v128
    v_mfma_f32_16x16x32_bf16 v[92:95], v[12:15], a[12:15], 0
    v_fmac_f32 v112, v140, v128
    v_fmac_f32 v113, v141, v128
    s_waitcnt lgkmcnt(3)
    v_mfma_f32_16x16x32_bf16 v[64:67], v[16:19], a[16:19], v[64:67]
    ds_read_b128 v[8:11], v4 offset:6144
    v_fmac_f32 v114, v142, v128
    v_mfma_f32_16x16x32_bf16 v[68:71], v[16:19], a[20:23], v[68:71]
    v_fmac_f32 v115, v143, v128
    v_mul_f32 v96, v96, v132
    v_mfma_f32_16x16x32_bf16 v[72:75], v[16:19], a[24:27], v[72:75]
    v_mul_f32 v97, v97, v132
    v_mul_f32 v98, v98, v132
    v_mfma_f32_16x16x32_bf16 v[76:79], v[16:19], a[28:31], v[76:79]
    v_mul_f32 v99, v99, v132
    v_mul_f32 v96, v96, v112
    s_waitcnt lgkmcnt(3)
    v_mfma_f32_16x16x32_bf16 v[80:83], v[20:23], a[16:19], v[80:83]
    ds_read_b128 v[12:15], v4 offset:7168
    v_mul_f32 v97, v97, v113
    v_mfma_f32_16x16x32_bf16 v[84:87], v[20:23], a[20:23], v[84:87]
    v_mul_f32 v98, v98, v114
    v_mul_f32 v99, v99, v115
    v_mfma_f32_16x16x32_bf16 v[88:91], v[20:23], a[24:27], v[88:91]
    v_cvt_pk_bf16_f32 v178, v96, v97
    v_cvt_pk_bf16_f32 v179, v98, v99
    v_mfma_f32_16x16x32_bf16 v[92:95], v[20:23], a[28:31], v[92:95]
    s_add_u32 s66, s51, 0
    buffer_store_dwordx4 v[176:179], v2, s[4:7], s66 offen offset:0 sc1
    s_waitcnt lgkmcnt(3)
    v_mfma_f32_16x16x32_bf16 v[64:67], v[24:27], a[32:35], v[64:67]
    ds_read_b128 v[16:19], v4 offset:8192
    v_fmac_f32 v100, v136, v129
    v_mfma_f32_16x16x32_bf16 v[68:71], v[24:27], a[36:39], v[68:71]
    v_fmac_f32 v101, v137, v129
    v_fmac_f32 v102, v138, v129
    v_mfma_f32_16x16x32_bf16 v[72:75], v[24:27], a[40:43], v[72:75]
    v_fmac_f32 v103, v139, v129
    v_fmac_f32 v116, v140, v129
    v_mfma_f32_16x16x32_bf16 v[76:79], v[24:27], a[44:47], v[76:79]
    v_fmac_f32 v117, v141, v129
    v_fmac_f32 v118, v142, v129
    s_waitcnt lgkmcnt(3)
    v_mfma_f32_16x16x32_bf16 v[80:83], v[28:31], a[32:35], v[80:83]
    ds_read_b128 v[20:23], v4 offset:9216
    v_fmac_f32 v119, v143, v129
    v_mfma_f32_16x16x32_bf16 v[84:87], v[28:31], a[36:39], v[84:87]
    v_mul_f32 v100, v100, v133
    v_mul_f32 v101, v101, v133
    v_mfma_f32_16x16x32_bf16 v[88:91], v[28:31], a[40:43], v[88:91]
    v_mul_f32 v102, v102, v133
    v_mul_f32 v103, v103, v133
    v_mfma_f32_16x16x32_bf16 v[92:95], v[28:31], a[44:47], v[92:95]
    v_mul_f32 v100, v100, v116
    v_mul_f32 v101, v101, v117
    s_waitcnt lgkmcnt(3)
    v_mfma_f32_16x16x32_bf16 v[64:67], v[8:11], a[48:51], v[64:67]
    ds_read_b128 v[24:27], v4 offset:10240
    v_mul_f32 v102, v102, v118
    v_mfma_f32_16x16x32_bf16 v[68:71], v[8:11], a[52:55], v[68:71]
    v_mul_f32 v103, v103, v119
    v_cvt_pk_bf16_f32 v182, v100, v101
    v_mfma_f32_16x16x32_bf16 v[72:75], v[8:11], a[56:59], v[72:75]
    v_cvt_pk_bf16_f32 v183, v102, v103
    buffer_store_dwordx4 v[180:183], v2, s[4:7], s66 offen offset:1024 sc1
    v_mfma_f32_16x16x32_bf16 v[76:79], v[8:11], a[60:63], v[76:79]
    v_fmac_f32 v104, v136, v130
    v_fmac_f32 v105, v137, v130
    s_waitcnt lgkmcnt(3)
    v_mfma_f32_16x16x32_bf16 v[80:83], v[12:15], a[48:51], v[80:83]
    ds_read_b128 v[28:31], v4 offset:11264
    v_fmac_f32 v106, v138, v130
    v_mfma_f32_16x16x32_bf16 v[84:87], v[12:15], a[52:55], v[84:87]
    v_fmac_f32 v107, v139, v130
    v_fmac_f32 v120, v140, v130
    v_mfma_f32_16x16x32_bf16 v[88:91], v[12:15], a[56:59], v[88:91]
    v_fmac_f32 v121, v141, v130
    v_fmac_f32 v122, v142, v130
    v_mfma_f32_16x16x32_bf16 v[92:95], v[12:15], a[60:63], v[92:95]
    v_fmac_f32 v123, v143, v130
    v_mul_f32 v104, v104, v134
    s_waitcnt lgkmcnt(3)
    v_mfma_f32_16x16x32_bf16 v[64:67], v[16:19], a[64:67], v[64:67]
    ds_read_b128 v[8:11], v4 offset:12288
    v_mul_f32 v105, v105, v134
    v_mfma_f32_16x16x32_bf16 v[68:71], v[16:19], a[68:71], v[68:71]
    v_mul_f32 v106, v106, v134
    v_mul_f32 v107, v107, v134
    v_mfma_f32_16x16x32_bf16 v[72:75], v[16:19], a[72:75], v[72:75]
    v_mul_f32 v104, v104, v120
    v_mul_f32 v105, v105, v121
    v_mfma_f32_16x16x32_bf16 v[76:79], v[16:19], a[76:79], v[76:79]
    v_mul_f32 v106, v106, v122
    v_mul_f32 v107, v107, v123
    s_waitcnt lgkmcnt(3)
    v_mfma_f32_16x16x32_bf16 v[80:83], v[20:23], a[64:67], v[80:83]
    ds_read_b128 v[12:15], v4 offset:13312
    v_cvt_pk_bf16_f32 v186, v104, v105
    v_mfma_f32_16x16x32_bf16 v[84:87], v[20:23], a[68:71], v[84:87]
    v_cvt_pk_bf16_f32 v187, v106, v107
    buffer_store_dwordx4 v[184:187], v2, s[4:7], s66 offen offset:2048 sc1
    v_mfma_f32_16x16x32_bf16 v[88:91], v[20:23], a[72:75], v[88:91]
    v_fmac_f32 v108, v136, v131
    v_fmac_f32 v109, v137, v131
    v_mfma_f32_16x16x32_bf16 v[92:95], v[20:23], a[76:79], v[92:95]
    v_fmac_f32 v110, v138, v131
    v_fmac_f32 v111, v139, v131
    s_waitcnt lgkmcnt(3)
    v_mfma_f32_16x16x32_bf16 v[64:67], v[24:27], a[80:83], v[64:67]
    ds_read_b128 v[16:19], v4 offset:14336
    v_fmac_f32 v124, v140, v131
    v_mfma_f32_16x16x32_bf16 v[68:71], v[24:27], a[84:87], v[68:71]
    v_fmac_f32 v125, v141, v131
    v_fmac_f32 v126, v142, v131
    v_mfma_f32_16x16x32_bf16 v[72:75], v[24:27], a[88:91], v[72:75]
    v_fmac_f32 v127, v143, v131
    v_mul_f32 v108, v108, v135
    v_mfma_f32_16x16x32_bf16 v[76:79], v[24:27], a[92:95], v[76:79]
    v_mul_f32 v109, v109, v135
    v_mul_f32 v110, v110, v135
    s_waitcnt lgkmcnt(3)
    v_mfma_f32_16x16x32_bf16 v[80:83], v[28:31], a[80:83], v[80:83]
    ds_read_b128 v[20:23], v4 offset:15360
    v_mul_f32 v111, v111, v135
    v_mfma_f32_16x16x32_bf16 v[84:87], v[28:31], a[84:87], v[84:87]
    v_mul_f32 v108, v108, v124
    v_mul_f32 v109, v109, v125
    v_mfma_f32_16x16x32_bf16 v[88:91], v[28:31], a[88:91], v[88:91]
    v_mul_f32 v110, v110, v126
    v_mul_f32 v111, v111, v127
    v_mfma_f32_16x16x32_bf16 v[92:95], v[28:31], a[92:95], v[92:95]
    v_cvt_pk_bf16_f32 v190, v108, v109
    v_cvt_pk_bf16_f32 v191, v110, v111
    s_waitcnt lgkmcnt(3)
    v_mfma_f32_16x16x32_bf16 v[64:67], v[8:11], a[96:99], v[64:67]
    ds_read_b128 v[24:27], v4 offset:16384
    buffer_store_dwordx4 v[188:191], v2, s[4:7], s66 offen offset:3072 sc1
    v_mfma_f32_16x16x32_bf16 v[68:71], v[8:11], a[100:103], v[68:71]
    v_mfma_f32_16x16x32_bf16 v[72:75], v[8:11], a[104:107], v[72:75]
    v_mfma_f32_16x16x32_bf16 v[76:79], v[8:11], a[108:111], v[76:79]
    s_waitcnt lgkmcnt(3)
    v_mfma_f32_16x16x32_bf16 v[80:83], v[12:15], a[96:99], v[80:83]
    ds_read_b128 v[28:31], v4 offset:17408
    v_mfma_f32_16x16x32_bf16 v[84:87], v[12:15], a[100:103], v[84:87]
    v_mfma_f32_16x16x32_bf16 v[88:91], v[12:15], a[104:107], v[88:91]
    v_mfma_f32_16x16x32_bf16 v[92:95], v[12:15], a[108:111], v[92:95]
    s_waitcnt lgkmcnt(3)
    v_mfma_f32_16x16x32_bf16 v[64:67], v[16:19], a[112:115], v[64:67]
    ds_read_b128 v[8:11], v4 offset:18432
    v_mfma_f32_16x16x32_bf16 v[68:71], v[16:19], a[116:119], v[68:71]
    v_mfma_f32_16x16x32_bf16 v[72:75], v[16:19], a[120:123], v[72:75]
    v_mfma_f32_16x16x32_bf16 v[76:79], v[16:19], a[124:127], v[76:79]
    s_waitcnt lgkmcnt(3)
    v_mfma_f32_16x16x32_bf16 v[80:83], v[20:23], a[112:115], v[80:83]
    ds_read_b128 v[12:15], v4 offset:19456
    v_mfma_f32_16x16x32_bf16 v[84:87], v[20:23], a[116:119], v[84:87]
    v_mfma_f32_16x16x32_bf16 v[88:91], v[20:23], a[120:123], v[88:91]
    v_mfma_f32_16x16x32_bf16 v[92:95], v[20:23], a[124:127], v[92:95]
    s_waitcnt lgkmcnt(3)
    v_mfma_f32_16x16x32_bf16 v[64:67], v[24:27], a[128:131], v[64:67]
    ds_read_b128 v[16:19], v4 offset:20480
    v_mfma_f32_16x16x32_bf16 v[68:71], v[24:27], a[132:135], v[68:71]
    v_mfma_f32_16x16x32_bf16 v[72:75], v[24:27], a[136:139], v[72:75]
    v_mfma_f32_16x16x32_bf16 v[76:79], v[24:27], a[140:143], v[76:79]
    s_waitcnt lgkmcnt(3)
    v_mfma_f32_16x16x32_bf16 v[80:83], v[28:31], a[128:131], v[80:83]
    ds_read_b128 v[20:23], v4 offset:21504
    v_mfma_f32_16x16x32_bf16 v[84:87], v[28:31], a[132:135], v[84:87]
    v_mfma_f32_16x16x32_bf16 v[88:91], v[28:31], a[136:139], v[88:91]
    v_mfma_f32_16x16x32_bf16 v[92:95], v[28:31], a[140:143], v[92:95]
    s_waitcnt lgkmcnt(3)
    v_mfma_f32_16x16x32_bf16 v[64:67], v[8:11], a[144:147], v[64:67]
    ds_read_b128 v[24:27], v4 offset:22528
    v_mfma_f32_16x16x32_bf16 v[68:71], v[8:11], a[148:151], v[68:71]
    v_mfma_f32_16x16x32_bf16 v[72:75], v[8:11], a[152:155], v[72:75]
    v_mfma_f32_16x16x32_bf16 v[76:79], v[8:11], a[156:159], v[76:79]
    s_waitcnt lgkmcnt(3)
    v_mfma_f32_16x16x32_bf16 v[80:83], v[12:15], a[144:147], v[80:83]
    ds_read_b128 v[28:31], v4 offset:23552
    v_mfma_f32_16x16x32_bf16 v[84:87], v[12:15], a[148:151], v[84:87]
    v_mfma_f32_16x16x32_bf16 v[88:91], v[12:15], a[152:155], v[88:91]
    v_mfma_f32_16x16x32_bf16 v[92:95], v[12:15], a[156:159], v[92:95]
    s_waitcnt lgkmcnt(3)
    v_mfma_f32_16x16x32_bf16 v[64:67], v[16:19], a[160:163], v[64:67]
    ds_read_b128 v[8:11], v4 offset:24576
    v_mfma_f32_16x16x32_bf16 v[68:71], v[16:19], a[164:167], v[68:71]
    v_mfma_f32_16x16x32_bf16 v[72:75], v[16:19], a[168:171], v[72:75]
    v_mfma_f32_16x16x32_bf16 v[76:79], v[16:19], a[172:175], v[76:79]
    s_waitcnt lgkmcnt(3)
    v_mfma_f32_16x16x32_bf16 v[80:83], v[20:23], a[160:163], v[80:83]
    ds_read_b128 v[12:15], v4 offset:25600
    v_mfma_f32_16x16x32_bf16 v[84:87], v[20:23], a[164:167], v[84:87]
    v_mfma_f32_16x16x32_bf16 v[88:91], v[20:23], a[168:171], v[88:91]
    v_mfma_f32_16x16x32_bf16 v[92:95], v[20:23], a[172:175], v[92:95]
    s_waitcnt lgkmcnt(3)
    v_mfma_f32_16x16x32_bf16 v[64:67], v[24:27], a[176:179], v[64:67]
    ds_read_b128 v[16:19], v4 offset:26624
    v_mfma_f32_16x16x32_bf16 v[68:71], v[24:27], a[180:183], v[68:71]
    v_mfma_f32_16x16x32_bf16 v[72:75], v[24:27], a[184:187], v[72:75]
    v_mfma_f32_16x16x32_bf16 v[76:79], v[24:27], a[188:191], v[76:79]
    s_waitcnt lgkmcnt(3)
    v_mfma_f32_16x16x32_bf16 v[80:83], v[28:31], a[176:179], v[80:83]
    ds_read_b128 v[20:23], v4 offset:27648
    v_mfma_f32_16x16x32_bf16 v[84:87], v[28:31], a[180:183], v[84:87]
    v_mfma_f32_16x16x32_bf16 v[88:91], v[28:31], a[184:187], v[88:91]
    v_mfma_f32_16x16x32_bf16 v[92:95], v[28:31], a[188:191], v[92:95]
    s_waitcnt lgkmcnt(3)
    v_mfma_f32_16x16x32_bf16 v[64:67], v[8:11], a[192:195], v[64:67]
    ds_read_b128 v[24:27], v4 offset:28672
    v_mfma_f32_16x16x32_bf16 v[68:71], v[8:11], a[196:199], v[68:71]
    v_mfma_f32_16x16x32_bf16 v[72:75], v[8:11], a[200:203], v[72:75]
    v_mfma_f32_16x16x32_bf16 v[76:79], v[8:11], a[204:207], v[76:79]
    s_waitcnt lgkmcnt(3)
    v_mfma_f32_16x16x32_bf16 v[80:83], v[12:15], a[192:195], v[80:83]
    ds_read_b128 v[28:31], v4 offset:29696
    v_mfma_f32_16x16x32_bf16 v[84:87], v[12:15], a[196:199], v[84:87]
    v_mfma_f32_16x16x32_bf16 v[88:91], v[12:15], a[200:203], v[88:91]
    v_mfma_f32_16x16x32_bf16 v[92:95], v[12:15], a[204:207], v[92:95]
    s_waitcnt lgkmcnt(3)
    v_mfma_f32_16x16x32_bf16 v[64:67], v[16:19], a[208:211], v[64:67]
    ds_read_b128 v[8:11], v4 offset:30720
    v_mfma_f32_16x16x32_bf16 v[68:71], v[16:19], a[212:215], v[68:71]
    v_mfma_f32_16x16x32_bf16 v[72:75], v[16:19], a[216:219], v[72:75]
    v_mfma_f32_16x16x32_bf16 v[76:79], v[16:19], a[220:223], v[76:79]
    s_waitcnt lgkmcnt(3)
    v_mfma_f32_16x16x32_bf16 v[80:83], v[20:23], a[208:211], v[80:83]
    ds_read_b128 v[12:15], v4 offset:31744
    v_mfma_f32_16x16x32_bf16 v[84:87], v[20:23], a[212:215], v[84:87]
    v_mfma_f32_16x16x32_bf16 v[88:91], v[20:23], a[216:219], v[88:91]
    v_mfma_f32_16x16x32_bf16 v[92:95], v[20:23], a[220:223], v[92:95]
    s_waitcnt lgkmcnt(3)
    v_mfma_f32_16x16x32_bf16 v[64:67], v[24:27], a[224:227], v[64:67]
    ds_read_b128 v[16:19], v4 offset:32768
    v_mfma_f32_16x16x32_bf16 v[68:71], v[24:27], a[228:231], v[68:71]
    v_mfma_f32_16x16x32_bf16 v[72:75], v[24:27], a[232:235], v[72:75]
    v_mfma_f32_16x16x32_bf16 v[76:79], v[24:27], a[236:239], v[76:79]
    s_waitcnt lgkmcnt(3)
    v_mfma_f32_16x16x32_bf16 v[80:83], v[28:31], a[224:227], v[80:83]
    ds_read_b128 v[20:23], v4 offset:33792
    v_mfma_f32_16x16x32_bf16 v[84:87], v[28:31], a[228:231], v[84:87]
    v_mfma_f32_16x16x32_bf16 v[88:91], v[28:31], a[232:235], v[88:91]
    v_mfma_f32_16x16x32_bf16 v[92:95], v[28:31], a[236:239], v[92:95]
    s_waitcnt lgkmcnt(3)
    v_mfma_f32_16x16x32_bf16 v[64:67], v[8:11], a[240:243], v[64:67]
    ds_read_b128 v[24:27], v4 offset:34816
    v_mfma_f32_16x16x32_bf16 v[68:71], v[8:11], a[244:247], v[68:71]
    v_mfma_f32_16x16x32_bf16 v[72:75], v[8:11], a[248:251], v[72:75]
    v_mfma_f32_16x16x32_bf16 v[76:79], v[8:11], a[252:255], v[76:79]
    ds_read_b128 v[144:147], v5 offset:384
    ds_read_b128 v[148:151], v5 offset:448
    s_waitcnt lgkmcnt(5)
    v_mfma_f32_16x16x32_bf16 v[80:83], v[12:15], a[240:243], v[80:83]
    ds_read_b128 v[28:31], v4 offset:35840
    v_mfma_f32_16x16x32_bf16 v[84:87], v[12:15], a[244:247], v[84:87]
    v_mfma_f32_16x16x32_bf16 v[88:91], v[12:15], a[248:251], v[88:91]
    v_mfma_f32_16x16x32_bf16 v[92:95], v[12:15], a[252:255], v[92:95]
    s_waitcnt lgkmcnt(5)
    v_mfma_f32_16x16x32_bf16 v[64:67], v[16:19], v[32:35], v[64:67]
    s_waitcnt vmcnt(17)
    s_barrier
    v_mfma_f32_16x16x32_bf16 v[68:71], v[16:19], v[36:39], v[68:71]
    v_add_u32 v4, 0xfffe5000, v4
    ds_read_b128 v[8:11], v4 offset:0
    v_mfma_f32_16x16x32_bf16 v[72:75], v[16:19], v[40:43], v[72:75]
    s_add_u32 m0, s49, 73728
    s_add_u32 s61, s48, 221184
    v_mfma_f32_16x16x32_bf16 v[76:79], v[16:19], v[44:47], v[76:79]
    buffer_load_dwordx4 v2, s[4:7], s61 offen offset:0 lds
    s_waitcnt lgkmcnt(5)
    v_mfma_f32_16x16x32_bf16 v[80:83], v[20:23], v[32:35], v[80:83]
    ds_read_b128 v[12:15], v4 offset:1024
    v_mfma_f32_16x16x32_bf16 v[84:87], v[20:23], v[36:39], v[84:87]
    v_mfma_f32_16x16x32_bf16 v[88:91], v[20:23], v[40:43], v[88:91]
    v_mfma_f32_16x16x32_bf16 v[92:95], v[20:23], v[44:47], v[92:95]
    buffer_load_dwordx4 v2, s[4:7], s61 offen offset:1024 lds
    s_waitcnt lgkmcnt(5)
    v_mfma_f32_16x16x32_bf16 v[64:67], v[24:27], v[48:51], v[64:67]
    ds_read_b128 v[16:19], v4 offset:2048
    v_mfma_f32_16x16x32_bf16 v[68:71], v[24:27], v[52:55], v[68:71]
    v_mfma_f32_16x16x32_bf16 v[72:75], v[24:27], v[56:59], v[72:75]
    v_mfma_f32_16x16x32_bf16 v[76:79], v[24:27], v[60:63], v[76:79]
    buffer_load_dwordx4 v2, s[4:7], s61 offen offset:2048 lds
    s_waitcnt lgkmcnt(3)
    v_mfma_f32_16x16x32_bf16 v[80:83], v[28:31], v[48:51], v[80:83]
    ds_read_b128 v[20:23], v4 offset:3072
    v_mfma_f32_16x16x32_bf16 v[84:87], v[28:31], v[52:55], v[84:87]
    v_mfma_f32_16x16x32_bf16 v[88:91], v[28:31], v[56:59], v[88:91]
    v_mfma_f32_16x16x32_bf16 v[92:95], v[28:31], v[60:63], v[92:95]
    buffer_load_dwordx4 v2, s[4:7], s61 offen offset:3072 lds
    s_add_u32 m0, s49, 77824
    s_waitcnt lgkmcnt(3)
    v_mfma_f32_16x16x32_bf16 v[96:99], v[8:11], a[0:3], 0
    ds_read_b128 v[24:27], v4 offset:4096
    s_add_u32 s61, s48, 225280
    v_mfma_f32_16x16x32_bf16 v[100:103], v[8:11], a[4:7], 0
    v_mfma_f32_16x16x32_bf16 v[104:107], v[8:11], a[8:11], 0
    v_mfma_f32_16x16x32_bf16 v[108:111], v[8:11], a[12:15], 0
    buffer_load_dwordx4 v2, s[4:7], s61 offen offset:0 lds
    s_waitcnt lgkmcnt(3)
    v_mfma_f32_16x16x32_bf16 v[112:115], v[12:15], a[0:3], 0
    ds_read_b128 v[28:31], v4 offset:5120
    v_mfma_f32_16x16x32_bf16 v[116:119], v[12:15], a[4:7], 0
    v_fmac_f32 v64, v144, v128
    v_fmac_f32 v65, v145, v128
    v_mfma_f32_16x16x32_bf16 v[120:123], v[12:15], a[8:11], 0
    v_fmac_f32 v66, v146, v128
    v_fmac_f32 v67, v147, v128
    v_mfma_f32_16x16x32_bf16 v[124:127], v[12:15], a[12:15], 0
    buffer_load_dwordx4 v2, s[4:7], s61 offen offset:1024 lds
    v_fmac_f32 v80, v148, v128
    s_waitcnt lgkmcnt(3)
    v_mfma_f32_16x16x32_bf16 v[96:99], v[16:19], a[16:19], v[96:99]
    ds_read_b128 v[8:11], v4 offset:6144
    v_fmac_f32 v81, v149, v128
    v_mfma_f32_16x16x32_bf16 v[100:103], v[16:19], a[20:23], v[100:103]
    v_fmac_f32 v82, v150, v128
    v_fmac_f32 v83, v151, v128
    v_mfma_f32_16x16x32_bf16 v[104:107], v[16:19], a[24:27], v[104:107]
    v_mul_f32 v64, v64, v132
    v_mul_f32 v65, v65, v132
    v_mfma_f32_16x16x32_bf16 v[108:111], v[16:19], a[28:31], v[108:111]
    buffer_load_dwordx4 v2, s[4:7], s61 offen offset:2048 lds
    v_mul_f32 v66, v66, v132
    s_waitcnt lgkmcnt(3)
    v_mfma_f32_16x16x32_bf16 v[112:115], v[20:23], a[16:19], v[112:115]
    ds_read_b128 v[12:15], v4 offset:7168
    v_mul_f32 v67, v67, v132
    v_mfma_f32_16x16x32_bf16 v[116:119], v[20:23], a[20:23], v[116:119]
    v_mul_f32 v64, v64, v80
    v_mul_f32 v65, v65, v81
    v_mfma_f32_16x16x32_bf16 v[120:123], v[20:23], a[24:27], v[120:123]
    v_mul_f32 v66, v66, v82
    v_mul_f32 v67, v67, v83
    v_mfma_f32_16x16x32_bf16 v[124:127], v[20:23], a[28:31], v[124:127]
    buffer_load_dwordx4 v2, s[4:7], s61 offen offset:3072 lds
    s_add_u32 m0, s49, 81920
    s_waitcnt lgkmcnt(3)
    v_mfma_f32_16x16x32_bf16 v[96:99], v[24:27], a[32:35], v[96:99]
    ds_read_b128 v[16:19], v4 offset:8192
    s_add_u32 s61, s48, 229376
    v_mfma_f32_16x16x32_bf16 v[100:103], v[24:27], a[36:39], v[100:103]
    v_cvt_pk_bf16_f32 v192, v64, v65
    v_cvt_pk_bf16_f32 v193, v66, v67
    v_mfma_f32_16x16x32_bf16 v[104:107], v[24:27], a[40:43], v[104:107]
    v_fmac_f32 v68, v144, v129
    v_fmac_f32 v69, v145, v129
    v_mfma_f32_16x16x32_bf16 v[108:111], v[24:27], a[44:47], v[108:111]
    buffer_load_dwordx4 v2, s[4:7], s61 offen offset:0 lds
    v_fmac_f32 v70, v146, v129
    s_waitcnt lgkmcnt(3)
    v_mfma_f32_16x16x32_bf16 v[112:115], v[28:31], a[32:35], v[112:115]
    ds_read_b128 v[20:23], v4 offset:9216
    v_fmac_f32 v71, v147, v129
    v_mfma_f32_16x16x32_bf16 v[116:119], v[28:31], a[36:39], v[116:119]
    v_fmac_f32 v84, v148, v129
    v_fmac_f32 v85, v149, v129
    v_mfma_f32_16x16x32_bf16 v[120:123], v[28:31], a[40:43], v[120:123]
    v_fmac_f32 v86, v150, v129
    v_fmac_f32 v87, v151, v129
    v_mfma_f32_16x16x32_bf16 v[124:127], v[28:31], a[44:47], v[124:127]
    v_mul_f32 v68, v68, v133
    v_mul_f32 v69, v69, v133
    s_waitcnt lgkmcnt(3)
    v_mfma_f32_16x16x32_bf16 v[96:99], v[8:11], a[48:51], v[96:99]
    ds_read_b128 v[24:27], v4 offset:10240
    v_mul_f32 v70, v70, v133
    v_mfma_f32_16x16x32_bf16 v[100:103], v[8:11], a[52:55], v[100:103]
    v_mul_f32 v71, v71, v133
    v_mul_f32 v68, v68, v84
    v_mfma_f32_16x16x32_bf16 v[104:107], v[8:11], a[56:59], v[104:107]
    v_mul_f32 v69, v69, v85
    v_mul_f32 v70, v70, v86
    v_mfma_f32_16x16x32_bf16 v[108:111], v[8:11], a[60:63], v[108:111]
    v_mul_f32 v71, v71, v87
    v_cvt_pk_bf16_f32 v196, v68, v69
    s_waitcnt lgkmcnt(3)
    v_mfma_f32_16x16x32_bf16 v[112:115], v[12:15], a[48:51], v[112:115]
    ds_read_b128 v[28:31], v4 offset:11264
    v_cvt_pk_bf16_f32 v197, v70, v71
    v_mfma_f32_16x16x32_bf16 v[116:119], v[12:15], a[52:55], v[116:119]
    v_fmac_f32 v72, v144, v130
    v_fmac_f32 v73, v145, v130
    v_mfma_f32_16x16x32_bf16 v[120:123], v[12:15], a[56:59], v[120:123]
    v_fmac_f32 v74, v146, v130
    v_fmac_f32 v75, v147, v130
    v_mfma_f32_16x16x32_bf16 v[124:127], v[12:15], a[60:63], v[124:127]
    v_fmac_f32 v88, v148, v130
    v_fmac_f32 v89, v149, v130
    s_waitcnt lgkmcnt(3)
    v_mfma_f32_16x16x32_bf16 v[96:99], v[16:19], a[64:67], v[96:99]
    ds_read_b128 v[8:11], v4 offset:12288
    v_fmac_f32 v90, v150, v130
    v_mfma_f32_16x16x32_bf16 v[100:103], v[16:19], a[68:71], v[100:103]
    v_fmac_f32 v91, v151, v130
    v_mul_f32 v72, v72, v134
    v_mfma_f32_16x16x32_bf16 v[104:107], v[16:19], a[72:75], v[104:107]
    v_mul_f32 v73, v73, v134
    v_mul_f32 v74, v74, v134
    v_mfma_f32_16x16x32_bf16 v[108:111], v[16:19], a[76:79], v[108:111]
    v_mul_f32 v75, v75, v134
    v_mul_f32 v72, v72, v88
    s_waitcnt lgkmcnt(3)
    v_mfma_f32_16x16x32_bf16 v[112:115], v[20:23], a[64:67], v[112:115]
    ds_read_b128 v[12:15], v4 offset:13312
    v_mul_f32 v73, v73, v89
    v_mfma_f32_16x16x32_bf16 v[116:119], v[20:23], a[68:71], v[116:119]
    v_mul_f32 v74, v74, v90
    v_mul_f32 v75, v75, v91
    v_mfma_f32_16x16x32_bf16 v[120:123], v[20:23], a[72:75], v[120:123]
    v_cvt_pk_bf16_f32 v200, v72, v73
    v_cvt_pk_bf16_f32 v201, v74, v75
    v_mfma_f32_16x16x32_bf16 v[124:127], v[20:23], a[76:79], v[124:127]
    v_fmac_f32 v76, v144, v131
    v_fmac_f32 v77, v145, v131
    s_waitcnt lgkmcnt(3)
    v_mfma_f32_16x16x32_bf16 v[96:99], v[24:27], a[80:83], v[96:99]
    ds_read_b128 v[16:19], v4 offset:14336
    v_fmac_f32 v78, v146, v131
    v_mfma_f32_16x16x32_bf16 v[100:103], v[24:27], a[84:87], v[100:103]
    v_fmac_f32 v79, v147, v131
    v_fmac_f32 v92, v148, v131
    v_mfma_f32_16x16x32_bf16 v[104:107], v[24:27], a[88:91], v[104:107]
    v_fmac_f32 v93, v149, v131
    v_fmac_f32 v94, v150, v131
    v_mfma_f32_16x16x32_bf16 v[108:111], v[24:27], a[92:95], v[108:111]
    v_fmac_f32 v95, v151, v131
    v_mul_f32 v76, v76, v135
    s_waitcnt lgkmcnt(3)
    v_mfma_f32_16x16x32_bf16 v[112:115], v[28:31], a[80:83], v[112:115]
    ds_read_b128 v[20:23], v4 offset:15360
    v_mul_f32 v77, v77, v135
    v_mfma_f32_16x16x32_bf16 v[116:119], v[28:31], a[84:87], v[116:119]
    v_mul_f32 v78, v78, v135
    v_mul_f32 v79, v79, v135
    v_mfma_f32_16x16x32_bf16 v[120:123], v[28:31], a[88:91], v[120:123]
    v_mul_f32 v76, v76, v92
    v_mul_f32 v77, v77, v93
    v_mfma_f32_16x16x32_bf16 v[124:127], v[28:31], a[92:95], v[124:127]
    v_mul_f32 v78, v78, v94
    v_mul_f32 v79, v79, v95
    s_waitcnt lgkmcnt(3)
    v_mfma_f32_16x16x32_bf16 v[96:99], v[8:11], a[96:99], v[96:99]
    ds_read_b128 v[24:27], v4 offset:16384
    v_cvt_pk_bf16_f32 v204, v76, v77
    v_mfma_f32_16x16x32_bf16 v[100:103], v[8:11], a[100:103], v[100:103]
    v_cvt_pk_bf16_f32 v205, v78, v79
    v_mfma_f32_16x16x32_bf16 v[104:107], v[8:11], a[104:107], v[104:107]
    v_mfma_f32_16x16x32_bf16 v[108:111], v[8:11], a[108:111], v[108:111]
    s_waitcnt lgkmcnt(3)
    v_mfma_f32_16x16x32_bf16 v[112:115], v[12:15], a[96:99], v[112:115]
    ds_read_b128 v[28:31], v4 offset:17408
    v_mfma_f32_16x16x32_bf16 v[116:119], v[12:15], a[100:103], v[116:119]
    v_mfma_f32_16x16x32_bf16 v[120:123], v[12:15], a[104:107], v[120:123]
    v_mfma_f32_16x16x32_bf16 v[124:127], v[12:15], a[108:111], v[124:127]
    s_waitcnt lgkmcnt(3)
    v_mfma_f32_16x16x32_bf16 v[96:99], v[16:19], a[112:115], v[96:99]
    ds_read_b128 v[8:11], v4 offset:18432
    v_mfma_f32_16x16x32_bf16 v[100:103], v[16:19], a[116:119], v[100:103]
    v_mfma_f32_16x16x32_bf16 v[104:107], v[16:19], a[120:123], v[104:107]
    v_mfma_f32_16x16x32_bf16 v[108:111], v[16:19], a[124:127], v[108:111]
    s_waitcnt lgkmcnt(3)
    v_mfma_f32_16x16x32_bf16 v[112:115], v[20:23], a[112:115], v[112:115]
    ds_read_b128 v[12:15], v4 offset:19456
    v_mfma_f32_16x16x32_bf16 v[116:119], v[20:23], a[116:119], v[116:119]
    v_mfma_f32_16x16x32_bf16 v[120:123], v[20:23], a[120:123], v[120:123]
    v_mfma_f32_16x16x32_bf16 v[124:127], v[20:23], a[124:127], v[124:127]
    s_waitcnt lgkmcnt(3)
    v_mfma_f32_16x16x32_bf16 v[96:99], v[24:27], a[128:131], v[96:99]
    ds_read_b128 v[16:19], v4 offset:20480
    v_mfma_f32_16x16x32_bf16 v[100:103], v[24:27], a[132:135], v[100:103]
    v_min_u32 v0, 17, v1
    v_lshlrev_b32 v0, 3, v0
    v_mfma_f32_16x16x32_bf16 v[104:107], v[24:27], a[136:139], v[104:107]
    s_add_u32 s55, s64, 288
    v_mfma_f32_16x16x32_bf16 v[108:111], v[24:27], a[140:143], v[108:111]
    s_waitcnt lgkmcnt(3)
    v_mfma_f32_16x16x32_bf16 v[112:115], v[28:31], a[128:131], v[112:115]
    ds_read_b128 v[20:23], v4 offset:21504
    v_mfma_f32_16x16x32_bf16 v[116:119], v[28:31], a[132:135], v[116:119]
    buffer_load_dwordx2 v[6:7], v0, s[4:7], s55 offen sc1
    v_mfma_f32_16x16x32_bf16 v[120:123], v[28:31], a[136:139], v[120:123]
    v_mfma_f32_16x16x32_bf16 v[124:127], v[28:31], a[140:143], v[124:127]
    s_waitcnt lgkmcnt(3)
    v_mfma_f32_16x16x32_bf16 v[96:99], v[8:11], a[144:147], v[96:99]
    ds_read_b128 v[24:27], v4 offset:22528
    v_mfma_f32_16x16x32_bf16 v[100:103], v[8:11], a[148:151], v[100:103]
    v_mfma_f32_16x16x32_bf16 v[104:107], v[8:11], a[152:155], v[104:107]
    v_mfma_f32_16x16x32_bf16 v[108:111], v[8:11], a[156:159], v[108:111]
    s_waitcnt lgkmcnt(3)
    v_mfma_f32_16x16x32_bf16 v[112:115], v[12:15], a[144:147], v[112:115]
    ds_read_b128 v[28:31], v4 offset:23552
    v_mfma_f32_16x16x32_bf16 v[116:119], v[12:15], a[148:151], v[116:119]
    v_mfma_f32_16x16x32_bf16 v[120:123], v[12:15], a[152:155], v[120:123]
    v_mfma_f32_16x16x32_bf16 v[124:127], v[12:15], a[156:159], v[124:127]
    s_waitcnt lgkmcnt(3)
    v_mfma_f32_16x16x32_bf16 v[96:99], v[16:19], a[160:163], v[96:99]
    ds_read_b128 v[8:11], v4 offset:24576
    v_mfma_f32_16x16x32_bf16 v[100:103], v[16:19], a[164:167], v[100:103]
    v_mfma_f32_16x16x32_bf16 v[104:107], v[16:19], a[168:171], v[104:107]
    v_mfma_f32_16x16x32_bf16 v[108:111], v[16:19], a[172:175], v[108:111]
    s_waitcnt lgkmcnt(3)
    v_mfma_f32_16x16x32_bf16 v[112:115], v[20:23], a[160:163], v[112:115]
    ds_read_b128 v[12:15], v4 offset:25600
    v_mfma_f32_16x16x32_bf16 v[116:119], v[20:23], a[164:167], v[116:119]
    v_mfma_f32_16x16x32_bf16 v[120:123], v[20:23], a[168:171], v[120:123]
    v_mfma_f32_16x16x32_bf16 v[124:127], v[20:23], a[172:175], v[124:127]
    s_waitcnt lgkmcnt(3)
    v_mfma_f32_16x16x32_bf16 v[96:99], v[24:27], a[176:179], v[96:99]
    ds_read_b128 v[16:19], v4 offset:26624
    v_mfma_f32_16x16x32_bf16 v[100:103], v[24:27], a[180:183], v[100:103]
    v_mfma_f32_16x16x32_bf16 v[104:107], v[24:27], a[184:187], v[104:107]
    v_mfma_f32_16x16x32_bf16 v[108:111], v[24:27], a[188:191], v[108:111]
    s_waitcnt lgkmcnt(3)
    v_mfma_f32_16x16x32_bf16 v[112:115], v[28:31], a[176:179], v[112:115]
    ds_read_b128 v[20:23], v4 offset:27648
    v_mfma_f32_16x16x32_bf16 v[116:119], v[28:31], a[180:183], v[116:119]
    v_mfma_f32_16x16x32_bf16 v[120:123], v[28:31], a[184:187], v[120:123]
    v_mfma_f32_16x16x32_bf16 v[124:127], v[28:31], a[188:191], v[124:127]
    s_waitcnt lgkmcnt(3)
    v_mfma_f32_16x16x32_bf16 v[96:99], v[8:11], a[192:195], v[96:99]
    ds_read_b128 v[24:27], v4 offset:28672
    v_mfma_f32_16x16x32_bf16 v[100:103], v[8:11], a[196:199], v[100:103]
    v_mfma_f32_16x16x32_bf16 v[104:107], v[8:11], a[200:203], v[104:107]
    v_mfma_f32_16x16x32_bf16 v[108:111], v[8:11], a[204:207], v[108:111]
    s_waitcnt lgkmcnt(3)
    v_mfma_f32_16x16x32_bf16 v[112:115], v[12:15], a[192:195], v[112:115]
    ds_read_b128 v[28:31], v4 offset:29696
    v_mfma_f32_16x16x32_bf16 v[116:119], v[12:15], a[196:199], v[116:119]
    v_mfma_f32_16x16x32_bf16 v[120:123], v[12:15], a[200:203], v[120:123]
    v_mfma_f32_16x16x32_bf16 v[124:127], v[12:15], a[204:207], v[124:127]
    s_waitcnt lgkmcnt(3)
    v_mfma_f32_16x16x32_bf16 v[96:99], v[16:19], a[208:211], v[96:99]
    ds_read_b128 v[8:11], v4 offset:30720
    v_mfma_f32_16x16x32_bf16 v[100:103], v[16:19], a[212:215], v[100:103]
    v_mfma_f32_16x16x32_bf16 v[104:107], v[16:19], a[216:219], v[104:107]
    v_mfma_f32_16x16x32_bf16 v[108:111], v[16:19], a[220:223], v[108:111]
    s_waitcnt lgkmcnt(3)
    v_mfma_f32_16x16x32_bf16 v[112:115], v[20:23], a[208:211], v[112:115]
    ds_read_b128 v[12:15], v4 offset:31744
    v_mfma_f32_16x16x32_bf16 v[116:119], v[20:23], a[212:215], v[116:119]
    s_waitcnt vmcnt(0)
    v_cmp_eq_u64 vcc, s[98:99], v[6:7]
    s_nop 0
    s_cmp_eq_u64 vcc, exec
    s_cbranch_scc0 L_pd_slow_63
L_pd_back_64:
    v_mfma_f32_16x16x32_bf16 v[120:123], v[20:23], a[216:219], v[120:123]
    v_mfma_f32_16x16x32_bf16 v[124:127], v[20:23], a[220:223], v[124:127]
    s_waitcnt lgkmcnt(3)
    v_mfma_f32_16x16x32_bf16 v[96:99], v[24:27], a[224:227], v[96:99]
    ds_read_b128 v[16:19], v4 offset:32768
    v_mfma_f32_16x16x32_bf16 v[100:103], v[24:27], a[228:231], v[100:103]
    v_mfma_f32_16x16x32_bf16 v[104:107], v[24:27], a[232:235], v[104:107]
    v_mfma_f32_16x16x32_bf16 v[108:111], v[24:27], a[236:239], v[108:111]
    s_waitcnt lgkmcnt(3)
    v_mfma_f32_16x16x32_bf16 v[112:115], v[28:31], a[224:227], v[112:115]
    ds_read_b128 v[20:23], v4 offset:33792
    v_mfma_f32_16x16x32_bf16 v[116:119], v[28:31], a[228:231], v[116:119]
    v_mfma_f32_16x16x32_bf16 v[120:123], v[28:31], a[232:235], v[120:123]
    v_mfma_f32_16x16x32_bf16 v[124:127], v[28:31], a[236:239], v[124:127]
    s_waitcnt lgkmcnt(3)
    v_mfma_f32_16x16x32_bf16 v[96:99], v[8:11], a[240:243], v[96:99]
    ds_read_b128 v[24:27], v4 offset:34816
    v_mfma_f32_16x16x32_bf16 v[100:103], v[8:11], a[244:247], v[100:103]
    v_mfma_f32_16x16x32_bf16 v[104:107], v[8:11], a[248:251], v[104:107]
    v_mfma_f32_16x16x32_bf16 v[108:111], v[8:11], a[252:255], v[108:111]
    ds_read_b128 v[136:139], v5 offset:512
    ds_read_b128 v[140:143], v5 offset:576
    s_waitcnt lgkmcnt(5)
    v_mfma_f32_16x16x32_bf16 v[112:115], v[12:15], a[240:243], v[112:115]
    ds_read_b128 v[28:31], v4 offset:35840
    v_mfma_f32_16x16x32_bf16 v[116:119], v[12:15], a[244:247], v[116:119]
    v_mfma_f32_16x16x32_bf16 v[120:123], v[12:15], a[248:251], v[120:123]
    v_mfma_f32_16x16x32_bf16 v[124:127], v[12:15], a[252:255], v[124:127]
    s_waitcnt lgkmcnt(5)
    v_mfma_f32_16x16x32_bf16 v[96:99], v[16:19], v[32:35], v[96:99]
    s_barrier
    v_mfma_f32_16x16x32_bf16 v[100:103], v[16:19], v[36:39], v[100:103]
    v_add_u32 v4, 0x9000, v4
    ds_read_b128 v[8:11], v4 offset:0
    v_mfma_f32_16x16x32_bf16 v[104:107], v[16:19], v[40:43], v[104:107]
    s_add_u32 m0, s49, 110592
    s_add_u32 s61, s48, 258048
    v_mfma_f32_16x16x32_bf16 v[108:111], v[16:19], v[44:47], v[108:111]
    buffer_load_dwordx4 v2, s[4:7], s61 offen offset:0 lds
    s_waitcnt lgkmcnt(5)
    v_mfma_f32_16x16x32_bf16 v[112:115], v[20:23], v[32:35], v[112:115]
    ds_read_b128 v[12:15], v4 offset:1024
    v_mfma_f32_16x16x32_bf16 v[116:119], v[20:23], v[36:39], v[116:119]
    v_mfma_f32_16x16x32_bf16 v[120:123], v[20:23], v[40:43], v[120:123]
    v_mfma_f32_16x16x32_bf16 v[124:127], v[20:23], v[44:47], v[124:127]
    buffer_load_dwordx4 v2, s[4:7], s61 offen offset:1024 lds
    s_waitcnt lgkmcnt(5)
    v_mfma_f32_16x16x32_bf16 v[96:99], v[24:27], v[48:51], v[96:99]
    ds_read_b128 v[16:19], v4 offset:2048
    v_mfma_f32_16x16x32_bf16 v[100:103], v[24:27], v[52:55], v[100:103]
    v_mfma_f32_16x16x32_bf16 v[104:107], v[24:27], v[56:59], v[104:107]
    v_mfma_f32_16x16x32_bf16 v[108:111], v[24:27], v[60:63], v[108:111]
    buffer_load_dwordx4 v2, s[4:7], s61 offen offset:2048 lds
    s_waitcnt lgkmcnt(3)
    v_mfma_f32_16x16x32_bf16 v[112:115], v[28:31], v[48:51], v[112:115]
    ds_read_b128 v[20:23], v4 offset:3072
    v_mfma_f32_16x16x32_bf16 v[116:119], v[28:31], v[52:55], v[116:119]
    v_mfma_f32_16x16x32_bf16 v[120:123], v[28:31], v[56:59], v[120:123]
    v_mfma_f32_16x16x32_bf16 v[124:127], v[28:31], v[60:63], v[124:127]
    buffer_load_dwordx4 v2, s[4:7], s61 offen offset:3072 lds
    s_add_u32 m0, s49, 114688
    s_waitcnt lgkmcnt(3)
    v_mfma_f32_16x16x32_bf16 v[64:67], v[8:11], a[0:3], 0
    ds_read_b128 v[24:27], v4 offset:4096
    s_add_u32 s61, s48, 262144
    v_mfma_f32_16x16x32_bf16 v[68:71], v[8:11], a[4:7], 0
    v_mfma_f32_16x16x32_bf16 v[72:75], v[8:11], a[8:11], 0
    v_mfma_f32_16x16x32_bf16 v[76:79], v[8:11], a[12:15], 0
    buffer_load_dwordx4 v2, s[4:7], s61 offen offset:0 lds
    s_waitcnt lgkmcnt(3)
    v_mfma_f32_16x16x32_bf16 v[80:83], v[12:15], a[0:3], 0
    ds_read_b128 v[28:31], v4 offset:5120
    v_mfma_f32_16x16x32_bf16 v[84:87], v[12:15], a[4:7], 0
    v_fmac_f32 v96, v136, v128
    v_fmac_f32 v97, v137, v128
    v_mfma_f32_16x16x32_bf16 v[88:91], v[12:15], a[8:11], 0
    v_fmac_f32 v98, v138, v128
    v_fmac_f32 v99, v139, v128
    v_mfma_f32_16x16x32_bf16 v[92:95], v[12:15], a[12:15], 0
    buffer_load_dwordx4 v2, s[4:7], s61 offen offset:1024 lds
    v_fmac_f32 v112, v140, v128
    s_waitcnt lgkmcnt(3)
    v_mfma_f32_16x16x32_bf16 v[64:67], v[16:19], a[16:19], v[64:67]
    ds_read_b128 v[8:11], v4 offset:6144
    v_fmac_f32 v113, v141, v128
    v_mfma_f32_16x16x32_bf16 v[68:71], v[16:19], a[20:23], v[68:71]
    v_fmac_f32 v114, v142, v128
    v_fmac_f32 v115, v143, v128
    v_mfma_f32_16x16x32_bf16 v[72:75], v[16:19], a[24:27], v[72:75]
    v_mul_f32 v96, v96, v132
    v_mul_f32 v97, v97, v132
    v_mfma_f32_16x16x32_bf16 v[76:79], v[16:19], a[28:31], v[76:79]
    buffer_load_dwordx4 v2, s[4:7], s61 offen offset:2048 lds
    v_mul_f32 v98, v98, v132
    s_waitcnt lgkmcnt(3)
    v_mfma_f32_16x16x32_bf16 v[80:83], v[20:23], a[16:19], v[80:83]
    ds_read_b128 v[12:15], v4 offset:7168
    v_mul_f32 v99, v99, v132
    v_mfma_f32_16x16x32_bf16 v[84:87], v[20:23], a[20:23], v[84:87]
    v_mul_f32 v96, v96, v112
    v_mul_f32 v97, v97, v113
    v_mfma_f32_16x16x32_bf16 v[88:91], v[20:23], a[24:27], v[88:91]
    v_mul_f32 v98, v98, v114
    v_mul_f32 v99, v99, v115
    v_mfma_f32_16x16x32_bf16 v[92:95], v[20:23], a[28:31], v[92:95]
    buffer_load_dwordx4 v2, s[4:7], s61 offen offset:3072 lds
    s_add_u32 m0, s49, 118784
    s_waitcnt lgkmcnt(3)
    v_mfma_f32_16x16x32_bf16 v[64:67], v[24:27], a[32:35], v[64:67]
    ds_read_b128 v[16:19], v4 offset:8192
    s_add_u32 s61, s48, 266240
    v_mfma_f32_16x16x32_bf16 v[68:71], v[24:27], a[36:39], v[68:71]
    v_cvt_pk_bf16_f32 v194, v96, v97
    v_cvt_pk_bf16_f32 v195, v98, v99
    v_mfma_f32_16x16x32_bf16 v[72:75], v[24:27], a[40:43], v[72:75]
    s_add_u32 s66, s51, 16384
    v_mfma_f32_16x16x32_bf16 v[76:79], v[24:27], a[44:47], v[76:79]
    buffer_load_dwordx4 v2, s[4:7], s61 offen offset:0 lds
    s_waitcnt lgkmcnt(3)
    v_mfma_f32_16x16x32_bf16 v[80:83], v[28:31], a[32:35], v[80:83]
    ds_read_b128 v[20:23], v4 offset:9216
    v_mfma_f32_16x16x32_bf16 v[84:87], v[28:31], a[36:39], v[84:87]
    v_mfma_f32_16x16x32_bf16 v[88:91], v[28:31], a[40:43], v[88:91]
    v_mfma_f32_16x16x32_bf16 v[92:95], v[28:31], a[44:47], v[92:95]
    buffer_store_dwordx4 v[192:195], v2, s[4:7], s66 offen offset:0 sc1
    v_fmac_f32 v100, v136, v129
    s_waitcnt lgkmcnt(3)
    v_mfma_f32_16x16x32_bf16 v[64:67], v[8:11], a[48:51], v[64:67]
    ds_read_b128 v[24:27], v4 offset:10240
    v_fmac_f32 v101, v137, v129
    v_mfma_f32_16x16x32_bf16 v[68:71], v[8:11], a[52:55], v[68:71]
    v_fmac_f32 v102, v138, v129
    v_fmac_f32 v103, v139, v129
    v_mfma_f32_16x16x32_bf16 v[72:75], v[8:11], a[56:59], v[72:75]
    v_fmac_f32 v116, v140, v129
    v_fmac_f32 v117, v141, v129
    v_mfma_f32_16x16x32_bf16 v[76:79], v[8:11], a[60:63], v[76:79]
    v_fmac_f32 v118, v142, v129
    v_fmac_f32 v119, v143, v129
    s_waitcnt lgkmcnt(3)
    v_mfma_f32_16x16x32_bf16 v[80:83], v[12:15], a[48:51], v[80:83]
    ds_read_b128 v[28:31], v4 offset:11264
    v_mul_f32 v100, v100, v133
    v_mfma_f32_16x16x32_bf16 v[84:87], v[12:15], a[52:55], v[84:87]
    v_mul_f32 v101, v101, v133
    v_mul_f32 v102, v102, v133
    v_mfma_f32_16x16x32_bf16 v[88:91], v[12:15], a[56:59], v[88:91]
    v_mul_f32 v103, v103, v133
    v_mul_f32 v100, v100, v116
    v_mfma_f32_16x16x32_bf16 v[92:95], v[12:15], a[60:63], v[92:95]
    v_mul_f32 v101, v101, v117
    v_mul_f32 v102, v102, v118
    s_waitcnt lgkmcnt(3)
    v_mfma_f32_16x16x32_bf16 v[64:67], v[16:19], a[64:67], v[64:67]
    ds_read_b128 v[8:11], v4 offset:12288
    v_mul_f32 v103, v103, v119
    v_mfma_f32_16x16x32_bf16 v[68:71], v[16:19], a[68:71], v[68:71]
    v_cvt_pk_bf16_f32 v198, v100, v101
    v_cvt_pk_bf16_f32 v199, v102, v103
    v_mfma_f32_16x16x32_bf16 v[72:75], v[16:19], a[72:75], v[72:75]
    buffer_store_dwordx4 v[196:199], v2, s[4:7], s66 offen offset:1024 sc1
    v_fmac_f32 v104, v136, v130
    v_mfma_f32_16x16x32_bf16 v[76:79], v[16:19], a[76:79], v[76:79]
    v_fmac_f32 v105, v137, v130
    v_fmac_f32 v106, v138, v130
    s_waitcnt lgkmcnt(3)
    v_mfma_f32_16x16x32_bf16 v[80:83], v[20:23], a[64:67], v[80:83]
    ds_read_b128 v[12:15], v4 offset:13312
    v_fmac_f32 v107, v139, v130
    v_mfma_f32_16x16x32_bf16 v[84:87], v[20:23], a[68:71], v[84:87]
    v_fmac_f32 v120, v140, v130
    v_fmac_f32 v121, v141, v130
    v_mfma_f32_16x16x32_bf16 v[88:91], v[20:23], a[72:75], v[88:91]
    v_fmac_f32 v122, v142, v130
    v_fmac_f32 v123, v143, v130
    v_mfma_f32_16x16x32_bf16 v[92:95], v[20:23], a[76:79], v[92:95]
    v_mul_f32 v104, v104, v134
    v_mul_f32 v105, v105, v134
    s_waitcnt lgkmcnt(3)
    v_mfma_f32_16x16x32_bf16 v[64:67], v[24:27], a[80:83], v[64:67]
    ds_read_b128 v[16:19], v4 offset:14336
    v_mul_f32 v106, v106, v134
    v_mfma_f32_16x16x32_bf16 v[68:71], v[24:27], a[84:87], v[68:71]
    v_mul_f32 v107, v107, v134
    v_mul_f32 v104, v104, v120
    v_mfma_f32_16x16x32_bf16 v[72:75], v[24:27], a[88:91], v[72:75]
    v_mul_f32 v105, v105, v121
    v_mul_f32 v106, v106, v122
    v_mfma_f32_16x16x32_bf16 v[76:79], v[24:27], a[92:95], v[76:79]
    v_mul_f32 v107, v107, v123
    v_cvt_pk_bf16_f32 v202, v104, v105
    s_waitcnt lgkmcnt(3)
    v_mfma_f32_16x16x32_bf16 v[80:83], v[28:31], a[80:83], v[80:83]
    ds_read_b128 v[20:23], v4 offset:15360
    v_cvt_pk_bf16_f32 v203, v106, v107
    v_mfma_f32_16x16x32_bf16 v[84:87], v[28:31], a[84:87], v[84:87]
    buffer_store_dwordx4 v[200:203], v2, s[4:7], s66 offen offset:2048 sc1
    v_fmac_f32 v108, v136, v131
    v_mfma_f32_16x16x32_bf16 v[88:91], v[28:31], a[88:91], v[88:91]
    v_fmac_f32 v109, v137, v131
    v_fmac_f32 v110, v138, v131
    v_mfma_f32_16x16x32_bf16 v[92:95], v[28:31], a[92:95], v[92:95]
    v_fmac_f32 v111, v139, v131
    v_fmac_f32 v124, v140, v131
    s_waitcnt lgkmcnt(3)
    v_mfma_f32_16x16x32_bf16 v[64:67], v[8:11], a[96:99], v[64:67]
    ds_read_b128 v[24:27], v4 offset:16384
    v_fmac_f32 v125, v141, v131
    v_mfma_f32_16x16x32_bf16 v[68:71], v[8:11], a[100:103], v[68:71]
    v_fmac_f32 v126, v142, v131
    v_fmac_f32 v127, v143, v131
    v_mfma_f32_16x16x32_bf16 v[72:75], v[8:11], a[104:107], v[72:75]
    v_mul_f32 v108, v108, v135
    v_mul_f32 v109, v109, v135
    v_mfma_f32_16x16x32_bf16 v[76:79], v[8:11], a[108:111], v[76:79]
    v_mul_f32 v110, v110, v135
    v_mul_f32 v111, v111, v135
    s_waitcnt lgkmcnt(3)
    v_mfma_f32_16x16x32_bf16 v[80:83], v[12:15], a[96:99], v[80:83]
    ds_read_b128 v[28:31], v4 offset:17408
    v_mul_f32 v108, v108, v124
    v_mfma_f32_16x16x32_bf16 v[84:87], v[12:15], a[100:103], v[84:87]
    v_mul_f32 v109, v109, v125
    v_mul_f32 v110, v110, v126
    v_mfma_f32_16x16x32_bf16 v[88:91], v[12:15], a[104:107], v[88:91]
    v_mul_f32 v111, v111, v127
    v_cvt_pk_bf16_f32 v206, v108, v109
    v_mfma_f32_16x16x32_bf16 v[92:95], v[12:15], a[108:111], v[92:95]
    v_cvt_pk_bf16_f32 v207, v110, v111
    buffer_store_dwordx4 v[204:207], v2, s[4:7], s66 offen offset:3072 sc1
    s_waitcnt lgkmcnt(3)
    v_mfma_f32_16x16x32_bf16 v[64:67], v[16:19], a[112:115], v[64:67]
    ds_read_b128 v[8:11], v4 offset:18432
    v_mfma_f32_16x16x32_bf16 v[68:71], v[16:19], a[116:119], v[68:71]
    v_mfma_f32_16x16x32_bf16 v[72:75], v[16:19], a[120:123], v[72:75]
    v_mfma_f32_16x16x32_bf16 v[76:79], v[16:19], a[124:127], v[76:79]
    s_waitcnt lgkmcnt(3)
    v_mfma_f32_16x16x32_bf16 v[80:83], v[20:23], a[112:115], v[80:83]
    ds_read_b128 v[12:15], v4 offset:19456
    v_mfma_f32_16x16x32_bf16 v[84:87], v[20:23], a[116:119], v[84:87]
    v_mfma_f32_16x16x32_bf16 v[88:91], v[20:23], a[120:123], v[88:91]
    v_mfma_f32_16x16x32_bf16 v[92:95], v[20:23], a[124:127], v[92:95]
    s_waitcnt lgkmcnt(3)
    v_mfma_f32_16x16x32_bf16 v[64:67], v[24:27], a[128:131], v[64:67]
    ds_read_b128 v[16:19], v4 offset:20480
    v_mfma_f32_16x16x32_bf16 v[68:71], v[24:27], a[132:135], v[68:71]
    v_mfma_f32_16x16x32_bf16 v[72:75], v[24:27], a[136:139], v[72:75]
    v_mfma_f32_16x16x32_bf16 v[76:79], v[24:27], a[140:143], v[76:79]
    s_waitcnt lgkmcnt(3)
    v_mfma_f32_16x16x32_bf16 v[80:83], v[28:31], a[128:131], v[80:83]
    ds_read_b128 v[20:23], v4 offset:21504
    v_mfma_f32_16x16x32_bf16 v[84:87], v[28:31], a[132:135], v[84:87]
    v_mfma_f32_16x16x32_bf16 v[88:91], v[28:31], a[136:139], v[88:91]
    v_mfma_f32_16x16x32_bf16 v[92:95], v[28:31], a[140:143], v[92:95]
    s_waitcnt lgkmcnt(3)
    v_mfma_f32_16x16x32_bf16 v[64:67], v[8:11], a[144:147], v[64:67]
    ds_read_b128 v[24:27], v4 offset:22528
    v_mfma_f32_16x16x32_bf16 v[68:71], v[8:11], a[148:151], v[68:71]
    v_mfma_f32_16x16x32_bf16 v[72:75], v[8:11], a[152:155], v[72:75]
    v_mfma_f32_16x16x32_bf16 v[76:79], v[8:11], a[156:159], v[76:79]
    s_waitcnt lgkmcnt(3)
    v_mfma_f32_16x16x32_bf16 v[80:83], v[12:15], a[144:147], v[80:83]
    ds_read_b128 v[28:31], v4 offset:23552
    v_mfma_f32_16x16x32_bf16 v[84:87], v[12:15], a[148:151], v[84:87]
    v_mfma_f32_16x16x32_bf16 v[88:91], v[12:15], a[152:155], v[88:91]
    v_mfma_f32_16x16x32_bf16 v[92:95], v[12:15], a[156:159], v[92:95]
    s_waitcnt lgkmcnt(3)
    v_mfma_f32_16x16x32_bf16 v[64:67], v[16:19], a[160:163], v[64:67]
    ds_read_b128 v[8:11], v4 offset:24576
    v_mfma_f32_16x16x32_bf16 v[68:71], v[16:19], a[164:167], v[68:71]
    v_mfma_f32_16x16x32_bf16 v[72:75], v[16:19], a[168:171], v[72:75]
    v_mfma_f32_16x16x32_bf16 v[76:79], v[16:19], a[172:175], v[76:79]
    s_waitcnt lgkmcnt(3)
    v_mfma_f32_16x16x32_bf16 v[80:83], v[20:23], a[160:163], v[80:83]
    ds_read_b128 v[12:15], v4 offset:25600
    v_mfma_f32_16x16x32_bf16 v[84:87], v[20:23], a[164:167], v[84:87]
    v_mfma_f32_16x16x32_bf16 v[88:91], v[20:23], a[168:171], v[88:91]
    v_mfma_f32_16x16x32_bf16 v[92:95], v[20:23], a[172:175], v[92:95]
    s_waitcnt lgkmcnt(3)
    v_mfma_f32_16x16x32_bf16 v[64:67], v[24:27], a[176:179], v[64:67]
    ds_read_b128 v[16:19], v4 offset:26624
    v_mfma_f32_16x16x32_bf16 v[68:71], v[24:27], a[180:183], v[68:71]
    v_mfma_f32_16x16x32_bf16 v[72:75], v[24:27], a[184:187], v[72:75]
    v_mfma_f32_16x16x32_bf16 v[76:79], v[24:27], a[188:191], v[76:79]
    s_waitcnt lgkmcnt(3)
    v_mfma_f32_16x16x32_bf16 v[80:83], v[28:31], a[176:179], v[80:83]
    ds_read_b128 v[20:23], v4 offset:27648
    v_mfma_f32_16x16x32_bf16 v[84:87], v[28:31], a[180:183], v[84:87]
    v_mfma_f32_16x16x32_bf16 v[88:91], v[28:31], a[184:187], v[88:91]
    v_mfma_f32_16x16x32_bf16 v[92:95], v[28:31], a[188:191], v[92:95]
    s_waitcnt lgkmcnt(3)
    v_mfma_f32_16x16x32_bf16 v[64:67], v[8:11], a[192:195], v[64:67]
    ds_read_b128 v[24:27], v4 offset:28672
    v_mfma_f32_16x16x32_bf16 v[68:71], v[8:11], a[196:199], v[68:71]
    v_mfma_f32_16x16x32_bf16 v[72:75], v[8:11], a[200:203], v[72:75]
    v_mfma_f32_16x16x32_bf16 v[76:79], v[8:11], a[204:207], v[76:79]
    s_waitcnt lgkmcnt(3)
    v_mfma_f32_16x16x32_bf16 v[80:83], v[12:15], a[192:195], v[80:83]
    ds_read_b128 v[28:31], v4 offset:29696
    v_mfma_f32_16x16x32_bf16 v[84:87], v[12:15], a[196:199], v[84:87]
    v_mfma_f32_16x16x32_bf16 v[88:91], v[12:15], a[200:203], v[88:91]
    v_mfma_f32_16x16x32_bf16 v[92:95], v[12:15], a[204:207], v[92:95]
    s_waitcnt lgkmcnt(3)
    v_mfma_f32_16x16x32_bf16 v[64:67], v[16:19], a[208:211], v[64:67]
    ds_read_b128 v[8:11], v4 offset:30720
    v_mfma_f32_16x16x32_bf16 v[68:71], v[16:19], a[212:215], v[68:71]
    v_mfma_f32_16x16x32_bf16 v[72:75], v[16:19], a[216:219], v[72:75]
    v_mfma_f32_16x16x32_bf16 v[76:79], v[16:19], a[220:223], v[76:79]
    s_waitcnt lgkmcnt(3)
    v_mfma_f32_16x16x32_bf16 v[80:83], v[20:23], a[208:211], v[80:83]
    ds_read_b128 v[12:15], v4 offset:31744
    v_mfma_f32_16x16x32_bf16 v[84:87], v[20:23], a[212:215], v[84:87]
    v_mfma_f32_16x16x32_bf16 v[88:91], v[20:23], a[216:219], v[88:91]
    v_mfma_f32_16x16x32_bf16 v[92:95], v[20:23], a[220:223], v[92:95]
    s_waitcnt lgkmcnt(3)
    v_mfma_f32_16x16x32_bf16 v[64:67], v[24:27], a[224:227], v[64:67]
    ds_read_b128 v[16:19], v4 offset:32768
    v_mfma_f32_16x16x32_bf16 v[68:71], v[24:27], a[228:231], v[68:71]
    v_mfma_f32_16x16x32_bf16 v[72:75], v[24:27], a[232:235], v[72:75]
    v_mfma_f32_16x16x32_bf16 v[76:79], v[24:27], a[236:239], v[76:79]
    s_waitcnt lgkmcnt(3)
    v_mfma_f32_16x16x32_bf16 v[80:83], v[28:31], a[224:227], v[80:83]
    ds_read_b128 v[20:23], v4 offset:33792
    v_mfma_f32_16x16x32_bf16 v[84:87], v[28:31], a[228:231], v[84:87]
    v_mfma_f32_16x16x32_bf16 v[88:91], v[28:31], a[232:235], v[88:91]
    v_mfma_f32_16x16x32_bf16 v[92:95], v[28:31], a[236:239], v[92:95]
    s_waitcnt lgkmcnt(3)
    v_mfma_f32_16x16x32_bf16 v[64:67], v[8:11], a[240:243], v[64:67]
    ds_read_b128 v[24:27], v4 offset:34816
    v_mfma_f32_16x16x32_bf16 v[68:71], v[8:11], a[244:247], v[68:71]
    v_mfma_f32_16x16x32_bf16 v[72:75], v[8:11], a[248:251], v[72:75]
    v_mfma_f32_16x16x32_bf16 v[76:79], v[8:11], a[252:255], v[76:79]
    ds_read_b128 v[144:147], v5 offset:640
    ds_read_b128 v[148:151], v5 offset:704
    s_waitcnt lgkmcnt(5)
    v_mfma_f32_16x16x32_bf16 v[80:83], v[12:15], a[240:243], v[80:83]
    ds_read_b128 v[28:31], v4 offset:35840
    v_mfma_f32_16x16x32_bf16 v[84:87], v[12:15], a[244:247], v[84:87]
    v_mfma_f32_16x16x32_bf16 v[88:91], v[12:15], a[248:251], v[88:91]
    v_mfma_f32_16x16x32_bf16 v[92:95], v[12:15], a[252:255], v[92:95]
    s_waitcnt lgkmcnt(5)
    v_mfma_f32_16x16x32_bf16 v[64:67], v[16:19], v[32:35], v[64:67]
    s_barrier
    v_mfma_f32_16x16x32_bf16 v[68:71], v[16:19], v[36:39], v[68:71]
    v_add_u32 v4, 0x9000, v4
    ds_read_b128 v[8:11], v4 offset:0
    v_mfma_f32_16x16x32_bf16 v[72:75], v[16:19], v[40:43], v[72:75]
    s_add_u32 m0, s49, 0
    s_add_u32 s61, s48, 294912
    v_mfma_f32_16x16x32_bf16 v[76:79], v[16:19], v[44:47], v[76:79]
    buffer_load_dwordx4 v2, s[4:7], s61 offen offset:0 lds
    s_waitcnt lgkmcnt(5)
    v_mfma_f32_16x16x32_bf16 v[80:83], v[20:23], v[32:35], v[80:83]
    ds_read_b128 v[12:15], v4 offset:1024
    v_mfma_f32_16x16x32_bf16 v[84:87], v[20:23], v[36:39], v[84:87]
    v_mfma_f32_16x16x32_bf16 v[88:91], v[20:23], v[40:43], v[88:91]
    v_mfma_f32_16x16x32_bf16 v[92:95], v[20:23], v[44:47], v[92:95]
    buffer_load_dwordx4 v2, s[4:7], s61 offen offset:1024 lds
    s_waitcnt lgkmcnt(5)
    v_mfma_f32_16x16x32_bf16 v[64:67], v[24:27], v[48:51], v[64:67]
    ds_read_b128 v[16:19], v4 offset:2048
    v_mfma_f32_16x16x32_bf16 v[68:71], v[24:27], v[52:55], v[68:71]
    v_mfma_f32_16x16x32_bf16 v[72:75], v[24:27], v[56:59], v[72:75]
    v_mfma_f32_16x16x32_bf16 v[76:79], v[24:27], v[60:63], v[76:79]
    buffer_load_dwordx4 v2, s[4:7], s61 offen offset:2048 lds
    s_waitcnt lgkmcnt(3)
    v_mfma_f32_16x16x32_bf16 v[80:83], v[28:31], v[48:51], v[80:83]
    ds_read_b128 v[20:23], v4 offset:3072
    v_mfma_f32_16x16x32_bf16 v[84:87], v[28:31], v[52:55], v[84:87]
    v_mfma_f32_16x16x32_bf16 v[88:91], v[28:31], v[56:59], v[88:91]
    v_mfma_f32_16x16x32_bf16 v[92:95], v[28:31], v[60:63], v[92:95]
    buffer_load_dwordx4 v2, s[4:7], s61 offen offset:3072 lds
    s_add_u32 m0, s49, 4096
    s_waitcnt lgkmcnt(3)
    v_mfma_f32_16x16x32_bf16 v[96:99], v[8:11], a[0:3], 0
    ds_read_b128 v[24:27], v4 offset:4096
    s_add_u32 s61, s48, 299008
    v_mfma_f32_16x16x32_bf16 v[100:103], v[8:11], a[4:7], 0
    v_mfma_f32_16x16x32_bf16 v[104:107], v[8:11], a[8:11], 0
    v_mfma_f32_16x16x32_bf16 v[108:111], v[8:11], a[12:15], 0
    buffer_load_dwordx4 v2, s[4:7], s61 offen offset:0 lds
    s_waitcnt lgkmcnt(3)
    v_mfma_f32_16x16x32_bf16 v[112:115], v[12:15], a[0:3], 0
    ds_read_b128 v[28:31], v4 offset:5120
    v_mfma_f32_16x16x32_bf16 v[116:119], v[12:15], a[4:7], 0
    v_fmac_f32 v64, v144, v128
    v_fmac_f32 v65, v145, v128
    v_mfma_f32_16x16x32_bf16 v[120:123], v[12:15], a[8:11], 0
    v_fmac_f32 v66, v146, v128
    v_fmac_f32 v67, v147, v128
    v_mfma_f32_16x16x32_bf16 v[124:127], v[12:15], a[12:15], 0
    buffer_load_dwordx4 v2, s[4:7], s61 offen offset:1024 lds
    v_fmac_f32 v80, v148, v128
    s_waitcnt lgkmcnt(3)
    v_mfma_f32_16x16x32_bf16 v[96:99], v[16:19], a[16:19], v[96:99]
    ds_read_b128 v[8:11], v4 offset:6144
    v_fmac_f32 v81, v149, v128
    v_mfma_f32_16x16x32_bf16 v[100:103], v[16:19], a[20:23], v[100:103]
    v_fmac_f32 v82, v150, v128
    v_fmac_f32 v83, v151, v128
    v_mfma_f32_16x16x32_bf16 v[104:107], v[16:19], a[24:27], v[104:107]
    v_mul_f32 v64, v64, v132
    v_mul_f32 v65, v65, v132
    v_mfma_f32_16x16x32_bf16 v[108:111], v[16:19], a[28:31], v[108:111]
    buffer_load_dwordx4 v2, s[4:7], s61 offen offset:2048 lds
    v_mul_f32 v66, v66, v132
    s_waitcnt lgkmcnt(3)
    v_mfma_f32_16x16x32_bf16 v[112:115], v[20:23], a[16:19], v[112:115]
    ds_read_b128 v[12:15], v4 offset:7168
    v_mul_f32 v67, v67, v132
    v_mfma_f32_16x16x32_bf16 v[116:119], v[20:23], a[20:23], v[116:119]
    v_mul_f32 v64, v64, v80
    v_mul_f32 v65, v65, v81
    v_mfma_f32_16x16x32_bf16 v[120:123], v[20:23], a[24:27], v[120:123]
    v_mul_f32 v66, v66, v82
    v_mul_f32 v67, v67, v83
    v_mfma_f32_16x16x32_bf16 v[124:127], v[20:23], a[28:31], v[124:127]
    buffer_load_dwordx4 v2, s[4:7], s61 offen offset:3072 lds
    s_add_u32 m0, s49, 8192
    s_waitcnt lgkmcnt(3)
    v_mfma_f32_16x16x32_bf16 v[96:99], v[24:27], a[32:35], v[96:99]
    ds_read_b128 v[16:19], v4 offset:8192
    s_add_u32 s61, s48, 303104
    v_mfma_f32_16x16x32_bf16 v[100:103], v[24:27], a[36:39], v[100:103]
    v_cvt_pk_bf16_f32 v208, v64, v65
    v_cvt_pk_bf16_f32 v209, v66, v67
    v_mfma_f32_16x16x32_bf16 v[104:107], v[24:27], a[40:43], v[104:107]
    v_fmac_f32 v68, v144, v129
    v_fmac_f32 v69, v145, v129
    v_mfma_f32_16x16x32_bf16 v[108:111], v[24:27], a[44:47], v[108:111]
    buffer_load_dwordx4 v2, s[4:7], s61 offen offset:0 lds
    v_fmac_f32 v70, v146, v129
    s_waitcnt lgkmcnt(3)
    v_mfma_f32_16x16x32_bf16 v[112:115], v[28:31], a[32:35], v[112:115]
    ds_read_b128 v[20:23], v4 offset:9216
    v_fmac_f32 v71, v147, v129
    v_mfma_f32_16x16x32_bf16 v[116:119], v[28:31], a[36:39], v[116:119]
    v_fmac_f32 v84, v148, v129
    v_fmac_f32 v85, v149, v129
    v_mfma_f32_16x16x32_bf16 v[120:123], v[28:31], a[40:43], v[120:123]
    v_fmac_f32 v86, v150, v129
    v_fmac_f32 v87, v151, v129
    v_mfma_f32_16x16x32_bf16 v[124:127], v[28:31], a[44:47], v[124:127]
    v_mul_f32 v68, v68, v133
    v_mul_f32 v69, v69, v133
    s_waitcnt lgkmcnt(3)
    v_mfma_f32_16x16x32_bf16 v[96:99], v[8:11], a[48:51], v[96:99]
    ds_read_b128 v[24:27], v4 offset:10240
    v_mul_f32 v70, v70, v133
    v_mfma_f32_16x16x32_bf16 v[100:103], v[8:11], a[52:55], v[100:103]
    v_mul_f32 v71, v71, v133
    v_mul_f32 v68, v68, v84
    v_mfma_f32_16x16x32_bf16 v[104:107], v[8:11], a[56:59], v[104:107]
    v_mul_f32 v69, v69, v85
    v_mul_f32 v70, v70, v86
    v_mfma_f32_16x16x32_bf16 v[108:111], v[8:11], a[60:63], v[108:111]
    v_mul_f32 v71, v71, v87
    v_cvt_pk_bf16_f32 v212, v68, v69
    s_waitcnt lgkmcnt(3)
    v_mfma_f32_16x16x32_bf16 v[112:115], v[12:15], a[48:51], v[112:115]
    ds_read_b128 v[28:31], v4 offset:11264
    v_cvt_pk_bf16_f32 v213, v70, v71
    v_mfma_f32_16x16x32_bf16 v[116:119], v[12:15], a[52:55], v[116:119]
    v_fmac_f32 v72, v144, v130
    v_fmac_f32 v73, v145, v130
    v_mfma_f32_16x16x32_bf16 v[120:123], v[12:15], a[56:59], v[120:123]
    v_fmac_f32 v74, v146, v130
    v_fmac_f32 v75, v147, v130
    v_mfma_f32_16x16x32_bf16 v[124:127], v[12:15], a[60:63], v[124:127]
    v_fmac_f32 v88, v148, v130
    v_fmac_f32 v89, v149, v130
    s_waitcnt lgkmcnt(3)
    v_mfma_f32_16x16x32_bf16 v[96:99], v[16:19], a[64:67], v[96:99]
    ds_read_b128 v[8:11], v4 offset:12288
    v_fmac_f32 v90, v150, v130
    v_mfma_f32_16x16x32_bf16 v[100:103], v[16:19], a[68:71], v[100:103]
    v_fmac_f32 v91, v151, v130
    v_mul_f32 v72, v72, v134
    v_mfma_f32_16x16x32_bf16 v[104:107], v[16:19], a[72:75], v[104:107]
    v_mul_f32 v73, v73, v134
    v_mul_f32 v74, v74, v134
    v_mfma_f32_16x16x32_bf16 v[108:111], v[16:19], a[76:79], v[108:111]
    v_mul_f32 v75, v75, v134
    v_mul_f32 v72, v72, v88
    s_waitcnt lgkmcnt(3)
    v_mfma_f32_16x16x32_bf16 v[112:115], v[20:23], a[64:67], v[112:115]
    ds_read_b128 v[12:15], v4 offset:13312
    v_mul_f32 v73, v73, v89
    v_mfma_f32_16x16x32_bf16 v[116:119], v[20:23], a[68:71], v[116:119]
    v_mul_f32 v74, v74, v90
    v_mul_f32 v75, v75, v91
    v_mfma_f32_16x16x32_bf16 v[120:123], v[20:23], a[72:75], v[120:123]
    v_cvt_pk_bf16_f32 v216, v72, v73
    v_cvt_pk_bf16_f32 v217, v74, v75
    v_mfma_f32_16x16x32_bf16 v[124:127], v[20:23], a[76:79], v[124:127]
    v_fmac_f32 v76, v144, v131
    v_fmac_f32 v77, v145, v131
    s_waitcnt lgkmcnt(3)
    v_mfma_f32_16x16x32_bf16 v[96:99], v[24:27], a[80:83], v[96:99]
    ds_read_b128 v[16:19], v4 offset:14336
    v_fmac_f32 v78, v146, v131
    v_mfma_f32_16x16x32_bf16 v[100:103], v[24:27], a[84:87], v[100:103]
    v_fmac_f32 v79, v147, v131
    v_fmac_f32 v92, v148, v131
    v_mfma_f32_16x16x32_bf16 v[104:107], v[24:27], a[88:91], v[104:107]
    v_fmac_f32 v93, v149, v131
    v_fmac_f32 v94, v150, v131
    v_mfma_f32_16x16x32_bf16 v[108:111], v[24:27], a[92:95], v[108:111]
    v_fmac_f32 v95, v151, v131
    v_mul_f32 v76, v76, v135
    s_waitcnt lgkmcnt(3)
    v_mfma_f32_16x16x32_bf16 v[112:115], v[28:31], a[80:83], v[112:115]
    ds_read_b128 v[20:23], v4 offset:15360
    v_mul_f32 v77, v77, v135
    v_mfma_f32_16x16x32_bf16 v[116:119], v[28:31], a[84:87], v[116:119]
    v_mul_f32 v78, v78, v135
    v_mul_f32 v79, v79, v135
    v_mfma_f32_16x16x32_bf16 v[120:123], v[28:31], a[88:91], v[120:123]
    v_mul_f32 v76, v76, v92
    v_mul_f32 v77, v77, v93
    v_mfma_f32_16x16x32_bf16 v[124:127], v[28:31], a[92:95], v[124:127]
    v_mul_f32 v78, v78, v94
    v_mul_f32 v79, v79, v95
    s_waitcnt lgkmcnt(3)
    v_mfma_f32_16x16x32_bf16 v[96:99], v[8:11], a[96:99], v[96:99]
    ds_read_b128 v[24:27], v4 offset:16384
    v_cvt_pk_bf16_f32 v220, v76, v77
    v_mfma_f32_16x16x32_bf16 v[100:103], v[8:11], a[100:103], v[100:103]
    v_cvt_pk_bf16_f32 v221, v78, v79
    v_mfma_f32_16x16x32_bf16 v[104:107], v[8:11], a[104:107], v[104:107]
    v_mfma_f32_16x16x32_bf16 v[108:111], v[8:11], a[108:111], v[108:111]
    s_waitcnt lgkmcnt(3)
    v_mfma_f32_16x16x32_bf16 v[112:115], v[12:15], a[96:99], v[112:115]
    ds_read_b128 v[28:31], v4 offset:17408
    v_mfma_f32_16x16x32_bf16 v[116:119], v[12:15], a[100:103], v[116:119]
    v_mfma_f32_16x16x32_bf16 v[120:123], v[12:15], a[104:107], v[120:123]
    v_mfma_f32_16x16x32_bf16 v[124:127], v[12:15], a[108:111], v[124:127]
    s_waitcnt lgkmcnt(3)
    v_mfma_f32_16x16x32_bf16 v[96:99], v[16:19], a[112:115], v[96:99]
    ds_read_b128 v[8:11], v4 offset:18432
    v_mfma_f32_16x16x32_bf16 v[100:103], v[16:19], a[116:119], v[100:103]
    s_add_u32 s71, s67, 0
    v_mov_b32 v6, s98
    v_mfma_f32_16x16x32_bf16 v[104:107], v[16:19], a[120:123], v[104:107]
    v_mov_b32 v7, s99
    v_mfma_f32_16x16x32_bf16 v[108:111], v[16:19], a[124:127], v[108:111]
    s_waitcnt vmcnt(9)
    s_waitcnt lgkmcnt(3)
    v_mfma_f32_16x16x32_bf16 v[112:115], v[20:23], a[112:115], v[112:115]
    ds_read_b128 v[12:15], v4 offset:19456
    v_mfma_f32_16x16x32_bf16 v[116:119], v[20:23], a[116:119], v[116:119]
    s_mov_b64 exec, 1
    buffer_store_dwordx2 v[6:7], off, s[4:7], s71 sc1
    s_mov_b64 exec, -1
    v_mfma_f32_16x16x32_bf16 v[120:123], v[20:23], a[120:123], v[120:123]
    v_mfma_f32_16x16x32_bf16 v[124:127], v[20:23], a[124:127], v[124:127]
    s_waitcnt lgkmcnt(3)
    v_mfma_f32_16x16x32_bf16 v[96:99], v[24:27], a[128:131], v[96:99]
    ds_read_b128 v[16:19], v4 offset:20480
    v_mfma_f32_16x16x32_bf16 v[100:103], v[24:27], a[132:135], v[100:103]
    v_mfma_f32_16x16x32_bf16 v[104:107], v[24:27], a[136:139], v[104:107]
    v_mfma_f32_16x16x32_bf16 v[108:111], v[24:27], a[140:143], v[108:111]
    s_waitcnt lgkmcnt(3)
    v_mfma_f32_16x16x32_bf16 v[112:115], v[28:31], a[128:131], v[112:115]
    ds_read_b128 v[20:23], v4 offset:21504
    v_mfma_f32_16x16x32_bf16 v[116:119], v[28:31], a[132:135], v[116:119]
    v_mfma_f32_16x16x32_bf16 v[120:123], v[28:31], a[136:139], v[120:123]
    v_mfma_f32_16x16x32_bf16 v[124:127], v[28:31], a[140:143], v[124:127]
    s_waitcnt lgkmcnt(3)
    v_mfma_f32_16x16x32_bf16 v[96:99], v[8:11], a[144:147], v[96:99]
    ds_read_b128 v[24:27], v4 offset:22528
    v_mfma_f32_16x16x32_bf16 v[100:103], v[8:11], a[148:151], v[100:103]
    v_mfma_f32_16x16x32_bf16 v[104:107], v[8:11], a[152:155], v[104:107]
    v_mfma_f32_16x16x32_bf16 v[108:111], v[8:11], a[156:159], v[108:111]
    s_waitcnt lgkmcnt(3)
    v_mfma_f32_16x16x32_bf16 v[112:115], v[12:15], a[144:147], v[112:115]
    ds_read_b128 v[28:31], v4 offset:23552
    v_mfma_f32_16x16x32_bf16 v[116:119], v[12:15], a[148:151], v[116:119]
    v_mfma_f32_16x16x32_bf16 v[120:123], v[12:15], a[152:155], v[120:123]
    v_mfma_f32_16x16x32_bf16 v[124:127], v[12:15], a[156:159], v[124:127]
    s_waitcnt lgkmcnt(3)
    v_mfma_f32_16x16x32_bf16 v[96:99], v[16:19], a[160:163], v[96:99]
    ds_read_b128 v[8:11], v4 offset:24576
    v_mfma_f32_16x16x32_bf16 v[100:103], v[16:19], a[164:167], v[100:103]
    v_mfma_f32_16x16x32_bf16 v[104:107], v[16:19], a[168:171], v[104:107]
    v_mfma_f32_16x16x32_bf16 v[108:111], v[16:19], a[172:175], v[108:111]
    s_waitcnt lgkmcnt(3)
    v_mfma_f32_16x16x32_bf16 v[112:115], v[20:23], a[160:163], v[112:115]
    ds_read_b128 v[12:15], v4 offset:25600
    v_mfma_f32_16x16x32_bf16 v[116:119], v[20:23], a[164:167], v[116:119]
    v_mfma_f32_16x16x32_bf16 v[120:123], v[20:23], a[168:171], v[120:123]
    v_mfma_f32_16x16x32_bf16 v[124:127], v[20:23], a[172:175], v[124:127]
    s_waitcnt lgkmcnt(3)
    v_mfma_f32_16x16x32_bf16 v[96:99], v[24:27], a[176:179], v[96:99]
    ds_read_b128 v[16:19], v4 offset:26624
    v_mfma_f32_16x16x32_bf16 v[100:103], v[24:27], a[180:183], v[100:103]
    v_mfma_f32_16x16x32_bf16 v[104:107], v[24:27], a[184:187], v[104:107]
    v_mfma_f32_16x16x32_bf16 v[108:111], v[24:27], a[188:191], v[108:111]
    s_waitcnt lgkmcnt(3)
    v_mfma_f32_16x16x32_bf16 v[112:115], v[28:31], a[176:179], v[112:115]
    ds_read_b128 v[20:23], v4 offset:27648
    v_mfma_f32_16x16x32_bf16 v[116:119], v[28:31], a[180:183], v[116:119]
    v_mfma_f32_16x16x32_bf16 v[120:123], v[28:31], a[184:187], v[120:123]
    v_mfma_f32_16x16x32_bf16 v[124:127], v[28:31], a[188:191], v[124:127]
    s_waitcnt lgkmcnt(3)
    v_mfma_f32_16x16x32_bf16 v[96:99], v[8:11], a[192:195], v[96:99]
    ds_read_b128 v[24:27], v4 offset:28672
    v_mfma_f32_16x16x32_bf16 v[100:103], v[8:11], a[196:199], v[100:103]
    v_mfma_f32_16x16x32_bf16 v[104:107], v[8:11], a[200:203], v[104:107]
    v_mfma_f32_16x16x32_bf16 v[108:111], v[8:11], a[204:207], v[108:111]
    s_waitcnt lgkmcnt(3)
    v_mfma_f32_16x16x32_bf16 v[112:115], v[12:15], a[192:195], v[112:115]
    ds_read_b128 v[28:31], v4 offset:29696
    v_mfma_f32_16x16x32_bf16 v[116:119], v[12:15], a[196:199], v[116:119]
    v_mfma_f32_16x16x32_bf16 v[120:123], v[12:15], a[200:203], v[120:123]
    v_mfma_f32_16x16x32_bf16 v[124:127], v[12:15], a[204:207], v[124:127]
    s_waitcnt lgkmcnt(3)
    v_mfma_f32_16x16x32_bf16 v[96:99], v[16:19], a[208:211], v[96:99]
    ds_read_b128 v[8:11], v4 offset:30720
    v_mfma_f32_16x16x32_bf16 v[100:103], v[16:19], a[212:215], v[100:103]
    v_mfma_f32_16x16x32_bf16 v[104:107], v[16:19], a[216:219], v[104:107]
    v_mfma_f32_16x16x32_bf16 v[108:111], v[16:19], a[220:223], v[108:111]
    s_waitcnt lgkmcnt(3)
    v_mfma_f32_16x16x32_bf16 v[112:115], v[20:23], a[208:211], v[112:115]
    ds_read_b128 v[12:15], v4 offset:31744
    v_mfma_f32_16x16x32_bf16 v[116:119], v[20:23], a[212:215], v[116:119]
    v_mfma_f32_16x16x32_bf16 v[120:123], v[20:23], a[216:219], v[120:123]
    v_mfma_f32_16x16x32_bf16 v[124:127], v[20:23], a[220:223], v[124:127]
    s_waitcnt lgkmcnt(3)
    v_mfma_f32_16x16x32_bf16 v[96:99], v[24:27], a[224:227], v[96:99]
    ds_read_b128 v[16:19], v4 offset:32768
    v_mfma_f32_16x16x32_bf16 v[100:103], v[24:27], a[228:231], v[100:103]
    v_mfma_f32_16x16x32_bf16 v[104:107], v[24:27], a[232:235], v[104:107]
    v_mfma_f32_16x16x32_bf16 v[108:111], v[24:27], a[236:239], v[108:111]
    s_waitcnt lgkmcnt(3)
    v_mfma_f32_16x16x32_bf16 v[112:115], v[28:31], a[224:227], v[112:115]
    ds_read_b128 v[20:23], v4 offset:33792
    v_mfma_f32_16x16x32_bf16 v[116:119], v[28:31], a[228:231], v[116:119]
    v_mfma_f32_16x16x32_bf16 v[120:123], v[28:31], a[232:235], v[120:123]
    v_mfma_f32_16x16x32_bf16 v[124:127], v[28:31], a[236:239], v[124:127]
    s_waitcnt lgkmcnt(3)
    v_mfma_f32_16x16x32_bf16 v[96:99], v[8:11], a[240:243], v[96:99]
    ds_read_b128 v[24:27], v4 offset:34816
    v_mfma_f32_16x16x32_bf16 v[100:103], v[8:11], a[244:247], v[100:103]
    v_mfma_f32_16x16x32_bf16 v[104:107], v[8:11], a[248:251], v[104:107]
    v_mfma_f32_16x16x32_bf16 v[108:111], v[8:11], a[252:255], v[108:111]
    ds_read_b128 v[136:139], v5 offset:768
    ds_read_b128 v[140:143], v5 offset:832
    s_waitcnt lgkmcnt(5)
    v_mfma_f32_16x16x32_bf16 v[112:115], v[12:15], a[240:243], v[112:115]
    ds_read_b128 v[28:31], v4 offset:35840
    v_mfma_f32_16x16x32_bf16 v[116:119], v[12:15], a[244:247], v[116:119]
    v_mfma_f32_16x16x32_bf16 v[120:123], v[12:15], a[248:251], v[120:123]
    v_mfma_f32_16x16x32_bf16 v[124:127], v[12:15], a[252:255], v[124:127]
    s_waitcnt lgkmcnt(5)
    v_mfma_f32_16x16x32_bf16 v[96:99], v[16:19], v[32:35], v[96:99]
    s_barrier
    v_mfma_f32_16x16x32_bf16 v[100:103], v[16:19], v[36:39], v[100:103]
    v_add_u32 v4, 0x9000, v4
    ds_read_b128 v[8:11], v4 offset:0
    v_mfma_f32_16x16x32_bf16 v[104:107], v[16:19], v[40:43], v[104:107]
    s_add_u32 m0, s49, 36864
    s_add_u32 s61, s48, 331776
    v_mfma_f32_16x16x32_bf16 v[108:111], v[16:19], v[44:47], v[108:111]
    buffer_load_dwordx4 v2, s[4:7], s61 offen offset:0 lds
    s_waitcnt lgkmcnt(5)
    v_mfma_f32_16x16x32_bf16 v[112:115], v[20:23], v[32:35], v[112:115]
    ds_read_b128 v[12:15], v4 offset:1024
    v_mfma_f32_16x16x32_bf16 v[116:119], v[20:23], v[36:39], v[116:119]
    v_mfma_f32_16x16x32_bf16 v[120:123], v[20:23], v[40:43], v[120:123]
    v_mfma_f32_16x16x32_bf16 v[124:127], v[20:23], v[44:47], v[124:127]
    buffer_load_dwordx4 v2, s[4:7], s61 offen offset:1024 lds
    s_waitcnt lgkmcnt(5)
    v_mfma_f32_16x16x32_bf16 v[96:99], v[24:27], v[48:51], v[96:99]
    ds_read_b128 v[16:19], v4 offset:2048
    v_mfma_f32_16x16x32_bf16 v[100:103], v[24:27], v[52:55], v[100:103]
    v_mfma_f32_16x16x32_bf16 v[104:107], v[24:27], v[56:59], v[104:107]
    v_mfma_f32_16x16x32_bf16 v[108:111], v[24:27], v[60:63], v[108:111]
    buffer_load_dwordx4 v2, s[4:7], s61 offen offset:2048 lds
    s_waitcnt lgkmcnt(3)
    v_mfma_f32_16x16x32_bf16 v[112:115], v[28:31], v[48:51], v[112:115]
    ds_read_b128 v[20:23], v4 offset:3072
    v_mfma_f32_16x16x32_bf16 v[116:119], v[28:31], v[52:55], v[116:119]
    v_mfma_f32_16x16x32_bf16 v[120:123], v[28:31], v[56:59], v[120:123]
    v_mfma_f32_16x16x32_bf16 v[124:127], v[28:31], v[60:63], v[124:127]
    buffer_load_dwordx4 v2, s[4:7], s61 offen offset:3072 lds
    s_add_u32 m0, s49, 40960
    s_waitcnt lgkmcnt(3)
    v_mfma_f32_16x16x32_bf16 v[64:67], v[8:11], a[0:3], 0
    ds_read_b128 v[24:27], v4 offset:4096
    s_add_u32 s61, s48, 335872
    v_mfma_f32_16x16x32_bf16 v[68:71], v[8:11], a[4:7], 0
    v_mfma_f32_16x16x32_bf16 v[72:75], v[8:11], a[8:11], 0
    v_mfma_f32_16x16x32_bf16 v[76:79], v[8:11], a[12:15], 0
    buffer_load_dwordx4 v2, s[4:7], s61 offen offset:0 lds
    s_waitcnt lgkmcnt(3)
    v_mfma_f32_16x16x32_bf16 v[80:83], v[12:15], a[0:3], 0
    ds_read_b128 v[28:31], v4 offset:5120
    v_mfma_f32_16x16x32_bf16 v[84:87], v[12:15], a[4:7], 0
    v_fmac_f32 v96, v136, v128
    v_fmac_f32 v97, v137, v128
    v_mfma_f32_16x16x32_bf16 v[88:91], v[12:15], a[8:11], 0
    v_fmac_f32 v98, v138, v128
    v_fmac_f32 v99, v139, v128
    v_mfma_f32_16x16x32_bf16 v[92:95], v[12:15], a[12:15], 0
    buffer_load_dwordx4 v2, s[4:7], s61 offen offset:1024 lds
    v_fmac_f32 v112, v140, v128
    s_waitcnt lgkmcnt(3)
    v_mfma_f32_16x16x32_bf16 v[64:67], v[16:19], a[16:19], v[64:67]
    ds_read_b128 v[8:11], v4 offset:6144
    v_fmac_f32 v113, v141, v128
    v_mfma_f32_16x16x32_bf16 v[68:71], v[16:19], a[20:23], v[68:71]
    v_fmac_f32 v114, v142, v128
    v_fmac_f32 v115, v143, v128
    v_mfma_f32_16x16x32_bf16 v[72:75], v[16:19], a[24:27], v[72:75]
    v_mul_f32 v96, v96, v132
    v_mul_f32 v97, v97, v132
    v_mfma_f32_16x16x32_bf16 v[76:79], v[16:19], a[28:31], v[76:79]
    buffer_load_dwordx4 v2, s[4:7], s61 offen offset:2048 lds
    v_mul_f32 v98, v98, v132
    s_waitcnt lgkmcnt(3)
    v_mfma_f32_16x16x32_bf16 v[80:83], v[20:23], a[16:19], v[80:83]
    ds_read_b128 v[12:15], v4 offset:7168
    v_mul_f32 v99, v99, v132
    v_mfma_f32_16x16x32_bf16 v[84:87], v[20:23], a[20:23], v[84:87]
    v_mul_f32 v96, v96, v112
    v_mul_f32 v97, v97, v113
    v_mfma_f32_16x16x32_bf16 v[88:91], v[20:23], a[24:27], v[88:91]
    v_mul_f32 v98, v98, v114
    v_mul_f32 v99, v99, v115
    v_mfma_f32_16x16x32_bf16 v[92:95], v[20:23], a[28:31], v[92:95]
    buffer_load_dwordx4 v2, s[4:7], s61 offen offset:3072 lds
    s_add_u32 m0, s49, 45056
    s_waitcnt lgkmcnt(3)
    v_mfma_f32_16x16x32_bf16 v[64:67], v[24:27], a[32:35], v[64:67]
    ds_read_b128 v[16:19], v4 offset:8192
    s_add_u32 s61, s48, 339968
    v_mfma_f32_16x16x32_bf16 v[68:71], v[24:27], a[36:39], v[68:71]
    v_cvt_pk_bf16_f32 v210, v96, v97
    v_cvt_pk_bf16_f32 v211, v98, v99
    v_mfma_f32_16x16x32_bf16 v[72:75], v[24:27], a[40:43], v[72:75]
    s_add_u32 s66, s51, 32768
    v_mfma_f32_16x16x32_bf16 v[76:79], v[24:27], a[44:47], v[76:79]
    buffer_load_dwordx4 v2, s[4:7], s61 offen offset:0 lds
    s_waitcnt lgkmcnt(3)
    v_mfma_f32_16x16x32_bf16 v[80:83], v[28:31], a[32:35], v[80:83]
    ds_read_b128 v[20:23], v4 offset:9216
    v_mfma_f32_16x16x32_bf16 v[84:87], v[28:31], a[36:39], v[84:87]
    v_mfma_f32_16x16x32_bf16 v[88:91], v[28:31], a[40:43], v[88:91]
    v_mfma_f32_16x16x32_bf16 v[92:95], v[28:31], a[44:47], v[92:95]
    buffer_store_dwordx4 v[208:211], v2, s[4:7], s66 offen offset:0 sc1
    v_fmac_f32 v100, v136, v129
    s_waitcnt lgkmcnt(3)
    v_mfma_f32_16x16x32_bf16 v[64:67], v[8:11], a[48:51], v[64:67]
    ds_read_b128 v[24:27], v4 offset:10240
    v_fmac_f32 v101, v137, v129
    v_mfma_f32_16x16x32_bf16 v[68:71], v[8:11], a[52:55], v[68:71]
    v_fmac_f32 v102, v138, v129
    v_fmac_f32 v103, v139, v129
    v_mfma_f32_16x16x32_bf16 v[72:75], v[8:11], a[56:59], v[72:75]
    v_fmac_f32 v116, v140, v129
    v_fmac_f32 v117, v141, v129
    v_mfma_f32_16x16x32_bf16 v[76:79], v[8:11], a[60:63], v[76:79]
    v_fmac_f32 v118, v142, v129
    v_fmac_f32 v119, v143, v129
    s_waitcnt lgkmcnt(3)
    v_mfma_f32_16x16x32_bf16 v[80:83], v[12:15], a[48:51], v[80:83]
    ds_read_b128 v[28:31], v4 offset:11264
    v_mul_f32 v100, v100, v133
    v_mfma_f32_16x16x32_bf16 v[84:87], v[12:15], a[52:55], v[84:87]
    v_mul_f32 v101, v101, v133
    v_mul_f32 v102, v102, v133
    v_mfma_f32_16x16x32_bf16 v[88:91], v[12:15], a[56:59], v[88:91]
    v_mul_f32 v103, v103, v133
    v_mul_f32 v100, v100, v116
    v_mfma_f32_16x16x32_bf16 v[92:95], v[12:15], a[60:63], v[92:95]
    v_mul_f32 v101, v101, v117
    v_mul_f32 v102, v102, v118
    s_waitcnt lgkmcnt(3)
    v_mfma_f32_16x16x32_bf16 v[64:67], v[16:19], a[64:67], v[64:67]
    ds_read_b128 v[8:11], v4 offset:12288
    v_mul_f32 v103, v103, v119
    v_mfma_f32_16x16x32_bf16 v[68:71], v[16:19], a[68:71], v[68:71]
    v_cvt_pk_bf16_f32 v214, v100, v101
    v_cvt_pk_bf16_f32 v215, v102, v103
    v_mfma_f32_16x16x32_bf16 v[72:75], v[16:19], a[72:75], v[72:75]
    buffer_store_dwordx4 v[212:215], v2, s[4:7], s66 offen offset:1024 sc1
    v_fmac_f32 v104, v136, v130
    v_mfma_f32_16x16x32_bf16 v[76:79], v[16:19], a[76:79], v[76:79]
    v_fmac_f32 v105, v137, v130
    v_fmac_f32 v106, v138, v130
    s_waitcnt lgkmcnt(3)
    v_mfma_f32_16x16x32_bf16 v[80:83], v[20:23], a[64:67], v[80:83]
    ds_read_b128 v[12:15], v4 offset:13312
    v_fmac_f32 v107, v139, v130
    v_mfma_f32_16x16x32_bf16 v[84:87], v[20:23], a[68:71], v[84:87]
    v_fmac_f32 v120, v140, v130
    v_fmac_f32 v121, v141, v130
    v_mfma_f32_16x16x32_bf16 v[88:91], v[20:23], a[72:75], v[88:91]
    v_fmac_f32 v122, v142, v130
    v_fmac_f32 v123, v143, v130
    v_mfma_f32_16x16x32_bf16 v[92:95], v[20:23], a[76:79], v[92:95]
    v_mul_f32 v104, v104, v134
    v_mul_f32 v105, v105, v134
    s_waitcnt lgkmcnt(3)
    v_mfma_f32_16x16x32_bf16 v[64:67], v[24:27], a[80:83], v[64:67]
    ds_read_b128 v[16:19], v4 offset:14336
    v_mul_f32 v106, v106, v134
    v_mfma_f32_16x16x32_bf16 v[68:71], v[24:27], a[84:87], v[68:71]
    v_mul_f32 v107, v107, v134
    v_mul_f32 v104, v104, v120
    v_mfma_f32_16x16x32_bf16 v[72:75], v[24:27], a[88:91], v[72:75]
    v_mul_f32 v105, v105, v121
    v_mul_f32 v106, v106, v122
    v_mfma_f32_16x16x32_bf16 v[76:79], v[24:27], a[92:95], v[76:79]
    v_mul_f32 v107, v107, v123
    v_cvt_pk_bf16_f32 v218, v104, v105
    s_waitcnt lgkmcnt(3)
    v_mfma_f32_16x16x32_bf16 v[80:83], v[28:31], a[80:83], v[80:83]
    ds_read_b128 v[20:23], v4 offset:15360
    v_cvt_pk_bf16_f32 v219, v106, v107
    v_mfma_f32_16x16x32_bf16 v[84:87], v[28:31], a[84:87], v[84:87]
    buffer_store_dwordx4 v[216:219], v2, s[4:7], s66 offen offset:2048 sc1
    v_fmac_f32 v108, v136, v131
    v_mfma_f32_16x16x32_bf16 v[88:91], v[28:31], a[88:91], v[88:91]
    v_fmac_f32 v109, v137, v131
    v_fmac_f32 v110, v138, v131
    v_mfma_f32_16x16x32_bf16 v[92:95], v[28:31], a[92:95], v[92:95]
    v_fmac_f32 v111, v139, v131
    v_fmac_f32 v124, v140, v131
    s_waitcnt lgkmcnt(3)
    v_mfma_f32_16x16x32_bf16 v[64:67], v[8:11], a[96:99], v[64:67]
    ds_read_b128 v[24:27], v4 offset:16384
    v_fmac_f32 v125, v141, v131
    v_mfma_f32_16x16x32_bf16 v[68:71], v[8:11], a[100:103], v[68:71]
    v_fmac_f32 v126, v142, v131
    v_fmac_f32 v127, v143, v131
    v_mfma_f32_16x16x32_bf16 v[72:75], v[8:11], a[104:107], v[72:75]
    v_mul_f32 v108, v108, v135
    v_mul_f32 v109, v109, v135
    v_mfma_f32_16x16x32_bf16 v[76:79], v[8:11], a[108:111], v[76:79]
    v_mul_f32 v110, v110, v135
    v_mul_f32 v111, v111, v135
    s_waitcnt lgkmcnt(3)
    v_mfma_f32_16x16x32_bf16 v[80:83], v[12:15], a[96:99], v[80:83]
    ds_read_b128 v[28:31], v4 offset:17408
    v_mul_f32 v108, v108, v124
    v_mfma_f32_16x16x32_bf16 v[84:87], v[12:15], a[100:103], v[84:87]
    v_mul_f32 v109, v109, v125
    v_mul_f32 v110, v110, v126
    v_mfma_f32_16x16x32_bf16 v[88:91], v[12:15], a[104:107], v[88:91]
    v_mul_f32 v111, v111, v127
    v_cvt_pk_bf16_f32 v222, v108, v109
    v_mfma_f32_16x16x32_bf16 v[92:95], v[12:15], a[108:111], v[92:95]
    v_cvt_pk_bf16_f32 v223, v110, v111
    buffer_store_dwordx4 v[220:223], v2, s[4:7], s66 offen offset:3072 sc1
    s_waitcnt lgkmcnt(3)
    v_mfma_f32_16x16x32_bf16 v[64:67], v[16:19], a[112:115], v[64:67]
    ds_read_b128 v[8:11], v4 offset:18432
    v_mfma_f32_16x16x32_bf16 v[68:71], v[16:19], a[116:119], v[68:71]
    v_mfma_f32_16x16x32_bf16 v[72:75], v[16:19], a[120:123], v[72:75]
    v_mfma_f32_16x16x32_bf16 v[76:79], v[16:19], a[124:127], v[76:79]
    s_waitcnt lgkmcnt(3)
    v_mfma_f32_16x16x32_bf16 v[80:83], v[20:23], a[112:115], v[80:83]
    ds_read_b128 v[12:15], v4 offset:19456
    v_mfma_f32_16x16x32_bf16 v[84:87], v[20:23], a[116:119], v[84:87]
    v_mfma_f32_16x16x32_bf16 v[88:91], v[20:23], a[120:123], v[88:91]
    v_mfma_f32_16x16x32_bf16 v[92:95], v[20:23], a[124:127], v[92:95]
    v_and_b32 v0, 3, v1
    v_lshlrev_b32 v0, 3, v0
    s_waitcnt lgkmcnt(3)
    v_mfma_f32_16x16x32_bf16 v[64:67], v[24:27], a[128:131], v[64:67]
    ds_read_b128 v[16:19], v4 offset:20480
    s_mov_b32 s55, s52
    v_mfma_f32_16x16x32_bf16 v[68:71], v[24:27], a[132:135], v[68:71]
    v_mfma_f32_16x16x32_bf16 v[72:75], v[24:27], a[136:139], v[72:75]
    v_mfma_f32_16x16x32_bf16 v[76:79], v[24:27], a[140:143], v[76:79]
    s_waitcnt lgkmcnt(3)
    v_mfma_f32_16x16x32_bf16 v[80:83], v[28:31], a[128:131], v[80:83]
    ds_read_b128 v[20:23], v4 offset:21504
    v_mfma_f32_16x16x32_bf16 v[84:87], v[28:31], a[132:135], v[84:87]
    v_mfma_f32_16x16x32_bf16 v[88:91], v[28:31], a[136:139], v[88:91]
    v_mfma_f32_16x16x32_bf16 v[92:95], v[28:31], a[140:143], v[92:95]
    s_waitcnt lgkmcnt(3)
    v_mfma_f32_16x16x32_bf16 v[64:67], v[8:11], a[144:147], v[64:67]
    ds_read_b128 v[24:27], v4 offset:22528
    v_mfma_f32_16x16x32_bf16 v[68:71], v[8:11], a[148:151], v[68:71]
    v_mfma_f32_16x16x32_bf16 v[72:75], v[8:11], a[152:155], v[72:75]
    v_mfma_f32_16x16x32_bf16 v[76:79], v[8:11], a[156:159], v[76:79]
    s_waitcnt lgkmcnt(3)
    v_mfma_f32_16x16x32_bf16 v[80:83], v[12:15], a[144:147], v[80:83]
    ds_read_b128 v[28:31], v4 offset:23552
    v_mfma_f32_16x16x32_bf16 v[84:87], v[12:15], a[148:151], v[84:87]
    v_mfma_f32_16x16x32_bf16 v[88:91], v[12:15], a[152:155], v[88:91]
    v_mfma_f32_16x16x32_bf16 v[92:95], v[12:15], a[156:159], v[92:95]
    s_waitcnt lgkmcnt(3)
    v_mfma_f32_16x16x32_bf16 v[64:67], v[16:19], a[160:163], v[64:67]
    ds_read_b128 v[8:11], v4 offset:24576
    v_mfma_f32_16x16x32_bf16 v[68:71], v[16:19], a[164:167], v[68:71]
    v_mfma_f32_16x16x32_bf16 v[72:75], v[16:19], a[168:171], v[72:75]
    v_mfma_f32_16x16x32_bf16 v[76:79], v[16:19], a[172:175], v[76:79]
    buffer_load_dwordx2 v[6:7], v0, s[4:7], s55 offen sc1
    s_waitcnt lgkmcnt(3)
    v_mfma_f32_16x16x32_bf16 v[80:83], v[20:23], a[160:163], v[80:83]
    ds_read_b128 v[12:15], v4 offset:25600
    v_mfma_f32_16x16x32_bf16 v[84:87], v[20:23], a[164:167], v[84:87]
    v_mfma_f32_16x16x32_bf16 v[88:91], v[20:23], a[168:171], v[88:91]
    v_mfma_f32_16x16x32_bf16 v[92:95], v[20:23], a[172:175], v[92:95]
    s_waitcnt lgkmcnt(3)
    v_mfma_f32_16x16x32_bf16 v[64:67], v[24:27], a[176:179], v[64:67]
    ds_read_b128 v[16:19], v4 offset:26624
    v_mfma_f32_16x16x32_bf16 v[68:71], v[24:27], a[180:183], v[68:71]
    v_mfma_f32_16x16x32_bf16 v[72:75], v[24:27], a[184:187], v[72:75]
    v_mfma_f32_16x16x32_bf16 v[76:79], v[24:27], a[188:191], v[76:79]
    s_waitcnt lgkmcnt(3)
    v_mfma_f32_16x16x32_bf16 v[80:83], v[28:31], a[176:179], v[80:83]
    ds_read_b128 v[20:23], v4 offset:27648
    v_mfma_f32_16x16x32_bf16 v[84:87], v[28:31], a[180:183], v[84:87]
    v_mfma_f32_16x16x32_bf16 v[88:91], v[28:31], a[184:187], v[88:91]
    v_mfma_f32_16x16x32_bf16 v[92:95], v[28:31], a[188:191], v[92:95]
    s_waitcnt lgkmcnt(3)
    v_mfma_f32_16x16x32_bf16 v[64:67], v[8:11], a[192:195], v[64:67]
    ds_read_b128 v[24:27], v4 offset:28672
    v_mfma_f32_16x16x32_bf16 v[68:71], v[8:11], a[196:199], v[68:71]
    v_mfma_f32_16x16x32_bf16 v[72:75], v[8:11], a[200:203], v[72:75]
    v_mfma_f32_16x16x32_bf16 v[76:79], v[8:11], a[204:207], v[76:79]
    s_waitcnt lgkmcnt(3)
    v_mfma_f32_16x16x32_bf16 v[80:83], v[12:15], a[192:195], v[80:83]
    ds_read_b128 v[28:31], v4 offset:29696
    v_mfma_f32_16x16x32_bf16 v[84:87], v[12:15], a[196:199], v[84:87]
    v_mfma_f32_16x16x32_bf16 v[88:91], v[12:15], a[200:203], v[88:91]
    v_mfma_f32_16x16x32_bf16 v[92:95], v[12:15], a[204:207], v[92:95]
    s_waitcnt lgkmcnt(3)
    v_mfma_f32_16x16x32_bf16 v[64:67], v[16:19], a[208:211], v[64:67]
    ds_read_b128 v[8:11], v4 offset:30720
    v_mfma_f32_16x16x32_bf16 v[68:71], v[16:19], a[212:215], v[68:71]
    v_mfma_f32_16x16x32_bf16 v[72:75], v[16:19], a[216:219], v[72:75]
    v_mfma_f32_16x16x32_bf16 v[76:79], v[16:19], a[220:223], v[76:79]
    s_waitcnt lgkmcnt(3)
    v_mfma_f32_16x16x32_bf16 v[80:83], v[20:23], a[208:211], v[80:83]
    ds_read_b128 v[12:15], v4 offset:31744
    v_mfma_f32_16x16x32_bf16 v[84:87], v[20:23], a[212:215], v[84:87]
    v_mfma_f32_16x16x32_bf16 v[88:91], v[20:23], a[216:219], v[88:91]
    v_mfma_f32_16x16x32_bf16 v[92:95], v[20:23], a[220:223], v[92:95]
    s_waitcnt lgkmcnt(3)
    v_mfma_f32_16x16x32_bf16 v[64:67], v[24:27], a[224:227], v[64:67]
    ds_read_b128 v[16:19], v4 offset:32768
    v_mfma_f32_16x16x32_bf16 v[68:71], v[24:27], a[228:231], v[68:71]
    v_mfma_f32_16x16x32_bf16 v[72:75], v[24:27], a[232:235], v[72:75]
    v_mfma_f32_16x16x32_bf16 v[76:79], v[24:27], a[236:239], v[76:79]
    s_waitcnt lgkmcnt(3)
    v_mfma_f32_16x16x32_bf16 v[80:83], v[28:31], a[224:227], v[80:83]
    ds_read_b128 v[20:23], v4 offset:33792
    v_mfma_f32_16x16x32_bf16 v[84:87], v[28:31], a[228:231], v[84:87]
    v_mfma_f32_16x16x32_bf16 v[88:91], v[28:31], a[232:235], v[88:91]
    v_mfma_f32_16x16x32_bf16 v[92:95], v[28:31], a[236:239], v[92:95]
    s_waitcnt lgkmcnt(3)
    v_mfma_f32_16x16x32_bf16 v[64:67], v[8:11], a[240:243], v[64:67]
    ds_read_b128 v[24:27], v4 offset:34816
    v_mfma_f32_16x16x32_bf16 v[68:71], v[8:11], a[244:247], v[68:71]
    v_mfma_f32_16x16x32_bf16 v[72:75], v[8:11], a[248:251], v[72:75]
    v_mfma_f32_16x16x32_bf16 v[76:79], v[8:11], a[252:255], v[76:79]
    s_waitcnt vmcnt(0)
    v_cmp_eq_u64 vcc, s[98:99], v[6:7]
    s_nop 0
    s_cmp_eq_u64 vcc, exec
    s_cbranch_scc0 L_p0_slow_66
L_p0_back_67:
    s_waitcnt lgkmcnt(3)
    v_mfma_f32_16x16x32_bf16 v[80:83], v[12:15], a[240:243], v[80:83]
    ds_read_b128 v[28:31], v4 offset:35840
    ds_read_b128 v[144:147], v5 offset:896
    v_mfma_f32_16x16x32_bf16 v[84:87], v[12:15], a[244:247], v[84:87]
    s_add_u32 s60, s56, s65
    buffer_load_dwordx2 v[242:243], v3, s[4:7], s60 offen offset:0 sc1
    v_mfma_f32_16x16x32_bf16 v[88:91], v[12:15], a[248:251], v[88:91]
    ds_read_b128 v[148:151], v5 offset:960
    v_mfma_f32_16x16x32_bf16 v[92:95], v[12:15], a[252:255], v[92:95]
    s_waitcnt lgkmcnt(5)
    v_mfma_f32_16x16x32_bf16 v[64:67], v[16:19], v[32:35], v[64:67]
    s_barrier
    v_mfma_f32_16x16x32_bf16 v[68:71], v[16:19], v[36:39], v[68:71]
    v_add_u32 v4, 0xfffe5000, v4
    ds_read_b128 v[8:11], v4 offset:0
    v_mfma_f32_16x16x32_bf16 v[72:75], v[16:19], v[40:43], v[72:75]
    s_add_u32 m0, s49, 73728
    s_add_u32 s61, s48, 368640
    v_mfma_f32_16x16x32_bf16 v[76:79], v[16:19], v[44:47], v[76:79]
    buffer_load_dwordx4 v2, s[4:7], s61 offen offset:0 lds
    s_waitcnt lgkmcnt(5)
    v_mfma_f32_16x16x32_bf16 v[80:83], v[20:23], v[32:35], v[80:83]
    ds_read_b128 v[12:15], v4 offset:1024
    v_mfma_f32_16x16x32_bf16 v[84:87], v[20:23], v[36:39], v[84:87]
    v_mfma_f32_16x16x32_bf16 v[88:91], v[20:23], v[40:43], v[88:91]
    v_mfma_f32_16x16x32_bf16 v[92:95], v[20:23], v[44:47], v[92:95]
    buffer_load_dwordx4 v2, s[4:7], s61 offen offset:1024 lds
    s_waitcnt lgkmcnt(5)
    v_mfma_f32_16x16x32_bf16 v[64:67], v[24:27], v[48:51], v[64:67]
    ds_read_b128 v[16:19], v4 offset:2048
    v_mfma_f32_16x16x32_bf16 v[68:71], v[24:27], v[52:55], v[68:71]
    s_add_u32 s71, s67, 32
    v_mov_b32 v6, s98
    v_mfma_f32_16x16x32_bf16 v[72:75], v[24:27], v[56:59], v[72:75]
    v_mov_b32 v7, s99
    v_mfma_f32_16x16x32_bf16 v[76:79], v[24:27], v[60:63], v[76:79]
    buffer_load_dwordx4 v2, s[4:7], s61 offen offset:2048 lds
    s_waitcnt lgkmcnt(5)
    v_mfma_f32_16x16x32_bf16 v[80:83], v[28:31], v[48:51], v[80:83]
    ds_read_b128 v[20:23], v4 offset:3072
    v_mfma_f32_16x16x32_bf16 v[84:87], v[28:31], v[52:55], v[84:87]
    v_mfma_f32_16x16x32_bf16 v[88:91], v[28:31], v[56:59], v[88:91]
    s_mov_b64 exec, 1
    buffer_store_dwordx2 v[6:7], off, s[4:7], s71 sc1
    s_mov_b64 exec, -1
    v_mfma_f32_16x16x32_bf16 v[92:95], v[28:31], v[60:63], v[92:95]
    s_waitcnt lgkmcnt(3)
    v_mfma_f32_16x16x32_bf16 v[96:99], v[8:11], a[0:3], 0
    ds_read_b128 v[24:27], v4 offset:4096
    v_mfma_f32_16x16x32_bf16 v[100:103], v[8:11], a[4:7], 0
    v_mfma_f32_16x16x32_bf16 v[104:107], v[8:11], a[8:11], 0
    buffer_load_dwordx4 v2, s[4:7], s61 offen offset:3072 lds
    s_add_u32 m0, s49, 77824
    v_mfma_f32_16x16x32_bf16 v[108:111], v[8:11], a[12:15], 0
    s_add_u32 s61, s48, 372736
    s_waitcnt lgkmcnt(3)
    v_mfma_f32_16x16x32_bf16 v[112:115], v[12:15], a[0:3], 0
    ds_read_b128 v[28:31], v4 offset:5120
    v_mfma_f32_16x16x32_bf16 v[116:119], v[12:15], a[4:7], 0
    v_fmac_f32 v64, v144, v128
    v_fmac_f32 v65, v145, v128
    v_mfma_f32_16x16x32_bf16 v[120:123], v[12:15], a[8:11], 0
    buffer_load_dwordx4 v2, s[4:7], s61 offen offset:0 lds
    v_fmac_f32 v66, v146, v128
    v_mfma_f32_16x16x32_bf16 v[124:127], v[12:15], a[12:15], 0
    v_fmac_f32 v67, v147, v128
    v_fmac_f32 v80, v148, v128
    s_waitcnt lgkmcnt(3)
    v_mfma_f32_16x16x32_bf16 v[96:99], v[16:19], a[16:19], v[96:99]
    ds_read_b128 v[8:11], v4 offset:6144
    v_fmac_f32 v81, v149, v128
    v_mfma_f32_16x16x32_bf16 v[100:103], v[16:19], a[20:23], v[100:103]
    v_fmac_f32 v82, v150, v128
    v_fmac_f32 v83, v151, v128
    v_mfma_f32_16x16x32_bf16 v[104:107], v[16:19], a[24:27], v[104:107]
    buffer_load_dwordx4 v2, s[4:7], s61 offen offset:1024 lds
    v_mul_f32 v64, v64, v132
    v_mfma_f32_16x16x32_bf16 v[108:111], v[16:19], a[28:31], v[108:111]
    v_mul_f32 v65, v65, v132
    v_mul_f32 v66, v66, v132
    s_waitcnt lgkmcnt(3)
    v_mfma_f32_16x16x32_bf16 v[112:115], v[20:23], a[16:19], v[112:115]
    ds_read_b128 v[12:15], v4 offset:7168
    v_mul_f32 v67, v67, v132
    v_mfma_f32_16x16x32_bf16 v[116:119], v[20:23], a[20:23], v[116:119]
    v_mul_f32 v64, v64, v80
    v_mul_f32 v65, v65, v81
    v_mfma_f32_16x16x32_bf16 v[120:123], v[20:23], a[24:27], v[120:123]
    buffer_load_dwordx4 v2, s[4:7], s61 offen offset:2048 lds
    v_mul_f32 v66, v66, v82
    v_mfma_f32_16x16x32_bf16 v[124:127], v[20:23], a[28:31], v[124:127]
    v_mul_f32 v67, v67, v83
    v_cvt_pk_bf16_f32 v224, v64, v65
    s_waitcnt lgkmcnt(3)
    v_mfma_f32_16x16x32_bf16 v[96:99], v[24:27], a[32:35], v[96:99]
    ds_read_b128 v[16:19], v4 offset:8192
    v_cvt_pk_bf16_f32 v225, v66, v67
    v_mfma_f32_16x16x32_bf16 v[100:103], v[24:27], a[36:39], v[100:103]
    v_fmac_f32 v68, v144, v129
    v_fmac_f32 v69, v145, v129
    v_mfma_f32_16x16x32_bf16 v[104:107], v[24:27], a[40:43], v[104:107]
    buffer_load_dwordx4 v2, s[4:7], s61 offen offset:3072 lds
    s_add_u32 m0, s49, 81920
    v_mfma_f32_16x16x32_bf16 v[108:111], v[24:27], a[44:47], v[108:111]
    s_add_u32 s61, s48, 376832
    v_fmac_f32 v70, v146, v129
    s_waitcnt lgkmcnt(3)
    v_mfma_f32_16x16x32_bf16 v[112:115], v[28:31], a[32:35], v[112:115]
    ds_read_b128 v[20:23], v4 offset:9216
    v_fmac_f32 v71, v147, v129
    v_mfma_f32_16x16x32_bf16 v[116:119], v[28:31], a[36:39], v[116:119]
    v_fmac_f32 v84, v148, v129
    v_fmac_f32 v85, v149, v129
    v_mfma_f32_16x16x32_bf16 v[120:123], v[28:31], a[40:43], v[120:123]
    buffer_load_dwordx4 v2, s[4:7], s61 offen offset:0 lds
    v_fmac_f32 v86, v150, v129
    v_mfma_f32_16x16x32_bf16 v[124:127], v[28:31], a[44:47], v[124:127]
    v_fmac_f32 v87, v151, v129
    v_mul_f32 v68, v68, v133
    s_waitcnt lgkmcnt(3)
    v_mfma_f32_16x16x32_bf16 v[96:99], v[8:11], a[48:51], v[96:99]
    ds_read_b128 v[24:27], v4 offset:10240
    v_mul_f32 v69, v69, v133
    v_mfma_f32_16x16x32_bf16 v[100:103], v[8:11], a[52:55], v[100:103]
    v_mul_f32 v70, v70, v133
    v_mul_f32 v71, v71, v133
    v_mfma_f32_16x16x32_bf16 v[104:107], v[8:11], a[56:59], v[104:107]
    buffer_load_dwordx2 v[246:247], v3, s[4:7], s60 offen offset:512 sc1
    v_mul_f32 v68, v68, v84
    v_mfma_f32_16x16x32_bf16 v[108:111], v[8:11], a[60:63], v[108:111]
    v_mul_f32 v69, v69, v85
    v_mul_f32 v70, v70, v86
    s_waitcnt lgkmcnt(3)
    v_mfma_f32_16x16x32_bf16 v[112:115], v[12:15], a[48:51], v[112:115]
    ds_read_b128 v[28:31], v4 offset:11264
    v_mul_f32 v71, v71, v87
    v_mfma_f32_16x16x32_bf16 v[116:119], v[12:15], a[52:55], v[116:119]
    v_cvt_pk_bf16_f32 v228, v68, v69
    v_cvt_pk_bf16_f32 v229, v70, v71
    v_mfma_f32_16x16x32_bf16 v[120:123], v[12:15], a[56:59], v[120:123]
    buffer_load_dwordx2 v[250:251], v3, s[4:7], s60 offen offset:1024 sc1
    v_fmac_f32 v72, v144, v130
    v_mfma_f32_16x16x32_bf16 v[124:127], v[12:15], a[60:63], v[124:127]
    v_fmac_f32 v73, v145, v130
    v_fmac_f32 v74, v146, v130
    s_waitcnt lgkmcnt(3)
    v_mfma_f32_16x16x32_bf16 v[96:99], v[16:19], a[64:67], v[96:99]
    ds_read_b128 v[8:11], v4 offset:12288
    v_fmac_f32 v75, v147, v130
    v_mfma_f32_16x16x32_bf16 v[100:103], v[16:19], a[68:71], v[100:103]
    v_fmac_f32 v88, v148, v130
    v_fmac_f32 v89, v149, v130
    v_mfma_f32_16x16x32_bf16 v[104:107], v[16:19], a[72:75], v[104:107]
    buffer_load_dwordx2 v[254:255], v3, s[4:7], s60 offen offset:1536 sc1
    s_add_u32 s60, s57, s65
    v_mfma_f32_16x16x32_bf16 v[108:111], v[16:19], a[76:79], v[108:111]
    v_fmac_f32 v90, v150, v130
    v_fmac_f32 v91, v151, v130
    s_waitcnt lgkmcnt(3)
    v_mfma_f32_16x16x32_bf16 v[112:115], v[20:23], a[64:67], v[112:115]
    ds_read_b128 v[12:15], v4 offset:13312
    v_mul_f32 v72, v72, v134
    v_mfma_f32_16x16x32_bf16 v[116:119], v[20:23], a[68:71], v[116:119]
    v_mul_f32 v73, v73, v134
    v_mul_f32 v74, v74, v134
    v_mfma_f32_16x16x32_bf16 v[120:123], v[20:23], a[72:75], v[120:123]
    buffer_load_dwordx2 a[0:1], v3, s[4:7], s60 offen offset:0 sc1
    v_mul_f32 v75, v75, v134
    v_mfma_f32_16x16x32_bf16 v[124:127], v[20:23], a[76:79], v[124:127]
    v_mul_f32 v72, v72, v88
    v_mul_f32 v73, v73, v89
    s_waitcnt lgkmcnt(3)
    v_mfma_f32_16x16x32_bf16 v[96:99], v[24:27], a[80:83], v[96:99]
    ds_read_b128 v[16:19], v4 offset:14336
    v_mul_f32 v74, v74, v90
    v_mfma_f32_16x16x32_bf16 v[100:103], v[24:27], a[84:87], v[100:103]
    v_mul_f32 v75, v75, v91
    v_cvt_pk_bf16_f32 v232, v72, v73
    v_mfma_f32_16x16x32_bf16 v[104:107], v[24:27], a[88:91], v[104:107]
    buffer_load_dwordx2 a[4:5], v3, s[4:7], s60 offen offset:512 sc1
    v_cvt_pk_bf16_f32 v233, v74, v75
    v_mfma_f32_16x16x32_bf16 v[108:111], v[24:27], a[92:95], v[108:111]
    v_fmac_f32 v76, v144, v131
    v_fmac_f32 v77, v145, v131
    s_waitcnt lgkmcnt(3)
    v_mfma_f32_16x16x32_bf16 v[112:115], v[28:31], a[80:83], v[112:115]
    ds_read_b128 v[20:23], v4 offset:15360
    v_fmac_f32 v78, v146, v131
    v_mfma_f32_16x16x32_bf16 v[116:119], v[28:31], a[84:87], v[116:119]
    v_fmac_f32 v79, v147, v131
    v_fmac_f32 v92, v148, v131
    v_mfma_f32_16x16x32_bf16 v[120:123], v[28:31], a[88:91], v[120:123]
    buffer_load_dwordx2 a[8:9], v3, s[4:7], s60 offen offset:1024 sc1
    v_fmac_f32 v93, v149, v131
    v_mfma_f32_16x16x32_bf16 v[124:127], v[28:31], a[92:95], v[124:127]
    v_fmac_f32 v94, v150, v131
    v_fmac_f32 v95, v151, v131
    s_waitcnt lgkmcnt(3)
    v_mfma_f32_16x16x32_bf16 v[96:99], v[8:11], a[96:99], v[96:99]
    ds_read_b128 v[24:27], v4 offset:16384
    v_mul_f32 v76, v76, v135
    v_mfma_f32_16x16x32_bf16 v[100:103], v[8:11], a[100:103], v[100:103]
    v_mul_f32 v77, v77, v135
    v_mul_f32 v78, v78, v135
    v_mfma_f32_16x16x32_bf16 v[104:107], v[8:11], a[104:107], v[104:107]
    buffer_load_dwordx2 a[12:13], v3, s[4:7], s60 offen offset:1536 sc1
    s_add_u32 s60, s58, s65
    v_mfma_f32_16x16x32_bf16 v[108:111], v[8:11], a[108:111], v[108:111]
    v_mul_f32 v79, v79, v135
    v_mul_f32 v76, v76, v92
    s_waitcnt lgkmcnt(3)
    v_mfma_f32_16x16x32_bf16 v[112:115], v[12:15], a[96:99], v[112:115]
    ds_read_b128 v[28:31], v4 offset:17408
    v_mul_f32 v77, v77, v93
    v_mfma_f32_16x16x32_bf16 v[116:119], v[12:15], a[100:103], v[116:119]
    v_mul_f32 v78, v78, v94
    v_mul_f32 v79, v79, v95
    v_mfma_f32_16x16x32_bf16 v[120:123], v[12:15], a[104:107], v[120:123]
    buffer_load_dwordx2 a[2:3], v3, s[4:7], s60 offen offset:0 sc1
    v_cvt_pk_bf16_f32 v236, v76, v77
    v_mfma_f32_16x16x32_bf16 v[124:127], v[12:15], a[108:111], v[124:127]
    v_cvt_pk_bf16_f32 v237, v78, v79
    s_waitcnt lgkmcnt(3)
    v_mfma_f32_16x16x32_bf16 v[96:99], v[16:19], a[112:115], v[96:99]
    ds_read_b128 v[8:11], v4 offset:18432
    v_mfma_f32_16x16x32_bf16 v[100:103], v[16:19], a[116:119], v[100:103]
    v_mfma_f32_16x16x32_bf16 v[104:107], v[16:19], a[120:123], v[104:107]
    buffer_load_dwordx2 a[6:7], v3, s[4:7], s60 offen offset:512 sc1
    v_mfma_f32_16x16x32_bf16 v[108:111], v[16:19], a[124:127], v[108:111]
    s_waitcnt lgkmcnt(3)
    v_mfma_f32_16x16x32_bf16 v[112:115], v[20:23], a[112:115], v[112:115]
    ds_read_b128 v[12:15], v4 offset:19456
    v_mfma_f32_16x16x32_bf16 v[116:119], v[20:23], a[116:119], v[116:119]
    v_mfma_f32_16x16x32_bf16 v[120:123], v[20:23], a[120:123], v[120:123]
    buffer_load_dwordx2 a[10:11], v3, s[4:7], s60 offen offset:1024 sc1
    v_mfma_f32_16x16x32_bf16 v[124:127], v[20:23], a[124:127], v[124:127]
    s_waitcnt lgkmcnt(3)
    v_mfma_f32_16x16x32_bf16 v[96:99], v[24:27], a[128:131], v[96:99]
    ds_read_b128 v[16:19], v4 offset:20480
    v_mfma_f32_16x16x32_bf16 v[100:103], v[24:27], a[132:135], v[100:103]
    v_mfma_f32_16x16x32_bf16 v[104:107], v[24:27], a[136:139], v[104:107]
    buffer_load_dwordx2 a[14:15], v3, s[4:7], s60 offen offset:1536 sc1
    s_add_u32 s60, s56, 0
    v_mfma_f32_16x16x32_bf16 v[108:111], v[24:27], a[140:143], v[108:111]
    s_waitcnt lgkmcnt(3)
    v_mfma_f32_16x16x32_bf16 v[112:115], v[28:31], a[128:131], v[112:115]
    ds_read_b128 v[20:23], v4 offset:21504
    v_mfma_f32_16x16x32_bf16 v[116:119], v[28:31], a[132:135], v[116:119]
    v_mfma_f32_16x16x32_bf16 v[120:123], v[28:31], a[136:139], v[120:123]
    buffer_load_dwordx4 a[16:19], v2, s[4:7], s60 offen offset:0 sc1
    v_mfma_f32_16x16x32_bf16 v[124:127], v[28:31], a[140:143], v[124:127]
    s_waitcnt lgkmcnt(3)
    v_mfma_f32_16x16x32_bf16 v[96:99], v[8:11], a[144:147], v[96:99]
    ds_read_b128 v[24:27], v4 offset:22528
    v_mfma_f32_16x16x32_bf16 v[100:103], v[8:11], a[148:151], v[100:103]
    v_mfma_f32_16x16x32_bf16 v[104:107], v[8:11], a[152:155], v[104:107]
    buffer_load_dwordx4 a[20:23], v2, s[4:7], s60 offen offset:1024 sc1
    v_mfma_f32_16x16x32_bf16 v[108:111], v[8:11], a[156:159], v[108:111]
    s_waitcnt lgkmcnt(3)
    v_mfma_f32_16x16x32_bf16 v[112:115], v[12:15], a[144:147], v[112:115]
    ds_read_b128 v[28:31], v4 offset:23552
    v_mfma_f32_16x16x32_bf16 v[116:119], v[12:15], a[148:151], v[116:119]
    v_mfma_f32_16x16x32_bf16 v[120:123], v[12:15], a[152:155], v[120:123]
    buffer_load_dwordx4 a[24:27], v2, s[4:7], s60 offen offset:2048 sc1
    v_mfma_f32_16x16x32_bf16 v[124:127], v[12:15], a[156:159], v[124:127]
    s_waitcnt lgkmcnt(3)
    v_mfma_f32_16x16x32_bf16 v[96:99], v[16:19], a[160:163], v[96:99]
    ds_read_b128 v[8:11], v4 offset:24576
    v_mfma_f32_16x16x32_bf16 v[100:103], v[16:19], a[164:167], v[100:103]
    v_mfma_f32_16x16x32_bf16 v[104:107], v[16:19], a[168:171], v[104:107]
    buffer_load_dwordx4 a[28:31], v2, s[4:7], s60 offen offset:3072 sc1
    s_add_u32 s60, s57, 0
    v_mfma_f32_16x16x32_bf16 v[108:111], v[16:19], a[172:175], v[108:111]
    s_waitcnt lgkmcnt(3)
    v_mfma_f32_16x16x32_bf16 v[112:115], v[20:23], a[160:163], v[112:115]
    ds_read_b128 v[12:15], v4 offset:25600
    v_mfma_f32_16x16x32_bf16 v[116:119], v[20:23], a[164:167], v[116:119]
    v_mfma_f32_16x16x32_bf16 v[120:123], v[20:23], a[168:171], v[120:123]
    buffer_load_dwordx4 a[32:35], v2, s[4:7], s60 offen offset:0 sc1
    v_mfma_f32_16x16x32_bf16 v[124:127], v[20:23], a[172:175], v[124:127]
    s_waitcnt lgkmcnt(3)
    v_mfma_f32_16x16x32_bf16 v[96:99], v[24:27], a[176:179], v[96:99]
    ds_read_b128 v[16:19], v4 offset:26624
    v_mfma_f32_16x16x32_bf16 v[100:103], v[24:27], a[180:183], v[100:103]
    v_mfma_f32_16x16x32_bf16 v[104:107], v[24:27], a[184:187], v[104:107]
    buffer_load_dwordx4 a[36:39], v2, s[4:7], s60 offen offset:1024 sc1
    v_mfma_f32_16x16x32_bf16 v[108:111], v[24:27], a[188:191], v[108:111]
    s_waitcnt lgkmcnt(3)
    v_mfma_f32_16x16x32_bf16 v[112:115], v[28:31], a[176:179], v[112:115]
    ds_read_b128 v[20:23], v4 offset:27648
    v_mfma_f32_16x16x32_bf16 v[116:119], v[28:31], a[180:183], v[116:119]
    v_mfma_f32_16x16x32_bf16 v[120:123], v[28:31], a[184:187], v[120:123]
    buffer_load_dwordx4 a[40:43], v2, s[4:7], s60 offen offset:2048 sc1
    v_mfma_f32_16x16x32_bf16 v[124:127], v[28:31], a[188:191], v[124:127]
    s_waitcnt lgkmcnt(3)
    v_mfma_f32_16x16x32_bf16 v[96:99], v[8:11], a[192:195], v[96:99]
    ds_read_b128 v[24:27], v4 offset:28672
    v_mfma_f32_16x16x32_bf16 v[100:103], v[8:11], a[196:199], v[100:103]
    v_mfma_f32_16x16x32_bf16 v[104:107], v[8:11], a[200:203], v[104:107]
    buffer_load_dwordx4 a[44:47], v2, s[4:7], s60 offen offset:3072 sc1
    s_add_u32 s60, s58, 0
    v_mfma_f32_16x16x32_bf16 v[108:111], v[8:11], a[204:207], v[108:111]
    s_waitcnt lgkmcnt(3)
    v_mfma_f32_16x16x32_bf16 v[112:115], v[12:15], a[192:195], v[112:115]
    ds_read_b128 v[28:31], v4 offset:29696
    v_mfma_f32_16x16x32_bf16 v[116:119], v[12:15], a[196:199], v[116:119]
    v_mfma_f32_16x16x32_bf16 v[120:123], v[12:15], a[200:203], v[120:123]
    buffer_load_dwordx4 a[48:51], v2, s[4:7], s60 offen offset:0 sc1
    v_mfma_f32_16x16x32_bf16 v[124:127], v[12:15], a[204:207], v[124:127]
    s_waitcnt lgkmcnt(3)
    v_mfma_f32_16x16x32_bf16 v[96:99], v[16:19], a[208:211], v[96:99]
    ds_read_b128 v[8:11], v4 offset:30720
    v_mfma_f32_16x16x32_bf16 v[100:103], v[16:19], a[212:215], v[100:103]
    v_mfma_f32_16x16x32_bf16 v[104:107], v[16:19], a[216:219], v[104:107]
    buffer_load_dwordx4 a[52:55], v2, s[4:7], s60 offen offset:1024 sc1
    v_mfma_f32_16x16x32_bf16 v[108:111], v[16:19], a[220:223], v[108:111]
    s_waitcnt lgkmcnt(3)
    v_mfma_f32_16x16x32_bf16 v[112:115], v[20:23], a[208:211], v[112:115]
    ds_read_b128 v[12:15], v4 offset:31744
    v_mfma_f32_16x16x32_bf16 v[116:119], v[20:23], a[212:215], v[116:119]
    v_mfma_f32_16x16x32_bf16 v[120:123], v[20:23], a[216:219], v[120:123]
    buffer_load_dwordx4 a[56:59], v2, s[4:7], s60 offen offset:2048 sc1
    v_mfma_f32_16x16x32_bf16 v[124:127], v[20:23], a[220:223], v[124:127]
    s_waitcnt lgkmcnt(3)
    v_mfma_f32_16x16x32_bf16 v[96:99], v[24:27], a[224:227], v[96:99]
    ds_read_b128 v[16:19], v4 offset:32768
    v_mfma_f32_16x16x32_bf16 v[100:103], v[24:27], a[228:231], v[100:103]
    v_mfma_f32_16x16x32_bf16 v[104:107], v[24:27], a[232:235], v[104:107]
    buffer_load_dwordx4 a[60:63], v2, s[4:7], s60 offen offset:3072 sc1
    s_add_u32 s60, s56, 16384
    v_mfma_f32_16x16x32_bf16 v[108:111], v[24:27], a[236:239], v[108:111]
    s_waitcnt lgkmcnt(3)
    v_mfma_f32_16x16x32_bf16 v[112:115], v[28:31], a[224:227], v[112:115]
    ds_read_b128 v[20:23], v4 offset:33792
    v_mfma_f32_16x16x32_bf16 v[116:119], v[28:31], a[228:231], v[116:119]
    v_mfma_f32_16x16x32_bf16 v[120:123], v[28:31], a[232:235], v[120:123]
    buffer_load_dwordx4 a[64:67], v2, s[4:7], s60 offen offset:0 sc1
    v_mfma_f32_16x16x32_bf16 v[124:127], v[28:31], a[236:239], v[124:127]
    s_waitcnt lgkmcnt(3)
    v_mfma_f32_16x16x32_bf16 v[96:99], v[8:11], a[240:243], v[96:99]
    ds_read_b128 v[24:27], v4 offset:34816
    v_mfma_f32_16x16x32_bf16 v[100:103], v[8:11], a[244:247], v[100:103]
    v_mfma_f32_16x16x32_bf16 v[104:107], v[8:11], a[248:251], v[104:107]
    buffer_load_dwordx4 a[68:71], v2, s[4:7], s60 offen offset:1024 sc1
    v_mfma_f32_16x16x32_bf16 v[108:111], v[8:11], a[252:255], v[108:111]
    ds_read_b128 v[136:139], v5 offset:1024
    ds_read_b128 v[140:143], v5 offset:1088
    s_waitcnt lgkmcnt(5)
    v_mfma_f32_16x16x32_bf16 v[112:115], v[12:15], a[240:243], v[112:115]
    ds_read_b128 v[28:31], v4 offset:35840
    v_mfma_f32_16x16x32_bf16 v[116:119], v[12:15], a[244:247], v[116:119]
    v_mfma_f32_16x16x32_bf16 v[120:123], v[12:15], a[248:251], v[120:123]
    buffer_load_dwordx4 a[72:75], v2, s[4:7], s60 offen offset:2048 sc1
    v_mfma_f32_16x16x32_bf16 v[124:127], v[12:15], a[252:255], v[124:127]
    s_waitcnt lgkmcnt(5)
    v_mfma_f32_16x16x32_bf16 v[96:99], v[16:19], v[32:35], v[96:99]
    s_barrier
    v_mfma_f32_16x16x32_bf16 v[100:103], v[16:19], v[36:39], v[100:103]
    v_add_u32 v4, 0x9000, v4
    ds_read_b128 v[8:11], v4 offset:0
    v_mfma_f32_16x16x32_bf16 v[104:107], v[16:19], v[40:43], v[104:107]
    buffer_load_dwordx4 a[76:79], v2, s[4:7], s60 offen offset:3072 sc1
    s_add_u32 s60, s57, 16384
    v_mfma_f32_16x16x32_bf16 v[108:111], v[16:19], v[44:47], v[108:111]
    s_add_u32 m0, s49, 110592
    s_add_u32 s61, s48, 405504
    s_waitcnt lgkmcnt(5)
    v_mfma_f32_16x16x32_bf16 v[112:115], v[20:23], v[32:35], v[112:115]
    ds_read_b128 v[12:15], v4 offset:1024
    v_mfma_f32_16x16x32_bf16 v[116:119], v[20:23], v[36:39], v[116:119]
    v_mfma_f32_16x16x32_bf16 v[120:123], v[20:23], v[40:43], v[120:123]
    buffer_load_dwordx4 a[80:83], v2, s[4:7], s60 offen offset:0 sc1
    v_mfma_f32_16x16x32_bf16 v[124:127], v[20:23], v[44:47], v[124:127]
    s_waitcnt lgkmcnt(5)
    v_mfma_f32_16x16x32_bf16 v[96:99], v[24:27], v[48:51], v[96:99]
    ds_read_b128 v[16:19], v4 offset:2048
    v_mfma_f32_16x16x32_bf16 v[100:103], v[24:27], v[52:55], v[100:103]
    v_mfma_f32_16x16x32_bf16 v[104:107], v[24:27], v[56:59], v[104:107]
    buffer_load_dwordx4 a[84:87], v2, s[4:7], s60 offen offset:1024 sc1
    v_mfma_f32_16x16x32_bf16 v[108:111], v[24:27], v[60:63], v[108:111]
    s_waitcnt lgkmcnt(3)
    v_mfma_f32_16x16x32_bf16 v[112:115], v[28:31], v[48:51], v[112:115]
    ds_read_b128 v[20:23], v4 offset:3072
    v_mfma_f32_16x16x32_bf16 v[116:119], v[28:31], v[52:55], v[116:119]
    v_mfma_f32_16x16x32_bf16 v[120:123], v[28:31], v[56:59], v[120:123]
    buffer_load_dwordx4 a[88:91], v2, s[4:7], s60 offen offset:2048 sc1
    v_mfma_f32_16x16x32_bf16 v[124:127], v[28:31], v[60:63], v[124:127]
    s_waitcnt lgkmcnt(3)
    v_mfma_f32_16x16x32_bf16 v[32:35], v[8:11], v[176:179], 0
    ds_read_b128 v[24:27], v4 offset:4096
    v_mfma_f32_16x16x32_bf16 v[40:43], v[8:11], v[180:183], 0
    v_mfma_f32_16x16x32_bf16 v[48:51], v[8:11], v[184:187], 0
    buffer_load_dwordx4 a[92:95], v2, s[4:7], s60 offen offset:3072 sc1
    s_add_u32 s60, s58, 16384
    v_mfma_f32_16x16x32_bf16 v[56:59], v[8:11], v[188:191], 0
    s_waitcnt lgkmcnt(3)
    v_mfma_f32_16x16x32_bf16 v[36:39], v[12:15], v[176:179], 0
    ds_read_b128 v[28:31], v4 offset:5120
    v_mfma_f32_16x16x32_bf16 v[44:47], v[12:15], v[180:183], 0
    v_fmac_f32 v96, v136, v128
    v_fmac_f32 v97, v137, v128
    v_mfma_f32_16x16x32_bf16 v[52:55], v[12:15], v[184:187], 0
    buffer_load_dwordx4 a[96:99], v2, s[4:7], s60 offen offset:0 sc1
    v_fmac_f32 v98, v138, v128
    v_mfma_f32_16x16x32_bf16 v[60:63], v[12:15], v[188:191], 0
    v_fmac_f32 v99, v139, v128
    v_fmac_f32 v112, v140, v128
    s_waitcnt lgkmcnt(3)
    v_mfma_f32_16x16x32_bf16 v[64:67], v[16:19], v[176:179], 0
    ds_read_b128 v[8:11], v4 offset:6144
    v_fmac_f32 v113, v141, v128
    v_mfma_f32_16x16x32_bf16 v[72:75], v[16:19], v[180:183], 0
    v_fmac_f32 v114, v142, v128
    v_fmac_f32 v115, v143, v128
    v_mfma_f32_16x16x32_bf16 v[80:83], v[16:19], v[184:187], 0
    buffer_load_dwordx4 a[100:103], v2, s[4:7], s60 offen offset:1024 sc1
    v_mul_f32 v96, v96, v132
    v_mfma_f32_16x16x32_bf16 v[88:91], v[16:19], v[188:191], 0
    v_mul_f32 v97, v97, v132
    v_mul_f32 v98, v98, v132
    s_waitcnt lgkmcnt(3)
    v_mfma_f32_16x16x32_bf16 v[68:71], v[20:23], v[176:179], 0
    ds_read_b128 v[12:15], v4 offset:7168
    v_mul_f32 v99, v99, v132
    v_mfma_f32_16x16x32_bf16 v[76:79], v[20:23], v[180:183], 0
    v_mul_f32 v96, v96, v112
    v_mul_f32 v97, v97, v113
    v_mfma_f32_16x16x32_bf16 v[84:87], v[20:23], v[184:187], 0
    buffer_load_dwordx4 a[104:107], v2, s[4:7], s60 offen offset:2048 sc1
    v_mul_f32 v98, v98, v114
    v_mfma_f32_16x16x32_bf16 v[92:95], v[20:23], v[188:191], 0
    v_mul_f32 v99, v99, v115
    v_cvt_pk_bf16_f32 v226, v96, v97
    s_waitcnt lgkmcnt(3)
    v_mfma_f32_16x16x32_bf16 v[32:35], v[24:27], v[192:195], v[32:35]
    ds_read_b128 v[16:19], v4 offset:8192
    v_cvt_pk_bf16_f32 v227, v98, v99
    v_mfma_f32_16x16x32_bf16 v[40:43], v[24:27], v[196:199], v[40:43]
    s_add_u32 s66, s51, 49152
    v_mfma_f32_16x16x32_bf16 v[48:51], v[24:27], v[200:203], v[48:51]
    buffer_store_dwordx4 v[224:227], v2, s[4:7], s66 offen offset:0 sc1
    v_fmac_f32 v100, v136, v129
    v_mfma_f32_16x16x32_bf16 v[56:59], v[24:27], v[204:207], v[56:59]
    v_fmac_f32 v101, v137, v129
    v_fmac_f32 v102, v138, v129
    s_waitcnt lgkmcnt(3)
    v_mfma_f32_16x16x32_bf16 v[36:39], v[28:31], v[192:195], v[36:39]
    ds_read_b128 v[20:23], v4 offset:9216
    v_fmac_f32 v103, v139, v129
    v_mfma_f32_16x16x32_bf16 v[44:47], v[28:31], v[196:199], v[44:47]
    v_fmac_f32 v116, v140, v129
    v_fmac_f32 v117, v141, v129
    v_mfma_f32_16x16x32_bf16 v[52:55], v[28:31], v[200:203], v[52:55]
    buffer_load_dwordx4 a[108:111], v2, s[4:7], s60 offen offset:3072 sc1
    v_fmac_f32 v118, v142, v129
    v_mfma_f32_16x16x32_bf16 v[60:63], v[28:31], v[204:207], v[60:63]
    v_fmac_f32 v119, v143, v129
    v_mul_f32 v100, v100, v133
    s_waitcnt lgkmcnt(3)
    v_mfma_f32_16x16x32_bf16 v[64:67], v[8:11], v[192:195], v[64:67]
    ds_read_b128 v[24:27], v4 offset:10240
    v_mul_f32 v101, v101, v133
    v_mfma_f32_16x16x32_bf16 v[72:75], v[8:11], v[196:199], v[72:75]
    v_mul_f32 v102, v102, v133
    v_mul_f32 v103, v103, v133
    v_mfma_f32_16x16x32_bf16 v[80:83], v[8:11], v[200:203], v[80:83]
    buffer_load_dwordx4 v2, s[4:7], s61 offen offset:0 lds
    v_mul_f32 v100, v100, v116
    v_mfma_f32_16x16x32_bf16 v[88:91], v[8:11], v[204:207], v[88:91]
    v_mul_f32 v101, v101, v117
    v_mul_f32 v102, v102, v118
    s_waitcnt lgkmcnt(3)
    v_mfma_f32_16x16x32_bf16 v[68:71], v[12:15], v[192:195], v[68:71]
    ds_read_b128 v[28:31], v4 offset:11264
    v_mul_f32 v103, v103, v119
    v_mfma_f32_16x16x32_bf16 v[76:79], v[12:15], v[196:199], v[76:79]
    v_cvt_pk_bf16_f32 v230, v100, v101
    v_cvt_pk_bf16_f32 v231, v102, v103
    v_mfma_f32_16x16x32_bf16 v[84:87], v[12:15], v[200:203], v[84:87]
    buffer_store_dwordx4 v[228:231], v2, s[4:7], s66 offen offset:1024 sc1
    v_fmac_f32 v104, v136, v130
    v_mfma_f32_16x16x32_bf16 v[92:95], v[12:15], v[204:207], v[92:95]
    v_fmac_f32 v105, v137, v130
    v_fmac_f32 v106, v138, v130
    s_waitcnt lgkmcnt(3)
    v_mfma_f32_16x16x32_bf16 v[32:35], v[16:19], v[208:211], v[32:35]
    ds_read_b128 v[8:11], v4 offset:12288
    v_fmac_f32 v107, v139, v130
    v_mfma_f32_16x16x32_bf16 v[40:43], v[16:19], v[212:215], v[40:43]
    v_fmac_f32 v120, v140, v130
    v_fmac_f32 v121, v141, v130
    v_mfma_f32_16x16x32_bf16 v[48:51], v[16:19], v[216:219], v[48:51]
    buffer_load_dwordx4 v2, s[4:7], s61 offen offset:1024 lds
    v_fmac_f32 v122, v142, v130
    v_mfma_f32_16x16x32_bf16 v[56:59], v[16:19], v[220:223], v[56:59]
    v_fmac_f32 v123, v143, v130
    v_mul_f32 v104, v104, v134
    s_waitcnt lgkmcnt(3)
    v_mfma_f32_16x16x32_bf16 v[36:39], v[20:23], v[208:211], v[36:39]
    ds_read_b128 v[12:15], v4 offset:13312
    v_mul_f32 v105, v105, v134
    v_mfma_f32_16x16x32_bf16 v[44:47], v[20:23], v[212:215], v[44:47]
    v_mul_f32 v106, v106, v134
    v_mul_f32 v107, v107, v134
    v_mfma_f32_16x16x32_bf16 v[52:55], v[20:23], v[216:219], v[52:55]
    buffer_load_dwordx4 v2, s[4:7], s61 offen offset:2048 lds
    v_mul_f32 v104, v104, v120
    v_mfma_f32_16x16x32_bf16 v[60:63], v[20:23], v[220:223], v[60:63]
    v_mul_f32 v105, v105, v121
    v_mul_f32 v106, v106, v122
    s_waitcnt lgkmcnt(3)
    v_mfma_f32_16x16x32_bf16 v[64:67], v[24:27], v[208:211], v[64:67]
    ds_read_b128 v[16:19], v4 offset:14336
    v_mul_f32 v107, v107, v123
    v_mfma_f32_16x16x32_bf16 v[72:75], v[24:27], v[212:215], v[72:75]
    v_cvt_pk_bf16_f32 v234, v104, v105
    v_cvt_pk_bf16_f32 v235, v106, v107
    v_mfma_f32_16x16x32_bf16 v[80:83], v[24:27], v[216:219], v[80:83]
    buffer_store_dwordx4 v[232:235], v2, s[4:7], s66 offen offset:2048 sc1
    v_fmac_f32 v108, v136, v131
    v_mfma_f32_16x16x32_bf16 v[88:91], v[24:27], v[220:223], v[88:91]
    v_fmac_f32 v109, v137, v131
    v_fmac_f32 v110, v138, v131
    s_waitcnt lgkmcnt(3)
    v_mfma_f32_16x16x32_bf16 v[68:71], v[28:31], v[208:211], v[68:71]
    ds_read_b128 v[20:23], v4 offset:15360
    v_fmac_f32 v111, v139, v131
    v_mfma_f32_16x16x32_bf16 v[76:79], v[28:31], v[212:215], v[76:79]
    v_fmac_f32 v124, v140, v131
    v_fmac_f32 v125, v141, v131
    v_mfma_f32_16x16x32_bf16 v[84:87], v[28:31], v[216:219], v[84:87]
    v_fmac_f32 v126, v142, v131
    v_fmac_f32 v127, v143, v131
    v_mfma_f32_16x16x32_bf16 v[92:95], v[28:31], v[220:223], v[92:95]
    v_mul_f32 v108, v108, v135
    v_mul_f32 v109, v109, v135
    v_mul_f32 v110, v110, v135
    v_mul_f32 v111, v111, v135
    v_mul_f32 v108, v108, v124
    v_mul_f32 v109, v109, v125
    v_mul_f32 v110, v110, v126
    v_mul_f32 v111, v111, v127
    v_cvt_pk_bf16_f32 v238, v108, v109
    v_cvt_pk_bf16_f32 v239, v110, v111
    buffer_store_dwordx4 v[236:239], v2, s[4:7], s66 offen offset:3072 sc1
    s_waitcnt lgkmcnt(3)
    v_mfma_f32_16x16x32_bf16 v[96:99], v[8:11], v[176:179], 0
    ds_read_b128 v[24:27], v4 offset:16384
    v_mfma_f32_16x16x32_bf16 v[104:107], v[8:11], v[180:183], 0
    s_add_u32 s55, s52, 32
    v_mfma_f32_16x16x32_bf16 v[112:115], v[8:11], v[184:187], 0
    v_mfma_f32_16x16x32_bf16 v[120:123], v[8:11], v[188:191], 0
    buffer_load_dwordx4 v2, s[4:7], s61 offen offset:3072 lds
    s_add_u32 m0, s49, 114688
    s_waitcnt lgkmcnt(3)
    v_mfma_f32_16x16x32_bf16 v[100:103], v[12:15], v[176:179], 0
    ds_read_b128 v[28:31], v4 offset:17408
    s_add_u32 s61, s48, 409600
    v_mfma_f32_16x16x32_bf16 v[108:111], v[12:15], v[180:183], 0
    v_mfma_f32_16x16x32_bf16 v[116:119], v[12:15], v[184:187], 0
    v_mfma_f32_16x16x32_bf16 v[124:127], v[12:15], v[188:191], 0
    buffer_load_dwordx4 v2, s[4:7], s61 offen offset:0 lds
    s_waitcnt lgkmcnt(3)
    v_mfma_f32_16x16x32_bf16 v[128:131], v[16:19], v[176:179], 0
    ds_read_b128 v[8:11], v4 offset:18432
    v_mfma_f32_16x16x32_bf16 v[136:139], v[16:19], v[180:183], 0
    v_mfma_f32_16x16x32_bf16 v[144:147], v[16:19], v[184:187], 0
    v_mfma_f32_16x16x32_bf16 v[152:155], v[16:19], v[188:191], 0
    buffer_load_dwordx2 v[6:7], v0, s[4:7], s55 offen sc1
    s_waitcnt lgkmcnt(3)
    v_mfma_f32_16x16x32_bf16 v[132:135], v[20:23], v[176:179], 0
    ds_read_b128 v[12:15], v4 offset:19456
    v_mfma_f32_16x16x32_bf16 v[140:143], v[20:23], v[180:183], 0
    v_mfma_f32_16x16x32_bf16 v[148:151], v[20:23], v[184:187], 0
    v_mfma_f32_16x16x32_bf16 v[156:159], v[20:23], v[188:191], 0
    buffer_load_dwordx4 v2, s[4:7], s61 offen offset:1024 lds
    s_waitcnt lgkmcnt(3)
    v_mfma_f32_16x16x32_bf16 v[160:163], v[24:27], v[176:179], 0
    ds_read_b128 v[16:19], v4 offset:20480
    v_mfma_f32_16x16x32_bf16 v[164:167], v[24:27], v[180:183], 0
    v_mfma_f32_16x16x32_bf16 v[168:171], v[24:27], v[184:187], 0
    v_mfma_f32_16x16x32_bf16 v[172:175], v[24:27], v[188:191], 0
    buffer_load_dwordx4 v2, s[4:7], s61 offen offset:2048 lds
    s_waitcnt lgkmcnt(3)
    v_mfma_f32_16x16x32_bf16 v[96:99], v[28:31], v[192:195], v[96:99]
    ds_read_b128 v[20:23], v4 offset:21504
    v_mfma_f32_16x16x32_bf16 v[104:107], v[28:31], v[196:199], v[104:107]
    v_mfma_f32_16x16x32_bf16 v[112:115], v[28:31], v[200:203], v[112:115]
    v_mfma_f32_16x16x32_bf16 v[120:123], v[28:31], v[204:207], v[120:123]
    buffer_load_dwordx4 v2, s[4:7], s61 offen offset:3072 lds
    s_add_u32 m0, s49, 118784
    s_waitcnt lgkmcnt(3)
    v_mfma_f32_16x16x32_bf16 v[100:103], v[8:11], v[192:195], v[100:103]
    ds_read_b128 v[24:27], v4 offset:22528
    s_add_u32 s61, s48, 413696
    v_mfma_f32_16x16x32_bf16 v[108:111], v[8:11], v[196:199], v[108:111]
    v_mfma_f32_16x16x32_bf16 v[116:119], v[8:11], v[200:203], v[116:119]
    v_mfma_f32_16x16x32_bf16 v[124:127], v[8:11], v[204:207], v[124:127]
    buffer_load_dwordx4 v2, s[4:7], s61 offen offset:0 lds
    s_waitcnt lgkmcnt(3)
    v_mfma_f32_16x16x32_bf16 v[128:131], v[12:15], v[192:195], v[128:131]
    ds_read_b128 v[28:31], v4 offset:23552
    v_mfma_f32_16x16x32_bf16 v[136:139], v[12:15], v[196:199], v[136:139]
    v_mfma_f32_16x16x32_bf16 v[144:147], v[12:15], v[200:203], v[144:147]
    v_mfma_f32_16x16x32_bf16 v[152:155], v[12:15], v[204:207], v[152:155]
    s_waitcnt lgkmcnt(3)
    v_mfma_f32_16x16x32_bf16 v[132:135], v[16:19], v[192:195], v[132:135]
    ds_read_b128 v[8:11], v4 offset:24576
    v_mfma_f32_16x16x32_bf16 v[140:143], v[16:19], v[196:199], v[140:143]
    v_mfma_f32_16x16x32_bf16 v[148:151], v[16:19], v[200:203], v[148:151]
    v_mfma_f32_16x16x32_bf16 v[156:159], v[16:19], v[204:207], v[156:159]
    s_waitcnt lgkmcnt(3)
    v_mfma_f32_16x16x32_bf16 v[160:163], v[20:23], v[192:195], v[160:163]
    ds_read_b128 v[12:15], v4 offset:25600
    v_mfma_f32_16x16x32_bf16 v[164:167], v[20:23], v[196:199], v[164:167]
    v_mfma_f32_16x16x32_bf16 v[168:171], v[20:23], v[200:203], v[168:171]
    v_mfma_f32_16x16x32_bf16 v[172:175], v[20:23], v[204:207], v[172:175]
    s_waitcnt lgkmcnt(3)
    v_mfma_f32_16x16x32_bf16 v[96:99], v[24:27], v[208:211], v[96:99]
    ds_read_b128 v[16:19], v4 offset:26624
    v_mfma_f32_16x16x32_bf16 v[104:107], v[24:27], v[212:215], v[104:107]
    v_mfma_f32_16x16x32_bf16 v[112:115], v[24:27], v[216:219], v[112:115]
    v_mfma_f32_16x16x32_bf16 v[120:123], v[24:27], v[220:223], v[120:123]
    s_waitcnt lgkmcnt(3)
    v_mfma_f32_16x16x32_bf16 v[100:103], v[28:31], v[208:211], v[100:103]
    ds_read_b128 v[20:23], v4 offset:27648
    v_mfma_f32_16x16x32_bf16 v[108:111], v[28:31], v[212:215], v[108:111]
    v_mfma_f32_16x16x32_bf16 v[116:119], v[28:31], v[216:219], v[116:119]
    v_mfma_f32_16x16x32_bf16 v[124:127], v[28:31], v[220:223], v[124:127]
    s_waitcnt lgkmcnt(3)
    v_mfma_f32_16x16x32_bf16 v[128:131], v[8:11], v[208:211], v[128:131]
    ds_read_b128 v[24:27], v4 offset:28672
    v_mfma_f32_16x16x32_bf16 v[136:139], v[8:11], v[212:215], v[136:139]
    v_mfma_f32_16x16x32_bf16 v[144:147], v[8:11], v[216:219], v[144:147]
    v_mfma_f32_16x16x32_bf16 v[152:155], v[8:11], v[220:223], v[152:155]
    s_waitcnt vmcnt(4)
    v_cmp_eq_u64 vcc, s[98:99], v[6:7]
    s_nop 0
    s_cmp_eq_u64 vcc, exec
    s_cbranch_scc0 L_p1_slow_69
L_p1_back_70:
    s_waitcnt lgkmcnt(3)
    v_mfma_f32_16x16x32_bf16 v[132:135], v[12:15], v[208:211], v[132:135]
    ds_read_b128 v[28:31], v4 offset:29696
    s_add_u32 s60, s56, 32768
    v_mfma_f32_16x16x32_bf16 v[140:143], v[12:15], v[212:215], v[140:143]
    buffer_load_dwordx4 a[112:115], v2, s[4:7], s60 offen offset:0 sc1
    v_mfma_f32_16x16x32_bf16 v[148:151], v[12:15], v[216:219], v[148:151]
    v_mfma_f32_16x16x32_bf16 v[156:159], v[12:15], v[220:223], v[156:159]
    s_waitcnt lgkmcnt(3)
    v_mfma_f32_16x16x32_bf16 v[160:163], v[16:19], v[208:211], v[160:163]
    ds_read_b128 v[8:11], v4 offset:30720
    v_mfma_f32_16x16x32_bf16 v[164:167], v[16:19], v[212:215], v[164:167]
    buffer_load_dwordx4 a[116:119], v2, s[4:7], s60 offen offset:1024 sc1
    v_mfma_f32_16x16x32_bf16 v[168:171], v[16:19], v[216:219], v[168:171]
    v_mfma_f32_16x16x32_bf16 v[172:175], v[16:19], v[220:223], v[172:175]
    s_waitcnt lgkmcnt(3)
    v_mfma_f32_16x16x32_bf16 v[32:35], v[20:23], v[224:227], v[32:35]
    ds_read_b128 v[12:15], v4 offset:31744
    v_mfma_f32_16x16x32_bf16 v[40:43], v[20:23], v[228:231], v[40:43]
    buffer_load_dwordx4 a[120:123], v2, s[4:7], s60 offen offset:2048 sc1
    v_mfma_f32_16x16x32_bf16 v[48:51], v[20:23], v[232:235], v[48:51]
    v_mfma_f32_16x16x32_bf16 v[56:59], v[20:23], v[236:239], v[56:59]
    s_waitcnt lgkmcnt(3)
    v_mfma_f32_16x16x32_bf16 v[36:39], v[24:27], v[224:227], v[36:39]
    ds_read_b128 v[16:19], v4 offset:32768
    v_mfma_f32_16x16x32_bf16 v[44:47], v[24:27], v[228:231], v[44:47]
    s_add_u32 s71, s67, 64
    buffer_load_dwordx4 a[124:127], v2, s[4:7], s60 offen offset:3072 sc1
    v_mfma_f32_16x16x32_bf16 v[52:55], v[24:27], v[232:235], v[52:55]
    v_mov_b32 v6, s98
    v_mov_b32 v7, s99
    v_mfma_f32_16x16x32_bf16 v[60:63], v[24:27], v[236:239], v[60:63]
    s_add_u32 s60, s57, 32768
    s_waitcnt lgkmcnt(3)
    v_mfma_f32_16x16x32_bf16 v[64:67], v[28:31], v[224:227], v[64:67]
    ds_read_b128 v[20:23], v4 offset:33792
    v_mfma_f32_16x16x32_bf16 v[72:75], v[28:31], v[228:231], v[72:75]
    s_mov_b64 exec, 1
    buffer_store_dwordx2 v[6:7], off, s[4:7], s71 sc1
    s_mov_b64 exec, -1
    v_mfma_f32_16x16x32_bf16 v[80:83], v[28:31], v[232:235], v[80:83]
    v_mfma_f32_16x16x32_bf16 v[88:91], v[28:31], v[236:239], v[88:91]
    s_waitcnt lgkmcnt(3)
    v_mfma_f32_16x16x32_bf16 v[68:71], v[8:11], v[224:227], v[68:71]
    ds_read_b128 v[24:27], v4 offset:34816
    v_mfma_f32_16x16x32_bf16 v[76:79], v[8:11], v[228:231], v[76:79]
    buffer_load_dwordx4 a[128:131], v2, s[4:7], s60 offen offset:0 sc1
    v_mfma_f32_16x16x32_bf16 v[84:87], v[8:11], v[232:235], v[84:87]
    v_mfma_f32_16x16x32_bf16 v[92:95], v[8:11], v[236:239], v[92:95]
    s_waitcnt lgkmcnt(3)
    v_mfma_f32_16x16x32_bf16 v[96:99], v[12:15], v[224:227], v[96:99]
    ds_read_b128 v[28:31], v4 offset:35840
    v_mfma_f32_16x16x32_bf16 v[104:107], v[12:15], v[228:231], v[104:107]
    buffer_load_dwordx4 a[132:135], v2, s[4:7], s60 offen offset:1024 sc1
    v_mfma_f32_16x16x32_bf16 v[112:115], v[12:15], v[232:235], v[112:115]
    v_mfma_f32_16x16x32_bf16 v[120:123], v[12:15], v[236:239], v[120:123]
    s_waitcnt lgkmcnt(3)
    v_mfma_f32_16x16x32_bf16 v[100:103], v[16:19], v[224:227], v[100:103]
    s_barrier
    v_mfma_f32_16x16x32_bf16 v[108:111], v[16:19], v[228:231], v[108:111]
    v_add_u32 v4, 0x9000, v4
    ds_read_b128 v[8:11], v4 offset:0
    v_mfma_f32_16x16x32_bf16 v[116:119], v[16:19], v[232:235], v[116:119]
    buffer_load_dwordx4 a[136:139], v2, s[4:7], s60 offen offset:2048 sc1
    s_add_u32 m0, s49, 0
    v_mfma_f32_16x16x32_bf16 v[124:127], v[16:19], v[236:239], v[124:127]
    s_add_u32 s61, s48, 442368
    s_waitcnt lgkmcnt(3)
    v_mfma_f32_16x16x32_bf16 v[128:131], v[20:23], v[224:227], v[128:131]
    ds_read_b128 v[12:15], v4 offset:1024
    v_mfma_f32_16x16x32_bf16 v[136:139], v[20:23], v[228:231], v[136:139]
    v_mfma_f32_16x16x32_bf16 v[144:147], v[20:23], v[232:235], v[144:147]
    buffer_load_dwordx4 a[140:143], v2, s[4:7], s60 offen offset:3072 sc1
    s_add_u32 s60, s58, 32768
    v_mfma_f32_16x16x32_bf16 v[152:155], v[20:23], v[236:239], v[152:155]
    s_waitcnt lgkmcnt(3)
    v_mfma_f32_16x16x32_bf16 v[132:135], v[24:27], v[224:227], v[132:135]
    ds_read_b128 v[16:19], v4 offset:2048
    v_mfma_f32_16x16x32_bf16 v[140:143], v[24:27], v[228:231], v[140:143]
    v_mfma_f32_16x16x32_bf16 v[148:151], v[24:27], v[232:235], v[148:151]
    buffer_load_dwordx4 a[144:147], v2, s[4:7], s60 offen offset:0 sc1
    v_mfma_f32_16x16x32_bf16 v[156:159], v[24:27], v[236:239], v[156:159]
    s_waitcnt lgkmcnt(3)
    v_mfma_f32_16x16x32_bf16 v[160:163], v[28:31], v[224:227], v[160:163]
    ds_read_b128 v[20:23], v4 offset:3072
    v_mfma_f32_16x16x32_bf16 v[164:167], v[28:31], v[228:231], v[164:167]
    v_mfma_f32_16x16x32_bf16 v[168:171], v[28:31], v[232:235], v[168:171]
    buffer_load_dwordx4 a[148:151], v2, s[4:7], s60 offen offset:1024 sc1
    v_mfma_f32_16x16x32_bf16 v[172:175], v[28:31], v[236:239], v[172:175]
    s_waitcnt lgkmcnt(3)
    v_mfma_f32_16x16x32_bf16 v[32:35], v[8:11], v[240:243], v[32:35]
    ds_read_b128 v[24:27], v4 offset:4096
    v_mfma_f32_16x16x32_bf16 v[40:43], v[8:11], v[244:247], v[40:43]
    v_mfma_f32_16x16x32_bf16 v[48:51], v[8:11], v[248:251], v[48:51]
    buffer_load_dwordx4 a[152:155], v2, s[4:7], s60 offen offset:2048 sc1
    v_mfma_f32_16x16x32_bf16 v[56:59], v[8:11], v[252:255], v[56:59]
    s_waitcnt lgkmcnt(3)
    v_mfma_f32_16x16x32_bf16 v[36:39], v[12:15], v[240:243], v[36:39]
    ds_read_b128 v[28:31], v4 offset:5120
    v_mfma_f32_16x16x32_bf16 v[44:47], v[12:15], v[244:247], v[44:47]
    v_mfma_f32_16x16x32_bf16 v[52:55], v[12:15], v[248:251], v[52:55]
    buffer_load_dwordx4 a[156:159], v2, s[4:7], s60 offen offset:3072 sc1
    v_mfma_f32_16x16x32_bf16 v[60:63], v[12:15], v[252:255], v[60:63]
    s_waitcnt lgkmcnt(3)
    v_mfma_f32_16x16x32_bf16 v[64:67], v[16:19], v[240:243], v[64:67]
    ds_read_b128 v[8:11], v4 offset:6144
    v_mfma_f32_16x16x32_bf16 v[72:75], v[16:19], v[244:247], v[72:75]
    v_mfma_f32_16x16x32_bf16 v[80:83], v[16:19], v[248:251], v[80:83]
    buffer_load_dwordx4 v2, s[4:7], s61 offen offset:0 lds
    v_mfma_f32_16x16x32_bf16 v[88:91], v[16:19], v[252:255], v[88:91]
    s_waitcnt lgkmcnt(3)
    v_mfma_f32_16x16x32_bf16 v[68:71], v[20:23], v[240:243], v[68:71]
    ds_read_b128 v[12:15], v4 offset:7168
    v_mfma_f32_16x16x32_bf16 v[76:79], v[20:23], v[244:247], v[76:79]
    v_mfma_f32_16x16x32_bf16 v[84:87], v[20:23], v[248:251], v[84:87]
    buffer_load_dwordx4 v2, s[4:7], s61 offen offset:1024 lds
    v_mfma_f32_16x16x32_bf16 v[92:95], v[20:23], v[252:255], v[92:95]
    s_waitcnt lgkmcnt(3)
    v_mfma_f32_16x16x32_bf16 v[96:99], v[24:27], v[240:243], v[96:99]
    ds_read_b128 v[16:19], v4 offset:8192
    v_mfma_f32_16x16x32_bf16 v[104:107], v[24:27], v[244:247], v[104:107]
    v_mfma_f32_16x16x32_bf16 v[112:115], v[24:27], v[248:251], v[112:115]
    buffer_load_dwordx4 v2, s[4:7], s61 offen offset:2048 lds
    v_mfma_f32_16x16x32_bf16 v[120:123], v[24:27], v[252:255], v[120:123]
    s_waitcnt lgkmcnt(3)
    v_mfma_f32_16x16x32_bf16 v[100:103], v[28:31], v[240:243], v[100:103]
    ds_read_b128 v[20:23], v4 offset:9216
    v_mfma_f32_16x16x32_bf16 v[108:111], v[28:31], v[244:247], v[108:111]
    v_mfma_f32_16x16x32_bf16 v[116:119], v[28:31], v[248:251], v[116:119]
    buffer_load_dwordx4 v2, s[4:7], s61 offen offset:3072 lds
    s_add_u32 m0, s49, 4096
    v_mfma_f32_16x16x32_bf16 v[124:127], v[28:31], v[252:255], v[124:127]
    s_add_u32 s61, s48, 446464
    s_waitcnt lgkmcnt(3)
    v_mfma_f32_16x16x32_bf16 v[128:131], v[8:11], v[240:243], v[128:131]
    ds_read_b128 v[24:27], v4 offset:10240
    v_mfma_f32_16x16x32_bf16 v[136:139], v[8:11], v[244:247], v[136:139]
    v_mfma_f32_16x16x32_bf16 v[144:147], v[8:11], v[248:251], v[144:147]
    buffer_load_dwordx4 v2, s[4:7], s61 offen offset:0 lds
    v_mfma_f32_16x16x32_bf16 v[152:155], v[8:11], v[252:255], v[152:155]
    s_waitcnt lgkmcnt(3)
    v_mfma_f32_16x16x32_bf16 v[132:135], v[12:15], v[240:243], v[132:135]
    ds_read_b128 v[28:31], v4 offset:11264
    v_mfma_f32_16x16x32_bf16 v[140:143], v[12:15], v[244:247], v[140:143]
    v_mfma_f32_16x16x32_bf16 v[148:151], v[12:15], v[248:251], v[148:151]
    buffer_load_dwordx4 v2, s[4:7], s61 offen offset:1024 lds
    v_mfma_f32_16x16x32_bf16 v[156:159], v[12:15], v[252:255], v[156:159]
    s_waitcnt lgkmcnt(3)
    v_mfma_f32_16x16x32_bf16 v[160:163], v[16:19], v[240:243], v[160:163]
    ds_read_b128 v[8:11], v4 offset:12288
    v_mfma_f32_16x16x32_bf16 v[164:167], v[16:19], v[244:247], v[164:167]
    v_mfma_f32_16x16x32_bf16 v[168:171], v[16:19], v[248:251], v[168:171]
    buffer_load_dwordx4 v2, s[4:7], s61 offen offset:2048 lds
    v_mfma_f32_16x16x32_bf16 v[172:175], v[16:19], v[252:255], v[172:175]
    s_waitcnt lgkmcnt(3)
    v_mfma_f32_16x16x32_bf16 v[32:35], v[20:23], a[0:3], v[32:35]
    ds_read_b128 v[12:15], v4 offset:13312
    v_mfma_f32_16x16x32_bf16 v[40:43], v[20:23], a[4:7], v[40:43]
    v_mfma_f32_16x16x32_bf16 v[48:51], v[20:23], a[8:11], v[48:51]
    buffer_load_dwordx4 v2, s[4:7], s61 offen offset:3072 lds
    s_add_u32 m0, s49, 8192
    v_mfma_f32_16x16x32_bf16 v[56:59], v[20:23], a[12:15], v[56:59]
    s_add_u32 s61, s48, 450560
    s_waitcnt lgkmcnt(3)
    v_mfma_f32_16x16x32_bf16 v[36:39], v[24:27], a[0:3], v[36:39]
    ds_read_b128 v[16:19], v4 offset:14336
    v_mfma_f32_16x16x32_bf16 v[44:47], v[24:27], a[4:7], v[44:47]
    v_mfma_f32_16x16x32_bf16 v[52:55], v[24:27], a[8:11], v[52:55]
    buffer_load_dwordx4 v2, s[4:7], s61 offen offset:0 lds
    v_mfma_f32_16x16x32_bf16 v[60:63], v[24:27], a[12:15], v[60:63]
    s_waitcnt lgkmcnt(3)
    v_mfma_f32_16x16x32_bf16 v[64:67], v[28:31], a[0:3], v[64:67]
    ds_read_b128 v[20:23], v4 offset:15360
    v_mfma_f32_16x16x32_bf16 v[72:75], v[28:31], a[4:7], v[72:75]
    v_mfma_f32_16x16x32_bf16 v[80:83], v[28:31], a[8:11], v[80:83]
    v_mfma_f32_16x16x32_bf16 v[88:91], v[28:31], a[12:15], v[88:91]
    s_waitcnt lgkmcnt(3)
    v_mfma_f32_16x16x32_bf16 v[68:71], v[8:11], a[0:3], v[68:71]
    ds_read_b128 v[24:27], v4 offset:16384
    v_mfma_f32_16x16x32_bf16 v[76:79], v[8:11], a[4:7], v[76:79]
    v_mfma_f32_16x16x32_bf16 v[84:87], v[8:11], a[8:11], v[84:87]
    v_mfma_f32_16x16x32_bf16 v[92:95], v[8:11], a[12:15], v[92:95]
    s_waitcnt lgkmcnt(3)
    v_mfma_f32_16x16x32_bf16 v[96:99], v[12:15], a[0:3], v[96:99]
    ds_read_b128 v[28:31], v4 offset:17408
    v_mfma_f32_16x16x32_bf16 v[104:107], v[12:15], a[4:7], v[104:107]
    v_mfma_f32_16x16x32_bf16 v[112:115], v[12:15], a[8:11], v[112:115]
    v_mfma_f32_16x16x32_bf16 v[120:123], v[12:15], a[12:15], v[120:123]
    s_waitcnt lgkmcnt(3)
    v_mfma_f32_16x16x32_bf16 v[100:103], v[16:19], a[0:3], v[100:103]
    ds_read_b128 v[8:11], v4 offset:18432
    v_mfma_f32_16x16x32_bf16 v[108:111], v[16:19], a[4:7], v[108:111]
    s_add_u32 s55, s52, 64
    v_mfma_f32_16x16x32_bf16 v[116:119], v[16:19], a[8:11], v[116:119]
    v_mfma_f32_16x16x32_bf16 v[124:127], v[16:19], a[12:15], v[124:127]
    s_waitcnt lgkmcnt(3)
    v_mfma_f32_16x16x32_bf16 v[128:131], v[20:23], a[0:3], v[128:131]
    ds_read_b128 v[12:15], v4 offset:19456
    v_mfma_f32_16x16x32_bf16 v[136:139], v[20:23], a[4:7], v[136:139]
    v_mfma_f32_16x16x32_bf16 v[144:147], v[20:23], a[8:11], v[144:147]
    v_mfma_f32_16x16x32_bf16 v[152:155], v[20:23], a[12:15], v[152:155]
    s_waitcnt lgkmcnt(3)
    v_mfma_f32_16x16x32_bf16 v[132:135], v[24:27], a[0:3], v[132:135]
    ds_read_b128 v[16:19], v4 offset:20480
    v_mfma_f32_16x16x32_bf16 v[140:143], v[24:27], a[4:7], v[140:143]
    v_mfma_f32_16x16x32_bf16 v[148:151], v[24:27], a[8:11], v[148:151]
    v_mfma_f32_16x16x32_bf16 v[156:159], v[24:27], a[12:15], v[156:159]
    buffer_load_dwordx2 v[6:7], v0, s[4:7], s55 offen sc1
    s_waitcnt lgkmcnt(3)
    v_mfma_f32_16x16x32_bf16 v[160:163], v[28:31], a[0:3], v[160:163]
    ds_read_b128 v[20:23], v4 offset:21504
    v_mfma_f32_16x16x32_bf16 v[164:167], v[28:31], a[4:7], v[164:167]
    v_mfma_f32_16x16x32_bf16 v[168:171], v[28:31], a[8:11], v[168:171]
    v_mfma_f32_16x16x32_bf16 v[172:175], v[28:31], a[12:15], v[172:175]
    s_waitcnt lgkmcnt(3)
    v_mfma_f32_16x16x32_bf16 v[32:35], v[8:11], a[16:19], v[32:35]
    ds_read_b128 v[24:27], v4 offset:22528
    v_mfma_f32_16x16x32_bf16 v[40:43], v[8:11], a[20:23], v[40:43]
    v_mfma_f32_16x16x32_bf16 v[48:51], v[8:11], a[24:27], v[48:51]
    v_mfma_f32_16x16x32_bf16 v[56:59], v[8:11], a[28:31], v[56:59]
    s_waitcnt lgkmcnt(3)
    v_mfma_f32_16x16x32_bf16 v[36:39], v[12:15], a[16:19], v[36:39]
    ds_read_b128 v[28:31], v4 offset:23552
    v_mfma_f32_16x16x32_bf16 v[44:47], v[12:15], a[20:23], v[44:47]
    v_mfma_f32_16x16x32_bf16 v[52:55], v[12:15], a[24:27], v[52:55]
    v_mfma_f32_16x16x32_bf16 v[60:63], v[12:15], a[28:31], v[60:63]
    s_waitcnt lgkmcnt(3)
    v_mfma_f32_16x16x32_bf16 v[64:67], v[16:19], a[16:19], v[64:67]
    ds_read_b128 v[8:11], v4 offset:24576
    v_mfma_f32_16x16x32_bf16 v[72:75], v[16:19], a[20:23], v[72:75]
    v_mfma_f32_16x16x32_bf16 v[80:83], v[16:19], a[24:27], v[80:83]
    v_mfma_f32_16x16x32_bf16 v[88:91], v[16:19], a[28:31], v[88:91]
    s_waitcnt lgkmcnt(3)
    v_mfma_f32_16x16x32_bf16 v[68:71], v[20:23], a[16:19], v[68:71]
    ds_read_b128 v[12:15], v4 offset:25600
    v_mfma_f32_16x16x32_bf16 v[76:79], v[20:23], a[20:23], v[76:79]
    v_mfma_f32_16x16x32_bf16 v[84:87], v[20:23], a[24:27], v[84:87]
    v_mfma_f32_16x16x32_bf16 v[92:95], v[20:23], a[28:31], v[92:95]
    s_waitcnt lgkmcnt(3)
    v_mfma_f32_16x16x32_bf16 v[96:99], v[24:27], a[16:19], v[96:99]
    ds_read_b128 v[16:19], v4 offset:26624
    v_mfma_f32_16x16x32_bf16 v[104:107], v[24:27], a[20:23], v[104:107]
    v_mfma_f32_16x16x32_bf16 v[112:115], v[24:27], a[24:27], v[112:115]
    v_mfma_f32_16x16x32_bf16 v[120:123], v[24:27], a[28:31], v[120:123]
    s_waitcnt lgkmcnt(3)
    v_mfma_f32_16x16x32_bf16 v[100:103], v[28:31], a[16:19], v[100:103]
    ds_read_b128 v[20:23], v4 offset:27648
    v_mfma_f32_16x16x32_bf16 v[108:111], v[28:31], a[20:23], v[108:111]
    v_mfma_f32_16x16x32_bf16 v[116:119], v[28:31], a[24:27], v[116:119]
    v_mfma_f32_16x16x32_bf16 v[124:127], v[28:31], a[28:31], v[124:127]
    s_waitcnt lgkmcnt(3)
    v_mfma_f32_16x16x32_bf16 v[128:131], v[8:11], a[16:19], v[128:131]
    ds_read_b128 v[24:27], v4 offset:28672
    v_mfma_f32_16x16x32_bf16 v[136:139], v[8:11], a[20:23], v[136:139]
    v_mfma_f32_16x16x32_bf16 v[144:147], v[8:11], a[24:27], v[144:147]
    v_mfma_f32_16x16x32_bf16 v[152:155], v[8:11], a[28:31], v[152:155]
    s_waitcnt lgkmcnt(3)
    v_mfma_f32_16x16x32_bf16 v[132:135], v[12:15], a[16:19], v[132:135]
    ds_read_b128 v[28:31], v4 offset:29696
    v_mfma_f32_16x16x32_bf16 v[140:143], v[12:15], a[20:23], v[140:143]
    v_mfma_f32_16x16x32_bf16 v[148:151], v[12:15], a[24:27], v[148:151]
    v_mfma_f32_16x16x32_bf16 v[156:159], v[12:15], a[28:31], v[156:159]
    s_waitcnt lgkmcnt(3)
    v_mfma_f32_16x16x32_bf16 v[160:163], v[16:19], a[16:19], v[160:163]
    ds_read_b128 v[8:11], v4 offset:30720
    v_mfma_f32_16x16x32_bf16 v[164:167], v[16:19], a[20:23], v[164:167]
    v_mfma_f32_16x16x32_bf16 v[168:171], v[16:19], a[24:27], v[168:171]
    v_mfma_f32_16x16x32_bf16 v[172:175], v[16:19], a[28:31], v[172:175]
    s_waitcnt vmcnt(0)
    v_cmp_eq_u64 vcc, s[98:99], v[6:7]
    s_nop 0
    s_cmp_eq_u64 vcc, exec
    s_cbranch_scc0 L_p2_slow_72
L_p2_back_73:
    s_waitcnt lgkmcnt(3)
    v_mfma_f32_16x16x32_bf16 v[32:35], v[20:23], a[32:35], v[32:35]
    ds_read_b128 v[12:15], v4 offset:31744
    s_add_u32 s60, s56, 49152
    v_mfma_f32_16x16x32_bf16 v[40:43], v[20:23], a[36:39], v[40:43]
    buffer_load_dwordx4 a[160:163], v2, s[4:7], s60 offen offset:0 sc1
    v_mfma_f32_16x16x32_bf16 v[48:51], v[20:23], a[40:43], v[48:51]
    v_mfma_f32_16x16x32_bf16 v[56:59], v[20:23], a[44:47], v[56:59]
    s_and_b32 s68, s46, 1
    s_mul_i32 s69, s68, 5120
    s_waitcnt lgkmcnt(3)
    v_mfma_f32_16x16x32_bf16 v[36:39], v[24:27], a[32:35], v[36:39]
    ds_read_b128 v[16:19], v4 offset:32768
    s_add_u32 s69, s69, s53
    v_mfma_f32_16x16x32_bf16 v[44:47], v[24:27], a[36:39], v[44:47]
    buffer_load_dwordx4 a[164:167], v2, s[4:7], s60 offen offset:1024 sc1
    s_lshl_b32 s68, s68, 9
    v_mfma_f32_16x16x32_bf16 v[52:55], v[24:27], a[40:43], v[52:55]
    s_add_u32 s68, s68, s53
    v_and_b32 v0, 15, v1
    v_mfma_f32_16x16x32_bf16 v[60:63], v[24:27], a[44:47], v[60:63]
    v_lshlrev_b32 v0, 5, v0
    v_lshrrev_b32 v5, 4, v1
    s_waitcnt lgkmcnt(3)
    v_mfma_f32_16x16x32_bf16 v[64:67], v[28:31], a[32:35], v[64:67]
    ds_read_b128 v[20:23], v4 offset:33792
    v_lshl_add_u32 v0, v5, 3, v0
    v_mfma_f32_16x16x32_bf16 v[72:75], v[28:31], a[36:39], v[72:75]
    buffer_load_dwordx4 a[168:171], v2, s[4:7], s60 offen offset:2048 sc1
    v_mfma_f32_16x16x32_bf16 v[80:83], v[28:31], a[40:43], v[80:83]
    v_mfma_f32_16x16x32_bf16 v[88:91], v[28:31], a[44:47], v[88:91]
    s_waitcnt lgkmcnt(3)
    v_mfma_f32_16x16x32_bf16 v[68:71], v[8:11], a[32:35], v[68:71]
    ds_read_b128 v[24:27], v4 offset:34816
    v_mfma_f32_16x16x32_bf16 v[76:79], v[8:11], a[36:39], v[76:79]
    buffer_load_dwordx4 a[172:175], v2, s[4:7], s60 offen offset:3072 sc1
    s_add_u32 s60, s57, 49152
    v_mfma_f32_16x16x32_bf16 v[84:87], v[8:11], a[40:43], v[84:87]
    v_mfma_f32_16x16x32_bf16 v[92:95], v[8:11], a[44:47], v[92:95]
    s_waitcnt lgkmcnt(3)
    v_mfma_f32_16x16x32_bf16 v[96:99], v[12:15], a[32:35], v[96:99]
    ds_read_b128 v[28:31], v4 offset:35840
    v_mfma_f32_16x16x32_bf16 v[104:107], v[12:15], a[36:39], v[104:107]
    buffer_load_dwordx4 a[176:179], v2, s[4:7], s60 offen offset:0 sc1
    v_mfma_f32_16x16x32_bf16 v[112:115], v[12:15], a[40:43], v[112:115]
    v_mfma_f32_16x16x32_bf16 v[120:123], v[12:15], a[44:47], v[120:123]
    s_waitcnt lgkmcnt(3)
    v_mfma_f32_16x16x32_bf16 v[100:103], v[16:19], a[32:35], v[100:103]
    s_barrier
    v_mfma_f32_16x16x32_bf16 v[108:111], v[16:19], a[36:39], v[108:111]
    v_add_u32 v4, 0x9000, v4
    ds_read_b128 v[8:11], v4 offset:0
    v_mfma_f32_16x16x32_bf16 v[116:119], v[16:19], a[40:43], v[116:119]
    buffer_load_dwordx4 a[180:183], v2, s[4:7], s60 offen offset:1024 sc1
    s_add_u32 m0, s63, 36864
    v_mfma_f32_16x16x32_bf16 v[124:127], v[16:19], a[44:47], v[124:127]
    s_add_u32 s61, s62, 479232
    s_waitcnt lgkmcnt(3)
    v_mfma_f32_16x16x32_bf16 v[128:131], v[20:23], a[32:35], v[128:131]
    ds_read_b128 v[12:15], v4 offset:1024
    v_mfma_f32_16x16x32_bf16 v[136:139], v[20:23], a[36:39], v[136:139]
    v_mfma_f32_16x16x32_bf16 v[144:147], v[20:23], a[40:43], v[144:147]
    buffer_load_dwordx4 a[184:187], v2, s[4:7], s60 offen offset:2048 sc1
    v_mfma_f32_16x16x32_bf16 v[152:155], v[20:23], a[44:47], v[152:155]
    s_waitcnt lgkmcnt(3)
    v_mfma_f32_16x16x32_bf16 v[132:135], v[24:27], a[32:35], v[132:135]
    ds_read_b128 v[16:19], v4 offset:2048
    v_mfma_f32_16x16x32_bf16 v[140:143], v[24:27], a[36:39], v[140:143]
    v_mfma_f32_16x16x32_bf16 v[148:151], v[24:27], a[40:43], v[148:151]
    buffer_load_dwordx4 a[188:191], v2, s[4:7], s60 offen offset:3072 sc1
    s_add_u32 s60, s58, 49152
    v_mfma_f32_16x16x32_bf16 v[156:159], v[24:27], a[44:47], v[156:159]
    s_waitcnt lgkmcnt(3)
    v_mfma_f32_16x16x32_bf16 v[160:163], v[28:31], a[32:35], v[160:163]
    ds_read_b128 v[20:23], v4 offset:3072
    v_mfma_f32_16x16x32_bf16 v[164:167], v[28:31], a[36:39], v[164:167]
    v_mfma_f32_16x16x32_bf16 v[168:171], v[28:31], a[40:43], v[168:171]
    buffer_load_dwordx4 a[192:195], v2, s[4:7], s60 offen offset:0 sc1
    v_mfma_f32_16x16x32_bf16 v[172:175], v[28:31], a[44:47], v[172:175]
    s_waitcnt lgkmcnt(3)
    v_mfma_f32_16x16x32_bf16 v[32:35], v[8:11], a[48:51], v[32:35]
    ds_read_b128 v[24:27], v4 offset:4096
    v_mfma_f32_16x16x32_bf16 v[40:43], v[8:11], a[52:55], v[40:43]
    v_mfma_f32_16x16x32_bf16 v[48:51], v[8:11], a[56:59], v[48:51]
    buffer_load_dwordx4 a[196:199], v2, s[4:7], s60 offen offset:1024 sc1
    v_mfma_f32_16x16x32_bf16 v[56:59], v[8:11], a[60:63], v[56:59]
    s_waitcnt lgkmcnt(3)
    v_mfma_f32_16x16x32_bf16 v[36:39], v[12:15], a[48:51], v[36:39]
    ds_read_b128 v[28:31], v4 offset:5120
    v_mfma_f32_16x16x32_bf16 v[44:47], v[12:15], a[52:55], v[44:47]
    v_mfma_f32_16x16x32_bf16 v[52:55], v[12:15], a[56:59], v[52:55]
    buffer_load_dwordx4 a[200:203], v2, s[4:7], s60 offen offset:2048 sc1
    v_mfma_f32_16x16x32_bf16 v[60:63], v[12:15], a[60:63], v[60:63]
    s_waitcnt lgkmcnt(3)
    v_mfma_f32_16x16x32_bf16 v[64:67], v[16:19], a[48:51], v[64:67]
    ds_read_b128 v[8:11], v4 offset:6144
    v_mfma_f32_16x16x32_bf16 v[72:75], v[16:19], a[52:55], v[72:75]
    v_mfma_f32_16x16x32_bf16 v[80:83], v[16:19], a[56:59], v[80:83]
    buffer_load_dwordx4 a[204:207], v2, s[4:7], s60 offen offset:3072 sc1
    v_mfma_f32_16x16x32_bf16 v[88:91], v[16:19], a[60:63], v[88:91]
    s_waitcnt lgkmcnt(3)
    v_mfma_f32_16x16x32_bf16 v[68:71], v[20:23], a[48:51], v[68:71]
    ds_read_b128 v[12:15], v4 offset:7168
    v_mfma_f32_16x16x32_bf16 v[76:79], v[20:23], a[52:55], v[76:79]
    v_mfma_f32_16x16x32_bf16 v[84:87], v[20:23], a[56:59], v[84:87]
    buffer_load_dwordx4 v2, s[4:7], s61 offen offset:0 lds
    v_mfma_f32_16x16x32_bf16 v[92:95], v[20:23], a[60:63], v[92:95]
    s_waitcnt lgkmcnt(3)
    v_mfma_f32_16x16x32_bf16 v[96:99], v[24:27], a[48:51], v[96:99]
    ds_read_b128 v[16:19], v4 offset:8192
    v_mfma_f32_16x16x32_bf16 v[104:107], v[24:27], a[52:55], v[104:107]
    v_mfma_f32_16x16x32_bf16 v[112:115], v[24:27], a[56:59], v[112:115]
    buffer_load_dwordx4 v2, s[4:7], s61 offen offset:1024 lds
    v_mfma_f32_16x16x32_bf16 v[120:123], v[24:27], a[60:63], v[120:123]
    s_waitcnt lgkmcnt(3)
    v_mfma_f32_16x16x32_bf16 v[100:103], v[28:31], a[48:51], v[100:103]
    ds_read_b128 v[20:23], v4 offset:9216
    v_mfma_f32_16x16x32_bf16 v[108:111], v[28:31], a[52:55], v[108:111]
    v_mfma_f32_16x16x32_bf16 v[116:119], v[28:31], a[56:59], v[116:119]
    buffer_load_dwordx4 v2, s[4:7], s61 offen offset:2048 lds
    v_mfma_f32_16x16x32_bf16 v[124:127], v[28:31], a[60:63], v[124:127]
    s_waitcnt lgkmcnt(3)
    v_mfma_f32_16x16x32_bf16 v[128:131], v[8:11], a[48:51], v[128:131]
    ds_read_b128 v[24:27], v4 offset:10240
    v_mfma_f32_16x16x32_bf16 v[136:139], v[8:11], a[52:55], v[136:139]
    v_mfma_f32_16x16x32_bf16 v[144:147], v[8:11], a[56:59], v[144:147]
    buffer_load_dwordx4 v2, s[4:7], s61 offen offset:3072 lds
    s_add_u32 m0, s63, 40960
    v_mfma_f32_16x16x32_bf16 v[152:155], v[8:11], a[60:63], v[152:155]
    s_add_u32 s61, s62, 483328
    s_waitcnt lgkmcnt(3)
    v_mfma_f32_16x16x32_bf16 v[132:135], v[12:15], a[48:51], v[132:135]
    ds_read_b128 v[28:31], v4 offset:11264
    v_mfma_f32_16x16x32_bf16 v[140:143], v[12:15], a[52:55], v[140:143]
    v_mfma_f32_16x16x32_bf16 v[148:151], v[12:15], a[56:59], v[148:151]
    buffer_load_dwordx4 v2, s[4:7], s61 offen offset:0 lds
    v_mfma_f32_16x16x32_bf16 v[156:159], v[12:15], a[60:63], v[156:159]
    s_waitcnt lgkmcnt(3)
    v_mfma_f32_16x16x32_bf16 v[160:163], v[16:19], a[48:51], v[160:163]
    ds_read_b128 v[8:11], v4 offset:12288
    v_mfma_f32_16x16x32_bf16 v[164:167], v[16:19], a[52:55], v[164:167]
    v_mfma_f32_16x16x32_bf16 v[168:171], v[16:19], a[56:59], v[168:171]
    v_mfma_f32_16x16x32_bf16 v[172:175], v[16:19], a[60:63], v[172:175]
    s_waitcnt lgkmcnt(3)
    v_mfma_f32_16x16x32_bf16 v[32:35], v[20:23], a[64:67], v[32:35]
    ds_read_b128 v[12:15], v4 offset:13312
    v_mfma_f32_16x16x32_bf16 v[40:43], v[20:23], a[68:71], v[40:43]
    v_mfma_f32_16x16x32_bf16 v[48:51], v[20:23], a[72:75], v[48:51]
    v_mfma_f32_16x16x32_bf16 v[56:59], v[20:23], a[76:79], v[56:59]
    s_waitcnt lgkmcnt(3)
    v_mfma_f32_16x16x32_bf16 v[36:39], v[24:27], a[64:67], v[36:39]
    ds_read_b128 v[16:19], v4 offset:14336
    v_mfma_f32_16x16x32_bf16 v[44:47], v[24:27], a[68:71], v[44:47]
    v_mfma_f32_16x16x32_bf16 v[52:55], v[24:27], a[72:75], v[52:55]
    v_mfma_f32_16x16x32_bf16 v[60:63], v[24:27], a[76:79], v[60:63]
    s_waitcnt lgkmcnt(3)
    v_mfma_f32_16x16x32_bf16 v[32:35], v[28:31], a[80:83], v[32:35]
    ds_read_b128 v[20:23], v4 offset:15360
    v_mfma_f32_16x16x32_bf16 v[40:43], v[28:31], a[84:87], v[40:43]
    v_mfma_f32_16x16x32_bf16 v[48:51], v[28:31], a[88:91], v[48:51]
    v_mfma_f32_16x16x32_bf16 v[56:59], v[28:31], a[92:95], v[56:59]
    s_waitcnt lgkmcnt(3)
    v_mfma_f32_16x16x32_bf16 v[36:39], v[8:11], a[80:83], v[36:39]
    ds_read_b128 v[24:27], v4 offset:16384
    v_mfma_f32_16x16x32_bf16 v[44:47], v[8:11], a[84:87], v[44:47]
    v_mfma_f32_16x16x32_bf16 v[52:55], v[8:11], a[88:91], v[52:55]
    v_mfma_f32_16x16x32_bf16 v[60:63], v[8:11], a[92:95], v[60:63]
    s_waitcnt lgkmcnt(3)
    v_mfma_f32_16x16x32_bf16 v[32:35], v[12:15], a[96:99], v[32:35]
    ds_read_b128 v[28:31], v4 offset:17408
    v_mfma_f32_16x16x32_bf16 v[40:43], v[12:15], a[100:103], v[40:43]
    v_mfma_f32_16x16x32_bf16 v[48:51], v[12:15], a[104:107], v[48:51]
    v_mfma_f32_16x16x32_bf16 v[56:59], v[12:15], a[108:111], v[56:59]
    s_waitcnt lgkmcnt(3)
    v_mfma_f32_16x16x32_bf16 v[36:39], v[16:19], a[96:99], v[36:39]
    ds_read_b128 v[8:11], v4 offset:18432
    v_mfma_f32_16x16x32_bf16 v[44:47], v[16:19], a[100:103], v[44:47]
    v_mfma_f32_16x16x32_bf16 v[52:55], v[16:19], a[104:107], v[52:55]
    v_mfma_f32_16x16x32_bf16 v[60:63], v[16:19], a[108:111], v[60:63]
    s_waitcnt lgkmcnt(3)
    v_mfma_f32_16x16x32_bf16 v[32:35], v[20:23], a[112:115], v[32:35]
    ds_read_b128 v[12:15], v4 offset:19456
    v_mfma_f32_16x16x32_bf16 v[40:43], v[20:23], a[116:119], v[40:43]
    v_mfma_f32_16x16x32_bf16 v[48:51], v[20:23], a[120:123], v[48:51]
    v_mfma_f32_16x16x32_bf16 v[56:59], v[20:23], a[124:127], v[56:59]
    s_waitcnt lgkmcnt(3)
    v_mfma_f32_16x16x32_bf16 v[36:39], v[24:27], a[112:115], v[36:39]
    ds_read_b128 v[16:19], v4 offset:20480
    v_mfma_f32_16x16x32_bf16 v[44:47], v[24:27], a[116:119], v[44:47]
    v_mfma_f32_16x16x32_bf16 v[52:55], v[24:27], a[120:123], v[52:55]
    v_mfma_f32_16x16x32_bf16 v[60:63], v[24:27], a[124:127], v[60:63]
    s_waitcnt lgkmcnt(3)
    v_mfma_f32_16x16x32_bf16 v[32:35], v[28:31], a[128:131], v[32:35]
    ds_read_b128 v[20:23], v4 offset:21504
    v_mfma_f32_16x16x32_bf16 v[40:43], v[28:31], a[132:135], v[40:43]
    v_mfma_f32_16x16x32_bf16 v[48:51], v[28:31], a[136:139], v[48:51]
    v_mfma_f32_16x16x32_bf16 v[56:59], v[28:31], a[140:143], v[56:59]
    s_waitcnt lgkmcnt(3)
    v_mfma_f32_16x16x32_bf16 v[36:39], v[8:11], a[128:131], v[36:39]
    ds_read_b128 v[24:27], v4 offset:22528
    v_mfma_f32_16x16x32_bf16 v[44:47], v[8:11], a[132:135], v[44:47]
    v_mfma_f32_16x16x32_bf16 v[52:55], v[8:11], a[136:139], v[52:55]
    v_mfma_f32_16x16x32_bf16 v[60:63], v[8:11], a[140:143], v[60:63]
    s_waitcnt lgkmcnt(3)
    v_mfma_f32_16x16x32_bf16 v[32:35], v[12:15], a[144:147], v[32:35]
    ds_read_b128 v[28:31], v4 offset:23552
    v_mfma_f32_16x16x32_bf16 v[40:43], v[12:15], a[148:151], v[40:43]
    v_mfma_f32_16x16x32_bf16 v[48:51], v[12:15], a[152:155], v[48:51]
    v_mfma_f32_16x16x32_bf16 v[56:59], v[12:15], a[156:159], v[56:59]
    s_waitcnt lgkmcnt(3)
    v_mfma_f32_16x16x32_bf16 v[36:39], v[16:19], a[144:147], v[36:39]
    ds_read_b128 v[8:11], v4 offset:24576
    v_mfma_f32_16x16x32_bf16 v[44:47], v[16:19], a[148:151], v[44:47]
    v_mfma_f32_16x16x32_bf16 v[52:55], v[16:19], a[152:155], v[52:55]
    v_mfma_f32_16x16x32_bf16 v[60:63], v[16:19], a[156:159], v[60:63]
    s_waitcnt vmcnt(16) lgkmcnt(3)
    v_mfma_f32_16x16x32_bf16 v[32:35], v[20:23], a[160:163], v[32:35]
    ds_read_b128 v[12:15], v4 offset:25600
    s_waitcnt vmcnt(15)
    v_mfma_f32_16x16x32_bf16 v[40:43], v[20:23], a[164:167], v[40:43]
    s_waitcnt vmcnt(14)
    v_mfma_f32_16x16x32_bf16 v[48:51], v[20:23], a[168:171], v[48:51]
    s_waitcnt vmcnt(13)
    v_mfma_f32_16x16x32_bf16 v[56:59], v[20:23], a[172:175], v[56:59]
    s_waitcnt lgkmcnt(3)
    v_mfma_f32_16x16x32_bf16 v[36:39], v[24:27], a[160:163], v[36:39]
    ds_read_b128 v[16:19], v4 offset:26624
    v_mfma_f32_16x16x32_bf16 v[44:47], v[24:27], a[164:167], v[44:47]
    v_mfma_f32_16x16x32_bf16 v[52:55], v[24:27], a[168:171], v[52:55]
    v_mfma_f32_16x16x32_bf16 v[60:63], v[24:27], a[172:175], v[60:63]
    s_waitcnt vmcnt(12) lgkmcnt(3)
    v_mfma_f32_16x16x32_bf16 v[32:35], v[28:31], a[176:179], v[32:35]
    ds_read_b128 v[20:23], v4 offset:27648
    s_waitcnt vmcnt(11)
    v_mfma_f32_16x16x32_bf16 v[40:43], v[28:31], a[180:183], v[40:43]
    s_waitcnt vmcnt(10)
    v_mfma_f32_16x16x32_bf16 v[48:51], v[28:31], a[184:187], v[48:51]
    s_waitcnt vmcnt(9)
    v_mfma_f32_16x16x32_bf16 v[56:59], v[28:31], a[188:191], v[56:59]
    s_waitcnt lgkmcnt(3)
    v_mfma_f32_16x16x32_bf16 v[36:39], v[8:11], a[176:179], v[36:39]
    ds_read_b128 v[24:27], v4 offset:28672
    v_mfma_f32_16x16x32_bf16 v[44:47], v[8:11], a[180:183], v[44:47]
    v_mfma_f32_16x16x32_bf16 v[52:55], v[8:11], a[184:187], v[52:55]
    v_mfma_f32_16x16x32_bf16 v[60:63], v[8:11], a[188:191], v[60:63]
    s_waitcnt vmcnt(8) lgkmcnt(3)
    v_mfma_f32_16x16x32_bf16 v[32:35], v[12:15], a[192:195], v[32:35]
    ds_read_b128 v[28:31], v4 offset:29696
    s_waitcnt vmcnt(7)
    v_mfma_f32_16x16x32_bf16 v[40:43], v[12:15], a[196:199], v[40:43]
    s_waitcnt vmcnt(6)
    v_mfma_f32_16x16x32_bf16 v[48:51], v[12:15], a[200:203], v[48:51]
    s_waitcnt vmcnt(5)
    v_mfma_f32_16x16x32_bf16 v[56:59], v[12:15], a[204:207], v[56:59]
    s_waitcnt lgkmcnt(3)
    v_mfma_f32_16x16x32_bf16 v[36:39], v[16:19], a[192:195], v[36:39]
    ds_read_b128 v[8:11], v4 offset:30720
    v_mfma_f32_16x16x32_bf16 v[44:47], v[16:19], a[196:199], v[44:47]
    v_mfma_f32_16x16x32_bf16 v[52:55], v[16:19], a[200:203], v[52:55]
    v_mfma_f32_16x16x32_bf16 v[60:63], v[16:19], a[204:207], v[60:63]
    s_waitcnt lgkmcnt(3)
    v_mfma_f32_16x16x32_bf16 v[64:67], v[20:23], a[64:67], v[64:67]
    ds_read_b128 v[12:15], v4 offset:31744
    v_mfma_f32_16x16x32_bf16 v[72:75], v[20:23], a[68:71], v[72:75]
    v_mfma_f32_16x16x32_bf16 v[80:83], v[20:23], a[72:75], v[80:83]
    v_mfma_f32_16x16x32_bf16 v[88:91], v[20:23], a[76:79], v[88:91]
    v_cvt_pk_bf16_f32 v32, v32, v33
    v_cvt_pk_bf16_f32 v33, v34, v35
    s_waitcnt lgkmcnt(3)
    v_mfma_f32_16x16x32_bf16 v[68:71], v[24:27], a[64:67], v[68:71]
    ds_read_b128 v[16:19], v4 offset:32768
    v_cvt_pk_bf16_f32 v34, v36, v37
    v_mfma_f32_16x16x32_bf16 v[76:79], v[24:27], a[68:71], v[76:79]
    v_cvt_pk_bf16_f32 v35, v38, v39
    s_add_u32 s70, s69, 0
    v_mfma_f32_16x16x32_bf16 v[84:87], v[24:27], a[72:75], v[84:87]
    buffer_store_dwordx4 v[32:35], v2, s[4:7], s70 offen sc1
    v_cvt_pk_bf16_f32 v40, v40, v41
    v_mfma_f32_16x16x32_bf16 v[92:95], v[24:27], a[76:79], v[92:95]
    v_cvt_pk_bf16_f32 v41, v42, v43
    v_cvt_pk_bf16_f32 v42, v44, v45
    s_waitcnt lgkmcnt(3)
    v_mfma_f32_16x16x32_bf16 v[64:67], v[28:31], a[80:83], v[64:67]
    ds_read_b128 v[20:23], v4 offset:33792
    v_cvt_pk_bf16_f32 v43, v46, v47
    v_mfma_f32_16x16x32_bf16 v[72:75], v[28:31], a[84:87], v[72:75]
    s_add_u32 s70, s69, 18432
    v_mfma_f32_16x16x32_bf16 v[80:83], v[28:31], a[88:91], v[80:83]
    buffer_store_dwordx4 v[40:43], v2, s[4:7], s70 offen sc1
    v_cvt_pk_bf16_f32 v48, v48, v49
    v_mfma_f32_16x16x32_bf16 v[88:91], v[28:31], a[92:95], v[88:91]
    v_cvt_pk_bf16_f32 v49, v50, v51
    v_cvt_pk_bf16_f32 v50, v52, v53
    s_waitcnt lgkmcnt(3)
    v_mfma_f32_16x16x32_bf16 v[68:71], v[8:11], a[80:83], v[68:71]
    ds_read_b128 v[24:27], v4 offset:34816
    v_cvt_pk_bf16_f32 v51, v54, v55
    v_mfma_f32_16x16x32_bf16 v[76:79], v[8:11], a[84:87], v[76:79]
    s_add_u32 s70, s69, 36864
    v_mfma_f32_16x16x32_bf16 v[84:87], v[8:11], a[88:91], v[84:87]
    buffer_store_dwordx4 v[48:51], v2, s[4:7], s70 offen sc1
    v_cvt_pk_bf16_f32 v56, v56, v57
    v_mfma_f32_16x16x32_bf16 v[92:95], v[8:11], a[92:95], v[92:95]
    v_cvt_pk_bf16_f32 v57, v58, v59
    v_cvt_pk_bf16_f32 v58, v60, v61
    s_waitcnt lgkmcnt(3)
    v_mfma_f32_16x16x32_bf16 v[64:67], v[12:15], a[96:99], v[64:67]
    ds_read_b128 v[28:31], v4 offset:35840
    v_cvt_pk_bf16_f32 v59, v62, v63
    v_mfma_f32_16x16x32_bf16 v[72:75], v[12:15], a[100:103], v[72:75]
    s_add_u32 s70, s69, 55296
    v_mfma_f32_16x16x32_bf16 v[80:83], v[12:15], a[104:107], v[80:83]
    buffer_store_dwordx4 v[56:59], v2, s[4:7], s70 offen sc1
    v_mfma_f32_16x16x32_bf16 v[88:91], v[12:15], a[108:111], v[88:91]
    s_waitcnt lgkmcnt(3)
    v_mfma_f32_16x16x32_bf16 v[68:71], v[16:19], a[96:99], v[68:71]
    s_barrier
    v_mfma_f32_16x16x32_bf16 v[76:79], v[16:19], a[100:103], v[76:79]
    v_add_u32 v4, 0xfffe5000, v4
    ds_read_b128 v[8:11], v4 offset:0
    v_mfma_f32_16x16x32_bf16 v[84:87], v[16:19], a[104:107], v[84:87]
    v_mfma_f32_16x16x32_bf16 v[92:95], v[16:19], a[108:111], v[92:95]
    s_waitcnt lgkmcnt(3)
    v_mfma_f32_16x16x32_bf16 v[64:67], v[20:23], a[112:115], v[64:67]
    ds_read_b128 v[12:15], v4 offset:1024
    v_mfma_f32_16x16x32_bf16 v[72:75], v[20:23], a[116:119], v[72:75]
    v_mfma_f32_16x16x32_bf16 v[80:83], v[20:23], a[120:123], v[80:83]
    v_mfma_f32_16x16x32_bf16 v[88:91], v[20:23], a[124:127], v[88:91]
    s_waitcnt lgkmcnt(3)
    v_mfma_f32_16x16x32_bf16 v[68:71], v[24:27], a[112:115], v[68:71]
    ds_read_b128 v[16:19], v4 offset:2048
    v_mfma_f32_16x16x32_bf16 v[76:79], v[24:27], a[116:119], v[76:79]
    v_mfma_f32_16x16x32_bf16 v[84:87], v[24:27], a[120:123], v[84:87]
    v_mfma_f32_16x16x32_bf16 v[92:95], v[24:27], a[124:127], v[92:95]
    s_waitcnt lgkmcnt(3)
    v_mfma_f32_16x16x32_bf16 v[64:67], v[28:31], a[128:131], v[64:67]
    ds_read_b128 v[20:23], v4 offset:3072
    v_mfma_f32_16x16x32_bf16 v[72:75], v[28:31], a[132:135], v[72:75]
    v_mfma_f32_16x16x32_bf16 v[80:83], v[28:31], a[136:139], v[80:83]
    v_mfma_f32_16x16x32_bf16 v[88:91], v[28:31], a[140:143], v[88:91]
    s_waitcnt lgkmcnt(3)
    v_mfma_f32_16x16x32_bf16 v[68:71], v[8:11], a[128:131], v[68:71]
    ds_read_b128 v[24:27], v4 offset:4096
    v_mfma_f32_16x16x32_bf16 v[76:79], v[8:11], a[132:135], v[76:79]
    v_mfma_f32_16x16x32_bf16 v[84:87], v[8:11], a[136:139], v[84:87]
    v_mfma_f32_16x16x32_bf16 v[92:95], v[8:11], a[140:143], v[92:95]
    s_waitcnt lgkmcnt(3)
    v_mfma_f32_16x16x32_bf16 v[64:67], v[12:15], a[144:147], v[64:67]
    ds_read_b128 v[28:31], v4 offset:5120
    v_mfma_f32_16x16x32_bf16 v[72:75], v[12:15], a[148:151], v[72:75]
    v_mfma_f32_16x16x32_bf16 v[80:83], v[12:15], a[152:155], v[80:83]
    v_mfma_f32_16x16x32_bf16 v[88:91], v[12:15], a[156:159], v[88:91]
    s_waitcnt lgkmcnt(3)
    v_mfma_f32_16x16x32_bf16 v[68:71], v[16:19], a[144:147], v[68:71]
    ds_read_b128 v[8:11], v4 offset:6144
    v_mfma_f32_16x16x32_bf16 v[76:79], v[16:19], a[148:151], v[76:79]
    v_mfma_f32_16x16x32_bf16 v[84:87], v[16:19], a[152:155], v[84:87]
    v_mfma_f32_16x16x32_bf16 v[92:95], v[16:19], a[156:159], v[92:95]
    s_waitcnt lgkmcnt(3)
    v_mfma_f32_16x16x32_bf16 v[64:67], v[20:23], a[160:163], v[64:67]
    ds_read_b128 v[12:15], v4 offset:7168
    v_mfma_f32_16x16x32_bf16 v[72:75], v[20:23], a[164:167], v[72:75]
    v_mfma_f32_16x16x32_bf16 v[80:83], v[20:23], a[168:171], v[80:83]
    v_mfma_f32_16x16x32_bf16 v[88:91], v[20:23], a[172:175], v[88:91]
    s_waitcnt lgkmcnt(3)
    v_mfma_f32_16x16x32_bf16 v[68:71], v[24:27], a[160:163], v[68:71]
    ds_read_b128 v[16:19], v4 offset:8192
    v_mfma_f32_16x16x32_bf16 v[76:79], v[24:27], a[164:167], v[76:79]
    v_mfma_f32_16x16x32_bf16 v[84:87], v[24:27], a[168:171], v[84:87]
    v_mfma_f32_16x16x32_bf16 v[92:95], v[24:27], a[172:175], v[92:95]
    s_waitcnt lgkmcnt(3)
    v_mfma_f32_16x16x32_bf16 v[64:67], v[28:31], a[176:179], v[64:67]
    ds_read_b128 v[20:23], v4 offset:9216
    v_mfma_f32_16x16x32_bf16 v[72:75], v[28:31], a[180:183], v[72:75]
    v_mfma_f32_16x16x32_bf16 v[80:83], v[28:31], a[184:187], v[80:83]
    v_mfma_f32_16x16x32_bf16 v[88:91], v[28:31], a[188:191], v[88:91]
    s_waitcnt lgkmcnt(3)
    v_mfma_f32_16x16x32_bf16 v[68:71], v[8:11], a[176:179], v[68:71]
    ds_read_b128 v[24:27], v4 offset:10240
    v_mfma_f32_16x16x32_bf16 v[76:79], v[8:11], a[180:183], v[76:79]
    v_mfma_f32_16x16x32_bf16 v[84:87], v[8:11], a[184:187], v[84:87]
    v_mfma_f32_16x16x32_bf16 v[92:95], v[8:11], a[188:191], v[92:95]
    s_waitcnt lgkmcnt(3)
    v_mfma_f32_16x16x32_bf16 v[64:67], v[12:15], a[192:195], v[64:67]
    ds_read_b128 v[28:31], v4 offset:11264
    v_mfma_f32_16x16x32_bf16 v[72:75], v[12:15], a[196:199], v[72:75]
    v_mfma_f32_16x16x32_bf16 v[80:83], v[12:15], a[200:203], v[80:83]
    v_mfma_f32_16x16x32_bf16 v[88:91], v[12:15], a[204:207], v[88:91]
    s_waitcnt lgkmcnt(3)
    v_mfma_f32_16x16x32_bf16 v[68:71], v[16:19], a[192:195], v[68:71]
    ds_read_b128 v[8:11], v4 offset:12288
    v_mfma_f32_16x16x32_bf16 v[76:79], v[16:19], a[196:199], v[76:79]
    v_mfma_f32_16x16x32_bf16 v[84:87], v[16:19], a[200:203], v[84:87]
    v_mfma_f32_16x16x32_bf16 v[92:95], v[16:19], a[204:207], v[92:95]
    s_waitcnt lgkmcnt(3)
    v_mfma_f32_16x16x32_bf16 v[96:99], v[20:23], a[64:67], v[96:99]
    ds_read_b128 v[12:15], v4 offset:13312
    v_mfma_f32_16x16x32_bf16 v[104:107], v[20:23], a[68:71], v[104:107]
    v_mfma_f32_16x16x32_bf16 v[112:115], v[20:23], a[72:75], v[112:115]
    v_mfma_f32_16x16x32_bf16 v[120:123], v[20:23], a[76:79], v[120:123]
    v_cvt_pk_bf16_f32 v64, v64, v65
    v_cvt_pk_bf16_f32 v65, v66, v67
    s_waitcnt lgkmcnt(3)
    v_mfma_f32_16x16x32_bf16 v[100:103], v[24:27], a[64:67], v[100:103]
    ds_read_b128 v[16:19], v4 offset:14336
    v_cvt_pk_bf16_f32 v66, v68, v69
    v_mfma_f32_16x16x32_bf16 v[108:111], v[24:27], a[68:71], v[108:111]
    v_cvt_pk_bf16_f32 v67, v70, v71
    s_add_u32 s70, s69, 1024
    v_mfma_f32_16x16x32_bf16 v[116:119], v[24:27], a[72:75], v[116:119]
    buffer_store_dwordx4 v[64:67], v2, s[4:7], s70 offen sc1
    v_cvt_pk_bf16_f32 v72, v72, v73
    v_mfma_f32_16x16x32_bf16 v[124:127], v[24:27], a[76:79], v[124:127]
    v_cvt_pk_bf16_f32 v73, v74, v75
    v_cvt_pk_bf16_f32 v74, v76, v77
    s_waitcnt lgkmcnt(3)
    v_mfma_f32_16x16x32_bf16 v[96:99], v[28:31], a[80:83], v[96:99]
    ds_read_b128 v[20:23], v4 offset:15360
    v_cvt_pk_bf16_f32 v75, v78, v79
    v_mfma_f32_16x16x32_bf16 v[104:107], v[28:31], a[84:87], v[104:107]
    s_add_u32 s70, s69, 19456
    v_mfma_f32_16x16x32_bf16 v[112:115], v[28:31], a[88:91], v[112:115]
    buffer_store_dwordx4 v[72:75], v2, s[4:7], s70 offen sc1
    v_cvt_pk_bf16_f32 v80, v80, v81
    v_mfma_f32_16x16x32_bf16 v[120:123], v[28:31], a[92:95], v[120:123]
    v_cvt_pk_bf16_f32 v81, v82, v83
    v_cvt_pk_bf16_f32 v82, v84, v85
    s_waitcnt lgkmcnt(3)
    v_mfma_f32_16x16x32_bf16 v[100:103], v[8:11], a[80:83], v[100:103]
    ds_read_b128 v[24:27], v4 offset:16384
    v_cvt_pk_bf16_f32 v83, v86, v87
    v_mfma_f32_16x16x32_bf16 v[108:111], v[8:11], a[84:87], v[108:111]
    s_add_u32 s70, s69, 37888
    v_mfma_f32_16x16x32_bf16 v[116:119], v[8:11], a[88:91], v[116:119]
    buffer_store_dwordx4 v[80:83], v2, s[4:7], s70 offen sc1
    v_cvt_pk_bf16_f32 v88, v88, v89
    v_mfma_f32_16x16x32_bf16 v[124:127], v[8:11], a[92:95], v[124:127]
    v_cvt_pk_bf16_f32 v89, v90, v91
    v_cvt_pk_bf16_f32 v90, v92, v93
    s_waitcnt lgkmcnt(3)
    v_mfma_f32_16x16x32_bf16 v[96:99], v[12:15], a[96:99], v[96:99]
    ds_read_b128 v[28:31], v4 offset:17408
    v_cvt_pk_bf16_f32 v91, v94, v95
    v_mfma_f32_16x16x32_bf16 v[104:107], v[12:15], a[100:103], v[104:107]
    s_add_u32 s70, s69, 56320
    v_mfma_f32_16x16x32_bf16 v[112:115], v[12:15], a[104:107], v[112:115]
    buffer_store_dwordx4 v[88:91], v2, s[4:7], s70 offen sc1
    v_mfma_f32_16x16x32_bf16 v[120:123], v[12:15], a[108:111], v[120:123]
    s_waitcnt lgkmcnt(3)
    v_mfma_f32_16x16x32_bf16 v[100:103], v[16:19], a[96:99], v[100:103]
    ds_read_b128 v[8:11], v4 offset:18432
    v_mfma_f32_16x16x32_bf16 v[108:111], v[16:19], a[100:103], v[108:111]
    v_mfma_f32_16x16x32_bf16 v[116:119], v[16:19], a[104:107], v[116:119]
    v_mfma_f32_16x16x32_bf16 v[124:127], v[16:19], a[108:111], v[124:127]
    s_waitcnt lgkmcnt(3)
    v_mfma_f32_16x16x32_bf16 v[96:99], v[20:23], a[112:115], v[96:99]
    ds_read_b128 v[12:15], v4 offset:19456
    v_mfma_f32_16x16x32_bf16 v[104:107], v[20:23], a[116:119], v[104:107]
    v_mfma_f32_16x16x32_bf16 v[112:115], v[20:23], a[120:123], v[112:115]
    v_mfma_f32_16x16x32_bf16 v[120:123], v[20:23], a[124:127], v[120:123]
    s_waitcnt lgkmcnt(3)
    v_mfma_f32_16x16x32_bf16 v[100:103], v[24:27], a[112:115], v[100:103]
    ds_read_b128 v[16:19], v4 offset:20480
    v_mfma_f32_16x16x32_bf16 v[108:111], v[24:27], a[116:119], v[108:111]
    v_mfma_f32_16x16x32_bf16 v[116:119], v[24:27], a[120:123], v[116:119]
    v_mfma_f32_16x16x32_bf16 v[124:127], v[24:27], a[124:127], v[124:127]
    s_waitcnt lgkmcnt(3)
    v_mfma_f32_16x16x32_bf16 v[96:99], v[28:31], a[128:131], v[96:99]
    ds_read_b128 v[20:23], v4 offset:21504
    v_mfma_f32_16x16x32_bf16 v[104:107], v[28:31], a[132:135], v[104:107]
    v_mfma_f32_16x16x32_bf16 v[112:115], v[28:31], a[136:139], v[112:115]
    v_mfma_f32_16x16x32_bf16 v[120:123], v[28:31], a[140:143], v[120:123]
    s_waitcnt lgkmcnt(3)
    v_mfma_f32_16x16x32_bf16 v[100:103], v[8:11], a[128:131], v[100:103]
    ds_read_b128 v[24:27], v4 offset:22528
    v_mfma_f32_16x16x32_bf16 v[108:111], v[8:11], a[132:135], v[108:111]
    v_mfma_f32_16x16x32_bf16 v[116:119], v[8:11], a[136:139], v[116:119]
    v_mfma_f32_16x16x32_bf16 v[124:127], v[8:11], a[140:143], v[124:127]
    s_waitcnt lgkmcnt(3)
    v_mfma_f32_16x16x32_bf16 v[96:99], v[12:15], a[144:147], v[96:99]
    ds_read_b128 v[28:31], v4 offset:23552
    v_mfma_f32_16x16x32_bf16 v[104:107], v[12:15], a[148:151], v[104:107]
    v_mfma_f32_16x16x32_bf16 v[112:115], v[12:15], a[152:155], v[112:115]
    v_mfma_f32_16x16x32_bf16 v[120:123], v[12:15], a[156:159], v[120:123]
    s_waitcnt lgkmcnt(3)
    v_mfma_f32_16x16x32_bf16 v[100:103], v[16:19], a[144:147], v[100:103]
    ds_read_b128 v[8:11], v4 offset:24576
    v_mfma_f32_16x16x32_bf16 v[108:111], v[16:19], a[148:151], v[108:111]
    v_mfma_f32_16x16x32_bf16 v[116:119], v[16:19], a[152:155], v[116:119]
    v_mfma_f32_16x16x32_bf16 v[124:127], v[16:19], a[156:159], v[124:127]
    s_waitcnt lgkmcnt(3)
    v_mfma_f32_16x16x32_bf16 v[96:99], v[20:23], a[160:163], v[96:99]
    ds_read_b128 v[12:15], v4 offset:25600
    v_mfma_f32_16x16x32_bf16 v[104:107], v[20:23], a[164:167], v[104:107]
    v_mfma_f32_16x16x32_bf16 v[112:115], v[20:23], a[168:171], v[112:115]
    v_mfma_f32_16x16x32_bf16 v[120:123], v[20:23], a[172:175], v[120:123]
    s_waitcnt lgkmcnt(3)
    v_mfma_f32_16x16x32_bf16 v[100:103], v[24:27], a[160:163], v[100:103]
    ds_read_b128 v[16:19], v4 offset:26624
    v_mfma_f32_16x16x32_bf16 v[108:111], v[24:27], a[164:167], v[108:111]
    v_mfma_f32_16x16x32_bf16 v[116:119], v[24:27], a[168:171], v[116:119]
    v_mfma_f32_16x16x32_bf16 v[124:127], v[24:27], a[172:175], v[124:127]
    s_waitcnt lgkmcnt(3)
    v_mfma_f32_16x16x32_bf16 v[96:99], v[28:31], a[176:179], v[96:99]
    ds_read_b128 v[20:23], v4 offset:27648
    v_mfma_f32_16x16x32_bf16 v[104:107], v[28:31], a[180:183], v[104:107]
    v_mfma_f32_16x16x32_bf16 v[112:115], v[28:31], a[184:187], v[112:115]
    v_mfma_f32_16x16x32_bf16 v[120:123], v[28:31], a[188:191], v[120:123]
    s_waitcnt lgkmcnt(3)
    v_mfma_f32_16x16x32_bf16 v[100:103], v[8:11], a[176:179], v[100:103]
    ds_read_b128 v[24:27], v4 offset:28672
    v_mfma_f32_16x16x32_bf16 v[108:111], v[8:11], a[180:183], v[108:111]
    v_mfma_f32_16x16x32_bf16 v[116:119], v[8:11], a[184:187], v[116:119]
    v_mfma_f32_16x16x32_bf16 v[124:127], v[8:11], a[188:191], v[124:127]
    s_waitcnt lgkmcnt(3)
    v_mfma_f32_16x16x32_bf16 v[96:99], v[12:15], a[192:195], v[96:99]
    ds_read_b128 v[28:31], v4 offset:29696
    v_mfma_f32_16x16x32_bf16 v[104:107], v[12:15], a[196:199], v[104:107]
    v_mfma_f32_16x16x32_bf16 v[112:115], v[12:15], a[200:203], v[112:115]
    v_mfma_f32_16x16x32_bf16 v[120:123], v[12:15], a[204:207], v[120:123]
    s_waitcnt lgkmcnt(3)
    v_mfma_f32_16x16x32_bf16 v[100:103], v[16:19], a[192:195], v[100:103]
    ds_read_b128 v[8:11], v4 offset:30720
    v_mfma_f32_16x16x32_bf16 v[108:111], v[16:19], a[196:199], v[108:111]
    v_mfma_f32_16x16x32_bf16 v[116:119], v[16:19], a[200:203], v[116:119]
    v_mfma_f32_16x16x32_bf16 v[124:127], v[16:19], a[204:207], v[124:127]
    s_waitcnt lgkmcnt(3)
    v_mfma_f32_16x16x32_bf16 v[128:131], v[20:23], a[64:67], v[128:131]
    ds_read_b128 v[12:15], v4 offset:31744
    v_mfma_f32_16x16x32_bf16 v[136:139], v[20:23], a[68:71], v[136:139]
    v_mfma_f32_16x16x32_bf16 v[144:147], v[20:23], a[72:75], v[144:147]
    v_mfma_f32_16x16x32_bf16 v[152:155], v[20:23], a[76:79], v[152:155]
    v_cvt_pk_bf16_f32 v96, v96, v97
    v_cvt_pk_bf16_f32 v97, v98, v99
    s_waitcnt lgkmcnt(3)
    v_mfma_f32_16x16x32_bf16 v[132:135], v[24:27], a[64:67], v[132:135]
    ds_read_b128 v[16:19], v4 offset:32768
    v_cvt_pk_bf16_f32 v98, v100, v101
    v_mfma_f32_16x16x32_bf16 v[140:143], v[24:27], a[68:71], v[140:143]
    v_cvt_pk_bf16_f32 v99, v102, v103
    s_add_u32 s70, s69, 2048
    v_mfma_f32_16x16x32_bf16 v[148:151], v[24:27], a[72:75], v[148:151]
    buffer_store_dwordx4 v[96:99], v2, s[4:7], s70 offen sc1
    v_cvt_pk_bf16_f32 v104, v104, v105
    v_mfma_f32_16x16x32_bf16 v[156:159], v[24:27], a[76:79], v[156:159]
    v_cvt_pk_bf16_f32 v105, v106, v107
    v_cvt_pk_bf16_f32 v106, v108, v109
    s_waitcnt lgkmcnt(3)
    v_mfma_f32_16x16x32_bf16 v[128:131], v[28:31], a[80:83], v[128:131]
    ds_read_b128 v[20:23], v4 offset:33792
    v_cvt_pk_bf16_f32 v107, v110, v111
    v_mfma_f32_16x16x32_bf16 v[136:139], v[28:31], a[84:87], v[136:139]
    s_add_u32 s70, s69, 20480
    v_mfma_f32_16x16x32_bf16 v[144:147], v[28:31], a[88:91], v[144:147]
    buffer_store_dwordx4 v[104:107], v2, s[4:7], s70 offen sc1
    v_cvt_pk_bf16_f32 v112, v112, v113
    v_mfma_f32_16x16x32_bf16 v[152:155], v[28:31], a[92:95], v[152:155]
    v_cvt_pk_bf16_f32 v113, v114, v115
    v_cvt_pk_bf16_f32 v114, v116, v117
    s_waitcnt lgkmcnt(3)
    v_mfma_f32_16x16x32_bf16 v[132:135], v[8:11], a[80:83], v[132:135]
    ds_read_b128 v[24:27], v4 offset:34816
    v_cvt_pk_bf16_f32 v115, v118, v119
    v_mfma_f32_16x16x32_bf16 v[140:143], v[8:11], a[84:87], v[140:143]
    s_add_u32 s70, s69, 38912
    v_mfma_f32_16x16x32_bf16 v[148:151], v[8:11], a[88:91], v[148:151]
    buffer_store_dwordx4 v[112:115], v2, s[4:7], s70 offen sc1
    v_cvt_pk_bf16_f32 v120, v120, v121
    v_mfma_f32_16x16x32_bf16 v[156:159], v[8:11], a[92:95], v[156:159]
    v_cvt_pk_bf16_f32 v121, v122, v123
    v_cvt_pk_bf16_f32 v122, v124, v125
    s_waitcnt lgkmcnt(3)
    v_mfma_f32_16x16x32_bf16 v[128:131], v[12:15], a[96:99], v[128:131]
    ds_read_b128 v[28:31], v4 offset:35840
    v_cvt_pk_bf16_f32 v123, v126, v127
    v_mfma_f32_16x16x32_bf16 v[136:139], v[12:15], a[100:103], v[136:139]
    s_add_u32 s70, s69, 57344
    v_mfma_f32_16x16x32_bf16 v[144:147], v[12:15], a[104:107], v[144:147]
    buffer_store_dwordx4 v[120:123], v2, s[4:7], s70 offen sc1
    v_mfma_f32_16x16x32_bf16 v[152:155], v[12:15], a[108:111], v[152:155]
    s_waitcnt lgkmcnt(3)
    v_mfma_f32_16x16x32_bf16 v[132:135], v[16:19], a[96:99], v[132:135]
    s_waitcnt vmcnt(12)
    s_barrier
    v_mfma_f32_16x16x32_bf16 v[140:143], v[16:19], a[100:103], v[140:143]
    v_add_u32 v4, 0x9000, v4
    ds_read_b128 v[8:11], v4 offset:0
    v_mfma_f32_16x16x32_bf16 v[148:151], v[16:19], a[104:107], v[148:151]
    v_mfma_f32_16x16x32_bf16 v[156:159], v[16:19], a[108:111], v[156:159]
    s_waitcnt lgkmcnt(3)
    v_mfma_f32_16x16x32_bf16 v[128:131], v[20:23], a[112:115], v[128:131]
    ds_read_b128 v[12:15], v4 offset:1024
    v_mfma_f32_16x16x32_bf16 v[136:139], v[20:23], a[116:119], v[136:139]
    v_mfma_f32_16x16x32_bf16 v[144:147], v[20:23], a[120:123], v[144:147]
    v_mfma_f32_16x16x32_bf16 v[152:155], v[20:23], a[124:127], v[152:155]
    s_waitcnt lgkmcnt(3)
    v_mfma_f32_16x16x32_bf16 v[132:135], v[24:27], a[112:115], v[132:135]
    ds_read_b128 v[16:19], v4 offset:2048
    v_mfma_f32_16x16x32_bf16 v[140:143], v[24:27], a[116:119], v[140:143]
    v_mfma_f32_16x16x32_bf16 v[148:151], v[24:27], a[120:123], v[148:151]
    v_mfma_f32_16x16x32_bf16 v[156:159], v[24:27], a[124:127], v[156:159]
    s_waitcnt lgkmcnt(3)
    v_mfma_f32_16x16x32_bf16 v[128:131], v[28:31], a[128:131], v[128:131]
    ds_read_b128 v[20:23], v4 offset:3072
    v_mfma_f32_16x16x32_bf16 v[136:139], v[28:31], a[132:135], v[136:139]
    v_mfma_f32_16x16x32_bf16 v[144:147], v[28:31], a[136:139], v[144:147]
    v_mfma_f32_16x16x32_bf16 v[152:155], v[28:31], a[140:143], v[152:155]
    s_waitcnt lgkmcnt(3)
    v_mfma_f32_16x16x32_bf16 v[132:135], v[8:11], a[128:131], v[132:135]
    ds_read_b128 v[24:27], v4 offset:4096
    v_mfma_f32_16x16x32_bf16 v[140:143], v[8:11], a[132:135], v[140:143]
    v_mfma_f32_16x16x32_bf16 v[148:151], v[8:11], a[136:139], v[148:151]
    v_mfma_f32_16x16x32_bf16 v[156:159], v[8:11], a[140:143], v[156:159]
    s_waitcnt lgkmcnt(3)
    v_mfma_f32_16x16x32_bf16 v[128:131], v[12:15], a[144:147], v[128:131]
    ds_read_b128 v[28:31], v4 offset:5120
    v_mfma_f32_16x16x32_bf16 v[136:139], v[12:15], a[148:151], v[136:139]
    v_mfma_f32_16x16x32_bf16 v[144:147], v[12:15], a[152:155], v[144:147]
    v_mfma_f32_16x16x32_bf16 v[152:155], v[12:15], a[156:159], v[152:155]
    s_waitcnt lgkmcnt(3)
    v_mfma_f32_16x16x32_bf16 v[132:135], v[16:19], a[144:147], v[132:135]
    ds_read_b128 v[8:11], v4 offset:6144
    v_mfma_f32_16x16x32_bf16 v[140:143], v[16:19], a[148:151], v[140:143]
    v_mfma_f32_16x16x32_bf16 v[148:151], v[16:19], a[152:155], v[148:151]
    v_mfma_f32_16x16x32_bf16 v[156:159], v[16:19], a[156:159], v[156:159]
    s_waitcnt lgkmcnt(3)
    v_mfma_f32_16x16x32_bf16 v[128:131], v[20:23], a[160:163], v[128:131]
    ds_read_b128 v[12:15], v4 offset:7168
    v_mfma_f32_16x16x32_bf16 v[136:139], v[20:23], a[164:167], v[136:139]
    v_mfma_f32_16x16x32_bf16 v[144:147], v[20:23], a[168:171], v[144:147]
    v_mfma_f32_16x16x32_bf16 v[152:155], v[20:23], a[172:175], v[152:155]
    s_waitcnt lgkmcnt(3)
    v_mfma_f32_16x16x32_bf16 v[132:135], v[24:27], a[160:163], v[132:135]
    ds_read_b128 v[16:19], v4 offset:8192
    v_mfma_f32_16x16x32_bf16 v[140:143], v[24:27], a[164:167], v[140:143]
    v_mfma_f32_16x16x32_bf16 v[148:151], v[24:27], a[168:171], v[148:151]
    v_mfma_f32_16x16x32_bf16 v[156:159], v[24:27], a[172:175], v[156:159]
    s_waitcnt lgkmcnt(3)
    v_mfma_f32_16x16x32_bf16 v[128:131], v[28:31], a[176:179], v[128:131]
    ds_read_b128 v[20:23], v4 offset:9216
    v_mfma_f32_16x16x32_bf16 v[136:139], v[28:31], a[180:183], v[136:139]
    v_mfma_f32_16x16x32_bf16 v[144:147], v[28:31], a[184:187], v[144:147]
    v_mfma_f32_16x16x32_bf16 v[152:155], v[28:31], a[188:191], v[152:155]
    s_waitcnt lgkmcnt(3)
    v_mfma_f32_16x16x32_bf16 v[132:135], v[8:11], a[176:179], v[132:135]
    ds_read_b128 v[24:27], v4 offset:10240
    v_mfma_f32_16x16x32_bf16 v[140:143], v[8:11], a[180:183], v[140:143]
    v_mfma_f32_16x16x32_bf16 v[148:151], v[8:11], a[184:187], v[148:151]
    v_mfma_f32_16x16x32_bf16 v[156:159], v[8:11], a[188:191], v[156:159]
    s_waitcnt lgkmcnt(3)
    v_mfma_f32_16x16x32_bf16 v[128:131], v[12:15], a[192:195], v[128:131]
    ds_read_b128 v[28:31], v4 offset:11264
    v_mfma_f32_16x16x32_bf16 v[136:139], v[12:15], a[196:199], v[136:139]
    v_mfma_f32_16x16x32_bf16 v[144:147], v[12:15], a[200:203], v[144:147]
    v_mfma_f32_16x16x32_bf16 v[152:155], v[12:15], a[204:207], v[152:155]
    s_waitcnt lgkmcnt(3)
    v_mfma_f32_16x16x32_bf16 v[132:135], v[16:19], a[192:195], v[132:135]
    ds_read_b128 v[8:11], v4 offset:12288
    v_mfma_f32_16x16x32_bf16 v[140:143], v[16:19], a[196:199], v[140:143]
    v_mfma_f32_16x16x32_bf16 v[148:151], v[16:19], a[200:203], v[148:151]
    v_mfma_f32_16x16x32_bf16 v[156:159], v[16:19], a[204:207], v[156:159]
    s_waitcnt lgkmcnt(3)
    v_mfma_f32_16x16x32_bf16 v[160:163], v[20:23], a[64:67], v[160:163]
    ds_read_b128 v[12:15], v4 offset:13312
    v_mfma_f32_16x16x32_bf16 v[164:167], v[20:23], a[68:71], v[164:167]
    v_mfma_f32_16x16x32_bf16 v[168:171], v[20:23], a[72:75], v[168:171]
    v_mfma_f32_16x16x32_bf16 v[172:175], v[20:23], a[76:79], v[172:175]
    v_cvt_pk_bf16_f32 v128, v128, v129
    v_cvt_pk_bf16_f32 v129, v130, v131
    s_waitcnt lgkmcnt(3)
    v_mfma_f32_16x16x32_bf16 v[160:163], v[24:27], a[80:83], v[160:163]
    ds_read_b128 v[16:19], v4 offset:14336
    v_cvt_pk_bf16_f32 v130, v132, v133
    v_mfma_f32_16x16x32_bf16 v[164:167], v[24:27], a[84:87], v[164:167]
    v_cvt_pk_bf16_f32 v131, v134, v135
    s_add_u32 s70, s69, 3072
    v_mfma_f32_16x16x32_bf16 v[168:171], v[24:27], a[88:91], v[168:171]
    buffer_store_dwordx4 v[128:131], v2, s[4:7], s70 offen sc1
    v_cvt_pk_bf16_f32 v136, v136, v137
    v_mfma_f32_16x16x32_bf16 v[172:175], v[24:27], a[92:95], v[172:175]
    v_cvt_pk_bf16_f32 v137, v138, v139
    v_cvt_pk_bf16_f32 v138, v140, v141
    s_waitcnt lgkmcnt(3)
    v_mfma_f32_16x16x32_bf16 v[160:163], v[28:31], a[96:99], v[160:163]
    ds_read_b128 v[20:23], v4 offset:15360
    v_cvt_pk_bf16_f32 v139, v142, v143
    v_mfma_f32_16x16x32_bf16 v[164:167], v[28:31], a[100:103], v[164:167]
    s_add_u32 s70, s69, 21504
    v_mfma_f32_16x16x32_bf16 v[168:171], v[28:31], a[104:107], v[168:171]
    buffer_store_dwordx4 v[136:139], v2, s[4:7], s70 offen sc1
    v_cvt_pk_bf16_f32 v144, v144, v145
    v_mfma_f32_16x16x32_bf16 v[172:175], v[28:31], a[108:111], v[172:175]
    v_cvt_pk_bf16_f32 v145, v146, v147
    v_cvt_pk_bf16_f32 v146, v148, v149
    s_waitcnt lgkmcnt(3)
    v_mfma_f32_16x16x32_bf16 v[160:163], v[8:11], a[112:115], v[160:163]
    ds_read_b128 v[24:27], v4 offset:16384
    v_cvt_pk_bf16_f32 v147, v150, v151
    v_mfma_f32_16x16x32_bf16 v[164:167], v[8:11], a[116:119], v[164:167]
    s_add_u32 s70, s69, 39936
    v_mfma_f32_16x16x32_bf16 v[168:171], v[8:11], a[120:123], v[168:171]
    buffer_store_dwordx4 v[144:147], v2, s[4:7], s70 offen sc1
    v_cvt_pk_bf16_f32 v152, v152, v153
    v_mfma_f32_16x16x32_bf16 v[172:175], v[8:11], a[124:127], v[172:175]
    v_cvt_pk_bf16_f32 v153, v154, v155
    v_cvt_pk_bf16_f32 v154, v156, v157
    s_waitcnt lgkmcnt(3)
    v_mfma_f32_16x16x32_bf16 v[160:163], v[12:15], a[128:131], v[160:163]
    ds_read_b128 v[28:31], v4 offset:17408
    v_cvt_pk_bf16_f32 v155, v158, v159
    v_mfma_f32_16x16x32_bf16 v[164:167], v[12:15], a[132:135], v[164:167]
    s_add_u32 s70, s69, 58368
    v_mfma_f32_16x16x32_bf16 v[168:171], v[12:15], a[136:139], v[168:171]
    buffer_store_dwordx4 v[152:155], v2, s[4:7], s70 offen sc1
    v_mfma_f32_16x16x32_bf16 v[172:175], v[12:15], a[140:143], v[172:175]
    s_waitcnt lgkmcnt(3)
    v_mfma_f32_16x16x32_bf16 v[160:163], v[16:19], a[144:147], v[160:163]
    v_mfma_f32_16x16x32_bf16 v[164:167], v[16:19], a[148:151], v[164:167]
    v_mfma_f32_16x16x32_bf16 v[168:171], v[16:19], a[152:155], v[168:171]
    v_mfma_f32_16x16x32_bf16 v[172:175], v[16:19], a[156:159], v[172:175]
    s_waitcnt lgkmcnt(2)
    v_mfma_f32_16x16x32_bf16 v[160:163], v[20:23], a[160:163], v[160:163]
    v_mfma_f32_16x16x32_bf16 v[164:167], v[20:23], a[164:167], v[164:167]
    v_mfma_f32_16x16x32_bf16 v[168:171], v[20:23], a[168:171], v[168:171]
    v_mfma_f32_16x16x32_bf16 v[172:175], v[20:23], a[172:175], v[172:175]
    s_waitcnt lgkmcnt(1)
    v_mfma_f32_16x16x32_bf16 v[160:163], v[24:27], a[176:179], v[160:163]
    v_mfma_f32_16x16x32_bf16 v[164:167], v[24:27], a[180:183], v[164:167]
    v_mfma_f32_16x16x32_bf16 v[168:171], v[24:27], a[184:187], v[168:171]
    v_mfma_f32_16x16x32_bf16 v[172:175], v[24:27], a[188:191], v[172:175]
    s_waitcnt lgkmcnt(0)
    v_mfma_f32_16x16x32_bf16 v[160:163], v[28:31], a[192:195], v[160:163]
    v_mfma_f32_16x16x32_bf16 v[164:167], v[28:31], a[196:199], v[164:167]
    v_mfma_f32_16x16x32_bf16 v[168:171], v[28:31], a[200:203], v[168:171]
    v_mfma_f32_16x16x32_bf16 v[172:175], v[28:31], a[204:207], v[172:175]
    s_nop 4
    v_cvt_pk_bf16_f32 v160, v160, v161
    v_cvt_pk_bf16_f32 v161, v162, v163
    s_add_u32 s70, s68, 4096
    buffer_store_dwordx2 v[160:161], v0, s[4:7], s70 offen sc1
    v_cvt_pk_bf16_f32 v164, v164, v165
    v_cvt_pk_bf16_f32 v165, v166, v167
    s_add_u32 s70, s68, 22528
    buffer_store_dwordx2 v[164:165], v0, s[4:7], s70 offen sc1
    v_cvt_pk_bf16_f32 v168, v168, v169
    v_cvt_pk_bf16_f32 v169, v170, v171
    s_add_u32 s70, s68, 40960
    buffer_store_dwordx2 v[168:169], v0, s[4:7], s70 offen sc1
    v_cvt_pk_bf16_f32 v172, v172, v173
    v_cvt_pk_bf16_f32 v173, v174, v175
    s_add_u32 s70, s68, 59392
    buffer_store_dwordx2 v[172:173], v0, s[4:7], s70 offen sc1
    s_lshl_b32 s60, s44, 2
    s_add_u32 s60, s60, s20
    s_lshl_b32 s60, s60, 5
    s_add_u32 s60, s60, s47
    s_lshl_b32 s60, s60, 3
    s_add_u32 s60, s60, s101
    s_add_u32 s60, s60, 4046848
    v_mov_b32 v6, s98
    v_mov_b32 v7, s99
    s_waitcnt vmcnt(0)
    s_mov_b64 exec, 1
    buffer_store_dwordx2 v[6:7], off, s[4:7], s60 sc1
    s_mov_b64 exec, -1
    s_cmp_lg_u32 s101, 0
    s_cbranch_scc1 L_red1_24
    s_barrier
    s_lshr_b32 s44, s22, 4
    s_lshl_b32 s52, s21, 1
    s_add_u32 s44, s44, s52
    s_and_b32 s45, s22, 15
    s_mul_i32 s48, s20, 21
    s_lshr_b32 s48, s48, 1
    s_lshl_b32 s48, s48, 10
    s_mul_i32 s47, s45, 129024
    s_add_u32 s47, s47, s48
    s_add_u32 s47, s47, 0
    s_add_u32 m0, s48, 0
    s_add_u32 s53, s47, 0
    buffer_load_dwordx4 v2, s[4:7], s53 offen offset:0 lds
    buffer_load_dwordx4 v2, s[4:7], s53 offen offset:1024 lds
    buffer_load_dwordx4 v2, s[4:7], s53 offen offset:2048 lds
    buffer_load_dwordx4 v2, s[4:7], s53 offen offset:3072 lds
    s_add_u32 m0, s48, 4096
    s_add_u32 s53, s47, 4096
    buffer_load_dwordx4 v2, s[4:7], s53 offen offset:0 lds
    buffer_load_dwordx4 v2, s[4:7], s53 offen offset:1024 lds
    buffer_load_dwordx4 v2, s[4:7], s53 offen offset:2048 lds
    buffer_load_dwordx4 v2, s[4:7], s53 offen offset:3072 lds
    s_add_u32 m0, s48, 8192
    s_add_u32 s53, s47, 8192
    buffer_load_dwordx4 v2, s[4:7], s53 offen offset:0 lds
    buffer_load_dwordx4 v2, s[4:7], s53 offen offset:1024 lds
    buffer_load_dwordx4 v2, s[4:7], s53 offen offset:2048 lds
    s_add_u32 m0, s48, 43008
    s_add_u32 s53, s47, 43008
    buffer_load_dwordx4 v2, s[4:7], s53 offen offset:0 lds
    buffer_load_dwordx4 v2, s[4:7], s53 offen offset:1024 lds
    buffer_load_dwordx4 v2, s[4:7], s53 offen offset:2048 lds
    buffer_load_dwordx4 v2, s[4:7], s53 offen offset:3072 lds
    s_add_u32 m0, s48, 47104
    s_add_u32 s53, s47, 47104
    buffer_load_dwordx4 v2, s[4:7], s53 offen offset:0 lds
    buffer_load_dwordx4 v2, s[4:7], s53 offen offset:1024 lds
    buffer_load_dwordx4 v2, s[4:7], s53 offen offset:2048 lds
    buffer_load_dwordx4 v2, s[4:7], s53 offen offset:3072 lds
    s_add_u32 m0, s48, 51200
    s_add_u32 s53, s47, 51200
    buffer_load_dwordx4 v2, s[4:7], s53 offen offset:0 lds
    buffer_load_dwordx4 v2, s[4:7], s53 offen offset:1024 lds
    buffer_load_dwordx4 v2, s[4:7], s53 offen offset:2048 lds
    s_lshl_b32 s47, s21, 5
    s_add_u32 s47, s47, s22
    v_and_b32 v8, 7, v1
    v_lshrrev_b32 v9, 3, v1
    s_lshl_b32 s48, s47, 3
    v_add_u32 v3, s48, v8
    v_mul_u32_u24 v3, 1152, v3
    s_mul_i32 s48, s20, 384
    v_lshl_add_u32 v3, v9, 4, v3
    v_add_u32 v3, s48, v3
    s_lshr_b32 s48, s47, 1
    s_mul_i32 s48, s48, 18432
    s_and_b32 s49, s47, 1
    s_lshl_b32 s49, s49, 7
    s_add_u32 s48, s48, s49
    s_mul_i32 s49, s20, 6144
    s_add_u32 s48, s48, s49
    v_lshlrev_b32 v8, 4, v8
    v_lshl_add_u32 v8, v9, 8, v8
    v_add_u32 v4, s48, v8
    v_lshrrev_b32 v8, 3, v1
    v_and_b32 v9, 7, v1
    s_and_b32 s48, s47, 1
    s_lshl_b32 s48, s48, 3
    v_add_u32 v9, s48, v9
    v_lshlrev_b32 v9, 4, v9
    v_bfe_u32 v10, v8, 1, 1
    v_and_b32 v11, 1, v8
    v_lshl_add_u32 v9, v11, 4, v9
    v_lshl_add_u32 v9, v10, 9, v9
    v_and_b32 v10, 3, v8
    v_lshlrev_b32 v10, 8, v10
    v_sub_u32 v9, v9, v10
    s_mul_i32 s48, s20, 6
    v_lshrrev_b32 v8, 2, v8
    v_add_u32 v8, s48, v8
    v_add_u32 v10, 0, v8
    v_cmp_eq_u32 vcc, 4, v10
    v_cmp_eq_u32 s[56:57], 13, v10
    s_nop 0
    s_or_b64 vcc, vcc, s[56:57]
    v_cndmask_b32 v10, 0, v9, vcc
    v_add3_u32 v5, v4, v10, 0
    v_add_u32 v5, 0, v5
    v_add_u32 v10, 2, v8
    v_cmp_eq_u32 vcc, 4, v10
    v_cmp_eq_u32 s[56:57], 13, v10
    s_nop 0
    s_or_b64 vcc, vcc, s[56:57]
    v_cndmask_b32 v10, 0, v9, vcc
    v_add3_u32 v6, v4, v10, 0
    v_add_u32 v6, 2048, v6
    v_add_u32 v10, 4, v8
    v_cmp_eq_u32 vcc, 4, v10
    v_cmp_eq_u32 s[56:57], 13, v10
    s_nop 0
    s_or_b64 vcc, vcc, s[56:57]
    v_cndmask_b32 v10, 0, v9, vcc
    v_add3_u32 v7, v4, v10, 0
    v_add_u32 v7, 4096, v7
    s_cmp_eq_u32 s20, 3
    s_cbranch_scc1 L_w3a_75
    s_lshr_b32 s49, s47, 3
    s_lshl_b32 s49, s49, 8
    s_add_u32 s49, s49, 4046848
    v_and_b32 v10, 31, v1
    v_lshlrev_b32 v10, 3, v10
    buffer_load_dwordx2 v[8:9], v10, s[4:7], s49 offen sc1
    s_waitcnt vmcnt(0)
    v_cmp_eq_u64 vcc, s[98:99], v[8:9]
    s_nop 0
    s_cmp_eq_u64 vcc, exec
    s_cbranch_scc0 L_pp_slow_76
L_pp_back_77:
    s_mov_b32 s48, 25690112
    buffer_load_dwordx4 v[16:19], v4, s[4:7], s48 offen offset:0 sc1
    buffer_load_dwordx4 v[52:55], v4, s[4:7], s48 offen offset:2048 sc1
    s_add_u32 s48, s48, 4096
    buffer_load_dwordx4 v[88:91], v4, s[4:7], s48 offen offset:0 sc1
    s_mov_b32 s48, 50331648
    buffer_load_dwordx4 v[20:23], v5, s[4:7], s48 offen sc1
    buffer_load_dwordx4 v[56:59], v6, s[4:7], s48 offen sc1
    buffer_load_dwordx4 v[92:95], v7, s[4:7], s48 offen sc1
    s_mov_b32 s48, 52690944
    buffer_load_dwordx4 v[24:27], v5, s[4:7], s48 offen sc1
    buffer_load_dwordx4 v[60:63], v6, s[4:7], s48 offen sc1
    buffer_load_dwordx4 v[96:99], v7, s[4:7], s48 offen sc1
    s_mov_b32 s48, 55050240
    buffer_load_dwordx4 v[28:31], v5, s[4:7], s48 offen sc1
    buffer_load_dwordx4 v[64:67], v6, s[4:7], s48 offen sc1
    buffer_load_dwordx4 v[100:103], v7, s[4:7], s48 offen sc1
    s_mov_b32 s48, 57409536
    buffer_load_dwordx4 v[32:35], v5, s[4:7], s48 offen sc1
    buffer_load_dwordx4 v[68:71], v6, s[4:7], s48 offen sc1
    buffer_load_dwordx4 v[104:107], v7, s[4:7], s48 offen sc1
    s_mov_b32 s48, 59768832
    buffer_load_dwordx4 v[36:39], v5, s[4:7], s48 offen sc1
    buffer_load_dwordx4 v[72:75], v6, s[4:7], s48 offen sc1
    buffer_load_dwordx4 v[108:111], v7, s[4:7], s48 offen sc1
    s_mov_b32 s48, 62128128
    buffer_load_dwordx4 v[40:43], v5, s[4:7], s48 offen sc1
    buffer_load_dwordx4 v[76:79], v6, s[4:7], s48 offen sc1
    buffer_load_dwordx4 v[112:115], v7, s[4:7], s48 offen sc1
    s_mov_b32 s48, 64487424
    buffer_load_dwordx4 v[44:47], v5, s[4:7], s48 offen sc1
    buffer_load_dwordx4 v[80:83], v6, s[4:7], s48 offen sc1
    buffer_load_dwordx4 v[116:119], v7, s[4:7], s48 offen sc1
    s_mov_b32 s48, 66846720
    buffer_load_dwordx4 v[48:51], v5, s[4:7], s48 offen sc1
    buffer_load_dwordx4 v[84:87], v6, s[4:7], s48 offen sc1
    buffer_load_dwordx4 v[120:123], v7, s[4:7], s48 offen sc1
    s_waitcnt vmcnt(26)
    v_lshlrev_b32 v128, 16, v16
    v_and_b32 v129, 0xffff0000, v16
    v_lshlrev_b32 v130, 16, v17
    v_and_b32 v131, 0xffff0000, v17
    v_lshlrev_b32 v132, 16, v18
    v_and_b32 v133, 0xffff0000, v18
    v_lshlrev_b32 v134, 16, v19
    v_and_b32 v135, 0xffff0000, v19
    s_waitcnt vmcnt(25)
    v_lshlrev_b32 v136, 16, v52
    v_and_b32 v137, 0xffff0000, v52
    v_lshlrev_b32 v138, 16, v53
    v_and_b32 v139, 0xffff0000, v53
    v_lshlrev_b32 v140, 16, v54
    v_and_b32 v141, 0xffff0000, v54
    v_lshlrev_b32 v142, 16, v55
    v_and_b32 v143, 0xffff0000, v55
    s_waitcnt vmcnt(24)
    v_lshlrev_b32 v144, 16, v88
    v_and_b32 v145, 0xffff0000, v88
    v_lshlrev_b32 v146, 16, v89
    v_and_b32 v147, 0xffff0000, v89
    v_lshlrev_b32 v148, 16, v90
    v_and_b32 v149, 0xffff0000, v90
    v_lshlrev_b32 v150, 16, v91
    v_and_b32 v151, 0xffff0000, v91
    s_waitcnt vmcnt(23)
    v_lshlrev_b32 v8, 16, v20
    v_and_b32 v9, 0xffff0000, v20
    v_add_f32 v128, v128, v8
    v_add_f32 v129, v129, v9
    v_lshlrev_b32 v10, 16, v21
    v_and_b32 v11, 0xffff0000, v21
    v_add_f32 v130, v130, v10
    v_add_f32 v131, v131, v11
    v_lshlrev_b32 v8, 16, v22
    v_and_b32 v9, 0xffff0000, v22
    v_add_f32 v132, v132, v8
    v_add_f32 v133, v133, v9
    v_lshlrev_b32 v10, 16, v23
    v_and_b32 v11, 0xffff0000, v23
    v_add_f32 v134, v134, v10
    v_add_f32 v135, v135, v11
    s_waitcnt vmcnt(22)
    v_lshlrev_b32 v8, 16, v56
    v_and_b32 v9, 0xffff0000, v56
    v_add_f32 v136, v136, v8
    v_add_f32 v137, v137, v9
    v_lshlrev_b32 v10, 16, v57
    v_and_b32 v11, 0xffff0000, v57
    v_add_f32 v138, v138, v10
    v_add_f32 v139, v139, v11
    v_lshlrev_b32 v8, 16, v58
    v_and_b32 v9, 0xffff0000, v58
    v_add_f32 v140, v140, v8
    v_add_f32 v141, v141, v9
    v_lshlrev_b32 v10, 16, v59
    v_and_b32 v11, 0xffff0000, v59
    v_add_f32 v142, v142, v10
    v_add_f32 v143, v143, v11
    s_waitcnt vmcnt(21)
    v_lshlrev_b32 v8, 16, v92
    v_and_b32 v9, 0xffff0000, v92
    v_add_f32 v144, v144, v8
    v_add_f32 v145, v145, v9
    v_lshlrev_b32 v10, 16, v93
    v_and_b32 v11, 0xffff0000, v93
    v_add_f32 v146, v146, v10
    v_add_f32 v147, v147, v11
    v_lshlrev_b32 v8, 16, v94
    v_and_b32 v9, 0xffff0000, v94
    v_add_f32 v148, v148, v8
    v_add_f32 v149, v149, v9
    v_lshlrev_b32 v10, 16, v95
    v_and_b32 v11, 0xffff0000, v95
    v_add_f32 v150, v150, v10
    v_add_f32 v151, v151, v11
    s_waitcnt vmcnt(20)
    v_lshlrev_b32 v8, 16, v24
    v_and_b32 v9, 0xffff0000, v24
    v_add_f32 v128, v128, v8
    v_add_f32 v129, v129, v9
    v_lshlrev_b32 v10, 16, v25
    v_and_b32 v11, 0xffff0000, v25
    v_add_f32 v130, v130, v10
    v_add_f32 v131, v131, v11
    v_lshlrev_b32 v8, 16, v26
    v_and_b32 v9, 0xffff0000, v26
    v_add_f32 v132, v132, v8
    v_add_f32 v133, v133, v9
    v_lshlrev_b32 v10, 16, v27
    v_and_b32 v11, 0xffff0000, v27
    v_add_f32 v134, v134, v10
    v_add_f32 v135, v135, v11
    s_waitcnt vmcnt(19)
    v_lshlrev_b32 v8, 16, v60
    v_and_b32 v9, 0xffff0000, v60
    v_add_f32 v136, v136, v8
    v_add_f32 v137, v137, v9
    v_lshlrev_b32 v10, 16, v61
    v_and_b32 v11, 0xffff0000, v61
    v_add_f32 v138, v138, v10
    v_add_f32 v139, v139, v11
    v_lshlrev_b32 v8, 16, v62
    v_and_b32 v9, 0xffff0000, v62
    v_add_f32 v140, v140, v8
    v_add_f32 v141, v141, v9
    v_lshlrev_b32 v10, 16, v63
    v_and_b32 v11, 0xffff0000, v63
    v_add_f32 v142, v142, v10
    v_add_f32 v143, v143, v11
    s_waitcnt vmcnt(18)
    v_lshlrev_b32 v8, 16, v96
    v_and_b32 v9, 0xffff0000, v96
    v_add_f32 v144, v144, v8
    v_add_f32 v145, v145, v9
    v_lshlrev_b32 v10, 16, v97
    v_and_b32 v11, 0xffff0000, v97
    v_add_f32 v146, v146, v10
    v_add_f32 v147, v147, v11
    v_lshlrev_b32 v8, 16, v98
    v_and_b32 v9, 0xffff0000, v98
    v_add_f32 v148, v148, v8
    v_add_f32 v149, v149, v9
    v_lshlrev_b32 v10, 16, v99
    v_and_b32 v11, 0xffff0000, v99
    v_add_f32 v150, v150, v10
    v_add_f32 v151, v151, v11
    s_waitcnt vmcnt(17)
    v_lshlrev_b32 v8, 16, v28
    v_and_b32 v9, 0xffff0000, v28
    v_add_f32 v128, v128, v8
    v_add_f32 v129, v129, v9
    v_lshlrev_b32 v10, 16, v29
    v_and_b32 v11, 0xffff0000, v29
    v_add_f32 v130, v130, v10
    v_add_f32 v131, v131, v11
    v_lshlrev_b32 v8, 16, v30
    v_and_b32 v9, 0xffff0000, v30
    v_add_f32 v132, v132, v8
    v_add_f32 v133, v133, v9
    v_lshlrev_b32 v10, 16, v31
    v_and_b32 v11, 0xffff0000, v31
    v_add_f32 v134, v134, v10
    v_add_f32 v135, v135, v11
    s_waitcnt vmcnt(16)
    v_lshlrev_b32 v8, 16, v64
    v_and_b32 v9, 0xffff0000, v64
    v_add_f32 v136, v136, v8
    v_add_f32 v137, v137, v9
    v_lshlrev_b32 v10, 16, v65
    v_and_b32 v11, 0xffff0000, v65
    v_add_f32 v138, v138, v10
    v_add_f32 v139, v139, v11
    v_lshlrev_b32 v8, 16, v66
    v_and_b32 v9, 0xffff0000, v66
    v_add_f32 v140, v140, v8
    v_add_f32 v141, v141, v9
    v_lshlrev_b32 v10, 16, v67
    v_and_b32 v11, 0xffff0000, v67
    v_add_f32 v142, v142, v10
    v_add_f32 v143, v143, v11
    s_waitcnt vmcnt(15)
    v_lshlrev_b32 v8, 16, v100
    v_and_b32 v9, 0xffff0000, v100
    v_add_f32 v144, v144, v8
    v_add_f32 v145, v145, v9
    v_lshlrev_b32 v10, 16, v101
    v_and_b32 v11, 0xffff0000, v101
    v_add_f32 v146, v146, v10
    v_add_f32 v147, v147, v11
    v_lshlrev_b32 v8, 16, v102
    v_and_b32 v9, 0xffff0000, v102
    v_add_f32 v148, v148, v8
    v_add_f32 v149, v149, v9
    v_lshlrev_b32 v10, 16, v103
    v_and_b32 v11, 0xffff0000, v103
    v_add_f32 v150, v150, v10
    v_add_f32 v151, v151, v11
    s_waitcnt vmcnt(14)
    v_lshlrev_b32 v8, 16, v32
    v_and_b32 v9, 0xffff0000, v32
    v_add_f32 v128, v128, v8
    v_add_f32 v129, v129, v9
    v_lshlrev_b32 v10, 16, v33
    v_and_b32 v11, 0xffff0000, v33
    v_add_f32 v130, v130, v10
    v_add_f32 v131, v131, v11
    v_lshlrev_b32 v8, 16, v34
    v_and_b32 v9, 0xffff0000, v34
    v_add_f32 v132, v132, v8
    v_add_f32 v133, v133, v9
    v_lshlrev_b32 v10, 16, v35
    v_and_b32 v11, 0xffff0000, v35
    v_add_f32 v134, v134, v10
    v_add_f32 v135, v135, v11
    s_waitcnt vmcnt(13)
    v_lshlrev_b32 v8, 16, v68
    v_and_b32 v9, 0xffff0000, v68
    v_add_f32 v136, v136, v8
    v_add_f32 v137, v137, v9
    v_lshlrev_b32 v10, 16, v69
    v_and_b32 v11, 0xffff0000, v69
    v_add_f32 v138, v138, v10
    v_add_f32 v139, v139, v11
    v_lshlrev_b32 v8, 16, v70
    v_and_b32 v9, 0xffff0000, v70
    v_add_f32 v140, v140, v8
    v_add_f32 v141, v141, v9
    v_lshlrev_b32 v10, 16, v71
    v_and_b32 v11, 0xffff0000, v71
    v_add_f32 v142, v142, v10
    v_add_f32 v143, v143, v11
    s_waitcnt vmcnt(12)
    v_lshlrev_b32 v8, 16, v104
    v_and_b32 v9, 0xffff0000, v104
    v_add_f32 v144, v144, v8
    v_add_f32 v145, v145, v9
    v_lshlrev_b32 v10, 16, v105
    v_and_b32 v11, 0xffff0000, v105
    v_add_f32 v146, v146, v10
    v_add_f32 v147, v147, v11
    v_lshlrev_b32 v8, 16, v106
    v_and_b32 v9, 0xffff0000, v106
    v_add_f32 v148, v148, v8
    v_add_f32 v149, v149, v9
    v_lshlrev_b32 v10, 16, v107
    v_and_b32 v11, 0xffff0000, v107
    v_add_f32 v150, v150, v10
    v_add_f32 v151, v151, v11
    s_waitcnt vmcnt(11)
    v_lshlrev_b32 v8, 16, v36
    v_and_b32 v9, 0xffff0000, v36
    v_add_f32 v128, v128, v8
    v_add_f32 v129, v129, v9
    v_lshlrev_b32 v10, 16, v37
    v_and_b32 v11, 0xffff0000, v37
    v_add_f32 v130, v130, v10
    v_add_f32 v131, v131, v11
    v_lshlrev_b32 v8, 16, v38
    v_and_b32 v9, 0xffff0000, v38
    v_add_f32 v132, v132, v8
    v_add_f32 v133, v133, v9
    v_lshlrev_b32 v10, 16, v39
    v_and_b32 v11, 0xffff0000, v39
    v_add_f32 v134, v134, v10
    v_add_f32 v135, v135, v11
    s_waitcnt vmcnt(10)
    v_lshlrev_b32 v8, 16, v72
    v_and_b32 v9, 0xffff0000, v72
    v_add_f32 v136, v136, v8
    v_add_f32 v137, v137, v9
    v_lshlrev_b32 v10, 16, v73
    v_and_b32 v11, 0xffff0000, v73
    v_add_f32 v138, v138, v10
    v_add_f32 v139, v139, v11
    v_lshlrev_b32 v8, 16, v74
    v_and_b32 v9, 0xffff0000, v74
    v_add_f32 v140, v140, v8
    v_add_f32 v141, v141, v9
    v_lshlrev_b32 v10, 16, v75
    v_and_b32 v11, 0xffff0000, v75
    v_add_f32 v142, v142, v10
    v_add_f32 v143, v143, v11
    s_waitcnt vmcnt(9)
    v_lshlrev_b32 v8, 16, v108
    v_and_b32 v9, 0xffff0000, v108
    v_add_f32 v144, v144, v8
    v_add_f32 v145, v145, v9
    v_lshlrev_b32 v10, 16, v109
    v_and_b32 v11, 0xffff0000, v109
    v_add_f32 v146, v146, v10
    v_add_f32 v147, v147, v11
    v_lshlrev_b32 v8, 16, v110
    v_and_b32 v9, 0xffff0000, v110
    v_add_f32 v148, v148, v8
    v_add_f32 v149, v149, v9
    v_lshlrev_b32 v10, 16, v111
    v_and_b32 v11, 0xffff0000, v111
    v_add_f32 v150, v150, v10
    v_add_f32 v151, v151, v11
    s_waitcnt vmcnt(8)
    v_lshlrev_b32 v8, 16, v40
    v_and_b32 v9, 0xffff0000, v40
    v_add_f32 v128, v128, v8
    v_add_f32 v129, v129, v9
    v_lshlrev_b32 v10, 16, v41
    v_and_b32 v11, 0xffff0000, v41
    v_add_f32 v130, v130, v10
    v_add_f32 v131, v131, v11
    v_lshlrev_b32 v8, 16, v42
    v_and_b32 v9, 0xffff0000, v42
    v_add_f32 v132, v132, v8
    v_add_f32 v133, v133, v9
    v_lshlrev_b32 v10, 16, v43
    v_and_b32 v11, 0xffff0000, v43
    v_add_f32 v134, v134, v10
    v_add_f32 v135, v135, v11
    s_waitcnt vmcnt(7)
    v_lshlrev_b32 v8, 16, v76
    v_and_b32 v9, 0xffff0000, v76
    v_add_f32 v136, v136, v8
    v_add_f32 v137, v137, v9
    v_lshlrev_b32 v10, 16, v77
    v_and_b32 v11, 0xffff0000, v77
    v_add_f32 v138, v138, v10
    v_add_f32 v139, v139, v11
    v_lshlrev_b32 v8, 16, v78
    v_and_b32 v9, 0xffff0000, v78
    v_add_f32 v140, v140, v8
    v_add_f32 v141, v141, v9
    v_lshlrev_b32 v10, 16, v79
    v_and_b32 v11, 0xffff0000, v79
    v_add_f32 v142, v142, v10
    v_add_f32 v143, v143, v11
    s_waitcnt vmcnt(6)
    v_lshlrev_b32 v8, 16, v112
    v_and_b32 v9, 0xffff0000, v112
    v_add_f32 v144, v144, v8
    v_add_f32 v145, v145, v9
    v_lshlrev_b32 v10, 16, v113
    v_and_b32 v11, 0xffff0000, v113
    v_add_f32 v146, v146, v10
    v_add_f32 v147, v147, v11
    v_lshlrev_b32 v8, 16, v114
    v_and_b32 v9, 0xffff0000, v114
    v_add_f32 v148, v148, v8
    v_add_f32 v149, v149, v9
    v_lshlrev_b32 v10, 16, v115
    v_and_b32 v11, 0xffff0000, v115
    v_add_f32 v150, v150, v10
    v_add_f32 v151, v151, v11
    s_waitcnt vmcnt(5)
    v_lshlrev_b32 v8, 16, v44
    v_and_b32 v9, 0xffff0000, v44
    v_add_f32 v128, v128, v8
    v_add_f32 v129, v129, v9
    v_lshlrev_b32 v10, 16, v45
    v_and_b32 v11, 0xffff0000, v45
    v_add_f32 v130, v130, v10
    v_add_f32 v131, v131, v11
    v_lshlrev_b32 v8, 16, v46
    v_and_b32 v9, 0xffff0000, v46
    v_add_f32 v132, v132, v8
    v_add_f32 v133, v133, v9
    v_lshlrev_b32 v10, 16, v47
    v_and_b32 v11, 0xffff0000, v47
    v_add_f32 v134, v134, v10
    v_add_f32 v135, v135, v11
    s_waitcnt vmcnt(4)
    v_lshlrev_b32 v8, 16, v80
    v_and_b32 v9, 0xffff0000, v80
    v_add_f32 v136, v136, v8
    v_add_f32 v137, v137, v9
    v_lshlrev_b32 v10, 16, v81
    v_and_b32 v11, 0xffff0000, v81
    v_add_f32 v138, v138, v10
    v_add_f32 v139, v139, v11
    v_lshlrev_b32 v8, 16, v82
    v_and_b32 v9, 0xffff0000, v82
    v_add_f32 v140, v140, v8
    v_add_f32 v141, v141, v9
    v_lshlrev_b32 v10, 16, v83
    v_and_b32 v11, 0xffff0000, v83
    v_add_f32 v142, v142, v10
    v_add_f32 v143, v143, v11
    s_waitcnt vmcnt(3)
    v_lshlrev_b32 v8, 16, v116
    v_and_b32 v9, 0xffff0000, v116
    v_add_f32 v144, v144, v8
    v_add_f32 v145, v145, v9
    v_lshlrev_b32 v10, 16, v117
    v_and_b32 v11, 0xffff0000, v117
    v_add_f32 v146, v146, v10
    v_add_f32 v147, v147, v11
    v_lshlrev_b32 v8, 16, v118
    v_and_b32 v9, 0xffff0000, v118
    v_add_f32 v148, v148, v8
    v_add_f32 v149, v149, v9
    v_lshlrev_b32 v10, 16, v119
    v_and_b32 v11, 0xffff0000, v119
    v_add_f32 v150, v150, v10
    v_add_f32 v151, v151, v11
    s_waitcnt vmcnt(2)
    v_lshlrev_b32 v8, 16, v48
    v_and_b32 v9, 0xffff0000, v48
    v_add_f32 v128, v128, v8
    v_add_f32 v129, v129, v9
    v_lshlrev_b32 v10, 16, v49
    v_and_b32 v11, 0xffff0000, v49
    v_add_f32 v130, v130, v10
    v_add_f32 v131, v131, v11
    v_lshlrev_b32 v8, 16, v50
    v_and_b32 v9, 0xffff0000, v50
    v_add_f32 v132, v132, v8
    v_add_f32 v133, v133, v9
    v_lshlrev_b32 v10, 16, v51
    v_and_b32 v11, 0xffff0000, v51
    v_add_f32 v134, v134, v10
    v_add_f32 v135, v135, v11
    s_waitcnt vmcnt(1)
    v_lshlrev_b32 v8, 16, v84
    v_and_b32 v9, 0xffff0000, v84
    v_add_f32 v136, v136, v8
    v_add_f32 v137, v137, v9
    v_lshlrev_b32 v10, 16, v85
    v_and_b32 v11, 0xffff0000, v85
    v_add_f32 v138, v138, v10
    v_add_f32 v139, v139, v11
    v_lshlrev_b32 v8, 16, v86
    v_and_b32 v9, 0xffff0000, v86
    v_add_f32 v140, v140, v8
    v_add_f32 v141, v141, v9
    v_lshlrev_b32 v10, 16, v87
    v_and_b32 v11, 0xffff0000, v87
    v_add_f32 v142, v142, v10
    v_add_f32 v143, v143, v11
    s_waitcnt vmcnt(0)
    v_lshlrev_b32 v8, 16, v120
    v_and_b32 v9, 0xffff0000, v120
    v_add_f32 v144, v144, v8
    v_add_f32 v145, v145, v9
    v_lshlrev_b32 v10, 16, v121
    v_and_b32 v11, 0xffff0000, v121
    v_add_f32 v146, v146, v10
    v_add_f32 v147, v147, v11
    v_lshlrev_b32 v8, 16, v122
    v_and_b32 v9, 0xffff0000, v122
    v_add_f32 v148, v148, v8
    v_add_f32 v149, v149, v9
    v_lshlrev_b32 v10, 16, v123
    v_and_b32 v11, 0xffff0000, v123
    v_add_f32 v150, v150, v10
    v_add_f32 v151, v151, v11
    s_add_u32 s16, s42, 28311552
    s_addc_u32 s17, s43, 0
    s_mov_b32 s18, 0x240000
    s_mov_b32 s19, 0x20000
    v_cvt_pk_bf16_f32 v160, v128, v129
    v_cvt_pk_bf16_f32 v161, v130, v131
    v_cvt_pk_bf16_f32 v162, v132, v133
    v_cvt_pk_bf16_f32 v163, v134, v135
    buffer_store_dwordx4 v[160:163], v3, s[16:19], 0 offen offset:0 sc1
    v_cvt_pk_bf16_f32 v164, v136, v137
    v_cvt_pk_bf16_f32 v165, v138, v139
    v_cvt_pk_bf16_f32 v166, v140, v141
    v_cvt_pk_bf16_f32 v167, v142, v143
    buffer_store_dwordx4 v[164:167], v3, s[16:19], 0 offen offset:128 sc1
    v_cvt_pk_bf16_f32 v168, v144, v145
    v_cvt_pk_bf16_f32 v169, v146, v147
    v_cvt_pk_bf16_f32 v170, v148, v149
    v_cvt_pk_bf16_f32 v171, v150, v151
    buffer_store_dwordx4 v[168:171], v3, s[16:19], 0 offen offset:256 sc1
    v_lshlrev_b32 v128, 16, v160
    v_and_b32 v129, 0xffff0000, v160
    v_lshlrev_b32 v130, 16, v161
    v_and_b32 v131, 0xffff0000, v161
    v_lshlrev_b32 v132, 16, v162
    v_and_b32 v133, 0xffff0000, v162
    v_lshlrev_b32 v134, 16, v163
    v_and_b32 v135, 0xffff0000, v163
    v_lshlrev_b32 v136, 16, v164
    v_and_b32 v137, 0xffff0000, v164
    v_lshlrev_b32 v138, 16, v165
    v_and_b32 v139, 0xffff0000, v165
    v_lshlrev_b32 v140, 16, v166
    v_and_b32 v141, 0xffff0000, v166
    v_lshlrev_b32 v142, 16, v167
    v_and_b32 v143, 0xffff0000, v167
    v_lshlrev_b32 v144, 16, v168
    v_and_b32 v145, 0xffff0000, v168
    v_lshlrev_b32 v146, 16, v169
    v_and_b32 v147, 0xffff0000, v169
    v_lshlrev_b32 v148, 16, v170
    v_and_b32 v149, 0xffff0000, v170
    v_lshlrev_b32 v150, 16, v171
    v_and_b32 v151, 0xffff0000, v171
    v_add_f32 v152, v128, v129
    v_add_f32 v8, v130, v131
    v_add_f32 v152, v152, v132
    v_add_f32 v8, v8, v133
    v_add_f32 v152, v152, v134
    v_add_f32 v8, v8, v135
    v_add_f32 v152, v152, v136
    v_add_f32 v8, v8, v137
    v_add_f32 v152, v152, v138
    v_add_f32 v8, v8, v139
    v_add_f32 v152, v152, v140
    v_add_f32 v8, v8, v141
    v_add_f32 v152, v152, v142
    v_add_f32 v8, v8, v143
    v_add_f32 v152, v152, v144
    v_add_f32 v8, v8, v145
    v_add_f32 v152, v152, v146
    v_add_f32 v8, v8, v147
    v_add_f32 v152, v152, v148
    v_add_f32 v8, v8, v149
    v_add_f32 v152, v152, v150
    v_add_f32 v8, v8, v151
    v_add_f32 v152, v152, v8
    s_nop 1
    v_add_f32_dpp v152, v152, v152 row_ror:8 row_mask:0xf bank_mask:0xf
    v_mov_b32 v8, v152
    s_nop 1
    v_permlane16_swap_b32 v152, v8
    v_add_f32 v152, v152, v8
    v_mov_b32 v8, v152
    s_nop 1
    v_permlane32_swap_b32 v152, v8
    v_add_f32 v152, v152, v8
    v_mul_f32 v9, 0x3baaaaab, v152
    v_sub_f32 v8, v128, v9
    v_mul_f32 v153, v8, v8
    v_sub_f32 v11, v129, v9
    v_fmac_f32 v153, v11, v11
    v_sub_f32 v10, v130, v9
    v_fmac_f32 v153, v10, v10
    v_sub_f32 v11, v131, v9
    v_fmac_f32 v153, v11, v11
    v_sub_f32 v10, v132, v9
    v_fmac_f32 v153, v10, v10
    v_sub_f32 v11, v133, v9
    v_fmac_f32 v153, v11, v11
    v_sub_f32 v10, v134, v9
    v_fmac_f32 v153, v10, v10
    v_sub_f32 v11, v135, v9
    v_fmac_f32 v153, v11, v11
    v_sub_f32 v10, v136, v9
    v_fmac_f32 v153, v10, v10
    v_sub_f32 v11, v137, v9
    v_fmac_f32 v153, v11, v11
    v_sub_f32 v10, v138, v9
    v_fmac_f32 v153, v10, v10
    v_sub_f32 v11, v139, v9
    v_fmac_f32 v153, v11, v11
    v_sub_f32 v10, v140, v9
    v_fmac_f32 v153, v10, v10
    v_sub_f32 v11, v141, v9
    v_fmac_f32 v153, v11, v11
    v_sub_f32 v10, v142, v9
    v_fmac_f32 v153, v10, v10
    v_sub_f32 v11, v143, v9
    v_fmac_f32 v153, v11, v11
    v_sub_f32 v10, v144, v9
    v_fmac_f32 v153, v10, v10
    v_sub_f32 v11, v145, v9
    v_fmac_f32 v153, v11, v11
    v_sub_f32 v10, v146, v9
    v_fmac_f32 v153, v10, v10
    v_sub_f32 v11, v147, v9
    v_fmac_f32 v153, v11, v11
    v_sub_f32 v10, v148, v9
    v_fmac_f32 v153, v10, v10
    v_sub_f32 v11, v149, v9
    v_fmac_f32 v153, v11, v11
    v_sub_f32 v10, v150, v9
    v_fmac_f32 v153, v10, v10
    v_sub_f32 v11, v151, v9
    v_fmac_f32 v153, v11, v11
    s_nop 1
    v_add_f32_dpp v153, v153, v153 row_ror:8 row_mask:0xf bank_mask:0xf
    v_mov_b32 v8, v153
    s_nop 1
    v_permlane16_swap_b32 v153, v8
    v_add_f32 v153, v153, v8
    v_mov_b32 v8, v153
    s_nop 1
    v_permlane32_swap_b32 v153, v8
    v_add_f32 v153, v153, v8
    v_and_b32 v8, 7, v1
    s_mul_i32 s46, s20, 64
    s_add_u32 s46, s46, 160896
    v_lshl_add_u32 v8, v8, 3, s46
    ds_write_b64 v8, v[152:153]
    s_waitcnt lgkmcnt(0)
L_w3a_75:
    s_barrier
    s_cmp_eq_u32 s20, 3
    s_cbranch_scc1 L_w3b_79
    v_and_b32 v8, 7, v1
    v_lshlrev_b32 v8, 3, v8
    v_add_u32 v8, 160896, v8
    ds_read_b64 v[152:153], v8 offset:0
    ds_read_b64 v[154:155], v8 offset:64
    ds_read_b64 v[156:157], v8 offset:128
    s_waitcnt lgkmcnt(1)
    v_add_f32 v8, v152, v154
    s_waitcnt lgkmcnt(0)
    v_add_f32 v8, v8, v156
    v_mul_f32 v8, 0x3ae38e39, v8
    v_add_f32 v9, v153, v155
    v_add_f32 v9, v9, v157
    v_mul_f32 v10, 0x3baaaaab, v152
    v_sub_f32 v10, v10, v8
    v_mul_f32 v10, v10, v10
    v_fmac_f32 v9, 0x43400000, v10
    v_mul_f32 v10, 0x3baaaaab, v154
    v_sub_f32 v10, v10, v8
    v_mul_f32 v10, v10, v10
    v_fmac_f32 v9, 0x43400000, v10
    v_mul_f32 v10, 0x3baaaaab, v156
    v_sub_f32 v10, v10, v8
    v_mul_f32 v10, v10, v10
    v_fmac_f32 v9, 0x43400000, v10
    v_mul_f32 v9, 0x3ae38e39, v9
    v_cvt_pk_bf16_f32 v9, v9, v9
    v_lshlrev_b32 v9, 16, v9
    v_add_f32 v9, 0x3727c5ac, v9
    v_cvt_pk_bf16_f32 v9, v9, v9
    v_lshlrev_b32 v9, 16, v9
    v_sqrt_f32 v9, v9
    s_nop 0
    v_cvt_pk_bf16_f32 v9, v9, v9
    v_lshlrev_b32 v9, 16, v9
    v_rcp_f32 v9, v9
    v_cvt_pk_bf16_f32 v8, v8, v8
    v_lshlrev_b32 v8, 16, v8
    v_sub_f32 v128, v128, v8
    v_sub_f32 v129, v129, v8
    v_cvt_pk_bf16_f32 v10, v128, v129
    v_lshlrev_b32 v128, 16, v10
    v_and_b32 v129, 0xffff0000, v10
    v_mul_f32 v128, v128, v9
    v_mul_f32 v129, v129, v9
    v_cvt_pk_bf16_f32 v16, v128, v129
    v_sub_f32 v130, v130, v8
    v_sub_f32 v131, v131, v8
    v_cvt_pk_bf16_f32 v10, v130, v131
    v_lshlrev_b32 v130, 16, v10
    v_and_b32 v131, 0xffff0000, v10
    v_mul_f32 v130, v130, v9
    v_mul_f32 v131, v131, v9
    v_cvt_pk_bf16_f32 v17, v130, v131
    v_sub_f32 v132, v132, v8
    v_sub_f32 v133, v133, v8
    v_cvt_pk_bf16_f32 v10, v132, v133
    v_lshlrev_b32 v132, 16, v10
    v_and_b32 v133, 0xffff0000, v10
    v_mul_f32 v132, v132, v9
    v_mul_f32 v133, v133, v9
    v_cvt_pk_bf16_f32 v18, v132, v133
    v_sub_f32 v134, v134, v8
    v_sub_f32 v135, v135, v8
    v_cvt_pk_bf16_f32 v10, v134, v135
    v_lshlrev_b32 v134, 16, v10
    v_and_b32 v135, 0xffff0000, v10
    v_mul_f32 v134, v134, v9
    v_mul_f32 v135, v135, v9
    v_cvt_pk_bf16_f32 v19, v134, v135
    v_sub_f32 v136, v136, v8
    v_sub_f32 v137, v137, v8
    v_cvt_pk_bf16_f32 v10, v136, v137
    v_lshlrev_b32 v136, 16, v10
    v_and_b32 v137, 0xffff0000, v10
    v_mul_f32 v136, v136, v9
    v_mul_f32 v137, v137, v9
    v_cvt_pk_bf16_f32 v20, v136, v137
    v_sub_f32 v138, v138, v8
    v_sub_f32 v139, v139, v8
    v_cvt_pk_bf16_f32 v10, v138, v139
    v_lshlrev_b32 v138, 16, v10
    v_and_b32 v139, 0xffff0000, v10
    v_mul_f32 v138, v138, v9
    v_mul_f32 v139, v139, v9
    v_cvt_pk_bf16_f32 v21, v138, v139
    v_sub_f32 v140, v140, v8
    v_sub_f32 v141, v141, v8
    v_cvt_pk_bf16_f32 v10, v140, v141
    v_lshlrev_b32 v140, 16, v10
    v_and_b32 v141, 0xffff0000, v10
    v_mul_f32 v140, v140, v9
    v_mul_f32 v141, v141, v9
    v_cvt_pk_bf16_f32 v22, v140, v141
    v_sub_f32 v142, v142, v8
    v_sub_f32 v143, v143, v8
    v_cvt_pk_bf16_f32 v10, v142, v143
    v_lshlrev_b32 v142, 16, v10
    v_and_b32 v143, 0xffff0000, v10
    v_mul_f32 v142, v142, v9
    v_mul_f32 v143, v143, v9
    v_cvt_pk_bf16_f32 v23, v142, v143
    v_sub_f32 v144, v144, v8
    v_sub_f32 v145, v145, v8
    v_cvt_pk_bf16_f32 v10, v144, v145
    v_lshlrev_b32 v144, 16, v10
    v_and_b32 v145, 0xffff0000, v10
    v_mul_f32 v144, v144, v9
    v_mul_f32 v145, v145, v9
    v_cvt_pk_bf16_f32 v24, v144, v145
    v_sub_f32 v146, v146, v8
    v_sub_f32 v147, v147, v8
    v_cvt_pk_bf16_f32 v10, v146, v147
    v_lshlrev_b32 v146, 16, v10
    v_and_b32 v147, 0xffff0000, v10
    v_mul_f32 v146, v146, v9
    v_mul_f32 v147, v147, v9
    v_cvt_pk_bf16_f32 v25, v146, v147
    v_sub_f32 v148, v148, v8
    v_sub_f32 v149, v149, v8
    v_cvt_pk_bf16_f32 v10, v148, v149
    v_lshlrev_b32 v148, 16, v10
    v_and_b32 v149, 0xffff0000, v10
    v_mul_f32 v148, v148, v9
    v_mul_f32 v149, v149, v9
    v_cvt_pk_bf16_f32 v26, v148, v149
    v_sub_f32 v150, v150, v8
    v_sub_f32 v151, v151, v8
    v_cvt_pk_bf16_f32 v10, v150, v151
    v_lshlrev_b32 v150, 16, v10
    v_and_b32 v151, 0xffff0000, v10
    v_mul_f32 v150, v150, v9
    v_mul_f32 v151, v151, v9
    v_cvt_pk_bf16_f32 v27, v150, v151
    s_mov_b32 s46, 71303168
    buffer_store_dwordx4 v[16:19], v4, s[4:7], s46 offen offset:0 sc1
    buffer_store_dwordx4 v[20:23], v4, s[4:7], s46 offen offset:2048 sc1
    s_add_u32 s46, s46, 4096
    buffer_store_dwordx4 v[24:27], v4, s[4:7], s46 offen offset:0 sc1
    s_lshl_b32 s46, s47, 2
    s_add_u32 s46, s46, s20
    s_lshl_b32 s46, s46, 3
    s_add_u32 s46, s46, 3940352
    v_mov_b32 v8, s98
    v_mov_b32 v9, s99
    s_waitcnt vmcnt(0)
    s_mov_b64 exec, 1
    buffer_store_dwordx2 v[8:9], off, s[4:7], s46 sc1
    s_mov_b64 exec, -1
L_w3b_79:
    s_lshr_b32 s44, s22, 4
    s_lshl_b32 s52, s21, 1
    s_add_u32 s44, s44, s52
    s_and_b32 s45, s22, 15
    s_mul_i32 s48, s20, 21
    s_lshr_b32 s48, s48, 1
    s_lshl_b32 s48, s48, 10
    s_mul_i32 s47, s45, 129024
    s_add_u32 s47, s47, s48
    s_add_u32 s47, s47, 0
    s_add_u32 m0, s48, 86016
    s_add_u32 s53, s47, 86016
    buffer_load_dwordx4 v2, s[4:7], s53 offen offset:0 lds
    buffer_load_dwordx4 v2, s[4:7], s53 offen offset:1024 lds
    buffer_load_dwordx4 v2, s[4:7], s53 offen offset:2048 lds
    buffer_load_dwordx4 v2, s[4:7], s53 offen offset:3072 lds
    s_add_u32 m0, s48, 90112
    s_add_u32 s53, s47, 90112
    buffer_load_dwordx4 v2, s[4:7], s53 offen offset:0 lds
    buffer_load_dwordx4 v2, s[4:7], s53 offen offset:1024 lds
    buffer_load_dwordx4 v2, s[4:7], s53 offen offset:2048 lds
    buffer_load_dwordx4 v2, s[4:7], s53 offen offset:3072 lds
    s_add_u32 m0, s48, 94208
    s_add_u32 s53, s47, 94208
    buffer_load_dwordx4 v2, s[4:7], s53 offen offset:0 lds
    buffer_load_dwordx4 v2, s[4:7], s53 offen offset:1024 lds
    buffer_load_dwordx4 v2, s[4:7], s53 offen offset:2048 lds
    s_lshl_b32 s46, s44, 3
    s_max_u32 s52, s46, 1
    s_sub_u32 s52, s52, 1
    s_mul_i32 s49, s52, 18432
    s_mul_i32 s50, s20, 9
    s_lshr_b32 s50, s50, 1
    s_lshl_b32 s50, s50, 10
    s_add_u32 s49, s49, s50
    s_add_u32 s49, s49, 71303168
    s_add_u32 s50, s50, 129024
    s_lshl_b32 s54, s52, 6
    s_lshl_b32 s52, s20, 1
    s_add_u32 s46, s46, s52
    s_mul_i32 s51, s46, 18432
    s_add_u32 s51, s51, 71303168
    s_lshl_b32 s55, s46, 6
    v_and_b32 v6, 3, v1
    v_min_u32 v6, 2, v6
    v_and_b32 v7, 12, v1
    v_add_lshl_u32 v8, v6, v7, 3
    v_add_u32 v8, s55, v8
    v_and_b32 v7, 4, v1
    v_add_lshl_u32 v9, v6, v7, 3
    v_add_u32 v9, s54, v9
    v_and_b32 v7, 16, v1
    v_cmp_eq_u32 vcc, 0, v7
    s_nop 1
    v_cndmask_b32 v8, v9, v8, vcc
    s_mov_b32 s52, 3940352
    buffer_load_dwordx2 v[6:7], v8, s[4:7], s52 offen sc1
    s_min_u32 s56, s20, 2
    s_add_u32 s57, s56, 2
    s_add_u32 s56, s56, 4
    s_cmp_ge_u32 s20, 2
    s_cselect_b32 s57, 6, s57
    s_lshl_b32 s57, s57, 10
    s_lshl_b32 s56, s56, 10
    v_mov_b32 v3, v2
    v_add_u32 v4, s57, v2
    v_add_u32 v5, s56, v2
    v_add_u32 v10, 129024, v2
    s_waitcnt vmcnt(0)
    v_cmp_eq_u64 vcc, s[98:99], v[6:7]
    s_nop 0
    s_cmp_eq_u64 vcc, exec
    s_cbranch_scc0 L_px_slow_80
L_px_back_81:
    s_add_u32 s54, s51, 0
    buffer_load_dwordx4 a[0:3], v2, s[4:7], s54 offen offset:0 sc1
    s_add_u32 s55, s51, 18432
    buffer_load_dwordx4 a[72:75], v2, s[4:7], s55 offen offset:0 sc1
    buffer_load_dwordx4 a[4:7], v2, s[4:7], s54 offen offset:1024 sc1
    buffer_load_dwordx4 a[76:79], v2, s[4:7], s55 offen offset:1024 sc1
    buffer_load_dwordx4 a[8:11], v2, s[4:7], s54 offen offset:2048 sc1
    buffer_load_dwordx4 a[80:83], v2, s[4:7], s55 offen offset:2048 sc1
    buffer_load_dwordx4 a[12:15], v2, s[4:7], s54 offen offset:3072 sc1
    buffer_load_dwordx4 a[84:87], v2, s[4:7], s55 offen offset:3072 sc1
    s_add_u32 s54, s51, 4096
    buffer_load_dwordx4 a[16:19], v2, s[4:7], s54 offen offset:0 sc1
    s_add_u32 s55, s51, 22528
    buffer_load_dwordx4 a[88:91], v2, s[4:7], s55 offen offset:0 sc1
    buffer_load_dwordx4 a[20:23], v2, s[4:7], s54 offen offset:1024 sc1
    buffer_load_dwordx4 a[92:95], v2, s[4:7], s55 offen offset:1024 sc1
    buffer_load_dwordx4 a[24:27], v2, s[4:7], s54 offen offset:2048 sc1
    buffer_load_dwordx4 a[96:99], v2, s[4:7], s55 offen offset:2048 sc1
    buffer_load_dwordx4 a[28:31], v2, s[4:7], s54 offen offset:3072 sc1
    buffer_load_dwordx4 a[100:103], v2, s[4:7], s55 offen offset:3072 sc1
    v_and_b32 v6, 15, v1
    v_lshrrev_b32 v7, 4, v1
    v_lshlrev_b32 v7, 2, v7
    v_sub_u32 v6, v6, v7
    v_mov_b32 v8, 0xf149f2ca
    s_or_b32 s52, s44, s20
    s_cmp_eq_u32 s52, 0
    s_cselect_b64 s[56:57], -1, 0
    v_subrev_u32 v7, 0, v6
    v_and_b32 v9, 0xfffffff1, v7
    v_cmp_eq_u32 vcc, 0, v9
    v_add_u32 v7, 16, v7
    v_and_b32 v9, 0xfffffff1, v7
    v_cndmask_b32_e64 v168, v8, 0, vcc
    v_cmp_eq_u32 vcc, 0, v9
    s_nop 1
    v_cndmask_b32_e64 v172, v8, 0, vcc
    v_cndmask_b32_e64 v176, v172, v8, s[56:57]
    v_subrev_u32 v7, 1, v6
    v_and_b32 v9, 0xfffffff1, v7
    v_cmp_eq_u32 vcc, 0, v9
    v_add_u32 v7, 16, v7
    v_and_b32 v9, 0xfffffff1, v7
    v_cndmask_b32_e64 v169, v8, 0, vcc
    v_cmp_eq_u32 vcc, 0, v9
    s_nop 1
    v_cndmask_b32_e64 v173, v8, 0, vcc
    v_cndmask_b32_e64 v177, v173, v8, s[56:57]
    v_subrev_u32 v7, 2, v6
    v_and_b32 v9, 0xfffffff1, v7
    v_cmp_eq_u32 vcc, 0, v9
    v_add_u32 v7, 16, v7
    v_and_b32 v9, 0xfffffff1, v7
    v_cndmask_b32_e64 v170, v8, 0, vcc
    v_cmp_eq_u32 vcc, 0, v9
    s_nop 1
    v_cndmask_b32_e64 v174, v8, 0, vcc
    v_cndmask_b32_e64 v178, v174, v8, s[56:57]
    v_subrev_u32 v7, 3, v6
    v_and_b32 v9, 0xfffffff1, v7
    v_cmp_eq_u32 vcc, 0, v9
    v_add_u32 v7, 16, v7
    v_and_b32 v9, 0xfffffff1, v7
    v_cndmask_b32_e64 v171, v8, 0, vcc
    v_cmp_eq_u32 vcc, 0, v9
    s_nop 1
    v_cndmask_b32_e64 v175, v8, 0, vcc
    v_cndmask_b32_e64 v179, v175, v8, s[56:57]
    s_barrier
    ds_read_b128 v[88:91], v3 offset:0
    ds_read_b128 v[92:95], v3 offset:1024
    ds_read_b128 v[96:99], v3 offset:2048
    ds_read_b128 v[100:103], v3 offset:3072
    ds_read_b128 v[112:115], v3 offset:6144
    ds_read_b128 v[104:107], v3 offset:4096
    ds_read_b128 v[108:111], v3 offset:5120
    s_add_u32 m0, s50, 0
    s_add_u32 s53, s49, 0
    s_waitcnt vmcnt(15) lgkmcnt(6)
    v_mfma_f32_16x16x32_bf16 v[16:19], v[88:91], a[0:3], 0
    buffer_load_dwordx4 v2, s[4:7], s53 offen offset:0 sc1 lds
    ds_read_b128 v[116:119], v3 offset:7168
    s_waitcnt vmcnt(15)
    v_mfma_f32_16x16x32_bf16 v[48:51], v[88:91], a[72:75], 0
    ds_read_b128 v[120:123], v3 offset:8192
    s_waitcnt lgkmcnt(7)
    v_mfma_f32_16x16x32_bf16 v[20:23], v[92:95], a[0:3], 0
    v_mfma_f32_16x16x32_bf16 v[52:55], v[92:95], a[72:75], 0
    ds_read_b128 v[124:127], v3 offset:9216
    s_waitcnt lgkmcnt(7)
    v_mfma_f32_16x16x32_bf16 v[24:27], v[96:99], a[0:3], 0
    v_mfma_f32_16x16x32_bf16 v[56:59], v[96:99], a[72:75], 0
    buffer_load_dwordx4 v2, s[4:7], s53 offen offset:1024 sc1 lds
    ds_read_b128 v[128:131], v3 offset:10240
    s_waitcnt lgkmcnt(7)
    v_mfma_f32_16x16x32_bf16 v[28:31], v[100:103], a[0:3], 0
    v_mfma_f32_16x16x32_bf16 v[60:63], v[100:103], a[72:75], 0
    ds_read_b128 v[140:143], v3 offset:13312
    s_waitcnt lgkmcnt(7)
    v_mfma_f32_16x16x32_bf16 v[32:35], v[112:115], a[0:3], 0
    v_mfma_f32_16x16x32_bf16 v[64:67], v[112:115], a[72:75], 0
    ds_read_b128 v[132:135], v3 offset:11264
    v_mfma_f32_16x16x32_bf16 v[44:47], a[0:3], v[112:115], 0
    buffer_load_dwordx4 v2, s[4:7], s53 offen offset:2048 sc1 lds
    v_mfma_f32_16x16x32_bf16 v[76:79], a[72:75], v[112:115], 0
    ds_read_b128 v[136:139], v3 offset:12288
    s_waitcnt lgkmcnt(8)
    v_mfma_f32_16x16x32_bf16 v[36:39], a[0:3], v[104:107], 0
    v_mfma_f32_16x16x32_bf16 v[68:71], a[72:75], v[104:107], 0
    s_waitcnt lgkmcnt(7)
    v_mfma_f32_16x16x32_bf16 v[40:43], a[0:3], v[108:111], 0
    v_mfma_f32_16x16x32_bf16 v[72:75], a[72:75], v[108:111], 0
    buffer_load_dwordx4 v2, s[4:7], s53 offen offset:3072 sc1 lds
    s_add_u32 m0, s50, 4096
    s_waitcnt vmcnt(17) lgkmcnt(6)
    v_mfma_f32_16x16x32_bf16 v[16:19], v[116:119], a[4:7], v[16:19]
    s_add_u32 s53, s49, 4096
    ds_read_b128 v[88:91], v3 offset:14336
    s_waitcnt vmcnt(16)
    v_mfma_f32_16x16x32_bf16 v[48:51], v[116:119], a[76:79], v[48:51]
    ds_read_b128 v[92:95], v3 offset:15360
    s_waitcnt lgkmcnt(7)
    v_mfma_f32_16x16x32_bf16 v[20:23], v[120:123], a[4:7], v[20:23]
    v_mfma_f32_16x16x32_bf16 v[52:55], v[120:123], a[76:79], v[52:55]
    ds_read_b128 v[96:99], v3 offset:16384
    s_waitcnt lgkmcnt(7)
    v_mfma_f32_16x16x32_bf16 v[24:27], v[124:127], a[4:7], v[24:27]
    buffer_load_dwordx4 v2, s[4:7], s53 offen offset:0 sc1 lds
    s_add_u32 s54, s51, 8192
    v_mfma_f32_16x16x32_bf16 v[56:59], v[124:127], a[76:79], v[56:59]
    ds_read_b128 v[100:103], v3 offset:17408
    s_waitcnt lgkmcnt(7)
    v_mfma_f32_16x16x32_bf16 v[28:31], v[128:131], a[4:7], v[28:31]
    v_mfma_f32_16x16x32_bf16 v[60:63], v[128:131], a[76:79], v[60:63]
    ds_read_b128 v[112:115], v3 offset:20480
    s_waitcnt lgkmcnt(7)
    v_mfma_f32_16x16x32_bf16 v[32:35], v[140:143], a[4:7], v[32:35]
    v_mfma_f32_16x16x32_bf16 v[64:67], v[140:143], a[76:79], v[64:67]
    buffer_load_dwordx4 a[32:35], v2, s[4:7], s54 offen offset:0 sc1
    s_add_u32 s55, s51, 26624
    v_mfma_f32_16x16x32_bf16 v[44:47], a[4:7], v[140:143], v[44:47]
    ds_read_b128 v[104:107], v3 offset:18432
    v_mfma_f32_16x16x32_bf16 v[76:79], a[76:79], v[140:143], v[76:79]
    ds_read_b128 v[108:111], v3 offset:19456
    s_waitcnt lgkmcnt(8)
    v_mfma_f32_16x16x32_bf16 v[36:39], a[4:7], v[132:135], v[36:39]
    v_mfma_f32_16x16x32_bf16 v[68:71], a[76:79], v[132:135], v[68:71]
    s_waitcnt lgkmcnt(7)
    v_mfma_f32_16x16x32_bf16 v[40:43], a[4:7], v[136:139], v[40:43]
    buffer_load_dwordx4 a[104:107], v2, s[4:7], s55 offen offset:0 sc1
    v_mfma_f32_16x16x32_bf16 v[72:75], a[76:79], v[136:139], v[72:75]
    s_waitcnt vmcnt(18) lgkmcnt(6)
    v_mfma_f32_16x16x32_bf16 v[16:19], v[88:91], a[8:11], v[16:19]
    ds_read_b128 v[116:119], v3 offset:21504
    s_waitcnt vmcnt(17)
    v_mfma_f32_16x16x32_bf16 v[48:51], v[88:91], a[80:83], v[48:51]
    ds_read_b128 v[120:123], v3 offset:22528
    s_waitcnt lgkmcnt(7)
    v_mfma_f32_16x16x32_bf16 v[20:23], v[92:95], a[8:11], v[20:23]
    v_mfma_f32_16x16x32_bf16 v[52:55], v[92:95], a[80:83], v[52:55]
    buffer_load_dwordx4 a[36:39], v2, s[4:7], s54 offen offset:1024 sc1
    ds_read_b128 v[124:127], v3 offset:23552
    s_waitcnt lgkmcnt(7)
    v_mfma_f32_16x16x32_bf16 v[24:27], v[96:99], a[8:11], v[24:27]
    v_mfma_f32_16x16x32_bf16 v[56:59], v[96:99], a[80:83], v[56:59]
    ds_read_b128 v[128:131], v3 offset:24576
    s_waitcnt lgkmcnt(7)
    v_mfma_f32_16x16x32_bf16 v[28:31], v[100:103], a[8:11], v[28:31]
    v_mfma_f32_16x16x32_bf16 v[60:63], v[100:103], a[80:83], v[60:63]
    ds_read_b128 v[140:143], v3 offset:27648
    s_waitcnt lgkmcnt(7)
    v_mfma_f32_16x16x32_bf16 v[32:35], v[112:115], a[8:11], v[32:35]
    buffer_load_dwordx4 a[108:111], v2, s[4:7], s55 offen offset:1024 sc1
    v_mfma_f32_16x16x32_bf16 v[64:67], v[112:115], a[80:83], v[64:67]
    ds_read_b128 v[132:135], v3 offset:25600
    v_mfma_f32_16x16x32_bf16 v[44:47], a[8:11], v[112:115], v[44:47]
    v_mfma_f32_16x16x32_bf16 v[76:79], a[80:83], v[112:115], v[76:79]
    ds_read_b128 v[136:139], v3 offset:26624
    s_waitcnt lgkmcnt(8)
    v_mfma_f32_16x16x32_bf16 v[36:39], a[8:11], v[104:107], v[36:39]
    v_mfma_f32_16x16x32_bf16 v[68:71], a[80:83], v[104:107], v[68:71]
    buffer_load_dwordx4 a[40:43], v2, s[4:7], s54 offen offset:2048 sc1
    s_waitcnt lgkmcnt(7)
    v_mfma_f32_16x16x32_bf16 v[40:43], a[8:11], v[108:111], v[40:43]
    v_mfma_f32_16x16x32_bf16 v[72:75], a[80:83], v[108:111], v[72:75]
    s_waitcnt vmcnt(19) lgkmcnt(6)
    v_mfma_f32_16x16x32_bf16 v[16:19], v[116:119], a[12:15], v[16:19]
    ds_read_b128 v[88:91], v3 offset:28672
    s_waitcnt vmcnt(18)
    v_mfma_f32_16x16x32_bf16 v[48:51], v[116:119], a[84:87], v[48:51]
    ds_read_b128 v[92:95], v3 offset:29696
    s_waitcnt lgkmcnt(7)
    v_mfma_f32_16x16x32_bf16 v[20:23], v[120:123], a[12:15], v[20:23]
    buffer_load_dwordx4 a[112:115], v2, s[4:7], s55 offen offset:2048 sc1
    v_mfma_f32_16x16x32_bf16 v[52:55], v[120:123], a[84:87], v[52:55]
    ds_read_b128 v[96:99], v3 offset:30720
    s_waitcnt lgkmcnt(7)
    v_mfma_f32_16x16x32_bf16 v[24:27], v[124:127], a[12:15], v[24:27]
    v_mfma_f32_16x16x32_bf16 v[56:59], v[124:127], a[84:87], v[56:59]
    ds_read_b128 v[100:103], v3 offset:31744
    s_waitcnt lgkmcnt(7)
    v_mfma_f32_16x16x32_bf16 v[28:31], v[128:131], a[12:15], v[28:31]
    v_mfma_f32_16x16x32_bf16 v[60:63], v[128:131], a[84:87], v[60:63]
    buffer_load_dwordx4 a[44:47], v2, s[4:7], s54 offen offset:3072 sc1
    ds_read_b128 v[112:115], v3 offset:34816
    s_waitcnt lgkmcnt(7)
    v_mfma_f32_16x16x32_bf16 v[32:35], v[140:143], a[12:15], v[32:35]
    v_mfma_f32_16x16x32_bf16 v[64:67], v[140:143], a[84:87], v[64:67]
    ds_read_b128 v[104:107], v3 offset:32768
    v_mfma_f32_16x16x32_bf16 v[44:47], a[12:15], v[140:143], v[44:47]
    v_mfma_f32_16x16x32_bf16 v[76:79], a[84:87], v[140:143], v[76:79]
    ds_read_b128 v[108:111], v3 offset:33792
    s_waitcnt lgkmcnt(8)
    v_mfma_f32_16x16x32_bf16 v[36:39], a[12:15], v[132:135], v[36:39]
    buffer_load_dwordx4 a[116:119], v2, s[4:7], s55 offen offset:3072 sc1
    s_add_u32 s54, s51, 12288
    v_mfma_f32_16x16x32_bf16 v[68:71], a[84:87], v[132:135], v[68:71]
    s_waitcnt lgkmcnt(7)
    v_mfma_f32_16x16x32_bf16 v[40:43], a[12:15], v[136:139], v[40:43]
    v_mfma_f32_16x16x32_bf16 v[72:75], a[84:87], v[136:139], v[72:75]
    s_waitcnt vmcnt(20) lgkmcnt(6)
    v_mfma_f32_16x16x32_bf16 v[16:19], v[88:91], a[16:19], v[16:19]
    ds_read_b128 v[116:119], v3 offset:35840
    s_waitcnt vmcnt(19)
    v_mfma_f32_16x16x32_bf16 v[48:51], v[88:91], a[88:91], v[48:51]
    buffer_load_dwordx4 a[48:51], v2, s[4:7], s54 offen offset:0 sc1
    s_add_u32 s55, s51, 30720
    s_waitcnt lgkmcnt(6)
    v_mfma_f32_16x16x32_bf16 v[20:23], v[92:95], a[16:19], v[20:23]
    ds_read_b128 v[120:123], v3 offset:36864
    v_mfma_f32_16x16x32_bf16 v[52:55], v[92:95], a[88:91], v[52:55]
    ds_read_b128 v[124:127], v3 offset:37888
    s_waitcnt lgkmcnt(7)
    v_mfma_f32_16x16x32_bf16 v[24:27], v[96:99], a[16:19], v[24:27]
    v_mfma_f32_16x16x32_bf16 v[56:59], v[96:99], a[88:91], v[56:59]
    ds_read_b128 v[128:131], v3 offset:38912
    s_waitcnt lgkmcnt(7)
    v_mfma_f32_16x16x32_bf16 v[28:31], v[100:103], a[16:19], v[28:31]
    buffer_load_dwordx4 a[120:123], v2, s[4:7], s55 offen offset:0 sc1
    v_mfma_f32_16x16x32_bf16 v[60:63], v[100:103], a[88:91], v[60:63]
    ds_read_b128 v[140:143], v3 offset:41984
    s_waitcnt lgkmcnt(7)
    v_mfma_f32_16x16x32_bf16 v[32:35], v[112:115], a[16:19], v[32:35]
    v_mfma_f32_16x16x32_bf16 v[64:67], v[112:115], a[88:91], v[64:67]
    ds_read_b128 v[132:135], v3 offset:39936
    v_mfma_f32_16x16x32_bf16 v[44:47], a[16:19], v[112:115], v[44:47]
    v_mfma_f32_16x16x32_bf16 v[76:79], a[88:91], v[112:115], v[76:79]
    buffer_load_dwordx4 a[52:55], v2, s[4:7], s54 offen offset:1024 sc1
    ds_read_b128 v[136:139], v3 offset:40960
    s_waitcnt lgkmcnt(8)
    v_mfma_f32_16x16x32_bf16 v[36:39], a[16:19], v[104:107], v[36:39]
    v_mfma_f32_16x16x32_bf16 v[68:71], a[88:91], v[104:107], v[68:71]
    s_waitcnt lgkmcnt(7)
    v_mfma_f32_16x16x32_bf16 v[40:43], a[16:19], v[108:111], v[40:43]
    v_mfma_f32_16x16x32_bf16 v[72:75], a[88:91], v[108:111], v[72:75]
    s_waitcnt vmcnt(21) lgkmcnt(6)
    v_mfma_f32_16x16x32_bf16 v[16:19], v[116:119], a[20:23], v[16:19]
    s_waitcnt vmcnt(11)
    s_barrier
    v_mfma_f32_16x16x32_bf16 v[48:51], v[116:119], a[92:95], v[48:51]
    buffer_load_dwordx4 a[124:127], v2, s[4:7], s55 offen offset:1024 sc1
    ds_read_b128 v[88:91], v3 offset:43008
    s_waitcnt lgkmcnt(6)
    v_mfma_f32_16x16x32_bf16 v[20:23], v[120:123], a[20:23], v[20:23]
    ds_read_b128 v[92:95], v3 offset:44032
    ds_read_b128 v[144:147], v10 offset:0
    v_mfma_f32_16x16x32_bf16 v[52:55], v[120:123], a[92:95], v[52:55]
    ds_read_b128 v[96:99], v3 offset:45056
    ds_read_b128 v[148:151], v4 offset:0
    s_waitcnt lgkmcnt(9)
    v_mfma_f32_16x16x32_bf16 v[24:27], v[124:127], a[20:23], v[24:27]
    ds_read_b128 v[152:155], v5 offset:0
    ds_read_b128 v[156:159], v10 offset:1024
    v_mfma_f32_16x16x32_bf16 v[56:59], v[124:127], a[92:95], v[56:59]
    ds_read_b128 v[100:103], v3 offset:46080
    ds_read_b128 v[160:163], v4 offset:7168
    s_waitcnt lgkmcnt(12)
    v_mfma_f32_16x16x32_bf16 v[28:31], v[128:131], a[20:23], v[28:31]
    buffer_load_dwordx4 a[56:59], v2, s[4:7], s54 offen offset:2048 sc1
    ds_read_b128 v[164:167], v5 offset:7168
    v_mfma_f32_16x16x32_bf16 v[60:63], v[128:131], a[92:95], v[60:63]
    ds_read_b128 v[112:115], v3 offset:49152
    s_waitcnt lgkmcnt(13)
    v_mfma_f32_16x16x32_bf16 v[32:35], v[140:143], a[20:23], v[32:35]
    v_mfma_f32_16x16x32_bf16 v[64:67], v[140:143], a[92:95], v[64:67]
    ds_read_b128 v[104:107], v3 offset:47104
    v_mfma_f32_16x16x32_bf16 v[44:47], a[20:23], v[140:143], v[44:47]
    v_mfma_f32_16x16x32_bf16 v[76:79], a[92:95], v[140:143], v[76:79]
    buffer_load_dwordx4 a[128:131], v2, s[4:7], s55 offen offset:2048 sc1
    ds_read_b128 v[108:111], v3 offset:48128
    s_waitcnt lgkmcnt(14)
    v_mfma_f32_16x16x32_bf16 v[36:39], a[20:23], v[132:135], v[36:39]
    v_mfma_f32_16x16x32_bf16 v[68:71], a[92:95], v[132:135], v[68:71]
    s_waitcnt lgkmcnt(13)
    v_mfma_f32_16x16x32_bf16 v[40:43], a[20:23], v[136:139], v[40:43]
    v_mfma_f32_16x16x32_bf16 v[72:75], a[92:95], v[136:139], v[72:75]
    s_waitcnt lgkmcnt(12)
    v_mfma_f32_16x16x32_bf16 v[16:19], v[88:91], a[24:27], v[16:19]
    buffer_load_dwordx4 a[60:63], v2, s[4:7], s54 offen offset:3072 sc1
    ds_read_b128 v[116:119], v3 offset:50176
    v_mfma_f32_16x16x32_bf16 v[48:51], v[88:91], a[96:99], v[48:51]
    ds_read_b128 v[120:123], v3 offset:51200
    s_waitcnt lgkmcnt(13)
    v_mfma_f32_16x16x32_bf16 v[20:23], v[92:95], a[24:27], v[20:23]
    v_mfma_f32_16x16x32_bf16 v[52:55], v[92:95], a[96:99], v[52:55]
    ds_read_b128 v[124:127], v3 offset:52224
    s_waitcnt lgkmcnt(12)
    v_mfma_f32_16x16x32_bf16 v[24:27], v[96:99], a[24:27], v[24:27]
    v_mfma_f32_16x16x32_bf16 v[56:59], v[96:99], a[96:99], v[56:59]
    buffer_load_dwordx4 a[132:135], v2, s[4:7], s55 offen offset:3072 sc1
    s_add_u32 s54, s51, 16384
    s_waitcnt lgkmcnt(8)
    v_mfma_f32_16x16x32_bf16 v[28:31], v[100:103], a[24:27], v[28:31]
    ds_read_b128 v[128:131], v3 offset:53248
    v_mfma_f32_16x16x32_bf16 v[60:63], v[100:103], a[96:99], v[60:63]
    ds_read_b128 v[140:143], v3 offset:56320
    s_waitcnt lgkmcnt(7)
    v_mfma_f32_16x16x32_bf16 v[32:35], v[112:115], a[24:27], v[32:35]
    v_mfma_f32_16x16x32_bf16 v[64:67], v[112:115], a[96:99], v[64:67]
    ds_read_b128 v[132:135], v3 offset:54272
    v_mfma_f32_16x16x32_bf16 v[44:47], a[24:27], v[112:115], v[44:47]
    buffer_load_dwordx4 a[64:67], v2, s[4:7], s54 offen offset:0 sc1
    s_add_u32 s55, s51, 34816
    v_mfma_f32_16x16x32_bf16 v[76:79], a[96:99], v[112:115], v[76:79]
    ds_read_b128 v[136:139], v3 offset:55296
    s_waitcnt lgkmcnt(8)
    v_mfma_f32_16x16x32_bf16 v[36:39], a[24:27], v[104:107], v[36:39]
    v_mfma_f32_16x16x32_bf16 v[68:71], a[96:99], v[104:107], v[68:71]
    s_waitcnt lgkmcnt(7)
    v_mfma_f32_16x16x32_bf16 v[40:43], a[24:27], v[108:111], v[40:43]
    v_mfma_f32_16x16x32_bf16 v[72:75], a[96:99], v[108:111], v[72:75]
    buffer_load_dwordx4 a[136:139], v2, s[4:7], s55 offen offset:0 sc1
    v_mfma_f32_16x16x32_bf16 v[80:83], v[148:151], v[144:147], 0
    v_mfma_f32_16x16x32_bf16 v[84:87], v[144:147], v[152:155], 0
    ds_read_b128 v[144:147], v10 offset:2048
    ds_read_b128 v[148:151], v4 offset:14336
    s_waitcnt lgkmcnt(8)
    v_mfma_f32_16x16x32_bf16 v[16:19], v[116:119], a[28:31], v[16:19]
    ds_read_b128 v[88:91], v3 offset:57344
    ds_read_b128 v[152:155], v5 offset:14336
    v_mfma_f32_16x16x32_bf16 v[48:51], v[116:119], a[100:103], v[48:51]
    ds_read_b128 v[92:95], v3 offset:58368
    s_waitcnt lgkmcnt(10)
    v_mfma_f32_16x16x32_bf16 v[20:23], v[120:123], a[28:31], v[20:23]
    buffer_load_dwordx4 a[68:71], v2, s[4:7], s54 offen offset:1024 sc1
    v_mfma_f32_16x16x32_bf16 v[52:55], v[120:123], a[100:103], v[52:55]
    ds_read_b128 v[96:99], v3 offset:59392
    s_waitcnt lgkmcnt(10)
    v_mfma_f32_16x16x32_bf16 v[24:27], v[124:127], a[28:31], v[24:27]
    v_mfma_f32_16x16x32_bf16 v[56:59], v[124:127], a[100:103], v[56:59]
    ds_read_b128 v[100:103], v3 offset:60416
    s_waitcnt lgkmcnt(10)
    v_mfma_f32_16x16x32_bf16 v[28:31], v[128:131], a[28:31], v[28:31]
    v_mfma_f32_16x16x32_bf16 v[60:63], v[128:131], a[100:103], v[60:63]
    buffer_load_dwordx4 a[140:143], v2, s[4:7], s55 offen offset:1024 sc1
    ds_read_b128 v[112:115], v3 offset:63488
    s_waitcnt lgkmcnt(10)
    v_mfma_f32_16x16x32_bf16 v[32:35], v[140:143], a[28:31], v[32:35]
    v_mfma_f32_16x16x32_bf16 v[64:67], v[140:143], a[100:103], v[64:67]
    ds_read_b128 v[104:107], v3 offset:61440
    v_mfma_f32_16x16x32_bf16 v[44:47], a[28:31], v[140:143], v[44:47]
    v_mfma_f32_16x16x32_bf16 v[76:79], a[100:103], v[140:143], v[76:79]
    ds_read_b128 v[108:111], v3 offset:62464
    s_waitcnt lgkmcnt(11)
    v_mfma_f32_16x16x32_bf16 v[36:39], a[28:31], v[132:135], v[36:39]
    v_mfma_f32_16x16x32_bf16 v[68:71], a[100:103], v[132:135], v[68:71]
    s_waitcnt lgkmcnt(10)
    v_mfma_f32_16x16x32_bf16 v[40:43], a[28:31], v[136:139], v[40:43]
    v_mfma_f32_16x16x32_bf16 v[72:75], a[100:103], v[136:139], v[72:75]
    v_mfma_f32_16x16x32_bf16 v[80:83], v[160:163], v[156:159], v[80:83]
    v_mfma_f32_16x16x32_bf16 v[84:87], v[156:159], v[164:167], v[84:87]
    ds_read_b128 v[156:159], v10 offset:3072
    ds_read_b128 v[160:163], v4 offset:21504
    s_waitcnt vmcnt(19) lgkmcnt(9)
    v_mfma_f32_16x16x32_bf16 v[16:19], v[88:91], a[32:35], v[16:19]
    v_add_u32 v3, 64512, v3
    ds_read_b128 v[164:167], v5 offset:21504
    s_waitcnt vmcnt(18)
    v_mfma_f32_16x16x32_bf16 v[48:51], v[88:91], a[104:107], v[48:51]
    ds_read_b128 v[116:119], v3 offset:0
    s_waitcnt lgkmcnt(9)
    v_mfma_f32_16x16x32_bf16 v[20:23], v[92:95], a[32:35], v[20:23]
    v_mfma_f32_16x16x32_bf16 v[52:55], v[92:95], a[104:107], v[52:55]
    ds_read_b128 v[120:123], v3 offset:1024
    s_waitcnt lgkmcnt(9)
    v_mfma_f32_16x16x32_bf16 v[24:27], v[96:99], a[32:35], v[24:27]
    v_mfma_f32_16x16x32_bf16 v[56:59], v[96:99], a[104:107], v[56:59]
    ds_read_b128 v[124:127], v3 offset:2048
    s_waitcnt lgkmcnt(9)
    v_mfma_f32_16x16x32_bf16 v[28:31], v[100:103], a[32:35], v[28:31]
    v_mfma_f32_16x16x32_bf16 v[60:63], v[100:103], a[104:107], v[60:63]
    ds_read_b128 v[128:131], v3 offset:3072
    s_waitcnt lgkmcnt(9)
    v_mfma_f32_16x16x32_bf16 v[32:35], v[112:115], a[32:35], v[32:35]
    v_mfma_f32_16x16x32_bf16 v[64:67], v[112:115], a[104:107], v[64:67]
    ds_read_b128 v[140:143], v3 offset:6144
    v_mfma_f32_16x16x32_bf16 v[44:47], a[32:35], v[112:115], v[44:47]
    v_mfma_f32_16x16x32_bf16 v[76:79], a[104:107], v[112:115], v[76:79]
    ds_read_b128 v[132:135], v3 offset:4096
    s_waitcnt lgkmcnt(10)
    v_mfma_f32_16x16x32_bf16 v[36:39], a[32:35], v[104:107], v[36:39]
    v_mfma_f32_16x16x32_bf16 v[68:71], a[104:107], v[104:107], v[68:71]
    ds_read_b128 v[136:139], v3 offset:5120
    s_waitcnt lgkmcnt(10)
    v_mfma_f32_16x16x32_bf16 v[40:43], a[32:35], v[108:111], v[40:43]
    v_mfma_f32_16x16x32_bf16 v[72:75], a[104:107], v[108:111], v[72:75]
    v_mfma_f32_16x16x32_bf16 v[80:83], v[148:151], v[144:147], v[80:83]
    v_mfma_f32_16x16x32_bf16 v[84:87], v[144:147], v[152:155], v[84:87]
    ds_read_b128 v[144:147], v10 offset:4096
    ds_read_b128 v[148:151], v4 offset:28672
    s_waitcnt vmcnt(17) lgkmcnt(8)
    v_mfma_f32_16x16x32_bf16 v[16:19], v[116:119], a[36:39], v[16:19]
    ds_read_b128 v[88:91], v3 offset:7168
    ds_read_b128 v[152:155], v5 offset:28672
    s_waitcnt vmcnt(16)
    v_mfma_f32_16x16x32_bf16 v[48:51], v[116:119], a[108:111], v[48:51]
    ds_read_b128 v[92:95], v3 offset:8192
    s_waitcnt lgkmcnt(10)
    v_mfma_f32_16x16x32_bf16 v[20:23], v[120:123], a[36:39], v[20:23]
    v_mfma_f32_16x16x32_bf16 v[52:55], v[120:123], a[108:111], v[52:55]
    ds_read_b128 v[96:99], v3 offset:9216
    s_waitcnt lgkmcnt(10)
    v_mfma_f32_16x16x32_bf16 v[24:27], v[124:127], a[36:39], v[24:27]
    v_mfma_f32_16x16x32_bf16 v[56:59], v[124:127], a[108:111], v[56:59]
    ds_read_b128 v[100:103], v3 offset:10240
    s_waitcnt lgkmcnt(10)
    v_mfma_f32_16x16x32_bf16 v[28:31], v[128:131], a[36:39], v[28:31]
    v_mfma_f32_16x16x32_bf16 v[60:63], v[128:131], a[108:111], v[60:63]
    ds_read_b128 v[112:115], v3 offset:13312
    s_waitcnt lgkmcnt(10)
    v_mfma_f32_16x16x32_bf16 v[32:35], v[140:143], a[36:39], v[32:35]
    v_mfma_f32_16x16x32_bf16 v[64:67], v[140:143], a[108:111], v[64:67]
    ds_read_b128 v[104:107], v3 offset:11264
    v_mfma_f32_16x16x32_bf16 v[44:47], a[36:39], v[140:143], v[44:47]
    v_mfma_f32_16x16x32_bf16 v[76:79], a[108:111], v[140:143], v[76:79]
    ds_read_b128 v[108:111], v3 offset:12288
    s_waitcnt lgkmcnt(11)
    v_mfma_f32_16x16x32_bf16 v[36:39], a[36:39], v[132:135], v[36:39]
    v_mfma_f32_16x16x32_bf16 v[68:71], a[108:111], v[132:135], v[68:71]
    s_waitcnt lgkmcnt(10)
    v_mfma_f32_16x16x32_bf16 v[40:43], a[36:39], v[136:139], v[40:43]
    v_mfma_f32_16x16x32_bf16 v[72:75], a[108:111], v[136:139], v[72:75]
    v_mfma_f32_16x16x32_bf16 v[80:83], v[160:163], v[156:159], v[80:83]
    v_mfma_f32_16x16x32_bf16 v[84:87], v[156:159], v[164:167], v[84:87]
    ds_read_b128 v[156:159], v10 offset:5120
    ds_read_b128 v[160:163], v4 offset:35840
    s_waitcnt vmcnt(15) lgkmcnt(9)
    v_mfma_f32_16x16x32_bf16 v[16:19], v[88:91], a[40:43], v[16:19]
    ds_read_b128 v[116:119], v3 offset:14336
    ds_read_b128 v[164:167], v5 offset:35840
    s_waitcnt vmcnt(14)
    v_mfma_f32_16x16x32_bf16 v[48:51], v[88:91], a[112:115], v[48:51]
    ds_read_b128 v[120:123], v3 offset:15360
    s_waitcnt lgkmcnt(10)
    v_mfma_f32_16x16x32_bf16 v[20:23], v[92:95], a[40:43], v[20:23]
    v_mfma_f32_16x16x32_bf16 v[52:55], v[92:95], a[112:115], v[52:55]
    ds_read_b128 v[124:127], v3 offset:16384
    s_waitcnt lgkmcnt(10)
    v_mfma_f32_16x16x32_bf16 v[24:27], v[96:99], a[40:43], v[24:27]
    v_mfma_f32_16x16x32_bf16 v[56:59], v[96:99], a[112:115], v[56:59]
    ds_read_b128 v[128:131], v3 offset:17408
    s_waitcnt lgkmcnt(10)
    v_mfma_f32_16x16x32_bf16 v[28:31], v[100:103], a[40:43], v[28:31]
    v_mfma_f32_16x16x32_bf16 v[60:63], v[100:103], a[112:115], v[60:63]
    ds_read_b128 v[140:143], v3 offset:20480
    s_waitcnt lgkmcnt(10)
    v_mfma_f32_16x16x32_bf16 v[32:35], v[112:115], a[40:43], v[32:35]
    v_mfma_f32_16x16x32_bf16 v[64:67], v[112:115], a[112:115], v[64:67]
    ds_read_b128 v[132:135], v3 offset:18432
    v_mfma_f32_16x16x32_bf16 v[44:47], a[40:43], v[112:115], v[44:47]
    v_mfma_f32_16x16x32_bf16 v[76:79], a[112:115], v[112:115], v[76:79]
    ds_read_b128 v[136:139], v3 offset:19456
    s_waitcnt lgkmcnt(11)
    v_mfma_f32_16x16x32_bf16 v[36:39], a[40:43], v[104:107], v[36:39]
    v_mfma_f32_16x16x32_bf16 v[68:71], a[112:115], v[104:107], v[68:71]
    s_waitcnt lgkmcnt(10)
    v_mfma_f32_16x16x32_bf16 v[40:43], a[40:43], v[108:111], v[40:43]
    v_mfma_f32_16x16x32_bf16 v[72:75], a[112:115], v[108:111], v[72:75]
    v_mfma_f32_16x16x32_bf16 v[80:83], v[148:151], v[144:147], v[80:83]
    v_mfma_f32_16x16x32_bf16 v[84:87], v[144:147], v[152:155], v[84:87]
    ds_read_b128 v[144:147], v10 offset:6144
    ds_read_b128 v[148:151], v4 offset:43008
    s_waitcnt vmcnt(13) lgkmcnt(9)
    v_mfma_f32_16x16x32_bf16 v[16:19], v[116:119], a[44:47], v[16:19]
    ds_read_b128 v[88:91], v3 offset:21504
    ds_read_b128 v[152:155], v5 offset:43008
    s_waitcnt vmcnt(12)
    v_mfma_f32_16x16x32_bf16 v[48:51], v[116:119], a[116:119], v[48:51]
    ds_read_b128 v[92:95], v3 offset:22528
    s_waitcnt lgkmcnt(10)
    v_mfma_f32_16x16x32_bf16 v[20:23], v[120:123], a[44:47], v[20:23]
    v_mfma_f32_16x16x32_bf16 v[52:55], v[120:123], a[116:119], v[52:55]
    ds_read_b128 v[96:99], v3 offset:23552
    s_waitcnt lgkmcnt(10)
    v_mfma_f32_16x16x32_bf16 v[24:27], v[124:127], a[44:47], v[24:27]
    v_mfma_f32_16x16x32_bf16 v[56:59], v[124:127], a[116:119], v[56:59]
    ds_read_b128 v[100:103], v3 offset:24576
    s_waitcnt lgkmcnt(10)
    v_mfma_f32_16x16x32_bf16 v[28:31], v[128:131], a[44:47], v[28:31]
    v_mfma_f32_16x16x32_bf16 v[60:63], v[128:131], a[116:119], v[60:63]
    ds_read_b128 v[112:115], v3 offset:27648
    s_waitcnt lgkmcnt(10)
    v_mfma_f32_16x16x32_bf16 v[32:35], v[140:143], a[44:47], v[32:35]
    v_mfma_f32_16x16x32_bf16 v[64:67], v[140:143], a[116:119], v[64:67]
    ds_read_b128 v[104:107], v3 offset:25600
    v_mfma_f32_16x16x32_bf16 v[44:47], a[44:47], v[140:143], v[44:47]
    v_mfma_f32_16x16x32_bf16 v[76:79], a[116:119], v[140:143], v[76:79]
    ds_read_b128 v[108:111], v3 offset:26624
    s_waitcnt lgkmcnt(11)
    v_mfma_f32_16x16x32_bf16 v[36:39], a[44:47], v[132:135], v[36:39]
    v_mfma_f32_16x16x32_bf16 v[68:71], a[116:119], v[132:135], v[68:71]
    s_waitcnt lgkmcnt(10)
    v_mfma_f32_16x16x32_bf16 v[40:43], a[44:47], v[136:139], v[40:43]
    v_mfma_f32_16x16x32_bf16 v[72:75], a[116:119], v[136:139], v[72:75]
    v_mfma_f32_16x16x32_bf16 v[80:83], v[160:163], v[156:159], v[80:83]
    v_mfma_f32_16x16x32_bf16 v[84:87], v[156:159], v[164:167], v[84:87]
    ds_read_b128 v[156:159], v10 offset:7168
    ds_read_b128 v[160:163], v4 offset:50176
    s_waitcnt vmcnt(11) lgkmcnt(9)
    v_mfma_f32_16x16x32_bf16 v[16:19], v[88:91], a[48:51], v[16:19]
    ds_read_b128 v[164:167], v5 offset:50176
    ds_read_b128 v[116:119], v3 offset:28672
    s_waitcnt vmcnt(10)
    v_mfma_f32_16x16x32_bf16 v[48:51], v[88:91], a[120:123], v[48:51]
    ds_read_b128 v[120:123], v3 offset:29696
    s_waitcnt lgkmcnt(10)
    v_mfma_f32_16x16x32_bf16 v[20:23], v[92:95], a[48:51], v[20:23]
    v_mfma_f32_16x16x32_bf16 v[52:55], v[92:95], a[120:123], v[52:55]
    ds_read_b128 v[124:127], v3 offset:30720
    s_waitcnt lgkmcnt(10)
    v_mfma_f32_16x16x32_bf16 v[24:27], v[96:99], a[48:51], v[24:27]
    v_mfma_f32_16x16x32_bf16 v[56:59], v[96:99], a[120:123], v[56:59]
    ds_read_b128 v[128:131], v3 offset:31744
    s_waitcnt lgkmcnt(10)
    v_mfma_f32_16x16x32_bf16 v[28:31], v[100:103], a[48:51], v[28:31]
    v_mfma_f32_16x16x32_bf16 v[60:63], v[100:103], a[120:123], v[60:63]
    ds_read_b128 v[140:143], v3 offset:34816
    v_mfma_f32_16x16x32_bf16 v[80:83], v[148:151], v[144:147], v[80:83]
    v_mfma_f32_16x16x32_bf16 v[84:87], v[144:147], v[152:155], v[84:87]
    ds_read_b128 v[132:135], v3 offset:32768
    ds_read_b128 v[144:147], v10 offset:8192
    s_waitcnt lgkmcnt(12)
    v_mfma_f32_16x16x32_bf16 v[32:35], v[112:115], a[48:51], v[32:35]
    ds_read_b128 v[148:151], v4 offset:57344
    ds_read_b128 v[152:155], v5 offset:57344
    v_mfma_f32_16x16x32_bf16 v[64:67], v[112:115], a[120:123], v[64:67]
    ds_read_b128 v[136:139], v3 offset:33792
    v_mfma_f32_16x16x32_bf16 v[44:47], a[48:51], v[112:115], v[44:47]
    v_mfma_f32_16x16x32_bf16 v[76:79], a[120:123], v[112:115], v[76:79]
    s_waitcnt lgkmcnt(14)
    v_mfma_f32_16x16x32_bf16 v[36:39], a[48:51], v[104:107], v[36:39]
    v_mfma_f32_16x16x32_bf16 v[68:71], a[120:123], v[104:107], v[68:71]
    s_waitcnt lgkmcnt(13)
    v_mfma_f32_16x16x32_bf16 v[40:43], a[48:51], v[108:111], v[40:43]
    v_mfma_f32_16x16x32_bf16 v[72:75], a[120:123], v[108:111], v[72:75]
    s_waitcnt lgkmcnt(11)
    v_mfma_f32_16x16x32_bf16 v[80:83], v[160:163], v[156:159], v[80:83]
    s_waitcnt lgkmcnt(10)
    v_mfma_f32_16x16x32_bf16 v[84:87], v[156:159], v[164:167], v[84:87]
    v_add_u32 v4, 64512, v4
    v_add_u32 v5, 64512, v5
    s_waitcnt vmcnt(9) lgkmcnt(9)
    v_mfma_f32_16x16x32_bf16 v[16:19], v[116:119], a[52:55], v[16:19]
    ds_read_b128 v[156:159], v10 offset:9216
    ds_read_b128 v[160:163], v4 offset:0
    s_waitcnt vmcnt(8)
    v_mfma_f32_16x16x32_bf16 v[48:51], v[116:119], a[124:127], v[48:51]
    ds_read_b128 v[164:167], v5 offset:0
    ds_read_b128 v[88:91], v3 offset:35840
    s_waitcnt lgkmcnt(12)
    v_mfma_f32_16x16x32_bf16 v[20:23], v[120:123], a[52:55], v[20:23]
    ds_read_b128 v[92:95], v3 offset:36864
    v_mfma_f32_16x16x32_bf16 v[52:55], v[120:123], a[124:127], v[52:55]
    ds_read_b128 v[96:99], v3 offset:37888
    s_waitcnt lgkmcnt(13)
    v_mfma_f32_16x16x32_bf16 v[24:27], v[124:127], a[52:55], v[24:27]
    v_mfma_f32_16x16x32_bf16 v[56:59], v[124:127], a[124:127], v[56:59]
    ds_read_b128 v[100:103], v3 offset:38912
    s_waitcnt lgkmcnt(13)
    v_mfma_f32_16x16x32_bf16 v[28:31], v[128:131], a[52:55], v[28:31]
    v_mfma_f32_16x16x32_bf16 v[60:63], v[128:131], a[124:127], v[60:63]
    ds_read_b128 v[112:115], v3 offset:41984
    s_waitcnt lgkmcnt(10)
    v_mfma_f32_16x16x32_bf16 v[80:83], v[148:151], v[144:147], v[80:83]
    s_waitcnt lgkmcnt(9)
    v_mfma_f32_16x16x32_bf16 v[84:87], v[144:147], v[152:155], v[84:87]
    ds_read_b128 v[104:107], v3 offset:39936
    ds_read_b128 v[144:147], v10 offset:10240
    v_mfma_f32_16x16x32_bf16 v[32:35], v[140:143], a[52:55], v[32:35]
    ds_read_b128 v[148:151], v4 offset:7168
    ds_read_b128 v[152:155], v5 offset:7168
    v_mfma_f32_16x16x32_bf16 v[64:67], v[140:143], a[124:127], v[64:67]
    ds_read_b128 v[108:111], v3 offset:40960
    v_mfma_f32_16x16x32_bf16 v[44:47], a[52:55], v[140:143], v[44:47]
    v_mfma_f32_16x16x32_bf16 v[76:79], a[124:127], v[140:143], v[76:79]
    v_mfma_f32_16x16x32_bf16 v[36:39], a[52:55], v[132:135], v[36:39]
    v_mfma_f32_16x16x32_bf16 v[68:71], a[124:127], v[132:135], v[68:71]
    s_waitcnt lgkmcnt(13)
    v_mfma_f32_16x16x32_bf16 v[40:43], a[52:55], v[136:139], v[40:43]
    v_mfma_f32_16x16x32_bf16 v[72:75], a[124:127], v[136:139], v[72:75]
    s_waitcnt lgkmcnt(11)
    v_mfma_f32_16x16x32_bf16 v[80:83], v[160:163], v[156:159], v[80:83]
    s_waitcnt lgkmcnt(10)
    v_mfma_f32_16x16x32_bf16 v[84:87], v[156:159], v[164:167], v[84:87]
    ds_read_b128 v[156:159], v10 offset:11264
    ds_read_b128 v[160:163], v4 offset:14336
    s_waitcnt vmcnt(7) lgkmcnt(11)
    v_mfma_f32_16x16x32_bf16 v[16:19], v[88:91], a[56:59], v[16:19]
    ds_read_b128 v[164:167], v5 offset:14336
    ds_read_b128 v[116:119], v3 offset:43008
    s_waitcnt vmcnt(6)
    v_mfma_f32_16x16x32_bf16 v[48:51], v[88:91], a[128:131], v[48:51]
    ds_read_b128 v[120:123], v3 offset:44032
    s_waitcnt lgkmcnt(13)
    v_mfma_f32_16x16x32_bf16 v[20:23], v[92:95], a[56:59], v[20:23]
    v_mfma_f32_16x16x32_bf16 v[52:55], v[92:95], a[128:131], v[52:55]
    ds_read_b128 v[124:127], v3 offset:45056
    s_waitcnt lgkmcnt(13)
    v_mfma_f32_16x16x32_bf16 v[24:27], v[96:99], a[56:59], v[24:27]
    v_mfma_f32_16x16x32_bf16 v[56:59], v[96:99], a[128:131], v[56:59]
    ds_read_b128 v[128:131], v3 offset:46080
    s_waitcnt lgkmcnt(13)
    v_mfma_f32_16x16x32_bf16 v[28:31], v[100:103], a[56:59], v[28:31]
    v_mfma_f32_16x16x32_bf16 v[60:63], v[100:103], a[128:131], v[60:63]
    ds_read_b128 v[140:143], v3 offset:49152
    s_waitcnt lgkmcnt(10)
    v_mfma_f32_16x16x32_bf16 v[80:83], v[148:151], v[144:147], v[80:83]
    s_waitcnt lgkmcnt(9)
    v_mfma_f32_16x16x32_bf16 v[84:87], v[144:147], v[152:155], v[84:87]
    ds_read_b128 v[132:135], v3 offset:47104
    ds_read_b128 v[144:147], v10 offset:12288
    v_mfma_f32_16x16x32_bf16 v[32:35], v[112:115], a[56:59], v[32:35]
    ds_read_b128 v[148:151], v4 offset:21504
    ds_read_b128 v[152:155], v5 offset:21504
    v_mfma_f32_16x16x32_bf16 v[64:67], v[112:115], a[128:131], v[64:67]
    ds_read_b128 v[136:139], v3 offset:48128
    v_mfma_f32_16x16x32_bf16 v[44:47], a[56:59], v[112:115], v[44:47]
    v_mfma_f32_16x16x32_bf16 v[76:79], a[128:131], v[112:115], v[76:79]
    v_mfma_f32_16x16x32_bf16 v[36:39], a[56:59], v[104:107], v[36:39]
    v_mfma_f32_16x16x32_bf16 v[68:71], a[128:131], v[104:107], v[68:71]
    s_waitcnt lgkmcnt(13)
    v_mfma_f32_16x16x32_bf16 v[40:43], a[56:59], v[108:111], v[40:43]
    v_mfma_f32_16x16x32_bf16 v[72:75], a[128:131], v[108:111], v[72:75]
    s_waitcnt lgkmcnt(11)
    v_mfma_f32_16x16x32_bf16 v[80:83], v[160:163], v[156:159], v[80:83]
    s_waitcnt lgkmcnt(10)
    v_mfma_f32_16x16x32_bf16 v[84:87], v[156:159], v[164:167], v[84:87]
    ds_read_b128 v[156:159], v10 offset:13312
    ds_read_b128 v[160:163], v4 offset:28672
    s_waitcnt vmcnt(5) lgkmcnt(11)
    v_mfma_f32_16x16x32_bf16 v[16:19], v[116:119], a[60:63], v[16:19]
    ds_read_b128 v[164:167], v5 offset:28672
    ds_read_b128 v[88:91], v3 offset:50176
    s_waitcnt vmcnt(4)
    v_mfma_f32_16x16x32_bf16 v[48:51], v[116:119], a[132:135], v[48:51]
    ds_read_b128 v[92:95], v3 offset:51200
    s_waitcnt lgkmcnt(13)
    v_mfma_f32_16x16x32_bf16 v[20:23], v[120:123], a[60:63], v[20:23]
    v_mfma_f32_16x16x32_bf16 v[52:55], v[120:123], a[132:135], v[52:55]
    ds_read_b128 v[96:99], v3 offset:52224
    s_waitcnt lgkmcnt(13)
    v_mfma_f32_16x16x32_bf16 v[24:27], v[124:127], a[60:63], v[24:27]
    v_mfma_f32_16x16x32_bf16 v[56:59], v[124:127], a[132:135], v[56:59]
    ds_read_b128 v[100:103], v3 offset:53248
    s_waitcnt lgkmcnt(13)
    v_mfma_f32_16x16x32_bf16 v[28:31], v[128:131], a[60:63], v[28:31]
    v_mfma_f32_16x16x32_bf16 v[60:63], v[128:131], a[132:135], v[60:63]
    ds_read_b128 v[112:115], v3 offset:56320
    s_waitcnt lgkmcnt(10)
    v_mfma_f32_16x16x32_bf16 v[80:83], v[148:151], v[144:147], v[80:83]
    s_waitcnt lgkmcnt(9)
    v_mfma_f32_16x16x32_bf16 v[84:87], v[144:147], v[152:155], v[84:87]
    ds_read_b128 v[104:107], v3 offset:54272
    ds_read_b128 v[144:147], v10 offset:14336
    v_mfma_f32_16x16x32_bf16 v[32:35], v[140:143], a[60:63], v[32:35]
    ds_read_b128 v[148:151], v4 offset:35840
    ds_read_b128 v[152:155], v5 offset:35840
    v_mfma_f32_16x16x32_bf16 v[64:67], v[140:143], a[132:135], v[64:67]
    ds_read_b128 v[108:111], v3 offset:55296
    v_mfma_f32_16x16x32_bf16 v[44:47], a[60:63], v[140:143], v[44:47]
    v_mfma_f32_16x16x32_bf16 v[76:79], a[132:135], v[140:143], v[76:79]
    v_mfma_f32_16x16x32_bf16 v[36:39], a[60:63], v[132:135], v[36:39]
    v_mfma_f32_16x16x32_bf16 v[68:71], a[132:135], v[132:135], v[68:71]
    s_waitcnt lgkmcnt(13)
    v_mfma_f32_16x16x32_bf16 v[40:43], a[60:63], v[136:139], v[40:43]
    v_mfma_f32_16x16x32_bf16 v[72:75], a[132:135], v[136:139], v[72:75]
    s_waitcnt lgkmcnt(11)
    v_mfma_f32_16x16x32_bf16 v[80:83], v[160:163], v[156:159], v[80:83]
    s_waitcnt lgkmcnt(10)
    v_mfma_f32_16x16x32_bf16 v[84:87], v[156:159], v[164:167], v[84:87]
    ds_read_b128 v[156:159], v10 offset:15360
    ds_read_b128 v[160:163], v4 offset:43008
    s_waitcnt vmcnt(3) lgkmcnt(11)
    v_mfma_f32_16x16x32_bf16 v[16:19], v[88:91], a[64:67], v[16:19]
    ds_read_b128 v[164:167], v5 offset:43008
    ds_read_b128 v[116:119], v3 offset:57344
    s_waitcnt vmcnt(2)
    v_mfma_f32_16x16x32_bf16 v[48:51], v[88:91], a[136:139], v[48:51]
    ds_read_b128 v[120:123], v3 offset:58368
    s_waitcnt lgkmcnt(13)
    v_mfma_f32_16x16x32_bf16 v[20:23], v[92:95], a[64:67], v[20:23]
    v_mfma_f32_16x16x32_bf16 v[52:55], v[92:95], a[136:139], v[52:55]
    ds_read_b128 v[124:127], v3 offset:59392
    s_waitcnt lgkmcnt(13)
    v_mfma_f32_16x16x32_bf16 v[24:27], v[96:99], a[64:67], v[24:27]
    v_mfma_f32_16x16x32_bf16 v[56:59], v[96:99], a[136:139], v[56:59]
    ds_read_b128 v[128:131], v3 offset:60416
    s_waitcnt lgkmcnt(13)
    v_mfma_f32_16x16x32_bf16 v[28:31], v[100:103], a[64:67], v[28:31]
    v_mfma_f32_16x16x32_bf16 v[60:63], v[100:103], a[136:139], v[60:63]
    ds_read_b128 v[140:143], v3 offset:63488
    s_waitcnt lgkmcnt(10)
    v_mfma_f32_16x16x32_bf16 v[80:83], v[148:151], v[144:147], v[80:83]
    s_waitcnt lgkmcnt(9)
    v_mfma_f32_16x16x32_bf16 v[84:87], v[144:147], v[152:155], v[84:87]
    ds_read_b128 v[132:135], v3 offset:61440
    ds_read_b128 v[144:147], v10 offset:16384
    v_mfma_f32_16x16x32_bf16 v[32:35], v[112:115], a[64:67], v[32:35]
    ds_read_b128 v[148:151], v4 offset:50176
    ds_read_b128 v[152:155], v5 offset:50176
    v_mfma_f32_16x16x32_bf16 v[64:67], v[112:115], a[136:139], v[64:67]
    ds_read_b128 v[136:139], v3 offset:62464
    v_mfma_f32_16x16x32_bf16 v[44:47], a[64:67], v[112:115], v[44:47]
    v_mfma_f32_16x16x32_bf16 v[76:79], a[136:139], v[112:115], v[76:79]
    v_mfma_f32_16x16x32_bf16 v[36:39], a[64:67], v[104:107], v[36:39]
    v_mfma_f32_16x16x32_bf16 v[68:71], a[136:139], v[104:107], v[68:71]
    s_waitcnt lgkmcnt(13)
    v_mfma_f32_16x16x32_bf16 v[40:43], a[64:67], v[108:111], v[40:43]
    v_mfma_f32_16x16x32_bf16 v[72:75], a[136:139], v[108:111], v[72:75]
    s_waitcnt lgkmcnt(11)
    v_mfma_f32_16x16x32_bf16 v[80:83], v[160:163], v[156:159], v[80:83]
    s_waitcnt lgkmcnt(10)
    v_mfma_f32_16x16x32_bf16 v[84:87], v[156:159], v[164:167], v[84:87]
    ds_read_b128 v[156:159], v10 offset:17408
    ds_read_b128 v[160:163], v4 offset:57344
    s_waitcnt vmcnt(1) lgkmcnt(11)
    v_mfma_f32_16x16x32_bf16 v[16:19], v[116:119], a[68:71], v[16:19]
    ds_read_b128 v[164:167], v5 offset:57344
    s_waitcnt vmcnt(0)
    v_mfma_f32_16x16x32_bf16 v[48:51], v[116:119], a[140:143], v[48:51]
    s_waitcnt lgkmcnt(11)
    v_mfma_f32_16x16x32_bf16 v[20:23], v[120:123], a[68:71], v[20:23]
    v_mfma_f32_16x16x32_bf16 v[52:55], v[120:123], a[140:143], v[52:55]
    s_waitcnt lgkmcnt(10)
    v_mfma_f32_16x16x32_bf16 v[24:27], v[124:127], a[68:71], v[24:27]
    v_mfma_f32_16x16x32_bf16 v[56:59], v[124:127], a[140:143], v[56:59]
    s_waitcnt lgkmcnt(9)
    v_mfma_f32_16x16x32_bf16 v[28:31], v[128:131], a[68:71], v[28:31]
    v_mfma_f32_16x16x32_bf16 v[60:63], v[128:131], a[140:143], v[60:63]
    s_waitcnt lgkmcnt(5)
    v_mfma_f32_16x16x32_bf16 v[80:83], v[148:151], v[144:147], v[80:83]
    s_waitcnt lgkmcnt(4)
    v_mfma_f32_16x16x32_bf16 v[84:87], v[144:147], v[152:155], v[84:87]
    v_mfma_f32_16x16x32_bf16 v[32:35], v[140:143], a[68:71], v[32:35]
    v_mfma_f32_16x16x32_bf16 v[64:67], v[140:143], a[140:143], v[64:67]
    v_mfma_f32_16x16x32_bf16 v[44:47], a[68:71], v[140:143], v[44:47]
    v_mfma_f32_16x16x32_bf16 v[76:79], a[140:143], v[140:143], v[76:79]
    v_mfma_f32_16x16x32_bf16 v[36:39], a[68:71], v[132:135], v[36:39]
    v_mfma_f32_16x16x32_bf16 v[68:71], a[140:143], v[132:135], v[68:71]
    s_waitcnt lgkmcnt(3)
    v_mfma_f32_16x16x32_bf16 v[40:43], a[68:71], v[136:139], v[40:43]
    v_mfma_f32_16x16x32_bf16 v[72:75], a[140:143], v[136:139], v[72:75]
    s_waitcnt lgkmcnt(1)
    v_mfma_f32_16x16x32_bf16 v[80:83], v[160:163], v[156:159], v[80:83]
    s_waitcnt lgkmcnt(0)
    v_mfma_f32_16x16x32_bf16 v[84:87], v[156:159], v[164:167], v[84:87]
    v_lshlrev_b32 v6, 3, v1
    v_add_u32 v6, 148608, v6
    s_mul_i32 s52, s20, 3072
    v_add_u32 v7, s52, v6
    v_cvt_pk_bf16_f32 v100, v56, v57
    v_cvt_pk_bf16_f32 v101, v58, v59
    v_cvt_pk_bf16_f32 v104, v60, v61
    v_cvt_pk_bf16_f32 v105, v62, v63
    v_cvt_pk_bf16_f32 v134, v64, v65
    v_cvt_pk_bf16_f32 v137, v66, v67
    v_mov_b32 v102, 0
    v_mov_b32 v103, 0
    v_cvt_pk_bf16_f32 v110, v68, v69
    v_cvt_pk_bf16_f32 v111, v70, v71
    v_cvt_pk_bf16_f32 v116, v72, v73
    v_cvt_pk_bf16_f32 v117, v74, v75
    v_cvt_pk_bf16_f32 v122, v76, v77
    v_cvt_pk_bf16_f32 v123, v78, v79
    v_permlane32_swap_b32 v134, v102
    v_permlane32_swap_b32 v137, v103
    s_cmp_eq_u32 s20, 3
    s_cbranch_scc1 L_w3_83
    ds_write_b64 v7, v[100:101] offset:3072
    ds_write_b64 v7, v[102:103] offset:3584
    ds_write_b64 v7, v[104:105] offset:4096
    ds_write_b64 v7, v[110:111] offset:4608
    ds_write_b64 v7, v[116:117] offset:5120
    ds_write_b64 v7, v[122:123] offset:5632
L_w3_83:
    v_cvt_pk_bf16_f32 v140, v80, v81
    v_cvt_pk_bf16_f32 v141, v82, v83
    v_cvt_pk_bf16_f32 v142, v84, v85
    v_cvt_pk_bf16_f32 v143, v86, v87
    s_min_u32 s52, s20, 2
    s_lshl_b32 s53, s52, 1
    s_cmp_ge_u32 s20, 2
    s_cselect_b32 s53, 1, s53
    s_lshl_b32 s53, s53, 9
    s_add_u32 s52, s52, 3
    s_lshl_b32 s52, s52, 9
    v_add_u32 v8, s53, v6
    v_add_u32 v9, s52, v6
    s_cmp_lt_u32 s20, 2
    s_cbranch_scc1 L_noswap_84
    v_mov_b32 v10, 0
    v_mov_b32 v11, 0
    s_nop 1
    v_permlane32_swap_b32 v140, v10
    v_permlane32_swap_b32 v141, v11
    v_mov_b32 v140, v10
    v_mov_b32 v141, v11
L_noswap_84:
    ds_write_b64 v8, v[140:141]
    ds_write_b64 v9, v[142:143]
    v_cvt_pk_bf16_f32 v132, v48, v49
    v_cvt_pk_bf16_f32 v133, v50, v51
    v_cvt_pk_bf16_f32 v138, v52, v53
    v_cvt_pk_bf16_f32 v139, v54, v55
    v_mov_b32 v135, 0
    v_mov_b32 v136, 0
    v_cvt_pk_bf16_f32 v94, v24, v25
    v_cvt_pk_bf16_f32 v95, v26, v27
    v_cvt_pk_bf16_f32 v98, v28, v29
    v_cvt_pk_bf16_f32 v99, v30, v31
    v_cvt_pk_bf16_f32 v126, v32, v33
    v_cvt_pk_bf16_f32 v129, v34, v35
    v_mov_b32 v96, 0
    v_mov_b32 v97, 0
    v_cvt_pk_bf16_f32 v108, v36, v37
    v_cvt_pk_bf16_f32 v109, v38, v39
    v_cvt_pk_bf16_f32 v114, v40, v41
    v_cvt_pk_bf16_f32 v115, v42, v43
    v_cvt_pk_bf16_f32 v120, v44, v45
    v_cvt_pk_bf16_f32 v121, v46, v47
    v_permlane32_swap_b32 v126, v96
    v_permlane32_swap_b32 v129, v97
    v_cvt_pk_bf16_f32 v124, v16, v17
    v_cvt_pk_bf16_f32 v125, v18, v19
    v_cvt_pk_bf16_f32 v130, v20, v21
    v_cvt_pk_bf16_f32 v131, v22, v23
    v_mov_b32 v127, 0
    v_mov_b32 v128, 0
    v_mov_b32 v12, 0x3f803f80
    v_mov_b32 v13, 0x3f803f80
    v_mov_b32 v14, 0x3f803f80
    v_mov_b32 v15, 0x3f803f80
    v_mfma_f32_16x16x32_bf16 v[32:35], v[94:97], v[132:135], v[172:175]
    v_mfma_f32_16x16x32_bf16 v[36:39], v[100:103], v[132:135], v[168:171]
    v_mfma_f32_16x16x32_bf16 v[20:23], v[94:97], v[124:127], v[168:171]
    v_mfma_f32_16x16x32_bf16 v[40:43], v[96:99], v[136:139], v[172:175]
    v_mfma_f32_16x16x32_bf16 v[44:47], v[102:105], v[136:139], v[168:171]
    v_mfma_f32_16x16x32_bf16 v[28:31], v[96:99], v[128:131], v[168:171]
    s_waitcnt lgkmcnt(0)
    s_barrier
    ds_read_b64 v[88:89], v7 offset:0
    ds_read_b64 v[90:91], v7 offset:512
    ds_read_b64 v[92:93], v7 offset:1024
    ds_read_b64 v[106:107], v7 offset:1536
    ds_read_b64 v[112:113], v7 offset:2048
    ds_read_b64 v[118:119], v7 offset:2560
    s_mov_b32 s52, 0x3eae1a93
    s_waitcnt lgkmcnt(4)
    v_mfma_f32_16x16x32_bf16 v[16:19], v[88:91], v[124:127], v[176:179]
    s_waitcnt lgkmcnt(3)
    v_mfma_f32_16x16x32_bf16 v[24:27], v[90:93], v[128:131], v[176:179]
    v_max3_f32 v48, v32, v33, v34
    v_max3_f32 v49, v40, v41, v42
    s_nop 3
    v_max3_f32 v50, v16, v17, v18
    s_nop 0
    v_max3_f32 v51, v24, v25, v26
    v_max3_f32 v48, v48, v35, v36
    v_max3_f32 v49, v49, v43, v44
    v_max3_f32 v50, v50, v19, v20
    v_max3_f32 v51, v51, v27, v28
    v_max3_f32 v48, v48, v37, v38
    v_max3_f32 v49, v49, v45, v46
    v_max3_f32 v50, v50, v21, v22
    v_max3_f32 v51, v51, v29, v30
    v_max_f32 v48, v48, v39
    v_max_f32 v49, v49, v47
    v_max_f32 v50, v50, v23
    v_max_f32 v51, v51, v31
    v_mov_b32 v52, v48
    v_mov_b32 v53, v49
    v_mov_b32 v54, v50
    v_mov_b32 v55, v51
    v_permlane16_swap_b32 v48, v52
    v_permlane16_swap_b32 v49, v53
    v_permlane16_swap_b32 v50, v54
    v_permlane16_swap_b32 v51, v55
    v_max_f32 v48, v48, v52
    v_max_f32 v49, v49, v53
    v_max_f32 v50, v50, v54
    v_max_f32 v51, v51, v55
    v_mov_b32 v52, v48
    v_mov_b32 v53, v49
    v_mov_b32 v54, v50
    v_mov_b32 v55, v51
    v_permlane32_swap_b32 v48, v52
    v_permlane32_swap_b32 v49, v53
    v_permlane32_swap_b32 v50, v54
    v_permlane32_swap_b32 v51, v55
    v_max_f32 v48, v48, v52
    v_max_f32 v49, v49, v53
    v_max_f32 v50, v50, v54
    v_max_f32 v51, v51, v55
    v_mul_f32 v48, s52, v48
    v_mul_f32 v49, s52, v49
    v_mul_f32 v50, s52, v50
    v_mul_f32 v51, s52, v51
    v_fma_f32 v32, v32, s52, -v48
    v_fma_f32 v40, v40, s52, -v49
    v_fma_f32 v16, v16, s52, -v50
    v_fma_f32 v24, v24, s52, -v51
    v_fma_f32 v33, v33, s52, -v48
    v_fma_f32 v41, v41, s52, -v49
    v_fma_f32 v17, v17, s52, -v50
    v_fma_f32 v25, v25, s52, -v51
    v_fma_f32 v34, v34, s52, -v48
    v_fma_f32 v42, v42, s52, -v49
    v_fma_f32 v18, v18, s52, -v50
    v_fma_f32 v26, v26, s52, -v51
    v_fma_f32 v35, v35, s52, -v48
    v_fma_f32 v43, v43, s52, -v49
    v_fma_f32 v19, v19, s52, -v50
    v_fma_f32 v27, v27, s52, -v51
    v_fma_f32 v36, v36, s52, -v48
    v_fma_f32 v44, v44, s52, -v49
    v_fma_f32 v20, v20, s52, -v50
    v_fma_f32 v28, v28, s52, -v51
    v_fma_f32 v37, v37, s52, -v48
    v_fma_f32 v45, v45, s52, -v49
    v_fma_f32 v21, v21, s52, -v50
    v_fma_f32 v29, v29, s52, -v51
    v_fma_f32 v38, v38, s52, -v48
    v_fma_f32 v46, v46, s52, -v49
    v_fma_f32 v22, v22, s52, -v50
    v_fma_f32 v30, v30, s52, -v51
    v_fma_f32 v39, v39, s52, -v48
    v_fma_f32 v47, v47, s52, -v49
    v_fma_f32 v23, v23, s52, -v50
    v_fma_f32 v31, v31, s52, -v51
    v_exp_f32 v32, v32
    v_exp_f32 v40, v40
    v_exp_f32 v16, v16
    v_exp_f32 v24, v24
    v_exp_f32 v33, v33
    v_exp_f32 v41, v41
    v_exp_f32 v17, v17
    v_exp_f32 v25, v25
    v_exp_f32 v34, v34
    v_exp_f32 v42, v42
    v_exp_f32 v18, v18
    v_exp_f32 v26, v26
    v_exp_f32 v35, v35
    v_exp_f32 v43, v43
    v_exp_f32 v19, v19
    v_exp_f32 v27, v27
    v_exp_f32 v36, v36
    v_exp_f32 v44, v44
    v_exp_f32 v20, v20
    v_exp_f32 v28, v28
    v_exp_f32 v37, v37
    v_exp_f32 v45, v45
    v_exp_f32 v21, v21
    v_exp_f32 v29, v29
    v_exp_f32 v38, v38
    v_exp_f32 v46, v46
    v_exp_f32 v22, v22
    v_exp_f32 v30, v30
    v_exp_f32 v39, v39
    v_exp_f32 v47, v47
    v_exp_f32 v23, v23
    v_exp_f32 v31, v31
    v_cvt_pk_bf16_f32 v56, v32, v33
    v_cvt_pk_bf16_f32 v60, v40, v41
    v_cvt_pk_bf16_f32 v64, v16, v17
    v_cvt_pk_bf16_f32 v68, v24, v25
    v_cvt_pk_bf16_f32 v57, v34, v35
    v_cvt_pk_bf16_f32 v61, v42, v43
    v_cvt_pk_bf16_f32 v65, v18, v19
    v_cvt_pk_bf16_f32 v69, v26, v27
    v_cvt_pk_bf16_f32 v58, v36, v37
    v_cvt_pk_bf16_f32 v62, v44, v45
    v_cvt_pk_bf16_f32 v66, v20, v21
    v_cvt_pk_bf16_f32 v70, v28, v29
    v_cvt_pk_bf16_f32 v59, v38, v39
    v_cvt_pk_bf16_f32 v63, v46, v47
    v_cvt_pk_bf16_f32 v67, v22, v23
    v_cvt_pk_bf16_f32 v71, v30, v31
    v_mfma_f32_16x16x32_bf16 v[188:191], v[12:15], v[56:59], 0
    v_mfma_f32_16x16x32_bf16 v[180:183], v[108:111], v[56:59], 0
    v_mfma_f32_16x16x32_bf16 v[184:187], v[120:123], v[56:59], 0
    v_mfma_f32_16x16x32_bf16 v[200:203], v[12:15], v[60:63], 0
    v_mfma_f32_16x16x32_bf16 v[192:195], v[114:117], v[60:63], 0
    v_mfma_f32_16x16x32_bf16 v[196:199], v[120:123], v[60:63], 0
    v_mfma_f32_16x16x32_bf16 v[212:215], v[12:15], v[64:67], 0
    s_waitcnt lgkmcnt(2)
    v_mfma_f32_16x16x32_bf16 v[204:207], v[106:109], v[64:67], 0
    s_waitcnt lgkmcnt(0)
    v_mfma_f32_16x16x32_bf16 v[208:211], v[118:121], v[64:67], 0
    v_mfma_f32_16x16x32_bf16 v[224:227], v[12:15], v[68:71], 0
    v_mfma_f32_16x16x32_bf16 v[216:219], v[112:115], v[68:71], 0
    v_mfma_f32_16x16x32_bf16 v[220:223], v[118:121], v[68:71], 0
    s_lshl_b32 s53, s46, 4
    s_add_u32 s53, s53, s45
    s_lshl_b32 s54, s53, 10
    s_add_u32 s54, s54, 73662464
    s_lshl_b32 s55, s53, 7
    s_add_u32 s55, s55, 75759488
    v_lshlrev_b32 v6, 3, v1
    v_rcp_f32 v188, v188
    v_rcp_f32 v200, v200
    v_rcp_f32 v212, v212
    v_rcp_f32 v224, v224
    v_mul_f32 v180, v180, v188
    v_mul_f32 v181, v181, v188
    v_mul_f32 v182, v182, v188
    v_mul_f32 v183, v183, v188
    v_mul_f32 v184, v184, v188
    v_mul_f32 v185, v185, v188
    v_cvt_pk_bf16_f32 v76, v180, v181
    v_cvt_pk_bf16_f32 v77, v182, v183
    v_cvt_pk_bf16_f32 v82, v184, v185
    v_mul_f32 v192, v192, v200
    v_mul_f32 v193, v193, v200
    v_mul_f32 v194, v194, v200
    v_mul_f32 v195, v195, v200
    v_mul_f32 v198, v198, v200
    v_mul_f32 v199, v199, v200
    v_cvt_pk_bf16_f32 v78, v192, v193
    v_cvt_pk_bf16_f32 v79, v194, v195
    v_cvt_pk_bf16_f32 v83, v198, v199
    s_add_u32 s53, s54, 16384
    buffer_store_dwordx4 v[76:79], v2, s[4:7], s53 offen sc1
    v_mul_f32 v204, v204, v212
    v_mul_f32 v205, v205, v212
    v_mul_f32 v206, v206, v212
    v_mul_f32 v207, v207, v212
    v_mul_f32 v208, v208, v212
    v_mul_f32 v209, v209, v212
    v_cvt_pk_bf16_f32 v72, v204, v205
    v_cvt_pk_bf16_f32 v73, v206, v207
    v_cvt_pk_bf16_f32 v80, v208, v209
    v_mul_f32 v216, v216, v224
    v_mul_f32 v217, v217, v224
    v_mul_f32 v218, v218, v224
    v_mul_f32 v219, v219, v224
    v_mul_f32 v222, v222, v224
    v_mul_f32 v223, v223, v224
    v_cvt_pk_bf16_f32 v74, v216, v217
    v_cvt_pk_bf16_f32 v75, v218, v219
    v_cvt_pk_bf16_f32 v81, v222, v223
    s_add_u32 s53, s54, 0
    buffer_store_dwordx4 v[72:75], v2, s[4:7], s53 offen sc1
    s_mov_b32 exec_lo, 0xffff0000
    s_mov_b32 exec_hi, 0
    buffer_store_dwordx2 v[80:81], v6, s[4:7], s55 offen offset:0 sc1
    buffer_store_dwordx2 v[82:83], v6, s[4:7], s55 offen offset:2048 sc1
    s_mov_b64 exec, -1
    s_lshl_b32 s52, s44, 2
    s_add_u32 s52, s52, s20
    s_lshl_b32 s52, s52, 4
    s_add_u32 s52, s52, s45
    s_lshl_b32 s52, s52, 3
    s_add_u32 s52, s52, 3956736
    v_mov_b32 v8, s98
    v_mov_b32 v9, s99
    s_waitcnt vmcnt(0)
    s_mov_b64 exec, 1
    buffer_store_dwordx2 v[8:9], off, s[4:7], s52 sc1
    s_mov_b64 exec, -1
    s_cmp_ge_u32 s22, 24
    s_cbranch_scc1 L_next_25
    s_mul_i32 s44, s22, 10923
    s_lshr_b32 s44, s44, 16
    s_mul_i32 s52, s44, 6
    s_sub_u32 s45, s22, s52
    s_lshl_b32 s52, s21, 2
    s_add_u32 s44, s44, s52
    s_lshl_b32 s46, s44, 2
    s_add_u32 s46, s46, s20
    s_mul_i32 s47, s45, 110592
    s_mul_i32 s48, s20, 3072
    s_add_u32 s47, s47, s48
    s_add_u32 s47, s47, 2097152
    s_lshl_b32 s49, s46, 14
    s_add_u32 s49, s49, 73662464
    s_lshl_b32 s50, s46, 11
    s_add_u32 s50, s50, 75759616
    v_and_b32 v3, 15, v1
    v_lshrrev_b32 v4, 4, v1
    v_lshlrev_b32 v5, 3, v3
    v_lshl_add_u32 v5, v4, 8, v5
    s_lshl_b32 s52, s46, 4
    v_add_u32 v6, s52, v3
    v_lshlrev_b32 v7, 3, v6
    v_mul_u32_u24 v6, 1152, v6
    v_lshl_add_u32 v6, v4, 4, v6
    s_mul_i32 s51, s45, 192
    s_add_u32 s8, s42, 28311552
    s_addc_u32 s9, s43, 0
    s_mov_b32 s10, 0x240000
    s_mov_b32 s11, 0x20000
    s_mov_b32 m0, s48
    s_nop 0
    buffer_load_dwordx4 v2, s[4:7], s47 offen offset:0 lds
    buffer_load_dwordx4 v2, s[4:7], s47 offen offset:1024 lds
    buffer_load_dwordx4 v2, s[4:7], s47 offen offset:2048 lds
    s_add_u32 s48, s48, 12288
    s_add_u32 s47, s47, 12288
    s_mov_b32 m0, s48
    s_nop 0
    buffer_load_dwordx4 v2, s[4:7], s47 offen offset:0 lds
    buffer_load_dwordx4 v2, s[4:7], s47 offen offset:1024 lds
    buffer_load_dwordx4 v2, s[4:7], s47 offen offset:2048 lds
    s_add_u32 s48, s48, 12288
    s_add_u32 s47, s47, 12288
    s_mov_b32 m0, s48
    s_nop 0
    buffer_load_dwordx4 v2, s[4:7], s47 offen offset:0 lds
    buffer_load_dwordx4 v2, s[4:7], s47 offen offset:1024 lds
    buffer_load_dwordx4 v2, s[4:7], s47 offen offset:2048 lds
    s_add_u32 s48, s48, 12288
    s_add_u32 s47, s47, 12288
    s_mov_b32 m0, s48
    s_nop 0
    buffer_load_dwordx4 v2, s[4:7], s47 offen offset:0 lds
    buffer_load_dwordx4 v2, s[4:7], s47 offen offset:1024 lds
    buffer_load_dwordx4 v2, s[4:7], s47 offen offset:2048 lds
    s_add_u32 s48, s48, 12288
    s_add_u32 s47, s47, 12288
    s_mov_b32 m0, s48
    s_nop 0
    buffer_load_dwordx4 v2, s[4:7], s47 offen offset:0 lds
    buffer_load_dwordx4 v2, s[4:7], s47 offen offset:1024 lds
    buffer_load_dwordx4 v2, s[4:7], s47 offen offset:2048 lds
    s_add_u32 s48, s48, 12288
    s_add_u32 s47, s47, 12288
    s_mov_b32 m0, s48
    s_nop 0
    buffer_load_dwordx4 v2, s[4:7], s47 offen offset:0 lds
    buffer_load_dwordx4 v2, s[4:7], s47 offen offset:1024 lds
    buffer_load_dwordx4 v2, s[4:7], s47 offen offset:2048 lds
    s_add_u32 s48, s48, 12288
    s_add_u32 s47, s47, 12288
    s_mov_b32 m0, s48
    s_nop 0
    buffer_load_dwordx4 v2, s[4:7], s47 offen offset:0 lds
    buffer_load_dwordx4 v2, s[4:7], s47 offen offset:1024 lds
    buffer_load_dwordx4 v2, s[4:7], s47 offen offset:2048 lds
    s_add_u32 s48, s48, 12288
    s_add_u32 s47, s47, 12288
    s_mov_b32 m0, s48
    s_nop 0
    buffer_load_dwordx4 v2, s[4:7], s47 offen offset:0 lds
    buffer_load_dwordx4 v2, s[4:7], s47 offen offset:1024 lds
    buffer_load_dwordx4 v2, s[4:7], s47 offen offset:2048 lds
    s_add_u32 s48, s48, 12288
    s_add_u32 s47, s47, 12288
    s_mov_b32 m0, s48
    s_nop 0
    buffer_load_dwordx4 v2, s[4:7], s47 offen offset:0 lds
    buffer_load_dwordx4 v2, s[4:7], s47 offen offset:1024 lds
    buffer_load_dwordx4 v2, s[4:7], s47 offen offset:2048 lds
    s_add_u32 s48, s48, 12288
    s_add_u32 s47, s47, 12288
    s_lshr_b32 s52, s46, 1
    s_lshl_b32 s52, s52, 7
    s_add_u32 s52, s52, 3956736
    v_and_b32 v10, 15, v1
    v_lshlrev_b32 v10, 3, v10
    buffer_load_dwordx2 v[8:9], v10, s[4:7], s52 offen sc1
    s_waitcnt vmcnt(0)
    v_cmp_eq_u64 vcc, s[98:99], v[8:9]
    s_nop 0
    s_cmp_eq_u64 vcc, exec
    s_cbranch_scc0 L_po_slow_85
L_po_back_86:
    buffer_load_dwordx4 v[16:19], v2, s[4:7], s49 offen offset:0 sc1
    buffer_load_dwordx4 v[20:23], v2, s[4:7], s49 offen offset:1024 sc1
    buffer_load_dwordx4 v[24:27], v2, s[4:7], s49 offen offset:2048 sc1
    buffer_load_dwordx4 v[28:31], v2, s[4:7], s49 offen offset:3072 sc1
    s_add_u32 s49, s49, 4096
    buffer_load_dwordx4 v[32:35], v2, s[4:7], s49 offen offset:0 sc1
    buffer_load_dwordx4 v[36:39], v2, s[4:7], s49 offen offset:1024 sc1
    buffer_load_dwordx4 v[40:43], v2, s[4:7], s49 offen offset:2048 sc1
    buffer_load_dwordx4 v[44:47], v2, s[4:7], s49 offen offset:3072 sc1
    s_add_u32 s49, s49, 4096
    buffer_load_dwordx4 v[48:51], v2, s[4:7], s49 offen offset:0 sc1
    buffer_load_dwordx4 v[52:55], v2, s[4:7], s49 offen offset:1024 sc1
    buffer_load_dwordx4 v[56:59], v2, s[4:7], s49 offen offset:2048 sc1
    buffer_load_dwordx4 v[60:63], v2, s[4:7], s49 offen offset:3072 sc1
    s_add_u32 s49, s49, 4096
    buffer_load_dwordx4 v[64:67], v2, s[4:7], s49 offen offset:0 sc1
    buffer_load_dwordx4 v[68:71], v2, s[4:7], s49 offen offset:1024 sc1
    buffer_load_dwordx4 v[72:75], v2, s[4:7], s49 offen offset:2048 sc1
    buffer_load_dwordx4 v[76:79], v2, s[4:7], s49 offen offset:3072 sc1
    buffer_load_dwordx2 v[80:81], v5, s[4:7], s50 offen offset:0 sc1
    buffer_load_dwordx2 v[82:83], v5, s[4:7], s50 offen offset:128 sc1
    buffer_load_dwordx2 v[84:85], v5, s[4:7], s50 offen offset:1024 sc1
    buffer_load_dwordx2 v[86:87], v5, s[4:7], s50 offen offset:1152 sc1
    buffer_load_dwordx4 v[160:163], v6, s[8:11], s51 offen offset:0 sc1
    buffer_load_dwordx4 v[164:167], v6, s[8:11], s51 offen offset:64 sc1
    buffer_load_dwordx4 v[168:171], v6, s[8:11], s51 offen offset:128 sc1
    v_mov_b32 v8, v2
    s_barrier
    ds_read_b128 v[112:115], v8 offset:0
    ds_read_b128 v[116:119], v8 offset:1024
    ds_read_b128 v[120:123], v8 offset:2048
    ds_read_b128 v[124:127], v8 offset:3072
    ds_read_b128 v[128:131], v8 offset:4096
    ds_read_b128 v[132:135], v8 offset:5120
    ds_read_b128 v[136:139], v8 offset:6144
    ds_read_b128 v[140:143], v8 offset:7168
    ds_read_b128 v[144:147], v8 offset:8192
    ds_read_b128 v[148:151], v8 offset:9216
    s_waitcnt vmcnt(22) lgkmcnt(9)
    v_mfma_f32_16x16x32_bf16 v[88:91], v[112:115], v[16:19], 0
    ds_read_b128 v[152:155], v8 offset:10240
    s_waitcnt lgkmcnt(9)
    v_mfma_f32_16x16x32_bf16 v[92:95], v[116:119], v[16:19], 0
    ds_read_b128 v[156:159], v8 offset:11264
    s_waitcnt lgkmcnt(9)
    v_mfma_f32_16x16x32_bf16 v[96:99], v[120:123], v[16:19], 0
    ds_read_b128 v[112:115], v8 offset:12288
    s_waitcnt lgkmcnt(9)
    v_mfma_f32_16x16x32_bf16 v[100:103], v[124:127], v[16:19], 0
    ds_read_b128 v[116:119], v8 offset:13312
    s_waitcnt lgkmcnt(9)
    v_mfma_f32_16x16x32_bf16 v[104:107], v[128:131], v[16:19], 0
    ds_read_b128 v[120:123], v8 offset:14336
    s_waitcnt lgkmcnt(9)
    v_mfma_f32_16x16x32_bf16 v[108:111], v[132:135], v[16:19], 0
    ds_read_b128 v[124:127], v8 offset:15360
    s_waitcnt vmcnt(21) lgkmcnt(9)
    v_mfma_f32_16x16x32_bf16 v[88:91], v[136:139], v[20:23], v[88:91]
    ds_read_b128 v[128:131], v8 offset:16384
    s_waitcnt lgkmcnt(9)
    v_mfma_f32_16x16x32_bf16 v[92:95], v[140:143], v[20:23], v[92:95]
    ds_read_b128 v[132:135], v8 offset:17408
    s_waitcnt lgkmcnt(9)
    v_mfma_f32_16x16x32_bf16 v[96:99], v[144:147], v[20:23], v[96:99]
    ds_read_b128 v[136:139], v8 offset:18432
    s_waitcnt lgkmcnt(9)
    v_mfma_f32_16x16x32_bf16 v[100:103], v[148:151], v[20:23], v[100:103]
    ds_read_b128 v[140:143], v8 offset:19456
    s_waitcnt lgkmcnt(9)
    v_mfma_f32_16x16x32_bf16 v[104:107], v[152:155], v[20:23], v[104:107]
    ds_read_b128 v[144:147], v8 offset:20480
    s_waitcnt lgkmcnt(9)
    v_mfma_f32_16x16x32_bf16 v[108:111], v[156:159], v[20:23], v[108:111]
    ds_read_b128 v[148:151], v8 offset:21504
    s_waitcnt vmcnt(20) lgkmcnt(9)
    v_mfma_f32_16x16x32_bf16 v[88:91], v[112:115], v[24:27], v[88:91]
    ds_read_b128 v[152:155], v8 offset:22528
    s_waitcnt lgkmcnt(9)
    v_mfma_f32_16x16x32_bf16 v[92:95], v[116:119], v[24:27], v[92:95]
    ds_read_b128 v[156:159], v8 offset:23552
    s_waitcnt lgkmcnt(9)
    v_mfma_f32_16x16x32_bf16 v[96:99], v[120:123], v[24:27], v[96:99]
    ds_read_b128 v[112:115], v8 offset:24576
    s_waitcnt lgkmcnt(9)
    v_mfma_f32_16x16x32_bf16 v[100:103], v[124:127], v[24:27], v[100:103]
    ds_read_b128 v[116:119], v8 offset:25600
    s_waitcnt lgkmcnt(9)
    v_mfma_f32_16x16x32_bf16 v[104:107], v[128:131], v[24:27], v[104:107]
    ds_read_b128 v[120:123], v8 offset:26624
    s_waitcnt lgkmcnt(9)
    v_mfma_f32_16x16x32_bf16 v[108:111], v[132:135], v[24:27], v[108:111]
    ds_read_b128 v[124:127], v8 offset:27648
    s_waitcnt vmcnt(19) lgkmcnt(9)
    v_mfma_f32_16x16x32_bf16 v[88:91], v[136:139], v[28:31], v[88:91]
    ds_read_b128 v[128:131], v8 offset:28672
    s_waitcnt lgkmcnt(9)
    v_mfma_f32_16x16x32_bf16 v[92:95], v[140:143], v[28:31], v[92:95]
    ds_read_b128 v[132:135], v8 offset:29696
    s_waitcnt lgkmcnt(9)
    v_mfma_f32_16x16x32_bf16 v[96:99], v[144:147], v[28:31], v[96:99]
    ds_read_b128 v[136:139], v8 offset:30720
    s_waitcnt lgkmcnt(9)
    v_mfma_f32_16x16x32_bf16 v[100:103], v[148:151], v[28:31], v[100:103]
    ds_read_b128 v[140:143], v8 offset:31744
    s_waitcnt lgkmcnt(9)
    v_mfma_f32_16x16x32_bf16 v[104:107], v[152:155], v[28:31], v[104:107]
    ds_read_b128 v[144:147], v8 offset:32768
    s_waitcnt lgkmcnt(9)
    v_mfma_f32_16x16x32_bf16 v[108:111], v[156:159], v[28:31], v[108:111]
    ds_read_b128 v[148:151], v8 offset:33792
    s_waitcnt vmcnt(18) lgkmcnt(9)
    v_mfma_f32_16x16x32_bf16 v[88:91], v[112:115], v[32:35], v[88:91]
    ds_read_b128 v[152:155], v8 offset:34816
    s_waitcnt lgkmcnt(9)
    v_mfma_f32_16x16x32_bf16 v[92:95], v[116:119], v[32:35], v[92:95]
    ds_read_b128 v[156:159], v8 offset:35840
    s_waitcnt lgkmcnt(9)
    v_mfma_f32_16x16x32_bf16 v[96:99], v[120:123], v[32:35], v[96:99]
    ds_read_b128 v[112:115], v8 offset:36864
    s_waitcnt lgkmcnt(9)
    v_mfma_f32_16x16x32_bf16 v[100:103], v[124:127], v[32:35], v[100:103]
    ds_read_b128 v[116:119], v8 offset:37888
    s_waitcnt lgkmcnt(9)
    v_mfma_f32_16x16x32_bf16 v[104:107], v[128:131], v[32:35], v[104:107]
    ds_read_b128 v[120:123], v8 offset:38912
    s_waitcnt lgkmcnt(9)
    v_mfma_f32_16x16x32_bf16 v[108:111], v[132:135], v[32:35], v[108:111]
    ds_read_b128 v[124:127], v8 offset:39936
    s_waitcnt vmcnt(17) lgkmcnt(9)
    v_mfma_f32_16x16x32_bf16 v[88:91], v[136:139], v[36:39], v[88:91]
    ds_read_b128 v[128:131], v8 offset:40960
    s_waitcnt lgkmcnt(9)
    v_mfma_f32_16x16x32_bf16 v[92:95], v[140:143], v[36:39], v[92:95]
    ds_read_b128 v[132:135], v8 offset:41984
    s_waitcnt lgkmcnt(9)
    v_mfma_f32_16x16x32_bf16 v[96:99], v[144:147], v[36:39], v[96:99]
    ds_read_b128 v[136:139], v8 offset:43008
    s_waitcnt lgkmcnt(9)
    v_mfma_f32_16x16x32_bf16 v[100:103], v[148:151], v[36:39], v[100:103]
    ds_read_b128 v[140:143], v8 offset:44032
    s_waitcnt lgkmcnt(9)
    v_mfma_f32_16x16x32_bf16 v[104:107], v[152:155], v[36:39], v[104:107]
    ds_read_b128 v[144:147], v8 offset:45056
    s_waitcnt lgkmcnt(9)
    v_mfma_f32_16x16x32_bf16 v[108:111], v[156:159], v[36:39], v[108:111]
    ds_read_b128 v[148:151], v8 offset:46080
    s_waitcnt vmcnt(16) lgkmcnt(9)
    v_mfma_f32_16x16x32_bf16 v[88:91], v[112:115], v[40:43], v[88:91]
    ds_read_b128 v[152:155], v8 offset:47104
    s_waitcnt lgkmcnt(9)
    v_mfma_f32_16x16x32_bf16 v[92:95], v[116:119], v[40:43], v[92:95]
    ds_read_b128 v[156:159], v8 offset:48128
    s_waitcnt lgkmcnt(9)
    v_mfma_f32_16x16x32_bf16 v[96:99], v[120:123], v[40:43], v[96:99]
    ds_read_b128 v[112:115], v8 offset:49152
    s_waitcnt lgkmcnt(9)
    v_mfma_f32_16x16x32_bf16 v[100:103], v[124:127], v[40:43], v[100:103]
    ds_read_b128 v[116:119], v8 offset:50176
    s_waitcnt lgkmcnt(9)
    v_mfma_f32_16x16x32_bf16 v[104:107], v[128:131], v[40:43], v[104:107]
    ds_read_b128 v[120:123], v8 offset:51200
    s_waitcnt lgkmcnt(9)
    v_mfma_f32_16x16x32_bf16 v[108:111], v[132:135], v[40:43], v[108:111]
    ds_read_b128 v[124:127], v8 offset:52224
    s_waitcnt vmcnt(15) lgkmcnt(9)
    v_mfma_f32_16x16x32_bf16 v[88:91], v[136:139], v[44:47], v[88:91]
    ds_read_b128 v[128:131], v8 offset:53248
    s_waitcnt lgkmcnt(9)
    v_mfma_f32_16x16x32_bf16 v[92:95], v[140:143], v[44:47], v[92:95]
    ds_read_b128 v[132:135], v8 offset:54272
    s_waitcnt lgkmcnt(9)
    v_mfma_f32_16x16x32_bf16 v[96:99], v[144:147], v[44:47], v[96:99]
    ds_read_b128 v[136:139], v8 offset:55296
    s_waitcnt lgkmcnt(9)
    v_mfma_f32_16x16x32_bf16 v[100:103], v[148:151], v[44:47], v[100:103]
    ds_read_b128 v[140:143], v8 offset:56320
    s_waitcnt lgkmcnt(9)
    v_mfma_f32_16x16x32_bf16 v[104:107], v[152:155], v[44:47], v[104:107]
    ds_read_b128 v[144:147], v8 offset:57344
    s_waitcnt lgkmcnt(9)
    v_mfma_f32_16x16x32_bf16 v[108:111], v[156:159], v[44:47], v[108:111]
    ds_read_b128 v[148:151], v8 offset:58368
    s_waitcnt vmcnt(14) lgkmcnt(9)
    v_mfma_f32_16x16x32_bf16 v[88:91], v[112:115], v[48:51], v[88:91]
    ds_read_b128 v[152:155], v8 offset:59392
    s_waitcnt lgkmcnt(9)
    v_mfma_f32_16x16x32_bf16 v[92:95], v[116:119], v[48:51], v[92:95]
    ds_read_b128 v[156:159], v8 offset:60416
    s_waitcnt lgkmcnt(9)
    v_mfma_f32_16x16x32_bf16 v[96:99], v[120:123], v[48:51], v[96:99]
    v_add_u32 v8, 61440, v8
    ds_read_b128 v[112:115], v8 offset:0
    s_waitcnt lgkmcnt(9)
    v_mfma_f32_16x16x32_bf16 v[100:103], v[124:127], v[48:51], v[100:103]
    ds_read_b128 v[116:119], v8 offset:1024
    s_waitcnt lgkmcnt(9)
    v_mfma_f32_16x16x32_bf16 v[104:107], v[128:131], v[48:51], v[104:107]
    ds_read_b128 v[120:123], v8 offset:2048
    s_waitcnt lgkmcnt(9)
    v_mfma_f32_16x16x32_bf16 v[108:111], v[132:135], v[48:51], v[108:111]
    ds_read_b128 v[124:127], v8 offset:3072
    s_waitcnt vmcnt(13) lgkmcnt(9)
    v_mfma_f32_16x16x32_bf16 v[88:91], v[136:139], v[52:55], v[88:91]
    ds_read_b128 v[128:131], v8 offset:4096
    s_waitcnt lgkmcnt(9)
    v_mfma_f32_16x16x32_bf16 v[92:95], v[140:143], v[52:55], v[92:95]
    ds_read_b128 v[132:135], v8 offset:5120
    s_waitcnt lgkmcnt(9)
    v_mfma_f32_16x16x32_bf16 v[96:99], v[144:147], v[52:55], v[96:99]
    ds_read_b128 v[136:139], v8 offset:6144
    s_waitcnt lgkmcnt(9)
    v_mfma_f32_16x16x32_bf16 v[100:103], v[148:151], v[52:55], v[100:103]
    ds_read_b128 v[140:143], v8 offset:7168
    s_waitcnt lgkmcnt(9)
    v_mfma_f32_16x16x32_bf16 v[104:107], v[152:155], v[52:55], v[104:107]
    ds_read_b128 v[144:147], v8 offset:8192
    s_waitcnt lgkmcnt(9)
    v_mfma_f32_16x16x32_bf16 v[108:111], v[156:159], v[52:55], v[108:111]
    ds_read_b128 v[148:151], v8 offset:9216
    s_waitcnt vmcnt(12) lgkmcnt(9)
    v_mfma_f32_16x16x32_bf16 v[88:91], v[112:115], v[56:59], v[88:91]
    ds_read_b128 v[152:155], v8 offset:10240
    s_waitcnt lgkmcnt(9)
    v_mfma_f32_16x16x32_bf16 v[92:95], v[116:119], v[56:59], v[92:95]
    ds_read_b128 v[156:159], v8 offset:11264
    s_waitcnt lgkmcnt(9)
    v_mfma_f32_16x16x32_bf16 v[96:99], v[120:123], v[56:59], v[96:99]
    ds_read_b128 v[112:115], v8 offset:12288
    s_waitcnt lgkmcnt(9)
    v_mfma_f32_16x16x32_bf16 v[100:103], v[124:127], v[56:59], v[100:103]
    ds_read_b128 v[116:119], v8 offset:13312
    s_waitcnt lgkmcnt(9)
    v_mfma_f32_16x16x32_bf16 v[104:107], v[128:131], v[56:59], v[104:107]
    ds_read_b128 v[120:123], v8 offset:14336
    s_waitcnt lgkmcnt(9)
    v_mfma_f32_16x16x32_bf16 v[108:111], v[132:135], v[56:59], v[108:111]
    ds_read_b128 v[124:127], v8 offset:15360
    s_waitcnt vmcnt(11) lgkmcnt(9)
    v_mfma_f32_16x16x32_bf16 v[88:91], v[136:139], v[60:63], v[88:91]
    ds_read_b128 v[128:131], v8 offset:16384
    s_waitcnt lgkmcnt(9)
    v_mfma_f32_16x16x32_bf16 v[92:95], v[140:143], v[60:63], v[92:95]
    ds_read_b128 v[132:135], v8 offset:17408
    s_waitcnt lgkmcnt(9)
    v_mfma_f32_16x16x32_bf16 v[96:99], v[144:147], v[60:63], v[96:99]
    ds_read_b128 v[136:139], v8 offset:18432
    s_waitcnt lgkmcnt(9)
    v_mfma_f32_16x16x32_bf16 v[100:103], v[148:151], v[60:63], v[100:103]
    ds_read_b128 v[140:143], v8 offset:19456
    s_waitcnt lgkmcnt(9)
    v_mfma_f32_16x16x32_bf16 v[104:107], v[152:155], v[60:63], v[104:107]
    ds_read_b128 v[144:147], v8 offset:20480
    s_waitcnt lgkmcnt(9)
    v_mfma_f32_16x16x32_bf16 v[108:111], v[156:159], v[60:63], v[108:111]
    ds_read_b128 v[148:151], v8 offset:21504
    s_waitcnt vmcnt(10) lgkmcnt(9)
    v_mfma_f32_16x16x32_bf16 v[88:91], v[112:115], v[64:67], v[88:91]
    ds_read_b128 v[152:155], v8 offset:22528
    s_waitcnt lgkmcnt(9)
    v_mfma_f32_16x16x32_bf16 v[92:95], v[116:119], v[64:67], v[92:95]
    ds_read_b128 v[156:159], v8 offset:23552
    s_waitcnt lgkmcnt(9)
    v_mfma_f32_16x16x32_bf16 v[96:99], v[120:123], v[64:67], v[96:99]
    ds_read_b128 v[112:115], v8 offset:24576
    s_waitcnt lgkmcnt(9)
    v_mfma_f32_16x16x32_bf16 v[100:103], v[124:127], v[64:67], v[100:103]
    ds_read_b128 v[116:119], v8 offset:25600
    s_waitcnt lgkmcnt(9)
    v_mfma_f32_16x16x32_bf16 v[104:107], v[128:131], v[64:67], v[104:107]
    ds_read_b128 v[120:123], v8 offset:26624
    s_waitcnt lgkmcnt(9)
    v_mfma_f32_16x16x32_bf16 v[108:111], v[132:135], v[64:67], v[108:111]
    ds_read_b128 v[124:127], v8 offset:27648
    s_waitcnt vmcnt(9) lgkmcnt(9)
    v_mfma_f32_16x16x32_bf16 v[88:91], v[136:139], v[68:71], v[88:91]
    ds_read_b128 v[128:131], v8 offset:28672
    s_waitcnt lgkmcnt(9)
    v_mfma_f32_16x16x32_bf16 v[92:95], v[140:143], v[68:71], v[92:95]
    ds_read_b128 v[132:135], v8 offset:29696
    s_waitcnt lgkmcnt(9)
    v_mfma_f32_16x16x32_bf16 v[96:99], v[144:147], v[68:71], v[96:99]
    ds_read_b128 v[136:139], v8 offset:30720
    s_waitcnt lgkmcnt(9)
    v_mfma_f32_16x16x32_bf16 v[100:103], v[148:151], v[68:71], v[100:103]
    ds_read_b128 v[140:143], v8 offset:31744
    s_waitcnt lgkmcnt(9)
    v_mfma_f32_16x16x32_bf16 v[104:107], v[152:155], v[68:71], v[104:107]
    ds_read_b128 v[144:147], v8 offset:32768
    s_waitcnt lgkmcnt(9)
    v_mfma_f32_16x16x32_bf16 v[108:111], v[156:159], v[68:71], v[108:111]
    ds_read_b128 v[148:151], v8 offset:33792
    s_waitcnt vmcnt(8) lgkmcnt(9)
    v_mfma_f32_16x16x32_bf16 v[88:91], v[112:115], v[72:75], v[88:91]
    ds_read_b128 v[152:155], v8 offset:34816
    s_waitcnt lgkmcnt(9)
    v_mfma_f32_16x16x32_bf16 v[92:95], v[116:119], v[72:75], v[92:95]
    ds_read_b128 v[156:159], v8 offset:35840
    s_waitcnt lgkmcnt(9)
    v_mfma_f32_16x16x32_bf16 v[96:99], v[120:123], v[72:75], v[96:99]
    ds_read_b128 v[112:115], v8 offset:36864
    s_waitcnt lgkmcnt(9)
    v_mfma_f32_16x16x32_bf16 v[100:103], v[124:127], v[72:75], v[100:103]
    ds_read_b128 v[116:119], v8 offset:37888
    s_waitcnt lgkmcnt(9)
    v_mfma_f32_16x16x32_bf16 v[104:107], v[128:131], v[72:75], v[104:107]
    ds_read_b128 v[120:123], v8 offset:38912
    s_waitcnt lgkmcnt(9)
    v_mfma_f32_16x16x32_bf16 v[108:111], v[132:135], v[72:75], v[108:111]
    ds_read_b128 v[124:127], v8 offset:39936
    s_waitcnt vmcnt(7) lgkmcnt(9)
    v_mfma_f32_16x16x32_bf16 v[88:91], v[136:139], v[76:79], v[88:91]
    ds_read_b128 v[128:131], v8 offset:40960
    s_waitcnt lgkmcnt(9)
    v_mfma_f32_16x16x32_bf16 v[92:95], v[140:143], v[76:79], v[92:95]
    ds_read_b128 v[132:135], v8 offset:41984
    s_waitcnt lgkmcnt(9)
    v_mfma_f32_16x16x32_bf16 v[96:99], v[144:147], v[76:79], v[96:99]
    ds_read_b128 v[136:139], v8 offset:43008
    s_waitcnt lgkmcnt(9)
    v_mfma_f32_16x16x32_bf16 v[100:103], v[148:151], v[76:79], v[100:103]
    ds_read_b128 v[140:143], v8 offset:44032
    s_waitcnt lgkmcnt(9)
    v_mfma_f32_16x16x32_bf16 v[104:107], v[152:155], v[76:79], v[104:107]
    ds_read_b128 v[144:147], v8 offset:45056
    s_waitcnt lgkmcnt(9)
    v_mfma_f32_16x16x32_bf16 v[108:111], v[156:159], v[76:79], v[108:111]
    ds_read_b128 v[148:151], v8 offset:46080
    s_waitcnt vmcnt(5) lgkmcnt(9)
    v_mfma_f32_16x16x32_bf16 v[88:91], v[112:115], v[80:83], v[88:91]
    ds_read_b128 v[152:155], v8 offset:47104
    s_waitcnt lgkmcnt(9)
    v_mfma_f32_16x16x32_bf16 v[92:95], v[116:119], v[80:83], v[92:95]
    ds_read_b128 v[156:159], v8 offset:48128
    s_waitcnt lgkmcnt(9)
    v_mfma_f32_16x16x32_bf16 v[96:99], v[120:123], v[80:83], v[96:99]
    s_waitcnt lgkmcnt(8)
    v_mfma_f32_16x16x32_bf16 v[100:103], v[124:127], v[80:83], v[100:103]
    s_waitcnt lgkmcnt(7)
    v_mfma_f32_16x16x32_bf16 v[104:107], v[128:131], v[80:83], v[104:107]
    s_waitcnt lgkmcnt(6)
    v_mfma_f32_16x16x32_bf16 v[108:111], v[132:135], v[80:83], v[108:111]
    s_waitcnt vmcnt(3) lgkmcnt(5)
    v_mfma_f32_16x16x32_bf16 v[88:91], v[136:139], v[84:87], v[88:91]
    s_waitcnt lgkmcnt(4)
    v_mfma_f32_16x16x32_bf16 v[92:95], v[140:143], v[84:87], v[92:95]
    s_waitcnt lgkmcnt(3)
    v_mfma_f32_16x16x32_bf16 v[96:99], v[144:147], v[84:87], v[96:99]
    s_waitcnt lgkmcnt(2)
    v_mfma_f32_16x16x32_bf16 v[100:103], v[148:151], v[84:87], v[100:103]
    s_waitcnt lgkmcnt(1)
    v_mfma_f32_16x16x32_bf16 v[104:107], v[152:155], v[84:87], v[104:107]
    s_waitcnt lgkmcnt(0)
    v_mfma_f32_16x16x32_bf16 v[108:111], v[156:159], v[84:87], v[108:111]
    s_waitcnt vmcnt(2)
    v_lshlrev_b32 v16, 16, v160
    v_and_b32 v17, 0xffff0000, v160
    v_lshlrev_b32 v18, 16, v161
    v_and_b32 v19, 0xffff0000, v161
    v_lshlrev_b32 v20, 16, v162
    v_and_b32 v21, 0xffff0000, v162
    v_lshlrev_b32 v22, 16, v163
    v_and_b32 v23, 0xffff0000, v163
    s_waitcnt vmcnt(1)
    v_lshlrev_b32 v24, 16, v164
    v_and_b32 v25, 0xffff0000, v164
    v_lshlrev_b32 v26, 16, v165
    v_and_b32 v27, 0xffff0000, v165
    v_lshlrev_b32 v28, 16, v166
    v_and_b32 v29, 0xffff0000, v166
    v_lshlrev_b32 v30, 16, v167
    v_and_b32 v31, 0xffff0000, v167
    s_waitcnt vmcnt(0)
    v_lshlrev_b32 v32, 16, v168
    v_and_b32 v33, 0xffff0000, v168
    v_lshlrev_b32 v34, 16, v169
    v_and_b32 v35, 0xffff0000, v169
    v_lshlrev_b32 v36, 16, v170
    v_and_b32 v37, 0xffff0000, v170
    v_lshlrev_b32 v38, 16, v171
    v_and_b32 v39, 0xffff0000, v171
    v_add_f32 v16, v16, v88
    v_add_f32 v17, v17, v89
    v_add_f32 v18, v18, v90
    v_add_f32 v19, v19, v91
    v_add_f32 v20, v20, v92
    v_add_f32 v21, v21, v93
    v_add_f32 v22, v22, v94
    v_add_f32 v23, v23, v95
    v_add_f32 v24, v24, v96
    v_add_f32 v25, v25, v97
    v_add_f32 v26, v26, v98
    v_add_f32 v27, v27, v99
    v_add_f32 v28, v28, v100
    v_add_f32 v29, v29, v101
    v_add_f32 v30, v30, v102
    v_add_f32 v31, v31, v103
    v_add_f32 v32, v32, v104
    v_add_f32 v33, v33, v105
    v_add_f32 v34, v34, v106
    v_add_f32 v35, v35, v107
    v_add_f32 v36, v36, v108
    v_add_f32 v37, v37, v109
    v_add_f32 v38, v38, v110
    v_add_f32 v39, v39, v111
    s_mul_i32 s52, s46, 18
    s_mul_i32 s53, s45, 3
    s_add_u32 s52, s52, s53
    s_lshl_b32 s52, s52, 10
    s_add_u32 s52, s52, 76021760
    v_cvt_pk_bf16_f32 v40, v16, v17
    v_cvt_pk_bf16_f32 v41, v18, v19
    v_cvt_pk_bf16_f32 v42, v20, v21
    v_cvt_pk_bf16_f32 v43, v22, v23
    buffer_store_dwordx4 v[40:43], v2, s[4:7], s52 offen offset:0 sc1
    v_cvt_pk_bf16_f32 v44, v24, v25
    v_cvt_pk_bf16_f32 v45, v26, v27
    v_cvt_pk_bf16_f32 v46, v28, v29
    v_cvt_pk_bf16_f32 v47, v30, v31
    buffer_store_dwordx4 v[44:47], v2, s[4:7], s52 offen offset:1024 sc1
    v_cvt_pk_bf16_f32 v48, v32, v33
    v_cvt_pk_bf16_f32 v49, v34, v35
    v_cvt_pk_bf16_f32 v50, v36, v37
    v_cvt_pk_bf16_f32 v51, v38, v39
    buffer_store_dwordx4 v[48:51], v2, s[4:7], s52 offen offset:2048 sc1
    v_lshlrev_b32 v16, 16, v40
    v_and_b32 v17, 0xffff0000, v40
    v_lshlrev_b32 v18, 16, v41
    v_and_b32 v19, 0xffff0000, v41
    v_lshlrev_b32 v20, 16, v42
    v_and_b32 v21, 0xffff0000, v42
    v_lshlrev_b32 v22, 16, v43
    v_and_b32 v23, 0xffff0000, v43
    v_lshlrev_b32 v24, 16, v44
    v_and_b32 v25, 0xffff0000, v44
    v_lshlrev_b32 v26, 16, v45
    v_and_b32 v27, 0xffff0000, v45
    v_lshlrev_b32 v28, 16, v46
    v_and_b32 v29, 0xffff0000, v46
    v_lshlrev_b32 v30, 16, v47
    v_and_b32 v31, 0xffff0000, v47
    v_lshlrev_b32 v32, 16, v48
    v_and_b32 v33, 0xffff0000, v48
    v_lshlrev_b32 v34, 16, v49
    v_and_b32 v35, 0xffff0000, v49
    v_lshlrev_b32 v36, 16, v50
    v_and_b32 v37, 0xffff0000, v50
    v_lshlrev_b32 v38, 16, v51
    v_and_b32 v39, 0xffff0000, v51
    v_add_f32 v56, v16, v17
    v_add_f32 v58, v18, v19
    v_add_f32 v56, v56, v20
    v_add_f32 v58, v58, v21
    v_add_f32 v56, v56, v22
    v_add_f32 v58, v58, v23
    v_add_f32 v56, v56, v24
    v_add_f32 v58, v58, v25
    v_add_f32 v56, v56, v26
    v_add_f32 v58, v58, v27
    v_add_f32 v56, v56, v28
    v_add_f32 v58, v58, v29
    v_add_f32 v56, v56, v30
    v_add_f32 v58, v58, v31
    v_add_f32 v56, v56, v32
    v_add_f32 v58, v58, v33
    v_add_f32 v56, v56, v34
    v_add_f32 v58, v58, v35
    v_add_f32 v56, v56, v36
    v_add_f32 v58, v58, v37
    v_add_f32 v56, v56, v38
    v_add_f32 v58, v58, v39
    v_add_f32 v56, v56, v58
    v_mov_b32 v58, v56
    s_nop 1
    v_permlane16_swap_b32 v56, v58
    v_add_f32 v56, v56, v58
    v_mov_b32 v58, v56
    s_nop 1
    v_permlane32_swap_b32 v56, v58
    v_add_f32 v56, v56, v58
    v_mul_f32 v59, 0x3c2aaaab, v56
    v_sub_f32 v58, v16, v59
    v_mul_f32 v57, v58, v58
    v_sub_f32 v61, v17, v59
    v_fmac_f32 v57, v61, v61
    v_sub_f32 v60, v18, v59
    v_fmac_f32 v57, v60, v60
    v_sub_f32 v61, v19, v59
    v_fmac_f32 v57, v61, v61
    v_sub_f32 v60, v20, v59
    v_fmac_f32 v57, v60, v60
    v_sub_f32 v61, v21, v59
    v_fmac_f32 v57, v61, v61
    v_sub_f32 v60, v22, v59
    v_fmac_f32 v57, v60, v60
    v_sub_f32 v61, v23, v59
    v_fmac_f32 v57, v61, v61
    v_sub_f32 v60, v24, v59
    v_fmac_f32 v57, v60, v60
    v_sub_f32 v61, v25, v59
    v_fmac_f32 v57, v61, v61
    v_sub_f32 v60, v26, v59
    v_fmac_f32 v57, v60, v60
    v_sub_f32 v61, v27, v59
    v_fmac_f32 v57, v61, v61
    v_sub_f32 v60, v28, v59
    v_fmac_f32 v57, v60, v60
    v_sub_f32 v61, v29, v59
    v_fmac_f32 v57, v61, v61
    v_sub_f32 v60, v30, v59
    v_fmac_f32 v57, v60, v60
    v_sub_f32 v61, v31, v59
    v_fmac_f32 v57, v61, v61
    v_sub_f32 v60, v32, v59
    v_fmac_f32 v57, v60, v60
    v_sub_f32 v61, v33, v59
    v_fmac_f32 v57, v61, v61
    v_sub_f32 v60, v34, v59
    v_fmac_f32 v57, v60, v60
    v_sub_f32 v61, v35, v59
    v_fmac_f32 v57, v61, v61
    v_sub_f32 v60, v36, v59
    v_fmac_f32 v57, v60, v60
    v_sub_f32 v61, v37, v59
    v_fmac_f32 v57, v61, v61
    v_sub_f32 v60, v38, v59
    v_fmac_f32 v57, v60, v60
    v_sub_f32 v61, v39, v59
    v_fmac_f32 v57, v61, v61
    v_mov_b32 v58, v57
    s_nop 1
    v_permlane16_swap_b32 v57, v58
    v_add_f32 v57, v57, v58
    v_mov_b32 v58, v57
    s_nop 1
    v_permlane32_swap_b32 v57, v58
    v_add_f32 v57, v57, v58
    s_lshl_b32 s52, s45, 14
    s_add_u32 s52, s52, 78381056
    s_mov_b32 exec_lo, 0xffff
    s_mov_b32 exec_hi, 0
    buffer_store_dwordx2 v[56:57], v7, s[4:7], s52 offen sc1
    s_mov_b64 exec, -1
    s_lshl_b32 s52, s46, 3
    s_add_u32 s52, s52, s45
    s_lshl_b32 s52, s52, 3
    s_add_u32 s52, s52, 3973120
    v_mov_b32 v8, s98
    v_mov_b32 v9, s99
    s_waitcnt vmcnt(0)
    s_mov_b64 exec, 1
    buffer_store_dwordx2 v[8:9], off, s[4:7], s52 sc1
    s_mov_b64 exec, -1
L_next_25:
    s_mov_b32 s100, 71303168
    s_mov_b32 s101, 0x2000
    s_branch L_ffn_23
L_red1_24:
    s_lshl_b32 s47, s21, 5
    s_add_u32 s47, s47, s22
    v_and_b32 v8, 7, v1
    v_lshrrev_b32 v9, 3, v1
    s_lshl_b32 s48, s47, 3
    v_add_u32 v3, s48, v8
    v_mul_u32_u24 v3, 1152, v3
    s_mul_i32 s48, s20, 384
    v_lshl_add_u32 v3, v9, 4, v3
    v_add_u32 v3, s48, v3
    s_lshr_b32 s48, s47, 1
    s_mul_i32 s48, s48, 18432
    s_and_b32 s49, s47, 1
    s_lshl_b32 s49, s49, 7
    s_add_u32 s48, s48, s49
    s_mul_i32 s49, s20, 6144
    s_add_u32 s48, s48, s49
    v_lshlrev_b32 v8, 4, v8
    v_lshl_add_u32 v8, v9, 8, v8
    v_add_u32 v4, s48, v8
    v_lshrrev_b32 v8, 3, v1
    v_and_b32 v9, 7, v1
    s_and_b32 s48, s47, 1
    s_lshl_b32 s48, s48, 3
    v_add_u32 v9, s48, v9
    v_lshlrev_b32 v9, 4, v9
    v_bfe_u32 v10, v8, 1, 1
    v_and_b32 v11, 1, v8
    v_lshl_add_u32 v9, v11, 4, v9
    v_lshl_add_u32 v9, v10, 9, v9
    v_and_b32 v10, 3, v8
    v_lshlrev_b32 v10, 8, v10
    v_sub_u32 v9, v9, v10
    s_mul_i32 s48, s20, 6
    v_lshrrev_b32 v8, 2, v8
    v_add_u32 v8, s48, v8
    v_add_u32 v10, 0, v8
    v_cmp_eq_u32 vcc, 4, v10
    v_cmp_eq_u32 s[56:57], 13, v10
    s_nop 0
    s_or_b64 vcc, vcc, s[56:57]
    v_cndmask_b32 v10, 0, v9, vcc
    v_add3_u32 v5, v4, v10, 0
    v_add_u32 v5, 0, v5
    v_add_u32 v10, 2, v8
    v_cmp_eq_u32 vcc, 4, v10
    v_cmp_eq_u32 s[56:57], 13, v10
    s_nop 0
    s_or_b64 vcc, vcc, s[56:57]
    v_cndmask_b32 v10, 0, v9, vcc
    v_add3_u32 v6, v4, v10, 0
    v_add_u32 v6, 2048, v6
    v_add_u32 v10, 4, v8
    v_cmp_eq_u32 vcc, 4, v10
    v_cmp_eq_u32 s[56:57], 13, v10
    s_nop 0
    s_or_b64 vcc, vcc, s[56:57]
    v_cndmask_b32 v10, 0, v9, vcc
    v_add3_u32 v7, v4, v10, 0
    v_add_u32 v7, 4096, v7
    s_cmp_eq_u32 s20, 3
    s_cbranch_scc1 L_w3a_88
    s_lshr_b32 s49, s47, 3
    s_lshl_b32 s49, s49, 8
    s_add_u32 s49, s49, 4055040
    v_and_b32 v10, 31, v1
    v_lshlrev_b32 v10, 3, v10
    buffer_load_dwordx2 v[8:9], v10, s[4:7], s49 offen sc1
    s_waitcnt vmcnt(0)
    v_cmp_eq_u64 vcc, s[98:99], v[8:9]
    s_nop 0
    s_cmp_eq_u64 vcc, exec
    s_cbranch_scc0 L_pp_slow_89
L_pp_back_90:
    s_mov_b32 s48, 76021760
    buffer_load_dwordx4 v[16:19], v4, s[4:7], s48 offen offset:0 sc1
    buffer_load_dwordx4 v[52:55], v4, s[4:7], s48 offen offset:2048 sc1
    s_add_u32 s48, s48, 4096
    buffer_load_dwordx4 v[88:91], v4, s[4:7], s48 offen offset:0 sc1
    s_mov_b32 s48, 100663296
    buffer_load_dwordx4 v[20:23], v5, s[4:7], s48 offen sc1
    buffer_load_dwordx4 v[56:59], v6, s[4:7], s48 offen sc1
    buffer_load_dwordx4 v[92:95], v7, s[4:7], s48 offen sc1
    s_mov_b32 s48, 103022592
    buffer_load_dwordx4 v[24:27], v5, s[4:7], s48 offen sc1
    buffer_load_dwordx4 v[60:63], v6, s[4:7], s48 offen sc1
    buffer_load_dwordx4 v[96:99], v7, s[4:7], s48 offen sc1
    s_mov_b32 s48, 105381888
    buffer_load_dwordx4 v[28:31], v5, s[4:7], s48 offen sc1
    buffer_load_dwordx4 v[64:67], v6, s[4:7], s48 offen sc1
    buffer_load_dwordx4 v[100:103], v7, s[4:7], s48 offen sc1
    s_mov_b32 s48, 107741184
    buffer_load_dwordx4 v[32:35], v5, s[4:7], s48 offen sc1
    buffer_load_dwordx4 v[68:71], v6, s[4:7], s48 offen sc1
    buffer_load_dwordx4 v[104:107], v7, s[4:7], s48 offen sc1
    s_mov_b32 s48, 110100480
    buffer_load_dwordx4 v[36:39], v5, s[4:7], s48 offen sc1
    buffer_load_dwordx4 v[72:75], v6, s[4:7], s48 offen sc1
    buffer_load_dwordx4 v[108:111], v7, s[4:7], s48 offen sc1
    s_mov_b32 s48, 112459776
    buffer_load_dwordx4 v[40:43], v5, s[4:7], s48 offen sc1
    buffer_load_dwordx4 v[76:79], v6, s[4:7], s48 offen sc1
    buffer_load_dwordx4 v[112:115], v7, s[4:7], s48 offen sc1
    s_mov_b32 s48, 114819072
    buffer_load_dwordx4 v[44:47], v5, s[4:7], s48 offen sc1
    buffer_load_dwordx4 v[80:83], v6, s[4:7], s48 offen sc1
    buffer_load_dwordx4 v[116:119], v7, s[4:7], s48 offen sc1
    s_mov_b32 s48, 117178368
    buffer_load_dwordx4 v[48:51], v5, s[4:7], s48 offen sc1
    buffer_load_dwordx4 v[84:87], v6, s[4:7], s48 offen sc1
    buffer_load_dwordx4 v[120:123], v7, s[4:7], s48 offen sc1
    s_waitcnt vmcnt(26)
    v_lshlrev_b32 v128, 16, v16
    v_and_b32 v129, 0xffff0000, v16
    v_lshlrev_b32 v130, 16, v17
    v_and_b32 v131, 0xffff0000, v17
    v_lshlrev_b32 v132, 16, v18
    v_and_b32 v133, 0xffff0000, v18
    v_lshlrev_b32 v134, 16, v19
    v_and_b32 v135, 0xffff0000, v19
    s_waitcnt vmcnt(25)
    v_lshlrev_b32 v136, 16, v52
    v_and_b32 v137, 0xffff0000, v52
    v_lshlrev_b32 v138, 16, v53
    v_and_b32 v139, 0xffff0000, v53
    v_lshlrev_b32 v140, 16, v54
    v_and_b32 v141, 0xffff0000, v54
    v_lshlrev_b32 v142, 16, v55
    v_and_b32 v143, 0xffff0000, v55
    s_waitcnt vmcnt(24)
    v_lshlrev_b32 v144, 16, v88
    v_and_b32 v145, 0xffff0000, v88
    v_lshlrev_b32 v146, 16, v89
    v_and_b32 v147, 0xffff0000, v89
    v_lshlrev_b32 v148, 16, v90
    v_and_b32 v149, 0xffff0000, v90
    v_lshlrev_b32 v150, 16, v91
    v_and_b32 v151, 0xffff0000, v91
    s_waitcnt vmcnt(23)
    v_lshlrev_b32 v8, 16, v20
    v_and_b32 v9, 0xffff0000, v20
    v_add_f32 v128, v128, v8
    v_add_f32 v129, v129, v9
    v_lshlrev_b32 v10, 16, v21
    v_and_b32 v11, 0xffff0000, v21
    v_add_f32 v130, v130, v10
    v_add_f32 v131, v131, v11
    v_lshlrev_b32 v8, 16, v22
    v_and_b32 v9, 0xffff0000, v22
    v_add_f32 v132, v132, v8
    v_add_f32 v133, v133, v9
    v_lshlrev_b32 v10, 16, v23
    v_and_b32 v11, 0xffff0000, v23
    v_add_f32 v134, v134, v10
    v_add_f32 v135, v135, v11
    s_waitcnt vmcnt(22)
    v_lshlrev_b32 v8, 16, v56
    v_and_b32 v9, 0xffff0000, v56
    v_add_f32 v136, v136, v8
    v_add_f32 v137, v137, v9
    v_lshlrev_b32 v10, 16, v57
    v_and_b32 v11, 0xffff0000, v57
    v_add_f32 v138, v138, v10
    v_add_f32 v139, v139, v11
    v_lshlrev_b32 v8, 16, v58
    v_and_b32 v9, 0xffff0000, v58
    v_add_f32 v140, v140, v8
    v_add_f32 v141, v141, v9
    v_lshlrev_b32 v10, 16, v59
    v_and_b32 v11, 0xffff0000, v59
    v_add_f32 v142, v142, v10
    v_add_f32 v143, v143, v11
    s_waitcnt vmcnt(21)
    v_lshlrev_b32 v8, 16, v92
    v_and_b32 v9, 0xffff0000, v92
    v_add_f32 v144, v144, v8
    v_add_f32 v145, v145, v9
    v_lshlrev_b32 v10, 16, v93
    v_and_b32 v11, 0xffff0000, v93
    v_add_f32 v146, v146, v10
    v_add_f32 v147, v147, v11
    v_lshlrev_b32 v8, 16, v94
    v_and_b32 v9, 0xffff0000, v94
    v_add_f32 v148, v148, v8
    v_add_f32 v149, v149, v9
    v_lshlrev_b32 v10, 16, v95
    v_and_b32 v11, 0xffff0000, v95
    v_add_f32 v150, v150, v10
    v_add_f32 v151, v151, v11
    s_waitcnt vmcnt(20)
    v_lshlrev_b32 v8, 16, v24
    v_and_b32 v9, 0xffff0000, v24
    v_add_f32 v128, v128, v8
    v_add_f32 v129, v129, v9
    v_lshlrev_b32 v10, 16, v25
    v_and_b32 v11, 0xffff0000, v25
    v_add_f32 v130, v130, v10
    v_add_f32 v131, v131, v11
    v_lshlrev_b32 v8, 16, v26
    v_and_b32 v9, 0xffff0000, v26
    v_add_f32 v132, v132, v8
    v_add_f32 v133, v133, v9
    v_lshlrev_b32 v10, 16, v27
    v_and_b32 v11, 0xffff0000, v27
    v_add_f32 v134, v134, v10
    v_add_f32 v135, v135, v11
    s_waitcnt vmcnt(19)
    v_lshlrev_b32 v8, 16, v60
    v_and_b32 v9, 0xffff0000, v60
    v_add_f32 v136, v136, v8
    v_add_f32 v137, v137, v9
    v_lshlrev_b32 v10, 16, v61
    v_and_b32 v11, 0xffff0000, v61
    v_add_f32 v138, v138, v10
    v_add_f32 v139, v139, v11
    v_lshlrev_b32 v8, 16, v62
    v_and_b32 v9, 0xffff0000, v62
    v_add_f32 v140, v140, v8
    v_add_f32 v141, v141, v9
    v_lshlrev_b32 v10, 16, v63
    v_and_b32 v11, 0xffff0000, v63
    v_add_f32 v142, v142, v10
    v_add_f32 v143, v143, v11
    s_waitcnt vmcnt(18)
    v_lshlrev_b32 v8, 16, v96
    v_and_b32 v9, 0xffff0000, v96
    v_add_f32 v144, v144, v8
    v_add_f32 v145, v145, v9
    v_lshlrev_b32 v10, 16, v97
    v_and_b32 v11, 0xffff0000, v97
    v_add_f32 v146, v146, v10
    v_add_f32 v147, v147, v11
    v_lshlrev_b32 v8, 16, v98
    v_and_b32 v9, 0xffff0000, v98
    v_add_f32 v148, v148, v8
    v_add_f32 v149, v149, v9
    v_lshlrev_b32 v10, 16, v99
    v_and_b32 v11, 0xffff0000, v99
    v_add_f32 v150, v150, v10
    v_add_f32 v151, v151, v11
    s_waitcnt vmcnt(17)
    v_lshlrev_b32 v8, 16, v28
    v_and_b32 v9, 0xffff0000, v28
    v_add_f32 v128, v128, v8
    v_add_f32 v129, v129, v9
    v_lshlrev_b32 v10, 16, v29
    v_and_b32 v11, 0xffff0000, v29
    v_add_f32 v130, v130, v10
    v_add_f32 v131, v131, v11
    v_lshlrev_b32 v8, 16, v30
    v_and_b32 v9, 0xffff0000, v30
    v_add_f32 v132, v132, v8
    v_add_f32 v133, v133, v9
    v_lshlrev_b32 v10, 16, v31
    v_and_b32 v11, 0xffff0000, v31
    v_add_f32 v134, v134, v10
    v_add_f32 v135, v135, v11
    s_waitcnt vmcnt(16)
    v_lshlrev_b32 v8, 16, v64
    v_and_b32 v9, 0xffff0000, v64
    v_add_f32 v136, v136, v8
    v_add_f32 v137, v137, v9
    v_lshlrev_b32 v10, 16, v65
    v_and_b32 v11, 0xffff0000, v65
    v_add_f32 v138, v138, v10
    v_add_f32 v139, v139, v11
    v_lshlrev_b32 v8, 16, v66
    v_and_b32 v9, 0xffff0000, v66
    v_add_f32 v140, v140, v8
    v_add_f32 v141, v141, v9
    v_lshlrev_b32 v10, 16, v67
    v_and_b32 v11, 0xffff0000, v67
    v_add_f32 v142, v142, v10
    v_add_f32 v143, v143, v11
    s_waitcnt vmcnt(15)
    v_lshlrev_b32 v8, 16, v100
    v_and_b32 v9, 0xffff0000, v100
    v_add_f32 v144, v144, v8
    v_add_f32 v145, v145, v9
    v_lshlrev_b32 v10, 16, v101
    v_and_b32 v11, 0xffff0000, v101
    v_add_f32 v146, v146, v10
    v_add_f32 v147, v147, v11
    v_lshlrev_b32 v8, 16, v102
    v_and_b32 v9, 0xffff0000, v102
    v_add_f32 v148, v148, v8
    v_add_f32 v149, v149, v9
    v_lshlrev_b32 v10, 16, v103
    v_and_b32 v11, 0xffff0000, v103
    v_add_f32 v150, v150, v10
    v_add_f32 v151, v151, v11
    s_waitcnt vmcnt(14)
    v_lshlrev_b32 v8, 16, v32
    v_and_b32 v9, 0xffff0000, v32
    v_add_f32 v128, v128, v8
    v_add_f32 v129, v129, v9
    v_lshlrev_b32 v10, 16, v33
    v_and_b32 v11, 0xffff0000, v33
    v_add_f32 v130, v130, v10
    v_add_f32 v131, v131, v11
    v_lshlrev_b32 v8, 16, v34
    v_and_b32 v9, 0xffff0000, v34
    v_add_f32 v132, v132, v8
    v_add_f32 v133, v133, v9
    v_lshlrev_b32 v10, 16, v35
    v_and_b32 v11, 0xffff0000, v35
    v_add_f32 v134, v134, v10
    v_add_f32 v135, v135, v11
    s_waitcnt vmcnt(13)
    v_lshlrev_b32 v8, 16, v68
    v_and_b32 v9, 0xffff0000, v68
    v_add_f32 v136, v136, v8
    v_add_f32 v137, v137, v9
    v_lshlrev_b32 v10, 16, v69
    v_and_b32 v11, 0xffff0000, v69
    v_add_f32 v138, v138, v10
    v_add_f32 v139, v139, v11
    v_lshlrev_b32 v8, 16, v70
    v_and_b32 v9, 0xffff0000, v70
    v_add_f32 v140, v140, v8
    v_add_f32 v141, v141, v9
    v_lshlrev_b32 v10, 16, v71
    v_and_b32 v11, 0xffff0000, v71
    v_add_f32 v142, v142, v10
    v_add_f32 v143, v143, v11
    s_waitcnt vmcnt(12)
    v_lshlrev_b32 v8, 16, v104
    v_and_b32 v9, 0xffff0000, v104
    v_add_f32 v144, v144, v8
    v_add_f32 v145, v145, v9
    v_lshlrev_b32 v10, 16, v105
    v_and_b32 v11, 0xffff0000, v105
    v_add_f32 v146, v146, v10
    v_add_f32 v147, v147, v11
    v_lshlrev_b32 v8, 16, v106
    v_and_b32 v9, 0xffff0000, v106
    v_add_f32 v148, v148, v8
    v_add_f32 v149, v149, v9
    v_lshlrev_b32 v10, 16, v107
    v_and_b32 v11, 0xffff0000, v107
    v_add_f32 v150, v150, v10
    v_add_f32 v151, v151, v11
    s_waitcnt vmcnt(11)
    v_lshlrev_b32 v8, 16, v36
    v_and_b32 v9, 0xffff0000, v36
    v_add_f32 v128, v128, v8
    v_add_f32 v129, v129, v9
    v_lshlrev_b32 v10, 16, v37
    v_and_b32 v11, 0xffff0000, v37
    v_add_f32 v130, v130, v10
    v_add_f32 v131, v131, v11
    v_lshlrev_b32 v8, 16, v38
    v_and_b32 v9, 0xffff0000, v38
    v_add_f32 v132, v132, v8
    v_add_f32 v133, v133, v9
    v_lshlrev_b32 v10, 16, v39
    v_and_b32 v11, 0xffff0000, v39
    v_add_f32 v134, v134, v10
    v_add_f32 v135, v135, v11
    s_waitcnt vmcnt(10)
    v_lshlrev_b32 v8, 16, v72
    v_and_b32 v9, 0xffff0000, v72
    v_add_f32 v136, v136, v8
    v_add_f32 v137, v137, v9
    v_lshlrev_b32 v10, 16, v73
    v_and_b32 v11, 0xffff0000, v73
    v_add_f32 v138, v138, v10
    v_add_f32 v139, v139, v11
    v_lshlrev_b32 v8, 16, v74
    v_and_b32 v9, 0xffff0000, v74
    v_add_f32 v140, v140, v8
    v_add_f32 v141, v141, v9
    v_lshlrev_b32 v10, 16, v75
    v_and_b32 v11, 0xffff0000, v75
    v_add_f32 v142, v142, v10
    v_add_f32 v143, v143, v11
    s_waitcnt vmcnt(9)
    v_lshlrev_b32 v8, 16, v108
    v_and_b32 v9, 0xffff0000, v108
    v_add_f32 v144, v144, v8
    v_add_f32 v145, v145, v9
    v_lshlrev_b32 v10, 16, v109
    v_and_b32 v11, 0xffff0000, v109
    v_add_f32 v146, v146, v10
    v_add_f32 v147, v147, v11
    v_lshlrev_b32 v8, 16, v110
    v_and_b32 v9, 0xffff0000, v110
    v_add_f32 v148, v148, v8
    v_add_f32 v149, v149, v9
    v_lshlrev_b32 v10, 16, v111
    v_and_b32 v11, 0xffff0000, v111
    v_add_f32 v150, v150, v10
    v_add_f32 v151, v151, v11
    s_waitcnt vmcnt(8)
    v_lshlrev_b32 v8, 16, v40
    v_and_b32 v9, 0xffff0000, v40
    v_add_f32 v128, v128, v8
    v_add_f32 v129, v129, v9
    v_lshlrev_b32 v10, 16, v41
    v_and_b32 v11, 0xffff0000, v41
    v_add_f32 v130, v130, v10
    v_add_f32 v131, v131, v11
    v_lshlrev_b32 v8, 16, v42
    v_and_b32 v9, 0xffff0000, v42
    v_add_f32 v132, v132, v8
    v_add_f32 v133, v133, v9
    v_lshlrev_b32 v10, 16, v43
    v_and_b32 v11, 0xffff0000, v43
    v_add_f32 v134, v134, v10
    v_add_f32 v135, v135, v11
    s_waitcnt vmcnt(7)
    v_lshlrev_b32 v8, 16, v76
    v_and_b32 v9, 0xffff0000, v76
    v_add_f32 v136, v136, v8
    v_add_f32 v137, v137, v9
    v_lshlrev_b32 v10, 16, v77
    v_and_b32 v11, 0xffff0000, v77
    v_add_f32 v138, v138, v10
    v_add_f32 v139, v139, v11
    v_lshlrev_b32 v8, 16, v78
    v_and_b32 v9, 0xffff0000, v78
    v_add_f32 v140, v140, v8
    v_add_f32 v141, v141, v9
    v_lshlrev_b32 v10, 16, v79
    v_and_b32 v11, 0xffff0000, v79
    v_add_f32 v142, v142, v10
    v_add_f32 v143, v143, v11
    s_waitcnt vmcnt(6)
    v_lshlrev_b32 v8, 16, v112
    v_and_b32 v9, 0xffff0000, v112
    v_add_f32 v144, v144, v8
    v_add_f32 v145, v145, v9
    v_lshlrev_b32 v10, 16, v113
    v_and_b32 v11, 0xffff0000, v113
    v_add_f32 v146, v146, v10
    v_add_f32 v147, v147, v11
    v_lshlrev_b32 v8, 16, v114
    v_and_b32 v9, 0xffff0000, v114
    v_add_f32 v148, v148, v8
    v_add_f32 v149, v149, v9
    v_lshlrev_b32 v10, 16, v115
    v_and_b32 v11, 0xffff0000, v115
    v_add_f32 v150, v150, v10
    v_add_f32 v151, v151, v11
    s_waitcnt vmcnt(5)
    v_lshlrev_b32 v8, 16, v44
    v_and_b32 v9, 0xffff0000, v44
    v_add_f32 v128, v128, v8
    v_add_f32 v129, v129, v9
    v_lshlrev_b32 v10, 16, v45
    v_and_b32 v11, 0xffff0000, v45
    v_add_f32 v130, v130, v10
    v_add_f32 v131, v131, v11
    v_lshlrev_b32 v8, 16, v46
    v_and_b32 v9, 0xffff0000, v46
    v_add_f32 v132, v132, v8
    v_add_f32 v133, v133, v9
    v_lshlrev_b32 v10, 16, v47
    v_and_b32 v11, 0xffff0000, v47
    v_add_f32 v134, v134, v10
    v_add_f32 v135, v135, v11
    s_waitcnt vmcnt(4)
    v_lshlrev_b32 v8, 16, v80
    v_and_b32 v9, 0xffff0000, v80
    v_add_f32 v136, v136, v8
    v_add_f32 v137, v137, v9
    v_lshlrev_b32 v10, 16, v81
    v_and_b32 v11, 0xffff0000, v81
    v_add_f32 v138, v138, v10
    v_add_f32 v139, v139, v11
    v_lshlrev_b32 v8, 16, v82
    v_and_b32 v9, 0xffff0000, v82
    v_add_f32 v140, v140, v8
    v_add_f32 v141, v141, v9
    v_lshlrev_b32 v10, 16, v83
    v_and_b32 v11, 0xffff0000, v83
    v_add_f32 v142, v142, v10
    v_add_f32 v143, v143, v11
    s_waitcnt vmcnt(3)
    v_lshlrev_b32 v8, 16, v116
    v_and_b32 v9, 0xffff0000, v116
    v_add_f32 v144, v144, v8
    v_add_f32 v145, v145, v9
    v_lshlrev_b32 v10, 16, v117
    v_and_b32 v11, 0xffff0000, v117
    v_add_f32 v146, v146, v10
    v_add_f32 v147, v147, v11
    v_lshlrev_b32 v8, 16, v118
    v_and_b32 v9, 0xffff0000, v118
    v_add_f32 v148, v148, v8
    v_add_f32 v149, v149, v9
    v_lshlrev_b32 v10, 16, v119
    v_and_b32 v11, 0xffff0000, v119
    v_add_f32 v150, v150, v10
    v_add_f32 v151, v151, v11
    s_waitcnt vmcnt(2)
    v_lshlrev_b32 v8, 16, v48
    v_and_b32 v9, 0xffff0000, v48
    v_add_f32 v128, v128, v8
    v_add_f32 v129, v129, v9
    v_lshlrev_b32 v10, 16, v49
    v_and_b32 v11, 0xffff0000, v49
    v_add_f32 v130, v130, v10
    v_add_f32 v131, v131, v11
    v_lshlrev_b32 v8, 16, v50
    v_and_b32 v9, 0xffff0000, v50
    v_add_f32 v132, v132, v8
    v_add_f32 v133, v133, v9
    v_lshlrev_b32 v10, 16, v51
    v_and_b32 v11, 0xffff0000, v51
    v_add_f32 v134, v134, v10
    v_add_f32 v135, v135, v11
    s_waitcnt vmcnt(1)
    v_lshlrev_b32 v8, 16, v84
    v_and_b32 v9, 0xffff0000, v84
    v_add_f32 v136, v136, v8
    v_add_f32 v137, v137, v9
    v_lshlrev_b32 v10, 16, v85
    v_and_b32 v11, 0xffff0000, v85
    v_add_f32 v138, v138, v10
    v_add_f32 v139, v139, v11
    v_lshlrev_b32 v8, 16, v86
    v_and_b32 v9, 0xffff0000, v86
    v_add_f32 v140, v140, v8
    v_add_f32 v141, v141, v9
    v_lshlrev_b32 v10, 16, v87
    v_and_b32 v11, 0xffff0000, v87
    v_add_f32 v142, v142, v10
    v_add_f32 v143, v143, v11
    s_waitcnt vmcnt(0)
    v_lshlrev_b32 v8, 16, v120
    v_and_b32 v9, 0xffff0000, v120
    v_add_f32 v144, v144, v8
    v_add_f32 v145, v145, v9
    v_lshlrev_b32 v10, 16, v121
    v_and_b32 v11, 0xffff0000, v121
    v_add_f32 v146, v146, v10
    v_add_f32 v147, v147, v11
    v_lshlrev_b32 v8, 16, v122
    v_and_b32 v9, 0xffff0000, v122
    v_add_f32 v148, v148, v8
    v_add_f32 v149, v149, v9
    v_lshlrev_b32 v10, 16, v123
    v_and_b32 v11, 0xffff0000, v123
    v_add_f32 v150, v150, v10
    v_add_f32 v151, v151, v11
    s_mov_b32 s16, s38
    s_mov_b32 s17, s39
    s_mov_b32 s18, 0x240000
    s_mov_b32 s19, 0x20000
    v_cvt_pk_bf16_f32 v160, v128, v129
    v_cvt_pk_bf16_f32 v161, v130, v131
    v_cvt_pk_bf16_f32 v162, v132, v133
    v_cvt_pk_bf16_f32 v163, v134, v135
    buffer_store_dwordx4 v[160:163], v3, s[16:19], 0 offen offset:0
    v_cvt_pk_bf16_f32 v164, v136, v137
    v_cvt_pk_bf16_f32 v165, v138, v139
    v_cvt_pk_bf16_f32 v166, v140, v141
    v_cvt_pk_bf16_f32 v167, v142, v143
    buffer_store_dwordx4 v[164:167], v3, s[16:19], 0 offen offset:128
    v_cvt_pk_bf16_f32 v168, v144, v145
    v_cvt_pk_bf16_f32 v169, v146, v147
    v_cvt_pk_bf16_f32 v170, v148, v149
    v_cvt_pk_bf16_f32 v171, v150, v151
    buffer_store_dwordx4 v[168:171], v3, s[16:19], 0 offen offset:256
L_w3a_88:
    s_waitcnt vmcnt(0) lgkmcnt(0)
interleave_layers__sliding_local_dilated__glu_gated_bilinear__prompt_kernel_end:
    s_endpgm
L_pn_slow_7:
    s_mov_b32 s97, 0x40000
L_pn_spin_9:
    global_load_dwordx2 v[6:7], v5, s[40:41] sc1
    s_waitcnt vmcnt(0)
    v_cmp_ne_u64 vcc, 0, v[6:7]
    s_sub_u32 s97, s97, 1
    s_cbranch_scc1 L_pn_back_8
    s_cmp_eq_u64 vcc, exec
    s_cbranch_scc1 L_pn_back_8
    s_branch L_pn_spin_9
L_px_slow_17:
    s_mov_b32 s97, 0x40000
L_px_spin_19:
    buffer_load_dwordx2 v[6:7], v8, s[4:7], s52 offen sc1
    s_waitcnt vmcnt(0)
    v_cmp_eq_u64 vcc, s[98:99], v[6:7]
    s_sub_u32 s97, s97, 1
    s_cbranch_scc1 L_px_back_18
    s_cmp_eq_u64 vcc, exec
    s_cbranch_scc1 L_px_back_18
    s_branch L_px_spin_19
L_pwo_slow_26:
    s_mov_b32 s97, 0x40000
L_pwo_spin_28:
    buffer_load_dwordx2 v[8:9], v10, s[4:7], s52 offen sc1
    s_waitcnt vmcnt(0)
    v_cmp_eq_u64 vcc, s[98:99], v[8:9]
    s_sub_u32 s97, s97, 1
    s_cbranch_scc1 L_pwo_back_27
    s_cmp_eq_u64 vcc, exec
    s_cbranch_scc1 L_pwo_back_27
    s_branch L_pwo_spin_28
L_po_slow_29:
    s_mov_b32 s97, 0x40000
L_po_spin_31:
    buffer_load_dwordx2 v[8:9], v10, s[4:7], s52 offen sc1
    s_waitcnt vmcnt(0)
    v_cmp_eq_u64 vcc, s[98:99], v[8:9]
    s_sub_u32 s97, s97, 1
    s_cbranch_scc1 L_po_back_30
    s_cmp_eq_u64 vcc, exec
    s_cbranch_scc1 L_po_back_30
    s_branch L_po_spin_31
L_pw_slow_56:
    s_mov_b32 s97, 0x40000
L_pw_spin_58:
    buffer_load_dwordx2 v[6:7], v0, s[4:7], s64 offen sc1
    s_waitcnt vmcnt(0)
    v_cmp_eq_u64 vcc, s[98:99], v[6:7]
    s_sub_u32 s97, s97, 1
    s_cbranch_scc1 L_pw_back_57
    s_cmp_eq_u64 vcc, exec
    s_cbranch_scc1 L_pw_back_57
    s_branch L_pw_spin_58
L_p1_slow_60:
    s_mov_b32 s97, 0x40000
L_p1_spin_62:
    buffer_load_dwordx2 v[6:7], v0, s[4:7], s55 offen sc1
    s_waitcnt vmcnt(0)
    v_cmp_eq_u64 vcc, s[98:99], v[6:7]
    s_sub_u32 s97, s97, 1
    s_cbranch_scc1 L_p1_back_61
    s_cmp_eq_u64 vcc, exec
    s_cbranch_scc1 L_p1_back_61
    s_branch L_p1_spin_62
L_pd_slow_63:
    s_mov_b32 s97, 0x40000
L_pd_spin_65:
    buffer_load_dwordx2 v[6:7], v0, s[4:7], s55 offen sc1
    s_waitcnt vmcnt(0)
    v_cmp_eq_u64 vcc, s[98:99], v[6:7]
    s_sub_u32 s97, s97, 1
    s_cbranch_scc1 L_pd_back_64
    s_cmp_eq_u64 vcc, exec
    s_cbranch_scc1 L_pd_back_64
    s_branch L_pd_spin_65
L_p0_slow_66:
    s_mov_b32 s97, 0x40000
L_p0_spin_68:
    buffer_load_dwordx2 v[6:7], v0, s[4:7], s55 offen sc1
    s_waitcnt vmcnt(0)
    v_cmp_eq_u64 vcc, s[98:99], v[6:7]
    s_sub_u32 s97, s97, 1
    s_cbranch_scc1 L_p0_back_67
    s_cmp_eq_u64 vcc, exec
    s_cbranch_scc1 L_p0_back_67
    s_branch L_p0_spin_68
L_p1_slow_69:
    s_mov_b32 s97, 0x40000
L_p1_spin_71:
    buffer_load_dwordx2 v[6:7], v0, s[4:7], s55 offen sc1
    s_waitcnt vmcnt(0)
    v_cmp_eq_u64 vcc, s[98:99], v[6:7]
    s_sub_u32 s97, s97, 1
    s_cbranch_scc1 L_p1_back_70
    s_cmp_eq_u64 vcc, exec
    s_cbranch_scc1 L_p1_back_70
    s_branch L_p1_spin_71
L_p2_slow_72:
    s_mov_b32 s97, 0x40000
L_p2_spin_74:
    buffer_load_dwordx2 v[6:7], v0, s[4:7], s55 offen sc1
    s_waitcnt vmcnt(0)
    v_cmp_eq_u64 vcc, s[98:99], v[6:7]
    s_sub_u32 s97, s97, 1
    s_cbranch_scc1 L_p2_back_73
    s_cmp_eq_u64 vcc, exec
    s_cbranch_scc1 L_p2_back_73
    s_branch L_p2_spin_74
L_pp_slow_76:
    s_mov_b32 s97, 0x40000
L_pp_spin_78:
    buffer_load_dwordx2 v[8:9], v10, s[4:7], s49 offen sc1
    s_waitcnt vmcnt(0)
    v_cmp_eq_u64 vcc, s[98:99], v[8:9]
    s_sub_u32 s97, s97, 1
    s_cbranch_scc1 L_pp_back_77
    s_cmp_eq_u64 vcc, exec
    s_cbranch_scc1 L_pp_back_77
    s_branch L_pp_spin_78
L_px_slow_80:
    s_mov_b32 s97, 0x40000
L_px_spin_82:
    buffer_load_dwordx2 v[6:7], v8, s[4:7], s52 offen sc1
    s_waitcnt vmcnt(0)
    v_cmp_eq_u64 vcc, s[98:99], v[6:7]
    s_sub_u32 s97, s97, 1
    s_cbranch_scc1 L_px_back_81
    s_cmp_eq_u64 vcc, exec
    s_cbranch_scc1 L_px_back_81
    s_branch L_px_spin_82
L_po_slow_85:
    s_mov_b32 s97, 0x40000
L_po_spin_87:
    buffer_load_dwordx2 v[8:9], v10, s[4:7], s52 offen sc1
    s_waitcnt vmcnt(0)
    v_cmp_eq_u64 vcc, s[98:99], v[8:9]
    s_sub_u32 s97, s97, 1
    s_cbranch_scc1 L_po_back_86
    s_cmp_eq_u64 vcc, exec
    s_cbranch_scc1 L_po_back_86
    s_branch L_po_spin_87
L_pp_slow_89:
    s_mov_b32 s97, 0x40000
L_pp_spin_91:
    buffer_load_dwordx2 v[8:9], v10, s[4:7], s49 offen sc1
    s_waitcnt vmcnt(0)
    v_cmp_eq_u64 vcc, s[98:99], v[8:9]
    s_sub_u32 s97, s97, 1
    s_cbranch_scc1 L_pp_back_90
    s_cmp_eq_u64 vcc, exec
    s_cbranch_scc1 L_pp_back_90
    s_branch L_pp_spin_91
interleave_layers__sliding_local_dilated__glu_gated_bilinear__prompt_kernel_last:
    s_endpgm
.section .rodata,"a"
.p2align 6
.amdhsa_kernel interleave_layers__sliding_local_dilated__glu_gated_bilinear__prompt_kernel
  .amdhsa_next_free_vgpr 512
  .amdhsa_next_free_sgpr 102
  .amdhsa_accum_offset 256
  .amdhsa_group_segment_fixed_size 0
  .amdhsa_kernarg_size 80
  .amdhsa_user_sgpr_count 2
  .amdhsa_user_sgpr_kernarg_segment_ptr 1
  .amdhsa_system_sgpr_workgroup_id_x 1
  .amdhsa_float_denorm_mode_32 3
.end_amdhsa_kernel
```

```asm
; @launch grid=(256,1,1) block=(256,1,1) lds=163840
.amdgcn_target "amdgcn-amd-amdhsa--gfx950"
.text
.globl interleave_layers__sliding_local_dilated__glu_gated_bilinear__prompt_kernel
.p2align 8
.type interleave_layers__sliding_local_dilated__glu_gated_bilinear__prompt_kernel,@function
interleave_layers__sliding_local_dilated__glu_gated_bilinear__prompt_kernel:
    s_cmp_ge_u32 s2, 256
    s_cbranch_scc1 interleave_layers__sliding_local_dilated__glu_gated_bilinear__prompt_kernel_end
    s_load_dwordx16 s[24:39], s[0:1], 0
    s_load_dwordx4 s[40:43], s[0:1], 64
    v_lshrrev_b32 v1, 6, v0
    s_and_b32 s21, s2, 7
    v_readfirstlane_b32 s20, v1
    s_lshr_b32 s22, s2, 3
    v_and_b32 v1, 63, v0
    v_lshlrev_b32 v2, 4, v1
    s_lshl_b32 s23, s22, 2
    s_add_u32 s23, s23, s20
    s_mul_i32 s23, s23, 5
    v_add_lshl_u32 v219, v1, s23, 7
    s_getpc_b64 s[16:17]
L_pc_1:
    v_min_u32 v219, interleave_layers__sliding_local_dilated__glu_gated_bilinear__prompt_kernel_last-L_pc_1, v219
    s_mov_b64 exec, 31
    global_load_dword v219, v219, s[16:17]
    s_mov_b64 exec, -1
    s_waitcnt lgkmcnt(0)
    s_mov_b32 s4, s42
    s_mov_b32 s5, s43
    s_mov_b32 s6, 0x10000000
    s_mov_b32 s7, 0x20000
    s_mov_b32 s100, 20971520
    s_mov_b32 s101, 0
    s_mov_b32 s8, s24
    s_mov_b32 s9, s25
    s_mov_b32 s10, 0x240000
    s_mov_b32 s11, 0x20000
    s_mov_b32 s12, s26
    s_mov_b32 s13, s27
    s_mov_b32 s14, 0x1e6000
    s_mov_b32 s15, 0x20000
    v_mov_b32 v3, 0
    v_mov_b32 v4, 0
    v_mov_b32 v5, 0
    s_or_b32 s44, s2, s20
    s_cmp_lg_u32 s44, 0
    s_cbranch_scc1 L_nonce_2
    s_memrealtime s[44:45]
    s_waitcnt lgkmcnt(0)
    v_mov_b32 v6, s44
    v_mov_b32 v7, s45
    s_mov_b64 exec, 1
    global_store_dwordx2 v5, v[6:7], s[40:41] sc1
    s_mov_b64 exec, -1
L_nonce_2:
    s_cmp_eq_u32 s20, 3
    s_cbranch_scc1 L_w3_3
    s_lshl_b32 s47, s21, 5
    s_add_u32 s47, s47, s22
    v_and_b32 v6, 7, v1
    v_lshrrev_b32 v7, 3, v1
    s_lshl_b32 s48, s47, 3
    v_add_u32 v3, s48, v6
    v_mul_u32_u24 v3, 1152, v3
    s_mul_i32 s48, s20, 384
    v_lshl_add_u32 v3, v7, 4, v3
    v_add_u32 v3, s48, v3
    s_lshr_b32 s48, s47, 1
    s_mul_i32 s48, s48, 18432
    s_and_b32 s49, s47, 1
    s_lshl_b32 s49, s49, 7
    s_add_u32 s48, s48, s49
    s_mul_i32 s49, s20, 6144
    s_add_u32 s48, s48, s49
    v_lshlrev_b32 v6, 4, v6
    v_lshl_add_u32 v6, v7, 8, v6
    v_add_u32 v4, s48, v6
    buffer_load_dwordx4 v[8:11], v3, s[8:11], 0 offen offset:0
    buffer_load_dwordx4 v[12:15], v3, s[8:11], 0 offen offset:128
    buffer_load_dwordx4 v[16:19], v3, s[8:11], 0 offen offset:256
    s_branch L_uend_4
L_w3_3:
    s_mov_b32 s55, 0
    s_mov_b32 s56, 0
    s_mov_b32 s57, 8192
    s_mul_i32 s67, s21, 36
    s_add_u32 s67, s67, s22
    s_lshr_b32 s0, s67, 4
    s_and_b32 s67, s67, 15
    s_mul_i32 s67, s67, 18
    s_add_u32 s67, s67, s0
    s_mul_i32 s44, s67, 3641
    s_lshr_b32 s44, s44, 16
    s_mul_i32 s45, s44, 18
    s_sub_u32 s45, s67, s45
    s_mul_i32 s46, s44, 72
    s_and_b32 s47, s46, 8
    s_and_b32 s46, s46, -16
    s_mul_i32 s48, s45, 110592
    s_add_u32 s46, s46, s48
    s_mov_b32 s48, 3216
    s_mul_i32 s51, s67, 7168
    s_mov_b32 s12, s26
    s_mov_b32 s13, s27
    s_mov_b32 s14, 0x1e6000
    s_mov_b32 s15, 0x20000
    v_add_u32 v64, 0, v1
    v_mul_u32_u24 v65, 4370, v64
    v_lshrrev_b32 v65, 16, v65
    v_mad_i32_i24 v66, v65, -15, v64
    v_mul_u32_u24 v66, 13108, v66
    v_lshrrev_b32 v66, 16, v66
    v_mul_u32_u24 v66, 1072, v66
    v_mad_u32_u24 v65, v65, s48, v66
    v_lshl_add_u32 v64, v64, 4, v65
    s_add_u32 m0, s56, 0
    s_nop 0
    buffer_load_dwordx4 v64, s[12:15], s46 offen nt lds
    v_add_u32 v64, 64, v1
    v_mul_u32_u24 v65, 4370, v64
    v_lshrrev_b32 v65, 16, v65
    v_mad_i32_i24 v66, v65, -15, v64
    v_mul_u32_u24 v66, 13108, v66
    v_lshrrev_b32 v66, 16, v66
    v_mul_u32_u24 v66, 1072, v66
    v_mad_u32_u24 v65, v65, s48, v66
    v_lshl_add_u32 v64, v64, 4, v65
    s_add_u32 m0, s56, 1024
    s_nop 0
    buffer_load_dwordx4 v64, s[12:15], s46 offen nt lds
    v_add_u32 v64, 128, v1
    v_mul_u32_u24 v65, 4370, v64
    v_lshrrev_b32 v65, 16, v65
    v_mad_i32_i24 v66, v65, -15, v64
    v_mul_u32_u24 v66, 13108, v66
    v_lshrrev_b32 v66, 16, v66
    v_mul_u32_u24 v66, 1072, v66
    v_mad_u32_u24 v65, v65, s48, v66
    v_lshl_add_u32 v64, v64, 4, v65
    s_add_u32 m0, s56, 2048
    s_nop 0
    buffer_load_dwordx4 v64, s[12:15], s46 offen nt lds
    v_add_u32 v64, 192, v1
    v_mul_u32_u24 v65, 4370, v64
    v_lshrrev_b32 v65, 16, v65
    v_mad_i32_i24 v66, v65, -15, v64
    v_mul_u32_u24 v66, 13108, v66
    v_lshrrev_b32 v66, 16, v66
    v_mul_u32_u24 v66, 1072, v66
    v_mad_u32_u24 v65, v65, s48, v66
    v_lshl_add_u32 v64, v64, 4, v65
    s_add_u32 m0, s56, 3072
    s_nop 0
    buffer_load_dwordx4 v64, s[12:15], s46 offen nt lds
    v_add_u32 v64, 256, v1
    v_mul_u32_u24 v65, 4370, v64
    v_lshrrev_b32 v65, 16, v65
    v_mad_i32_i24 v66, v65, -15, v64
    v_mul_u32_u24 v66, 13108, v66
    v_lshrrev_b32 v66, 16, v66
    v_mul_u32_u24 v66, 1072, v66
    v_mad_u32_u24 v65, v65, s48, v66
    v_lshl_add_u32 v64, v64, 4, v65
    s_add_u32 m0, s56, 4096
    s_nop 0
    buffer_load_dwordx4 v64, s[12:15], s46 offen nt lds
    v_add_u32 v64, 320, v1
    v_mul_u32_u24 v65, 4370, v64
    v_lshrrev_b32 v65, 16, v65
    v_mad_i32_i24 v66, v65, -15, v64
    v_mul_u32_u24 v66, 13108, v66
    v_lshrrev_b32 v66, 16, v66
    v_mul_u32_u24 v66, 1072, v66
    v_mad_u32_u24 v65, v65, s48, v66
    v_lshl_add_u32 v64, v64, 4, v65
    s_add_u32 m0, s56, 5120
    s_nop 0
    buffer_load_dwordx4 v64, s[12:15], s46 offen nt lds
    v_add_u32 v64, 384, v1
    v_mul_u32_u24 v65, 4370, v64
    v_lshrrev_b32 v65, 16, v65
    v_mad_i32_i24 v66, v65, -15, v64
    v_mul_u32_u24 v66, 13108, v66
    v_lshrrev_b32 v66, 16, v66
    v_mul_u32_u24 v66, 1072, v66
    v_mad_u32_u24 v65, v65, s48, v66
    v_lshl_add_u32 v64, v64, 4, v65
    s_add_u32 m0, s56, 6144
    s_nop 0
    buffer_load_dwordx4 v64, s[12:15], s46 offen nt lds
    v_add_u32 v64, 448, v1
    v_mul_u32_u24 v65, 4370, v64
    v_lshrrev_b32 v65, 16, v65
    v_mad_i32_i24 v66, v65, -15, v64
    v_mul_u32_u24 v66, 13108, v66
    v_lshrrev_b32 v66, 16, v66
    v_mul_u32_u24 v66, 1072, v66
    v_mad_u32_u24 v65, v65, s48, v66
    v_lshl_add_u32 v64, v64, 4, v65
    s_add_u32 m0, s56, 7168
    s_nop 0
    buffer_load_dwordx4 v64, s[12:15], s46 offen nt lds
    s_lshl_b32 s0, s44, 5
    s_add_u32 s0, s0, s45
    s_lshl_b32 s0, s0, 3
    s_add_u32 s0, s0, 4063232
    s_cmp_ge_u32 s22, 4
    s_cbranch_scc1 L_uw_5
    s_mov_b32 s55, 1
    s_mul_i32 s67, s21, 36
    s_add_u32 s67, s67, s22
    s_add_u32 s67, s67, 32
    s_lshr_b32 s1, s67, 4
    s_and_b32 s67, s67, 15
    s_mul_i32 s67, s67, 18
    s_add_u32 s67, s67, s1
    s_mul_i32 s84, s67, 3641
    s_lshr_b32 s84, s84, 16
    s_mul_i32 s85, s84, 18
    s_sub_u32 s85, s67, s85
    s_mul_i32 s86, s84, 72
    s_and_b32 s87, s86, 8
    s_and_b32 s86, s86, -16
    s_mul_i32 s88, s85, 110592
    s_add_u32 s86, s86, s88
    s_mov_b32 s88, 3216
    s_mul_i32 s91, s67, 7168
    s_mov_b32 s12, s26
    s_mov_b32 s13, s27
    s_mov_b32 s14, 0x1e6000
    s_mov_b32 s15, 0x20000
    v_add_u32 v64, 0, v1
    v_mul_u32_u24 v65, 4370, v64
    v_lshrrev_b32 v65, 16, v65
    v_mad_i32_i24 v66, v65, -15, v64
    v_mul_u32_u24 v66, 13108, v66
    v_lshrrev_b32 v66, 16, v66
    v_mul_u32_u24 v66, 1072, v66
    v_mad_u32_u24 v65, v65, s88, v66
    v_lshl_add_u32 v64, v64, 4, v65
    s_add_u32 m0, s57, 0
    s_nop 0
    buffer_load_dwordx4 v64, s[12:15], s86 offen nt lds
    v_add_u32 v64, 64, v1
    v_mul_u32_u24 v65, 4370, v64
    v_lshrrev_b32 v65, 16, v65
    v_mad_i32_i24 v66, v65, -15, v64
    v_mul_u32_u24 v66, 13108, v66
    v_lshrrev_b32 v66, 16, v66
    v_mul_u32_u24 v66, 1072, v66
    v_mad_u32_u24 v65, v65, s88, v66
    v_lshl_add_u32 v64, v64, 4, v65
    s_add_u32 m0, s57, 1024
    s_nop 0
    buffer_load_dwordx4 v64, s[12:15], s86 offen nt lds
    v_add_u32 v64, 128, v1
    v_mul_u32_u24 v65, 4370, v64
    v_lshrrev_b32 v65, 16, v65
    v_mad_i32_i24 v66, v65, -15, v64
    v_mul_u32_u24 v66, 13108, v66
    v_lshrrev_b32 v66, 16, v66
    v_mul_u32_u24 v66, 1072, v66
    v_mad_u32_u24 v65, v65, s88, v66
    v_lshl_add_u32 v64, v64, 4, v65
    s_add_u32 m0, s57, 2048
    s_nop 0
    buffer_load_dwordx4 v64, s[12:15], s86 offen nt lds
    v_add_u32 v64, 192, v1
    v_mul_u32_u24 v65, 4370, v64
    v_lshrrev_b32 v65, 16, v65
    v_mad_i32_i24 v66, v65, -15, v64
    v_mul_u32_u24 v66, 13108, v66
    v_lshrrev_b32 v66, 16, v66
    v_mul_u32_u24 v66, 1072, v66
    v_mad_u32_u24 v65, v65, s88, v66
    v_lshl_add_u32 v64, v64, 4, v65
    s_add_u32 m0, s57, 3072
    s_nop 0
    buffer_load_dwordx4 v64, s[12:15], s86 offen nt lds
    v_add_u32 v64, 256, v1
    v_mul_u32_u24 v65, 4370, v64
    v_lshrrev_b32 v65, 16, v65
    v_mad_i32_i24 v66, v65, -15, v64
    v_mul_u32_u24 v66, 13108, v66
    v_lshrrev_b32 v66, 16, v66
    v_mul_u32_u24 v66, 1072, v66
    v_mad_u32_u24 v65, v65, s88, v66
    v_lshl_add_u32 v64, v64, 4, v65
    s_add_u32 m0, s57, 4096
    s_nop 0
    buffer_load_dwordx4 v64, s[12:15], s86 offen nt lds
    v_add_u32 v64, 320, v1
    v_mul_u32_u24 v65, 4370, v64
    v_lshrrev_b32 v65, 16, v65
    v_mad_i32_i24 v66, v65, -15, v64
    v_mul_u32_u24 v66, 13108, v66
    v_lshrrev_b32 v66, 16, v66
    v_mul_u32_u24 v66, 1072, v66
    v_mad_u32_u24 v65, v65, s88, v66
    v_lshl_add_u32 v64, v64, 4, v65
    s_add_u32 m0, s57, 5120
    s_nop 0
    buffer_load_dwordx4 v64, s[12:15], s86 offen nt lds
    v_add_u32 v64, 384, v1
    v_mul_u32_u24 v65, 4370, v64
    v_lshrrev_b32 v65, 16, v65
    v_mad_i32_i24 v66, v65, -15, v64
    v_mul_u32_u24 v66, 13108, v66
    v_lshrrev_b32 v66, 16, v66
    v_mul_u32_u24 v66, 1072, v66
    v_mad_u32_u24 v65, v65, s88, v66
    v_lshl_add_u32 v64, v64, 4, v65
    s_add_u32 m0, s57, 6144
    s_nop 0
    buffer_load_dwordx4 v64, s[12:15], s86 offen nt lds
    v_add_u32 v64, 448, v1
    v_mul_u32_u24 v65, 4370, v64
    v_lshrrev_b32 v65, 16, v65
    v_mad_i32_i24 v66, v65, -15, v64
    v_mul_u32_u24 v66, 13108, v66
    v_lshrrev_b32 v66, 16, v66
    v_mul_u32_u24 v66, 1072, v66
    v_mad_u32_u24 v65, v65, s88, v66
    v_lshl_add_u32 v64, v64, 4, v65
    s_add_u32 m0, s57, 7168
    s_nop 0
    buffer_load_dwordx4 v64, s[12:15], s86 offen nt lds
    s_lshl_b32 s1, s84, 5
    s_add_u32 s1, s1, s85
    s_lshl_b32 s1, s1, 3
    s_add_u32 s1, s1, 4063232
    s_branch L_uend_4
L_uw_5:
    s_cmp_ge_u32 s22, 18
    s_cbranch_scc1 L_uend_4
    s_mul_i32 s67, s21, 14
    s_add_u32 s67, s67, s22
    s_sub_u32 s67, s67, 4
    s_cmp_ge_u32 s67, 108
    s_cbranch_scc1 L_uend_4
    s_mov_b32 s55, 2
    s_mul_i32 s84, s67, 3641
    s_lshr_b32 s84, s84, 16
    s_mul_i32 s85, s84, 18
    s_sub_u32 s85, s67, s85
    s_mul_i32 s86, s85, 41472
    s_sub_u32 s87, s85, 16
    s_mul_i32 s87, s87, 331776
    s_add_u32 s87, s87, 18432
    s_cmp_lt_u32 s85, 16
    s_cselect_b32 s86, s86, s87
    s_mov_b32 s88, 82944
    s_mov_b32 s89, 41472
    s_cselect_b32 s88, 4608, s88
    s_cselect_b32 s89, 23040, s89
    s_mul_i32 s87, s84, 192
    s_add_u32 s86, s86, s87
    s_mov_b32 s90, 1152
    s_mul_i32 s91, s67, 6144
    s_mov_b32 s12, s28
    s_mov_b32 s13, s29
    s_mov_b32 s14, 0xa2000
    s_mov_b32 s15, 0x20000
    v_add_u32 v64, 0, v1
    v_mul_u32_u24 v65, 5462, v64
    v_lshrrev_b32 v65, 16, v65
    v_mul_u32_u24 v66, 12, v65
    v_sub_u32 v64, v64, v66
    v_lshlrev_b32 v64, 4, v64
    v_lshrrev_b32 v66, 3, v65
    v_mul_lo_u32 v66, v66, s88
    v_bfe_u32 v67, v65, 2, 1
    v_mul_lo_u32 v67, v67, s89
    v_and_b32 v65, 3, v65
    v_mul_lo_u32 v65, v65, s90
    v_add3_u32 v64, v64, v66, v67
    v_add3_u32 v64, v64, v65, s86
    s_add_u32 m0, s57, 0
    s_nop 0
    buffer_load_dwordx4 v64, s[12:15], 0 offen nt lds
    v_add_u32 v64, 64, v1
    v_mul_u32_u24 v65, 5462, v64
    v_lshrrev_b32 v65, 16, v65
    v_mul_u32_u24 v66, 12, v65
    v_sub_u32 v64, v64, v66
    v_lshlrev_b32 v64, 4, v64
    v_lshrrev_b32 v66, 3, v65
    v_mul_lo_u32 v66, v66, s88
    v_bfe_u32 v67, v65, 2, 1
    v_mul_lo_u32 v67, v67, s89
    v_and_b32 v65, 3, v65
    v_mul_lo_u32 v65, v65, s90
    v_add3_u32 v64, v64, v66, v67
    v_add3_u32 v64, v64, v65, s86
    s_add_u32 m0, s57, 1024
    s_nop 0
    buffer_load_dwordx4 v64, s[12:15], 0 offen nt lds
    v_add_u32 v64, 128, v1
    v_mul_u32_u24 v65, 5462, v64
    v_lshrrev_b32 v65, 16, v65
    v_mul_u32_u24 v66, 12, v65
    v_sub_u32 v64, v64, v66
    v_lshlrev_b32 v64, 4, v64
    v_lshrrev_b32 v66, 3, v65
    v_mul_lo_u32 v66, v66, s88
    v_bfe_u32 v67, v65, 2, 1
    v_mul_lo_u32 v67, v67, s89
    v_and_b32 v65, 3, v65
    v_mul_lo_u32 v65, v65, s90
    v_add3_u32 v64, v64, v66, v67
    v_add3_u32 v64, v64, v65, s86
    s_add_u32 m0, s57, 2048
    s_nop 0
    buffer_load_dwordx4 v64, s[12:15], 0 offen nt lds
    v_add_u32 v64, 192, v1
    v_mul_u32_u24 v65, 5462, v64
    v_lshrrev_b32 v65, 16, v65
    v_mul_u32_u24 v66, 12, v65
    v_sub_u32 v64, v64, v66
    v_lshlrev_b32 v64, 4, v64
    v_lshrrev_b32 v66, 3, v65
    v_mul_lo_u32 v66, v66, s88
    v_bfe_u32 v67, v65, 2, 1
    v_mul_lo_u32 v67, v67, s89
    v_and_b32 v65, 3, v65
    v_mul_lo_u32 v65, v65, s90
    v_add3_u32 v64, v64, v66, v67
    v_add3_u32 v64, v64, v65, s86
    s_add_u32 m0, s57, 3072
    s_nop 0
    buffer_load_dwordx4 v64, s[12:15], 0 offen nt lds
    v_add_u32 v64, 256, v1
    v_mul_u32_u24 v65, 5462, v64
    v_lshrrev_b32 v65, 16, v65
    v_mul_u32_u24 v66, 12, v65
    v_sub_u32 v64, v64, v66
    v_lshlrev_b32 v64, 4, v64
    v_lshrrev_b32 v66, 3, v65
    v_mul_lo_u32 v66, v66, s88
    v_bfe_u32 v67, v65, 2, 1
    v_mul_lo_u32 v67, v67, s89
    v_and_b32 v65, 3, v65
    v_mul_lo_u32 v65, v65, s90
    v_add3_u32 v64, v64, v66, v67
    v_add3_u32 v64, v64, v65, s86
    s_add_u32 m0, s57, 4096
    s_nop 0
    buffer_load_dwordx4 v64, s[12:15], 0 offen nt lds
    v_add_u32 v64, 320, v1
    v_mul_u32_u24 v65, 5462, v64
    v_lshrrev_b32 v65, 16, v65
    v_mul_u32_u24 v66, 12, v65
    v_sub_u32 v64, v64, v66
    v_lshlrev_b32 v64, 4, v64
    v_lshrrev_b32 v66, 3, v65
    v_mul_lo_u32 v66, v66, s88
    v_bfe_u32 v67, v65, 2, 1
    v_mul_lo_u32 v67, v67, s89
    v_and_b32 v65, 3, v65
    v_mul_lo_u32 v65, v65, s90
    v_add3_u32 v64, v64, v66, v67
    v_add3_u32 v64, v64, v65, s86
    s_add_u32 m0, s57, 5120
    s_nop 0
    buffer_load_dwordx4 v64, s[12:15], 0 offen nt lds
    s_lshl_b32 s1, s84, 5
    s_add_u32 s1, s1, s85
    s_lshl_b32 s1, s1, 3
    s_add_u32 s1, s1, 4067328
L_uend_4:
    v_add_u32 v64, 0, v1
    v_mul_u32_u24 v65, 3641, v64
    v_lshrrev_b32 v65, 16, v65
    v_mul_u32_u24 v66, 18, v65
    v_sub_u32 v64, v64, v66
    v_lshl_or_b32 v220, v64, 8, v65
    v_add_u32 v64, 64, v1
    v_mul_u32_u24 v65, 3641, v64
    v_lshrrev_b32 v65, 16, v65
    v_mul_u32_u24 v66, 18, v65
    v_sub_u32 v64, v64, v66
    v_lshl_or_b32 v221, v64, 8, v65
    v_add_u32 v64, 128, v1
    v_mul_u32_u24 v65, 3641, v64
    v_lshrrev_b32 v65, 16, v65
    v_mul_u32_u24 v66, 18, v65
    v_sub_u32 v64, v64, v66
    v_lshl_or_b32 v222, v64, 8, v65
    v_add_u32 v64, 192, v1
    v_mul_u32_u24 v65, 3641, v64
    v_lshrrev_b32 v65, 16, v65
    v_mul_u32_u24 v66, 18, v65
    v_sub_u32 v64, v64, v66
    v_lshl_or_b32 v223, v64, 8, v65
    v_add_u32 v64, 256, v1
    v_mul_u32_u24 v65, 3641, v64
    v_lshrrev_b32 v65, 16, v65
    v_mul_u32_u24 v66, 18, v65
    v_sub_u32 v64, v64, v66
    v_lshl_or_b32 v224, v64, 8, v65
    v_add_u32 v64, 320, v1
    v_mul_u32_u24 v65, 3641, v64
    v_lshrrev_b32 v65, 16, v65
    v_mul_u32_u24 v66, 18, v65
    v_sub_u32 v64, v64, v66
    v_lshl_or_b32 v225, v64, 8, v65
    v_add_u32 v64, 384, v1
    v_mul_u32_u24 v65, 3641, v64
    v_lshrrev_b32 v65, 16, v65
    v_mul_u32_u24 v66, 18, v65
    v_sub_u32 v64, v64, v66
    v_lshl_or_b32 v226, v64, 8, v65
    v_add_u32 v64, 448, v1
    v_mul_u32_u24 v65, 3641, v64
    v_lshrrev_b32 v65, 16, v65
    v_mul_u32_u24 v66, 18, v65
    v_sub_u32 v64, v64, v66
    v_lshl_or_b32 v227, v64, 8, v65
    v_add_u32 v64, 512, v1
    v_mul_u32_u24 v65, 3641, v64
    v_lshrrev_b32 v65, 16, v65
    v_mul_u32_u24 v66, 18, v65
    v_sub_u32 v64, v64, v66
    v_lshl_or_b32 v228, v64, 8, v65
    s_lshl_b32 s3, s21, 7
    s_lshl_b32 s52, s22, 2
    s_add_u32 s53, s52, s20
    s_add_u32 s3, s3, s53
    s_lshr_b32 s52, s3, 5
    s_and_b32 s3, s3, 31
    s_mul_i32 s3, s3, 36
    s_add_u32 s3, s3, s52
    s_cmp_ge_u32 s3, 1152
    s_cbranch_scc1 L_ud_6
    s_mul_i32 s64, s3, 1821
    s_lshr_b32 s64, s64, 16
    s_mul_i32 s92, s64, 36
    s_sub_u32 s92, s3, s92
    s_and_b32 s93, s92, 1
    s_lshr_b32 s94, s92, 1
    s_cmp_eq_u32 s93, 0
    s_cselect_b32 s16, s32, s34
    s_cselect_b32 s17, s33, s35
    s_mul_i32 s58, s94, 294912
    s_mul_i32 s95, s64, 288
    s_add_u32 s58, s58, s95
    s_mov_b32 s59, 73728
    s_mov_b32 s60, 36864
    s_mov_b32 s61, 9216
    s_branch L_udone_7
L_ud_6:
    s_sub_u32 s92, s3, 1152
    s_mul_i32 s64, s92, 3641
    s_lshr_b32 s64, s64, 16
    s_mul_i32 s93, s64, 18
    s_sub_u32 s92, s92, s93
    s_and_b32 s93, s64, 3
    s_and_b32 s94, s93, 1
    s_mov_b32 s16, s36
    s_mov_b32 s17, s37
    s_mov_b32 s61, 1152
    s_cmp_eq_u32 s94, 0
    s_mov_b32 s97, -165888
    s_cselect_b32 s97, 165888, s97
    s_mov_b32 s59, 9216
    s_mov_b32 s60, 4608
    s_cmp_ge_u32 s92, 4
    s_cbranch_scc1 L_ush_8
    s_mov_b32 s95, s93
    s_lshl_b32 s96, s92, 5
    s_branch L_urows_10
L_ush_8:
    s_cmp_ge_u32 s92, 6
    s_cbranch_scc1 L_urm_9
    s_sub_u32 s95, s92, 4
    s_lshl_b32 s95, s95, 1
    s_xor_b32 s95, s95, s93
    s_mov_b32 s96, 128
    s_mov_b32 s59, 4608
    s_mov_b32 s60, s97
    s_branch L_urows_10
L_urm_9:
    s_sub_u32 s95, s92, 6
    s_mul_i32 s96, s95, 21846
    s_lshr_b32 s96, s96, 16
    s_mul_i32 s97, s96, 3
    s_sub_u32 s95, s95, s97
    s_add_u32 s95, s95, 1
    s_xor_b32 s95, s95, s93
    s_lshl_b32 s96, s96, 5
L_urows_10:
    s_mul_i32 s95, s95, 144
    s_add_u32 s95, s95, s96
    s_lshr_b32 s96, s64, 2
    s_mul_i32 s96, s96, 576
    s_add_u32 s95, s95, s96
    s_mul_i32 s95, s95, 1152
    s_mul_i32 s96, s93, 288
    s_add_u32 s58, s95, s96
L_udone_7:
    s_mov_b32 s18, 0x510000
    s_mov_b32 s19, 0x20000
    v_bfe_u32 v64, v220, 3, 2
    v_mul_u32_u24 v64, s59, v64
    v_bfe_u32 v65, v220, 2, 1
    v_mul_lo_u32 v65, v65, s60
    v_and_b32 v66, 3, v220
    v_mul_u32_u24 v66, s61, v66
    v_add3_u32 v64, v64, v65, v66
    v_lshrrev_b32 v65, 8, v220
    v_lshl_add_u32 v64, v65, 4, v64
    v_add_u32 v229, s58, v64
    v_bfe_u32 v64, v221, 3, 2
    v_mul_u32_u24 v64, s59, v64
    v_bfe_u32 v65, v221, 2, 1
    v_mul_lo_u32 v65, v65, s60
    v_and_b32 v66, 3, v221
    v_mul_u32_u24 v66, s61, v66
    v_add3_u32 v64, v64, v65, v66
    v_lshrrev_b32 v65, 8, v221
    v_lshl_add_u32 v64, v65, 4, v64
    v_add_u32 v230, s58, v64
    v_bfe_u32 v64, v222, 3, 2
    v_mul_u32_u24 v64, s59, v64
    v_bfe_u32 v65, v222, 2, 1
    v_mul_lo_u32 v65, v65, s60
    v_and_b32 v66, 3, v222
    v_mul_u32_u24 v66, s61, v66
    v_add3_u32 v64, v64, v65, v66
    v_lshrrev_b32 v65, 8, v222
    v_lshl_add_u32 v64, v65, 4, v64
    v_add_u32 v231, s58, v64
    v_bfe_u32 v64, v223, 3, 2
    v_mul_u32_u24 v64, s59, v64
    v_bfe_u32 v65, v223, 2, 1
    v_mul_lo_u32 v65, v65, s60
    v_and_b32 v66, 3, v223
    v_mul_u32_u24 v66, s61, v66
    v_add3_u32 v64, v64, v65, v66
    v_lshrrev_b32 v65, 8, v223
    v_lshl_add_u32 v64, v65, 4, v64
    v_add_u32 v232, s58, v64
    v_bfe_u32 v64, v224, 3, 2
    v_mul_u32_u24 v64, s59, v64
    v_bfe_u32 v65, v224, 2, 1
    v_mul_lo_u32 v65, v65, s60
    v_and_b32 v66, 3, v224
    v_mul_u32_u24 v66, s61, v66
    v_add3_u32 v64, v64, v65, v66
    v_lshrrev_b32 v65, 8, v224
    v_lshl_add_u32 v64, v65, 4, v64
    v_add_u32 v233, s58, v64
    v_bfe_u32 v64, v225, 3, 2
    v_mul_u32_u24 v64, s59, v64
    v_bfe_u32 v65, v225, 2, 1
    v_mul_lo_u32 v65, v65, s60
    v_and_b32 v66, 3, v225
    v_mul_u32_u24 v66, s61, v66
    v_add3_u32 v64, v64, v65, v66
    v_lshrrev_b32 v65, 8, v225
    v_lshl_add_u32 v64, v65, 4, v64
    v_add_u32 v234, s58, v64
    v_bfe_u32 v64, v226, 3, 2
    v_mul_u32_u24 v64, s59, v64
    v_bfe_u32 v65, v226, 2, 1
    v_mul_lo_u32 v65, v65, s60
    v_and_b32 v66, 3, v226
    v_mul_u32_u24 v66, s61, v66
    v_add3_u32 v64, v64, v65, v66
    v_lshrrev_b32 v65, 8, v226
    v_lshl_add_u32 v64, v65, 4, v64
    v_add_u32 v235, s58, v64
    v_bfe_u32 v64, v227, 3, 2
    v_mul_u32_u24 v64, s59, v64
    v_bfe_u32 v65, v227, 2, 1
    v_mul_lo_u32 v65, v65, s60
    v_and_b32 v66, 3, v227
    v_mul_u32_u24 v66, s61, v66
    v_add3_u32 v64, v64, v65, v66
    v_lshrrev_b32 v65, 8, v227
    v_lshl_add_u32 v64, v65, 4, v64
    v_add_u32 v236, s58, v64
    v_bfe_u32 v64, v228, 3, 2
    v_mul_u32_u24 v64, s59, v64
    v_bfe_u32 v65, v228, 2, 1
    v_mul_lo_u32 v65, v65, s60
    v_and_b32 v66, 3, v228
    v_mul_u32_u24 v66, s61, v66
    v_add3_u32 v64, v64, v65, v66
    v_lshrrev_b32 v65, 8, v228
    v_lshl_add_u32 v64, v65, 4, v64
    v_add_u32 v237, s58, v64
    s_mov_b32 s30, -1
    s_mov_b32 s31, -1
    s_mul_i32 s54, s21, 72
    s_add_u32 s54, s54, 1152
    s_cmp_ge_u32 s22, 24
    s_cbranch_scc1 L_ui_11
    s_cmp_lg_u32 s20, 3
    s_cbranch_scc1 L_ue_14
    s_add_u32 s30, s54, s22
    s_add_u32 s30, s30, 48
    s_branch L_ub_13
L_ui_11:
    s_sub_u32 s53, s53, 96
    s_add_u32 s31, s54, s53
    s_add_u32 s30, s31, -16
    s_add_u32 s31, s31, 16
    s_cmp_ge_u32 s53, 16
    s_cbranch_scc1 L_ud_12
    s_lshl_b32 s30, s21, 4
    s_add_u32 s30, s30, s53
    s_add_u32 s30, s30, 1024
    s_lshr_b32 s52, s30, 5
    s_and_b32 s30, s30, 31
    s_mul_i32 s30, s30, 36
    s_add_u32 s30, s30, s52
L_ud_12:
L_ub_13:
L_ue_14:
    v_mov_b32 v238, 0
    v_mov_b32 v239, 0
    v_mov_b32 v240, 0
    v_mov_b32 v241, 0
    v_mov_b32 v242, 0
    v_mov_b32 v243, 0
    v_mov_b32 v244, 0
    v_mov_b32 v245, 0
    v_mov_b32 v246, 0
    s_mov_b32 s14, 0
    s_cmp_eq_u32 s30, -1
    s_cbranch_scc1 L_absent_15
    s_cmp_ge_u32 s30, 1152
    s_cbranch_scc1 L_ud_16
    s_mul_i32 s64, s30, 1821
    s_lshr_b32 s64, s64, 16
    s_mul_i32 s92, s64, 36
    s_sub_u32 s92, s30, s92
    s_and_b32 s93, s92, 1
    s_lshr_b32 s94, s92, 1
    s_cmp_eq_u32 s93, 0
    s_cselect_b32 s12, s32, s34
    s_cselect_b32 s13, s33, s35
    s_mul_i32 s58, s94, 294912
    s_mul_i32 s95, s64, 288
    s_add_u32 s58, s58, s95
    s_mov_b32 s59, 73728
    s_mov_b32 s60, 36864
    s_mov_b32 s61, 9216
    s_branch L_udone_17
L_ud_16:
    s_sub_u32 s92, s30, 1152
    s_mul_i32 s64, s92, 3641
    s_lshr_b32 s64, s64, 16
    s_mul_i32 s93, s64, 18
    s_sub_u32 s92, s92, s93
    s_and_b32 s93, s64, 3
    s_and_b32 s94, s93, 1
    s_mov_b32 s12, s36
    s_mov_b32 s13, s37
    s_mov_b32 s61, 1152
    s_cmp_eq_u32 s94, 0
    s_mov_b32 s97, -165888
    s_cselect_b32 s97, 165888, s97
    s_mov_b32 s59, 9216
    s_mov_b32 s60, 4608
    s_cmp_ge_u32 s92, 4
    s_cbranch_scc1 L_ush_18
    s_mov_b32 s95, s93
    s_lshl_b32 s96, s92, 5
    s_branch L_urows_20
L_ush_18:
    s_cmp_ge_u32 s92, 6
    s_cbranch_scc1 L_urm_19
    s_sub_u32 s95, s92, 4
    s_lshl_b32 s95, s95, 1
    s_xor_b32 s95, s95, s93
    s_mov_b32 s96, 128
    s_mov_b32 s59, 4608
    s_mov_b32 s60, s97
    s_branch L_urows_20
L_urm_19:
    s_sub_u32 s95, s92, 6
    s_mul_i32 s96, s95, 21846
    s_lshr_b32 s96, s96, 16
    s_mul_i32 s97, s96, 3
    s_sub_u32 s95, s95, s97
    s_add_u32 s95, s95, 1
    s_xor_b32 s95, s95, s93
    s_lshl_b32 s96, s96, 5
L_urows_20:
    s_mul_i32 s95, s95, 144
    s_add_u32 s95, s95, s96
    s_lshr_b32 s96, s64, 2
    s_mul_i32 s96, s96, 576
    s_add_u32 s95, s95, s96
    s_mul_i32 s95, s95, 1152
    s_mul_i32 s96, s93, 288
    s_add_u32 s58, s95, s96
L_udone_17:
    s_mov_b32 s14, 0x510000
    s_mov_b32 s15, 0x20000
    v_bfe_u32 v64, v220, 3, 2
    v_mul_u32_u24 v64, s59, v64
    v_bfe_u32 v65, v220, 2, 1
    v_mul_lo_u32 v65, v65, s60
    v_and_b32 v66, 3, v220
    v_mul_u32_u24 v66, s61, v66
    v_add3_u32 v64, v64, v65, v66
    v_lshrrev_b32 v65, 8, v220
    v_lshl_add_u32 v64, v65, 4, v64
    v_add_u32 v238, s58, v64
    v_bfe_u32 v64, v221, 3, 2
    v_mul_u32_u24 v64, s59, v64
    v_bfe_u32 v65, v221, 2, 1
    v_mul_lo_u32 v65, v65, s60
    v_and_b32 v66, 3, v221
    v_mul_u32_u24 v66, s61, v66
    v_add3_u32 v64, v64, v65, v66
    v_lshrrev_b32 v65, 8, v221
    v_lshl_add_u32 v64, v65, 4, v64
    v_add_u32 v239, s58, v64
    v_bfe_u32 v64, v222, 3, 2
    v_mul_u32_u24 v64, s59, v64
    v_bfe_u32 v65, v222, 2, 1
    v_mul_lo_u32 v65, v65, s60
    v_and_b32 v66, 3, v222
    v_mul_u32_u24 v66, s61, v66
    v_add3_u32 v64, v64, v65, v66
    v_lshrrev_b32 v65, 8, v222
    v_lshl_add_u32 v64, v65, 4, v64
    v_add_u32 v240, s58, v64
    v_bfe_u32 v64, v223, 3, 2
    v_mul_u32_u24 v64, s59, v64
    v_bfe_u32 v65, v223, 2, 1
    v_mul_lo_u32 v65, v65, s60
    v_and_b32 v66, 3, v223
    v_mul_u32_u24 v66, s61, v66
    v_add3_u32 v64, v64, v65, v66
    v_lshrrev_b32 v65, 8, v223
    v_lshl_add_u32 v64, v65, 4, v64
    v_add_u32 v241, s58, v64
    v_bfe_u32 v64, v224, 3, 2
    v_mul_u32_u24 v64, s59, v64
    v_bfe_u32 v65, v224, 2, 1
    v_mul_lo_u32 v65, v65, s60
    v_and_b32 v66, 3, v224
    v_mul_u32_u24 v66, s61, v66
    v_add3_u32 v64, v64, v65, v66
    v_lshrrev_b32 v65, 8, v224
    v_lshl_add_u32 v64, v65, 4, v64
    v_add_u32 v242, s58, v64
    v_bfe_u32 v64, v225, 3, 2
    v_mul_u32_u24 v64, s59, v64
    v_bfe_u32 v65, v225, 2, 1
    v_mul_lo_u32 v65, v65, s60
    v_and_b32 v66, 3, v225
    v_mul_u32_u24 v66, s61, v66
    v_add3_u32 v64, v64, v65, v66
    v_lshrrev_b32 v65, 8, v225
    v_lshl_add_u32 v64, v65, 4, v64
    v_add_u32 v243, s58, v64
    v_bfe_u32 v64, v226, 3, 2
    v_mul_u32_u24 v64, s59, v64
    v_bfe_u32 v65, v226, 2, 1
    v_mul_lo_u32 v65, v65, s60
    v_and_b32 v66, 3, v226
    v_mul_u32_u24 v66, s61, v66
    v_add3_u32 v64, v64, v65, v66
    v_lshrrev_b32 v65, 8, v226
    v_lshl_add_u32 v64, v65, 4, v64
    v_add_u32 v244, s58, v64
    v_bfe_u32 v64, v227, 3, 2
    v_mul_u32_u24 v64, s59, v64
    v_bfe_u32 v65, v227, 2, 1
    v_mul_lo_u32 v65, v65, s60
    v_and_b32 v66, 3, v227
    v_mul_u32_u24 v66, s61, v66
    v_add3_u32 v64, v64, v65, v66
    v_lshrrev_b32 v65, 8, v227
    v_lshl_add_u32 v64, v65, 4, v64
    v_add_u32 v245, s58, v64
    v_bfe_u32 v64, v228, 3, 2
    v_mul_u32_u24 v64, s59, v64
    v_bfe_u32 v65, v228, 2, 1
    v_mul_lo_u32 v65, v65, s60
    v_and_b32 v66, 3, v228
    v_mul_u32_u24 v66, s61, v66
    v_add3_u32 v64, v64, v65, v66
    v_lshrrev_b32 v65, 8, v228
    v_lshl_add_u32 v64, v65, 4, v64
    v_add_u32 v246, s58, v64
L_absent_15:
    v_mov_b32 v247, 0
    v_mov_b32 v248, 0
    v_mov_b32 v249, 0
    v_mov_b32 v250, 0
    v_mov_b32 v251, 0
    v_mov_b32 v252, 0
    v_mov_b32 v253, 0
    v_mov_b32 v254, 0
    v_mov_b32 v255, 0
    s_mov_b32 s10, 0
    s_cmp_eq_u32 s31, -1
    s_cbranch_scc1 L_absent_21
    s_cmp_ge_u32 s31, 1152
    s_cbranch_scc1 L_ud_22
    s_mul_i32 s64, s31, 1821
    s_lshr_b32 s64, s64, 16
    s_mul_i32 s92, s64, 36
    s_sub_u32 s92, s31, s92
    s_and_b32 s93, s92, 1
    s_lshr_b32 s94, s92, 1
    s_cmp_eq_u32 s93, 0
    s_cselect_b32 s8, s32, s34
    s_cselect_b32 s9, s33, s35
    s_mul_i32 s58, s94, 294912
    s_mul_i32 s95, s64, 288
    s_add_u32 s58, s58, s95
    s_mov_b32 s59, 73728
    s_mov_b32 s60, 36864
    s_mov_b32 s61, 9216
    s_branch L_udone_23
L_ud_22:
    s_sub_u32 s92, s31, 1152
    s_mul_i32 s64, s92, 3641
    s_lshr_b32 s64, s64, 16
    s_mul_i32 s93, s64, 18
    s_sub_u32 s92, s92, s93
    s_and_b32 s93, s64, 3
    s_and_b32 s94, s93, 1
    s_mov_b32 s8, s36
    s_mov_b32 s9, s37
    s_mov_b32 s61, 1152
    s_cmp_eq_u32 s94, 0
    s_mov_b32 s97, -165888
    s_cselect_b32 s97, 165888, s97
    s_mov_b32 s59, 9216
    s_mov_b32 s60, 4608
    s_cmp_ge_u32 s92, 4
    s_cbranch_scc1 L_ush_24
    s_mov_b32 s95, s93
    s_lshl_b32 s96, s92, 5
    s_branch L_urows_26
L_ush_24:
    s_cmp_ge_u32 s92, 6
    s_cbranch_scc1 L_urm_25
    s_sub_u32 s95, s92, 4
    s_lshl_b32 s95, s95, 1
    s_xor_b32 s95, s95, s93
    s_mov_b32 s96, 128
    s_mov_b32 s59, 4608
    s_mov_b32 s60, s97
    s_branch L_urows_26
L_urm_25:
    s_sub_u32 s95, s92, 6
    s_mul_i32 s96, s95, 21846
    s_lshr_b32 s96, s96, 16
    s_mul_i32 s97, s96, 3
    s_sub_u32 s95, s95, s97
    s_add_u32 s95, s95, 1
    s_xor_b32 s95, s95, s93
    s_lshl_b32 s96, s96, 5
L_urows_26:
    s_mul_i32 s95, s95, 144
    s_add_u32 s95, s95, s96
    s_lshr_b32 s96, s64, 2
    s_mul_i32 s96, s96, 576
    s_add_u32 s95, s95, s96
    s_mul_i32 s95, s95, 1152
    s_mul_i32 s96, s93, 288
    s_add_u32 s58, s95, s96
L_udone_23:
    s_mov_b32 s10, 0x510000
    s_mov_b32 s11, 0x20000
    v_bfe_u32 v64, v220, 3, 2
    v_mul_u32_u24 v64, s59, v64
    v_bfe_u32 v65, v220, 2, 1
    v_mul_lo_u32 v65, v65, s60
    v_and_b32 v66, 3, v220
    v_mul_u32_u24 v66, s61, v66
    v_add3_u32 v64, v64, v65, v66
    v_lshrrev_b32 v65, 8, v220
    v_lshl_add_u32 v64, v65, 4, v64
    v_add_u32 v247, s58, v64
    v_bfe_u32 v64, v221, 3, 2
    v_mul_u32_u24 v64, s59, v64
    v_bfe_u32 v65, v221, 2, 1
    v_mul_lo_u32 v65, v65, s60
    v_and_b32 v66, 3, v221
    v_mul_u32_u24 v66, s61, v66
    v_add3_u32 v64, v64, v65, v66
    v_lshrrev_b32 v65, 8, v221
    v_lshl_add_u32 v64, v65, 4, v64
    v_add_u32 v248, s58, v64
    v_bfe_u32 v64, v222, 3, 2
    v_mul_u32_u24 v64, s59, v64
    v_bfe_u32 v65, v222, 2, 1
    v_mul_lo_u32 v65, v65, s60
    v_and_b32 v66, 3, v222
    v_mul_u32_u24 v66, s61, v66
    v_add3_u32 v64, v64, v65, v66
    v_lshrrev_b32 v65, 8, v222
    v_lshl_add_u32 v64, v65, 4, v64
    v_add_u32 v249, s58, v64
    v_bfe_u32 v64, v223, 3, 2
    v_mul_u32_u24 v64, s59, v64
    v_bfe_u32 v65, v223, 2, 1
    v_mul_lo_u32 v65, v65, s60
    v_and_b32 v66, 3, v223
    v_mul_u32_u24 v66, s61, v66
    v_add3_u32 v64, v64, v65, v66
    v_lshrrev_b32 v65, 8, v223
    v_lshl_add_u32 v64, v65, 4, v64
    v_add_u32 v250, s58, v64
    v_bfe_u32 v64, v224, 3, 2
    v_mul_u32_u24 v64, s59, v64
    v_bfe_u32 v65, v224, 2, 1
    v_mul_lo_u32 v65, v65, s60
    v_and_b32 v66, 3, v224
    v_mul_u32_u24 v66, s61, v66
    v_add3_u32 v64, v64, v65, v66
    v_lshrrev_b32 v65, 8, v224
    v_lshl_add_u32 v64, v65, 4, v64
    v_add_u32 v251, s58, v64
    v_bfe_u32 v64, v225, 3, 2
    v_mul_u32_u24 v64, s59, v64
    v_bfe_u32 v65, v225, 2, 1
    v_mul_lo_u32 v65, v65, s60
    v_and_b32 v66, 3, v225
    v_mul_u32_u24 v66, s61, v66
    v_add3_u32 v64, v64, v65, v66
    v_lshrrev_b32 v65, 8, v225
    v_lshl_add_u32 v64, v65, 4, v64
    v_add_u32 v252, s58, v64
    v_bfe_u32 v64, v226, 3, 2
    v_mul_u32_u24 v64, s59, v64
    v_bfe_u32 v65, v226, 2, 1
    v_mul_lo_u32 v65, v65, s60
    v_and_b32 v66, 3, v226
    v_mul_u32_u24 v66, s61, v66
    v_add3_u32 v64, v64, v65, v66
    v_lshrrev_b32 v65, 8, v226
    v_lshl_add_u32 v64, v65, 4, v64
    v_add_u32 v253, s58, v64
    v_bfe_u32 v64, v227, 3, 2
    v_mul_u32_u24 v64, s59, v64
    v_bfe_u32 v65, v227, 2, 1
    v_mul_lo_u32 v65, v65, s60
    v_and_b32 v66, 3, v227
    v_mul_u32_u24 v66, s61, v66
    v_add3_u32 v64, v64, v65, v66
    v_lshrrev_b32 v65, 8, v227
    v_lshl_add_u32 v64, v65, 4, v64
    v_add_u32 v254, s58, v64
    v_bfe_u32 v64, v228, 3, 2
    v_mul_u32_u24 v64, s59, v64
    v_bfe_u32 v65, v228, 2, 1
    v_mul_lo_u32 v65, v65, s60
    v_and_b32 v66, 3, v228
    v_mul_u32_u24 v66, s61, v66
    v_add3_u32 v64, v64, v65, v66
    v_lshrrev_b32 v65, 8, v228
    v_lshl_add_u32 v64, v65, 4, v64
    v_add_u32 v255, s58, v64
L_absent_21:
    s_cmp_eq_u32 s20, 3
    s_cbranch_scc1 L_w3_30
    s_waitcnt vmcnt(0)
    v_lshlrev_b32 v20, 16, v8
    v_and_b32 v21, 0xffff0000, v8
    v_lshlrev_b32 v22, 16, v9
    v_and_b32 v23, 0xffff0000, v9
    v_lshlrev_b32 v24, 16, v10
    v_and_b32 v25, 0xffff0000, v10
    v_lshlrev_b32 v26, 16, v11
    v_and_b32 v27, 0xffff0000, v11
    v_lshlrev_b32 v28, 16, v12
    v_and_b32 v29, 0xffff0000, v12
    v_lshlrev_b32 v30, 16, v13
    v_and_b32 v31, 0xffff0000, v13
    v_lshlrev_b32 v32, 16, v14
    v_and_b32 v33, 0xffff0000, v14
    v_lshlrev_b32 v34, 16, v15
    v_and_b32 v35, 0xffff0000, v15
    v_lshlrev_b32 v36, 16, v16
    v_and_b32 v37, 0xffff0000, v16
    v_lshlrev_b32 v38, 16, v17
    v_and_b32 v39, 0xffff0000, v17
    v_lshlrev_b32 v40, 16, v18
    v_and_b32 v41, 0xffff0000, v18
    v_lshlrev_b32 v42, 16, v19
    v_and_b32 v43, 0xffff0000, v19
    v_add_f32 v44, v20, v21
    v_add_f32 v64, v22, v23
    v_add_f32 v44, v44, v24
    v_add_f32 v64, v64, v25
    v_add_f32 v44, v44, v26
    v_add_f32 v64, v64, v27
    v_add_f32 v44, v44, v28
    v_add_f32 v64, v64, v29
    v_add_f32 v44, v44, v30
    v_add_f32 v64, v64, v31
    v_add_f32 v44, v44, v32
    v_add_f32 v64, v64, v33
    v_add_f32 v44, v44, v34
    v_add_f32 v64, v64, v35
    v_add_f32 v44, v44, v36
    v_add_f32 v64, v64, v37
    v_add_f32 v44, v44, v38
    v_add_f32 v64, v64, v39
    v_add_f32 v44, v44, v40
    v_add_f32 v64, v64, v41
    v_add_f32 v44, v44, v42
    v_add_f32 v64, v64, v43
    v_add_f32 v44, v44, v64
    s_nop 1
    v_add_f32_dpp v44, v44, v44 row_ror:8 row_mask:0xf bank_mask:0xf
    v_mov_b32 v64, v44
    s_nop 1
    v_permlane16_swap_b32 v44, v64
    v_add_f32 v44, v44, v64
    v_mov_b32 v64, v44
    s_nop 1
    v_permlane32_swap_b32 v44, v64
    v_add_f32 v44, v44, v64
    v_mul_f32 v65, 0x3baaaaab, v44
    v_sub_f32 v64, v20, v65
    v_mul_f32 v45, v64, v64
    v_sub_f32 v67, v21, v65
    v_fmac_f32 v45, v67, v67
    v_sub_f32 v66, v22, v65
    v_fmac_f32 v45, v66, v66
    v_sub_f32 v67, v23, v65
    v_fmac_f32 v45, v67, v67
    v_sub_f32 v66, v24, v65
    v_fmac_f32 v45, v66, v66
    v_sub_f32 v67, v25, v65
    v_fmac_f32 v45, v67, v67
    v_sub_f32 v66, v26, v65
    v_fmac_f32 v45, v66, v66
    v_sub_f32 v67, v27, v65
    v_fmac_f32 v45, v67, v67
    v_sub_f32 v66, v28, v65
    v_fmac_f32 v45, v66, v66
    v_sub_f32 v67, v29, v65
    v_fmac_f32 v45, v67, v67
    v_sub_f32 v66, v30, v65
    v_fmac_f32 v45, v66, v66
    v_sub_f32 v67, v31, v65
    v_fmac_f32 v45, v67, v67
    v_sub_f32 v66, v32, v65
    v_fmac_f32 v45, v66, v66
    v_sub_f32 v67, v33, v65
    v_fmac_f32 v45, v67, v67
    v_sub_f32 v66, v34, v65
    v_fmac_f32 v45, v66, v66
    v_sub_f32 v67, v35, v65
    v_fmac_f32 v45, v67, v67
    v_sub_f32 v66, v36, v65
    v_fmac_f32 v45, v66, v66
    v_sub_f32 v67, v37, v65
    v_fmac_f32 v45, v67, v67
    v_sub_f32 v66, v38, v65
    v_fmac_f32 v45, v66, v66
    v_sub_f32 v67, v39, v65
    v_fmac_f32 v45, v67, v67
    v_sub_f32 v66, v40, v65
    v_fmac_f32 v45, v66, v66
    v_sub_f32 v67, v41, v65
    v_fmac_f32 v45, v67, v67
    v_sub_f32 v66, v42, v65
    v_fmac_f32 v45, v66, v66
    v_sub_f32 v67, v43, v65
    v_fmac_f32 v45, v67, v67
    s_nop 1
    v_add_f32_dpp v45, v45, v45 row_ror:8 row_mask:0xf bank_mask:0xf
    v_mov_b32 v64, v45
    s_nop 1
    v_permlane16_swap_b32 v45, v64
    v_add_f32 v45, v45, v64
    v_mov_b32 v64, v45
    s_nop 1
    v_permlane32_swap_b32 v45, v64
    v_add_f32 v45, v45, v64
    v_and_b32 v64, 7, v1
    s_mul_i32 s46, s20, 64
    s_add_u32 s46, s46, 160896
    v_lshl_add_u32 v64, v64, 3, s46
    ds_write_b64 v64, v[44:45]
    s_waitcnt lgkmcnt(0)
L_w3_30:
    s_barrier
    global_load_dwordx2 v[6:7], v5, s[40:41] sc1
    s_cmp_eq_u32 s20, 3
    s_cbranch_scc1 L_w3_31
    v_and_b32 v64, 7, v1
    v_lshlrev_b32 v64, 3, v64
    v_add_u32 v64, 160896, v64
    ds_read_b64 v[44:45], v64 offset:0
    ds_read_b64 v[46:47], v64 offset:64
    ds_read_b64 v[48:49], v64 offset:128
    s_waitcnt lgkmcnt(1)
    v_add_f32 v64, v44, v46
    s_waitcnt lgkmcnt(0)
    v_add_f32 v64, v64, v48
    v_mul_f32 v64, 0x3ae38e39, v64
    v_add_f32 v65, v45, v47
    v_add_f32 v65, v65, v49
    v_mul_f32 v66, 0x3baaaaab, v44
    v_sub_f32 v66, v66, v64
    v_mul_f32 v66, v66, v66
    v_fmac_f32 v65, 0x43400000, v66
    v_mul_f32 v66, 0x3baaaaab, v46
    v_sub_f32 v66, v66, v64
    v_mul_f32 v66, v66, v66
    v_fmac_f32 v65, 0x43400000, v66
    v_mul_f32 v66, 0x3baaaaab, v48
    v_sub_f32 v66, v66, v64
    v_mul_f32 v66, v66, v66
    v_fmac_f32 v65, 0x43400000, v66
    v_mul_f32 v65, 0x3ae38e39, v65
    v_cvt_pk_bf16_f32 v65, v65, v65
    v_lshlrev_b32 v65, 16, v65
    v_add_f32 v65, 0x3727c5ac, v65
    v_cvt_pk_bf16_f32 v65, v65, v65
    v_lshlrev_b32 v65, 16, v65
    v_sqrt_f32 v65, v65
    s_nop 0
    v_cvt_pk_bf16_f32 v65, v65, v65
    v_lshlrev_b32 v65, 16, v65
    v_rcp_f32 v65, v65
    v_cvt_pk_bf16_f32 v64, v64, v64
    v_lshlrev_b32 v64, 16, v64
    v_sub_f32 v20, v20, v64
    v_sub_f32 v21, v21, v64
    v_cvt_pk_bf16_f32 v66, v20, v21
    v_lshlrev_b32 v20, 16, v66
    v_and_b32 v21, 0xffff0000, v66
    v_mul_f32 v20, v20, v65
    v_mul_f32 v21, v21, v65
    v_cvt_pk_bf16_f32 v52, v20, v21
    v_sub_f32 v22, v22, v64
    v_sub_f32 v23, v23, v64
    v_cvt_pk_bf16_f32 v66, v22, v23
    v_lshlrev_b32 v22, 16, v66
    v_and_b32 v23, 0xffff0000, v66
    v_mul_f32 v22, v22, v65
    v_mul_f32 v23, v23, v65
    v_cvt_pk_bf16_f32 v53, v22, v23
    v_sub_f32 v24, v24, v64
    v_sub_f32 v25, v25, v64
    v_cvt_pk_bf16_f32 v66, v24, v25
    v_lshlrev_b32 v24, 16, v66
    v_and_b32 v25, 0xffff0000, v66
    v_mul_f32 v24, v24, v65
    v_mul_f32 v25, v25, v65
    v_cvt_pk_bf16_f32 v54, v24, v25
    v_sub_f32 v26, v26, v64
    v_sub_f32 v27, v27, v64
    v_cvt_pk_bf16_f32 v66, v26, v27
    v_lshlrev_b32 v26, 16, v66
    v_and_b32 v27, 0xffff0000, v66
    v_mul_f32 v26, v26, v65
    v_mul_f32 v27, v27, v65
    v_cvt_pk_bf16_f32 v55, v26, v27
    v_sub_f32 v28, v28, v64
    v_sub_f32 v29, v29, v64
    v_cvt_pk_bf16_f32 v66, v28, v29
    v_lshlrev_b32 v28, 16, v66
    v_and_b32 v29, 0xffff0000, v66
    v_mul_f32 v28, v28, v65
    v_mul_f32 v29, v29, v65
    v_cvt_pk_bf16_f32 v56, v28, v29
    v_sub_f32 v30, v30, v64
    v_sub_f32 v31, v31, v64
    v_cvt_pk_bf16_f32 v66, v30, v31
    v_lshlrev_b32 v30, 16, v66
    v_and_b32 v31, 0xffff0000, v66
    v_mul_f32 v30, v30, v65
    v_mul_f32 v31, v31, v65
    v_cvt_pk_bf16_f32 v57, v30, v31
    v_sub_f32 v32, v32, v64
    v_sub_f32 v33, v33, v64
    v_cvt_pk_bf16_f32 v66, v32, v33
    v_lshlrev_b32 v32, 16, v66
    v_and_b32 v33, 0xffff0000, v66
    v_mul_f32 v32, v32, v65
    v_mul_f32 v33, v33, v65
    v_cvt_pk_bf16_f32 v58, v32, v33
    v_sub_f32 v34, v34, v64
    v_sub_f32 v35, v35, v64
    v_cvt_pk_bf16_f32 v66, v34, v35
    v_lshlrev_b32 v34, 16, v66
    v_and_b32 v35, 0xffff0000, v66
    v_mul_f32 v34, v34, v65
    v_mul_f32 v35, v35, v65
    v_cvt_pk_bf16_f32 v59, v34, v35
    v_sub_f32 v36, v36, v64
    v_sub_f32 v37, v37, v64
    v_cvt_pk_bf16_f32 v66, v36, v37
    v_lshlrev_b32 v36, 16, v66
    v_and_b32 v37, 0xffff0000, v66
    v_mul_f32 v36, v36, v65
    v_mul_f32 v37, v37, v65
    v_cvt_pk_bf16_f32 v60, v36, v37
    v_sub_f32 v38, v38, v64
    v_sub_f32 v39, v39, v64
    v_cvt_pk_bf16_f32 v66, v38, v39
    v_lshlrev_b32 v38, 16, v66
    v_and_b32 v39, 0xffff0000, v66
    v_mul_f32 v38, v38, v65
    v_mul_f32 v39, v39, v65
    v_cvt_pk_bf16_f32 v61, v38, v39
    v_sub_f32 v40, v40, v64
    v_sub_f32 v41, v41, v64
    v_cvt_pk_bf16_f32 v66, v40, v41
    v_lshlrev_b32 v40, 16, v66
    v_and_b32 v41, 0xffff0000, v66
    v_mul_f32 v40, v40, v65
    v_mul_f32 v41, v41, v65
    v_cvt_pk_bf16_f32 v62, v40, v41
    v_sub_f32 v42, v42, v64
    v_sub_f32 v43, v43, v64
    v_cvt_pk_bf16_f32 v66, v42, v43
    v_lshlrev_b32 v42, 16, v66
    v_and_b32 v43, 0xffff0000, v66
    v_mul_f32 v42, v42, v65
    v_mul_f32 v43, v43, v65
    v_cvt_pk_bf16_f32 v63, v42, v43
    s_mov_b32 s46, 20971520
    buffer_store_dwordx4 v[52:55], v4, s[4:7], s46 offen offset:0 sc1
    buffer_store_dwordx4 v[56:59], v4, s[4:7], s46 offen offset:2048 sc1
    s_add_u32 s46, s46, 4096
    buffer_store_dwordx4 v[60:63], v4, s[4:7], s46 offen offset:0 sc1
    s_lshl_b32 s0, s47, 2
    s_add_u32 s0, s0, s20
    s_lshl_b32 s0, s0, 3
    s_add_u32 s0, s0, 3932160
    s_mov_b32 s55, 0
    s_branch L_ln_32
L_w3_31:
    v_lshrrev_b32 v64, 4, v1
    v_bfe_u32 v66, v1, 2, 2
    v_lshl_add_u32 v64, v64, 3, v66
    v_mul_u32_u24 v64, 240, v64
    v_add_u32 v64, s56, v64
    v_and_b32 v66, 3, v1
    v_add_u32 v64, s47, v64
    v_and_b32 v67, 1, v66
    v_mul_u32_u24 v67, 160, v67
    v_lshrrev_b32 v65, 1, v66
    v_mul_u32_u24 v65, 80, v65
    v_add3_u32 v65, v65, v67, v64
    v_cmp_eq_u32 vcc, 3, v66
    s_nop 1
    v_cndmask_b32 v65, v65, v64, vcc
    v_lshl_add_u32 v64, v66, 3, v64
    s_waitcnt vmcnt(1)
    ds_read_b64_tr_b16 v[72:73], v64 offset:0
    ds_read_b64_tr_b16 v[74:75], v64 offset:960
    ds_read_b64_tr_b16 v[76:77], v64 offset:40
    ds_read_b64_tr_b16 v[78:79], v64 offset:1000
    ds_read_b64_tr_b16 v[80:81], v64 offset:80
    ds_read_b64_tr_b16 v[82:83], v64 offset:1040
    ds_read_b64_tr_b16 v[84:85], v64 offset:120
    ds_read_b64_tr_b16 v[86:87], v64 offset:1080
    ds_read_b64_tr_b16 v[88:89], v64 offset:160
    ds_read_b64_tr_b16 v[90:91], v64 offset:1120
    ds_read_b64_tr_b16 v[92:93], v64 offset:200
    ds_read_b64_tr_b16 v[94:95], v64 offset:1160
    ds_read_b64_tr_b16 v[96:97], v65 offset:32
    ds_read_b64_tr_b16 v[98:99], v65 offset:992
    v_and_b32 v66, 15, v1
    v_cmp_gt_u32 vcc, 12, v66
    s_waitcnt lgkmcnt(1)
    s_nop 0
    v_cndmask_b32 v96, 0, v96, vcc
    v_cndmask_b32 v97, 0, v97, vcc
    s_waitcnt lgkmcnt(0)
    v_cndmask_b32 v98, 0, v98, vcc
    v_cndmask_b32 v99, 0, v99, vcc
    s_add_u32 s51, s51, 0
    buffer_store_dwordx4 v[72:75], v2, s[4:7], s51 offen offset:0 sc1
    buffer_store_dwordx4 v[76:79], v2, s[4:7], s51 offen offset:1024 sc1
    buffer_store_dwordx4 v[80:83], v2, s[4:7], s51 offen offset:2048 sc1
    buffer_store_dwordx4 v[84:87], v2, s[4:7], s51 offen offset:3072 sc1
    s_add_u32 s51, s51, 4096
    buffer_store_dwordx4 v[88:91], v2, s[4:7], s51 offen offset:0 sc1
    buffer_store_dwordx4 v[92:95], v2, s[4:7], s51 offen offset:1024 sc1
    buffer_store_dwordx4 v[96:99], v2, s[4:7], s51 offen offset:2048 sc1
    s_cmp_eq_u32 s55, 0
    s_cbranch_scc1 L_ln_32
    s_cmp_eq_u32 s55, 2
    s_cbranch_scc1 L_fw_33
    v_lshrrev_b32 v64, 4, v1
    v_bfe_u32 v66, v1, 2, 2
    v_lshl_add_u32 v64, v64, 3, v66
    v_mul_u32_u24 v64, 240, v64
    v_add_u32 v64, s57, v64
    v_and_b32 v66, 3, v1
    v_add_u32 v64, s87, v64
    v_and_b32 v67, 1, v66
    v_mul_u32_u24 v67, 160, v67
    v_lshrrev_b32 v65, 1, v66
    v_mul_u32_u24 v65, 80, v65
    v_add3_u32 v65, v65, v67, v64
    v_cmp_eq_u32 vcc, 3, v66
    s_nop 1
    v_cndmask_b32 v65, v65, v64, vcc
    v_lshl_add_u32 v64, v66, 3, v64
    s_waitcnt vmcnt(8)
    ds_read_b64_tr_b16 v[100:101], v64 offset:0
    ds_read_b64_tr_b16 v[102:103], v64 offset:960
    ds_read_b64_tr_b16 v[104:105], v64 offset:40
    ds_read_b64_tr_b16 v[106:107], v64 offset:1000
    ds_read_b64_tr_b16 v[108:109], v64 offset:80
    ds_read_b64_tr_b16 v[110:111], v64 offset:1040
    ds_read_b64_tr_b16 v[112:113], v64 offset:120
    ds_read_b64_tr_b16 v[114:115], v64 offset:1080
    ds_read_b64_tr_b16 v[116:117], v64 offset:160
    ds_read_b64_tr_b16 v[118:119], v64 offset:1120
    ds_read_b64_tr_b16 v[120:121], v64 offset:200
    ds_read_b64_tr_b16 v[122:123], v64 offset:1160
    ds_read_b64_tr_b16 v[124:125], v65 offset:32
    ds_read_b64_tr_b16 v[126:127], v65 offset:992
    v_and_b32 v66, 15, v1
    v_cmp_gt_u32 vcc, 12, v66
    s_waitcnt lgkmcnt(1)
    s_nop 0
    v_cndmask_b32 v124, 0, v124, vcc
    v_cndmask_b32 v125, 0, v125, vcc
    s_waitcnt lgkmcnt(0)
    v_cndmask_b32 v126, 0, v126, vcc
    v_cndmask_b32 v127, 0, v127, vcc
    s_add_u32 s91, s91, 0
    buffer_store_dwordx4 v[100:103], v2, s[4:7], s91 offen offset:0 sc1
    buffer_store_dwordx4 v[104:107], v2, s[4:7], s91 offen offset:1024 sc1
    buffer_store_dwordx4 v[108:111], v2, s[4:7], s91 offen offset:2048 sc1
    buffer_store_dwordx4 v[112:115], v2, s[4:7], s91 offen offset:3072 sc1
    s_add_u32 s91, s91, 4096
    buffer_store_dwordx4 v[116:119], v2, s[4:7], s91 offen offset:0 sc1
    buffer_store_dwordx4 v[120:123], v2, s[4:7], s91 offen offset:1024 sc1
    buffer_store_dwordx4 v[124:127], v2, s[4:7], s91 offen offset:2048 sc1
    s_branch L_ln_32
L_fw_33:
    v_lshrrev_b32 v64, 4, v1
    v_bfe_u32 v66, v1, 2, 2
    v_lshl_add_u32 v64, v64, 3, v66
    v_mul_u32_u24 v64, 192, v64
    v_add_u32 v64, s57, v64
    v_and_b32 v66, 3, v1
    v_lshl_add_u32 v64, v66, 4, v64
    s_waitcnt vmcnt(8)
    ds_read_b64_tr_b16 v[100:101], v64 offset:0
    ds_read_b64_tr_b16 v[102:103], v64 offset:768
    ds_read_b64_tr_b16 v[104:105], v64 offset:8
    ds_read_b64_tr_b16 v[106:107], v64 offset:776
    ds_read_b64_tr_b16 v[108:109], v64 offset:64
    ds_read_b64_tr_b16 v[110:111], v64 offset:832
    ds_read_b64_tr_b16 v[112:113], v64 offset:72
    ds_read_b64_tr_b16 v[114:115], v64 offset:840
    ds_read_b64_tr_b16 v[116:117], v64 offset:128
    ds_read_b64_tr_b16 v[118:119], v64 offset:896
    ds_read_b64_tr_b16 v[120:121], v64 offset:136
    ds_read_b64_tr_b16 v[122:123], v64 offset:904
    s_add_u32 s91, s91, 2097152
    s_waitcnt lgkmcnt(10)
    buffer_store_dwordx4 v[100:103], v2, s[4:7], s91 offen offset:0 sc1
    s_waitcnt lgkmcnt(8)
    buffer_store_dwordx4 v[104:107], v2, s[4:7], s91 offen offset:1024 sc1
    s_waitcnt lgkmcnt(6)
    buffer_store_dwordx4 v[108:111], v2, s[4:7], s91 offen offset:2048 sc1
    s_waitcnt lgkmcnt(4)
    buffer_store_dwordx4 v[112:115], v2, s[4:7], s91 offen offset:3072 sc1
    s_add_u32 s91, s91, 4096
    s_waitcnt lgkmcnt(2)
    buffer_store_dwordx4 v[116:119], v2, s[4:7], s91 offen offset:0 sc1
    s_waitcnt lgkmcnt(0)
    buffer_store_dwordx4 v[120:123], v2, s[4:7], s91 offen offset:1024 sc1
L_ln_32:
    s_waitcnt vmcnt(0)
    v_cmp_ne_u64 vcc, 0, v[6:7]
    s_nop 0
    s_cmp_eq_u64 vcc, exec
    s_cbranch_scc0 L_pn_slow_27
L_pn_back_28:
    v_readfirstlane_b32 s98, v6
    v_readfirstlane_b32 s99, v7
    s_nop 0
    v_mov_b32 v6, s98
    v_mov_b32 v7, s99
    s_waitcnt vmcnt(0)
    s_mov_b64 exec, 1
    buffer_store_dwordx2 v[6:7], off, s[4:7], s0 sc1
    s_mov_b64 exec, -1
    s_cmp_eq_u32 s55, 0
    s_cbranch_scc1 L_norole_34
    s_mov_b64 exec, 1
    buffer_store_dwordx2 v[6:7], off, s[4:7], s1 sc1
    s_mov_b64 exec, -1
L_norole_34:
    s_lshr_b32 s44, s22, 4
    s_lshl_b32 s52, s21, 1
    s_add_u32 s44, s44, s52
    s_and_b32 s45, s22, 15
    s_mul_i32 s48, s20, 21
    s_lshr_b32 s48, s48, 1
    s_lshl_b32 s48, s48, 10
    s_mul_i32 s47, s45, 129024
    s_add_u32 s47, s47, s48
    s_add_u32 s47, s47, 0
    s_lshl_b32 s46, s44, 3
    s_max_u32 s52, s46, 1
    s_sub_u32 s52, s52, 1
    s_mul_i32 s49, s52, 18432
    s_mul_i32 s50, s20, 9
    s_lshr_b32 s50, s50, 1
    s_lshl_b32 s50, s50, 10
    s_add_u32 s49, s49, s50
    s_add_u32 s49, s49, 20971520
    s_add_u32 s50, s50, 0
    s_lshl_b32 s54, s52, 6
    s_lshl_b32 s52, s20, 1
    s_add_u32 s46, s46, s52
    s_mul_i32 s51, s46, 18432
    s_add_u32 s51, s51, 20971520
    s_lshl_b32 s55, s46, 6
    v_and_b32 v6, 3, v1
    v_min_u32 v6, 2, v6
    v_and_b32 v7, 12, v1
    v_add_lshl_u32 v8, v6, v7, 3
    v_add_u32 v8, s55, v8
    v_and_b32 v7, 4, v1
    v_add_lshl_u32 v9, v6, v7, 3
    v_add_u32 v9, s54, v9
    v_and_b32 v7, 16, v1
    v_cmp_eq_u32 vcc, 0, v7
    s_nop 1
    v_cndmask_b32 v8, v9, v8, vcc
    v_subrev_u32 v7, 32, v1
    v_min_u32 v7, 17, v7
    s_lshl_b32 s52, s45, 8
    s_add_u32 s52, s52, 131072
    v_lshl_add_u32 v7, v7, 3, s52
    v_cmp_gt_u32 vcc, 32, v1
    s_nop 1
    v_cndmask_b32 v8, v7, v8, vcc
    s_mov_b32 s52, 3932160
    s_min_u32 s56, s20, 2
    s_add_u32 s57, s56, 2
    s_add_u32 s56, s56, 4
    s_cmp_ge_u32 s20, 2
    s_cselect_b32 s57, 6, s57
    s_lshl_b32 s57, s57, 10
    s_lshl_b32 s56, s56, 10
    v_add_u32 v3, 18432, v2
    v_add_u32 v4, s57, v3
    v_add_u32 v5, s56, v3
    v_add_u32 v10, 0, v2
    v_mov_b32 v11, v8
    s_mov_b32 s23, s52
    buffer_load_dwordx2 v[12:13], v11, s[4:7], s23 offen sc1
    v_and_b32 v6, 15, v1
    v_lshrrev_b32 v7, 4, v1
    v_lshlrev_b32 v7, 2, v7
    v_sub_u32 v6, v6, v7
    v_mov_b32 v8, 0xf149f2ca
    s_or_b32 s52, s44, s20
    s_cmp_eq_u32 s52, 0
    s_cselect_b64 s[56:57], -1, 0
    v_subrev_u32 v7, 0, v6
    v_and_b32 v9, 0xfffffff1, v7
    v_cmp_eq_u32 vcc, 0, v9
    v_add_u32 v7, 16, v7
    v_and_b32 v9, 0xfffffff1, v7
    v_cndmask_b32_e64 v168, v8, 0, vcc
    v_cmp_eq_u32 vcc, 0, v9
    s_nop 1
    v_cndmask_b32_e64 v172, v8, 0, vcc
    v_cndmask_b32_e64 v176, v172, v8, s[56:57]
    v_subrev_u32 v7, 1, v6
    v_and_b32 v9, 0xfffffff1, v7
    v_cmp_eq_u32 vcc, 0, v9
    v_add_u32 v7, 16, v7
    v_and_b32 v9, 0xfffffff1, v7
    v_cndmask_b32_e64 v169, v8, 0, vcc
    v_cmp_eq_u32 vcc, 0, v9
    s_nop 1
    v_cndmask_b32_e64 v173, v8, 0, vcc
    v_cndmask_b32_e64 v177, v173, v8, s[56:57]
    v_subrev_u32 v7, 2, v6
    v_and_b32 v9, 0xfffffff1, v7
    v_cmp_eq_u32 vcc, 0, v9
    v_add_u32 v7, 16, v7
    v_and_b32 v9, 0xfffffff1, v7
    v_cndmask_b32_e64 v170, v8, 0, vcc
    v_cmp_eq_u32 vcc, 0, v9
    s_nop 1
    v_cndmask_b32_e64 v174, v8, 0, vcc
    v_cndmask_b32_e64 v178, v174, v8, s[56:57]
    v_subrev_u32 v7, 3, v6
    v_and_b32 v9, 0xfffffff1, v7
    v_cmp_eq_u32 vcc, 0, v9
    v_add_u32 v7, 16, v7
    v_and_b32 v9, 0xfffffff1, v7
    v_cndmask_b32_e64 v171, v8, 0, vcc
    v_cmp_eq_u32 vcc, 0, v9
    s_nop 1
    v_cndmask_b32_e64 v175, v8, 0, vcc
    v_cndmask_b32_e64 v179, v175, v8, s[56:57]
    s_mul_i32 s53, s45, 2304
    s_add_u32 s53, s53, s51
    s_waitcnt vmcnt(0)
    v_cmp_eq_u64 vcc, s[98:99], v[12:13]
    s_nop 0
    s_cmp_eq_u64 vcc, exec
    s_cbranch_scc0 L_px_slow_38
L_px_back_39:
    s_barrier
    s_add_u32 m0, s48, 18432
    s_add_u32 s53, s47, 0
    buffer_load_dwordx4 v2, s[4:7], s53 offen offset:0 lds
    buffer_load_dwordx4 v2, s[4:7], s53 offen offset:1024 lds
    buffer_load_dwordx4 v2, s[4:7], s53 offen offset:2048 lds
    buffer_load_dwordx4 v2, s[4:7], s53 offen offset:3072 lds
    s_add_u32 m0, s48, 22528
    s_add_u32 s53, s47, 4096
    buffer_load_dwordx4 v2, s[4:7], s53 offen offset:0 lds
    buffer_load_dwordx4 v2, s[4:7], s53 offen offset:1024 lds
    buffer_load_dwordx4 v2, s[4:7], s53 offen offset:2048 lds
    buffer_load_dwordx4 v2, s[4:7], s53 offen offset:3072 lds
    s_add_u32 m0, s48, 26624
    s_add_u32 s53, s47, 8192
    buffer_load_dwordx4 v2, s[4:7], s53 offen offset:0 lds
    buffer_load_dwordx4 v2, s[4:7], s53 offen offset:1024 lds
    buffer_load_dwordx4 v2, s[4:7], s53 offen offset:2048 lds
    s_add_u32 s54, s51, 0
    buffer_load_dwordx4 a[0:3], v2, s[4:7], s54 offen offset:0 sc1
    s_add_u32 s55, s51, 18432
    buffer_load_dwordx4 a[72:75], v2, s[4:7], s55 offen offset:0 sc1
    buffer_load_dwordx4 a[4:7], v2, s[4:7], s54 offen offset:1024 sc1
    buffer_load_dwordx4 a[76:79], v2, s[4:7], s55 offen offset:1024 sc1
    buffer_load_dwordx4 a[8:11], v2, s[4:7], s54 offen offset:2048 sc1
    buffer_load_dwordx4 a[80:83], v2, s[4:7], s55 offen offset:2048 sc1
    buffer_load_dwordx4 a[12:15], v2, s[4:7], s54 offen offset:3072 sc1
    buffer_load_dwordx4 a[84:87], v2, s[4:7], s55 offen offset:3072 sc1
    s_add_u32 s54, s51, 4096
    buffer_load_dwordx4 a[16:19], v2, s[4:7], s54 offen offset:0 sc1
    s_add_u32 s55, s51, 22528
    buffer_load_dwordx4 a[88:91], v2, s[4:7], s55 offen offset:0 sc1
    buffer_load_dwordx4 a[20:23], v2, s[4:7], s54 offen offset:1024 sc1
    buffer_load_dwordx4 a[92:95], v2, s[4:7], s55 offen offset:1024 sc1
    s_add_u32 m0, s48, 61440
    s_add_u32 s53, s47, 43008
    buffer_load_dwordx4 v2, s[4:7], s53 offen offset:0 lds
    buffer_load_dwordx4 v2, s[4:7], s53 offen offset:1024 lds
    buffer_load_dwordx4 v2, s[4:7], s53 offen offset:2048 lds
    buffer_load_dwordx4 v2, s[4:7], s53 offen offset:3072 lds
    s_add_u32 m0, s48, 65536
    s_add_u32 s53, s47, 47104
    buffer_load_dwordx4 v2, s[4:7], s53 offen offset:0 lds
    buffer_load_dwordx4 v2, s[4:7], s53 offen offset:1024 lds
    buffer_load_dwordx4 v2, s[4:7], s53 offen offset:2048 lds
    buffer_load_dwordx4 v2, s[4:7], s53 offen offset:3072 lds
    s_add_u32 m0, s48, 69632
    s_add_u32 s53, s47, 51200
    buffer_load_dwordx4 v2, s[4:7], s53 offen offset:0 lds
    buffer_load_dwordx4 v2, s[4:7], s53 offen offset:1024 lds
    buffer_load_dwordx4 v2, s[4:7], s53 offen offset:2048 lds
    s_waitcnt vmcnt(23)
    s_barrier
    ds_read_b128 v[88:91], v3 offset:0
    ds_read_b128 v[92:95], v3 offset:1024
    ds_read_b128 v[96:99], v3 offset:2048
    ds_read_b128 v[100:103], v3 offset:3072
    ds_read_b128 v[112:115], v3 offset:6144
    ds_read_b128 v[104:107], v3 offset:4096
    ds_read_b128 v[108:111], v3 offset:5120
    s_waitcnt vmcnt(22) lgkmcnt(6)
    s_add_u32 m0, s50, 0
    s_add_u32 s53, s49, 0
    v_mfma_f32_16x16x32_bf16 v[16:19], v[88:91], a[0:3], 0
    buffer_load_dwordx4 v2, s[4:7], s53 offen offset:0 sc1 lds
    s_waitcnt vmcnt(22)
    v_mfma_f32_16x16x32_bf16 v[48:51], v[88:91], a[72:75], 0
    s_waitcnt lgkmcnt(5)
    ds_read_b128 v[116:119], v3 offset:7168
    ds_read_b128 v[120:123], v3 offset:8192
    v_mfma_f32_16x16x32_bf16 v[20:23], v[92:95], a[0:3], 0
    v_mfma_f32_16x16x32_bf16 v[52:55], v[92:95], a[72:75], 0
    s_waitcnt lgkmcnt(6)
    ds_read_b128 v[124:127], v3 offset:9216
    v_mfma_f32_16x16x32_bf16 v[24:27], v[96:99], a[0:3], 0
    buffer_load_dwordx4 v2, s[4:7], s53 offen offset:1024 sc1 lds
    v_mfma_f32_16x16x32_bf16 v[56:59], v[96:99], a[72:75], 0
    s_waitcnt lgkmcnt(6)
    ds_read_b128 v[128:131], v3 offset:10240
    v_mfma_f32_16x16x32_bf16 v[28:31], v[100:103], a[0:3], 0
    v_mfma_f32_16x16x32_bf16 v[60:63], v[100:103], a[72:75], 0
    s_waitcnt lgkmcnt(6)
    ds_read_b128 v[140:143], v3 offset:13312
    v_mfma_f32_16x16x32_bf16 v[32:35], v[112:115], a[0:3], 0
    buffer_load_dwordx4 v2, s[4:7], s53 offen offset:2048 sc1 lds
    v_mfma_f32_16x16x32_bf16 v[64:67], v[112:115], a[72:75], 0
    ds_read_b128 v[132:135], v3 offset:11264
    v_mfma_f32_16x16x32_bf16 v[44:47], a[0:3], v[112:115], 0
    v_mfma_f32_16x16x32_bf16 v[76:79], a[72:75], v[112:115], 0
    s_waitcnt lgkmcnt(7)
    ds_read_b128 v[136:139], v3 offset:12288
    v_mfma_f32_16x16x32_bf16 v[36:39], a[0:3], v[104:107], 0
    buffer_load_dwordx4 v2, s[4:7], s53 offen offset:3072 sc1 lds
    v_mfma_f32_16x16x32_bf16 v[68:71], a[72:75], v[104:107], 0
    s_waitcnt lgkmcnt(7)
    s_add_u32 m0, s50, 4096
    s_add_u32 s53, s49, 4096
    v_mfma_f32_16x16x32_bf16 v[40:43], a[0:3], v[108:111], 0
    v_mfma_f32_16x16x32_bf16 v[72:75], a[72:75], v[108:111], 0
    s_waitcnt vmcnt(24) lgkmcnt(6)
    v_mfma_f32_16x16x32_bf16 v[16:19], v[116:119], a[4:7], v[16:19]
    buffer_load_dwordx4 v2, s[4:7], s53 offen offset:0 sc1 lds
    s_waitcnt vmcnt(24)
    v_mfma_f32_16x16x32_bf16 v[48:51], v[116:119], a[76:79], v[48:51]
    s_waitcnt lgkmcnt(5)
    ds_read_b128 v[88:91], v3 offset:14336
    ds_read_b128 v[92:95], v3 offset:15360
    v_mfma_f32_16x16x32_bf16 v[20:23], v[120:123], a[4:7], v[20:23]
    v_mfma_f32_16x16x32_bf16 v[52:55], v[120:123], a[76:79], v[52:55]
    s_waitcnt lgkmcnt(6)
    ds_read_b128 v[96:99], v3 offset:16384
    v_mfma_f32_16x16x32_bf16 v[24:27], v[124:127], a[4:7], v[24:27]
    buffer_load_dwordx4 a[24:27], v2, s[4:7], s54 offen offset:2048 sc1
    v_mfma_f32_16x16x32_bf16 v[56:59], v[124:127], a[76:79], v[56:59]
    s_waitcnt lgkmcnt(6)
    ds_read_b128 v[100:103], v3 offset:17408
    v_mfma_f32_16x16x32_bf16 v[28:31], v[128:131], a[4:7], v[28:31]
    v_mfma_f32_16x16x32_bf16 v[60:63], v[128:131], a[76:79], v[60:63]
    s_waitcnt lgkmcnt(6)
    ds_read_b128 v[112:115], v3 offset:20480
    v_mfma_f32_16x16x32_bf16 v[32:35], v[140:143], a[4:7], v[32:35]
    buffer_load_dwordx4 a[96:99], v2, s[4:7], s55 offen offset:2048 sc1
    v_mfma_f32_16x16x32_bf16 v[64:67], v[140:143], a[76:79], v[64:67]
    ds_read_b128 v[104:107], v3 offset:18432
    v_mfma_f32_16x16x32_bf16 v[44:47], a[4:7], v[140:143], v[44:47]
    v_mfma_f32_16x16x32_bf16 v[76:79], a[76:79], v[140:143], v[76:79]
    s_waitcnt lgkmcnt(7)
    ds_read_b128 v[108:111], v3 offset:19456
    v_mfma_f32_16x16x32_bf16 v[36:39], a[4:7], v[132:135], v[36:39]
    buffer_load_dwordx4 a[28:31], v2, s[4:7], s54 offen offset:3072 sc1
    v_mfma_f32_16x16x32_bf16 v[68:71], a[76:79], v[132:135], v[68:71]
    s_waitcnt lgkmcnt(7)
    v_mfma_f32_16x16x32_bf16 v[40:43], a[4:7], v[136:139], v[40:43]
    v_mfma_f32_16x16x32_bf16 v[72:75], a[76:79], v[136:139], v[72:75]
    s_waitcnt vmcnt(26) lgkmcnt(6)
    v_mfma_f32_16x16x32_bf16 v[16:19], v[88:91], a[8:11], v[16:19]
    buffer_load_dwordx4 a[100:103], v2, s[4:7], s55 offen offset:3072 sc1
    s_waitcnt vmcnt(26)
    v_mfma_f32_16x16x32_bf16 v[48:51], v[88:91], a[80:83], v[48:51]
    s_waitcnt lgkmcnt(5)
    s_add_u32 s54, s51, 8192
    ds_read_b128 v[116:119], v3 offset:21504
    v_mfma_f32_16x16x32_bf16 v[20:23], v[92:95], a[8:11], v[20:23]
    ds_read_b128 v[120:123], v3 offset:22528
    v_mfma_f32_16x16x32_bf16 v[52:55], v[92:95], a[80:83], v[52:55]
    s_waitcnt lgkmcnt(6)
    ds_read_b128 v[124:127], v3 offset:23552
    v_mfma_f32_16x16x32_bf16 v[24:27], v[96:99], a[8:11], v[24:27]
    buffer_load_dwordx4 a[32:35], v2, s[4:7], s54 offen offset:0 sc1
    v_mfma_f32_16x16x32_bf16 v[56:59], v[96:99], a[80:83], v[56:59]
    s_waitcnt lgkmcnt(6)
    s_add_u32 s55, s51, 26624
    ds_read_b128 v[128:131], v3 offset:24576
    v_mfma_f32_16x16x32_bf16 v[28:31], v[100:103], a[8:11], v[28:31]
    v_mfma_f32_16x16x32_bf16 v[60:63], v[100:103], a[80:83], v[60:63]
    s_waitcnt lgkmcnt(6)
    ds_read_b128 v[140:143], v3 offset:27648
    v_mfma_f32_16x16x32_bf16 v[32:35], v[112:115], a[8:11], v[32:35]
    buffer_load_dwordx4 a[104:107], v2, s[4:7], s55 offen offset:0 sc1
    v_mfma_f32_16x16x32_bf16 v[64:67], v[112:115], a[80:83], v[64:67]
    ds_read_b128 v[132:135], v3 offset:25600
    v_mfma_f32_16x16x32_bf16 v[44:47], a[8:11], v[112:115], v[44:47]
    v_mfma_f32_16x16x32_bf16 v[76:79], a[80:83], v[112:115], v[76:79]
    s_waitcnt lgkmcnt(7)
    ds_read_b128 v[136:139], v3 offset:26624
    v_mfma_f32_16x16x32_bf16 v[36:39], a[8:11], v[104:107], v[36:39]
    buffer_load_dwordx4 a[36:39], v2, s[4:7], s54 offen offset:1024 sc1
    v_mfma_f32_16x16x32_bf16 v[68:71], a[80:83], v[104:107], v[68:71]
    s_waitcnt lgkmcnt(7)
    v_mfma_f32_16x16x32_bf16 v[40:43], a[8:11], v[108:111], v[40:43]
    v_mfma_f32_16x16x32_bf16 v[72:75], a[80:83], v[108:111], v[72:75]
    s_waitcnt vmcnt(28) lgkmcnt(6)
    v_mfma_f32_16x16x32_bf16 v[16:19], v[116:119], a[12:15], v[16:19]
    buffer_load_dwordx4 a[108:111], v2, s[4:7], s55 offen offset:1024 sc1
    s_waitcnt vmcnt(28)
    v_mfma_f32_16x16x32_bf16 v[48:51], v[116:119], a[84:87], v[48:51]
    s_waitcnt lgkmcnt(5)
    ds_read_b128 v[88:91], v3 offset:28672
    ds_read_b128 v[92:95], v3 offset:29696
    v_mfma_f32_16x16x32_bf16 v[20:23], v[120:123], a[12:15], v[20:23]
    v_mfma_f32_16x16x32_bf16 v[52:55], v[120:123], a[84:87], v[52:55]
    s_waitcnt lgkmcnt(6)
    ds_read_b128 v[96:99], v3 offset:30720
    v_mfma_f32_16x16x32_bf16 v[24:27], v[124:127], a[12:15], v[24:27]
    buffer_load_dwordx4 a[40:43], v2, s[4:7], s54 offen offset:2048 sc1
    v_mfma_f32_16x16x32_bf16 v[56:59], v[124:127], a[84:87], v[56:59]
    s_waitcnt lgkmcnt(6)
    ds_read_b128 v[100:103], v3 offset:31744
    v_mfma_f32_16x16x32_bf16 v[28:31], v[128:131], a[12:15], v[28:31]
    v_mfma_f32_16x16x32_bf16 v[60:63], v[128:131], a[84:87], v[60:63]
    s_waitcnt lgkmcnt(6)
    ds_read_b128 v[112:115], v3 offset:34816
    v_mfma_f32_16x16x32_bf16 v[32:35], v[140:143], a[12:15], v[32:35]
    buffer_load_dwordx4 a[112:115], v2, s[4:7], s55 offen offset:2048 sc1
    v_mfma_f32_16x16x32_bf16 v[64:67], v[140:143], a[84:87], v[64:67]
    ds_read_b128 v[104:107], v3 offset:32768
    v_mfma_f32_16x16x32_bf16 v[44:47], a[12:15], v[140:143], v[44:47]
    v_mfma_f32_16x16x32_bf16 v[76:79], a[84:87], v[140:143], v[76:79]
    s_waitcnt lgkmcnt(7)
    ds_read_b128 v[108:111], v3 offset:33792
    v_mfma_f32_16x16x32_bf16 v[36:39], a[12:15], v[132:135], v[36:39]
    buffer_load_dwordx4 a[44:47], v2, s[4:7], s54 offen offset:3072 sc1
    v_mfma_f32_16x16x32_bf16 v[68:71], a[84:87], v[132:135], v[68:71]
    s_waitcnt lgkmcnt(7)
    v_mfma_f32_16x16x32_bf16 v[40:43], a[12:15], v[136:139], v[40:43]
    v_mfma_f32_16x16x32_bf16 v[72:75], a[84:87], v[136:139], v[72:75]
    s_waitcnt vmcnt(30) lgkmcnt(6)
    v_mfma_f32_16x16x32_bf16 v[16:19], v[88:91], a[16:19], v[16:19]
    buffer_load_dwordx4 a[116:119], v2, s[4:7], s55 offen offset:3072 sc1
    s_waitcnt vmcnt(30)
    v_mfma_f32_16x16x32_bf16 v[48:51], v[88:91], a[88:91], v[48:51]
    s_waitcnt lgkmcnt(5)
    s_add_u32 m0, s48, 104448
    s_add_u32 s53, s47, 86016
    v_mfma_f32_16x16x32_bf16 v[20:23], v[92:95], a[16:19], v[20:23]
    ds_read_b128 v[116:119], v3 offset:35840
    ds_read_b128 v[120:123], v3 offset:36864
    v_mfma_f32_16x16x32_bf16 v[52:55], v[92:95], a[88:91], v[52:55]
    s_waitcnt lgkmcnt(6)
    ds_read_b128 v[124:127], v3 offset:37888
    v_mfma_f32_16x16x32_bf16 v[24:27], v[96:99], a[16:19], v[24:27]
    buffer_load_dwordx4 v2, s[4:7], s53 offen offset:0 lds
    v_mfma_f32_16x16x32_bf16 v[56:59], v[96:99], a[88:91], v[56:59]
    s_waitcnt lgkmcnt(6)
    ds_read_b128 v[128:131], v3 offset:38912
    v_mfma_f32_16x16x32_bf16 v[28:31], v[100:103], a[16:19], v[28:31]
    v_mfma_f32_16x16x32_bf16 v[60:63], v[100:103], a[88:91], v[60:63]
    s_waitcnt lgkmcnt(6)
    ds_read_b128 v[140:143], v3 offset:41984
    v_mfma_f32_16x16x32_bf16 v[32:35], v[112:115], a[16:19], v[32:35]
    buffer_load_dwordx4 v2, s[4:7], s53 offen offset:1024 lds
    v_mfma_f32_16x16x32_bf16 v[64:67], v[112:115], a[88:91], v[64:67]
    ds_read_b128 v[132:135], v3 offset:39936
    v_mfma_f32_16x16x32_bf16 v[44:47], a[16:19], v[112:115], v[44:47]
    v_mfma_f32_16x16x32_bf16 v[76:79], a[88:91], v[112:115], v[76:79]
    s_waitcnt lgkmcnt(7)
    ds_read_b128 v[136:139], v3 offset:40960
    v_mfma_f32_16x16x32_bf16 v[36:39], a[16:19], v[104:107], v[36:39]
    buffer_load_dwordx4 v2, s[4:7], s53 offen offset:2048 lds
    v_mfma_f32_16x16x32_bf16 v[68:71], a[88:91], v[104:107], v[68:71]
    s_waitcnt lgkmcnt(7)
    v_mfma_f32_16x16x32_bf16 v[40:43], a[16:19], v[108:111], v[40:43]
    v_mfma_f32_16x16x32_bf16 v[72:75], a[88:91], v[108:111], v[72:75]
    s_waitcnt vmcnt(32) lgkmcnt(6)
    v_mfma_f32_16x16x32_bf16 v[16:19], v[116:119], a[20:23], v[16:19]
    s_waitcnt vmcnt(31)
    s_waitcnt vmcnt(20)
    s_waitcnt vmcnt(15)
    s_barrier
    v_mfma_f32_16x16x32_bf16 v[48:51], v[116:119], a[92:95], v[48:51]
    s_waitcnt lgkmcnt(5)
    ds_read_b128 v[88:91], v3 offset:43008
    ds_read_b128 v[92:95], v3 offset:44032
    v_mfma_f32_16x16x32_bf16 v[20:23], v[120:123], a[20:23], v[20:23]
    buffer_load_dwordx4 v2, s[4:7], s53 offen offset:3072 lds
    v_mfma_f32_16x16x32_bf16 v[52:55], v[120:123], a[92:95], v[52:55]
    s_waitcnt lgkmcnt(6)
    s_add_u32 m0, s48, 108544
    s_add_u32 s53, s47, 90112
    v_mfma_f32_16x16x32_bf16 v[24:27], v[124:127], a[20:23], v[24:27]
    ds_read_b128 v[96:99], v3 offset:45056
    ds_read_b128 v[144:147], v10 offset:0
    v_mfma_f32_16x16x32_bf16 v[56:59], v[124:127], a[92:95], v[56:59]
    s_waitcnt lgkmcnt(7)
    ds_read_b128 v[100:103], v3 offset:46080
    ds_read_b128 v[148:151], v4 offset:0
    v_mfma_f32_16x16x32_bf16 v[28:31], v[128:131], a[20:23], v[28:31]
    buffer_load_dwordx4 v2, s[4:7], s53 offen offset:0 lds
    v_mfma_f32_16x16x32_bf16 v[60:63], v[128:131], a[92:95], v[60:63]
    s_waitcnt lgkmcnt(8)
    ds_read_b128 v[112:115], v3 offset:49152
    ds_read_b128 v[152:155], v5 offset:0
    v_mfma_f32_16x16x32_bf16 v[32:35], v[140:143], a[20:23], v[32:35]
    ds_read_b128 v[156:159], v10 offset:1024
    ds_read_b128 v[160:163], v4 offset:7168
    v_mfma_f32_16x16x32_bf16 v[64:67], v[140:143], a[92:95], v[64:67]
    ds_read_b128 v[104:107], v3 offset:47104
    ds_read_b128 v[164:167], v5 offset:7168
    v_mfma_f32_16x16x32_bf16 v[44:47], a[20:23], v[140:143], v[44:47]
    buffer_load_dwordx4 v2, s[4:7], s53 offen offset:1024 lds
    v_mfma_f32_16x16x32_bf16 v[76:79], a[92:95], v[140:143], v[76:79]
    s_waitcnt lgkmcnt(13)
    ds_read_b128 v[108:111], v3 offset:48128
    v_mfma_f32_16x16x32_bf16 v[36:39], a[20:23], v[132:135], v[36:39]
    v_mfma_f32_16x16x32_bf16 v[68:71], a[92:95], v[132:135], v[68:71]
    s_waitcnt lgkmcnt(13)
    v_mfma_f32_16x16x32_bf16 v[40:43], a[20:23], v[136:139], v[40:43]
    buffer_load_dwordx4 v2, s[4:7], s53 offen offset:2048 lds
    v_mfma_f32_16x16x32_bf16 v[72:75], a[92:95], v[136:139], v[72:75]
    s_waitcnt vmcnt(18) lgkmcnt(12)
    v_mfma_f32_16x16x32_bf16 v[16:19], v[88:91], a[24:27], v[16:19]
    s_waitcnt vmcnt(17)
    ds_read_b128 v[116:119], v3 offset:50176
    v_mfma_f32_16x16x32_bf16 v[48:51], v[88:91], a[96:99], v[48:51]
    s_waitcnt lgkmcnt(12)
    ds_read_b128 v[120:123], v3 offset:51200
    v_mfma_f32_16x16x32_bf16 v[20:23], v[92:95], a[24:27], v[20:23]
    buffer_load_dwordx4 v2, s[4:7], s53 offen offset:3072 lds
    v_mfma_f32_16x16x32_bf16 v[52:55], v[92:95], a[96:99], v[52:55]
    s_waitcnt lgkmcnt(12)
    s_add_u32 m0, s48, 112640
    s_add_u32 s53, s47, 94208
    v_mfma_f32_16x16x32_bf16 v[24:27], v[96:99], a[24:27], v[24:27]
    ds_read_b128 v[124:127], v3 offset:52224
    v_mfma_f32_16x16x32_bf16 v[56:59], v[96:99], a[96:99], v[56:59]
    s_waitcnt lgkmcnt(11)
    ds_read_b128 v[128:131], v3 offset:53248
    v_mfma_f32_16x16x32_bf16 v[28:31], v[100:103], a[24:27], v[28:31]
    buffer_load_dwordx4 v2, s[4:7], s53 offen offset:0 lds
    v_mfma_f32_16x16x32_bf16 v[60:63], v[100:103], a[96:99], v[60:63]
    s_waitcnt lgkmcnt(10)
    ds_read_b128 v[140:143], v3 offset:56320
    v_mfma_f32_16x16x32_bf16 v[32:35], v[112:115], a[24:27], v[32:35]
    v_mfma_f32_16x16x32_bf16 v[64:67], v[112:115], a[96:99], v[64:67]
    ds_read_b128 v[132:135], v3 offset:54272
    v_mfma_f32_16x16x32_bf16 v[44:47], a[24:27], v[112:115], v[44:47]
    buffer_load_dwordx4 v2, s[4:7], s53 offen offset:1024 lds
    v_mfma_f32_16x16x32_bf16 v[76:79], a[96:99], v[112:115], v[76:79]
    s_waitcnt lgkmcnt(8)
    ds_read_b128 v[136:139], v3 offset:55296
    v_mfma_f32_16x16x32_bf16 v[36:39], a[24:27], v[104:107], v[36:39]
    v_mfma_f32_16x16x32_bf16 v[68:71], a[96:99], v[104:107], v[68:71]
    s_waitcnt lgkmcnt(7)
    v_mfma_f32_16x16x32_bf16 v[40:43], a[24:27], v[108:111], v[40:43]
    buffer_load_dwordx4 v2, s[4:7], s53 offen offset:2048 lds
    v_mfma_f32_16x16x32_bf16 v[72:75], a[96:99], v[108:111], v[72:75]
    s_add_u32 s54, s51, 12288
    v_mfma_f32_16x16x32_bf16 v[80:83], v[148:151], v[144:147], 0
    v_mfma_f32_16x16x32_bf16 v[84:87], v[144:147], v[152:155], 0
    s_waitcnt vmcnt(20) lgkmcnt(6)
    ds_read_b128 v[144:147], v10 offset:2048
    ds_read_b128 v[148:151], v4 offset:14336
    v_mfma_f32_16x16x32_bf16 v[16:19], v[116:119], a[28:31], v[16:19]
    buffer_load_dwordx4 a[48:51], v2, s[4:7], s54 offen offset:0 sc1
    s_waitcnt vmcnt(20)
    v_mfma_f32_16x16x32_bf16 v[48:51], v[116:119], a[100:103], v[48:51]
    s_waitcnt lgkmcnt(7)
    s_add_u32 s55, s51, 30720
    ds_read_b128 v[88:91], v3 offset:57344
    v_mfma_f32_16x16x32_bf16 v[20:23], v[120:123], a[28:31], v[20:23]
    ds_read_b128 v[92:95], v3 offset:58368
    ds_read_b128 v[152:155], v5 offset:14336
    v_mfma_f32_16x16x32_bf16 v[52:55], v[120:123], a[100:103], v[52:55]
    s_waitcnt lgkmcnt(9)
    ds_read_b128 v[96:99], v3 offset:59392
    v_mfma_f32_16x16x32_bf16 v[24:27], v[124:127], a[28:31], v[24:27]
    buffer_load_dwordx4 a[120:123], v2, s[4:7], s55 offen offset:0 sc1
    v_mfma_f32_16x16x32_bf16 v[56:59], v[124:127], a[100:103], v[56:59]
    s_waitcnt lgkmcnt(9)
    ds_read_b128 v[100:103], v3 offset:60416
    v_mfma_f32_16x16x32_bf16 v[28:31], v[128:131], a[28:31], v[28:31]
    v_mfma_f32_16x16x32_bf16 v[60:63], v[128:131], a[100:103], v[60:63]
    s_waitcnt lgkmcnt(9)
    ds_read_b128 v[112:115], v3 offset:63488
    v_mfma_f32_16x16x32_bf16 v[32:35], v[140:143], a[28:31], v[32:35]
    buffer_load_dwordx4 a[52:55], v2, s[4:7], s54 offen offset:1024 sc1
    v_mfma_f32_16x16x32_bf16 v[64:67], v[140:143], a[100:103], v[64:67]
    ds_read_b128 v[104:107], v3 offset:61440
    v_mfma_f32_16x16x32_bf16 v[44:47], a[28:31], v[140:143], v[44:47]
    v_mfma_f32_16x16x32_bf16 v[76:79], a[100:103], v[140:143], v[76:79]
    s_waitcnt lgkmcnt(10)
    ds_read_b128 v[108:111], v3 offset:62464
    v_mfma_f32_16x16x32_bf16 v[36:39], a[28:31], v[132:135], v[36:39]
    buffer_load_dwordx4 a[124:127], v2, s[4:7], s55 offen offset:1024 sc1
    v_mfma_f32_16x16x32_bf16 v[68:71], a[100:103], v[132:135], v[68:71]
    s_waitcnt lgkmcnt(10)
    v_mfma_f32_16x16x32_bf16 v[40:43], a[28:31], v[136:139], v[40:43]
    v_mfma_f32_16x16x32_bf16 v[72:75], a[100:103], v[136:139], v[72:75]
    v_mfma_f32_16x16x32_bf16 v[80:83], v[160:163], v[156:159], v[80:83]
    v_mfma_f32_16x16x32_bf16 v[84:87], v[156:159], v[164:167], v[84:87]
    s_waitcnt vmcnt(22) lgkmcnt(7)
    ds_read_b128 v[156:159], v10 offset:3072
    ds_read_b128 v[160:163], v4 offset:21504
    v_mfma_f32_16x16x32_bf16 v[16:19], v[88:91], a[32:35], v[16:19]
    buffer_load_dwordx4 a[56:59], v2, s[4:7], s54 offen offset:2048 sc1
    s_waitcnt vmcnt(22)
    v_mfma_f32_16x16x32_bf16 v[48:51], v[88:91], a[104:107], v[48:51]
    s_waitcnt lgkmcnt(8)
    ds_read_b128 v[164:167], v5 offset:21504
    v_add_u32 v3, 64512, v3
    v_mfma_f32_16x16x32_bf16 v[20:23], v[92:95], a[32:35], v[20:23]
    ds_read_b128 v[116:119], v3 offset:0
    v_mfma_f32_16x16x32_bf16 v[52:55], v[92:95], a[104:107], v[52:55]
    s_waitcnt lgkmcnt(8)
    ds_read_b128 v[120:123], v3 offset:1024
    v_mfma_f32_16x16x32_bf16 v[24:27], v[96:99], a[32:35], v[24:27]
    buffer_load_dwordx4 a[128:131], v2, s[4:7], s55 offen offset:2048 sc1
    v_mfma_f32_16x16x32_bf16 v[56:59], v[96:99], a[104:107], v[56:59]
    s_waitcnt lgkmcnt(8)
    ds_read_b128 v[124:127], v3 offset:2048
    v_mfma_f32_16x16x32_bf16 v[28:31], v[100:103], a[32:35], v[28:31]
    v_mfma_f32_16x16x32_bf16 v[60:63], v[100:103], a[104:107], v[60:63]
    s_waitcnt lgkmcnt(8)
    ds_read_b128 v[128:131], v3 offset:3072
    v_mfma_f32_16x16x32_bf16 v[32:35], v[112:115], a[32:35], v[32:35]
    buffer_load_dwordx4 a[60:63], v2, s[4:7], s54 offen offset:3072 sc1
    v_mfma_f32_16x16x32_bf16 v[64:67], v[112:115], a[104:107], v[64:67]
    ds_read_b128 v[140:143], v3 offset:6144
    v_mfma_f32_16x16x32_bf16 v[44:47], a[32:35], v[112:115], v[44:47]
    v_mfma_f32_16x16x32_bf16 v[76:79], a[104:107], v[112:115], v[76:79]
    s_waitcnt lgkmcnt(9)
    ds_read_b128 v[132:135], v3 offset:4096
    v_mfma_f32_16x16x32_bf16 v[36:39], a[32:35], v[104:107], v[36:39]
    buffer_load_dwordx4 a[132:135], v2, s[4:7], s55 offen offset:3072 sc1
    v_mfma_f32_16x16x32_bf16 v[68:71], a[104:107], v[104:107], v[68:71]
    s_waitcnt lgkmcnt(9)
    s_add_u32 s54, s51, 16384
    ds_read_b128 v[136:139], v3 offset:5120
    v_mfma_f32_16x16x32_bf16 v[40:43], a[32:35], v[108:111], v[40:43]
    v_mfma_f32_16x16x32_bf16 v[72:75], a[104:107], v[108:111], v[72:75]
    v_mfma_f32_16x16x32_bf16 v[80:83], v[148:151], v[144:147], v[80:83]
    v_mfma_f32_16x16x32_bf16 v[84:87], v[144:147], v[152:155], v[84:87]
    s_waitcnt vmcnt(24) lgkmcnt(6)
    ds_read_b128 v[144:147], v10 offset:4096
    ds_read_b128 v[148:151], v4 offset:28672
    v_mfma_f32_16x16x32_bf16 v[16:19], v[116:119], a[36:39], v[16:19]
    buffer_load_dwordx4 a[64:67], v2, s[4:7], s54 offen offset:0 sc1
    s_waitcnt vmcnt(24)
    v_mfma_f32_16x16x32_bf16 v[48:51], v[116:119], a[108:111], v[48:51]
    s_waitcnt lgkmcnt(7)
    s_add_u32 s55, s51, 34816
    ds_read_b128 v[88:91], v3 offset:7168
    v_mfma_f32_16x16x32_bf16 v[20:23], v[120:123], a[36:39], v[20:23]
    ds_read_b128 v[92:95], v3 offset:8192
    ds_read_b128 v[152:155], v5 offset:28672
    v_mfma_f32_16x16x32_bf16 v[52:55], v[120:123], a[108:111], v[52:55]
    s_waitcnt lgkmcnt(9)
    ds_read_b128 v[96:99], v3 offset:9216
    v_mfma_f32_16x16x32_bf16 v[24:27], v[124:127], a[36:39], v[24:27]
    buffer_load_dwordx4 a[136:139], v2, s[4:7], s55 offen offset:0 sc1
    v_mfma_f32_16x16x32_bf16 v[56:59], v[124:127], a[108:111], v[56:59]
    s_waitcnt lgkmcnt(9)
    ds_read_b128 v[100:103], v3 offset:10240
    v_mfma_f32_16x16x32_bf16 v[28:31], v[128:131], a[36:39], v[28:31]
    v_mfma_f32_16x16x32_bf16 v[60:63], v[128:131], a[108:111], v[60:63]
    s_waitcnt lgkmcnt(9)
    ds_read_b128 v[112:115], v3 offset:13312
    v_mfma_f32_16x16x32_bf16 v[32:35], v[140:143], a[36:39], v[32:35]
    buffer_load_dwordx4 a[68:71], v2, s[4:7], s54 offen offset:1024 sc1
    v_mfma_f32_16x16x32_bf16 v[64:67], v[140:143], a[108:111], v[64:67]
    ds_read_b128 v[104:107], v3 offset:11264
    v_mfma_f32_16x16x32_bf16 v[44:47], a[36:39], v[140:143], v[44:47]
    v_mfma_f32_16x16x32_bf16 v[76:79], a[108:111], v[140:143], v[76:79]
    s_waitcnt lgkmcnt(10)
    ds_read_b128 v[108:111], v3 offset:12288
    v_mfma_f32_16x16x32_bf16 v[36:39], a[36:39], v[132:135], v[36:39]
    buffer_load_dwordx4 a[140:143], v2, s[4:7], s55 offen offset:1024 sc1
    v_mfma_f32_16x16x32_bf16 v[68:71], a[108:111], v[132:135], v[68:71]
    s_waitcnt lgkmcnt(10)
    v_mfma_f32_16x16x32_bf16 v[40:43], a[36:39], v[136:139], v[40:43]
    v_mfma_f32_16x16x32_bf16 v[72:75], a[108:111], v[136:139], v[72:75]
    v_mfma_f32_16x16x32_bf16 v[80:83], v[160:163], v[156:159], v[80:83]
    v_mfma_f32_16x16x32_bf16 v[84:87], v[156:159], v[164:167], v[84:87]
    s_waitcnt vmcnt(26) lgkmcnt(7)
    ds_read_b128 v[156:159], v10 offset:5120
    ds_read_b128 v[160:163], v4 offset:35840
    v_mfma_f32_16x16x32_bf16 v[16:19], v[88:91], a[40:43], v[16:19]
    buffer_load_dwordx4 a[144:147], v229, s[16:19], 0 offen nt
    s_waitcnt vmcnt(26)
    v_mfma_f32_16x16x32_bf16 v[48:51], v[88:91], a[112:115], v[48:51]
    s_waitcnt lgkmcnt(8)
    ds_read_b128 v[116:119], v3 offset:14336
    ds_read_b128 v[120:123], v3 offset:15360
    v_mfma_f32_16x16x32_bf16 v[20:23], v[92:95], a[40:43], v[20:23]
    ds_read_b128 v[164:167], v5 offset:35840
    v_mfma_f32_16x16x32_bf16 v[52:55], v[92:95], a[112:115], v[52:55]
    s_waitcnt lgkmcnt(9)
    ds_read_b128 v[124:127], v3 offset:16384
    v_mfma_f32_16x16x32_bf16 v[24:27], v[96:99], a[40:43], v[24:27]
    buffer_load_dwordx4 a[148:151], v230, s[16:19], 0 offen nt
    v_mfma_f32_16x16x32_bf16 v[56:59], v[96:99], a[112:115], v[56:59]
    s_waitcnt lgkmcnt(9)
    ds_read_b128 v[128:131], v3 offset:17408
    v_mfma_f32_16x16x32_bf16 v[28:31], v[100:103], a[40:43], v[28:31]
    v_mfma_f32_16x16x32_bf16 v[60:63], v[100:103], a[112:115], v[60:63]
    s_waitcnt lgkmcnt(9)
    ds_read_b128 v[140:143], v3 offset:20480
    v_mfma_f32_16x16x32_bf16 v[32:35], v[112:115], a[40:43], v[32:35]
    buffer_load_dwordx4 a[152:155], v231, s[16:19], 0 offen nt
    v_mfma_f32_16x16x32_bf16 v[64:67], v[112:115], a[112:115], v[64:67]
    ds_read_b128 v[132:135], v3 offset:18432
    v_mfma_f32_16x16x32_bf16 v[44:47], a[40:43], v[112:115], v[44:47]
    v_mfma_f32_16x16x32_bf16 v[76:79], a[112:115], v[112:115], v[76:79]
    s_waitcnt lgkmcnt(10)
    ds_read_b128 v[136:139], v3 offset:19456
    v_mfma_f32_16x16x32_bf16 v[36:39], a[40:43], v[104:107], v[36:39]
    buffer_load_dwordx4 a[156:159], v232, s[16:19], 0 offen nt
    v_mfma_f32_16x16x32_bf16 v[68:71], a[112:115], v[104:107], v[68:71]
    s_waitcnt lgkmcnt(10)
    v_mfma_f32_16x16x32_bf16 v[40:43], a[40:43], v[108:111], v[40:43]
    v_mfma_f32_16x16x32_bf16 v[72:75], a[112:115], v[108:111], v[72:75]
    v_mfma_f32_16x16x32_bf16 v[80:83], v[148:151], v[144:147], v[80:83]
    v_mfma_f32_16x16x32_bf16 v[84:87], v[144:147], v[152:155], v[84:87]
    s_waitcnt vmcnt(28) lgkmcnt(7)
    ds_read_b128 v[144:147], v10 offset:6144
    ds_read_b128 v[148:151], v4 offset:43008
    v_mfma_f32_16x16x32_bf16 v[16:19], v[116:119], a[44:47], v[16:19]
    s_waitcnt vmcnt(27)
    s_waitcnt vmcnt(16)
    s_barrier
    ds_read_b128 v[88:91], v3 offset:21504
    v_mfma_f32_16x16x32_bf16 v[48:51], v[116:119], a[116:119], v[48:51]
    s_waitcnt lgkmcnt(9)
    ds_read_b128 v[92:95], v3 offset:22528
    ds_read_b128 v[152:155], v5 offset:43008
    v_mfma_f32_16x16x32_bf16 v[20:23], v[120:123], a[44:47], v[20:23]
    buffer_load_dwordx4 a[160:163], v233, s[16:19], 0 offen nt
    v_mfma_f32_16x16x32_bf16 v[52:55], v[120:123], a[116:119], v[52:55]
    s_waitcnt lgkmcnt(9)
    ds_read_b128 v[96:99], v3 offset:23552
    v_mfma_f32_16x16x32_bf16 v[24:27], v[124:127], a[44:47], v[24:27]
    v_mfma_f32_16x16x32_bf16 v[56:59], v[124:127], a[116:119], v[56:59]
    s_waitcnt lgkmcnt(9)
    ds_read_b128 v[100:103], v3 offset:24576
    v_mfma_f32_16x16x32_bf16 v[28:31], v[128:131], a[44:47], v[28:31]
    buffer_load_dwordx4 a[164:167], v234, s[16:19], 0 offen nt
    v_mfma_f32_16x16x32_bf16 v[60:63], v[128:131], a[116:119], v[60:63]
    s_waitcnt lgkmcnt(9)
    ds_read_b128 v[112:115], v3 offset:27648
    v_mfma_f32_16x16x32_bf16 v[32:35], v[140:143], a[44:47], v[32:35]
    v_mfma_f32_16x16x32_bf16 v[64:67], v[140:143], a[116:119], v[64:67]
    ds_read_b128 v[104:107], v3 offset:25600
    v_mfma_f32_16x16x32_bf16 v[44:47], a[44:47], v[140:143], v[44:47]
    buffer_load_dwordx4 a[168:171], v235, s[16:19], 0 offen nt
    v_mfma_f32_16x16x32_bf16 v[76:79], a[116:119], v[140:143], v[76:79]
    s_waitcnt lgkmcnt(10)
    ds_read_b128 v[108:111], v3 offset:26624
    v_mfma_f32_16x16x32_bf16 v[36:39], a[44:47], v[132:135], v[36:39]
    v_mfma_f32_16x16x32_bf16 v[68:71], a[116:119], v[132:135], v[68:71]
    s_waitcnt lgkmcnt(10)
    v_mfma_f32_16x16x32_bf16 v[40:43], a[44:47], v[136:139], v[40:43]
    buffer_load_dwordx4 a[172:175], v236, s[16:19], 0 offen nt
    v_mfma_f32_16x16x32_bf16 v[72:75], a[116:119], v[136:139], v[72:75]
    v_mfma_f32_16x16x32_bf16 v[80:83], v[160:163], v[156:159], v[80:83]
    v_mfma_f32_16x16x32_bf16 v[84:87], v[156:159], v[164:167], v[84:87]
    s_waitcnt vmcnt(19) lgkmcnt(7)
    ds_read_b128 v[156:159], v10 offset:7168
    ds_read_b128 v[160:163], v4 offset:50176
    v_mfma_f32_16x16x32_bf16 v[16:19], v[88:91], a[48:51], v[16:19]
    buffer_load_dwordx4 a[176:179], v237, s[16:19], 0 offen nt
    s_waitcnt vmcnt(19)
    v_mfma_f32_16x16x32_bf16 v[48:51], v[88:91], a[120:123], v[48:51]
    s_waitcnt lgkmcnt(8)
    ds_read_b128 v[164:167], v5 offset:50176
    ds_read_b128 v[116:119], v3 offset:28672
    v_mfma_f32_16x16x32_bf16 v[20:23], v[92:95], a[48:51], v[20:23]
    ds_read_b128 v[120:123], v3 offset:29696
    v_mfma_f32_16x16x32_bf16 v[52:55], v[92:95], a[120:123], v[52:55]
    s_waitcnt lgkmcnt(9)
    ds_read_b128 v[124:127], v3 offset:30720
    v_mfma_f32_16x16x32_bf16 v[24:27], v[96:99], a[48:51], v[24:27]
    buffer_load_dwordx4 a[180:183], v238, s[12:15], 0 offen nt
    v_mfma_f32_16x16x32_bf16 v[56:59], v[96:99], a[120:123], v[56:59]
    s_waitcnt lgkmcnt(9)
    ds_read_b128 v[128:131], v3 offset:31744
    v_mfma_f32_16x16x32_bf16 v[28:31], v[100:103], a[48:51], v[28:31]
    v_mfma_f32_16x16x32_bf16 v[60:63], v[100:103], a[120:123], v[60:63]
    ds_read_b128 v[140:143], v3 offset:34816
    v_mfma_f32_16x16x32_bf16 v[80:83], v[148:151], v[144:147], v[80:83]
    v_mfma_f32_16x16x32_bf16 v[84:87], v[144:147], v[152:155], v[84:87]
    s_waitcnt lgkmcnt(10)
    ds_read_b128 v[132:135], v3 offset:32768
    ds_read_b128 v[144:147], v10 offset:8192
    v_mfma_f32_16x16x32_bf16 v[32:35], v[112:115], a[48:51], v[32:35]
    buffer_load_dwordx4 a[184:187], v239, s[12:15], 0 offen nt
    v_mfma_f32_16x16x32_bf16 v[64:67], v[112:115], a[120:123], v[64:67]
    ds_read_b128 v[136:139], v3 offset:33792
    ds_read_b128 v[148:151], v4 offset:57344
    v_mfma_f32_16x16x32_bf16 v[44:47], a[48:51], v[112:115], v[44:47]
    ds_read_b128 v[152:155], v5 offset:57344
    v_mfma_f32_16x16x32_bf16 v[76:79], a[120:123], v[112:115], v[76:79]
    s_waitcnt lgkmcnt(14)
    v_mfma_f32_16x16x32_bf16 v[36:39], a[48:51], v[104:107], v[36:39]
    buffer_load_dwordx4 a[188:191], v240, s[12:15], 0 offen nt
    v_mfma_f32_16x16x32_bf16 v[68:71], a[120:123], v[104:107], v[68:71]
    s_waitcnt lgkmcnt(13)
    v_mfma_f32_16x16x32_bf16 v[40:43], a[48:51], v[108:111], v[40:43]
    v_mfma_f32_16x16x32_bf16 v[72:75], a[120:123], v[108:111], v[72:75]
    s_waitcnt lgkmcnt(11)
    v_mfma_f32_16x16x32_bf16 v[80:83], v[160:163], v[156:159], v[80:83]
    s_waitcnt lgkmcnt(10)
    v_mfma_f32_16x16x32_bf16 v[84:87], v[156:159], v[164:167], v[84:87]
    s_waitcnt vmcnt(21) lgkmcnt(9)
    v_add_u32 v4, 64512, v4
    v_add_u32 v5, 64512, v5
    v_mfma_f32_16x16x32_bf16 v[16:19], v[116:119], a[52:55], v[16:19]
    buffer_load_dwordx4 a[192:195], v241, s[12:15], 0 offen nt
    s_waitcnt vmcnt(21)
    v_mfma_f32_16x16x32_bf16 v[48:51], v[116:119], a[124:127], v[48:51]
    s_waitcnt lgkmcnt(8)
    ds_read_b128 v[156:159], v10 offset:9216
    ds_read_b128 v[160:163], v4 offset:0
    v_mfma_f32_16x16x32_bf16 v[20:23], v[120:123], a[52:55], v[20:23]
    ds_read_b128 v[164:167], v5 offset:0
    ds_read_b128 v[88:91], v3 offset:35840
    v_mfma_f32_16x16x32_bf16 v[52:55], v[120:123], a[124:127], v[52:55]
    s_waitcnt lgkmcnt(11)
    ds_read_b128 v[92:95], v3 offset:36864
    ds_read_b128 v[96:99], v3 offset:37888
    v_mfma_f32_16x16x32_bf16 v[24:27], v[124:127], a[52:55], v[24:27]
    buffer_load_dwordx4 a[196:199], v242, s[12:15], 0 offen nt
    v_mfma_f32_16x16x32_bf16 v[56:59], v[124:127], a[124:127], v[56:59]
    s_waitcnt lgkmcnt(12)
    ds_read_b128 v[100:103], v3 offset:38912
    v_mfma_f32_16x16x32_bf16 v[28:31], v[128:131], a[52:55], v[28:31]
    v_mfma_f32_16x16x32_bf16 v[60:63], v[128:131], a[124:127], v[60:63]
    s_waitcnt lgkmcnt(8)
    ds_read_b128 v[112:115], v3 offset:41984
    v_mfma_f32_16x16x32_bf16 v[80:83], v[148:151], v[144:147], v[80:83]
    s_waitcnt lgkmcnt(8)
    v_mfma_f32_16x16x32_bf16 v[84:87], v[144:147], v[152:155], v[84:87]
    ds_read_b128 v[104:107], v3 offset:39936
    ds_read_b128 v[144:147], v10 offset:10240
    v_mfma_f32_16x16x32_bf16 v[32:35], v[140:143], a[52:55], v[32:35]
    buffer_load_dwordx4 a[200:203], v243, s[12:15], 0 offen nt
    v_mfma_f32_16x16x32_bf16 v[64:67], v[140:143], a[124:127], v[64:67]
    ds_read_b128 v[108:111], v3 offset:40960
    ds_read_b128 v[148:151], v4 offset:7168
    v_mfma_f32_16x16x32_bf16 v[44:47], a[52:55], v[140:143], v[44:47]
    ds_read_b128 v[152:155], v5 offset:7168
    v_mfma_f32_16x16x32_bf16 v[76:79], a[124:127], v[140:143], v[76:79]
    v_mfma_f32_16x16x32_bf16 v[36:39], a[52:55], v[132:135], v[36:39]
    buffer_load_dwordx4 a[204:207], v244, s[12:15], 0 offen nt
    v_mfma_f32_16x16x32_bf16 v[68:71], a[124:127], v[132:135], v[68:71]
    v_mfma_f32_16x16x32_bf16 v[40:43], a[52:55], v[136:139], v[40:43]
    v_mfma_f32_16x16x32_bf16 v[72:75], a[124:127], v[136:139], v[72:75]
    s_waitcnt lgkmcnt(11)
    v_mfma_f32_16x16x32_bf16 v[80:83], v[160:163], v[156:159], v[80:83]
    s_waitcnt lgkmcnt(10)
    v_mfma_f32_16x16x32_bf16 v[84:87], v[156:159], v[164:167], v[84:87]
    s_waitcnt vmcnt(23) lgkmcnt(9)
    ds_read_b128 v[156:159], v10 offset:11264
    ds_read_b128 v[160:163], v4 offset:14336
    v_mfma_f32_16x16x32_bf16 v[16:19], v[88:91], a[56:59], v[16:19]
    buffer_load_dwordx4 a[208:211], v245, s[12:15], 0 offen nt
    s_waitcnt vmcnt(23)
    v_mfma_f32_16x16x32_bf16 v[48:51], v[88:91], a[128:131], v[48:51]
    s_waitcnt lgkmcnt(10)
    ds_read_b128 v[164:167], v5 offset:14336
    ds_read_b128 v[116:119], v3 offset:43008
    v_mfma_f32_16x16x32_bf16 v[20:23], v[92:95], a[56:59], v[20:23]
    ds_read_b128 v[120:123], v3 offset:44032
    v_mfma_f32_16x16x32_bf16 v[52:55], v[92:95], a[128:131], v[52:55]
    s_waitcnt lgkmcnt(12)
    ds_read_b128 v[124:127], v3 offset:45056
    v_mfma_f32_16x16x32_bf16 v[24:27], v[96:99], a[56:59], v[24:27]
    buffer_load_dwordx4 a[212:215], v246, s[12:15], 0 offen nt
    v_mfma_f32_16x16x32_bf16 v[56:59], v[96:99], a[128:131], v[56:59]
    s_waitcnt lgkmcnt(12)
    ds_read_b128 v[128:131], v3 offset:46080
    v_mfma_f32_16x16x32_bf16 v[28:31], v[100:103], a[56:59], v[28:31]
    v_mfma_f32_16x16x32_bf16 v[60:63], v[100:103], a[128:131], v[60:63]
    s_waitcnt lgkmcnt(8)
    ds_read_b128 v[140:143], v3 offset:49152
    v_mfma_f32_16x16x32_bf16 v[80:83], v[148:151], v[144:147], v[80:83]
    s_waitcnt lgkmcnt(8)
    v_mfma_f32_16x16x32_bf16 v[84:87], v[144:147], v[152:155], v[84:87]
    ds_read_b128 v[132:135], v3 offset:47104
    ds_read_b128 v[144:147], v10 offset:12288
    v_mfma_f32_16x16x32_bf16 v[32:35], v[112:115], a[56:59], v[32:35]
    buffer_load_dwordx4 a[216:219], v247, s[8:11], 0 offen nt
    v_mfma_f32_16x16x32_bf16 v[64:67], v[112:115], a[128:131], v[64:67]
    ds_read_b128 v[136:139], v3 offset:48128
    ds_read_b128 v[148:151], v4 offset:21504
    v_mfma_f32_16x16x32_bf16 v[44:47], a[56:59], v[112:115], v[44:47]
    ds_read_b128 v[152:155], v5 offset:21504
    v_mfma_f32_16x16x32_bf16 v[76:79], a[128:131], v[112:115], v[76:79]
    v_mfma_f32_16x16x32_bf16 v[36:39], a[56:59], v[104:107], v[36:39]
    buffer_load_dwordx4 a[220:223], v248, s[8:11], 0 offen nt
    v_mfma_f32_16x16x32_bf16 v[68:71], a[128:131], v[104:107], v[68:71]
    v_mfma_f32_16x16x32_bf16 v[40:43], a[56:59], v[108:111], v[40:43]
    v_mfma_f32_16x16x32_bf16 v[72:75], a[128:131], v[108:111], v[72:75]
    s_waitcnt lgkmcnt(11)
    v_mfma_f32_16x16x32_bf16 v[80:83], v[160:163], v[156:159], v[80:83]
    s_waitcnt lgkmcnt(10)
    v_mfma_f32_16x16x32_bf16 v[84:87], v[156:159], v[164:167], v[84:87]
    s_waitcnt vmcnt(25) lgkmcnt(9)
    ds_read_b128 v[156:159], v10 offset:13312
    ds_read_b128 v[160:163], v4 offset:28672
    v_mfma_f32_16x16x32_bf16 v[16:19], v[116:119], a[60:63], v[16:19]
    buffer_load_dwordx4 a[224:227], v249, s[8:11], 0 offen nt
    s_waitcnt vmcnt(25)
    v_mfma_f32_16x16x32_bf16 v[48:51], v[116:119], a[132:135], v[48:51]
    s_waitcnt lgkmcnt(10)
    ds_read_b128 v[164:167], v5 offset:28672
    ds_read_b128 v[88:91], v3 offset:50176
    v_mfma_f32_16x16x32_bf16 v[20:23], v[120:123], a[60:63], v[20:23]
    ds_read_b128 v[92:95], v3 offset:51200
    v_mfma_f32_16x16x32_bf16 v[52:55], v[120:123], a[132:135], v[52:55]
    s_waitcnt lgkmcnt(12)
    ds_read_b128 v[96:99], v3 offset:52224
    v_mfma_f32_16x16x32_bf16 v[24:27], v[124:127], a[60:63], v[24:27]
    buffer_load_dwordx4 a[228:231], v250, s[8:11], 0 offen nt
    v_mfma_f32_16x16x32_bf16 v[56:59], v[124:127], a[132:135], v[56:59]
    s_waitcnt lgkmcnt(12)
    ds_read_b128 v[100:103], v3 offset:53248
    v_mfma_f32_16x16x32_bf16 v[28:31], v[128:131], a[60:63], v[28:31]
    v_mfma_f32_16x16x32_bf16 v[60:63], v[128:131], a[132:135], v[60:63]
    s_waitcnt lgkmcnt(8)
    ds_read_b128 v[112:115], v3 offset:56320
    v_mfma_f32_16x16x32_bf16 v[80:83], v[148:151], v[144:147], v[80:83]
    s_waitcnt lgkmcnt(8)
    v_mfma_f32_16x16x32_bf16 v[84:87], v[144:147], v[152:155], v[84:87]
    ds_read_b128 v[104:107], v3 offset:54272
    ds_read_b128 v[144:147], v10 offset:14336
    v_mfma_f32_16x16x32_bf16 v[32:35], v[140:143], a[60:63], v[32:35]
    buffer_load_dwordx4 a[232:235], v251, s[8:11], 0 offen nt
    v_mfma_f32_16x16x32_bf16 v[64:67], v[140:143], a[132:135], v[64:67]
    ds_read_b128 v[108:111], v3 offset:55296
    ds_read_b128 v[148:151], v4 offset:35840
    v_mfma_f32_16x16x32_bf16 v[44:47], a[60:63], v[140:143], v[44:47]
    ds_read_b128 v[152:155], v5 offset:35840
    v_mfma_f32_16x16x32_bf16 v[76:79], a[132:135], v[140:143], v[76:79]
    v_mfma_f32_16x16x32_bf16 v[36:39], a[60:63], v[132:135], v[36:39]
    buffer_load_dwordx4 a[236:239], v252, s[8:11], 0 offen nt
    v_mfma_f32_16x16x32_bf16 v[68:71], a[132:135], v[132:135], v[68:71]
    v_mfma_f32_16x16x32_bf16 v[40:43], a[60:63], v[136:139], v[40:43]
    v_mfma_f32_16x16x32_bf16 v[72:75], a[132:135], v[136:139], v[72:75]
    s_waitcnt lgkmcnt(11)
    v_mfma_f32_16x16x32_bf16 v[80:83], v[160:163], v[156:159], v[80:83]
    s_waitcnt lgkmcnt(10)
    v_mfma_f32_16x16x32_bf16 v[84:87], v[156:159], v[164:167], v[84:87]
    s_waitcnt vmcnt(27) lgkmcnt(9)
    ds_read_b128 v[156:159], v10 offset:15360
    ds_read_b128 v[160:163], v4 offset:43008
    v_mfma_f32_16x16x32_bf16 v[16:19], v[88:91], a[64:67], v[16:19]
    buffer_load_dwordx4 a[240:243], v253, s[8:11], 0 offen nt
    s_waitcnt vmcnt(27)
    v_mfma_f32_16x16x32_bf16 v[48:51], v[88:91], a[136:139], v[48:51]
    s_waitcnt lgkmcnt(10)
    ds_read_b128 v[164:167], v5 offset:43008
    ds_read_b128 v[116:119], v3 offset:57344
    v_mfma_f32_16x16x32_bf16 v[20:23], v[92:95], a[64:67], v[20:23]
    ds_read_b128 v[120:123], v3 offset:58368
    v_mfma_f32_16x16x32_bf16 v[52:55], v[92:95], a[136:139], v[52:55]
    s_waitcnt lgkmcnt(12)
    ds_read_b128 v[124:127], v3 offset:59392
    v_mfma_f32_16x16x32_bf16 v[24:27], v[96:99], a[64:67], v[24:27]
    buffer_load_dwordx4 a[244:247], v254, s[8:11], 0 offen nt
    v_mfma_f32_16x16x32_bf16 v[56:59], v[96:99], a[136:139], v[56:59]
    s_waitcnt lgkmcnt(12)
    ds_read_b128 v[128:131], v3 offset:60416
    v_mfma_f32_16x16x32_bf16 v[28:31], v[100:103], a[64:67], v[28:31]
    v_mfma_f32_16x16x32_bf16 v[60:63], v[100:103], a[136:139], v[60:63]
    s_waitcnt lgkmcnt(8)
    ds_read_b128 v[140:143], v3 offset:63488
    v_mfma_f32_16x16x32_bf16 v[80:83], v[148:151], v[144:147], v[80:83]
    s_waitcnt lgkmcnt(8)
    v_mfma_f32_16x16x32_bf16 v[84:87], v[144:147], v[152:155], v[84:87]
    ds_read_b128 v[132:135], v3 offset:61440
    ds_read_b128 v[144:147], v10 offset:16384
    v_mfma_f32_16x16x32_bf16 v[32:35], v[112:115], a[64:67], v[32:35]
    buffer_load_dwordx4 a[248:251], v255, s[8:11], 0 offen nt
    v_mfma_f32_16x16x32_bf16 v[64:67], v[112:115], a[136:139], v[64:67]
    ds_read_b128 v[136:139], v3 offset:62464
    ds_read_b128 v[148:151], v4 offset:50176
    v_mfma_f32_16x16x32_bf16 v[44:47], a[64:67], v[112:115], v[44:47]
    ds_read_b128 v[152:155], v5 offset:50176
    v_mfma_f32_16x16x32_bf16 v[76:79], a[136:139], v[112:115], v[76:79]
    v_mfma_f32_16x16x32_bf16 v[36:39], a[64:67], v[104:107], v[36:39]
    v_mfma_f32_16x16x32_bf16 v[68:71], a[136:139], v[104:107], v[68:71]
    v_mfma_f32_16x16x32_bf16 v[40:43], a[64:67], v[108:111], v[40:43]
    v_mfma_f32_16x16x32_bf16 v[72:75], a[136:139], v[108:111], v[72:75]
    s_waitcnt lgkmcnt(11)
    v_mfma_f32_16x16x32_bf16 v[80:83], v[160:163], v[156:159], v[80:83]
    s_waitcnt lgkmcnt(10)
    v_mfma_f32_16x16x32_bf16 v[84:87], v[156:159], v[164:167], v[84:87]
    s_waitcnt vmcnt(28) lgkmcnt(9)
    ds_read_b128 v[156:159], v10 offset:17408
    ds_read_b128 v[160:163], v4 offset:57344
    v_mfma_f32_16x16x32_bf16 v[16:19], v[116:119], a[68:71], v[16:19]
    s_waitcnt vmcnt(27)
    ds_read_b128 v[164:167], v5 offset:57344
    v_mfma_f32_16x16x32_bf16 v[48:51], v[116:119], a[140:143], v[48:51]
    s_waitcnt lgkmcnt(11)
    v_mfma_f32_16x16x32_bf16 v[20:23], v[120:123], a[68:71], v[20:23]
    v_mfma_f32_16x16x32_bf16 v[52:55], v[120:123], a[140:143], v[52:55]
    s_waitcnt lgkmcnt(10)
    v_mfma_f32_16x16x32_bf16 v[24:27], v[124:127], a[68:71], v[24:27]
    v_mfma_f32_16x16x32_bf16 v[56:59], v[124:127], a[140:143], v[56:59]
    s_waitcnt lgkmcnt(9)
    v_mfma_f32_16x16x32_bf16 v[28:31], v[128:131], a[68:71], v[28:31]
    v_mfma_f32_16x16x32_bf16 v[60:63], v[128:131], a[140:143], v[60:63]
    s_waitcnt lgkmcnt(4)
    v_mfma_f32_16x16x32_bf16 v[80:83], v[148:151], v[144:147], v[80:83]
    s_waitcnt lgkmcnt(3)
    v_mfma_f32_16x16x32_bf16 v[84:87], v[144:147], v[152:155], v[84:87]
    v_mfma_f32_16x16x32_bf16 v[32:35], v[140:143], a[68:71], v[32:35]
    v_mfma_f32_16x16x32_bf16 v[64:67], v[140:143], a[140:143], v[64:67]
    v_mfma_f32_16x16x32_bf16 v[44:47], a[68:71], v[140:143], v[44:47]
    v_mfma_f32_16x16x32_bf16 v[76:79], a[140:143], v[140:143], v[76:79]
    v_mfma_f32_16x16x32_bf16 v[36:39], a[68:71], v[132:135], v[36:39]
    v_mfma_f32_16x16x32_bf16 v[68:71], a[140:143], v[132:135], v[68:71]
    v_mfma_f32_16x16x32_bf16 v[40:43], a[68:71], v[136:139], v[40:43]
    v_mfma_f32_16x16x32_bf16 v[72:75], a[140:143], v[136:139], v[72:75]
    s_waitcnt lgkmcnt(1)
    v_mfma_f32_16x16x32_bf16 v[80:83], v[160:163], v[156:159], v[80:83]
    s_waitcnt lgkmcnt(0)
    v_mfma_f32_16x16x32_bf16 v[84:87], v[156:159], v[164:167], v[84:87]
    v_lshlrev_b32 v6, 3, v1
    v_add_u32 v6, 148608, v6
    s_mul_i32 s52, s20, 3072
    v_add_u32 v7, s52, v6
    v_cvt_pk_bf16_f32 v100, v56, v57
    v_cvt_pk_bf16_f32 v101, v58, v59
    v_cvt_pk_bf16_f32 v104, v60, v61
    v_cvt_pk_bf16_f32 v105, v62, v63
    v_cvt_pk_bf16_f32 v134, v64, v65
    v_cvt_pk_bf16_f32 v137, v66, v67
    v_mov_b32 v102, 0
    v_mov_b32 v103, 0
    v_cvt_pk_bf16_f32 v110, v68, v69
    v_cvt_pk_bf16_f32 v111, v70, v71
    v_cvt_pk_bf16_f32 v116, v72, v73
    v_cvt_pk_bf16_f32 v117, v74, v75
    v_cvt_pk_bf16_f32 v122, v76, v77
    v_cvt_pk_bf16_f32 v123, v78, v79
    v_permlane32_swap_b32 v134, v102
    v_permlane32_swap_b32 v137, v103
    s_cmp_eq_u32 s20, 3
    s_cbranch_scc1 L_w3_41
    ds_write_b64 v7, v[100:101] offset:3072
    ds_write_b64 v7, v[102:103] offset:3584
    ds_write_b64 v7, v[104:105] offset:4096
    ds_write_b64 v7, v[110:111] offset:4608
    ds_write_b64 v7, v[116:117] offset:5120
    ds_write_b64 v7, v[122:123] offset:5632
L_w3_41:
    v_cvt_pk_bf16_f32 v140, v80, v81
    v_cvt_pk_bf16_f32 v141, v82, v83
    v_cvt_pk_bf16_f32 v142, v84, v85
    v_cvt_pk_bf16_f32 v143, v86, v87
    s_min_u32 s52, s20, 2
    s_lshl_b32 s53, s52, 1
    s_cmp_ge_u32 s20, 2
    s_cselect_b32 s53, 1, s53
    s_lshl_b32 s53, s53, 9
    s_add_u32 s52, s52, 3
    s_lshl_b32 s52, s52, 9
    v_add_u32 v8, s53, v6
    v_add_u32 v9, s52, v6
    s_cmp_lt_u32 s20, 2
    s_cbranch_scc1 L_noswap_42
    v_mov_b32 v10, 0
    v_mov_b32 v11, 0
    s_nop 1
    v_permlane32_swap_b32 v140, v10
    v_permlane32_swap_b32 v141, v11
    v_mov_b32 v140, v10
    v_mov_b32 v141, v11
L_noswap_42:
    ds_write_b64 v8, v[140:141]
    ds_write_b64 v9, v[142:143]
    v_cvt_pk_bf16_f32 v132, v48, v49
    v_cvt_pk_bf16_f32 v133, v50, v51
    v_cvt_pk_bf16_f32 v138, v52, v53
    v_cvt_pk_bf16_f32 v139, v54, v55
    v_mov_b32 v135, 0
    v_mov_b32 v136, 0
    v_cvt_pk_bf16_f32 v94, v24, v25
    v_cvt_pk_bf16_f32 v95, v26, v27
    v_cvt_pk_bf16_f32 v98, v28, v29
    v_cvt_pk_bf16_f32 v99, v30, v31
    v_cvt_pk_bf16_f32 v126, v32, v33
    v_cvt_pk_bf16_f32 v129, v34, v35
    v_mov_b32 v96, 0
    v_mov_b32 v97, 0
    v_cvt_pk_bf16_f32 v108, v36, v37
    v_cvt_pk_bf16_f32 v109, v38, v39
    v_cvt_pk_bf16_f32 v114, v40, v41
    v_cvt_pk_bf16_f32 v115, v42, v43
    v_cvt_pk_bf16_f32 v120, v44, v45
    v_cvt_pk_bf16_f32 v121, v46, v47
    v_permlane32_swap_b32 v126, v96
    v_permlane32_swap_b32 v129, v97
    v_cvt_pk_bf16_f32 v124, v16, v17
    v_cvt_pk_bf16_f32 v125, v18, v19
    v_cvt_pk_bf16_f32 v130, v20, v21
    v_cvt_pk_bf16_f32 v131, v22, v23
    v_mov_b32 v127, 0
    v_mov_b32 v128, 0
    v_mov_b32 v12, 0x3f803f80
    v_mov_b32 v13, 0x3f803f80
    v_mov_b32 v14, 0x3f803f80
    v_mov_b32 v15, 0x3f803f80
    v_mfma_f32_16x16x32_bf16 v[32:35], v[94:97], v[132:135], v[172:175]
    v_mfma_f32_16x16x32_bf16 v[36:39], v[100:103], v[132:135], v[168:171]
    v_mfma_f32_16x16x32_bf16 v[20:23], v[94:97], v[124:127], v[168:171]
    v_mfma_f32_16x16x32_bf16 v[40:43], v[96:99], v[136:139], v[172:175]
    v_mfma_f32_16x16x32_bf16 v[44:47], v[102:105], v[136:139], v[168:171]
    v_mfma_f32_16x16x32_bf16 v[28:31], v[96:99], v[128:131], v[168:171]
    s_waitcnt lgkmcnt(0)
    s_barrier
    ds_read_b64 v[88:89], v7 offset:0
    ds_read_b64 v[90:91], v7 offset:512
    ds_read_b64 v[92:93], v7 offset:1024
    ds_read_b64 v[106:107], v7 offset:1536
    ds_read_b64 v[112:113], v7 offset:2048
    ds_read_b64 v[118:119], v7 offset:2560
    s_mov_b32 s52, 0x3eae1a93
    s_waitcnt lgkmcnt(4)
    v_mfma_f32_16x16x32_bf16 v[16:19], v[88:91], v[124:127], v[176:179]
    s_waitcnt lgkmcnt(3)
    v_mfma_f32_16x16x32_bf16 v[24:27], v[90:93], v[128:131], v[176:179]
    v_max3_f32 v48, v32, v33, v34
    v_max3_f32 v49, v40, v41, v42
    s_nop 3
    v_max3_f32 v50, v16, v17, v18
    s_nop 0
    v_max3_f32 v51, v24, v25, v26
    v_max3_f32 v48, v48, v35, v36
    v_max3_f32 v49, v49, v43, v44
    v_max3_f32 v50, v50, v19, v20
    v_max3_f32 v51, v51, v27, v28
    v_max3_f32 v48, v48, v37, v38
    v_max3_f32 v49, v49, v45, v46
    v_max3_f32 v50, v50, v21, v22
    v_max3_f32 v51, v51, v29, v30
    v_max_f32 v48, v48, v39
    v_max_f32 v49, v49, v47
    v_max_f32 v50, v50, v23
    v_max_f32 v51, v51, v31
    v_mov_b32 v52, v48
    v_mov_b32 v53, v49
    v_mov_b32 v54, v50
    v_mov_b32 v55, v51
    v_permlane16_swap_b32 v48, v52
    v_permlane16_swap_b32 v49, v53
    v_permlane16_swap_b32 v50, v54
    v_permlane16_swap_b32 v51, v55
    v_max_f32 v48, v48, v52
    v_max_f32 v49, v49, v53
    v_max_f32 v50, v50, v54
    v_max_f32 v51, v51, v55
    v_mov_b32 v52, v48
    v_mov_b32 v53, v49
    v_mov_b32 v54, v50
    v_mov_b32 v55, v51
    v_permlane32_swap_b32 v48, v52
    v_permlane32_swap_b32 v49, v53
    v_permlane32_swap_b32 v50, v54
    v_permlane32_swap_b32 v51, v55
    v_max_f32 v48, v48, v52
    v_max_f32 v49, v49, v53
    v_max_f32 v50, v50, v54
    v_max_f32 v51, v51, v55
    v_mul_f32 v48, s52, v48
    v_mul_f32 v49, s52, v49
    v_mul_f32 v50, s52, v50
    v_mul_f32 v51, s52, v51
    v_fma_f32 v32, v32, s52, -v48
    v_fma_f32 v40, v40, s52, -v49
    v_fma_f32 v16, v16, s52, -v50
    v_fma_f32 v24, v24, s52, -v51
    v_fma_f32 v33, v33, s52, -v48
    v_fma_f32 v41, v41, s52, -v49
    v_fma_f32 v17, v17, s52, -v50
    v_fma_f32 v25, v25, s52, -v51
    v_fma_f32 v34, v34, s52, -v48
    v_fma_f32 v42, v42, s52, -v49
    v_fma_f32 v18, v18, s52, -v50
    v_fma_f32 v26, v26, s52, -v51
    v_fma_f32 v35, v35, s52, -v48
    v_fma_f32 v43, v43, s52, -v49
    v_fma_f32 v19, v19, s52, -v50
    v_fma_f32 v27, v27, s52, -v51
    v_fma_f32 v36, v36, s52, -v48
    v_fma_f32 v44, v44, s52, -v49
    v_fma_f32 v20, v20, s52, -v50
    v_fma_f32 v28, v28, s52, -v51
    v_fma_f32 v37, v37, s52, -v48
    v_fma_f32 v45, v45, s52, -v49
    v_fma_f32 v21, v21, s52, -v50
    v_fma_f32 v29, v29, s52, -v51
    v_fma_f32 v38, v38, s52, -v48
    v_fma_f32 v46, v46, s52, -v49
    v_fma_f32 v22, v22, s52, -v50
    v_fma_f32 v30, v30, s52, -v51
    v_fma_f32 v39, v39, s52, -v48
    v_fma_f32 v47, v47, s52, -v49
    v_fma_f32 v23, v23, s52, -v50
    v_fma_f32 v31, v31, s52, -v51
    v_exp_f32 v32, v32
    v_exp_f32 v40, v40
    v_exp_f32 v16, v16
    v_exp_f32 v24, v24
    v_exp_f32 v33, v33
    v_exp_f32 v41, v41
    v_exp_f32 v17, v17
    v_exp_f32 v25, v25
    v_exp_f32 v34, v34
    v_exp_f32 v42, v42
    v_exp_f32 v18, v18
    v_exp_f32 v26, v26
    v_exp_f32 v35, v35
    v_exp_f32 v43, v43
    v_exp_f32 v19, v19
    v_exp_f32 v27, v27
    v_exp_f32 v36, v36
    v_exp_f32 v44, v44
    v_exp_f32 v20, v20
    v_exp_f32 v28, v28
    v_exp_f32 v37, v37
    v_exp_f32 v45, v45
    v_exp_f32 v21, v21
    v_exp_f32 v29, v29
    v_exp_f32 v38, v38
    v_exp_f32 v46, v46
    v_exp_f32 v22, v22
    v_exp_f32 v30, v30
    v_exp_f32 v39, v39
    v_exp_f32 v47, v47
    v_exp_f32 v23, v23
    v_exp_f32 v31, v31
    v_cvt_pk_bf16_f32 v56, v32, v33
    v_cvt_pk_bf16_f32 v60, v40, v41
    v_cvt_pk_bf16_f32 v64, v16, v17
    v_cvt_pk_bf16_f32 v68, v24, v25
    v_cvt_pk_bf16_f32 v57, v34, v35
    v_cvt_pk_bf16_f32 v61, v42, v43
    v_cvt_pk_bf16_f32 v65, v18, v19
    v_cvt_pk_bf16_f32 v69, v26, v27
    v_cvt_pk_bf16_f32 v58, v36, v37
    v_cvt_pk_bf16_f32 v62, v44, v45
    v_cvt_pk_bf16_f32 v66, v20, v21
    v_cvt_pk_bf16_f32 v70, v28, v29
    v_cvt_pk_bf16_f32 v59, v38, v39
    v_cvt_pk_bf16_f32 v63, v46, v47
    v_cvt_pk_bf16_f32 v67, v22, v23
    v_cvt_pk_bf16_f32 v71, v30, v31
    v_mfma_f32_16x16x32_bf16 v[188:191], v[12:15], v[56:59], 0
    v_mfma_f32_16x16x32_bf16 v[180:183], v[108:111], v[56:59], 0
    v_mfma_f32_16x16x32_bf16 v[184:187], v[120:123], v[56:59], 0
    v_mfma_f32_16x16x32_bf16 v[200:203], v[12:15], v[60:63], 0
    v_mfma_f32_16x16x32_bf16 v[192:195], v[114:117], v[60:63], 0
    v_mfma_f32_16x16x32_bf16 v[196:199], v[120:123], v[60:63], 0
    v_mfma_f32_16x16x32_bf16 v[212:215], v[12:15], v[64:67], 0
    s_waitcnt lgkmcnt(2)
    v_mfma_f32_16x16x32_bf16 v[204:207], v[106:109], v[64:67], 0
    s_waitcnt lgkmcnt(0)
    v_mfma_f32_16x16x32_bf16 v[208:211], v[118:121], v[64:67], 0
    v_mfma_f32_16x16x32_bf16 v[224:227], v[12:15], v[68:71], 0
    v_mfma_f32_16x16x32_bf16 v[216:219], v[112:115], v[68:71], 0
    v_mfma_f32_16x16x32_bf16 v[220:223], v[118:121], v[68:71], 0
    s_lshl_b32 s53, s46, 4
    s_add_u32 s53, s53, s45
    s_lshl_b32 s54, s53, 10
    s_add_u32 s54, s54, 23330816
    s_lshl_b32 s55, s53, 7
    s_add_u32 s55, s55, 25427840
    v_lshlrev_b32 v6, 3, v1
    v_rcp_f32 v188, v188
    v_rcp_f32 v200, v200
    v_rcp_f32 v212, v212
    v_rcp_f32 v224, v224
    v_mul_f32 v180, v180, v188
    v_mul_f32 v181, v181, v188
    v_mul_f32 v182, v182, v188
    v_mul_f32 v183, v183, v188
    v_mul_f32 v184, v184, v188
    v_mul_f32 v185, v185, v188
    v_cvt_pk_bf16_f32 v76, v180, v181
    v_cvt_pk_bf16_f32 v77, v182, v183
    v_cvt_pk_bf16_f32 v82, v184, v185
    v_mul_f32 v192, v192, v200
    v_mul_f32 v193, v193, v200
    v_mul_f32 v194, v194, v200
    v_mul_f32 v195, v195, v200
    v_mul_f32 v198, v198, v200
    v_mul_f32 v199, v199, v200
    v_cvt_pk_bf16_f32 v78, v192, v193
    v_cvt_pk_bf16_f32 v79, v194, v195
    v_cvt_pk_bf16_f32 v83, v198, v199
    s_add_u32 s53, s54, 16384
    buffer_store_dwordx4 v[76:79], v2, s[4:7], s53 offen sc1
    v_mul_f32 v204, v204, v212
    v_mul_f32 v205, v205, v212
    v_mul_f32 v206, v206, v212
    v_mul_f32 v207, v207, v212
    v_mul_f32 v208, v208, v212
    v_mul_f32 v209, v209, v212
    v_cvt_pk_bf16_f32 v72, v204, v205
    v_cvt_pk_bf16_f32 v73, v206, v207
    v_cvt_pk_bf16_f32 v80, v208, v209
    v_mul_f32 v216, v216, v224
    v_mul_f32 v217, v217, v224
    v_mul_f32 v218, v218, v224
    v_mul_f32 v219, v219, v224
    v_mul_f32 v222, v222, v224
    v_mul_f32 v223, v223, v224
    v_cvt_pk_bf16_f32 v74, v216, v217
    v_cvt_pk_bf16_f32 v75, v218, v219
    v_cvt_pk_bf16_f32 v81, v222, v223
    s_add_u32 s53, s54, 0
    buffer_store_dwordx4 v[72:75], v2, s[4:7], s53 offen sc1
    s_mov_b32 exec_lo, 0xffff0000
    s_mov_b32 exec_hi, 0
    buffer_store_dwordx2 v[80:81], v6, s[4:7], s55 offen offset:0 sc1
    buffer_store_dwordx2 v[82:83], v6, s[4:7], s55 offen offset:2048 sc1
    s_mov_b64 exec, -1
    s_lshl_b32 s52, s44, 2
    s_add_u32 s52, s52, s20
    s_lshl_b32 s52, s52, 4
    s_add_u32 s52, s52, s45
    s_lshl_b32 s52, s52, 3
    s_add_u32 s52, s52, 3948544
    s_mul_i32 s53, s22, 10923
    s_lshr_b32 s53, s53, 16
    s_mul_i32 s53, s53, 6
    s_sub_u32 s53, s22, s53
    s_lshl_b32 s53, s53, 8
    s_add_u32 s23, s53, 4067328
    v_min_u32 v13, 17, v1
    v_lshlrev_b32 v13, 3, v13
    buffer_load_dwordx2 v[14:15], v13, s[4:7], s23 offen sc1
    v_mov_b32 v8, s98
    v_mov_b32 v9, s99
    s_waitcnt vmcnt(1)
    s_mov_b64 exec, 1
    buffer_store_dwordx2 v[8:9], off, s[4:7], s52 sc1
    s_mov_b64 exec, -1
    s_cmp_ge_u32 s22, 24
    s_cbranch_scc1 L_idle0_43
    s_mul_i32 s44, s22, 10923
    s_lshr_b32 s44, s44, 16
    s_mul_i32 s52, s44, 6
    s_sub_u32 s45, s22, s52
    s_lshl_b32 s52, s21, 2
    s_add_u32 s44, s44, s52
    s_lshl_b32 s46, s44, 2
    s_add_u32 s46, s46, s20
    s_mul_i32 s47, s45, 110592
    s_mul_i32 s48, s20, 3072
    s_add_u32 s47, s47, s48
    s_add_u32 s47, s47, 2097152
    s_lshl_b32 s49, s46, 14
    s_add_u32 s49, s49, 23330816
    s_lshl_b32 s50, s46, 11
    s_add_u32 s50, s50, 25427968
    v_and_b32 v3, 15, v1
    v_lshrrev_b32 v4, 4, v1
    v_lshlrev_b32 v5, 3, v3
    v_lshl_add_u32 v5, v4, 8, v5
    s_lshl_b32 s52, s46, 4
    v_add_u32 v6, s52, v3
    v_lshlrev_b32 v7, 3, v6
    v_mul_u32_u24 v6, 1152, v6
    v_lshl_add_u32 v6, v4, 4, v6
    s_mul_i32 s51, s45, 192
    s_mov_b32 s8, s24
    s_mov_b32 s9, s25
    s_mov_b32 s10, 0x240000
    s_mov_b32 s11, 0x20000
    s_waitcnt vmcnt(1)
    v_cmp_eq_u64 vcc, s[98:99], v[14:15]
    s_nop 0
    s_cmp_eq_u64 vcc, exec
    s_cbranch_scc0 L_pwo_slow_35
L_pwo_back_36:
    s_mov_b32 m0, s48
    s_nop 0
    buffer_load_dwordx4 v2, s[4:7], s47 offen offset:0 lds
    buffer_load_dwordx4 v2, s[4:7], s47 offen offset:1024 lds
    buffer_load_dwordx4 v2, s[4:7], s47 offen offset:2048 lds
    s_add_u32 s48, s48, 12288
    s_add_u32 s47, s47, 12288
    s_mov_b32 m0, s48
    s_nop 0
    buffer_load_dwordx4 v2, s[4:7], s47 offen offset:0 lds
    buffer_load_dwordx4 v2, s[4:7], s47 offen offset:1024 lds
    buffer_load_dwordx4 v2, s[4:7], s47 offen offset:2048 lds
    s_add_u32 s48, s48, 12288
    s_add_u32 s47, s47, 12288
    s_mov_b32 m0, s48
    s_nop 0
    buffer_load_dwordx4 v2, s[4:7], s47 offen offset:0 lds
    buffer_load_dwordx4 v2, s[4:7], s47 offen offset:1024 lds
    buffer_load_dwordx4 v2, s[4:7], s47 offen offset:2048 lds
    s_add_u32 s48, s48, 12288
    s_add_u32 s47, s47, 12288
    s_mov_b32 m0, s48
    s_nop 0
    buffer_load_dwordx4 v2, s[4:7], s47 offen offset:0 lds
    buffer_load_dwordx4 v2, s[4:7], s47 offen offset:1024 lds
    buffer_load_dwordx4 v2, s[4:7], s47 offen offset:2048 lds
    s_add_u32 s48, s48, 12288
    s_add_u32 s47, s47, 12288
    s_mov_b32 m0, s48
    s_nop 0
    buffer_load_dwordx4 v2, s[4:7], s47 offen offset:0 lds
    buffer_load_dwordx4 v2, s[4:7], s47 offen offset:1024 lds
    buffer_load_dwordx4 v2, s[4:7], s47 offen offset:2048 lds
    s_add_u32 s48, s48, 12288
    s_add_u32 s47, s47, 12288
    s_mov_b32 m0, s48
    s_nop 0
    buffer_load_dwordx4 v2, s[4:7], s47 offen offset:0 lds
    buffer_load_dwordx4 v2, s[4:7], s47 offen offset:1024 lds
    buffer_load_dwordx4 v2, s[4:7], s47 offen offset:2048 lds
    s_add_u32 s48, s48, 12288
    s_add_u32 s47, s47, 12288
    s_mov_b32 m0, s48
    s_nop 0
    buffer_load_dwordx4 v2, s[4:7], s47 offen offset:0 lds
    buffer_load_dwordx4 v2, s[4:7], s47 offen offset:1024 lds
    buffer_load_dwordx4 v2, s[4:7], s47 offen offset:2048 lds
    s_add_u32 s48, s48, 12288
    s_add_u32 s47, s47, 12288
    s_mov_b32 m0, s48
    s_nop 0
    buffer_load_dwordx4 v2, s[4:7], s47 offen offset:0 lds
    buffer_load_dwordx4 v2, s[4:7], s47 offen offset:1024 lds
    buffer_load_dwordx4 v2, s[4:7], s47 offen offset:2048 lds
    s_add_u32 s48, s48, 12288
    s_add_u32 s47, s47, 12288
    s_mov_b32 m0, s48
    s_nop 0
    buffer_load_dwordx4 v2, s[4:7], s47 offen offset:0 lds
    buffer_load_dwordx4 v2, s[4:7], s47 offen offset:1024 lds
    buffer_load_dwordx4 v2, s[4:7], s47 offen offset:2048 lds
    s_add_u32 s48, s48, 12288
    s_add_u32 s47, s47, 12288
    s_mul_i32 s55, s20, 9216
    s_add_u32 s55, s55, 110592
    v_add_u32 v64, s55, v2
    ds_write_b128 v64, a[144:147] offset:0
    ds_write_b128 v64, a[148:151] offset:1024
    ds_write_b128 v64, a[152:155] offset:2048
    ds_write_b128 v64, a[156:159] offset:3072
    ds_write_b128 v64, a[160:163] offset:4096
    ds_write_b128 v64, a[164:167] offset:5120
    ds_write_b128 v64, a[168:171] offset:6144
    ds_write_b128 v64, a[172:175] offset:7168
    ds_write_b128 v64, a[176:179] offset:8192
    s_cmp_ge_u32 s3, 1152
    s_cbranch_scc1 L_ud_47
    s_mul_i32 s64, s3, 1821
    s_lshr_b32 s64, s64, 16
    s_mul_i32 s92, s64, 36
    s_sub_u32 s92, s3, s92
    s_and_b32 s93, s92, 1
    s_lshr_b32 s94, s92, 1
    s_mov_b32 s62, 0
    s_mov_b32 s63, 256
    s_mul_i32 s95, s64, 486
    s_add_u32 s95, s95, s92
    s_lshl_b32 s95, s95, 10
    s_add_u32 s69, s95, 4194304
    s_add_u32 s67, s69, 36864
    s_add_u32 s68, s69, 184320
    s_mov_b32 s70, 36864
    s_mov_b32 s71, 73728
    s_lshl_b32 s95, s64, 1
    s_add_u32 s95, s95, s93
    s_mul_i32 s95, s95, 18
    s_add_u32 s95, s95, s94
    s_mul_i32 s95, s95, 576
    s_add_u32 s65, s95, 2883584
    s_mov_b32 s66, s92
    s_branch L_udone_48
L_ud_47:
    s_sub_u32 s92, s3, 1152
    s_mul_i32 s64, s92, 3641
    s_lshr_b32 s64, s64, 16
    s_mul_i32 s93, s64, 18
    s_sub_u32 s92, s92, s93
    s_and_b32 s93, s64, 3
    s_and_b32 s94, s93, 1
    s_mov_b32 s65, 0
    s_lshl_b32 s62, s94, 5
    s_cmp_eq_u32 s94, 0
    s_cselect_b32 s63, 256, 0
    s_add_u32 s66, s92, 36
    s_mul_i32 s95, s64, 486
    s_add_u32 s95, s95, 324
    s_lshl_b32 s95, s95, 10
    s_add_u32 s95, s95, 4194304
    s_cmp_ge_u32 s92, 3
    s_cbranch_scc1 L_ub_49
    s_sub_u32 s96, s92, 0
    s_mov_b32 s70, 1024
    s_mov_b32 s71, 2048
    s_mul_i32 s97, s96, 5120
    s_add_u32 s97, s97, 0
    s_add_u32 s67, s97, s95
    s_mul_i32 s97, s96, 4096
    s_add_u32 s97, s97, 15360
    s_add_u32 s68, s97, s95
    s_mul_i32 s97, s96, 5120
    s_add_u32 s97, s97, 4096
    s_add_u32 s69, s97, s95
    s_branch L_udone_48
L_ub_49:
    s_cmp_ge_u32 s92, 9
    s_cbranch_scc1 L_uc_50
    s_sub_u32 s96, s92, 3
    s_mov_b32 s70, 1024
    s_mov_b32 s71, 2048
    s_mul_i32 s97, s96, 9216
    s_add_u32 s97, s97, 27648
    s_add_u32 s67, s97, s95
    s_mul_i32 s97, s96, 9216
    s_add_u32 s97, s97, 31744
    s_add_u32 s68, s97, s95
    s_mul_i32 s97, s96, 9216
    s_add_u32 s97, s97, 35840
    s_add_u32 s69, s97, s95
    s_branch L_udone_48
L_uc_50:
    s_sub_u32 s96, s92, 9
    s_mov_b32 s70, 1024
    s_mov_b32 s71, 18432
    s_mul_i32 s97, s96, 2048
    s_add_u32 s97, s97, 82944
    s_add_u32 s67, s97, s95
    s_mul_i32 s97, s96, 2048
    s_add_u32 s97, s97, 119808
    s_add_u32 s68, s97, s95
    s_mul_i32 s97, s96, 1024
    s_add_u32 s97, s97, 156672
    s_add_u32 s69, s97, s95
L_udone_48:
    s_lshl_b32 s95, s64, 6
    s_add_u32 s95, s95, s66
    s_lshl_b32 s95, s95, 3
    s_add_u32 s66, s95, 4071424
    v_lshrrev_b32 v64, 4, v1
    v_bfe_u32 v66, v1, 2, 2
    v_lshl_add_u32 v64, v64, 3, v66
    v_mul_u32_u24 v64, 288, v64
    v_add_u32 v64, s55, v64
    v_and_b32 v66, 3, v1
    v_lshl_add_u32 v65, v66, 3, v64
    v_add_u32 v65, s63, v65
    v_lshl_add_u32 v64, v66, 4, v64
    v_add_u32 v64, s62, v64
    ds_read_b64_tr_b16 v[72:73], v64 offset:0
    ds_read_b64_tr_b16 v[74:75], v64 offset:1152
    ds_read_b64_tr_b16 v[76:77], v64 offset:8
    ds_read_b64_tr_b16 v[78:79], v64 offset:1160
    ds_read_b64_tr_b16 v[80:81], v64 offset:64
    ds_read_b64_tr_b16 v[82:83], v64 offset:1216
    ds_read_b64_tr_b16 v[84:85], v64 offset:72
    ds_read_b64_tr_b16 v[86:87], v64 offset:1224
    ds_read_b64_tr_b16 v[88:89], v64 offset:128
    ds_read_b64_tr_b16 v[90:91], v64 offset:1280
    ds_read_b64_tr_b16 v[92:93], v64 offset:136
    ds_read_b64_tr_b16 v[94:95], v64 offset:1288
    ds_read_b64_tr_b16 v[96:97], v64 offset:192
    ds_read_b64_tr_b16 v[98:99], v64 offset:1344
    ds_read_b64_tr_b16 v[100:101], v64 offset:200
    ds_read_b64_tr_b16 v[102:103], v64 offset:1352
    ds_read_b64_tr_b16 v[104:105], v65 offset:0
    ds_read_b64_tr_b16 v[106:107], v65 offset:1152
    s_waitcnt lgkmcnt(15)
    buffer_store_dwordx4 v[72:75], v2, s[4:7], s67 offen sc1
    s_add_u32 s92, s67, s70
    s_waitcnt lgkmcnt(14)
    buffer_store_dwordx4 v[76:79], v2, s[4:7], s92 offen sc1
    s_add_u32 s92, s67, s71
    s_waitcnt lgkmcnt(12)
    buffer_store_dwordx4 v[80:83], v2, s[4:7], s92 offen sc1
    s_add_u32 s92, s92, s70
    s_waitcnt lgkmcnt(10)
    buffer_store_dwordx4 v[84:87], v2, s[4:7], s92 offen sc1
    s_waitcnt lgkmcnt(8)
    buffer_store_dwordx4 v[88:91], v2, s[4:7], s68 offen sc1
    s_add_u32 s92, s68, s70
    s_waitcnt lgkmcnt(6)
    buffer_store_dwordx4 v[92:95], v2, s[4:7], s92 offen sc1
    s_add_u32 s92, s68, s71
    s_waitcnt lgkmcnt(4)
    buffer_store_dwordx4 v[96:99], v2, s[4:7], s92 offen sc1
    s_add_u32 s92, s92, s70
    s_waitcnt lgkmcnt(2)
    buffer_store_dwordx4 v[100:103], v2, s[4:7], s92 offen sc1
    s_waitcnt lgkmcnt(0)
    buffer_store_dwordx4 v[104:107], v2, s[4:7], s69 offen sc1
    s_cmp_eq_u32 s65, 0
    s_cbranch_scc1 L_nocs_51
    v_mov_b32 v68, 0x3f803f80
    v_mov_b32 v69, 0x3f803f80
    v_mov_b32 v70, 0x3f803f80
    v_mov_b32 v71, 0x3f803f80
    s_nop 1
    v_mfma_f32_16x16x32_bf16 v[108:111], v[72:75], v[68:71], 0
    v_mfma_f32_16x16x32_bf16 v[112:115], v[76:79], v[68:71], 0
    v_mfma_f32_16x16x32_bf16 v[116:119], v[80:83], v[68:71], 0
    v_mfma_f32_16x16x32_bf16 v[120:123], v[84:87], v[68:71], 0
    v_mfma_f32_16x16x32_bf16 v[124:127], v[88:91], v[68:71], 0
    v_mfma_f32_16x16x32_bf16 v[128:131], v[92:95], v[68:71], 0
    v_mfma_f32_16x16x32_bf16 v[132:135], v[96:99], v[68:71], 0
    v_mfma_f32_16x16x32_bf16 v[136:139], v[100:103], v[68:71], 0
    v_mfma_f32_16x16x32_bf16 v[140:143], v[104:107], v[68:71], 0
    v_and_b32 v66, 15, v1
    v_add_u32 v67, 1, v66
    v_cmp_gt_u32 vcc, 8, v66
    v_and_b32 v64, 48, v1
    s_nop 0
    v_cndmask_b32 v67, 0, v67, vcc
    v_lshlrev_b32 v67, 6, v67
    v_add_u32 v67, v67, v64
    v_cmp_eq_u32 vcc, 1, v66
    s_nop 1
    v_cndmask_b32 v108, v108, v112, vcc
    v_cndmask_b32 v109, v109, v113, vcc
    v_cndmask_b32 v110, v110, v114, vcc
    v_cndmask_b32 v111, v111, v115, vcc
    v_cmp_eq_u32 vcc, 2, v66
    s_nop 1
    v_cndmask_b32 v108, v108, v116, vcc
    v_cndmask_b32 v109, v109, v117, vcc
    v_cndmask_b32 v110, v110, v118, vcc
    v_cndmask_b32 v111, v111, v119, vcc
    v_cmp_eq_u32 vcc, 3, v66
    s_nop 1
    v_cndmask_b32 v108, v108, v120, vcc
    v_cndmask_b32 v109, v109, v121, vcc
    v_cndmask_b32 v110, v110, v122, vcc
    v_cndmask_b32 v111, v111, v123, vcc
    v_cmp_eq_u32 vcc, 4, v66
    s_nop 1
    v_cndmask_b32 v108, v108, v124, vcc
    v_cndmask_b32 v109, v109, v125, vcc
    v_cndmask_b32 v110, v110, v126, vcc
    v_cndmask_b32 v111, v111, v127, vcc
    v_cmp_eq_u32 vcc, 5, v66
    s_nop 1
    v_cndmask_b32 v108, v108, v128, vcc
    v_cndmask_b32 v109, v109, v129, vcc
    v_cndmask_b32 v110, v110, v130, vcc
    v_cndmask_b32 v111, v111, v131, vcc
    v_cmp_eq_u32 vcc, 6, v66
    s_nop 1
    v_cndmask_b32 v108, v108, v132, vcc
    v_cndmask_b32 v109, v109, v133, vcc
    v_cndmask_b32 v110, v110, v134, vcc
    v_cndmask_b32 v111, v111, v135, vcc
    v_cmp_eq_u32 vcc, 7, v66
    s_nop 1
    v_cndmask_b32 v108, v108, v136, vcc
    v_cndmask_b32 v109, v109, v137, vcc
    v_cndmask_b32 v110, v110, v138, vcc
    v_cndmask_b32 v111, v111, v139, vcc
    v_cmp_eq_u32 vcc, 8, v66
    s_nop 1
    v_cndmask_b32 v108, v108, v140, vcc
    v_cndmask_b32 v109, v109, v141, vcc
    v_cndmask_b32 v110, v110, v142, vcc
    v_cndmask_b32 v111, v111, v143, vcc
    s_mov_b32 exec_lo, 0x01ff01ff
    s_mov_b32 exec_hi, 0x01ff01ff
    buffer_store_dwordx4 v[108:111], v67, s[4:7], s65 offen sc1
    s_mov_b64 exec, -1
L_nocs_51:
    s_lshr_b32 s52, s46, 1
    s_lshl_b32 s52, s52, 7
    s_add_u32 s52, s52, 3948544
    v_and_b32 v10, 15, v1
    v_lshlrev_b32 v10, 3, v10
    s_mul_i32 s53, s45, 2816
    s_min_u32 s53, s53, 13568
    s_add_u32 s53, s53, s49
    buffer_load_dwordx4 v[160:163], v6, s[8:11], s51 offen offset:0
    buffer_load_dwordx4 v[164:167], v6, s[8:11], s51 offen offset:64
    buffer_load_dwordx4 v[168:171], v6, s[8:11], s51 offen offset:128
    v_mov_b32 v8, v2
    s_waitcnt vmcnt(12)
    s_barrier
    buffer_load_dwordx2 v[12:13], v10, s[4:7], s52 offen sc1
    ds_read_b128 a[0:3], v8 offset:0
    ds_read_b128 a[4:7], v8 offset:1024
    ds_read_b128 a[8:11], v8 offset:2048
    ds_read_b128 a[12:15], v8 offset:3072
    ds_read_b128 a[16:19], v8 offset:4096
    ds_read_b128 a[20:23], v8 offset:5120
    ds_read_b128 a[24:27], v8 offset:6144
    ds_read_b128 a[28:31], v8 offset:7168
    ds_read_b128 a[32:35], v8 offset:8192
    ds_read_b128 a[36:39], v8 offset:9216
    ds_read_b128 a[40:43], v8 offset:10240
    ds_read_b128 a[44:47], v8 offset:11264
    ds_read_b128 a[48:51], v8 offset:12288
    ds_read_b128 a[52:55], v8 offset:13312
    ds_read_b128 a[56:59], v8 offset:14336
    ds_read_b128 a[60:63], v8 offset:15360
    ds_read_b128 a[64:67], v8 offset:16384
    ds_read_b128 a[68:71], v8 offset:17408
    ds_read_b128 a[72:75], v8 offset:18432
    ds_read_b128 a[76:79], v8 offset:19456
    ds_read_b128 a[80:83], v8 offset:20480
    ds_read_b128 a[84:87], v8 offset:21504
    ds_read_b128 a[88:91], v8 offset:22528
    ds_read_b128 a[92:95], v8 offset:23552
    ds_read_b128 v[112:115], v8 offset:24576
    ds_read_b128 v[116:119], v8 offset:25600
    ds_read_b128 v[120:123], v8 offset:26624
    ds_read_b128 v[124:127], v8 offset:27648
    ds_read_b128 v[128:131], v8 offset:28672
    ds_read_b128 v[132:135], v8 offset:29696
    ds_read_b128 v[136:139], v8 offset:30720
    ds_read_b128 v[140:143], v8 offset:31744
    ds_read_b128 v[144:147], v8 offset:32768
    ds_read_b128 v[148:151], v8 offset:33792
    s_waitcnt vmcnt(0)
    v_cmp_eq_u64 vcc, s[98:99], v[12:13]
    s_nop 0
    s_cmp_eq_u64 vcc, exec
    s_cbranch_scc0 L_po_slow_52
L_po_back_53:
    v_mov_b32 v12, s98
    v_mov_b32 v13, s99
    s_mov_b64 exec, 1
    buffer_store_dwordx2 v[12:13], off, s[4:7], s66 sc1
    s_mov_b64 exec, -1
    buffer_load_dwordx4 v[16:19], v2, s[4:7], s49 offen offset:0 sc1
    buffer_load_dwordx4 v[20:23], v2, s[4:7], s49 offen offset:1024 sc1
    buffer_load_dwordx4 v[24:27], v2, s[4:7], s49 offen offset:2048 sc1
    buffer_load_dwordx4 v[28:31], v2, s[4:7], s49 offen offset:3072 sc1
    s_add_u32 s49, s49, 4096
    buffer_load_dwordx4 v[32:35], v2, s[4:7], s49 offen offset:0 sc1
    buffer_load_dwordx4 v[36:39], v2, s[4:7], s49 offen offset:1024 sc1
    buffer_load_dwordx4 v[40:43], v2, s[4:7], s49 offen offset:2048 sc1
    buffer_load_dwordx4 v[44:47], v2, s[4:7], s49 offen offset:3072 sc1
    s_waitcnt vmcnt(7) lgkmcnt(15)
    s_add_u32 s49, s49, 4096
    v_mfma_f32_16x16x32_bf16 v[88:91], a[0:3], v[16:19], 0
    buffer_load_dwordx4 v[48:51], v2, s[4:7], s49 offen offset:0 sc1
    s_waitcnt lgkmcnt(15)
    v_mfma_f32_16x16x32_bf16 v[92:95], a[4:7], v[16:19], 0
    s_waitcnt lgkmcnt(15)
    v_mfma_f32_16x16x32_bf16 v[96:99], a[8:11], v[16:19], 0
    s_waitcnt lgkmcnt(15)
    v_mfma_f32_16x16x32_bf16 v[100:103], a[12:15], v[16:19], 0
    buffer_load_dwordx4 v[52:55], v2, s[4:7], s49 offen offset:1024 sc1
    s_waitcnt lgkmcnt(15)
    v_mfma_f32_16x16x32_bf16 v[104:107], a[16:19], v[16:19], 0
    s_waitcnt lgkmcnt(15)
    v_mfma_f32_16x16x32_bf16 v[108:111], a[20:23], v[16:19], 0
    s_waitcnt vmcnt(8) lgkmcnt(15)
    v_mfma_f32_16x16x32_bf16 v[88:91], a[24:27], v[20:23], v[88:91]
    buffer_load_dwordx4 v[56:59], v2, s[4:7], s49 offen offset:2048 sc1
    s_waitcnt lgkmcnt(15)
    v_mfma_f32_16x16x32_bf16 v[92:95], a[28:31], v[20:23], v[92:95]
    s_waitcnt lgkmcnt(15)
    v_mfma_f32_16x16x32_bf16 v[96:99], a[32:35], v[20:23], v[96:99]
    s_waitcnt lgkmcnt(15)
    v_mfma_f32_16x16x32_bf16 v[100:103], a[36:39], v[20:23], v[100:103]
    buffer_load_dwordx4 v[60:63], v2, s[4:7], s49 offen offset:3072 sc1
    s_waitcnt lgkmcnt(15)
    v_mfma_f32_16x16x32_bf16 v[104:107], a[40:43], v[20:23], v[104:107]
    s_waitcnt lgkmcnt(15)
    s_add_u32 s49, s49, 4096
    v_mfma_f32_16x16x32_bf16 v[108:111], a[44:47], v[20:23], v[108:111]
    s_waitcnt vmcnt(9) lgkmcnt(15)
    v_mfma_f32_16x16x32_bf16 v[88:91], a[48:51], v[24:27], v[88:91]
    buffer_load_dwordx4 v[64:67], v2, s[4:7], s49 offen offset:0 sc1
    s_waitcnt lgkmcnt(15)
    v_mfma_f32_16x16x32_bf16 v[92:95], a[52:55], v[24:27], v[92:95]
    s_waitcnt lgkmcnt(15)
    v_mfma_f32_16x16x32_bf16 v[96:99], a[56:59], v[24:27], v[96:99]
    s_waitcnt lgkmcnt(15)
    v_mfma_f32_16x16x32_bf16 v[100:103], a[60:63], v[24:27], v[100:103]
    buffer_load_dwordx4 v[68:71], v2, s[4:7], s49 offen offset:1024 sc1
    s_waitcnt lgkmcnt(15)
    v_mfma_f32_16x16x32_bf16 v[104:107], a[64:67], v[24:27], v[104:107]
    s_waitcnt lgkmcnt(15)
    v_mfma_f32_16x16x32_bf16 v[108:111], a[68:71], v[24:27], v[108:111]
    s_waitcnt vmcnt(10) lgkmcnt(15)
    v_mfma_f32_16x16x32_bf16 v[88:91], a[72:75], v[28:31], v[88:91]
    buffer_load_dwordx4 v[72:75], v2, s[4:7], s49 offen offset:2048 sc1
    s_waitcnt lgkmcnt(14)
    v_mfma_f32_16x16x32_bf16 v[92:95], a[76:79], v[28:31], v[92:95]
    s_waitcnt lgkmcnt(13)
    v_mfma_f32_16x16x32_bf16 v[96:99], a[80:83], v[28:31], v[96:99]
    s_waitcnt lgkmcnt(12)
    v_mfma_f32_16x16x32_bf16 v[100:103], a[84:87], v[28:31], v[100:103]
    buffer_load_dwordx4 v[76:79], v2, s[4:7], s49 offen offset:3072 sc1
    s_waitcnt lgkmcnt(11)
    v_mfma_f32_16x16x32_bf16 v[104:107], a[88:91], v[28:31], v[104:107]
    s_waitcnt lgkmcnt(10)
    v_mfma_f32_16x16x32_bf16 v[108:111], a[92:95], v[28:31], v[108:111]
    s_waitcnt vmcnt(11) lgkmcnt(9)
    v_mfma_f32_16x16x32_bf16 v[88:91], v[112:115], v[32:35], v[88:91]
    s_waitcnt lgkmcnt(8)
    ds_read_b128 v[152:155], v8 offset:34816
    v_mfma_f32_16x16x32_bf16 v[92:95], v[116:119], v[32:35], v[92:95]
    s_waitcnt lgkmcnt(8)
    ds_read_b128 v[156:159], v8 offset:35840
    v_mfma_f32_16x16x32_bf16 v[96:99], v[120:123], v[32:35], v[96:99]
    s_waitcnt lgkmcnt(8)
    ds_read_b128 v[112:115], v8 offset:36864
    v_mfma_f32_16x16x32_bf16 v[100:103], v[124:127], v[32:35], v[100:103]
    s_waitcnt lgkmcnt(8)
    ds_read_b128 v[116:119], v8 offset:37888
    v_mfma_f32_16x16x32_bf16 v[104:107], v[128:131], v[32:35], v[104:107]
    s_waitcnt lgkmcnt(8)
    ds_read_b128 v[120:123], v8 offset:38912
    v_mfma_f32_16x16x32_bf16 v[108:111], v[132:135], v[32:35], v[108:111]
    s_waitcnt vmcnt(10) lgkmcnt(8)
    ds_read_b128 v[124:127], v8 offset:39936
    v_mfma_f32_16x16x32_bf16 v[88:91], v[136:139], v[36:39], v[88:91]
    s_waitcnt lgkmcnt(8)
    ds_read_b128 v[128:131], v8 offset:40960
    v_mfma_f32_16x16x32_bf16 v[92:95], v[140:143], v[36:39], v[92:95]
    s_waitcnt lgkmcnt(8)
    ds_read_b128 v[132:135], v8 offset:41984
    v_mfma_f32_16x16x32_bf16 v[96:99], v[144:147], v[36:39], v[96:99]
    s_waitcnt lgkmcnt(8)
    ds_read_b128 v[136:139], v8 offset:43008
    v_mfma_f32_16x16x32_bf16 v[100:103], v[148:151], v[36:39], v[100:103]
    s_waitcnt lgkmcnt(8)
    ds_read_b128 v[140:143], v8 offset:44032
    v_mfma_f32_16x16x32_bf16 v[104:107], v[152:155], v[36:39], v[104:107]
    s_waitcnt lgkmcnt(8)
    ds_read_b128 v[144:147], v8 offset:45056
    v_mfma_f32_16x16x32_bf16 v[108:111], v[156:159], v[36:39], v[108:111]
    s_waitcnt vmcnt(9) lgkmcnt(8)
    ds_read_b128 v[148:151], v8 offset:46080
    v_mfma_f32_16x16x32_bf16 v[88:91], v[112:115], v[40:43], v[88:91]
    s_waitcnt lgkmcnt(8)
    ds_read_b128 v[152:155], v8 offset:47104
    v_mfma_f32_16x16x32_bf16 v[92:95], v[116:119], v[40:43], v[92:95]
    s_waitcnt lgkmcnt(8)
    ds_read_b128 v[156:159], v8 offset:48128
    v_mfma_f32_16x16x32_bf16 v[96:99], v[120:123], v[40:43], v[96:99]
    s_waitcnt lgkmcnt(8)
    ds_read_b128 v[112:115], v8 offset:49152
    v_mfma_f32_16x16x32_bf16 v[100:103], v[124:127], v[40:43], v[100:103]
    s_waitcnt lgkmcnt(8)
    ds_read_b128 v[116:119], v8 offset:50176
    v_mfma_f32_16x16x32_bf16 v[104:107], v[128:131], v[40:43], v[104:107]
    s_waitcnt lgkmcnt(8)
    ds_read_b128 v[120:123], v8 offset:51200
    v_mfma_f32_16x16x32_bf16 v[108:111], v[132:135], v[40:43], v[108:111]
    s_waitcnt vmcnt(8) lgkmcnt(8)
    ds_read_b128 v[124:127], v8 offset:52224
    v_mfma_f32_16x16x32_bf16 v[88:91], v[136:139], v[44:47], v[88:91]
    s_waitcnt lgkmcnt(8)
    ds_read_b128 v[128:131], v8 offset:53248
    v_mfma_f32_16x16x32_bf16 v[92:95], v[140:143], v[44:47], v[92:95]
    s_waitcnt lgkmcnt(8)
    ds_read_b128 v[132:135], v8 offset:54272
    v_mfma_f32_16x16x32_bf16 v[96:99], v[144:147], v[44:47], v[96:99]
    s_waitcnt lgkmcnt(8)
    ds_read_b128 v[136:139], v8 offset:55296
    v_mfma_f32_16x16x32_bf16 v[100:103], v[148:151], v[44:47], v[100:103]
    s_waitcnt lgkmcnt(8)
    ds_read_b128 v[140:143], v8 offset:56320
    v_mfma_f32_16x16x32_bf16 v[104:107], v[152:155], v[44:47], v[104:107]
    s_waitcnt lgkmcnt(8)
    ds_read_b128 v[144:147], v8 offset:57344
    v_mfma_f32_16x16x32_bf16 v[108:111], v[156:159], v[44:47], v[108:111]
    s_waitcnt vmcnt(7) lgkmcnt(8)
    ds_read_b128 v[148:151], v8 offset:58368
    v_mfma_f32_16x16x32_bf16 v[88:91], v[112:115], v[48:51], v[88:91]
    s_waitcnt lgkmcnt(8)
    ds_read_b128 v[152:155], v8 offset:59392
    v_mfma_f32_16x16x32_bf16 v[92:95], v[116:119], v[48:51], v[92:95]
    s_waitcnt lgkmcnt(8)
    ds_read_b128 v[156:159], v8 offset:60416
    v_mfma_f32_16x16x32_bf16 v[96:99], v[120:123], v[48:51], v[96:99]
    s_waitcnt lgkmcnt(8)
    v_add_u32 v8, 61440, v8
    ds_read_b128 v[112:115], v8 offset:0
    v_mfma_f32_16x16x32_bf16 v[100:103], v[124:127], v[48:51], v[100:103]
    s_waitcnt lgkmcnt(8)
    ds_read_b128 v[116:119], v8 offset:1024
    v_mfma_f32_16x16x32_bf16 v[104:107], v[128:131], v[48:51], v[104:107]
    s_waitcnt lgkmcnt(8)
    ds_read_b128 v[120:123], v8 offset:2048
    v_mfma_f32_16x16x32_bf16 v[108:111], v[132:135], v[48:51], v[108:111]
    s_waitcnt vmcnt(6) lgkmcnt(8)
    ds_read_b128 v[124:127], v8 offset:3072
    v_mfma_f32_16x16x32_bf16 v[88:91], v[136:139], v[52:55], v[88:91]
    s_waitcnt lgkmcnt(8)
    ds_read_b128 v[128:131], v8 offset:4096
    v_mfma_f32_16x16x32_bf16 v[92:95], v[140:143], v[52:55], v[92:95]
    s_waitcnt lgkmcnt(8)
    ds_read_b128 v[132:135], v8 offset:5120
    v_mfma_f32_16x16x32_bf16 v[96:99], v[144:147], v[52:55], v[96:99]
    s_waitcnt lgkmcnt(8)
    ds_read_b128 v[136:139], v8 offset:6144
    v_mfma_f32_16x16x32_bf16 v[100:103], v[148:151], v[52:55], v[100:103]
    s_waitcnt lgkmcnt(8)
    ds_read_b128 v[140:143], v8 offset:7168
    v_mfma_f32_16x16x32_bf16 v[104:107], v[152:155], v[52:55], v[104:107]
    s_waitcnt lgkmcnt(8)
    ds_read_b128 v[144:147], v8 offset:8192
    v_mfma_f32_16x16x32_bf16 v[108:111], v[156:159], v[52:55], v[108:111]
    s_waitcnt vmcnt(5) lgkmcnt(8)
    ds_read_b128 v[148:151], v8 offset:9216
    v_mfma_f32_16x16x32_bf16 v[88:91], v[112:115], v[56:59], v[88:91]
    s_waitcnt lgkmcnt(8)
    ds_read_b128 v[152:155], v8 offset:10240
    v_mfma_f32_16x16x32_bf16 v[92:95], v[116:119], v[56:59], v[92:95]
    s_waitcnt lgkmcnt(8)
    ds_read_b128 v[156:159], v8 offset:11264
    v_mfma_f32_16x16x32_bf16 v[96:99], v[120:123], v[56:59], v[96:99]
    s_waitcnt lgkmcnt(8)
    ds_read_b128 v[112:115], v8 offset:12288
    v_mfma_f32_16x16x32_bf16 v[100:103], v[124:127], v[56:59], v[100:103]
    s_waitcnt lgkmcnt(8)
    ds_read_b128 v[116:119], v8 offset:13312
    v_mfma_f32_16x16x32_bf16 v[104:107], v[128:131], v[56:59], v[104:107]
    s_waitcnt lgkmcnt(8)
    ds_read_b128 v[120:123], v8 offset:14336
    v_mfma_f32_16x16x32_bf16 v[108:111], v[132:135], v[56:59], v[108:111]
    ds_read_b128 v[124:127], v8 offset:15360
    buffer_load_dwordx2 v[80:81], v5, s[4:7], s50 offen offset:0 sc1
    buffer_load_dwordx2 v[82:83], v5, s[4:7], s50 offen offset:128 sc1
    s_waitcnt vmcnt(6) lgkmcnt(9)
    v_mfma_f32_16x16x32_bf16 v[88:91], v[136:139], v[60:63], v[88:91]
    s_waitcnt lgkmcnt(8)
    ds_read_b128 v[128:131], v8 offset:16384
    v_mfma_f32_16x16x32_bf16 v[92:95], v[140:143], v[60:63], v[92:95]
    s_waitcnt lgkmcnt(8)
    ds_read_b128 v[132:135], v8 offset:17408
    v_mfma_f32_16x16x32_bf16 v[96:99], v[144:147], v[60:63], v[96:99]
    s_waitcnt lgkmcnt(8)
    ds_read_b128 v[136:139], v8 offset:18432
    v_mfma_f32_16x16x32_bf16 v[100:103], v[148:151], v[60:63], v[100:103]
    s_waitcnt lgkmcnt(8)
    ds_read_b128 v[140:143], v8 offset:19456
    v_mfma_f32_16x16x32_bf16 v[104:107], v[152:155], v[60:63], v[104:107]
    s_waitcnt lgkmcnt(8)
    ds_read_b128 v[144:147], v8 offset:20480
    v_mfma_f32_16x16x32_bf16 v[108:111], v[156:159], v[60:63], v[108:111]
    ds_read_b128 v[148:151], v8 offset:21504
    buffer_load_dwordx2 v[84:85], v5, s[4:7], s50 offen offset:1024 sc1
    buffer_load_dwordx2 v[86:87], v5, s[4:7], s50 offen offset:1152 sc1
    s_waitcnt vmcnt(7) lgkmcnt(9)
    v_mfma_f32_16x16x32_bf16 v[88:91], v[112:115], v[64:67], v[88:91]
    s_waitcnt lgkmcnt(8)
    ds_read_b128 v[152:155], v8 offset:22528
    v_mfma_f32_16x16x32_bf16 v[92:95], v[116:119], v[64:67], v[92:95]
    s_waitcnt lgkmcnt(8)
    ds_read_b128 v[156:159], v8 offset:23552
    v_mfma_f32_16x16x32_bf16 v[96:99], v[120:123], v[64:67], v[96:99]
    s_waitcnt lgkmcnt(8)
    ds_read_b128 v[112:115], v8 offset:24576
    v_mfma_f32_16x16x32_bf16 v[100:103], v[124:127], v[64:67], v[100:103]
    s_waitcnt lgkmcnt(8)
    ds_read_b128 v[116:119], v8 offset:25600
    v_mfma_f32_16x16x32_bf16 v[104:107], v[128:131], v[64:67], v[104:107]
    s_waitcnt lgkmcnt(8)
    ds_read_b128 v[120:123], v8 offset:26624
    v_mfma_f32_16x16x32_bf16 v[108:111], v[132:135], v[64:67], v[108:111]
    s_waitcnt vmcnt(6) lgkmcnt(8)
    ds_read_b128 v[124:127], v8 offset:27648
    v_mfma_f32_16x16x32_bf16 v[88:91], v[136:139], v[68:71], v[88:91]
    s_waitcnt lgkmcnt(8)
    ds_read_b128 v[128:131], v8 offset:28672
    v_mfma_f32_16x16x32_bf16 v[92:95], v[140:143], v[68:71], v[92:95]
    s_waitcnt lgkmcnt(8)
    ds_read_b128 v[132:135], v8 offset:29696
    v_mfma_f32_16x16x32_bf16 v[96:99], v[144:147], v[68:71], v[96:99]
    s_waitcnt lgkmcnt(8)
    ds_read_b128 v[136:139], v8 offset:30720
    v_mfma_f32_16x16x32_bf16 v[100:103], v[148:151], v[68:71], v[100:103]
    s_waitcnt lgkmcnt(8)
    ds_read_b128 v[140:143], v8 offset:31744
    v_mfma_f32_16x16x32_bf16 v[104:107], v[152:155], v[68:71], v[104:107]
    s_waitcnt lgkmcnt(8)
    ds_read_b128 v[144:147], v8 offset:32768
    v_mfma_f32_16x16x32_bf16 v[108:111], v[156:159], v[68:71], v[108:111]
    s_waitcnt vmcnt(5) lgkmcnt(8)
    ds_read_b128 v[148:151], v8 offset:33792
    v_mfma_f32_16x16x32_bf16 v[88:91], v[112:115], v[72:75], v[88:91]
    s_waitcnt lgkmcnt(8)
    ds_read_b128 v[152:155], v8 offset:34816
    v_mfma_f32_16x16x32_bf16 v[92:95], v[116:119], v[72:75], v[92:95]
    s_waitcnt lgkmcnt(8)
    ds_read_b128 v[156:159], v8 offset:35840
    v_mfma_f32_16x16x32_bf16 v[96:99], v[120:123], v[72:75], v[96:99]
    s_waitcnt lgkmcnt(8)
    ds_read_b128 v[112:115], v8 offset:36864
    v_mfma_f32_16x16x32_bf16 v[100:103], v[124:127], v[72:75], v[100:103]
    s_waitcnt lgkmcnt(8)
    ds_read_b128 v[116:119], v8 offset:37888
    v_mfma_f32_16x16x32_bf16 v[104:107], v[128:131], v[72:75], v[104:107]
    s_waitcnt lgkmcnt(8)
    ds_read_b128 v[120:123], v8 offset:38912
    v_mfma_f32_16x16x32_bf16 v[108:111], v[132:135], v[72:75], v[108:111]
    s_waitcnt vmcnt(4) lgkmcnt(8)
    ds_read_b128 v[124:127], v8 offset:39936
    v_mfma_f32_16x16x32_bf16 v[88:91], v[136:139], v[76:79], v[88:91]
    s_waitcnt lgkmcnt(8)
    ds_read_b128 v[128:131], v8 offset:40960
    v_mfma_f32_16x16x32_bf16 v[92:95], v[140:143], v[76:79], v[92:95]
    s_waitcnt lgkmcnt(8)
    ds_read_b128 v[132:135], v8 offset:41984
    v_mfma_f32_16x16x32_bf16 v[96:99], v[144:147], v[76:79], v[96:99]
    s_waitcnt lgkmcnt(8)
    ds_read_b128 v[136:139], v8 offset:43008
    v_mfma_f32_16x16x32_bf16 v[100:103], v[148:151], v[76:79], v[100:103]
    s_waitcnt lgkmcnt(8)
    ds_read_b128 v[140:143], v8 offset:44032
    v_mfma_f32_16x16x32_bf16 v[104:107], v[152:155], v[76:79], v[104:107]
    s_waitcnt lgkmcnt(8)
    ds_read_b128 v[144:147], v8 offset:45056
    v_mfma_f32_16x16x32_bf16 v[108:111], v[156:159], v[76:79], v[108:111]
    s_waitcnt vmcnt(2) lgkmcnt(8)
    ds_read_b128 v[148:151], v8 offset:46080
    v_mfma_f32_16x16x32_bf16 v[88:91], v[112:115], v[80:83], v[88:91]
    s_waitcnt lgkmcnt(8)
    ds_read_b128 v[152:155], v8 offset:47104
    v_mfma_f32_16x16x32_bf16 v[92:95], v[116:119], v[80:83], v[92:95]
    s_waitcnt lgkmcnt(8)
    ds_read_b128 v[156:159], v8 offset:48128
    v_mfma_f32_16x16x32_bf16 v[96:99], v[120:123], v[80:83], v[96:99]
    s_waitcnt lgkmcnt(8)
    v_mfma_f32_16x16x32_bf16 v[100:103], v[124:127], v[80:83], v[100:103]
    s_waitcnt lgkmcnt(7)
    v_mfma_f32_16x16x32_bf16 v[104:107], v[128:131], v[80:83], v[104:107]
    s_waitcnt lgkmcnt(6)
    v_mfma_f32_16x16x32_bf16 v[108:111], v[132:135], v[80:83], v[108:111]
    s_waitcnt vmcnt(0) lgkmcnt(5)
    v_mfma_f32_16x16x32_bf16 v[88:91], v[136:139], v[84:87], v[88:91]
    s_waitcnt lgkmcnt(4)
    v_mfma_f32_16x16x32_bf16 v[92:95], v[140:143], v[84:87], v[92:95]
    s_waitcnt lgkmcnt(3)
    v_mfma_f32_16x16x32_bf16 v[96:99], v[144:147], v[84:87], v[96:99]
    s_waitcnt lgkmcnt(2)
    v_mfma_f32_16x16x32_bf16 v[100:103], v[148:151], v[84:87], v[100:103]
    s_waitcnt lgkmcnt(1)
    v_mfma_f32_16x16x32_bf16 v[104:107], v[152:155], v[84:87], v[104:107]
    s_waitcnt lgkmcnt(0)
    v_mfma_f32_16x16x32_bf16 v[108:111], v[156:159], v[84:87], v[108:111]
    v_lshlrev_b32 v16, 16, v160
    v_and_b32 v17, 0xffff0000, v160
    v_lshlrev_b32 v18, 16, v161
    v_and_b32 v19, 0xffff0000, v161
    v_lshlrev_b32 v20, 16, v162
    v_and_b32 v21, 0xffff0000, v162
    v_lshlrev_b32 v22, 16, v163
    v_and_b32 v23, 0xffff0000, v163
    v_lshlrev_b32 v24, 16, v164
    v_and_b32 v25, 0xffff0000, v164
    v_lshlrev_b32 v26, 16, v165
    v_and_b32 v27, 0xffff0000, v165
    v_lshlrev_b32 v28, 16, v166
    v_and_b32 v29, 0xffff0000, v166
    v_lshlrev_b32 v30, 16, v167
    v_and_b32 v31, 0xffff0000, v167
    v_lshlrev_b32 v32, 16, v168
    v_and_b32 v33, 0xffff0000, v168
    v_lshlrev_b32 v34, 16, v169
    v_and_b32 v35, 0xffff0000, v169
    v_lshlrev_b32 v36, 16, v170
    v_and_b32 v37, 0xffff0000, v170
    v_lshlrev_b32 v38, 16, v171
    v_and_b32 v39, 0xffff0000, v171
    v_add_f32 v16, v16, v88
    v_add_f32 v17, v17, v89
    v_add_f32 v18, v18, v90
    v_add_f32 v19, v19, v91
    v_add_f32 v20, v20, v92
    v_add_f32 v21, v21, v93
    v_add_f32 v22, v22, v94
    v_add_f32 v23, v23, v95
    v_add_f32 v24, v24, v96
    v_add_f32 v25, v25, v97
    v_add_f32 v26, v26, v98
    v_add_f32 v27, v27, v99
    v_add_f32 v28, v28, v100
    v_add_f32 v29, v29, v101
    v_add_f32 v30, v30, v102
    v_add_f32 v31, v31, v103
    v_add_f32 v32, v32, v104
    v_add_f32 v33, v33, v105
    v_add_f32 v34, v34, v106
    v_add_f32 v35, v35, v107
    v_add_f32 v36, v36, v108
    v_add_f32 v37, v37, v109
    v_add_f32 v38, v38, v110
    v_add_f32 v39, v39, v111
    s_mul_i32 s52, s46, 18
    s_mul_i32 s53, s45, 3
    s_add_u32 s52, s52, s53
    s_lshl_b32 s52, s52, 10
    s_add_u32 s52, s52, 25690112
    v_cvt_pk_bf16_f32 v40, v16, v17
    v_cvt_pk_bf16_f32 v41, v18, v19
    v_cvt_pk_bf16_f32 v42, v20, v21
    v_cvt_pk_bf16_f32 v43, v22, v23
    buffer_store_dwordx4 v[40:43], v2, s[4:7], s52 offen offset:0 sc1
    v_cvt_pk_bf16_f32 v44, v24, v25
    v_cvt_pk_bf16_f32 v45, v26, v27
    v_cvt_pk_bf16_f32 v46, v28, v29
    v_cvt_pk_bf16_f32 v47, v30, v31
    buffer_store_dwordx4 v[44:47], v2, s[4:7], s52 offen offset:1024 sc1
    v_cvt_pk_bf16_f32 v48, v32, v33
    v_cvt_pk_bf16_f32 v49, v34, v35
    v_cvt_pk_bf16_f32 v50, v36, v37
    v_cvt_pk_bf16_f32 v51, v38, v39
    buffer_store_dwordx4 v[48:51], v2, s[4:7], s52 offen offset:2048 sc1
    v_lshlrev_b32 v16, 16, v40
    v_and_b32 v17, 0xffff0000, v40
    v_lshlrev_b32 v18, 16, v41
    v_and_b32 v19, 0xffff0000, v41
    v_lshlrev_b32 v20, 16, v42
    v_and_b32 v21, 0xffff0000, v42
    v_lshlrev_b32 v22, 16, v43
    v_and_b32 v23, 0xffff0000, v43
    v_lshlrev_b32 v24, 16, v44
    v_and_b32 v25, 0xffff0000, v44
    v_lshlrev_b32 v26, 16, v45
    v_and_b32 v27, 0xffff0000, v45
    v_lshlrev_b32 v28, 16, v46
    v_and_b32 v29, 0xffff0000, v46
    v_lshlrev_b32 v30, 16, v47
    v_and_b32 v31, 0xffff0000, v47
    v_lshlrev_b32 v32, 16, v48
    v_and_b32 v33, 0xffff0000, v48
    v_lshlrev_b32 v34, 16, v49
    v_and_b32 v35, 0xffff0000, v49
    v_lshlrev_b32 v36, 16, v50
    v_and_b32 v37, 0xffff0000, v50
    v_lshlrev_b32 v38, 16, v51
    v_and_b32 v39, 0xffff0000, v51
    v_add_f32 v56, v16, v17
    v_add_f32 v58, v18, v19
    v_add_f32 v56, v56, v20
    v_add_f32 v58, v58, v21
    v_add_f32 v56, v56, v22
    v_add_f32 v58, v58, v23
    v_add_f32 v56, v56, v24
    v_add_f32 v58, v58, v25
    v_add_f32 v56, v56, v26
    v_add_f32 v58, v58, v27
    v_add_f32 v56, v56, v28
    v_add_f32 v58, v58, v29
    v_add_f32 v56, v56, v30
    v_add_f32 v58, v58, v31
    v_add_f32 v56, v56, v32
    v_add_f32 v58, v58, v33
    v_add_f32 v56, v56, v34
    v_add_f32 v58, v58, v35
    v_add_f32 v56, v56, v36
    v_add_f32 v58, v58, v37
    v_add_f32 v56, v56, v38
    v_add_f32 v58, v58, v39
    v_add_f32 v56, v56, v58
    v_mov_b32 v58, v56
    s_nop 1
    v_permlane16_swap_b32 v56, v58
    v_add_f32 v56, v56, v58
    v_mov_b32 v58, v56
    s_nop 1
    v_permlane32_swap_b32 v56, v58
    v_add_f32 v56, v56, v58
    v_mul_f32 v59, 0x3c2aaaab, v56
    v_sub_f32 v58, v16, v59
    v_mul_f32 v57, v58, v58
    v_sub_f32 v61, v17, v59
    v_fmac_f32 v57, v61, v61
    v_sub_f32 v60, v18, v59
    v_fmac_f32 v57, v60, v60
    v_sub_f32 v61, v19, v59
    v_fmac_f32 v57, v61, v61
    v_sub_f32 v60, v20, v59
    v_fmac_f32 v57, v60, v60
    v_sub_f32 v61, v21, v59
    v_fmac_f32 v57, v61, v61
    v_sub_f32 v60, v22, v59
    v_fmac_f32 v57, v60, v60
    v_sub_f32 v61, v23, v59
    v_fmac_f32 v57, v61, v61
    v_sub_f32 v60, v24, v59
    v_fmac_f32 v57, v60, v60
    v_sub_f32 v61, v25, v59
    v_fmac_f32 v57, v61, v61
    v_sub_f32 v60, v26, v59
    v_fmac_f32 v57, v60, v60
    v_sub_f32 v61, v27, v59
    v_fmac_f32 v57, v61, v61
    v_sub_f32 v60, v28, v59
    v_fmac_f32 v57, v60, v60
    v_sub_f32 v61, v29, v59
    v_fmac_f32 v57, v61, v61
    v_sub_f32 v60, v30, v59
    v_fmac_f32 v57, v60, v60
    v_sub_f32 v61, v31, v59
    v_fmac_f32 v57, v61, v61
    v_sub_f32 v60, v32, v59
    v_fmac_f32 v57, v60, v60
    v_sub_f32 v61, v33, v59
    v_fmac_f32 v57, v61, v61
    v_sub_f32 v60, v34, v59
    v_fmac_f32 v57, v60, v60
    v_sub_f32 v61, v35, v59
    v_fmac_f32 v57, v61, v61
    v_sub_f32 v60, v36, v59
    v_fmac_f32 v57, v60, v60
    v_sub_f32 v61, v37, v59
    v_fmac_f32 v57, v61, v61
    v_sub_f32 v60, v38, v59
    v_fmac_f32 v57, v60, v60
    v_sub_f32 v61, v39, v59
    v_fmac_f32 v57, v61, v61
    v_mov_b32 v58, v57
    s_nop 1
    v_permlane16_swap_b32 v57, v58
    v_add_f32 v57, v57, v58
    v_mov_b32 v58, v57
    s_nop 1
    v_permlane32_swap_b32 v57, v58
    v_add_f32 v57, v57, v58
    s_lshl_b32 s52, s45, 14
    s_add_u32 s52, s52, 28049408
    s_mov_b32 exec_lo, 0xffff
    s_mov_b32 exec_hi, 0
    buffer_store_dwordx2 v[56:57], v7, s[4:7], s52 offen sc1
    s_mov_b64 exec, -1
    s_lshl_b32 s52, s46, 3
    s_add_u32 s52, s52, s45
    s_lshl_b32 s52, s52, 3
    s_add_u32 s52, s52, 3964928
    v_mov_b32 v8, s98
    v_mov_b32 v9, s99
    s_waitcnt vmcnt(0)
    s_mov_b64 exec, 1
    buffer_store_dwordx2 v[8:9], off, s[4:7], s52 sc1
    s_mov_b64 exec, -1
    s_cmp_lg_u32 s20, 3
    s_cbranch_scc1 L_ffn_44
    s_mul_i32 s55, s20, 9216
    s_add_u32 s55, s55, 110592
    v_add_u32 v64, s55, v2
    ds_write_b128 v64, a[180:183] offset:0
    ds_write_b128 v64, a[184:187] offset:1024
    ds_write_b128 v64, a[188:191] offset:2048
    ds_write_b128 v64, a[192:195] offset:3072
    ds_write_b128 v64, a[196:199] offset:4096
    ds_write_b128 v64, a[200:203] offset:5120
    ds_write_b128 v64, a[204:207] offset:6144
    ds_write_b128 v64, a[208:211] offset:7168
    ds_write_b128 v64, a[212:215] offset:8192
    s_cmp_ge_u32 s30, 1152
    s_cbranch_scc1 L_ud_55
    s_mul_i32 s64, s30, 1821
    s_lshr_b32 s64, s64, 16
    s_mul_i32 s92, s64, 36
    s_sub_u32 s92, s30, s92
    s_and_b32 s93, s92, 1
    s_lshr_b32 s94, s92, 1
    s_mov_b32 s62, 0
    s_mov_b32 s63, 256
    s_mul_i32 s95, s64, 486
    s_add_u32 s95, s95, s92
    s_lshl_b32 s95, s95, 10
    s_add_u32 s69, s95, 4194304
    s_add_u32 s67, s69, 36864
    s_add_u32 s68, s69, 184320
    s_mov_b32 s70, 36864
    s_mov_b32 s71, 73728
    s_lshl_b32 s95, s64, 1
    s_add_u32 s95, s95, s93
    s_mul_i32 s95, s95, 18
    s_add_u32 s95, s95, s94
    s_mul_i32 s95, s95, 576
    s_add_u32 s65, s95, 2883584
    s_mov_b32 s66, s92
    s_branch L_udone_56
L_ud_55:
    s_sub_u32 s92, s30, 1152
    s_mul_i32 s64, s92, 3641
    s_lshr_b32 s64, s64, 16
    s_mul_i32 s93, s64, 18
    s_sub_u32 s92, s92, s93
    s_and_b32 s93, s64, 3
    s_and_b32 s94, s93, 1
    s_mov_b32 s65, 0
    s_lshl_b32 s62, s94, 5
    s_cmp_eq_u32 s94, 0
    s_cselect_b32 s63, 256, 0
    s_add_u32 s66, s92, 36
    s_mul_i32 s95, s64, 486
    s_add_u32 s95, s95, 324
    s_lshl_b32 s95, s95, 10
    s_add_u32 s95, s95, 4194304
    s_cmp_ge_u32 s92, 3
    s_cbranch_scc1 L_ub_57
    s_sub_u32 s96, s92, 0
    s_mov_b32 s70, 1024
    s_mov_b32 s71, 2048
    s_mul_i32 s97, s96, 5120
    s_add_u32 s97, s97, 0
    s_add_u32 s67, s97, s95
    s_mul_i32 s97, s96, 4096
    s_add_u32 s97, s97, 15360
    s_add_u32 s68, s97, s95
    s_mul_i32 s97, s96, 5120
    s_add_u32 s97, s97, 4096
    s_add_u32 s69, s97, s95
    s_branch L_udone_56
L_ub_57:
    s_cmp_ge_u32 s92, 9
    s_cbranch_scc1 L_uc_58
    s_sub_u32 s96, s92, 3
    s_mov_b32 s70, 1024
    s_mov_b32 s71, 2048
    s_mul_i32 s97, s96, 9216
    s_add_u32 s97, s97, 27648
    s_add_u32 s67, s97, s95
    s_mul_i32 s97, s96, 9216
    s_add_u32 s97, s97, 31744
    s_add_u32 s68, s97, s95
    s_mul_i32 s97, s96, 9216
    s_add_u32 s97, s97, 35840
    s_add_u32 s69, s97, s95
    s_branch L_udone_56
L_uc_58:
    s_sub_u32 s96, s92, 9
    s_mov_b32 s70, 1024
    s_mov_b32 s71, 18432
    s_mul_i32 s97, s96, 2048
    s_add_u32 s97, s97, 82944
    s_add_u32 s67, s97, s95
    s_mul_i32 s97, s96, 2048
    s_add_u32 s97, s97, 119808
    s_add_u32 s68, s97, s95
    s_mul_i32 s97, s96, 1024
    s_add_u32 s97, s97, 156672
    s_add_u32 s69, s97, s95
L_udone_56:
    s_lshl_b32 s95, s64, 6
    s_add_u32 s95, s95, s66
    s_lshl_b32 s95, s95, 3
    s_add_u32 s66, s95, 4071424
    v_lshrrev_b32 v64, 4, v1
    v_bfe_u32 v66, v1, 2, 2
    v_lshl_add_u32 v64, v64, 3, v66
    v_mul_u32_u24 v64, 288, v64
    v_add_u32 v64, s55, v64
    v_and_b32 v66, 3, v1
    v_lshl_add_u32 v65, v66, 3, v64
    v_add_u32 v65, s63, v65
    v_lshl_add_u32 v64, v66, 4, v64
    v_add_u32 v64, s62, v64
    ds_read_b64_tr_b16 v[72:73], v64 offset:0
    ds_read_b64_tr_b16 v[74:75], v64 offset:1152
    ds_read_b64_tr_b16 v[76:77], v64 offset:8
    ds_read_b64_tr_b16 v[78:79], v64 offset:1160
    ds_read_b64_tr_b16 v[80:81], v64 offset:64
    ds_read_b64_tr_b16 v[82:83], v64 offset:1216
    ds_read_b64_tr_b16 v[84:85], v64 offset:72
    ds_read_b64_tr_b16 v[86:87], v64 offset:1224
    ds_read_b64_tr_b16 v[88:89], v64 offset:128
    ds_read_b64_tr_b16 v[90:91], v64 offset:1280
    ds_read_b64_tr_b16 v[92:93], v64 offset:136
    ds_read_b64_tr_b16 v[94:95], v64 offset:1288
    ds_read_b64_tr_b16 v[96:97], v64 offset:192
    ds_read_b64_tr_b16 v[98:99], v64 offset:1344
    ds_read_b64_tr_b16 v[100:101], v64 offset:200
    ds_read_b64_tr_b16 v[102:103], v64 offset:1352
    ds_read_b64_tr_b16 v[104:105], v65 offset:0
    ds_read_b64_tr_b16 v[106:107], v65 offset:1152
    s_waitcnt lgkmcnt(15)
    buffer_store_dwordx4 v[72:75], v2, s[4:7], s67 offen sc1
    s_add_u32 s92, s67, s70
    s_waitcnt lgkmcnt(14)
    buffer_store_dwordx4 v[76:79], v2, s[4:7], s92 offen sc1
    s_add_u32 s92, s67, s71
    s_waitcnt lgkmcnt(12)
    buffer_store_dwordx4 v[80:83], v2, s[4:7], s92 offen sc1
    s_add_u32 s92, s92, s70
    s_waitcnt lgkmcnt(10)
    buffer_store_dwordx4 v[84:87], v2, s[4:7], s92 offen sc1
    s_waitcnt lgkmcnt(8)
    buffer_store_dwordx4 v[88:91], v2, s[4:7], s68 offen sc1
    s_add_u32 s92, s68, s70
    s_waitcnt lgkmcnt(6)
    buffer_store_dwordx4 v[92:95], v2, s[4:7], s92 offen sc1
    s_add_u32 s92, s68, s71
    s_waitcnt lgkmcnt(4)
    buffer_store_dwordx4 v[96:99], v2, s[4:7], s92 offen sc1
    s_add_u32 s92, s92, s70
    s_waitcnt lgkmcnt(2)
    buffer_store_dwordx4 v[100:103], v2, s[4:7], s92 offen sc1
    s_waitcnt lgkmcnt(0)
    buffer_store_dwordx4 v[104:107], v2, s[4:7], s69 offen sc1
    s_cmp_eq_u32 s65, 0
    s_cbranch_scc1 L_nocs_59
    v_mov_b32 v68, 0x3f803f80
    v_mov_b32 v69, 0x3f803f80
    v_mov_b32 v70, 0x3f803f80
    v_mov_b32 v71, 0x3f803f80
    s_nop 1
    v_mfma_f32_16x16x32_bf16 v[108:111], v[72:75], v[68:71], 0
    v_mfma_f32_16x16x32_bf16 v[112:115], v[76:79], v[68:71], 0
    v_mfma_f32_16x16x32_bf16 v[116:119], v[80:83], v[68:71], 0
    v_mfma_f32_16x16x32_bf16 v[120:123], v[84:87], v[68:71], 0
    v_mfma_f32_16x16x32_bf16 v[124:127], v[88:91], v[68:71], 0
    v_mfma_f32_16x16x32_bf16 v[128:131], v[92:95], v[68:71], 0
    v_mfma_f32_16x16x32_bf16 v[132:135], v[96:99], v[68:71], 0
    v_mfma_f32_16x16x32_bf16 v[136:139], v[100:103], v[68:71], 0
    v_mfma_f32_16x16x32_bf16 v[140:143], v[104:107], v[68:71], 0
    v_and_b32 v66, 15, v1
    v_add_u32 v67, 1, v66
    v_cmp_gt_u32 vcc, 8, v66
    v_and_b32 v64, 48, v1
    s_nop 0
    v_cndmask_b32 v67, 0, v67, vcc
    v_lshlrev_b32 v67, 6, v67
    v_add_u32 v67, v67, v64
    v_cmp_eq_u32 vcc, 1, v66
    s_nop 1
    v_cndmask_b32 v108, v108, v112, vcc
    v_cndmask_b32 v109, v109, v113, vcc
    v_cndmask_b32 v110, v110, v114, vcc
    v_cndmask_b32 v111, v111, v115, vcc
    v_cmp_eq_u32 vcc, 2, v66
    s_nop 1
    v_cndmask_b32 v108, v108, v116, vcc
    v_cndmask_b32 v109, v109, v117, vcc
    v_cndmask_b32 v110, v110, v118, vcc
    v_cndmask_b32 v111, v111, v119, vcc
    v_cmp_eq_u32 vcc, 3, v66
    s_nop 1
    v_cndmask_b32 v108, v108, v120, vcc
    v_cndmask_b32 v109, v109, v121, vcc
    v_cndmask_b32 v110, v110, v122, vcc
    v_cndmask_b32 v111, v111, v123, vcc
    v_cmp_eq_u32 vcc, 4, v66
    s_nop 1
    v_cndmask_b32 v108, v108, v124, vcc
    v_cndmask_b32 v109, v109, v125, vcc
    v_cndmask_b32 v110, v110, v126, vcc
    v_cndmask_b32 v111, v111, v127, vcc
    v_cmp_eq_u32 vcc, 5, v66
    s_nop 1
    v_cndmask_b32 v108, v108, v128, vcc
    v_cndmask_b32 v109, v109, v129, vcc
    v_cndmask_b32 v110, v110, v130, vcc
    v_cndmask_b32 v111, v111, v131, vcc
    v_cmp_eq_u32 vcc, 6, v66
    s_nop 1
    v_cndmask_b32 v108, v108, v132, vcc
    v_cndmask_b32 v109, v109, v133, vcc
    v_cndmask_b32 v110, v110, v134, vcc
    v_cndmask_b32 v111, v111, v135, vcc
    v_cmp_eq_u32 vcc, 7, v66
    s_nop 1
    v_cndmask_b32 v108, v108, v136, vcc
    v_cndmask_b32 v109, v109, v137, vcc
    v_cndmask_b32 v110, v110, v138, vcc
    v_cndmask_b32 v111, v111, v139, vcc
    v_cmp_eq_u32 vcc, 8, v66
    s_nop 1
    v_cndmask_b32 v108, v108, v140, vcc
    v_cndmask_b32 v109, v109, v141, vcc
    v_cndmask_b32 v110, v110, v142, vcc
    v_cndmask_b32 v111, v111, v143, vcc
    s_mov_b32 exec_lo, 0x01ff01ff
    s_mov_b32 exec_hi, 0x01ff01ff
    buffer_store_dwordx4 v[108:111], v67, s[4:7], s65 offen sc1
    s_mov_b64 exec, -1
L_nocs_59:
    v_mov_b32 v8, s98
    v_mov_b32 v9, s99
    s_waitcnt vmcnt(0)
    s_mov_b64 exec, 1
    buffer_store_dwordx2 v[8:9], off, s[4:7], s66 sc1
    s_mov_b64 exec, -1
    s_branch L_ffn_44
L_idle0_43:
    s_mul_i32 s55, s20, 9216
    s_add_u32 s55, s55, 110592
    v_add_u32 v64, s55, v2
    ds_write_b128 v64, a[144:147] offset:0
    ds_write_b128 v64, a[148:151] offset:1024
    ds_write_b128 v64, a[152:155] offset:2048
    ds_write_b128 v64, a[156:159] offset:3072
    ds_write_b128 v64, a[160:163] offset:4096
    ds_write_b128 v64, a[164:167] offset:5120
    ds_write_b128 v64, a[168:171] offset:6144
    ds_write_b128 v64, a[172:175] offset:7168
    ds_write_b128 v64, a[176:179] offset:8192
    s_cmp_ge_u32 s3, 1152
    s_cbranch_scc1 L_ud_60
    s_mul_i32 s64, s3, 1821
    s_lshr_b32 s64, s64, 16
    s_mul_i32 s92, s64, 36
    s_sub_u32 s92, s3, s92
    s_and_b32 s93, s92, 1
    s_lshr_b32 s94, s92, 1
    s_mov_b32 s62, 0
    s_mov_b32 s63, 256
    s_mul_i32 s95, s64, 486
    s_add_u32 s95, s95, s92
    s_lshl_b32 s95, s95, 10
    s_add_u32 s69, s95, 4194304
    s_add_u32 s67, s69, 36864
    s_add_u32 s68, s69, 184320
    s_mov_b32 s70, 36864
    s_mov_b32 s71, 73728
    s_lshl_b32 s95, s64, 1
    s_add_u32 s95, s95, s93
    s_mul_i32 s95, s95, 18
    s_add_u32 s95, s95, s94
    s_mul_i32 s95, s95, 576
    s_add_u32 s65, s95, 2883584
    s_mov_b32 s66, s92
    s_branch L_udone_61
L_ud_60:
    s_sub_u32 s92, s3, 1152
    s_mul_i32 s64, s92, 3641
    s_lshr_b32 s64, s64, 16
    s_mul_i32 s93, s64, 18
    s_sub_u32 s92, s92, s93
    s_and_b32 s93, s64, 3
    s_and_b32 s94, s93, 1
    s_mov_b32 s65, 0
    s_lshl_b32 s62, s94, 5
    s_cmp_eq_u32 s94, 0
    s_cselect_b32 s63, 256, 0
    s_add_u32 s66, s92, 36
    s_mul_i32 s95, s64, 486
    s_add_u32 s95, s95, 324
    s_lshl_b32 s95, s95, 10
    s_add_u32 s95, s95, 4194304
    s_cmp_ge_u32 s92, 3
    s_cbranch_scc1 L_ub_62
    s_sub_u32 s96, s92, 0
    s_mov_b32 s70, 1024
    s_mov_b32 s71, 2048
    s_mul_i32 s97, s96, 5120
    s_add_u32 s97, s97, 0
    s_add_u32 s67, s97, s95
    s_mul_i32 s97, s96, 4096
    s_add_u32 s97, s97, 15360
    s_add_u32 s68, s97, s95
    s_mul_i32 s97, s96, 5120
    s_add_u32 s97, s97, 4096
    s_add_u32 s69, s97, s95
    s_branch L_udone_61
L_ub_62:
    s_cmp_ge_u32 s92, 9
    s_cbranch_scc1 L_uc_63
    s_sub_u32 s96, s92, 3
    s_mov_b32 s70, 1024
    s_mov_b32 s71, 2048
    s_mul_i32 s97, s96, 9216
    s_add_u32 s97, s97, 27648
    s_add_u32 s67, s97, s95
    s_mul_i32 s97, s96, 9216
    s_add_u32 s97, s97, 31744
    s_add_u32 s68, s97, s95
    s_mul_i32 s97, s96, 9216
    s_add_u32 s97, s97, 35840
    s_add_u32 s69, s97, s95
    s_branch L_udone_61
L_uc_63:
    s_sub_u32 s96, s92, 9
    s_mov_b32 s70, 1024
    s_mov_b32 s71, 18432
    s_mul_i32 s97, s96, 2048
    s_add_u32 s97, s97, 82944
    s_add_u32 s67, s97, s95
    s_mul_i32 s97, s96, 2048
    s_add_u32 s97, s97, 119808
    s_add_u32 s68, s97, s95
    s_mul_i32 s97, s96, 1024
    s_add_u32 s97, s97, 156672
    s_add_u32 s69, s97, s95
L_udone_61:
    s_lshl_b32 s95, s64, 6
    s_add_u32 s95, s95, s66
    s_lshl_b32 s95, s95, 3
    s_add_u32 s66, s95, 4071424
    v_lshrrev_b32 v64, 4, v1
    v_bfe_u32 v66, v1, 2, 2
    v_lshl_add_u32 v64, v64, 3, v66
    v_mul_u32_u24 v64, 288, v64
    v_add_u32 v64, s55, v64
    v_and_b32 v66, 3, v1
    v_lshl_add_u32 v65, v66, 3, v64
    v_add_u32 v65, s63, v65
    v_lshl_add_u32 v64, v66, 4, v64
    v_add_u32 v64, s62, v64
    ds_read_b64_tr_b16 v[72:73], v64 offset:0
    ds_read_b64_tr_b16 v[74:75], v64 offset:1152
    ds_read_b64_tr_b16 v[76:77], v64 offset:8
    ds_read_b64_tr_b16 v[78:79], v64 offset:1160
    ds_read_b64_tr_b16 v[80:81], v64 offset:64
    ds_read_b64_tr_b16 v[82:83], v64 offset:1216
    ds_read_b64_tr_b16 v[84:85], v64 offset:72
    ds_read_b64_tr_b16 v[86:87], v64 offset:1224
    ds_read_b64_tr_b16 v[88:89], v64 offset:128
    ds_read_b64_tr_b16 v[90:91], v64 offset:1280
    ds_read_b64_tr_b16 v[92:93], v64 offset:136
    ds_read_b64_tr_b16 v[94:95], v64 offset:1288
    ds_read_b64_tr_b16 v[96:97], v64 offset:192
    ds_read_b64_tr_b16 v[98:99], v64 offset:1344
    ds_read_b64_tr_b16 v[100:101], v64 offset:200
    ds_read_b64_tr_b16 v[102:103], v64 offset:1352
    ds_read_b64_tr_b16 v[104:105], v65 offset:0
    ds_read_b64_tr_b16 v[106:107], v65 offset:1152
    s_waitcnt lgkmcnt(15)
    buffer_store_dwordx4 v[72:75], v2, s[4:7], s67 offen sc1
    s_add_u32 s92, s67, s70
    s_waitcnt lgkmcnt(14)
    buffer_store_dwordx4 v[76:79], v2, s[4:7], s92 offen sc1
    s_add_u32 s92, s67, s71
    s_waitcnt lgkmcnt(12)
    buffer_store_dwordx4 v[80:83], v2, s[4:7], s92 offen sc1
    s_add_u32 s92, s92, s70
    s_waitcnt lgkmcnt(10)
    buffer_store_dwordx4 v[84:87], v2, s[4:7], s92 offen sc1
    s_waitcnt lgkmcnt(8)
    buffer_store_dwordx4 v[88:91], v2, s[4:7], s68 offen sc1
    s_add_u32 s92, s68, s70
    s_waitcnt lgkmcnt(6)
    buffer_store_dwordx4 v[92:95], v2, s[4:7], s92 offen sc1
    s_add_u32 s92, s68, s71
    s_waitcnt lgkmcnt(4)
    buffer_store_dwordx4 v[96:99], v2, s[4:7], s92 offen sc1
    s_add_u32 s92, s92, s70
    s_waitcnt lgkmcnt(2)
    buffer_store_dwordx4 v[100:103], v2, s[4:7], s92 offen sc1
    s_waitcnt lgkmcnt(0)
    buffer_store_dwordx4 v[104:107], v2, s[4:7], s69 offen sc1
    s_cmp_eq_u32 s65, 0
    s_cbranch_scc1 L_nocs_64
    v_mov_b32 v68, 0x3f803f80
    v_mov_b32 v69, 0x3f803f80
    v_mov_b32 v70, 0x3f803f80
    v_mov_b32 v71, 0x3f803f80
    s_nop 1
    v_mfma_f32_16x16x32_bf16 v[108:111], v[72:75], v[68:71], 0
    v_mfma_f32_16x16x32_bf16 v[112:115], v[76:79], v[68:71], 0
    v_mfma_f32_16x16x32_bf16 v[116:119], v[80:83], v[68:71], 0
    v_mfma_f32_16x16x32_bf16 v[120:123], v[84:87], v[68:71], 0
    v_mfma_f32_16x16x32_bf16 v[124:127], v[88:91], v[68:71], 0
    v_mfma_f32_16x16x32_bf16 v[128:131], v[92:95], v[68:71], 0
    v_mfma_f32_16x16x32_bf16 v[132:135], v[96:99], v[68:71], 0
    v_mfma_f32_16x16x32_bf16 v[136:139], v[100:103], v[68:71], 0
    v_mfma_f32_16x16x32_bf16 v[140:143], v[104:107], v[68:71], 0
    v_and_b32 v66, 15, v1
    v_add_u32 v67, 1, v66
    v_cmp_gt_u32 vcc, 8, v66
    v_and_b32 v64, 48, v1
    s_nop 0
    v_cndmask_b32 v67, 0, v67, vcc
    v_lshlrev_b32 v67, 6, v67
    v_add_u32 v67, v67, v64
    v_cmp_eq_u32 vcc, 1, v66
    s_nop 1
    v_cndmask_b32 v108, v108, v112, vcc
    v_cndmask_b32 v109, v109, v113, vcc
    v_cndmask_b32 v110, v110, v114, vcc
    v_cndmask_b32 v111, v111, v115, vcc
    v_cmp_eq_u32 vcc, 2, v66
    s_nop 1
    v_cndmask_b32 v108, v108, v116, vcc
    v_cndmask_b32 v109, v109, v117, vcc
    v_cndmask_b32 v110, v110, v118, vcc
    v_cndmask_b32 v111, v111, v119, vcc
    v_cmp_eq_u32 vcc, 3, v66
    s_nop 1
    v_cndmask_b32 v108, v108, v120, vcc
    v_cndmask_b32 v109, v109, v121, vcc
    v_cndmask_b32 v110, v110, v122, vcc
    v_cndmask_b32 v111, v111, v123, vcc
    v_cmp_eq_u32 vcc, 4, v66
    s_nop 1
    v_cndmask_b32 v108, v108, v124, vcc
    v_cndmask_b32 v109, v109, v125, vcc
    v_cndmask_b32 v110, v110, v126, vcc
    v_cndmask_b32 v111, v111, v127, vcc
    v_cmp_eq_u32 vcc, 5, v66
    s_nop 1
    v_cndmask_b32 v108, v108, v128, vcc
    v_cndmask_b32 v109, v109, v129, vcc
    v_cndmask_b32 v110, v110, v130, vcc
    v_cndmask_b32 v111, v111, v131, vcc
    v_cmp_eq_u32 vcc, 6, v66
    s_nop 1
    v_cndmask_b32 v108, v108, v132, vcc
    v_cndmask_b32 v109, v109, v133, vcc
    v_cndmask_b32 v110, v110, v134, vcc
    v_cndmask_b32 v111, v111, v135, vcc
    v_cmp_eq_u32 vcc, 7, v66
    s_nop 1
    v_cndmask_b32 v108, v108, v136, vcc
    v_cndmask_b32 v109, v109, v137, vcc
    v_cndmask_b32 v110, v110, v138, vcc
    v_cndmask_b32 v111, v111, v139, vcc
    v_cmp_eq_u32 vcc, 8, v66
    s_nop 1
    v_cndmask_b32 v108, v108, v140, vcc
    v_cndmask_b32 v109, v109, v141, vcc
    v_cndmask_b32 v110, v110, v142, vcc
    v_cndmask_b32 v111, v111, v143, vcc
    s_mov_b32 exec_lo, 0x01ff01ff
    s_mov_b32 exec_hi, 0x01ff01ff
    buffer_store_dwordx4 v[108:111], v67, s[4:7], s65 offen sc1
    s_mov_b64 exec, -1
L_nocs_64:
    s_mov_b32 s44, s66
    s_mul_i32 s55, s20, 9216
    s_add_u32 s55, s55, 110592
    v_add_u32 v64, s55, v2
    ds_write_b128 v64, a[180:183] offset:0
    ds_write_b128 v64, a[184:187] offset:1024
    ds_write_b128 v64, a[188:191] offset:2048
    ds_write_b128 v64, a[192:195] offset:3072
    ds_write_b128 v64, a[196:199] offset:4096
    ds_write_b128 v64, a[200:203] offset:5120
    ds_write_b128 v64, a[204:207] offset:6144
    ds_write_b128 v64, a[208:211] offset:7168
    ds_write_b128 v64, a[212:215] offset:8192
    s_cmp_ge_u32 s30, 1152
    s_cbranch_scc1 L_ud_65
    s_mul_i32 s64, s30, 1821
    s_lshr_b32 s64, s64, 16
    s_mul_i32 s92, s64, 36
    s_sub_u32 s92, s30, s92
    s_and_b32 s93, s92, 1
    s_lshr_b32 s94, s92, 1
    s_mov_b32 s62, 0
    s_mov_b32 s63, 256
    s_mul_i32 s95, s64, 486
    s_add_u32 s95, s95, s92
    s_lshl_b32 s95, s95, 10
    s_add_u32 s69, s95, 4194304
    s_add_u32 s67, s69, 36864
    s_add_u32 s68, s69, 184320
    s_mov_b32 s70, 36864
    s_mov_b32 s71, 73728
    s_lshl_b32 s95, s64, 1
    s_add_u32 s95, s95, s93
    s_mul_i32 s95, s95, 18
    s_add_u32 s95, s95, s94
    s_mul_i32 s95, s95, 576
    s_add_u32 s65, s95, 2883584
    s_mov_b32 s66, s92
    s_branch L_udone_66
L_ud_65:
    s_sub_u32 s92, s30, 1152
    s_mul_i32 s64, s92, 3641
    s_lshr_b32 s64, s64, 16
    s_mul_i32 s93, s64, 18
    s_sub_u32 s92, s92, s93
    s_and_b32 s93, s64, 3
    s_and_b32 s94, s93, 1
    s_mov_b32 s65, 0
    s_lshl_b32 s62, s94, 5
    s_cmp_eq_u32 s94, 0
    s_cselect_b32 s63, 256, 0
    s_add_u32 s66, s92, 36
    s_mul_i32 s95, s64, 486
    s_add_u32 s95, s95, 324
    s_lshl_b32 s95, s95, 10
    s_add_u32 s95, s95, 4194304
    s_cmp_ge_u32 s92, 3
    s_cbranch_scc1 L_ub_67
    s_sub_u32 s96, s92, 0
    s_mov_b32 s70, 1024
    s_mov_b32 s71, 2048
    s_mul_i32 s97, s96, 5120
    s_add_u32 s97, s97, 0
    s_add_u32 s67, s97, s95
    s_mul_i32 s97, s96, 4096
    s_add_u32 s97, s97, 15360
    s_add_u32 s68, s97, s95
    s_mul_i32 s97, s96, 5120
    s_add_u32 s97, s97, 4096
    s_add_u32 s69, s97, s95
    s_branch L_udone_66
L_ub_67:
    s_cmp_ge_u32 s92, 9
    s_cbranch_scc1 L_uc_68
    s_sub_u32 s96, s92, 3
    s_mov_b32 s70, 1024
    s_mov_b32 s71, 2048
    s_mul_i32 s97, s96, 9216
    s_add_u32 s97, s97, 27648
    s_add_u32 s67, s97, s95
    s_mul_i32 s97, s96, 9216
    s_add_u32 s97, s97, 31744
    s_add_u32 s68, s97, s95
    s_mul_i32 s97, s96, 9216
    s_add_u32 s97, s97, 35840
    s_add_u32 s69, s97, s95
    s_branch L_udone_66
L_uc_68:
    s_sub_u32 s96, s92, 9
    s_mov_b32 s70, 1024
    s_mov_b32 s71, 18432
    s_mul_i32 s97, s96, 2048
    s_add_u32 s97, s97, 82944
    s_add_u32 s67, s97, s95
    s_mul_i32 s97, s96, 2048
    s_add_u32 s97, s97, 119808
    s_add_u32 s68, s97, s95
    s_mul_i32 s97, s96, 1024
    s_add_u32 s97, s97, 156672
    s_add_u32 s69, s97, s95
L_udone_66:
    s_lshl_b32 s95, s64, 6
    s_add_u32 s95, s95, s66
    s_lshl_b32 s95, s95, 3
    s_add_u32 s66, s95, 4071424
    v_lshrrev_b32 v64, 4, v1
    v_bfe_u32 v66, v1, 2, 2
    v_lshl_add_u32 v64, v64, 3, v66
    v_mul_u32_u24 v64, 288, v64
    v_add_u32 v64, s55, v64
    v_and_b32 v66, 3, v1
    v_lshl_add_u32 v65, v66, 3, v64
    v_add_u32 v65, s63, v65
    v_lshl_add_u32 v64, v66, 4, v64
    v_add_u32 v64, s62, v64
    ds_read_b64_tr_b16 v[72:73], v64 offset:0
    ds_read_b64_tr_b16 v[74:75], v64 offset:1152
    ds_read_b64_tr_b16 v[76:77], v64 offset:8
    ds_read_b64_tr_b16 v[78:79], v64 offset:1160
    ds_read_b64_tr_b16 v[80:81], v64 offset:64
    ds_read_b64_tr_b16 v[82:83], v64 offset:1216
    ds_read_b64_tr_b16 v[84:85], v64 offset:72
    ds_read_b64_tr_b16 v[86:87], v64 offset:1224
    ds_read_b64_tr_b16 v[88:89], v64 offset:128
    ds_read_b64_tr_b16 v[90:91], v64 offset:1280
    ds_read_b64_tr_b16 v[92:93], v64 offset:136
    ds_read_b64_tr_b16 v[94:95], v64 offset:1288
    ds_read_b64_tr_b16 v[96:97], v64 offset:192
    ds_read_b64_tr_b16 v[98:99], v64 offset:1344
    ds_read_b64_tr_b16 v[100:101], v64 offset:200
    ds_read_b64_tr_b16 v[102:103], v64 offset:1352
    ds_read_b64_tr_b16 v[104:105], v65 offset:0
    ds_read_b64_tr_b16 v[106:107], v65 offset:1152
    s_waitcnt lgkmcnt(15)
    buffer_store_dwordx4 v[72:75], v2, s[4:7], s67 offen sc1
    s_add_u32 s92, s67, s70
    s_waitcnt lgkmcnt(14)
    buffer_store_dwordx4 v[76:79], v2, s[4:7], s92 offen sc1
    s_add_u32 s92, s67, s71
    s_waitcnt lgkmcnt(12)
    buffer_store_dwordx4 v[80:83], v2, s[4:7], s92 offen sc1
    s_add_u32 s92, s92, s70
    s_waitcnt lgkmcnt(10)
    buffer_store_dwordx4 v[84:87], v2, s[4:7], s92 offen sc1
    s_waitcnt lgkmcnt(8)
    buffer_store_dwordx4 v[88:91], v2, s[4:7], s68 offen sc1
    s_add_u32 s92, s68, s70
    s_waitcnt lgkmcnt(6)
    buffer_store_dwordx4 v[92:95], v2, s[4:7], s92 offen sc1
    s_add_u32 s92, s68, s71
    s_waitcnt lgkmcnt(4)
    buffer_store_dwordx4 v[96:99], v2, s[4:7], s92 offen sc1
    s_add_u32 s92, s92, s70
    s_waitcnt lgkmcnt(2)
    buffer_store_dwordx4 v[100:103], v2, s[4:7], s92 offen sc1
    s_waitcnt lgkmcnt(0)
    buffer_store_dwordx4 v[104:107], v2, s[4:7], s69 offen sc1
    s_cmp_eq_u32 s65, 0
    s_cbranch_scc1 L_nocs_69
    v_mov_b32 v68, 0x3f803f80
    v_mov_b32 v69, 0x3f803f80
    v_mov_b32 v70, 0x3f803f80
    v_mov_b32 v71, 0x3f803f80
    s_nop 1
    v_mfma_f32_16x16x32_bf16 v[108:111], v[72:75], v[68:71], 0
    v_mfma_f32_16x16x32_bf16 v[112:115], v[76:79], v[68:71], 0
    v_mfma_f32_16x16x32_bf16 v[116:119], v[80:83], v[68:71], 0
    v_mfma_f32_16x16x32_bf16 v[120:123], v[84:87], v[68:71], 0
    v_mfma_f32_16x16x32_bf16 v[124:127], v[88:91], v[68:71], 0
    v_mfma_f32_16x16x32_bf16 v[128:131], v[92:95], v[68:71], 0
    v_mfma_f32_16x16x32_bf16 v[132:135], v[96:99], v[68:71], 0
    v_mfma_f32_16x16x32_bf16 v[136:139], v[100:103], v[68:71], 0
    v_mfma_f32_16x16x32_bf16 v[140:143], v[104:107], v[68:71], 0
    v_and_b32 v66, 15, v1
    v_add_u32 v67, 1, v66
    v_cmp_gt_u32 vcc, 8, v66
    v_and_b32 v64, 48, v1
    s_nop 0
    v_cndmask_b32 v67, 0, v67, vcc
    v_lshlrev_b32 v67, 6, v67
    v_add_u32 v67, v67, v64
    v_cmp_eq_u32 vcc, 1, v66
    s_nop 1
    v_cndmask_b32 v108, v108, v112, vcc
    v_cndmask_b32 v109, v109, v113, vcc
    v_cndmask_b32 v110, v110, v114, vcc
    v_cndmask_b32 v111, v111, v115, vcc
    v_cmp_eq_u32 vcc, 2, v66
    s_nop 1
    v_cndmask_b32 v108, v108, v116, vcc
    v_cndmask_b32 v109, v109, v117, vcc
    v_cndmask_b32 v110, v110, v118, vcc
    v_cndmask_b32 v111, v111, v119, vcc
    v_cmp_eq_u32 vcc, 3, v66
    s_nop 1
    v_cndmask_b32 v108, v108, v120, vcc
    v_cndmask_b32 v109, v109, v121, vcc
    v_cndmask_b32 v110, v110, v122, vcc
    v_cndmask_b32 v111, v111, v123, vcc
    v_cmp_eq_u32 vcc, 4, v66
    s_nop 1
    v_cndmask_b32 v108, v108, v124, vcc
    v_cndmask_b32 v109, v109, v125, vcc
    v_cndmask_b32 v110, v110, v126, vcc
    v_cndmask_b32 v111, v111, v127, vcc
    v_cmp_eq_u32 vcc, 5, v66
    s_nop 1
    v_cndmask_b32 v108, v108, v128, vcc
    v_cndmask_b32 v109, v109, v129, vcc
    v_cndmask_b32 v110, v110, v130, vcc
    v_cndmask_b32 v111, v111, v131, vcc
    v_cmp_eq_u32 vcc, 6, v66
    s_nop 1
    v_cndmask_b32 v108, v108, v132, vcc
    v_cndmask_b32 v109, v109, v133, vcc
    v_cndmask_b32 v110, v110, v134, vcc
    v_cndmask_b32 v111, v111, v135, vcc
    v_cmp_eq_u32 vcc, 7, v66
    s_nop 1
    v_cndmask_b32 v108, v108, v136, vcc
    v_cndmask_b32 v109, v109, v137, vcc
    v_cndmask_b32 v110, v110, v138, vcc
    v_cndmask_b32 v111, v111, v139, vcc
    v_cmp_eq_u32 vcc, 8, v66
    s_nop 1
    v_cndmask_b32 v108, v108, v140, vcc
    v_cndmask_b32 v109, v109, v141, vcc
    v_cndmask_b32 v110, v110, v142, vcc
    v_cndmask_b32 v111, v111, v143, vcc
    s_mov_b32 exec_lo, 0x01ff01ff
    s_mov_b32 exec_hi, 0x01ff01ff
    buffer_store_dwordx4 v[108:111], v67, s[4:7], s65 offen sc1
    s_mov_b64 exec, -1
L_nocs_69:
    s_mov_b32 s45, s66
    v_mov_b32 v8, s98
    v_mov_b32 v9, s99
    s_waitcnt vmcnt(0)
    s_mov_b64 exec, 1
    buffer_store_dwordx2 v[8:9], off, s[4:7], s44 sc1
    s_mov_b64 exec, -1
    s_mov_b64 exec, 1
    buffer_store_dwordx2 v[8:9], off, s[4:7], s45 sc1
    s_mov_b64 exec, -1
    s_mul_i32 s55, s20, 9216
    s_add_u32 s55, s55, 110592
    v_add_u32 v64, s55, v2
    ds_write_b128 v64, a[216:219] offset:0
    ds_write_b128 v64, a[220:223] offset:1024
    ds_write_b128 v64, a[224:227] offset:2048
    ds_write_b128 v64, a[228:231] offset:3072
    ds_write_b128 v64, a[232:235] offset:4096
    ds_write_b128 v64, a[236:239] offset:5120
    ds_write_b128 v64, a[240:243] offset:6144
    ds_write_b128 v64, a[244:247] offset:7168
    ds_write_b128 v64, a[248:251] offset:8192
    s_cmp_ge_u32 s31, 1152
    s_cbranch_scc1 L_ud_70
    s_mul_i32 s64, s31, 1821
    s_lshr_b32 s64, s64, 16
    s_mul_i32 s92, s64, 36
    s_sub_u32 s92, s31, s92
    s_and_b32 s93, s92, 1
    s_lshr_b32 s94, s92, 1
    s_mov_b32 s62, 0
    s_mov_b32 s63, 256
    s_mul_i32 s95, s64, 486
    s_add_u32 s95, s95, s92
    s_lshl_b32 s95, s95, 10
    s_add_u32 s69, s95, 4194304
    s_add_u32 s67, s69, 36864
    s_add_u32 s68, s69, 184320
    s_mov_b32 s70, 36864
    s_mov_b32 s71, 73728
    s_lshl_b32 s95, s64, 1
    s_add_u32 s95, s95, s93
    s_mul_i32 s95, s95, 18
    s_add_u32 s95, s95, s94
    s_mul_i32 s95, s95, 576
    s_add_u32 s65, s95, 2883584
    s_mov_b32 s66, s92
    s_branch L_udone_71
L_ud_70:
    s_sub_u32 s92, s31, 1152
    s_mul_i32 s64, s92, 3641
    s_lshr_b32 s64, s64, 16
    s_mul_i32 s93, s64, 18
    s_sub_u32 s92, s92, s93
    s_and_b32 s93, s64, 3
    s_and_b32 s94, s93, 1
    s_mov_b32 s65, 0
    s_lshl_b32 s62, s94, 5
    s_cmp_eq_u32 s94, 0
    s_cselect_b32 s63, 256, 0
    s_add_u32 s66, s92, 36
    s_mul_i32 s95, s64, 486
    s_add_u32 s95, s95, 324
    s_lshl_b32 s95, s95, 10
    s_add_u32 s95, s95, 4194304
    s_cmp_ge_u32 s92, 3
    s_cbranch_scc1 L_ub_72
    s_sub_u32 s96, s92, 0
    s_mov_b32 s70, 1024
    s_mov_b32 s71, 2048
    s_mul_i32 s97, s96, 5120
    s_add_u32 s97, s97, 0
    s_add_u32 s67, s97, s95
    s_mul_i32 s97, s96, 4096
    s_add_u32 s97, s97, 15360
    s_add_u32 s68, s97, s95
    s_mul_i32 s97, s96, 5120
    s_add_u32 s97, s97, 4096
    s_add_u32 s69, s97, s95
    s_branch L_udone_71
L_ub_72:
    s_cmp_ge_u32 s92, 9
    s_cbranch_scc1 L_uc_73
    s_sub_u32 s96, s92, 3
    s_mov_b32 s70, 1024
    s_mov_b32 s71, 2048
    s_mul_i32 s97, s96, 9216
    s_add_u32 s97, s97, 27648
    s_add_u32 s67, s97, s95
    s_mul_i32 s97, s96, 9216
    s_add_u32 s97, s97, 31744
    s_add_u32 s68, s97, s95
    s_mul_i32 s97, s96, 9216
    s_add_u32 s97, s97, 35840
    s_add_u32 s69, s97, s95
    s_branch L_udone_71
L_uc_73:
    s_sub_u32 s96, s92, 9
    s_mov_b32 s70, 1024
    s_mov_b32 s71, 18432
    s_mul_i32 s97, s96, 2048
    s_add_u32 s97, s97, 82944
    s_add_u32 s67, s97, s95
    s_mul_i32 s97, s96, 2048
    s_add_u32 s97, s97, 119808
    s_add_u32 s68, s97, s95
    s_mul_i32 s97, s96, 1024
    s_add_u32 s97, s97, 156672
    s_add_u32 s69, s97, s95
L_udone_71:
    s_lshl_b32 s95, s64, 6
    s_add_u32 s95, s95, s66
    s_lshl_b32 s95, s95, 3
    s_add_u32 s66, s95, 4071424
    v_lshrrev_b32 v64, 4, v1
    v_bfe_u32 v66, v1, 2, 2
    v_lshl_add_u32 v64, v64, 3, v66
    v_mul_u32_u24 v64, 288, v64
    v_add_u32 v64, s55, v64
    v_and_b32 v66, 3, v1
    v_lshl_add_u32 v65, v66, 3, v64
    v_add_u32 v65, s63, v65
    v_lshl_add_u32 v64, v66, 4, v64
    v_add_u32 v64, s62, v64
    ds_read_b64_tr_b16 v[72:73], v64 offset:0
    ds_read_b64_tr_b16 v[74:75], v64 offset:1152
    ds_read_b64_tr_b16 v[76:77], v64 offset:8
    ds_read_b64_tr_b16 v[78:79], v64 offset:1160
    ds_read_b64_tr_b16 v[80:81], v64 offset:64
    ds_read_b64_tr_b16 v[82:83], v64 offset:1216
    ds_read_b64_tr_b16 v[84:85], v64 offset:72
    ds_read_b64_tr_b16 v[86:87], v64 offset:1224
    ds_read_b64_tr_b16 v[88:89], v64 offset:128
    ds_read_b64_tr_b16 v[90:91], v64 offset:1280
    ds_read_b64_tr_b16 v[92:93], v64 offset:136
    ds_read_b64_tr_b16 v[94:95], v64 offset:1288
    ds_read_b64_tr_b16 v[96:97], v64 offset:192
    ds_read_b64_tr_b16 v[98:99], v64 offset:1344
    ds_read_b64_tr_b16 v[100:101], v64 offset:200
    ds_read_b64_tr_b16 v[102:103], v64 offset:1352
    ds_read_b64_tr_b16 v[104:105], v65 offset:0
    ds_read_b64_tr_b16 v[106:107], v65 offset:1152
    s_waitcnt lgkmcnt(15)
    buffer_store_dwordx4 v[72:75], v2, s[4:7], s67 offen sc1
    s_add_u32 s92, s67, s70
    s_waitcnt lgkmcnt(14)
    buffer_store_dwordx4 v[76:79], v2, s[4:7], s92 offen sc1
    s_add_u32 s92, s67, s71
    s_waitcnt lgkmcnt(12)
    buffer_store_dwordx4 v[80:83], v2, s[4:7], s92 offen sc1
    s_add_u32 s92, s92, s70
    s_waitcnt lgkmcnt(10)
    buffer_store_dwordx4 v[84:87], v2, s[4:7], s92 offen sc1
    s_waitcnt lgkmcnt(8)
    buffer_store_dwordx4 v[88:91], v2, s[4:7], s68 offen sc1
    s_add_u32 s92, s68, s70
    s_waitcnt lgkmcnt(6)
    buffer_store_dwordx4 v[92:95], v2, s[4:7], s92 offen sc1
    s_add_u32 s92, s68, s71
    s_waitcnt lgkmcnt(4)
    buffer_store_dwordx4 v[96:99], v2, s[4:7], s92 offen sc1
    s_add_u32 s92, s92, s70
    s_waitcnt lgkmcnt(2)
    buffer_store_dwordx4 v[100:103], v2, s[4:7], s92 offen sc1
    s_waitcnt lgkmcnt(0)
    buffer_store_dwordx4 v[104:107], v2, s[4:7], s69 offen sc1
    s_cmp_eq_u32 s65, 0
    s_cbranch_scc1 L_nocs_74
    v_mov_b32 v68, 0x3f803f80
    v_mov_b32 v69, 0x3f803f80
    v_mov_b32 v70, 0x3f803f80
    v_mov_b32 v71, 0x3f803f80
    s_nop 1
    v_mfma_f32_16x16x32_bf16 v[108:111], v[72:75], v[68:71], 0
    v_mfma_f32_16x16x32_bf16 v[112:115], v[76:79], v[68:71], 0
    v_mfma_f32_16x16x32_bf16 v[116:119], v[80:83], v[68:71], 0
    v_mfma_f32_16x16x32_bf16 v[120:123], v[84:87], v[68:71], 0
    v_mfma_f32_16x16x32_bf16 v[124:127], v[88:91], v[68:71], 0
    v_mfma_f32_16x16x32_bf16 v[128:131], v[92:95], v[68:71], 0
    v_mfma_f32_16x16x32_bf16 v[132:135], v[96:99], v[68:71], 0
    v_mfma_f32_16x16x32_bf16 v[136:139], v[100:103], v[68:71], 0
    v_mfma_f32_16x16x32_bf16 v[140:143], v[104:107], v[68:71], 0
    v_and_b32 v66, 15, v1
    v_add_u32 v67, 1, v66
    v_cmp_gt_u32 vcc, 8, v66
    v_and_b32 v64, 48, v1
    s_nop 0
    v_cndmask_b32 v67, 0, v67, vcc
    v_lshlrev_b32 v67, 6, v67
    v_add_u32 v67, v67, v64
    v_cmp_eq_u32 vcc, 1, v66
    s_nop 1
    v_cndmask_b32 v108, v108, v112, vcc
    v_cndmask_b32 v109, v109, v113, vcc
    v_cndmask_b32 v110, v110, v114, vcc
    v_cndmask_b32 v111, v111, v115, vcc
    v_cmp_eq_u32 vcc, 2, v66
    s_nop 1
    v_cndmask_b32 v108, v108, v116, vcc
    v_cndmask_b32 v109, v109, v117, vcc
    v_cndmask_b32 v110, v110, v118, vcc
    v_cndmask_b32 v111, v111, v119, vcc
    v_cmp_eq_u32 vcc, 3, v66
    s_nop 1
    v_cndmask_b32 v108, v108, v120, vcc
    v_cndmask_b32 v109, v109, v121, vcc
    v_cndmask_b32 v110, v110, v122, vcc
    v_cndmask_b32 v111, v111, v123, vcc
    v_cmp_eq_u32 vcc, 4, v66
    s_nop 1
    v_cndmask_b32 v108, v108, v124, vcc
    v_cndmask_b32 v109, v109, v125, vcc
    v_cndmask_b32 v110, v110, v126, vcc
    v_cndmask_b32 v111, v111, v127, vcc
    v_cmp_eq_u32 vcc, 5, v66
    s_nop 1
    v_cndmask_b32 v108, v108, v128, vcc
    v_cndmask_b32 v109, v109, v129, vcc
    v_cndmask_b32 v110, v110, v130, vcc
    v_cndmask_b32 v111, v111, v131, vcc
    v_cmp_eq_u32 vcc, 6, v66
    s_nop 1
    v_cndmask_b32 v108, v108, v132, vcc
    v_cndmask_b32 v109, v109, v133, vcc
    v_cndmask_b32 v110, v110, v134, vcc
    v_cndmask_b32 v111, v111, v135, vcc
    v_cmp_eq_u32 vcc, 7, v66
    s_nop 1
    v_cndmask_b32 v108, v108, v136, vcc
    v_cndmask_b32 v109, v109, v137, vcc
    v_cndmask_b32 v110, v110, v138, vcc
    v_cndmask_b32 v111, v111, v139, vcc
    v_cmp_eq_u32 vcc, 8, v66
    s_nop 1
    v_cndmask_b32 v108, v108, v140, vcc
    v_cndmask_b32 v109, v109, v141, vcc
    v_cndmask_b32 v110, v110, v142, vcc
    v_cndmask_b32 v111, v111, v143, vcc
    s_mov_b32 exec_lo, 0x01ff01ff
    s_mov_b32 exec_hi, 0x01ff01ff
    buffer_store_dwordx4 v[108:111], v67, s[4:7], s65 offen sc1
    s_mov_b64 exec, -1
L_nocs_74:
    s_mov_b32 s46, s66
    v_mov_b32 v8, s98
    v_mov_b32 v9, s99
    s_waitcnt vmcnt(0)
    s_mov_b64 exec, 1
    buffer_store_dwordx2 v[8:9], off, s[4:7], s46 sc1
    s_mov_b64 exec, -1
L_ffn_44:
    s_barrier
    s_lshr_b32 s44, s22, 3
    s_and_b32 s60, s21, 4
    s_add_u32 s44, s44, s60
    s_and_b32 s60, s21, 3
    s_lshl_b32 s60, s60, 3
    s_and_b32 s47, s22, 7
    s_add_u32 s47, s47, s60
    s_lshl_b32 s64, s47, 9
    s_add_u32 s64, s64, 4071424
    v_min_u32 v0, 35, v1
    v_lshlrev_b32 v0, 3, v0
    s_lshr_b32 s45, s47, 2
    s_and_b32 s46, s47, 3
    s_mul_i32 s48, s47, 497664
    s_add_u32 s48, s48, 4194304
    s_mul_i32 s63, s20, 9
    s_lshr_b32 s63, s63, 1
    s_lshl_b32 s63, s63, 10
    s_add_u32 s62, s48, s63
    s_mul_i32 s49, s20, 9216
    s_add_u32 s48, s48, s49
    s_lshl_b32 s54, s44, 4
    s_lshl_b32 s60, s20, 2
    s_add_u32 s54, s54, s60
    s_mul_i32 s50, s54, 18432
    s_mul_i32 s53, s45, 2359296
    s_add_u32 s53, s53, s50
    s_add_u32 s50, s50, 4718592
    s_add_u32 s50, s50, s100
    s_lshr_b32 s60, s46, 1
    s_mul_i32 s60, s60, 9216
    s_add_u32 s53, s53, s60
    s_add_u32 s53, s53, 29360128
    s_add_u32 s53, s53, s100
    v_lshlrev_b32 v3, 3, v1
    v_mov_b32 v4, v2
    s_cmp_lg_u32 s101, 0
    s_cbranch_scc1 L_nopw_78
    buffer_load_dwordx2 v[6:7], v0, s[4:7], s64 offen sc1
    s_waitcnt vmcnt(0)
    v_cmp_eq_u64 vcc, s[98:99], v[6:7]
    s_nop 0
    s_cmp_eq_u64 vcc, exec
    s_cbranch_scc0 L_pw_slow_75
L_pw_back_76:
L_nopw_78:
    s_add_u32 m0, s49, 0
    s_add_u32 s61, s48, 0
    buffer_load_dwordx4 v2, s[4:7], s61 offen offset:0 lds
    buffer_load_dwordx4 v2, s[4:7], s61 offen offset:1024 lds
    buffer_load_dwordx4 v2, s[4:7], s61 offen offset:2048 lds
    buffer_load_dwordx4 v2, s[4:7], s61 offen offset:3072 lds
    s_add_u32 m0, s49, 4096
    s_add_u32 s61, s48, 4096
    buffer_load_dwordx4 v2, s[4:7], s61 offen offset:0 lds
    buffer_load_dwordx4 v2, s[4:7], s61 offen offset:1024 lds
    buffer_load_dwordx4 v2, s[4:7], s61 offen offset:2048 lds
    buffer_load_dwordx4 v2, s[4:7], s61 offen offset:3072 lds
    s_add_u32 m0, s49, 8192
    s_add_u32 s61, s48, 8192
    buffer_load_dwordx4 v2, s[4:7], s61 offen offset:0 lds
    s_add_u32 m0, s49, 36864
    s_add_u32 s61, s48, 36864
    buffer_load_dwordx4 v2, s[4:7], s61 offen offset:0 lds
    buffer_load_dwordx4 v2, s[4:7], s61 offen offset:1024 lds
    buffer_load_dwordx4 v2, s[4:7], s61 offen offset:2048 lds
    buffer_load_dwordx4 v2, s[4:7], s61 offen offset:3072 lds
    s_add_u32 m0, s49, 40960
    s_add_u32 s61, s48, 40960
    buffer_load_dwordx4 v2, s[4:7], s61 offen offset:0 lds
    buffer_load_dwordx4 v2, s[4:7], s61 offen offset:1024 lds
    buffer_load_dwordx4 v2, s[4:7], s61 offen offset:2048 lds
    buffer_load_dwordx4 v2, s[4:7], s61 offen offset:3072 lds
    s_add_u32 m0, s49, 45056
    s_add_u32 s61, s48, 45056
    buffer_load_dwordx4 v2, s[4:7], s61 offen offset:0 lds
    s_cmp_lg_u32 s101, 0
    s_cbranch_scc1 L_nocs_79
    s_cmp_ge_u32 s20, 2
    s_cbranch_scc1 L_nocs_79
    s_lshl_b32 s60, s47, 1
    s_add_u32 s60, s60, s20
    s_mul_i32 s60, s60, 10368
    s_add_u32 s60, s60, 2883584
    v_lshrrev_b32 v6, 2, v1
    v_lshlrev_b32 v6, 7, v6
    v_and_b32 v7, 3, v1
    v_lshl_add_u32 v6, v7, 4, v6
    s_lshl_b32 s61, s20, 6
    s_add_u32 s61, s61, 147456
    v_add_u32 v6, s61, v6
    s_mov_b32 exec_hi, 15
    buffer_load_dwordx4 v[64:67], v2, s[4:7], s60 offen offset:0 sc1
    buffer_load_dwordx4 v[68:71], v2, s[4:7], s60 offen offset:576 sc1
    buffer_load_dwordx4 v[72:75], v2, s[4:7], s60 offen offset:1152 sc1
    buffer_load_dwordx4 v[76:79], v2, s[4:7], s60 offen offset:1728 sc1
    buffer_load_dwordx4 v[80:83], v2, s[4:7], s60 offen offset:2304 sc1
    buffer_load_dwordx4 v[84:87], v2, s[4:7], s60 offen offset:2880 sc1
    s_add_u32 s60, s60, 3456
    buffer_load_dwordx4 v[88:91], v2, s[4:7], s60 offen offset:0 sc1
    buffer_load_dwordx4 v[92:95], v2, s[4:7], s60 offen offset:576 sc1
    buffer_load_dwordx4 v[96:99], v2, s[4:7], s60 offen offset:1152 sc1
    buffer_load_dwordx4 v[100:103], v2, s[4:7], s60 offen offset:1728 sc1
    buffer_load_dwordx4 v[104:107], v2, s[4:7], s60 offen offset:2304 sc1
    buffer_load_dwordx4 v[108:111], v2, s[4:7], s60 offen offset:2880 sc1
    s_add_u32 s60, s60, 3456
    buffer_load_dwordx4 v[112:115], v2, s[4:7], s60 offen offset:0 sc1
    buffer_load_dwordx4 v[116:119], v2, s[4:7], s60 offen offset:576 sc1
    buffer_load_dwordx4 v[120:123], v2, s[4:7], s60 offen offset:1152 sc1
    buffer_load_dwordx4 v[124:127], v2, s[4:7], s60 offen offset:1728 sc1
    buffer_load_dwordx4 v[128:131], v2, s[4:7], s60 offen offset:2304 sc1
    buffer_load_dwordx4 v[132:135], v2, s[4:7], s60 offen offset:2880 sc1
    s_waitcnt vmcnt(16)
    v_add_f32 v64, v64, v68
    v_add_f32 v65, v65, v69
    v_add_f32 v66, v66, v70
    v_add_f32 v67, v67, v71
    s_waitcnt vmcnt(15)
    v_add_f32 v64, v64, v72
    v_add_f32 v65, v65, v73
    v_add_f32 v66, v66, v74
    v_add_f32 v67, v67, v75
    s_waitcnt vmcnt(14)
    v_add_f32 v64, v64, v76
    v_add_f32 v65, v65, v77
    v_add_f32 v66, v66, v78
    v_add_f32 v67, v67, v79
    s_waitcnt vmcnt(13)
    v_add_f32 v64, v64, v80
    v_add_f32 v65, v65, v81
    v_add_f32 v66, v66, v82
    v_add_f32 v67, v67, v83
    s_waitcnt vmcnt(12)
    v_add_f32 v64, v64, v84
    v_add_f32 v65, v65, v85
    v_add_f32 v66, v66, v86
    v_add_f32 v67, v67, v87
    s_waitcnt vmcnt(11)
    v_add_f32 v64, v64, v88
    v_add_f32 v65, v65, v89
    v_add_f32 v66, v66, v90
    v_add_f32 v67, v67, v91
    s_waitcnt vmcnt(10)
    v_add_f32 v64, v64, v92
    v_add_f32 v65, v65, v93
    v_add_f32 v66, v66, v94
    v_add_f32 v67, v67, v95
    s_waitcnt vmcnt(9)
    v_add_f32 v64, v64, v96
    v_add_f32 v65, v65, v97
    v_add_f32 v66, v66, v98
    v_add_f32 v67, v67, v99
    s_waitcnt vmcnt(8)
    v_add_f32 v64, v64, v100
    v_add_f32 v65, v65, v101
    v_add_f32 v66, v66, v102
    v_add_f32 v67, v67, v103
    s_waitcnt vmcnt(7)
    v_add_f32 v64, v64, v104
    v_add_f32 v65, v65, v105
    v_add_f32 v66, v66, v106
    v_add_f32 v67, v67, v107
    s_waitcnt vmcnt(6)
    v_add_f32 v64, v64, v108
    v_add_f32 v65, v65, v109
    v_add_f32 v66, v66, v110
    v_add_f32 v67, v67, v111
    s_waitcnt vmcnt(5)
    v_add_f32 v64, v64, v112
    v_add_f32 v65, v65, v113
    v_add_f32 v66, v66, v114
    v_add_f32 v67, v67, v115
    s_waitcnt vmcnt(4)
    v_add_f32 v64, v64, v116
    v_add_f32 v65, v65, v117
    v_add_f32 v66, v66, v118
    v_add_f32 v67, v67, v119
    s_waitcnt vmcnt(3)
    v_add_f32 v64, v64, v120
    v_add_f32 v65, v65, v121
    v_add_f32 v66, v66, v122
    v_add_f32 v67, v67, v123
    s_waitcnt vmcnt(2)
    v_add_f32 v64, v64, v124
    v_add_f32 v65, v65, v125
    v_add_f32 v66, v66, v126
    v_add_f32 v67, v67, v127
    s_waitcnt vmcnt(1)
    v_add_f32 v64, v64, v128
    v_add_f32 v65, v65, v129
    v_add_f32 v66, v66, v130
    v_add_f32 v67, v67, v131
    s_waitcnt vmcnt(0)
    v_add_f32 v64, v64, v132
    v_add_f32 v65, v65, v133
    v_add_f32 v66, v66, v134
    v_add_f32 v67, v67, v135
    ds_write_b128 v6, v[64:67]
    s_mov_b64 exec, -1
    s_waitcnt lgkmcnt(0)
L_nocs_79:
    s_lshr_b32 s60, s54, 2
    s_lshl_b32 s60, s60, 8
    s_add_u32 s55, s101, 3964928
    v_and_b32 v7, 7, v1
    v_min_u32 v7, 5, v7
    v_and_b32 v6, 24, v1
    v_add_lshl_u32 v0, v7, v6, 3
    v_add_u32 v0, s60, v0
    s_lshl_b32 s60, s21, 4
    s_lshr_b32 s61, s22, 1
    s_add_u32 s60, s60, s61
    s_lshl_b32 s60, s60, 6
    v_lshl_add_u32 v7, v7, 3, s60
    v_cmp_gt_u32 vcc, 32, v1
    s_nop 1
    v_cndmask_b32 v0, v7, v0, vcc
    buffer_load_dwordx2 v[6:7], v0, s[4:7], s55 offen sc1
    s_lshl_b32 s60, s44, 5
    s_add_u32 s60, s60, s47
    s_mul_i32 s51, s60, 73728
    s_add_u32 s51, s51, 9699328
    s_add_u32 s51, s51, s100
    s_xor_b32 s61, s60, 1
    s_mul_i32 s56, s61, 73728
    s_add_u32 s56, s56, 9699328
    s_add_u32 s56, s56, s100
    s_xor_b32 s61, s60, 2
    s_mul_i32 s57, s61, 73728
    s_add_u32 s57, s57, 9699328
    s_add_u32 s57, s57, s100
    s_xor_b32 s61, s60, 3
    s_mul_i32 s58, s61, 73728
    s_add_u32 s58, s58, 9699328
    s_add_u32 s58, s58, s100
    s_lshr_b32 s52, s60, 2
    s_lshl_b32 s52, s52, 2
    s_add_u32 s52, s52, s20
    s_lshl_b32 s52, s52, 7
    s_lshl_b32 s61, s101, 2
    s_add_u32 s52, s52, s61
    s_add_u32 s52, s52, 3981312
    v_lshrrev_b32 v5, 4, v1
    v_lshlrev_b32 v5, 4, v5
    v_add_u32 v5, 147456, v5
    s_lshl_b32 s60, s20, 12
    s_add_u32 s51, s51, s60
    s_add_u32 s56, s56, s60
    s_add_u32 s57, s57, s60
    s_add_u32 s58, s58, s60
    s_lshl_b32 s65, s20, 11
    s_sub_u32 s65, 65536, s65
    s_lshl_b32 s67, s46, 3
    s_add_u32 s67, s67, s52
    s_waitcnt vmcnt(1)
    s_barrier
    ds_read_b128 v[8:11], v4 offset:0
    ds_read_b128 v[12:15], v4 offset:1024
    ds_read_b128 v[16:19], v4 offset:36864
    ds_read_b128 v[20:23], v4 offset:37888
    s_and_b32 s61, s22, 7
    s_mul_i32 s61, s61, 9216
    s_add_u32 s61, s61, s50
    s_waitcnt vmcnt(0)
    v_cmp_eq_u64 vcc, s[98:99], v[6:7]
    s_nop 0
    s_cmp_eq_u64 vcc, exec
    s_cbranch_scc0 L_p1_slow_80
L_p1_back_81:
    s_add_u32 s59, s50, 0
    buffer_load_dwordx4 a[0:3], v2, s[4:7], s59 offen offset:0 sc1
    s_add_u32 s66, s50, 18432
    buffer_load_dwordx4 a[4:7], v2, s[4:7], s66 offen offset:0 sc1
    s_add_u32 s68, s50, 36864
    buffer_load_dwordx4 a[8:11], v2, s[4:7], s68 offen offset:0 sc1
    s_add_u32 s69, s50, 55296
    buffer_load_dwordx4 a[12:15], v2, s[4:7], s69 offen offset:0 sc1
    buffer_load_dwordx4 a[16:19], v2, s[4:7], s59 offen offset:1024 sc1
    buffer_load_dwordx4 a[20:23], v2, s[4:7], s66 offen offset:1024 sc1
    buffer_load_dwordx4 a[24:27], v2, s[4:7], s68 offen offset:1024 sc1
    buffer_load_dwordx4 a[28:31], v2, s[4:7], s69 offen offset:1024 sc1
    buffer_load_dwordx4 a[32:35], v2, s[4:7], s59 offen offset:2048 sc1
    buffer_load_dwordx4 a[36:39], v2, s[4:7], s66 offen offset:2048 sc1
    buffer_load_dwordx4 a[40:43], v2, s[4:7], s68 offen offset:2048 sc1
    buffer_load_dwordx4 a[44:47], v2, s[4:7], s69 offen offset:2048 sc1
    buffer_load_dwordx4 a[48:51], v2, s[4:7], s59 offen offset:3072 sc1
    buffer_load_dwordx4 a[52:55], v2, s[4:7], s66 offen offset:3072 sc1
    buffer_load_dwordx4 a[56:59], v2, s[4:7], s68 offen offset:3072 sc1
    buffer_load_dwordx4 a[60:63], v2, s[4:7], s69 offen offset:3072 sc1
    s_lshl_b32 s60, s54, 4
    v_add_u32 v6, s60, v1
    v_lshlrev_b32 v6, 3, v6
    s_add_u32 s55, s100, 7077888
    s_add_u32 s60, s55, 0
    buffer_load_dwordx2 v[152:153], v6, s[4:7], s60 offen sc1
    s_add_u32 s60, s55, 16384
    buffer_load_dwordx2 v[154:155], v6, s[4:7], s60 offen sc1
    s_add_u32 s60, s55, 32768
    buffer_load_dwordx2 v[156:157], v6, s[4:7], s60 offen sc1
    s_add_u32 s60, s55, 49152
    buffer_load_dwordx2 v[158:159], v6, s[4:7], s60 offen sc1
    s_add_u32 s60, s55, 65536
    buffer_load_dwordx2 v[160:161], v6, s[4:7], s60 offen sc1
    s_add_u32 s60, s55, 81920
    buffer_load_dwordx2 v[162:163], v6, s[4:7], s60 offen sc1
    v_add_u32 v7, 0x10000, v2
    s_waitcnt vmcnt(21) lgkmcnt(3)
    s_add_u32 s59, s50, 4096
    v_mfma_f32_16x16x32_bf16 v[208:211], v[8:11], a[0:3], 0
    s_waitcnt vmcnt(20)
    ds_read_b128 v[24:27], v4 offset:2048
    v_mfma_f32_16x16x32_bf16 v[212:215], v[8:11], a[4:7], 0
    buffer_load_dwordx4 a[64:67], v2, s[4:7], s59 offen offset:0 sc1
    s_waitcnt vmcnt(20)
    v_mfma_f32_16x16x32_bf16 v[216:219], v[8:11], a[8:11], 0
    s_waitcnt vmcnt(19)
    s_add_u32 s66, s50, 22528
    v_mfma_f32_16x16x32_bf16 v[220:223], v[8:11], a[12:15], 0
    s_waitcnt lgkmcnt(3)
    v_mfma_f32_16x16x32_bf16 v[224:227], v[12:15], a[0:3], 0
    ds_read_b128 v[28:31], v4 offset:3072
    v_mfma_f32_16x16x32_bf16 v[228:231], v[12:15], a[4:7], 0
    buffer_load_dwordx4 a[68:71], v2, s[4:7], s66 offen offset:0 sc1
    v_mfma_f32_16x16x32_bf16 v[232:235], v[12:15], a[8:11], 0
    s_add_u32 s68, s50, 40960
    v_mfma_f32_16x16x32_bf16 v[236:239], v[12:15], a[12:15], 0
    s_waitcnt lgkmcnt(3)
    v_mfma_f32_16x16x32_bf16 v[64:67], v[16:19], a[0:3], 0
    ds_read_b128 v[8:11], v4 offset:38912
    v_mfma_f32_16x16x32_bf16 v[68:71], v[16:19], a[4:7], 0
    buffer_load_dwordx4 a[72:75], v2, s[4:7], s68 offen offset:0 sc1
    v_mfma_f32_16x16x32_bf16 v[72:75], v[16:19], a[8:11], 0
    s_add_u32 s69, s50, 59392
    v_mfma_f32_16x16x32_bf16 v[76:79], v[16:19], a[12:15], 0
    s_waitcnt lgkmcnt(3)
    v_mfma_f32_16x16x32_bf16 v[80:83], v[20:23], a[0:3], 0
    ds_read_b128 v[12:15], v4 offset:39936
    v_mfma_f32_16x16x32_bf16 v[84:87], v[20:23], a[4:7], 0
    buffer_load_dwordx4 a[76:79], v2, s[4:7], s69 offen offset:0 sc1
    v_mfma_f32_16x16x32_bf16 v[88:91], v[20:23], a[8:11], 0
    v_mfma_f32_16x16x32_bf16 v[92:95], v[20:23], a[12:15], 0
    s_waitcnt vmcnt(21) lgkmcnt(3)
    v_mfma_f32_16x16x32_bf16 v[208:211], v[24:27], a[16:19], v[208:211]
    s_waitcnt vmcnt(20)
    ds_read_b128 v[16:19], v4 offset:4096
    v_mfma_f32_16x16x32_bf16 v[212:215], v[24:27], a[20:23], v[212:215]
    buffer_load_dwordx4 a[80:83], v2, s[4:7], s59 offen offset:1024 sc1
    s_waitcnt vmcnt(20)
    v_mfma_f32_16x16x32_bf16 v[216:219], v[24:27], a[24:27], v[216:219]
    s_waitcnt vmcnt(19)
    v_mfma_f32_16x16x32_bf16 v[220:223], v[24:27], a[28:31], v[220:223]
    s_waitcnt lgkmcnt(3)
    v_mfma_f32_16x16x32_bf16 v[224:227], v[28:31], a[16:19], v[224:227]
    ds_read_b128 v[20:23], v4 offset:5120
    v_mfma_f32_16x16x32_bf16 v[228:231], v[28:31], a[20:23], v[228:231]
    buffer_load_dwordx4 a[84:87], v2, s[4:7], s66 offen offset:1024 sc1
    v_mfma_f32_16x16x32_bf16 v[232:235], v[28:31], a[24:27], v[232:235]
    v_mfma_f32_16x16x32_bf16 v[236:239], v[28:31], a[28:31], v[236:239]
    s_waitcnt lgkmcnt(3)
    v_mfma_f32_16x16x32_bf16 v[64:67], v[8:11], a[16:19], v[64:67]
    ds_read_b128 v[24:27], v4 offset:40960
    v_mfma_f32_16x16x32_bf16 v[68:71], v[8:11], a[20:23], v[68:71]
    buffer_load_dwordx4 a[88:91], v2, s[4:7], s68 offen offset:1024 sc1
    v_mfma_f32_16x16x32_bf16 v[72:75], v[8:11], a[24:27], v[72:75]
    v_mfma_f32_16x16x32_bf16 v[76:79], v[8:11], a[28:31], v[76:79]
    s_waitcnt lgkmcnt(3)
    v_mfma_f32_16x16x32_bf16 v[80:83], v[12:15], a[16:19], v[80:83]
    ds_read_b128 v[28:31], v4 offset:41984
    v_mfma_f32_16x16x32_bf16 v[84:87], v[12:15], a[20:23], v[84:87]
    buffer_load_dwordx4 a[92:95], v2, s[4:7], s69 offen offset:1024 sc1
    v_mfma_f32_16x16x32_bf16 v[88:91], v[12:15], a[24:27], v[88:91]
    v_mfma_f32_16x16x32_bf16 v[92:95], v[12:15], a[28:31], v[92:95]
    s_waitcnt vmcnt(21) lgkmcnt(3)
    v_mfma_f32_16x16x32_bf16 v[208:211], v[16:19], a[32:35], v[208:211]
    s_waitcnt vmcnt(20)
    ds_read_b128 v[8:11], v4 offset:6144
    v_mfma_f32_16x16x32_bf16 v[212:215], v[16:19], a[36:39], v[212:215]
    buffer_load_dwordx4 a[96:99], v2, s[4:7], s59 offen offset:2048 sc1
    s_waitcnt vmcnt(20)
    v_mfma_f32_16x16x32_bf16 v[216:219], v[16:19], a[40:43], v[216:219]
    s_waitcnt vmcnt(19)
    v_mfma_f32_16x16x32_bf16 v[220:223], v[16:19], a[44:47], v[220:223]
    s_waitcnt lgkmcnt(3)
    v_mfma_f32_16x16x32_bf16 v[224:227], v[20:23], a[32:35], v[224:227]
    ds_read_b128 v[12:15], v4 offset:7168
    v_mfma_f32_16x16x32_bf16 v[228:231], v[20:23], a[36:39], v[228:231]
    buffer_load_dwordx4 a[100:103], v2, s[4:7], s66 offen offset:2048 sc1
    v_mfma_f32_16x16x32_bf16 v[232:235], v[20:23], a[40:43], v[232:235]
    v_mfma_f32_16x16x32_bf16 v[236:239], v[20:23], a[44:47], v[236:239]
    s_waitcnt lgkmcnt(3)
    v_mfma_f32_16x16x32_bf16 v[64:67], v[24:27], a[32:35], v[64:67]
    ds_read_b128 v[16:19], v4 offset:43008
    v_mfma_f32_16x16x32_bf16 v[68:71], v[24:27], a[36:39], v[68:71]
    buffer_load_dwordx4 a[104:107], v2, s[4:7], s68 offen offset:2048 sc1
    v_mfma_f32_16x16x32_bf16 v[72:75], v[24:27], a[40:43], v[72:75]
    v_mfma_f32_16x16x32_bf16 v[76:79], v[24:27], a[44:47], v[76:79]
    s_waitcnt lgkmcnt(3)
    v_mfma_f32_16x16x32_bf16 v[80:83], v[28:31], a[32:35], v[80:83]
    ds_read_b128 v[20:23], v4 offset:44032
    v_mfma_f32_16x16x32_bf16 v[84:87], v[28:31], a[36:39], v[84:87]
    buffer_load_dwordx4 a[108:111], v2, s[4:7], s69 offen offset:2048 sc1
    v_mfma_f32_16x16x32_bf16 v[88:91], v[28:31], a[40:43], v[88:91]
    v_mfma_f32_16x16x32_bf16 v[92:95], v[28:31], a[44:47], v[92:95]
    s_waitcnt vmcnt(21) lgkmcnt(3)
    v_mfma_f32_16x16x32_bf16 v[208:211], v[8:11], a[48:51], v[208:211]
    s_waitcnt vmcnt(20)
    ds_read_b128 v[24:27], v4 offset:8192
    v_mfma_f32_16x16x32_bf16 v[212:215], v[8:11], a[52:55], v[212:215]
    buffer_load_dwordx4 a[112:115], v2, s[4:7], s59 offen offset:3072 sc1
    s_waitcnt vmcnt(20)
    v_mfma_f32_16x16x32_bf16 v[216:219], v[8:11], a[56:59], v[216:219]
    s_waitcnt vmcnt(19)
    v_mfma_f32_16x16x32_bf16 v[220:223], v[8:11], a[60:63], v[220:223]
    s_waitcnt lgkmcnt(3)
    v_mfma_f32_16x16x32_bf16 v[224:227], v[12:15], a[48:51], v[224:227]
    ds_read_b128 v[28:31], v4 offset:9216
    v_mfma_f32_16x16x32_bf16 v[228:231], v[12:15], a[52:55], v[228:231]
    buffer_load_dwordx4 a[116:119], v2, s[4:7], s66 offen offset:3072 sc1
    v_mfma_f32_16x16x32_bf16 v[232:235], v[12:15], a[56:59], v[232:235]
    v_mfma_f32_16x16x32_bf16 v[236:239], v[12:15], a[60:63], v[236:239]
    s_waitcnt lgkmcnt(3)
    v_mfma_f32_16x16x32_bf16 v[64:67], v[16:19], a[48:51], v[64:67]
    ds_read_b128 v[8:11], v4 offset:45056
    v_mfma_f32_16x16x32_bf16 v[68:71], v[16:19], a[52:55], v[68:71]
    buffer_load_dwordx4 a[120:123], v2, s[4:7], s68 offen offset:3072 sc1
    v_mfma_f32_16x16x32_bf16 v[72:75], v[16:19], a[56:59], v[72:75]
    v_mfma_f32_16x16x32_bf16 v[76:79], v[16:19], a[60:63], v[76:79]
    s_waitcnt lgkmcnt(3)
    v_mfma_f32_16x16x32_bf16 v[80:83], v[20:23], a[48:51], v[80:83]
    ds_read_b128 v[12:15], v4 offset:46080
    v_mfma_f32_16x16x32_bf16 v[84:87], v[20:23], a[52:55], v[84:87]
    buffer_load_dwordx4 a[124:127], v2, s[4:7], s69 offen offset:3072 sc1
    v_mfma_f32_16x16x32_bf16 v[88:91], v[20:23], a[56:59], v[88:91]
    s_add_u32 s59, s50, 8192
    v_mfma_f32_16x16x32_bf16 v[92:95], v[20:23], a[60:63], v[92:95]
    s_waitcnt vmcnt(15) lgkmcnt(3)
    v_mfma_f32_16x16x32_bf16 v[208:211], v[24:27], a[64:67], v[208:211]
    s_waitcnt vmcnt(14)
    ds_read_b128 v[16:19], v4 offset:10240
    v_mfma_f32_16x16x32_bf16 v[212:215], v[24:27], a[68:71], v[212:215]
    buffer_load_dwordx4 a[128:131], v2, s[4:7], s59 offen offset:0 sc1
    s_waitcnt vmcnt(14)
    v_mfma_f32_16x16x32_bf16 v[216:219], v[24:27], a[72:75], v[216:219]
    s_waitcnt vmcnt(13)
    s_add_u32 s66, s50, 26624
    v_mfma_f32_16x16x32_bf16 v[220:223], v[24:27], a[76:79], v[220:223]
    s_waitcnt lgkmcnt(3)
    v_mfma_f32_16x16x32_bf16 v[224:227], v[28:31], a[64:67], v[224:227]
    ds_read_b128 v[20:23], v4 offset:11264
    v_mfma_f32_16x16x32_bf16 v[228:231], v[28:31], a[68:71], v[228:231]
    buffer_load_dwordx4 a[132:135], v2, s[4:7], s66 offen offset:0 sc1
    v_mfma_f32_16x16x32_bf16 v[232:235], v[28:31], a[72:75], v[232:235]
    s_add_u32 s68, s50, 45056
    v_mfma_f32_16x16x32_bf16 v[236:239], v[28:31], a[76:79], v[236:239]
    s_waitcnt lgkmcnt(3)
    v_mfma_f32_16x16x32_bf16 v[64:67], v[8:11], a[64:67], v[64:67]
    ds_read_b128 v[24:27], v4 offset:47104
    v_mfma_f32_16x16x32_bf16 v[68:71], v[8:11], a[68:71], v[68:71]
    buffer_load_dwordx4 a[136:139], v2, s[4:7], s68 offen offset:0 sc1
    v_mfma_f32_16x16x32_bf16 v[72:75], v[8:11], a[72:75], v[72:75]
    s_add_u32 s69, s50, 63488
    v_mfma_f32_16x16x32_bf16 v[76:79], v[8:11], a[76:79], v[76:79]
    s_waitcnt lgkmcnt(3)
    v_mfma_f32_16x16x32_bf16 v[80:83], v[12:15], a[64:67], v[80:83]
    ds_read_b128 v[28:31], v4 offset:48128
    v_mfma_f32_16x16x32_bf16 v[84:87], v[12:15], a[68:71], v[84:87]
    buffer_load_dwordx4 a[140:143], v2, s[4:7], s69 offen offset:0 sc1
    v_mfma_f32_16x16x32_bf16 v[88:91], v[12:15], a[72:75], v[88:91]
    v_mfma_f32_16x16x32_bf16 v[92:95], v[12:15], a[76:79], v[92:95]
    s_waitcnt vmcnt(15) lgkmcnt(3)
    v_mfma_f32_16x16x32_bf16 v[208:211], v[16:19], a[80:83], v[208:211]
    s_waitcnt vmcnt(14)
    ds_read_b128 v[8:11], v4 offset:12288
    v_mfma_f32_16x16x32_bf16 v[212:215], v[16:19], a[84:87], v[212:215]
    buffer_load_dwordx4 a[144:147], v2, s[4:7], s59 offen offset:1024 sc1
    s_waitcnt vmcnt(14)
    v_mfma_f32_16x16x32_bf16 v[216:219], v[16:19], a[88:91], v[216:219]
    s_waitcnt vmcnt(13)
    v_mfma_f32_16x16x32_bf16 v[220:223], v[16:19], a[92:95], v[220:223]
    s_waitcnt lgkmcnt(3)
    v_mfma_f32_16x16x32_bf16 v[224:227], v[20:23], a[80:83], v[224:227]
    ds_read_b128 v[12:15], v4 offset:13312
    v_mfma_f32_16x16x32_bf16 v[228:231], v[20:23], a[84:87], v[228:231]
    buffer_load_dwordx4 a[148:151], v2, s[4:7], s66 offen offset:1024 sc1
    v_mfma_f32_16x16x32_bf16 v[232:235], v[20:23], a[88:91], v[232:235]
    v_mfma_f32_16x16x32_bf16 v[236:239], v[20:23], a[92:95], v[236:239]
    s_waitcnt lgkmcnt(3)
    v_mfma_f32_16x16x32_bf16 v[64:67], v[24:27], a[80:83], v[64:67]
    ds_read_b128 v[16:19], v4 offset:49152
    v_mfma_f32_16x16x32_bf16 v[68:71], v[24:27], a[84:87], v[68:71]
    buffer_load_dwordx4 a[152:155], v2, s[4:7], s68 offen offset:1024 sc1
    v_mfma_f32_16x16x32_bf16 v[72:75], v[24:27], a[88:91], v[72:75]
    v_mfma_f32_16x16x32_bf16 v[76:79], v[24:27], a[92:95], v[76:79]
    s_waitcnt lgkmcnt(3)
    v_mfma_f32_16x16x32_bf16 v[80:83], v[28:31], a[80:83], v[80:83]
    ds_read_b128 v[20:23], v4 offset:50176
    v_mfma_f32_16x16x32_bf16 v[84:87], v[28:31], a[84:87], v[84:87]
    buffer_load_dwordx4 a[156:159], v2, s[4:7], s69 offen offset:1024 sc1
    v_mfma_f32_16x16x32_bf16 v[88:91], v[28:31], a[88:91], v[88:91]
    v_mfma_f32_16x16x32_bf16 v[92:95], v[28:31], a[92:95], v[92:95]
    s_waitcnt vmcnt(15) lgkmcnt(3)
    v_mfma_f32_16x16x32_bf16 v[208:211], v[8:11], a[96:99], v[208:211]
    s_waitcnt vmcnt(14)
    ds_read_b128 v[24:27], v4 offset:14336
    v_mfma_f32_16x16x32_bf16 v[212:215], v[8:11], a[100:103], v[212:215]
    buffer_load_dwordx4 a[160:163], v2, s[4:7], s59 offen offset:2048 sc1
    s_waitcnt vmcnt(14)
    v_mfma_f32_16x16x32_bf16 v[216:219], v[8:11], a[104:107], v[216:219]
    s_waitcnt vmcnt(13)
    v_mfma_f32_16x16x32_bf16 v[220:223], v[8:11], a[108:111], v[220:223]
    s_waitcnt lgkmcnt(3)
    v_mfma_f32_16x16x32_bf16 v[224:227], v[12:15], a[96:99], v[224:227]
    ds_read_b128 v[28:31], v4 offset:15360
    v_mfma_f32_16x16x32_bf16 v[228:231], v[12:15], a[100:103], v[228:231]
    buffer_load_dwordx4 a[164:167], v2, s[4:7], s66 offen offset:2048 sc1
    v_mfma_f32_16x16x32_bf16 v[232:235], v[12:15], a[104:107], v[232:235]
    v_mfma_f32_16x16x32_bf16 v[236:239], v[12:15], a[108:111], v[236:239]
    s_waitcnt lgkmcnt(3)
    v_mfma_f32_16x16x32_bf16 v[64:67], v[16:19], a[96:99], v[64:67]
    ds_read_b128 v[8:11], v4 offset:51200
    v_mfma_f32_16x16x32_bf16 v[68:71], v[16:19], a[100:103], v[68:71]
    buffer_load_dwordx4 a[168:171], v2, s[4:7], s68 offen offset:2048 sc1
    v_mfma_f32_16x16x32_bf16 v[72:75], v[16:19], a[104:107], v[72:75]
    v_mfma_f32_16x16x32_bf16 v[76:79], v[16:19], a[108:111], v[76:79]
    s_waitcnt lgkmcnt(3)
    v_mfma_f32_16x16x32_bf16 v[80:83], v[20:23], a[96:99], v[80:83]
    ds_read_b128 v[12:15], v4 offset:52224
    v_mfma_f32_16x16x32_bf16 v[84:87], v[20:23], a[100:103], v[84:87]
    buffer_load_dwordx4 a[172:175], v2, s[4:7], s69 offen offset:2048 sc1
    v_mfma_f32_16x16x32_bf16 v[88:91], v[20:23], a[104:107], v[88:91]
    v_mfma_f32_16x16x32_bf16 v[92:95], v[20:23], a[108:111], v[92:95]
    s_waitcnt vmcnt(15) lgkmcnt(3)
    v_mfma_f32_16x16x32_bf16 v[208:211], v[24:27], a[112:115], v[208:211]
    s_waitcnt vmcnt(14)
    ds_read_b128 v[16:19], v4 offset:16384
    v_mfma_f32_16x16x32_bf16 v[212:215], v[24:27], a[116:119], v[212:215]
    buffer_load_dwordx4 a[176:179], v2, s[4:7], s59 offen offset:3072 sc1
    s_waitcnt vmcnt(14)
    v_mfma_f32_16x16x32_bf16 v[216:219], v[24:27], a[120:123], v[216:219]
    s_waitcnt vmcnt(13)
    v_mfma_f32_16x16x32_bf16 v[220:223], v[24:27], a[124:127], v[220:223]
    s_waitcnt lgkmcnt(3)
    v_mfma_f32_16x16x32_bf16 v[224:227], v[28:31], a[112:115], v[224:227]
    ds_read_b128 v[20:23], v4 offset:17408
    v_mfma_f32_16x16x32_bf16 v[228:231], v[28:31], a[116:119], v[228:231]
    buffer_load_dwordx4 a[180:183], v2, s[4:7], s66 offen offset:3072 sc1
    v_mfma_f32_16x16x32_bf16 v[232:235], v[28:31], a[120:123], v[232:235]
    v_mfma_f32_16x16x32_bf16 v[236:239], v[28:31], a[124:127], v[236:239]
    s_waitcnt lgkmcnt(3)
    v_mfma_f32_16x16x32_bf16 v[64:67], v[8:11], a[112:115], v[64:67]
    ds_read_b128 v[24:27], v4 offset:53248
    v_mfma_f32_16x16x32_bf16 v[68:71], v[8:11], a[116:119], v[68:71]
    buffer_load_dwordx4 a[184:187], v2, s[4:7], s68 offen offset:3072 sc1
    v_mfma_f32_16x16x32_bf16 v[72:75], v[8:11], a[120:123], v[72:75]
    v_mfma_f32_16x16x32_bf16 v[76:79], v[8:11], a[124:127], v[76:79]
    s_waitcnt lgkmcnt(3)
    v_mfma_f32_16x16x32_bf16 v[80:83], v[12:15], a[112:115], v[80:83]
    ds_read_b128 v[28:31], v4 offset:54272
    v_mfma_f32_16x16x32_bf16 v[84:87], v[12:15], a[116:119], v[84:87]
    buffer_load_dwordx4 a[188:191], v2, s[4:7], s69 offen offset:3072 sc1
    v_mfma_f32_16x16x32_bf16 v[88:91], v[12:15], a[120:123], v[88:91]
    s_add_u32 s59, s50, 12288
    v_mfma_f32_16x16x32_bf16 v[92:95], v[12:15], a[124:127], v[92:95]
    s_waitcnt vmcnt(15) lgkmcnt(3)
    v_mfma_f32_16x16x32_bf16 v[208:211], v[16:19], a[128:131], v[208:211]
    s_waitcnt vmcnt(14)
    ds_read_b128 v[8:11], v4 offset:18432
    v_mfma_f32_16x16x32_bf16 v[212:215], v[16:19], a[132:135], v[212:215]
    buffer_load_dwordx4 a[192:195], v2, s[4:7], s59 offen offset:0 sc1
    s_waitcnt vmcnt(14)
    v_mfma_f32_16x16x32_bf16 v[216:219], v[16:19], a[136:139], v[216:219]
    s_waitcnt vmcnt(13)
    s_add_u32 s66, s50, 30720
    v_mfma_f32_16x16x32_bf16 v[220:223], v[16:19], a[140:143], v[220:223]
    s_waitcnt lgkmcnt(3)
    v_mfma_f32_16x16x32_bf16 v[224:227], v[20:23], a[128:131], v[224:227]
    ds_read_b128 v[12:15], v4 offset:19456
    v_mfma_f32_16x16x32_bf16 v[228:231], v[20:23], a[132:135], v[228:231]
    buffer_load_dwordx4 a[196:199], v2, s[4:7], s66 offen offset:0 sc1
    v_mfma_f32_16x16x32_bf16 v[232:235], v[20:23], a[136:139], v[232:235]
    s_add_u32 s68, s50, 49152
    v_mfma_f32_16x16x32_bf16 v[236:239], v[20:23], a[140:143], v[236:239]
    s_waitcnt lgkmcnt(3)
    v_mfma_f32_16x16x32_bf16 v[64:67], v[24:27], a[128:131], v[64:67]
    ds_read_b128 v[16:19], v4 offset:55296
    v_mfma_f32_16x16x32_bf16 v[68:71], v[24:27], a[132:135], v[68:71]
    buffer_load_dwordx4 a[200:203], v2, s[4:7], s68 offen offset:0 sc1
    v_mfma_f32_16x16x32_bf16 v[72:75], v[24:27], a[136:139], v[72:75]
    s_add_u32 s69, s50, 67584
    v_mfma_f32_16x16x32_bf16 v[76:79], v[24:27], a[140:143], v[76:79]
    s_waitcnt lgkmcnt(3)
    v_mfma_f32_16x16x32_bf16 v[80:83], v[28:31], a[128:131], v[80:83]
    ds_read_b128 v[20:23], v4 offset:56320
    v_mfma_f32_16x16x32_bf16 v[84:87], v[28:31], a[132:135], v[84:87]
    buffer_load_dwordx4 a[204:207], v2, s[4:7], s69 offen offset:0 sc1
    v_mfma_f32_16x16x32_bf16 v[88:91], v[28:31], a[136:139], v[88:91]
    v_mfma_f32_16x16x32_bf16 v[92:95], v[28:31], a[140:143], v[92:95]
    s_waitcnt vmcnt(15) lgkmcnt(3)
    v_mfma_f32_16x16x32_bf16 v[208:211], v[8:11], a[144:147], v[208:211]
    s_waitcnt vmcnt(14)
    ds_read_b128 v[24:27], v4 offset:20480
    v_mfma_f32_16x16x32_bf16 v[212:215], v[8:11], a[148:151], v[212:215]
    buffer_load_dwordx4 a[208:211], v2, s[4:7], s59 offen offset:1024 sc1
    s_waitcnt vmcnt(14)
    v_mfma_f32_16x16x32_bf16 v[216:219], v[8:11], a[152:155], v[216:219]
    s_waitcnt vmcnt(13)
    v_mfma_f32_16x16x32_bf16 v[220:223], v[8:11], a[156:159], v[220:223]
    s_waitcnt lgkmcnt(3)
    v_mfma_f32_16x16x32_bf16 v[224:227], v[12:15], a[144:147], v[224:227]
    ds_read_b128 v[28:31], v4 offset:21504
    v_mfma_f32_16x16x32_bf16 v[228:231], v[12:15], a[148:151], v[228:231]
    buffer_load_dwordx4 a[212:215], v2, s[4:7], s66 offen offset:1024 sc1
    v_mfma_f32_16x16x32_bf16 v[232:235], v[12:15], a[152:155], v[232:235]
    v_mfma_f32_16x16x32_bf16 v[236:239], v[12:15], a[156:159], v[236:239]
    s_waitcnt lgkmcnt(3)
    v_mfma_f32_16x16x32_bf16 v[64:67], v[16:19], a[144:147], v[64:67]
    ds_read_b128 v[8:11], v4 offset:57344
    v_mfma_f32_16x16x32_bf16 v[68:71], v[16:19], a[148:151], v[68:71]
    buffer_load_dwordx4 a[216:219], v2, s[4:7], s68 offen offset:1024 sc1
    v_mfma_f32_16x16x32_bf16 v[72:75], v[16:19], a[152:155], v[72:75]
    v_mfma_f32_16x16x32_bf16 v[76:79], v[16:19], a[156:159], v[76:79]
    s_waitcnt lgkmcnt(3)
    v_mfma_f32_16x16x32_bf16 v[80:83], v[20:23], a[144:147], v[80:83]
    ds_read_b128 v[12:15], v4 offset:58368
    v_mfma_f32_16x16x32_bf16 v[84:87], v[20:23], a[148:151], v[84:87]
    buffer_load_dwordx4 a[220:223], v2, s[4:7], s69 offen offset:1024 sc1
    v_mfma_f32_16x16x32_bf16 v[88:91], v[20:23], a[152:155], v[88:91]
    v_mfma_f32_16x16x32_bf16 v[92:95], v[20:23], a[156:159], v[92:95]
    s_waitcnt vmcnt(15) lgkmcnt(3)
    v_mfma_f32_16x16x32_bf16 v[208:211], v[24:27], a[160:163], v[208:211]
    s_waitcnt vmcnt(14)
    ds_read_b128 v[16:19], v4 offset:22528
    v_mfma_f32_16x16x32_bf16 v[212:215], v[24:27], a[164:167], v[212:215]
    buffer_load_dwordx4 a[224:227], v2, s[4:7], s59 offen offset:2048 sc1
    s_waitcnt vmcnt(14)
    v_mfma_f32_16x16x32_bf16 v[216:219], v[24:27], a[168:171], v[216:219]
    s_waitcnt vmcnt(13)
    v_mfma_f32_16x16x32_bf16 v[220:223], v[24:27], a[172:175], v[220:223]
    s_waitcnt lgkmcnt(3)
    v_mfma_f32_16x16x32_bf16 v[224:227], v[28:31], a[160:163], v[224:227]
    ds_read_b128 v[20:23], v4 offset:23552
    v_mfma_f32_16x16x32_bf16 v[228:231], v[28:31], a[164:167], v[228:231]
    buffer_load_dwordx4 a[228:231], v2, s[4:7], s66 offen offset:2048 sc1
    v_mfma_f32_16x16x32_bf16 v[232:235], v[28:31], a[168:171], v[232:235]
    v_mfma_f32_16x16x32_bf16 v[236:239], v[28:31], a[172:175], v[236:239]
    s_waitcnt lgkmcnt(3)
    v_mfma_f32_16x16x32_bf16 v[64:67], v[8:11], a[160:163], v[64:67]
    ds_read_b128 v[24:27], v4 offset:59392
    v_mfma_f32_16x16x32_bf16 v[68:71], v[8:11], a[164:167], v[68:71]
    buffer_load_dwordx4 a[232:235], v2, s[4:7], s68 offen offset:2048 sc1
    v_mfma_f32_16x16x32_bf16 v[72:75], v[8:11], a[168:171], v[72:75]
    v_mfma_f32_16x16x32_bf16 v[76:79], v[8:11], a[172:175], v[76:79]
    s_waitcnt lgkmcnt(3)
    v_mfma_f32_16x16x32_bf16 v[80:83], v[12:15], a[160:163], v[80:83]
    ds_read_b128 v[28:31], v4 offset:60416
    v_mfma_f32_16x16x32_bf16 v[84:87], v[12:15], a[164:167], v[84:87]
    buffer_load_dwordx4 a[236:239], v2, s[4:7], s69 offen offset:2048 sc1
    v_mfma_f32_16x16x32_bf16 v[88:91], v[12:15], a[168:171], v[88:91]
    v_mfma_f32_16x16x32_bf16 v[92:95], v[12:15], a[172:175], v[92:95]
    s_waitcnt vmcnt(15) lgkmcnt(3)
    v_mfma_f32_16x16x32_bf16 v[208:211], v[16:19], a[176:179], v[208:211]
    s_waitcnt vmcnt(14)
    ds_read_b128 v[8:11], v4 offset:24576
    v_mfma_f32_16x16x32_bf16 v[212:215], v[16:19], a[180:183], v[212:215]
    buffer_load_dwordx4 a[240:243], v2, s[4:7], s59 offen offset:3072 sc1
    s_waitcnt vmcnt(14)
    v_mfma_f32_16x16x32_bf16 v[216:219], v[16:19], a[184:187], v[216:219]
    s_waitcnt vmcnt(13)
    v_mfma_f32_16x16x32_bf16 v[220:223], v[16:19], a[188:191], v[220:223]
    s_waitcnt lgkmcnt(3)
    v_mfma_f32_16x16x32_bf16 v[224:227], v[20:23], a[176:179], v[224:227]
    ds_read_b128 v[12:15], v4 offset:25600
    v_mfma_f32_16x16x32_bf16 v[228:231], v[20:23], a[180:183], v[228:231]
    buffer_load_dwordx4 a[244:247], v2, s[4:7], s66 offen offset:3072 sc1
    v_mfma_f32_16x16x32_bf16 v[232:235], v[20:23], a[184:187], v[232:235]
    v_mfma_f32_16x16x32_bf16 v[236:239], v[20:23], a[188:191], v[236:239]
    s_waitcnt lgkmcnt(3)
    v_mfma_f32_16x16x32_bf16 v[64:67], v[24:27], a[176:179], v[64:67]
    ds_read_b128 v[16:19], v4 offset:61440
    v_mfma_f32_16x16x32_bf16 v[68:71], v[24:27], a[180:183], v[68:71]
    buffer_load_dwordx4 a[248:251], v2, s[4:7], s68 offen offset:3072 sc1
    v_mfma_f32_16x16x32_bf16 v[72:75], v[24:27], a[184:187], v[72:75]
    v_mfma_f32_16x16x32_bf16 v[76:79], v[24:27], a[188:191], v[76:79]
    s_waitcnt lgkmcnt(3)
    v_mfma_f32_16x16x32_bf16 v[80:83], v[28:31], a[176:179], v[80:83]
    ds_read_b128 v[20:23], v4 offset:62464
    v_mfma_f32_16x16x32_bf16 v[84:87], v[28:31], a[180:183], v[84:87]
    buffer_load_dwordx4 a[252:255], v2, s[4:7], s69 offen offset:3072 sc1
    v_mfma_f32_16x16x32_bf16 v[88:91], v[28:31], a[184:187], v[88:91]
    s_add_u32 s59, s50, 16384
    v_mfma_f32_16x16x32_bf16 v[92:95], v[28:31], a[188:191], v[92:95]
    s_waitcnt vmcnt(15) lgkmcnt(3)
    v_mfma_f32_16x16x32_bf16 v[208:211], v[8:11], a[192:195], v[208:211]
    s_waitcnt vmcnt(14)
    ds_read_b128 v[24:27], v4 offset:26624
    v_mfma_f32_16x16x32_bf16 v[212:215], v[8:11], a[196:199], v[212:215]
    buffer_load_dwordx4 v[32:35], v2, s[4:7], s59 offen offset:0 sc1
    s_waitcnt vmcnt(14)
    v_mfma_f32_16x16x32_bf16 v[216:219], v[8:11], a[200:203], v[216:219]
    s_waitcnt vmcnt(13)
    s_add_u32 s66, s50, 34816
    v_mfma_f32_16x16x32_bf16 v[220:223], v[8:11], a[204:207], v[220:223]
    s_waitcnt lgkmcnt(3)
    v_mfma_f32_16x16x32_bf16 v[224:227], v[12:15], a[192:195], v[224:227]
    ds_read_b128 v[28:31], v4 offset:27648
    v_mfma_f32_16x16x32_bf16 v[228:231], v[12:15], a[196:199], v[228:231]
    buffer_load_dwordx4 v[36:39], v2, s[4:7], s66 offen offset:0 sc1
    v_mfma_f32_16x16x32_bf16 v[232:235], v[12:15], a[200:203], v[232:235]
    s_add_u32 s68, s50, 53248
    v_mfma_f32_16x16x32_bf16 v[236:239], v[12:15], a[204:207], v[236:239]
    s_waitcnt lgkmcnt(3)
    s_add_u32 m0, s49, 73728
    s_add_u32 s61, s48, 73728
    v_mfma_f32_16x16x32_bf16 v[64:67], v[16:19], a[192:195], v[64:67]
    ds_read_b128 v[8:11], v4 offset:63488
    v_mfma_f32_16x16x32_bf16 v[68:71], v[16:19], a[196:199], v[68:71]
    buffer_load_dwordx4 v[40:43], v2, s[4:7], s68 offen offset:0 sc1
    v_mfma_f32_16x16x32_bf16 v[72:75], v[16:19], a[200:203], v[72:75]
    s_add_u32 s69, s50, 71680
    v_mfma_f32_16x16x32_bf16 v[76:79], v[16:19], a[204:207], v[76:79]
    s_waitcnt lgkmcnt(3)
    v_mfma_f32_16x16x32_bf16 v[80:83], v[20:23], a[192:195], v[80:83]
    ds_read_b128 v[12:15], v4 offset:64512
    v_mfma_f32_16x16x32_bf16 v[84:87], v[20:23], a[196:199], v[84:87]
    buffer_load_dwordx4 v[44:47], v2, s[4:7], s69 offen offset:0 sc1
    v_mfma_f32_16x16x32_bf16 v[88:91], v[20:23], a[200:203], v[88:91]
    v_mfma_f32_16x16x32_bf16 v[92:95], v[20:23], a[204:207], v[92:95]
    s_waitcnt vmcnt(15) lgkmcnt(3)
    v_mfma_f32_16x16x32_bf16 v[208:211], v[24:27], a[208:211], v[208:211]
    s_waitcnt vmcnt(14)
    ds_read_b128 v[16:19], v4 offset:28672
    v_mfma_f32_16x16x32_bf16 v[212:215], v[24:27], a[212:215], v[212:215]
    buffer_load_dwordx4 v[48:51], v2, s[4:7], s59 offen offset:1024 sc1
    s_waitcnt vmcnt(14)
    v_mfma_f32_16x16x32_bf16 v[216:219], v[24:27], a[216:219], v[216:219]
    s_waitcnt vmcnt(13)
    v_mfma_f32_16x16x32_bf16 v[220:223], v[24:27], a[220:223], v[220:223]
    s_waitcnt lgkmcnt(3)
    v_mfma_f32_16x16x32_bf16 v[224:227], v[28:31], a[208:211], v[224:227]
    ds_read_b128 v[20:23], v4 offset:29696
    v_mfma_f32_16x16x32_bf16 v[228:231], v[28:31], a[212:215], v[228:231]
    buffer_load_dwordx4 v[52:55], v2, s[4:7], s66 offen offset:1024 sc1
    v_mfma_f32_16x16x32_bf16 v[232:235], v[28:31], a[216:219], v[232:235]
    v_mfma_f32_16x16x32_bf16 v[236:239], v[28:31], a[220:223], v[236:239]
    s_waitcnt lgkmcnt(3)
    v_mfma_f32_16x16x32_bf16 v[64:67], v[8:11], a[208:211], v[64:67]
    ds_read_b128 v[24:27], v7 offset:0
    v_mfma_f32_16x16x32_bf16 v[68:71], v[8:11], a[212:215], v[68:71]
    buffer_load_dwordx4 v[56:59], v2, s[4:7], s68 offen offset:1024 sc1
    v_mfma_f32_16x16x32_bf16 v[72:75], v[8:11], a[216:219], v[72:75]
    v_mfma_f32_16x16x32_bf16 v[76:79], v[8:11], a[220:223], v[76:79]
    s_waitcnt lgkmcnt(3)
    v_mfma_f32_16x16x32_bf16 v[80:83], v[12:15], a[208:211], v[80:83]
    ds_read_b128 v[28:31], v7 offset:1024
    v_mfma_f32_16x16x32_bf16 v[84:87], v[12:15], a[212:215], v[84:87]
    buffer_load_dwordx4 v[60:63], v2, s[4:7], s69 offen offset:1024 sc1
    v_mfma_f32_16x16x32_bf16 v[88:91], v[12:15], a[216:219], v[88:91]
    v_mfma_f32_16x16x32_bf16 v[92:95], v[12:15], a[220:223], v[92:95]
    s_waitcnt vmcnt(15) lgkmcnt(3)
    v_mfma_f32_16x16x32_bf16 v[208:211], v[16:19], a[224:227], v[208:211]
    s_waitcnt vmcnt(14)
    ds_read_b128 v[8:11], v4 offset:30720
    v_mfma_f32_16x16x32_bf16 v[212:215], v[16:19], a[228:231], v[212:215]
    buffer_load_dwordx4 v2, s[4:7], s61 offen offset:0 lds
    s_waitcnt vmcnt(14)
    v_mfma_f32_16x16x32_bf16 v[216:219], v[16:19], a[232:235], v[216:219]
    s_waitcnt vmcnt(13)
    v_mfma_f32_16x16x32_bf16 v[220:223], v[16:19], a[236:239], v[220:223]
    s_waitcnt lgkmcnt(3)
    v_mfma_f32_16x16x32_bf16 v[224:227], v[20:23], a[224:227], v[224:227]
    ds_read_b128 v[12:15], v4 offset:31744
    v_mfma_f32_16x16x32_bf16 v[228:231], v[20:23], a[228:231], v[228:231]
    buffer_load_dwordx4 v2, s[4:7], s61 offen offset:1024 lds
    v_mfma_f32_16x16x32_bf16 v[232:235], v[20:23], a[232:235], v[232:235]
    v_mfma_f32_16x16x32_bf16 v[236:239], v[20:23], a[236:239], v[236:239]
    s_waitcnt lgkmcnt(3)
    v_mfma_f32_16x16x32_bf16 v[64:67], v[24:27], a[224:227], v[64:67]
    ds_read_b128 v[16:19], v7 offset:2048
    v_mfma_f32_16x16x32_bf16 v[68:71], v[24:27], a[228:231], v[68:71]
    buffer_load_dwordx4 v2, s[4:7], s61 offen offset:2048 lds
    v_mfma_f32_16x16x32_bf16 v[72:75], v[24:27], a[232:235], v[72:75]
    v_mfma_f32_16x16x32_bf16 v[76:79], v[24:27], a[236:239], v[76:79]
    s_waitcnt lgkmcnt(3)
    v_mfma_f32_16x16x32_bf16 v[80:83], v[28:31], a[224:227], v[80:83]
    ds_read_b128 v[20:23], v7 offset:3072
    v_mfma_f32_16x16x32_bf16 v[84:87], v[28:31], a[228:231], v[84:87]
    buffer_load_dwordx4 v2, s[4:7], s61 offen offset:3072 lds
    v_mfma_f32_16x16x32_bf16 v[88:91], v[28:31], a[232:235], v[88:91]
    s_add_u32 m0, s49, 77824
    s_add_u32 s61, s48, 77824
    v_add_f32 v166, v152, v154
    v_mfma_f32_16x16x32_bf16 v[92:95], v[28:31], a[236:239], v[92:95]
    s_waitcnt vmcnt(15) lgkmcnt(3)
    v_add_f32 v167, v153, v155
    v_add_f32 v166, v166, v156
    v_mfma_f32_16x16x32_bf16 v[208:211], v[8:11], a[240:243], v[208:211]
    s_waitcnt vmcnt(14)
    ds_read_b128 v[24:27], v4 offset:32768
    v_add_f32 v167, v167, v157
    v_mfma_f32_16x16x32_bf16 v[212:215], v[8:11], a[244:247], v[212:215]
    buffer_load_dwordx4 v2, s[4:7], s61 offen offset:0 lds
    s_waitcnt vmcnt(14)
    v_mfma_f32_16x16x32_bf16 v[216:219], v[8:11], a[248:251], v[216:219]
    s_waitcnt vmcnt(13)
    v_add_f32 v166, v166, v158
    v_add_f32 v167, v167, v159
    v_mfma_f32_16x16x32_bf16 v[220:223], v[8:11], a[252:255], v[220:223]
    s_waitcnt lgkmcnt(3)
    v_add_f32 v166, v166, v160
    v_add_f32 v167, v167, v161
    v_mfma_f32_16x16x32_bf16 v[224:227], v[12:15], a[240:243], v[224:227]
    ds_read_b128 v[28:31], v4 offset:33792
    v_add_f32 v166, v166, v162
    v_mfma_f32_16x16x32_bf16 v[228:231], v[12:15], a[244:247], v[228:231]
    buffer_load_dwordx4 v2, s[4:7], s61 offen offset:1024 lds
    v_mfma_f32_16x16x32_bf16 v[232:235], v[12:15], a[248:251], v[232:235]
    v_add_f32 v167, v167, v163
    v_mul_f32 v166, 0xbae38e39, v166
    v_mfma_f32_16x16x32_bf16 v[236:239], v[12:15], a[252:255], v[236:239]
    s_waitcnt lgkmcnt(3)
    v_fmamk_f32 v165, v152, 0x3c2aaaab, v166
    v_mul_f32 v164, v165, v165
    v_mfma_f32_16x16x32_bf16 v[64:67], v[16:19], a[240:243], v[64:67]
    ds_read_b128 v[8:11], v7 offset:4096
    v_fmamk_f32 v165, v154, 0x3c2aaaab, v166
    v_mfma_f32_16x16x32_bf16 v[68:71], v[16:19], a[244:247], v[68:71]
    buffer_load_dwordx4 v2, s[4:7], s61 offen offset:2048 lds
    v_mfma_f32_16x16x32_bf16 v[72:75], v[16:19], a[248:251], v[72:75]
    v_fmac_f32 v164, v165, v165
    v_fmamk_f32 v165, v156, 0x3c2aaaab, v166
    v_mfma_f32_16x16x32_bf16 v[76:79], v[16:19], a[252:255], v[76:79]
    s_waitcnt lgkmcnt(3)
    v_fmac_f32 v164, v165, v165
    v_fmamk_f32 v165, v158, 0x3c2aaaab, v166
    v_mfma_f32_16x16x32_bf16 v[80:83], v[20:23], a[240:243], v[80:83]
    ds_read_b128 v[12:15], v7 offset:5120
    v_fmac_f32 v164, v165, v165
    v_mfma_f32_16x16x32_bf16 v[84:87], v[20:23], a[244:247], v[84:87]
    buffer_load_dwordx4 v2, s[4:7], s61 offen offset:3072 lds
    v_mfma_f32_16x16x32_bf16 v[88:91], v[20:23], a[248:251], v[88:91]
    s_add_u32 m0, s49, 81920
    s_add_u32 s61, s48, 81920
    v_fmamk_f32 v165, v160, 0x3c2aaaab, v166
    v_mfma_f32_16x16x32_bf16 v[92:95], v[20:23], a[252:255], v[92:95]
    s_waitcnt vmcnt(15) lgkmcnt(3)
    v_fmac_f32 v164, v165, v165
    v_fmamk_f32 v165, v162, 0x3c2aaaab, v166
    v_mfma_f32_16x16x32_bf16 v[208:211], v[24:27], v[32:35], v[208:211]
    s_waitcnt vmcnt(14)
    ds_read_b128 v[16:19], v4 offset:34816
    v_fmac_f32 v164, v165, v165
    v_mfma_f32_16x16x32_bf16 v[212:215], v[24:27], v[36:39], v[212:215]
    buffer_load_dwordx4 v2, s[4:7], s61 offen offset:0 lds
    s_waitcnt vmcnt(14)
    v_mfma_f32_16x16x32_bf16 v[216:219], v[24:27], v[40:43], v[216:219]
    s_waitcnt vmcnt(13)
    s_add_u32 m0, s49, 110592
    s_add_u32 s61, s48, 110592
    v_fmac_f32 v167, 0x42c00000, v164
    v_mfma_f32_16x16x32_bf16 v[220:223], v[24:27], v[44:47], v[220:223]
    s_waitcnt lgkmcnt(3)
    v_mov_b32 v165, 0x3727c5ac
    v_fmac_f32 v165, 0x3ae38e39, v167
    v_mfma_f32_16x16x32_bf16 v[224:227], v[28:31], v[32:35], v[224:227]
    ds_read_b128 v[20:23], v4 offset:35840
    v_rcp_f32 v167, v165
    v_mfma_f32_16x16x32_bf16 v[228:231], v[28:31], v[36:39], v[228:231]
    buffer_load_dwordx4 v2, s[4:7], s61 offen offset:0 lds
    v_mfma_f32_16x16x32_bf16 v[232:235], v[28:31], v[40:43], v[232:235]
    v_and_b32 v164, 15, v1
    v_lshlrev_b32 v164, 2, v164
    v_mfma_f32_16x16x32_bf16 v[236:239], v[28:31], v[44:47], v[236:239]
    s_waitcnt lgkmcnt(3)
    ds_bpermute_b32 v128, v164, v166 offset:0
    ds_bpermute_b32 v132, v164, v167 offset:0
    v_mfma_f32_16x16x32_bf16 v[64:67], v[8:11], v[32:35], v[64:67]
    ds_read_b128 v[24:27], v7 offset:6144
    ds_bpermute_b32 v129, v164, v166 offset:64
    v_mfma_f32_16x16x32_bf16 v[68:71], v[8:11], v[36:39], v[68:71]
    buffer_load_dwordx4 v2, s[4:7], s61 offen offset:1024 lds
    v_mfma_f32_16x16x32_bf16 v[72:75], v[8:11], v[40:43], v[72:75]
    ds_bpermute_b32 v133, v164, v167 offset:64
    ds_bpermute_b32 v130, v164, v166 offset:128
    v_mfma_f32_16x16x32_bf16 v[76:79], v[8:11], v[44:47], v[76:79]
    s_waitcnt lgkmcnt(8)
    ds_bpermute_b32 v134, v164, v167 offset:128
    ds_bpermute_b32 v131, v164, v166 offset:192
    v_mfma_f32_16x16x32_bf16 v[80:83], v[12:15], v[32:35], v[80:83]
    ds_read_b128 v[28:31], v7 offset:7168
    ds_bpermute_b32 v135, v164, v167 offset:192
    v_mfma_f32_16x16x32_bf16 v[84:87], v[12:15], v[36:39], v[84:87]
    buffer_load_dwordx4 v2, s[4:7], s61 offen offset:2048 lds
    v_mfma_f32_16x16x32_bf16 v[88:91], v[12:15], v[40:43], v[88:91]
    ds_read_b128 v[136:139], v5 offset:0
    ds_read_b128 v[140:143], v5 offset:64
    v_mfma_f32_16x16x32_bf16 v[92:95], v[12:15], v[44:47], v[92:95]
    s_waitcnt vmcnt(15) lgkmcnt(13)
    ds_read_b128 v[144:147], v5 offset:128
    ds_read_b128 v[148:151], v5 offset:192
    v_mfma_f32_16x16x32_bf16 v[208:211], v[16:19], v[48:51], v[208:211]
    s_waitcnt vmcnt(14)
    s_waitcnt vmcnt(3)
    s_waitcnt lgkmcnt(0)
    s_barrier
    v_mfma_f32_16x16x32_bf16 v[212:215], v[16:19], v[52:55], v[212:215]
    v_add_u32 v4, 0x12000, v4
    ds_read_b128 v[8:11], v4 offset:0
    v_mfma_f32_16x16x32_bf16 v[216:219], v[16:19], v[56:59], v[216:219]
    buffer_load_dwordx4 v2, s[4:7], s61 offen offset:3072 lds
    v_mfma_f32_16x16x32_bf16 v[220:223], v[16:19], v[60:63], v[220:223]
    s_add_u32 m0, s49, 114688
    s_add_u32 s61, s48, 114688
    v_mfma_f32_16x16x32_bf16 v[224:227], v[20:23], v[48:51], v[224:227]
    ds_read_b128 v[12:15], v4 offset:1024
    v_mfma_f32_16x16x32_bf16 v[228:231], v[20:23], v[52:55], v[228:231]
    v_mfma_f32_16x16x32_bf16 v[232:235], v[20:23], v[56:59], v[232:235]
    buffer_load_dwordx4 v2, s[4:7], s61 offen offset:0 lds
    v_mfma_f32_16x16x32_bf16 v[236:239], v[20:23], v[60:63], v[236:239]
    v_mfma_f32_16x16x32_bf16 v[64:67], v[24:27], v[48:51], v[64:67]
    ds_read_b128 v[16:19], v4 offset:2048
    v_mfma_f32_16x16x32_bf16 v[68:71], v[24:27], v[52:55], v[68:71]
    v_mfma_f32_16x16x32_bf16 v[72:75], v[24:27], v[56:59], v[72:75]
    buffer_load_dwordx4 v2, s[4:7], s61 offen offset:1024 lds
    v_mfma_f32_16x16x32_bf16 v[76:79], v[24:27], v[60:63], v[76:79]
    v_mfma_f32_16x16x32_bf16 v[80:83], v[28:31], v[48:51], v[80:83]
    ds_read_b128 v[20:23], v4 offset:3072
    v_mfma_f32_16x16x32_bf16 v[84:87], v[28:31], v[52:55], v[84:87]
    v_mfma_f32_16x16x32_bf16 v[88:91], v[28:31], v[56:59], v[88:91]
    buffer_load_dwordx4 v2, s[4:7], s61 offen offset:2048 lds
    v_mfma_f32_16x16x32_bf16 v[92:95], v[28:31], v[60:63], v[92:95]
    s_waitcnt lgkmcnt(3)
    v_mfma_f32_16x16x32_bf16 v[96:99], v[8:11], a[0:3], 0
    ds_read_b128 v[24:27], v4 offset:4096
    v_mfma_f32_16x16x32_bf16 v[100:103], v[8:11], a[4:7], 0
    v_mfma_f32_16x16x32_bf16 v[104:107], v[8:11], a[8:11], 0
    buffer_load_dwordx4 v2, s[4:7], s61 offen offset:3072 lds
    v_mfma_f32_16x16x32_bf16 v[108:111], v[8:11], a[12:15], 0
    s_waitcnt lgkmcnt(3)
    s_add_u32 m0, s49, 118784
    s_add_u32 s61, s48, 118784
    v_mfma_f32_16x16x32_bf16 v[112:115], v[12:15], a[0:3], 0
    ds_read_b128 v[28:31], v4 offset:5120
    v_mfma_f32_16x16x32_bf16 v[116:119], v[12:15], a[4:7], 0
    v_fmac_f32 v64, v144, v128
    v_fmac_f32 v65, v145, v128
    v_mfma_f32_16x16x32_bf16 v[120:123], v[12:15], a[8:11], 0
    buffer_load_dwordx4 v2, s[4:7], s61 offen offset:0 lds
    v_mfma_f32_16x16x32_bf16 v[124:127], v[12:15], a[12:15], 0
    s_waitcnt lgkmcnt(3)
    s_add_u32 m0, s49, 0
    s_add_u32 s61, s48, 147456
    v_mfma_f32_16x16x32_bf16 v[96:99], v[16:19], a[16:19], v[96:99]
    ds_read_b128 v[8:11], v4 offset:6144
    v_fmac_f32 v66, v146, v128
    v_mfma_f32_16x16x32_bf16 v[100:103], v[16:19], a[20:23], v[100:103]
    v_fmac_f32 v67, v147, v128
    v_fmac_f32 v80, v148, v128
    v_mfma_f32_16x16x32_bf16 v[104:107], v[16:19], a[24:27], v[104:107]
    buffer_load_dwordx4 v2, s[4:7], s61 offen offset:0 lds
    v_mfma_f32_16x16x32_bf16 v[108:111], v[16:19], a[28:31], v[108:111]
    s_waitcnt lgkmcnt(3)
    v_fmac_f32 v81, v149, v128
    v_fmac_f32 v82, v150, v128
    v_mfma_f32_16x16x32_bf16 v[112:115], v[20:23], a[16:19], v[112:115]
    ds_read_b128 v[12:15], v4 offset:7168
    v_fmac_f32 v83, v151, v128
    v_mfma_f32_16x16x32_bf16 v[116:119], v[20:23], a[20:23], v[116:119]
    v_mul_f32 v64, v64, v132
    v_mul_f32 v65, v65, v132
    v_mfma_f32_16x16x32_bf16 v[120:123], v[20:23], a[24:27], v[120:123]
    buffer_load_dwordx4 v2, s[4:7], s61 offen offset:1024 lds
    v_mfma_f32_16x16x32_bf16 v[124:127], v[20:23], a[28:31], v[124:127]
    s_waitcnt lgkmcnt(3)
    v_mul_f32 v66, v66, v132
    v_mul_f32 v67, v67, v132
    v_mfma_f32_16x16x32_bf16 v[96:99], v[24:27], a[32:35], v[96:99]
    ds_read_b128 v[16:19], v4 offset:8192
    v_mul_f32 v64, v64, v80
    v_mfma_f32_16x16x32_bf16 v[100:103], v[24:27], a[36:39], v[100:103]
    v_mul_f32 v65, v65, v81
    v_mul_f32 v66, v66, v82
    v_mfma_f32_16x16x32_bf16 v[104:107], v[24:27], a[40:43], v[104:107]
    buffer_load_dwordx4 v2, s[4:7], s61 offen offset:2048 lds
    v_mfma_f32_16x16x32_bf16 v[108:111], v[24:27], a[44:47], v[108:111]
    s_waitcnt lgkmcnt(3)
    v_mul_f32 v67, v67, v83
    v_cvt_pk_bf16_f32 v176, v64, v65
    v_mfma_f32_16x16x32_bf16 v[112:115], v[28:31], a[32:35], v[112:115]
    ds_read_b128 v[20:23], v4 offset:9216
    v_cvt_pk_bf16_f32 v177, v66, v67
    v_mfma_f32_16x16x32_bf16 v[116:119], v[28:31], a[36:39], v[116:119]
    v_fmac_f32 v68, v144, v129
    v_fmac_f32 v69, v145, v129
    v_mfma_f32_16x16x32_bf16 v[120:123], v[28:31], a[40:43], v[120:123]
    buffer_load_dwordx4 v2, s[4:7], s61 offen offset:3072 lds
    v_mfma_f32_16x16x32_bf16 v[124:127], v[28:31], a[44:47], v[124:127]
    s_waitcnt lgkmcnt(3)
    s_add_u32 m0, s49, 4096
    s_add_u32 s61, s48, 151552
    v_mfma_f32_16x16x32_bf16 v[96:99], v[8:11], a[48:51], v[96:99]
    ds_read_b128 v[24:27], v4 offset:10240
    v_fmac_f32 v70, v146, v129
    v_mfma_f32_16x16x32_bf16 v[100:103], v[8:11], a[52:55], v[100:103]
    v_fmac_f32 v71, v147, v129
    v_fmac_f32 v84, v148, v129
    v_mfma_f32_16x16x32_bf16 v[104:107], v[8:11], a[56:59], v[104:107]
    buffer_load_dwordx4 v2, s[4:7], s61 offen offset:0 lds
    v_mfma_f32_16x16x32_bf16 v[108:111], v[8:11], a[60:63], v[108:111]
    s_waitcnt lgkmcnt(3)
    v_fmac_f32 v85, v149, v129
    v_fmac_f32 v86, v150, v129
    v_mfma_f32_16x16x32_bf16 v[112:115], v[12:15], a[48:51], v[112:115]
    ds_read_b128 v[28:31], v4 offset:11264
    v_fmac_f32 v87, v151, v129
    v_mfma_f32_16x16x32_bf16 v[116:119], v[12:15], a[52:55], v[116:119]
    v_mul_f32 v68, v68, v133
    v_mul_f32 v69, v69, v133
    v_mfma_f32_16x16x32_bf16 v[120:123], v[12:15], a[56:59], v[120:123]
    buffer_load_dwordx4 v2, s[4:7], s61 offen offset:1024 lds
    v_mfma_f32_16x16x32_bf16 v[124:127], v[12:15], a[60:63], v[124:127]
    s_waitcnt lgkmcnt(3)
    v_mul_f32 v70, v70, v133
    v_mul_f32 v71, v71, v133
    v_mfma_f32_16x16x32_bf16 v[96:99], v[16:19], a[64:67], v[96:99]
    ds_read_b128 v[8:11], v4 offset:12288
    v_mul_f32 v68, v68, v84
    v_mfma_f32_16x16x32_bf16 v[100:103], v[16:19], a[68:71], v[100:103]
    v_mul_f32 v69, v69, v85
    v_mul_f32 v70, v70, v86
    v_mfma_f32_16x16x32_bf16 v[104:107], v[16:19], a[72:75], v[104:107]
    buffer_load_dwordx4 v2, s[4:7], s61 offen offset:2048 lds
    v_mfma_f32_16x16x32_bf16 v[108:111], v[16:19], a[76:79], v[108:111]
    s_waitcnt lgkmcnt(3)
    v_mul_f32 v71, v71, v87
    v_cvt_pk_bf16_f32 v180, v68, v69
    v_mfma_f32_16x16x32_bf16 v[112:115], v[20:23], a[64:67], v[112:115]
    ds_read_b128 v[12:15], v4 offset:13312
    v_cvt_pk_bf16_f32 v181, v70, v71
    v_mfma_f32_16x16x32_bf16 v[116:119], v[20:23], a[68:71], v[116:119]
    v_fmac_f32 v72, v144, v130
    v_fmac_f32 v73, v145, v130
    v_mfma_f32_16x16x32_bf16 v[120:123], v[20:23], a[72:75], v[120:123]
    buffer_load_dwordx4 v2, s[4:7], s61 offen offset:3072 lds
    v_mfma_f32_16x16x32_bf16 v[124:127], v[20:23], a[76:79], v[124:127]
    s_waitcnt lgkmcnt(3)
    s_add_u32 m0, s49, 8192
    s_add_u32 s61, s48, 155648
    v_mfma_f32_16x16x32_bf16 v[96:99], v[24:27], a[80:83], v[96:99]
    ds_read_b128 v[16:19], v4 offset:14336
    v_fmac_f32 v74, v146, v130
    v_mfma_f32_16x16x32_bf16 v[100:103], v[24:27], a[84:87], v[100:103]
    v_fmac_f32 v75, v147, v130
    v_fmac_f32 v88, v148, v130
    v_mfma_f32_16x16x32_bf16 v[104:107], v[24:27], a[88:91], v[104:107]
    buffer_load_dwordx4 v2, s[4:7], s61 offen offset:0 lds
    v_mfma_f32_16x16x32_bf16 v[108:111], v[24:27], a[92:95], v[108:111]
    s_waitcnt lgkmcnt(3)
    s_add_u32 m0, s49, 36864
    s_add_u32 s61, s48, 184320
    v_mfma_f32_16x16x32_bf16 v[112:115], v[28:31], a[80:83], v[112:115]
    ds_read_b128 v[20:23], v4 offset:15360
    v_fmac_f32 v89, v149, v130
    v_mfma_f32_16x16x32_bf16 v[116:119], v[28:31], a[84:87], v[116:119]
    v_fmac_f32 v90, v150, v130
    v_fmac_f32 v91, v151, v130
    v_mfma_f32_16x16x32_bf16 v[120:123], v[28:31], a[88:91], v[120:123]
    buffer_load_dwordx4 v2, s[4:7], s61 offen offset:0 lds
    v_mfma_f32_16x16x32_bf16 v[124:127], v[28:31], a[92:95], v[124:127]
    s_waitcnt lgkmcnt(3)
    v_mul_f32 v72, v72, v134
    v_mul_f32 v73, v73, v134
    v_mfma_f32_16x16x32_bf16 v[96:99], v[8:11], a[96:99], v[96:99]
    ds_read_b128 v[24:27], v4 offset:16384
    v_mul_f32 v74, v74, v134
    v_mfma_f32_16x16x32_bf16 v[100:103], v[8:11], a[100:103], v[100:103]
    v_mul_f32 v75, v75, v134
    v_mul_f32 v72, v72, v88
    v_mfma_f32_16x16x32_bf16 v[104:107], v[8:11], a[104:107], v[104:107]
    buffer_load_dwordx4 v2, s[4:7], s61 offen offset:1024 lds
    v_mfma_f32_16x16x32_bf16 v[108:111], v[8:11], a[108:111], v[108:111]
    s_waitcnt lgkmcnt(3)
    v_mul_f32 v73, v73, v89
    v_mul_f32 v74, v74, v90
    v_mfma_f32_16x16x32_bf16 v[112:115], v[12:15], a[96:99], v[112:115]
    ds_read_b128 v[28:31], v4 offset:17408
    v_mul_f32 v75, v75, v91
    v_mfma_f32_16x16x32_bf16 v[116:119], v[12:15], a[100:103], v[116:119]
    v_cvt_pk_bf16_f32 v184, v72, v73
    v_cvt_pk_bf16_f32 v185, v74, v75
    v_mfma_f32_16x16x32_bf16 v[120:123], v[12:15], a[104:107], v[120:123]
    buffer_load_dwordx4 v2, s[4:7], s61 offen offset:2048 lds
    v_mfma_f32_16x16x32_bf16 v[124:127], v[12:15], a[108:111], v[124:127]
    s_waitcnt lgkmcnt(3)
    v_fmac_f32 v76, v144, v131
    v_fmac_f32 v77, v145, v131
    v_mfma_f32_16x16x32_bf16 v[96:99], v[16:19], a[112:115], v[96:99]
    ds_read_b128 v[8:11], v4 offset:18432
    v_fmac_f32 v78, v146, v131
    v_mfma_f32_16x16x32_bf16 v[100:103], v[16:19], a[116:119], v[100:103]
    v_fmac_f32 v79, v147, v131
    v_fmac_f32 v92, v148, v131
    v_mfma_f32_16x16x32_bf16 v[104:107], v[16:19], a[120:123], v[104:107]
    buffer_load_dwordx4 v2, s[4:7], s61 offen offset:3072 lds
    v_mfma_f32_16x16x32_bf16 v[108:111], v[16:19], a[124:127], v[108:111]
    s_waitcnt lgkmcnt(3)
    s_add_u32 m0, s49, 40960
    s_add_u32 s61, s48, 188416
    v_mfma_f32_16x16x32_bf16 v[112:115], v[20:23], a[112:115], v[112:115]
    ds_read_b128 v[12:15], v4 offset:19456
    v_fmac_f32 v93, v149, v131
    v_mfma_f32_16x16x32_bf16 v[116:119], v[20:23], a[116:119], v[116:119]
    v_fmac_f32 v94, v150, v131
    v_fmac_f32 v95, v151, v131
    v_mfma_f32_16x16x32_bf16 v[120:123], v[20:23], a[120:123], v[120:123]
    buffer_load_dwordx4 v2, s[4:7], s61 offen offset:0 lds
    v_mfma_f32_16x16x32_bf16 v[124:127], v[20:23], a[124:127], v[124:127]
    s_waitcnt lgkmcnt(3)
    v_mul_f32 v76, v76, v135
    v_mul_f32 v77, v77, v135
    v_mfma_f32_16x16x32_bf16 v[96:99], v[24:27], a[128:131], v[96:99]
    ds_read_b128 v[16:19], v4 offset:20480
    v_mul_f32 v78, v78, v135
    v_mfma_f32_16x16x32_bf16 v[100:103], v[24:27], a[132:135], v[100:103]
    v_mul_f32 v79, v79, v135
    v_mul_f32 v76, v76, v92
    v_mfma_f32_16x16x32_bf16 v[104:107], v[24:27], a[136:139], v[104:107]
    buffer_load_dwordx4 v2, s[4:7], s61 offen offset:1024 lds
    v_mfma_f32_16x16x32_bf16 v[108:111], v[24:27], a[140:143], v[108:111]
    s_waitcnt lgkmcnt(3)
    v_mul_f32 v77, v77, v93
    v_mul_f32 v78, v78, v94
    v_mfma_f32_16x16x32_bf16 v[112:115], v[28:31], a[128:131], v[112:115]
    ds_read_b128 v[20:23], v4 offset:21504
    v_mul_f32 v79, v79, v95
    v_mfma_f32_16x16x32_bf16 v[116:119], v[28:31], a[132:135], v[116:119]
    v_cvt_pk_bf16_f32 v188, v76, v77
    v_cvt_pk_bf16_f32 v189, v78, v79
    v_mfma_f32_16x16x32_bf16 v[120:123], v[28:31], a[136:139], v[120:123]
    buffer_load_dwordx4 v2, s[4:7], s61 offen offset:2048 lds
    v_mfma_f32_16x16x32_bf16 v[124:127], v[28:31], a[140:143], v[124:127]
    s_waitcnt lgkmcnt(3)
    v_fmac_f32 v208, v136, v128
    v_fmac_f32 v209, v137, v128
    v_mfma_f32_16x16x32_bf16 v[96:99], v[8:11], a[144:147], v[96:99]
    ds_read_b128 v[24:27], v4 offset:22528
    v_fmac_f32 v210, v138, v128
    v_mfma_f32_16x16x32_bf16 v[100:103], v[8:11], a[148:151], v[100:103]
    v_fmac_f32 v211, v139, v128
    v_fmac_f32 v224, v140, v128
    v_mfma_f32_16x16x32_bf16 v[104:107], v[8:11], a[152:155], v[104:107]
    buffer_load_dwordx4 v2, s[4:7], s61 offen offset:3072 lds
    v_mfma_f32_16x16x32_bf16 v[108:111], v[8:11], a[156:159], v[108:111]
    s_waitcnt lgkmcnt(3)
    s_add_u32 m0, s49, 45056
    s_add_u32 s61, s48, 192512
    v_mfma_f32_16x16x32_bf16 v[112:115], v[12:15], a[144:147], v[112:115]
    ds_read_b128 v[28:31], v4 offset:23552
    v_fmac_f32 v225, v141, v128
    v_mfma_f32_16x16x32_bf16 v[116:119], v[12:15], a[148:151], v[116:119]
    v_fmac_f32 v226, v142, v128
    v_fmac_f32 v227, v143, v128
    v_mfma_f32_16x16x32_bf16 v[120:123], v[12:15], a[152:155], v[120:123]
    buffer_load_dwordx4 v2, s[4:7], s61 offen offset:0 lds
    v_mfma_f32_16x16x32_bf16 v[124:127], v[12:15], a[156:159], v[124:127]
    s_waitcnt lgkmcnt(3)
    v_mul_f32 v208, v208, v132
    v_mul_f32 v209, v209, v132
    v_mfma_f32_16x16x32_bf16 v[96:99], v[16:19], a[160:163], v[96:99]
    ds_read_b128 v[8:11], v4 offset:24576
    v_mul_f32 v210, v210, v132
    v_mfma_f32_16x16x32_bf16 v[100:103], v[16:19], a[164:167], v[100:103]
    v_mul_f32 v211, v211, v132
    v_mul_f32 v208, v208, v224
    v_mfma_f32_16x16x32_bf16 v[104:107], v[16:19], a[168:171], v[104:107]
    v_mul_f32 v209, v209, v225
    v_mul_f32 v210, v210, v226
    v_mfma_f32_16x16x32_bf16 v[108:111], v[16:19], a[172:175], v[108:111]
    s_waitcnt lgkmcnt(3)
    v_mul_f32 v211, v211, v227
    v_cvt_pk_bf16_f32 v240, v208, v209
    v_mfma_f32_16x16x32_bf16 v[112:115], v[20:23], a[160:163], v[112:115]
    ds_read_b128 v[12:15], v4 offset:25600
    v_cvt_pk_bf16_f32 v241, v210, v211
    v_mfma_f32_16x16x32_bf16 v[116:119], v[20:23], a[164:167], v[116:119]
    s_add_u32 s66, s51, s65
    v_mfma_f32_16x16x32_bf16 v[120:123], v[20:23], a[168:171], v[120:123]
    buffer_store_dwordx2 v[240:241], v3, s[4:7], s66 offen offset:0 sc1
    v_mfma_f32_16x16x32_bf16 v[124:127], v[20:23], a[172:175], v[124:127]
    s_waitcnt lgkmcnt(3)
    v_fmac_f32 v212, v136, v129
    v_fmac_f32 v213, v137, v129
    v_mfma_f32_16x16x32_bf16 v[96:99], v[24:27], a[176:179], v[96:99]
    ds_read_b128 v[16:19], v4 offset:26624
    v_fmac_f32 v214, v138, v129
    v_mfma_f32_16x16x32_bf16 v[100:103], v[24:27], a[180:183], v[100:103]
    v_fmac_f32 v215, v139, v129
    v_fmac_f32 v228, v140, v129
    v_mfma_f32_16x16x32_bf16 v[104:107], v[24:27], a[184:187], v[104:107]
    v_fmac_f32 v229, v141, v129
    v_fmac_f32 v230, v142, v129
    v_mfma_f32_16x16x32_bf16 v[108:111], v[24:27], a[188:191], v[108:111]
    s_waitcnt lgkmcnt(3)
    v_fmac_f32 v231, v143, v129
    v_mul_f32 v212, v212, v133
    v_mfma_f32_16x16x32_bf16 v[112:115], v[28:31], a[176:179], v[112:115]
    ds_read_b128 v[20:23], v4 offset:27648
    v_mul_f32 v213, v213, v133
    v_mfma_f32_16x16x32_bf16 v[116:119], v[28:31], a[180:183], v[116:119]
    v_mul_f32 v214, v214, v133
    v_mul_f32 v215, v215, v133
    v_mfma_f32_16x16x32_bf16 v[120:123], v[28:31], a[184:187], v[120:123]
    v_mul_f32 v212, v212, v228
    v_mul_f32 v213, v213, v229
    v_mfma_f32_16x16x32_bf16 v[124:127], v[28:31], a[188:191], v[124:127]
    s_waitcnt lgkmcnt(3)
    v_mul_f32 v214, v214, v230
    v_mul_f32 v215, v215, v231
    v_mfma_f32_16x16x32_bf16 v[96:99], v[8:11], a[192:195], v[96:99]
    ds_read_b128 v[24:27], v4 offset:28672
    v_cvt_pk_bf16_f32 v244, v212, v213
    v_mfma_f32_16x16x32_bf16 v[100:103], v[8:11], a[196:199], v[100:103]
    v_cvt_pk_bf16_f32 v245, v214, v215
    v_mfma_f32_16x16x32_bf16 v[104:107], v[8:11], a[200:203], v[104:107]
    buffer_store_dwordx2 v[244:245], v3, s[4:7], s66 offen offset:512 sc1
    v_mfma_f32_16x16x32_bf16 v[108:111], v[8:11], a[204:207], v[108:111]
    s_waitcnt lgkmcnt(3)
    v_fmac_f32 v216, v136, v130
    v_fmac_f32 v217, v137, v130
    v_mfma_f32_16x16x32_bf16 v[112:115], v[12:15], a[192:195], v[112:115]
    ds_read_b128 v[28:31], v4 offset:29696
    v_fmac_f32 v218, v138, v130
    v_mfma_f32_16x16x32_bf16 v[116:119], v[12:15], a[196:199], v[116:119]
    v_fmac_f32 v219, v139, v130
    v_fmac_f32 v232, v140, v130
    v_mfma_f32_16x16x32_bf16 v[120:123], v[12:15], a[200:203], v[120:123]
    v_fmac_f32 v233, v141, v130
    v_fmac_f32 v234, v142, v130
    v_mfma_f32_16x16x32_bf16 v[124:127], v[12:15], a[204:207], v[124:127]
    s_waitcnt lgkmcnt(3)
    v_fmac_f32 v235, v143, v130
    v_mul_f32 v216, v216, v134
    v_mfma_f32_16x16x32_bf16 v[96:99], v[16:19], a[208:211], v[96:99]
    ds_read_b128 v[8:11], v4 offset:30720
    v_mul_f32 v217, v217, v134
    v_mfma_f32_16x16x32_bf16 v[100:103], v[16:19], a[212:215], v[100:103]
    v_mul_f32 v218, v218, v134
    v_mul_f32 v219, v219, v134
    v_mfma_f32_16x16x32_bf16 v[104:107], v[16:19], a[216:219], v[104:107]
    v_mul_f32 v216, v216, v232
    v_mul_f32 v217, v217, v233
    v_mfma_f32_16x16x32_bf16 v[108:111], v[16:19], a[220:223], v[108:111]
    s_waitcnt lgkmcnt(3)
    v_mul_f32 v218, v218, v234
    v_mul_f32 v219, v219, v235
    v_mfma_f32_16x16x32_bf16 v[112:115], v[20:23], a[208:211], v[112:115]
    ds_read_b128 v[12:15], v4 offset:31744
    v_cvt_pk_bf16_f32 v248, v216, v217
    v_mfma_f32_16x16x32_bf16 v[116:119], v[20:23], a[212:215], v[116:119]
    v_cvt_pk_bf16_f32 v249, v218, v219
    v_mfma_f32_16x16x32_bf16 v[120:123], v[20:23], a[216:219], v[120:123]
    buffer_store_dwordx2 v[248:249], v3, s[4:7], s66 offen offset:1024 sc1
    v_mfma_f32_16x16x32_bf16 v[124:127], v[20:23], a[220:223], v[124:127]
    s_waitcnt lgkmcnt(3)
    v_fmac_f32 v220, v136, v131
    v_fmac_f32 v221, v137, v131
    v_mfma_f32_16x16x32_bf16 v[96:99], v[24:27], a[224:227], v[96:99]
    ds_read_b128 v[16:19], v4 offset:32768
    v_fmac_f32 v222, v138, v131
    v_mfma_f32_16x16x32_bf16 v[100:103], v[24:27], a[228:231], v[100:103]
    v_fmac_f32 v223, v139, v131
    v_fmac_f32 v236, v140, v131
    v_mfma_f32_16x16x32_bf16 v[104:107], v[24:27], a[232:235], v[104:107]
    v_fmac_f32 v237, v141, v131
    v_fmac_f32 v238, v142, v131
    v_mfma_f32_16x16x32_bf16 v[108:111], v[24:27], a[236:239], v[108:111]
    s_waitcnt lgkmcnt(3)
    v_fmac_f32 v239, v143, v131
    v_mul_f32 v220, v220, v135
    v_mfma_f32_16x16x32_bf16 v[112:115], v[28:31], a[224:227], v[112:115]
    ds_read_b128 v[20:23], v4 offset:33792
    v_mul_f32 v221, v221, v135
    v_mfma_f32_16x16x32_bf16 v[116:119], v[28:31], a[228:231], v[116:119]
    v_mul_f32 v222, v222, v135
    v_mul_f32 v223, v223, v135
    v_mfma_f32_16x16x32_bf16 v[120:123], v[28:31], a[232:235], v[120:123]
    v_mul_f32 v220, v220, v236
    v_mul_f32 v221, v221, v237
    v_mfma_f32_16x16x32_bf16 v[124:127], v[28:31], a[236:239], v[124:127]
    s_waitcnt lgkmcnt(3)
    v_mul_f32 v222, v222, v238
    v_mul_f32 v223, v223, v239
    v_mfma_f32_16x16x32_bf16 v[96:99], v[8:11], a[240:243], v[96:99]
    ds_read_b128 v[24:27], v4 offset:34816
    v_cvt_pk_bf16_f32 v252, v220, v221
    v_mfma_f32_16x16x32_bf16 v[100:103], v[8:11], a[244:247], v[100:103]
    v_cvt_pk_bf16_f32 v253, v222, v223
    v_mfma_f32_16x16x32_bf16 v[104:107], v[8:11], a[248:251], v[104:107]
    buffer_store_dwordx2 v[252:253], v3, s[4:7], s66 offen offset:1536 sc1
    v_mfma_f32_16x16x32_bf16 v[108:111], v[8:11], a[252:255], v[108:111]
    s_waitcnt lgkmcnt(3)
    ds_read_b128 v[136:139], v5 offset:256
    ds_read_b128 v[140:143], v5 offset:320
    v_mfma_f32_16x16x32_bf16 v[112:115], v[12:15], a[240:243], v[112:115]
    ds_read_b128 v[28:31], v4 offset:35840
    v_mfma_f32_16x16x32_bf16 v[116:119], v[12:15], a[244:247], v[116:119]
    v_mfma_f32_16x16x32_bf16 v[120:123], v[12:15], a[248:251], v[120:123]
    v_mfma_f32_16x16x32_bf16 v[124:127], v[12:15], a[252:255], v[124:127]
    s_waitcnt lgkmcnt(5)
    v_mfma_f32_16x16x32_bf16 v[96:99], v[16:19], v[32:35], v[96:99]
    s_waitcnt vmcnt(22)
    s_barrier
    v_add_u32 v4, 0x9000, v4
    v_mfma_f32_16x16x32_bf16 v[100:103], v[16:19], v[36:39], v[100:103]
    ds_read_b128 v[8:11], v4 offset:0
    v_mfma_f32_16x16x32_bf16 v[104:107], v[16:19], v[40:43], v[104:107]
    v_mfma_f32_16x16x32_bf16 v[108:111], v[16:19], v[44:47], v[108:111]
    s_waitcnt lgkmcnt(5)
    v_mfma_f32_16x16x32_bf16 v[112:115], v[20:23], v[32:35], v[112:115]
    ds_read_b128 v[12:15], v4 offset:1024
    v_mfma_f32_16x16x32_bf16 v[116:119], v[20:23], v[36:39], v[116:119]
    v_mfma_f32_16x16x32_bf16 v[120:123], v[20:23], v[40:43], v[120:123]
    v_mfma_f32_16x16x32_bf16 v[124:127], v[20:23], v[44:47], v[124:127]
    s_waitcnt lgkmcnt(5)
    v_mfma_f32_16x16x32_bf16 v[96:99], v[24:27], v[48:51], v[96:99]
    ds_read_b128 v[16:19], v4 offset:2048
    v_mfma_f32_16x16x32_bf16 v[100:103], v[24:27], v[52:55], v[100:103]
    v_mfma_f32_16x16x32_bf16 v[104:107], v[24:27], v[56:59], v[104:107]
    v_mfma_f32_16x16x32_bf16 v[108:111], v[24:27], v[60:63], v[108:111]
    s_waitcnt lgkmcnt(3)
    v_mfma_f32_16x16x32_bf16 v[112:115], v[28:31], v[48:51], v[112:115]
    ds_read_b128 v[20:23], v4 offset:3072
    v_mfma_f32_16x16x32_bf16 v[116:119], v[28:31], v[52:55], v[116:119]
    v_mfma_f32_16x16x32_bf16 v[120:123], v[28:31], v[56:59], v[120:123]
    v_mfma_f32_16x16x32_bf16 v[124:127], v[28:31], v[60:63], v[124:127]
    s_waitcnt lgkmcnt(3)
    v_mfma_f32_16x16x32_bf16 v[64:67], v[8:11], a[0:3], 0
    ds_read_b128 v[24:27], v4 offset:4096
    v_mfma_f32_16x16x32_bf16 v[68:71], v[8:11], a[4:7], 0
    v_mfma_f32_16x16x32_bf16 v[72:75], v[8:11], a[8:11], 0
    v_mfma_f32_16x16x32_bf16 v[76:79], v[8:11], a[12:15], 0
    s_waitcnt lgkmcnt(3)
    v_mfma_f32_16x16x32_bf16 v[80:83], v[12:15], a[0:3], 0
    ds_read_b128 v[28:31], v4 offset:5120
    v_mfma_f32_16x16x32_bf16 v[84:87], v[12:15], a[4:7], 0
    v_fmac_f32 v96, v136, v128
    v_fmac_f32 v97, v137, v128
    v_mfma_f32_16x16x32_bf16 v[88:91], v[12:15], a[8:11], 0
    v_fmac_f32 v98, v138, v128
    v_fmac_f32 v99, v139, v128
    v_mfma_f32_16x16x32_bf16 v[92:95], v[12:15], a[12:15], 0
    s_waitcnt lgkmcnt(3)
    v_fmac_f32 v112, v140, v128
    v_fmac_f32 v113, v141, v128
    v_mfma_f32_16x16x32_bf16 v[64:67], v[16:19], a[16:19], v[64:67]
    ds_read_b128 v[8:11], v4 offset:6144
    v_fmac_f32 v114, v142, v128
    v_mfma_f32_16x16x32_bf16 v[68:71], v[16:19], a[20:23], v[68:71]
    v_fmac_f32 v115, v143, v128
    v_mul_f32 v96, v96, v132
    v_mfma_f32_16x16x32_bf16 v[72:75], v[16:19], a[24:27], v[72:75]
    v_mul_f32 v97, v97, v132
    v_mul_f32 v98, v98, v132
    v_mfma_f32_16x16x32_bf16 v[76:79], v[16:19], a[28:31], v[76:79]
    s_waitcnt lgkmcnt(3)
    v_mul_f32 v99, v99, v132
    v_mul_f32 v96, v96, v112
    v_mfma_f32_16x16x32_bf16 v[80:83], v[20:23], a[16:19], v[80:83]
    ds_read_b128 v[12:15], v4 offset:7168
    v_mul_f32 v97, v97, v113
    v_mfma_f32_16x16x32_bf16 v[84:87], v[20:23], a[20:23], v[84:87]
    v_mul_f32 v98, v98, v114
    v_mul_f32 v99, v99, v115
    v_mfma_f32_16x16x32_bf16 v[88:91], v[20:23], a[24:27], v[88:91]
    v_cvt_pk_bf16_f32 v178, v96, v97
    v_cvt_pk_bf16_f32 v179, v98, v99
    v_mfma_f32_16x16x32_bf16 v[92:95], v[20:23], a[28:31], v[92:95]
    s_waitcnt lgkmcnt(3)
    s_add_u32 s66, s51, 0
    v_mfma_f32_16x16x32_bf16 v[64:67], v[24:27], a[32:35], v[64:67]
    ds_read_b128 v[16:19], v4 offset:8192
    v_mfma_f32_16x16x32_bf16 v[68:71], v[24:27], a[36:39], v[68:71]
    buffer_store_dwordx4 v[176:179], v2, s[4:7], s66 offen offset:0 sc1
    v_mfma_f32_16x16x32_bf16 v[72:75], v[24:27], a[40:43], v[72:75]
    v_fmac_f32 v100, v136, v129
    v_fmac_f32 v101, v137, v129
    v_mfma_f32_16x16x32_bf16 v[76:79], v[24:27], a[44:47], v[76:79]
    s_waitcnt lgkmcnt(3)
    v_fmac_f32 v102, v138, v129
    v_fmac_f32 v103, v139, v129
    v_mfma_f32_16x16x32_bf16 v[80:83], v[28:31], a[32:35], v[80:83]
    ds_read_b128 v[20:23], v4 offset:9216
    v_fmac_f32 v116, v140, v129
    v_mfma_f32_16x16x32_bf16 v[84:87], v[28:31], a[36:39], v[84:87]
    v_fmac_f32 v117, v141, v129
    v_fmac_f32 v118, v142, v129
    v_mfma_f32_16x16x32_bf16 v[88:91], v[28:31], a[40:43], v[88:91]
    v_fmac_f32 v119, v143, v129
    v_mul_f32 v100, v100, v133
    v_mfma_f32_16x16x32_bf16 v[92:95], v[28:31], a[44:47], v[92:95]
    s_waitcnt lgkmcnt(3)
    v_mul_f32 v101, v101, v133
    v_mul_f32 v102, v102, v133
    v_mfma_f32_16x16x32_bf16 v[64:67], v[8:11], a[48:51], v[64:67]
    ds_read_b128 v[24:27], v4 offset:10240
    v_mul_f32 v103, v103, v133
    v_mfma_f32_16x16x32_bf16 v[68:71], v[8:11], a[52:55], v[68:71]
    v_mul_f32 v100, v100, v116
    v_mul_f32 v101, v101, v117
    v_mfma_f32_16x16x32_bf16 v[72:75], v[8:11], a[56:59], v[72:75]
    v_mul_f32 v102, v102, v118
    v_mul_f32 v103, v103, v119
    v_mfma_f32_16x16x32_bf16 v[76:79], v[8:11], a[60:63], v[76:79]
    s_waitcnt lgkmcnt(3)
    v_cvt_pk_bf16_f32 v182, v100, v101
    v_cvt_pk_bf16_f32 v183, v102, v103
    v_mfma_f32_16x16x32_bf16 v[80:83], v[12:15], a[48:51], v[80:83]
    ds_read_b128 v[28:31], v4 offset:11264
    v_mfma_f32_16x16x32_bf16 v[84:87], v[12:15], a[52:55], v[84:87]
    buffer_store_dwordx4 v[180:183], v2, s[4:7], s66 offen offset:1024 sc1
    v_mfma_f32_16x16x32_bf16 v[88:91], v[12:15], a[56:59], v[88:91]
    v_fmac_f32 v104, v136, v130
    v_fmac_f32 v105, v137, v130
    v_mfma_f32_16x16x32_bf16 v[92:95], v[12:15], a[60:63], v[92:95]
    s_waitcnt lgkmcnt(3)
    v_fmac_f32 v106, v138, v130
    v_fmac_f32 v107, v139, v130
    v_mfma_f32_16x16x32_bf16 v[64:67], v[16:19], a[64:67], v[64:67]
    ds_read_b128 v[8:11], v4 offset:12288
    v_fmac_f32 v120, v140, v130
    v_mfma_f32_16x16x32_bf16 v[68:71], v[16:19], a[68:71], v[68:71]
    v_fmac_f32 v121, v141, v130
    v_fmac_f32 v122, v142, v130
    v_mfma_f32_16x16x32_bf16 v[72:75], v[16:19], a[72:75], v[72:75]
    v_fmac_f32 v123, v143, v130
    v_mul_f32 v104, v104, v134
    v_mfma_f32_16x16x32_bf16 v[76:79], v[16:19], a[76:79], v[76:79]
    s_waitcnt lgkmcnt(3)
    v_mul_f32 v105, v105, v134
    v_mul_f32 v106, v106, v134
    v_mfma_f32_16x16x32_bf16 v[80:83], v[20:23], a[64:67], v[80:83]
    ds_read_b128 v[12:15], v4 offset:13312
    v_mul_f32 v107, v107, v134
    v_mfma_f32_16x16x32_bf16 v[84:87], v[20:23], a[68:71], v[84:87]
    v_mul_f32 v104, v104, v120
    v_mul_f32 v105, v105, v121
    v_mfma_f32_16x16x32_bf16 v[88:91], v[20:23], a[72:75], v[88:91]
    v_mul_f32 v106, v106, v122
    v_mul_f32 v107, v107, v123
    v_mfma_f32_16x16x32_bf16 v[92:95], v[20:23], a[76:79], v[92:95]
    s_waitcnt lgkmcnt(3)
    v_cvt_pk_bf16_f32 v186, v104, v105
    v_cvt_pk_bf16_f32 v187, v106, v107
    v_mfma_f32_16x16x32_bf16 v[64:67], v[24:27], a[80:83], v[64:67]
    ds_read_b128 v[16:19], v4 offset:14336
    v_mfma_f32_16x16x32_bf16 v[68:71], v[24:27], a[84:87], v[68:71]
    buffer_store_dwordx4 v[184:187], v2, s[4:7], s66 offen offset:2048 sc1
    v_mfma_f32_16x16x32_bf16 v[72:75], v[24:27], a[88:91], v[72:75]
    v_fmac_f32 v108, v136, v131
    v_fmac_f32 v109, v137, v131
    v_mfma_f32_16x16x32_bf16 v[76:79], v[24:27], a[92:95], v[76:79]
    s_waitcnt lgkmcnt(3)
    v_fmac_f32 v110, v138, v131
    v_fmac_f32 v111, v139, v131
    v_mfma_f32_16x16x32_bf16 v[80:83], v[28:31], a[80:83], v[80:83]
    ds_read_b128 v[20:23], v4 offset:15360
    v_fmac_f32 v124, v140, v131
    v_mfma_f32_16x16x32_bf16 v[84:87], v[28:31], a[84:87], v[84:87]
    v_fmac_f32 v125, v141, v131
    v_fmac_f32 v126, v142, v131
    v_mfma_f32_16x16x32_bf16 v[88:91], v[28:31], a[88:91], v[88:91]
    v_fmac_f32 v127, v143, v131
    v_mul_f32 v108, v108, v135
    v_mfma_f32_16x16x32_bf16 v[92:95], v[28:31], a[92:95], v[92:95]
    s_waitcnt lgkmcnt(3)
    v_mul_f32 v109, v109, v135
    v_mul_f32 v110, v110, v135
    v_mfma_f32_16x16x32_bf16 v[64:67], v[8:11], a[96:99], v[64:67]
    ds_read_b128 v[24:27], v4 offset:16384
    v_mul_f32 v111, v111, v135
    v_mfma_f32_16x16x32_bf16 v[68:71], v[8:11], a[100:103], v[68:71]
    v_mul_f32 v108, v108, v124
    v_mul_f32 v109, v109, v125
    v_mfma_f32_16x16x32_bf16 v[72:75], v[8:11], a[104:107], v[72:75]
    v_mul_f32 v110, v110, v126
    v_mul_f32 v111, v111, v127
    v_mfma_f32_16x16x32_bf16 v[76:79], v[8:11], a[108:111], v[76:79]
    s_waitcnt lgkmcnt(3)
    v_cvt_pk_bf16_f32 v190, v108, v109
    v_cvt_pk_bf16_f32 v191, v110, v111
    v_mfma_f32_16x16x32_bf16 v[80:83], v[12:15], a[96:99], v[80:83]
    ds_read_b128 v[28:31], v4 offset:17408
    v_mfma_f32_16x16x32_bf16 v[84:87], v[12:15], a[100:103], v[84:87]
    buffer_store_dwordx4 v[188:191], v2, s[4:7], s66 offen offset:3072 sc1
    v_mfma_f32_16x16x32_bf16 v[88:91], v[12:15], a[104:107], v[88:91]
    v_mfma_f32_16x16x32_bf16 v[92:95], v[12:15], a[108:111], v[92:95]
    s_waitcnt lgkmcnt(3)
    v_mfma_f32_16x16x32_bf16 v[64:67], v[16:19], a[112:115], v[64:67]
    ds_read_b128 v[8:11], v4 offset:18432
    v_mfma_f32_16x16x32_bf16 v[68:71], v[16:19], a[116:119], v[68:71]
    v_mfma_f32_16x16x32_bf16 v[72:75], v[16:19], a[120:123], v[72:75]
    v_mfma_f32_16x16x32_bf16 v[76:79], v[16:19], a[124:127], v[76:79]
    s_waitcnt lgkmcnt(3)
    v_mfma_f32_16x16x32_bf16 v[80:83], v[20:23], a[112:115], v[80:83]
    ds_read_b128 v[12:15], v4 offset:19456
    v_mfma_f32_16x16x32_bf16 v[84:87], v[20:23], a[116:119], v[84:87]
    v_mfma_f32_16x16x32_bf16 v[88:91], v[20:23], a[120:123], v[88:91]
    v_mfma_f32_16x16x32_bf16 v[92:95], v[20:23], a[124:127], v[92:95]
    s_waitcnt lgkmcnt(3)
    v_mfma_f32_16x16x32_bf16 v[64:67], v[24:27], a[128:131], v[64:67]
    ds_read_b128 v[16:19], v4 offset:20480
    v_mfma_f32_16x16x32_bf16 v[68:71], v[24:27], a[132:135], v[68:71]
    v_mfma_f32_16x16x32_bf16 v[72:75], v[24:27], a[136:139], v[72:75]
    v_mfma_f32_16x16x32_bf16 v[76:79], v[24:27], a[140:143], v[76:79]
    s_waitcnt lgkmcnt(3)
    v_mfma_f32_16x16x32_bf16 v[80:83], v[28:31], a[128:131], v[80:83]
    ds_read_b128 v[20:23], v4 offset:21504
    v_mfma_f32_16x16x32_bf16 v[84:87], v[28:31], a[132:135], v[84:87]
    v_mfma_f32_16x16x32_bf16 v[88:91], v[28:31], a[136:139], v[88:91]
    v_mfma_f32_16x16x32_bf16 v[92:95], v[28:31], a[140:143], v[92:95]
    s_waitcnt lgkmcnt(3)
    v_mfma_f32_16x16x32_bf16 v[64:67], v[8:11], a[144:147], v[64:67]
    ds_read_b128 v[24:27], v4 offset:22528
    v_mfma_f32_16x16x32_bf16 v[68:71], v[8:11], a[148:151], v[68:71]
    v_mfma_f32_16x16x32_bf16 v[72:75], v[8:11], a[152:155], v[72:75]
    v_mfma_f32_16x16x32_bf16 v[76:79], v[8:11], a[156:159], v[76:79]
    s_waitcnt lgkmcnt(3)
    v_mfma_f32_16x16x32_bf16 v[80:83], v[12:15], a[144:147], v[80:83]
    ds_read_b128 v[28:31], v4 offset:23552
    v_mfma_f32_16x16x32_bf16 v[84:87], v[12:15], a[148:151], v[84:87]
    v_mfma_f32_16x16x32_bf16 v[88:91], v[12:15], a[152:155], v[88:91]
    v_mfma_f32_16x16x32_bf16 v[92:95], v[12:15], a[156:159], v[92:95]
    s_waitcnt lgkmcnt(3)
    v_mfma_f32_16x16x32_bf16 v[64:67], v[16:19], a[160:163], v[64:67]
    ds_read_b128 v[8:11], v4 offset:24576
    v_mfma_f32_16x16x32_bf16 v[68:71], v[16:19], a[164:167], v[68:71]
    v_mfma_f32_16x16x32_bf16 v[72:75], v[16:19], a[168:171], v[72:75]
    v_mfma_f32_16x16x32_bf16 v[76:79], v[16:19], a[172:175], v[76:79]
    s_waitcnt lgkmcnt(3)
    v_mfma_f32_16x16x32_bf16 v[80:83], v[20:23], a[160:163], v[80:83]
    ds_read_b128 v[12:15], v4 offset:25600
    v_mfma_f32_16x16x32_bf16 v[84:87], v[20:23], a[164:167], v[84:87]
    v_mfma_f32_16x16x32_bf16 v[88:91], v[20:23], a[168:171], v[88:91]
    v_mfma_f32_16x16x32_bf16 v[92:95], v[20:23], a[172:175], v[92:95]
    s_waitcnt lgkmcnt(3)
    v_mfma_f32_16x16x32_bf16 v[64:67], v[24:27], a[176:179], v[64:67]
    ds_read_b128 v[16:19], v4 offset:26624
    v_mfma_f32_16x16x32_bf16 v[68:71], v[24:27], a[180:183], v[68:71]
    v_mfma_f32_16x16x32_bf16 v[72:75], v[24:27], a[184:187], v[72:75]
    v_mfma_f32_16x16x32_bf16 v[76:79], v[24:27], a[188:191], v[76:79]
    s_waitcnt lgkmcnt(3)
    v_mfma_f32_16x16x32_bf16 v[80:83], v[28:31], a[176:179], v[80:83]
    ds_read_b128 v[20:23], v4 offset:27648
    v_mfma_f32_16x16x32_bf16 v[84:87], v[28:31], a[180:183], v[84:87]
    v_mfma_f32_16x16x32_bf16 v[88:91], v[28:31], a[184:187], v[88:91]
    v_mfma_f32_16x16x32_bf16 v[92:95], v[28:31], a[188:191], v[92:95]
    s_waitcnt lgkmcnt(3)
    v_mfma_f32_16x16x32_bf16 v[64:67], v[8:11], a[192:195], v[64:67]
    ds_read_b128 v[24:27], v4 offset:28672
    v_mfma_f32_16x16x32_bf16 v[68:71], v[8:11], a[196:199], v[68:71]
    v_mfma_f32_16x16x32_bf16 v[72:75], v[8:11], a[200:203], v[72:75]
    v_mfma_f32_16x16x32_bf16 v[76:79], v[8:11], a[204:207], v[76:79]
    s_waitcnt lgkmcnt(3)
    v_mfma_f32_16x16x32_bf16 v[80:83], v[12:15], a[192:195], v[80:83]
    ds_read_b128 v[28:31], v4 offset:29696
    v_mfma_f32_16x16x32_bf16 v[84:87], v[12:15], a[196:199], v[84:87]
    v_mfma_f32_16x16x32_bf16 v[88:91], v[12:15], a[200:203], v[88:91]
    v_mfma_f32_16x16x32_bf16 v[92:95], v[12:15], a[204:207], v[92:95]
    s_waitcnt lgkmcnt(3)
    v_mfma_f32_16x16x32_bf16 v[64:67], v[16:19], a[208:211], v[64:67]
    ds_read_b128 v[8:11], v4 offset:30720
    v_mfma_f32_16x16x32_bf16 v[68:71], v[16:19], a[212:215], v[68:71]
    v_mfma_f32_16x16x32_bf16 v[72:75], v[16:19], a[216:219], v[72:75]
    v_mfma_f32_16x16x32_bf16 v[76:79], v[16:19], a[220:223], v[76:79]
    s_waitcnt lgkmcnt(3)
    v_mfma_f32_16x16x32_bf16 v[80:83], v[20:23], a[208:211], v[80:83]
    ds_read_b128 v[12:15], v4 offset:31744
    v_mfma_f32_16x16x32_bf16 v[84:87], v[20:23], a[212:215], v[84:87]
    v_mfma_f32_16x16x32_bf16 v[88:91], v[20:23], a[216:219], v[88:91]
    v_mfma_f32_16x16x32_bf16 v[92:95], v[20:23], a[220:223], v[92:95]
    s_waitcnt lgkmcnt(3)
    v_mfma_f32_16x16x32_bf16 v[64:67], v[24:27], a[224:227], v[64:67]
    ds_read_b128 v[16:19], v4 offset:32768
    v_mfma_f32_16x16x32_bf16 v[68:71], v[24:27], a[228:231], v[68:71]
    v_mfma_f32_16x16x32_bf16 v[72:75], v[24:27], a[232:235], v[72:75]
    v_mfma_f32_16x16x32_bf16 v[76:79], v[24:27], a[236:239], v[76:79]
    s_waitcnt lgkmcnt(3)
    v_mfma_f32_16x16x32_bf16 v[80:83], v[28:31], a[224:227], v[80:83]
    ds_read_b128 v[20:23], v4 offset:33792
    v_mfma_f32_16x16x32_bf16 v[84:87], v[28:31], a[228:231], v[84:87]
    v_mfma_f32_16x16x32_bf16 v[88:91], v[28:31], a[232:235], v[88:91]
    v_mfma_f32_16x16x32_bf16 v[92:95], v[28:31], a[236:239], v[92:95]
    s_waitcnt lgkmcnt(3)
    v_mfma_f32_16x16x32_bf16 v[64:67], v[8:11], a[240:243], v[64:67]
    ds_read_b128 v[24:27], v4 offset:34816
    v_mfma_f32_16x16x32_bf16 v[68:71], v[8:11], a[244:247], v[68:71]
    v_mfma_f32_16x16x32_bf16 v[72:75], v[8:11], a[248:251], v[72:75]
    v_mfma_f32_16x16x32_bf16 v[76:79], v[8:11], a[252:255], v[76:79]
    s_waitcnt lgkmcnt(3)
    ds_read_b128 v[144:147], v5 offset:384
    ds_read_b128 v[148:151], v5 offset:448
    v_mfma_f32_16x16x32_bf16 v[80:83], v[12:15], a[240:243], v[80:83]
    ds_read_b128 v[28:31], v4 offset:35840
    v_mfma_f32_16x16x32_bf16 v[84:87], v[12:15], a[244:247], v[84:87]
    v_mfma_f32_16x16x32_bf16 v[88:91], v[12:15], a[248:251], v[88:91]
    v_mfma_f32_16x16x32_bf16 v[92:95], v[12:15], a[252:255], v[92:95]
    s_waitcnt lgkmcnt(5)
    v_mfma_f32_16x16x32_bf16 v[64:67], v[16:19], v[32:35], v[64:67]
    s_waitcnt vmcnt(17)
    s_barrier
    v_add_u32 v4, 0xfffe5000, v4
    v_mfma_f32_16x16x32_bf16 v[68:71], v[16:19], v[36:39], v[68:71]
    s_add_u32 m0, s49, 73728
    s_add_u32 s61, s48, 221184
    ds_read_b128 v[8:11], v4 offset:0
    v_mfma_f32_16x16x32_bf16 v[72:75], v[16:19], v[40:43], v[72:75]
    buffer_load_dwordx4 v2, s[4:7], s61 offen offset:0 lds
    v_mfma_f32_16x16x32_bf16 v[76:79], v[16:19], v[44:47], v[76:79]
    s_waitcnt lgkmcnt(5)
    v_mfma_f32_16x16x32_bf16 v[80:83], v[20:23], v[32:35], v[80:83]
    ds_read_b128 v[12:15], v4 offset:1024
    v_mfma_f32_16x16x32_bf16 v[84:87], v[20:23], v[36:39], v[84:87]
    v_mfma_f32_16x16x32_bf16 v[88:91], v[20:23], v[40:43], v[88:91]
    buffer_load_dwordx4 v2, s[4:7], s61 offen offset:1024 lds
    v_mfma_f32_16x16x32_bf16 v[92:95], v[20:23], v[44:47], v[92:95]
    s_waitcnt lgkmcnt(5)
    v_mfma_f32_16x16x32_bf16 v[64:67], v[24:27], v[48:51], v[64:67]
    ds_read_b128 v[16:19], v4 offset:2048
    v_mfma_f32_16x16x32_bf16 v[68:71], v[24:27], v[52:55], v[68:71]
    v_mfma_f32_16x16x32_bf16 v[72:75], v[24:27], v[56:59], v[72:75]
    buffer_load_dwordx4 v2, s[4:7], s61 offen offset:2048 lds
    v_mfma_f32_16x16x32_bf16 v[76:79], v[24:27], v[60:63], v[76:79]
    s_waitcnt lgkmcnt(3)
    v_mfma_f32_16x16x32_bf16 v[80:83], v[28:31], v[48:51], v[80:83]
    ds_read_b128 v[20:23], v4 offset:3072
    v_mfma_f32_16x16x32_bf16 v[84:87], v[28:31], v[52:55], v[84:87]
    v_mfma_f32_16x16x32_bf16 v[88:91], v[28:31], v[56:59], v[88:91]
    buffer_load_dwordx4 v2, s[4:7], s61 offen offset:3072 lds
    v_mfma_f32_16x16x32_bf16 v[92:95], v[28:31], v[60:63], v[92:95]
    s_waitcnt lgkmcnt(3)
    s_add_u32 m0, s49, 77824
    s_add_u32 s61, s48, 225280
    v_mfma_f32_16x16x32_bf16 v[96:99], v[8:11], a[0:3], 0
    ds_read_b128 v[24:27], v4 offset:4096
    v_mfma_f32_16x16x32_bf16 v[100:103], v[8:11], a[4:7], 0
    v_mfma_f32_16x16x32_bf16 v[104:107], v[8:11], a[8:11], 0
    buffer_load_dwordx4 v2, s[4:7], s61 offen offset:0 lds
    v_mfma_f32_16x16x32_bf16 v[108:111], v[8:11], a[12:15], 0
    s_waitcnt lgkmcnt(3)
    v_mfma_f32_16x16x32_bf16 v[112:115], v[12:15], a[0:3], 0
    ds_read_b128 v[28:31], v4 offset:5120
    v_mfma_f32_16x16x32_bf16 v[116:119], v[12:15], a[4:7], 0
    v_fmac_f32 v64, v144, v128
    v_fmac_f32 v65, v145, v128
    v_mfma_f32_16x16x32_bf16 v[120:123], v[12:15], a[8:11], 0
    buffer_load_dwordx4 v2, s[4:7], s61 offen offset:1024 lds
    v_mfma_f32_16x16x32_bf16 v[124:127], v[12:15], a[12:15], 0
    s_waitcnt lgkmcnt(3)
    v_fmac_f32 v66, v146, v128
    v_fmac_f32 v67, v147, v128
    v_mfma_f32_16x16x32_bf16 v[96:99], v[16:19], a[16:19], v[96:99]
    ds_read_b128 v[8:11], v4 offset:6144
    v_fmac_f32 v80, v148, v128
    v_mfma_f32_16x16x32_bf16 v[100:103], v[16:19], a[20:23], v[100:103]
    v_fmac_f32 v81, v149, v128
    v_fmac_f32 v82, v150, v128
    v_mfma_f32_16x16x32_bf16 v[104:107], v[16:19], a[24:27], v[104:107]
    buffer_load_dwordx4 v2, s[4:7], s61 offen offset:2048 lds
    v_mfma_f32_16x16x32_bf16 v[108:111], v[16:19], a[28:31], v[108:111]
    s_waitcnt lgkmcnt(3)
    v_fmac_f32 v83, v151, v128
    v_mul_f32 v64, v64, v132
    v_mfma_f32_16x16x32_bf16 v[112:115], v[20:23], a[16:19], v[112:115]
    ds_read_b128 v[12:15], v4 offset:7168
    v_mul_f32 v65, v65, v132
    v_mfma_f32_16x16x32_bf16 v[116:119], v[20:23], a[20:23], v[116:119]
    v_mul_f32 v66, v66, v132
    v_mul_f32 v67, v67, v132
    v_mfma_f32_16x16x32_bf16 v[120:123], v[20:23], a[24:27], v[120:123]
    buffer_load_dwordx4 v2, s[4:7], s61 offen offset:3072 lds
    v_mfma_f32_16x16x32_bf16 v[124:127], v[20:23], a[28:31], v[124:127]
    s_waitcnt lgkmcnt(3)
    s_add_u32 m0, s49, 81920
    s_add_u32 s61, s48, 229376
    v_mfma_f32_16x16x32_bf16 v[96:99], v[24:27], a[32:35], v[96:99]
    ds_read_b128 v[16:19], v4 offset:8192
    v_mul_f32 v64, v64, v80
    v_mfma_f32_16x16x32_bf16 v[100:103], v[24:27], a[36:39], v[100:103]
    v_mul_f32 v65, v65, v81
    v_mul_f32 v66, v66, v82
    v_mfma_f32_16x16x32_bf16 v[104:107], v[24:27], a[40:43], v[104:107]
    buffer_load_dwordx4 v2, s[4:7], s61 offen offset:0 lds
    v_mfma_f32_16x16x32_bf16 v[108:111], v[24:27], a[44:47], v[108:111]
    s_waitcnt lgkmcnt(3)
    v_mul_f32 v67, v67, v83
    v_cvt_pk_bf16_f32 v192, v64, v65
    v_mfma_f32_16x16x32_bf16 v[112:115], v[28:31], a[32:35], v[112:115]
    ds_read_b128 v[20:23], v4 offset:9216
    v_cvt_pk_bf16_f32 v193, v66, v67
    v_mfma_f32_16x16x32_bf16 v[116:119], v[28:31], a[36:39], v[116:119]
    v_fmac_f32 v68, v144, v129
    v_fmac_f32 v69, v145, v129
    v_mfma_f32_16x16x32_bf16 v[120:123], v[28:31], a[40:43], v[120:123]
    v_fmac_f32 v70, v146, v129
    v_fmac_f32 v71, v147, v129
    v_mfma_f32_16x16x32_bf16 v[124:127], v[28:31], a[44:47], v[124:127]
    s_waitcnt lgkmcnt(3)
    v_fmac_f32 v84, v148, v129
    v_fmac_f32 v85, v149, v129
    v_mfma_f32_16x16x32_bf16 v[96:99], v[8:11], a[48:51], v[96:99]
    ds_read_b128 v[24:27], v4 offset:10240
    v_fmac_f32 v86, v150, v129
    v_mfma_f32_16x16x32_bf16 v[100:103], v[8:11], a[52:55], v[100:103]
    v_fmac_f32 v87, v151, v129
    v_mul_f32 v68, v68, v133
    v_mfma_f32_16x16x32_bf16 v[104:107], v[8:11], a[56:59], v[104:107]
    v_mul_f32 v69, v69, v133
    v_mul_f32 v70, v70, v133
    v_mfma_f32_16x16x32_bf16 v[108:111], v[8:11], a[60:63], v[108:111]
    s_waitcnt lgkmcnt(3)
    v_mul_f32 v71, v71, v133
    v_mul_f32 v68, v68, v84
    v_mfma_f32_16x16x32_bf16 v[112:115], v[12:15], a[48:51], v[112:115]
    ds_read_b128 v[28:31], v4 offset:11264
    v_mul_f32 v69, v69, v85
    v_mfma_f32_16x16x32_bf16 v[116:119], v[12:15], a[52:55], v[116:119]
    v_mul_f32 v70, v70, v86
    v_mul_f32 v71, v71, v87
    v_mfma_f32_16x16x32_bf16 v[120:123], v[12:15], a[56:59], v[120:123]
    v_cvt_pk_bf16_f32 v196, v68, v69
    v_cvt_pk_bf16_f32 v197, v70, v71
    v_mfma_f32_16x16x32_bf16 v[124:127], v[12:15], a[60:63], v[124:127]
    s_waitcnt lgkmcnt(3)
    v_fmac_f32 v72, v144, v130
    v_fmac_f32 v73, v145, v130
    v_mfma_f32_16x16x32_bf16 v[96:99], v[16:19], a[64:67], v[96:99]
    ds_read_b128 v[8:11], v4 offset:12288
    v_fmac_f32 v74, v146, v130
    v_mfma_f32_16x16x32_bf16 v[100:103], v[16:19], a[68:71], v[100:103]
    v_fmac_f32 v75, v147, v130
    v_fmac_f32 v88, v148, v130
    v_mfma_f32_16x16x32_bf16 v[104:107], v[16:19], a[72:75], v[104:107]
    v_fmac_f32 v89, v149, v130
    v_fmac_f32 v90, v150, v130
    v_mfma_f32_16x16x32_bf16 v[108:111], v[16:19], a[76:79], v[108:111]
    s_waitcnt lgkmcnt(3)
    v_fmac_f32 v91, v151, v130
    v_mul_f32 v72, v72, v134
    v_mfma_f32_16x16x32_bf16 v[112:115], v[20:23], a[64:67], v[112:115]
    ds_read_b128 v[12:15], v4 offset:13312
    v_mul_f32 v73, v73, v134
    v_mfma_f32_16x16x32_bf16 v[116:119], v[20:23], a[68:71], v[116:119]
    v_mul_f32 v74, v74, v134
    v_mul_f32 v75, v75, v134
    v_mfma_f32_16x16x32_bf16 v[120:123], v[20:23], a[72:75], v[120:123]
    v_mul_f32 v72, v72, v88
    v_mul_f32 v73, v73, v89
    v_mfma_f32_16x16x32_bf16 v[124:127], v[20:23], a[76:79], v[124:127]
    s_waitcnt lgkmcnt(3)
    v_mul_f32 v74, v74, v90
    v_mul_f32 v75, v75, v91
    v_mfma_f32_16x16x32_bf16 v[96:99], v[24:27], a[80:83], v[96:99]
    ds_read_b128 v[16:19], v4 offset:14336
    v_cvt_pk_bf16_f32 v200, v72, v73
    v_mfma_f32_16x16x32_bf16 v[100:103], v[24:27], a[84:87], v[100:103]
    v_cvt_pk_bf16_f32 v201, v74, v75
    v_fmac_f32 v76, v144, v131
    v_mfma_f32_16x16x32_bf16 v[104:107], v[24:27], a[88:91], v[104:107]
    v_fmac_f32 v77, v145, v131
    v_fmac_f32 v78, v146, v131
    v_mfma_f32_16x16x32_bf16 v[108:111], v[24:27], a[92:95], v[108:111]
    s_waitcnt lgkmcnt(3)
    v_fmac_f32 v79, v147, v131
    v_fmac_f32 v92, v148, v131
    v_mfma_f32_16x16x32_bf16 v[112:115], v[28:31], a[80:83], v[112:115]
    ds_read_b128 v[20:23], v4 offset:15360
    v_fmac_f32 v93, v149, v131
    v_mfma_f32_16x16x32_bf16 v[116:119], v[28:31], a[84:87], v[116:119]
    v_fmac_f32 v94, v150, v131
    v_fmac_f32 v95, v151, v131
    v_mfma_f32_16x16x32_bf16 v[120:123], v[28:31], a[88:91], v[120:123]
    v_mul_f32 v76, v76, v135
    v_mul_f32 v77, v77, v135
    v_mfma_f32_16x16x32_bf16 v[124:127], v[28:31], a[92:95], v[124:127]
    s_waitcnt lgkmcnt(3)
    v_mul_f32 v78, v78, v135
    v_mul_f32 v79, v79, v135
    v_mfma_f32_16x16x32_bf16 v[96:99], v[8:11], a[96:99], v[96:99]
    ds_read_b128 v[24:27], v4 offset:16384
    v_mul_f32 v76, v76, v92
    v_mfma_f32_16x16x32_bf16 v[100:103], v[8:11], a[100:103], v[100:103]
    v_mul_f32 v77, v77, v93
    v_mul_f32 v78, v78, v94
    v_mfma_f32_16x16x32_bf16 v[104:107], v[8:11], a[104:107], v[104:107]
    v_mul_f32 v79, v79, v95
    v_cvt_pk_bf16_f32 v204, v76, v77
    v_mfma_f32_16x16x32_bf16 v[108:111], v[8:11], a[108:111], v[108:111]
    s_waitcnt lgkmcnt(3)
    v_cvt_pk_bf16_f32 v205, v78, v79
    v_mfma_f32_16x16x32_bf16 v[112:115], v[12:15], a[96:99], v[112:115]
    ds_read_b128 v[28:31], v4 offset:17408
    v_mfma_f32_16x16x32_bf16 v[116:119], v[12:15], a[100:103], v[116:119]
    v_mfma_f32_16x16x32_bf16 v[120:123], v[12:15], a[104:107], v[120:123]
    v_mfma_f32_16x16x32_bf16 v[124:127], v[12:15], a[108:111], v[124:127]
    s_waitcnt lgkmcnt(3)
    v_mfma_f32_16x16x32_bf16 v[96:99], v[16:19], a[112:115], v[96:99]
    ds_read_b128 v[8:11], v4 offset:18432
    v_mfma_f32_16x16x32_bf16 v[100:103], v[16:19], a[116:119], v[100:103]
    v_mfma_f32_16x16x32_bf16 v[104:107], v[16:19], a[120:123], v[104:107]
    v_mfma_f32_16x16x32_bf16 v[108:111], v[16:19], a[124:127], v[108:111]
    s_waitcnt lgkmcnt(3)
    v_mfma_f32_16x16x32_bf16 v[112:115], v[20:23], a[112:115], v[112:115]
    ds_read_b128 v[12:15], v4 offset:19456
    v_mfma_f32_16x16x32_bf16 v[116:119], v[20:23], a[116:119], v[116:119]
    v_mfma_f32_16x16x32_bf16 v[120:123], v[20:23], a[120:123], v[120:123]
    v_mfma_f32_16x16x32_bf16 v[124:127], v[20:23], a[124:127], v[124:127]
    s_waitcnt lgkmcnt(3)
    v_mfma_f32_16x16x32_bf16 v[96:99], v[24:27], a[128:131], v[96:99]
    ds_read_b128 v[16:19], v4 offset:20480
    v_mfma_f32_16x16x32_bf16 v[100:103], v[24:27], a[132:135], v[100:103]
    v_min_u32 v0, 17, v1
    v_lshlrev_b32 v0, 3, v0
    v_mfma_f32_16x16x32_bf16 v[104:107], v[24:27], a[136:139], v[104:107]
    s_add_u32 s55, s64, 288
    v_mfma_f32_16x16x32_bf16 v[108:111], v[24:27], a[140:143], v[108:111]
    s_waitcnt lgkmcnt(3)
    v_mfma_f32_16x16x32_bf16 v[112:115], v[28:31], a[128:131], v[112:115]
    ds_read_b128 v[20:23], v4 offset:21504
    v_mfma_f32_16x16x32_bf16 v[116:119], v[28:31], a[132:135], v[116:119]
    buffer_load_dwordx2 v[6:7], v0, s[4:7], s55 offen sc1
    v_mfma_f32_16x16x32_bf16 v[120:123], v[28:31], a[136:139], v[120:123]
    v_mfma_f32_16x16x32_bf16 v[124:127], v[28:31], a[140:143], v[124:127]
    s_waitcnt lgkmcnt(3)
    v_mfma_f32_16x16x32_bf16 v[96:99], v[8:11], a[144:147], v[96:99]
    ds_read_b128 v[24:27], v4 offset:22528
    v_mfma_f32_16x16x32_bf16 v[100:103], v[8:11], a[148:151], v[100:103]
    v_mfma_f32_16x16x32_bf16 v[104:107], v[8:11], a[152:155], v[104:107]
    v_mfma_f32_16x16x32_bf16 v[108:111], v[8:11], a[156:159], v[108:111]
    s_waitcnt lgkmcnt(3)
    v_mfma_f32_16x16x32_bf16 v[112:115], v[12:15], a[144:147], v[112:115]
    ds_read_b128 v[28:31], v4 offset:23552
    v_mfma_f32_16x16x32_bf16 v[116:119], v[12:15], a[148:151], v[116:119]
    v_mfma_f32_16x16x32_bf16 v[120:123], v[12:15], a[152:155], v[120:123]
    v_mfma_f32_16x16x32_bf16 v[124:127], v[12:15], a[156:159], v[124:127]
    s_waitcnt lgkmcnt(3)
    v_mfma_f32_16x16x32_bf16 v[96:99], v[16:19], a[160:163], v[96:99]
    ds_read_b128 v[8:11], v4 offset:24576
    v_mfma_f32_16x16x32_bf16 v[100:103], v[16:19], a[164:167], v[100:103]
    v_mfma_f32_16x16x32_bf16 v[104:107], v[16:19], a[168:171], v[104:107]
    v_mfma_f32_16x16x32_bf16 v[108:111], v[16:19], a[172:175], v[108:111]
    s_waitcnt lgkmcnt(3)
    v_mfma_f32_16x16x32_bf16 v[112:115], v[20:23], a[160:163], v[112:115]
    ds_read_b128 v[12:15], v4 offset:25600
    v_mfma_f32_16x16x32_bf16 v[116:119], v[20:23], a[164:167], v[116:119]
    v_mfma_f32_16x16x32_bf16 v[120:123], v[20:23], a[168:171], v[120:123]
    v_mfma_f32_16x16x32_bf16 v[124:127], v[20:23], a[172:175], v[124:127]
    s_waitcnt lgkmcnt(3)
    v_mfma_f32_16x16x32_bf16 v[96:99], v[24:27], a[176:179], v[96:99]
    ds_read_b128 v[16:19], v4 offset:26624
    v_mfma_f32_16x16x32_bf16 v[100:103], v[24:27], a[180:183], v[100:103]
    v_mfma_f32_16x16x32_bf16 v[104:107], v[24:27], a[184:187], v[104:107]
    v_mfma_f32_16x16x32_bf16 v[108:111], v[24:27], a[188:191], v[108:111]
    s_waitcnt lgkmcnt(3)
    v_mfma_f32_16x16x32_bf16 v[112:115], v[28:31], a[176:179], v[112:115]
    ds_read_b128 v[20:23], v4 offset:27648
    v_mfma_f32_16x16x32_bf16 v[116:119], v[28:31], a[180:183], v[116:119]
    v_mfma_f32_16x16x32_bf16 v[120:123], v[28:31], a[184:187], v[120:123]
    v_mfma_f32_16x16x32_bf16 v[124:127], v[28:31], a[188:191], v[124:127]
    s_waitcnt lgkmcnt(3)
    v_mfma_f32_16x16x32_bf16 v[96:99], v[8:11], a[192:195], v[96:99]
    ds_read_b128 v[24:27], v4 offset:28672
    v_mfma_f32_16x16x32_bf16 v[100:103], v[8:11], a[196:199], v[100:103]
    v_mfma_f32_16x16x32_bf16 v[104:107], v[8:11], a[200:203], v[104:107]
    v_mfma_f32_16x16x32_bf16 v[108:111], v[8:11], a[204:207], v[108:111]
    s_waitcnt lgkmcnt(3)
    v_mfma_f32_16x16x32_bf16 v[112:115], v[12:15], a[192:195], v[112:115]
    ds_read_b128 v[28:31], v4 offset:29696
    v_mfma_f32_16x16x32_bf16 v[116:119], v[12:15], a[196:199], v[116:119]
    v_mfma_f32_16x16x32_bf16 v[120:123], v[12:15], a[200:203], v[120:123]
    v_mfma_f32_16x16x32_bf16 v[124:127], v[12:15], a[204:207], v[124:127]
    s_waitcnt lgkmcnt(3)
    v_mfma_f32_16x16x32_bf16 v[96:99], v[16:19], a[208:211], v[96:99]
    ds_read_b128 v[8:11], v4 offset:30720
    v_mfma_f32_16x16x32_bf16 v[100:103], v[16:19], a[212:215], v[100:103]
    v_mfma_f32_16x16x32_bf16 v[104:107], v[16:19], a[216:219], v[104:107]
    v_mfma_f32_16x16x32_bf16 v[108:111], v[16:19], a[220:223], v[108:111]
    s_waitcnt lgkmcnt(3)
    v_mfma_f32_16x16x32_bf16 v[112:115], v[20:23], a[208:211], v[112:115]
    ds_read_b128 v[12:15], v4 offset:31744
    v_mfma_f32_16x16x32_bf16 v[116:119], v[20:23], a[212:215], v[116:119]
    s_waitcnt vmcnt(0)
    v_cmp_eq_u64 vcc, s[98:99], v[6:7]
    s_nop 0
    s_cmp_eq_u64 vcc, exec
    s_cbranch_scc0 L_pd_slow_83
L_pd_back_84:
    v_mfma_f32_16x16x32_bf16 v[120:123], v[20:23], a[216:219], v[120:123]
    v_mfma_f32_16x16x32_bf16 v[124:127], v[20:23], a[220:223], v[124:127]
    s_waitcnt lgkmcnt(3)
    v_mfma_f32_16x16x32_bf16 v[96:99], v[24:27], a[224:227], v[96:99]
    ds_read_b128 v[16:19], v4 offset:32768
    v_mfma_f32_16x16x32_bf16 v[100:103], v[24:27], a[228:231], v[100:103]
    v_mfma_f32_16x16x32_bf16 v[104:107], v[24:27], a[232:235], v[104:107]
    v_mfma_f32_16x16x32_bf16 v[108:111], v[24:27], a[236:239], v[108:111]
    s_waitcnt lgkmcnt(3)
    v_mfma_f32_16x16x32_bf16 v[112:115], v[28:31], a[224:227], v[112:115]
    ds_read_b128 v[20:23], v4 offset:33792
    v_mfma_f32_16x16x32_bf16 v[116:119], v[28:31], a[228:231], v[116:119]
    v_mfma_f32_16x16x32_bf16 v[120:123], v[28:31], a[232:235], v[120:123]
    v_mfma_f32_16x16x32_bf16 v[124:127], v[28:31], a[236:239], v[124:127]
    s_waitcnt lgkmcnt(3)
    v_mfma_f32_16x16x32_bf16 v[96:99], v[8:11], a[240:243], v[96:99]
    ds_read_b128 v[24:27], v4 offset:34816
    v_mfma_f32_16x16x32_bf16 v[100:103], v[8:11], a[244:247], v[100:103]
    v_mfma_f32_16x16x32_bf16 v[104:107], v[8:11], a[248:251], v[104:107]
    v_mfma_f32_16x16x32_bf16 v[108:111], v[8:11], a[252:255], v[108:111]
    s_waitcnt lgkmcnt(3)
    ds_read_b128 v[136:139], v5 offset:512
    ds_read_b128 v[140:143], v5 offset:576
    v_mfma_f32_16x16x32_bf16 v[112:115], v[12:15], a[240:243], v[112:115]
    ds_read_b128 v[28:31], v4 offset:35840
    v_mfma_f32_16x16x32_bf16 v[116:119], v[12:15], a[244:247], v[116:119]
    v_mfma_f32_16x16x32_bf16 v[120:123], v[12:15], a[248:251], v[120:123]
    v_mfma_f32_16x16x32_bf16 v[124:127], v[12:15], a[252:255], v[124:127]
    s_waitcnt lgkmcnt(5)
    v_mfma_f32_16x16x32_bf16 v[96:99], v[16:19], v[32:35], v[96:99]
    s_barrier
    v_add_u32 v4, 0x9000, v4
    v_mfma_f32_16x16x32_bf16 v[100:103], v[16:19], v[36:39], v[100:103]
    s_add_u32 m0, s49, 110592
    s_add_u32 s61, s48, 258048
    ds_read_b128 v[8:11], v4 offset:0
    v_mfma_f32_16x16x32_bf16 v[104:107], v[16:19], v[40:43], v[104:107]
    buffer_load_dwordx4 v2, s[4:7], s61 offen offset:0 lds
    v_mfma_f32_16x16x32_bf16 v[108:111], v[16:19], v[44:47], v[108:111]
    s_waitcnt lgkmcnt(5)
    v_mfma_f32_16x16x32_bf16 v[112:115], v[20:23], v[32:35], v[112:115]
    ds_read_b128 v[12:15], v4 offset:1024
    v_mfma_f32_16x16x32_bf16 v[116:119], v[20:23], v[36:39], v[116:119]
    v_mfma_f32_16x16x32_bf16 v[120:123], v[20:23], v[40:43], v[120:123]
    buffer_load_dwordx4 v2, s[4:7], s61 offen offset:1024 lds
    v_mfma_f32_16x16x32_bf16 v[124:127], v[20:23], v[44:47], v[124:127]
    s_waitcnt lgkmcnt(5)
    v_mfma_f32_16x16x32_bf16 v[96:99], v[24:27], v[48:51], v[96:99]
    ds_read_b128 v[16:19], v4 offset:2048
    v_mfma_f32_16x16x32_bf16 v[100:103], v[24:27], v[52:55], v[100:103]
    v_mfma_f32_16x16x32_bf16 v[104:107], v[24:27], v[56:59], v[104:107]
    buffer_load_dwordx4 v2, s[4:7], s61 offen offset:2048 lds
    v_mfma_f32_16x16x32_bf16 v[108:111], v[24:27], v[60:63], v[108:111]
    s_waitcnt lgkmcnt(3)
    v_mfma_f32_16x16x32_bf16 v[112:115], v[28:31], v[48:51], v[112:115]
    ds_read_b128 v[20:23], v4 offset:3072
    v_mfma_f32_16x16x32_bf16 v[116:119], v[28:31], v[52:55], v[116:119]
    v_mfma_f32_16x16x32_bf16 v[120:123], v[28:31], v[56:59], v[120:123]
    buffer_load_dwordx4 v2, s[4:7], s61 offen offset:3072 lds
    v_mfma_f32_16x16x32_bf16 v[124:127], v[28:31], v[60:63], v[124:127]
    s_waitcnt lgkmcnt(3)
    s_add_u32 m0, s49, 114688
    s_add_u32 s61, s48, 262144
    v_mfma_f32_16x16x32_bf16 v[64:67], v[8:11], a[0:3], 0
    ds_read_b128 v[24:27], v4 offset:4096
    v_mfma_f32_16x16x32_bf16 v[68:71], v[8:11], a[4:7], 0
    v_mfma_f32_16x16x32_bf16 v[72:75], v[8:11], a[8:11], 0
    buffer_load_dwordx4 v2, s[4:7], s61 offen offset:0 lds
    v_mfma_f32_16x16x32_bf16 v[76:79], v[8:11], a[12:15], 0
    s_waitcnt lgkmcnt(3)
    v_mfma_f32_16x16x32_bf16 v[80:83], v[12:15], a[0:3], 0
    ds_read_b128 v[28:31], v4 offset:5120
    v_mfma_f32_16x16x32_bf16 v[84:87], v[12:15], a[4:7], 0
    v_fmac_f32 v96, v136, v128
    v_fmac_f32 v97, v137, v128
    v_mfma_f32_16x16x32_bf16 v[88:91], v[12:15], a[8:11], 0
    buffer_load_dwordx4 v2, s[4:7], s61 offen offset:1024 lds
    v_mfma_f32_16x16x32_bf16 v[92:95], v[12:15], a[12:15], 0
    s_waitcnt lgkmcnt(3)
    v_fmac_f32 v98, v138, v128
    v_fmac_f32 v99, v139, v128
    v_mfma_f32_16x16x32_bf16 v[64:67], v[16:19], a[16:19], v[64:67]
    ds_read_b128 v[8:11], v4 offset:6144
    v_fmac_f32 v112, v140, v128
    v_mfma_f32_16x16x32_bf16 v[68:71], v[16:19], a[20:23], v[68:71]
    v_fmac_f32 v113, v141, v128
    v_fmac_f32 v114, v142, v128
    v_mfma_f32_16x16x32_bf16 v[72:75], v[16:19], a[24:27], v[72:75]
    buffer_load_dwordx4 v2, s[4:7], s61 offen offset:2048 lds
    v_mfma_f32_16x16x32_bf16 v[76:79], v[16:19], a[28:31], v[76:79]
    s_waitcnt lgkmcnt(3)
    v_fmac_f32 v115, v143, v128
    v_mul_f32 v96, v96, v132
    v_mfma_f32_16x16x32_bf16 v[80:83], v[20:23], a[16:19], v[80:83]
    ds_read_b128 v[12:15], v4 offset:7168
    v_mul_f32 v97, v97, v132
    v_mfma_f32_16x16x32_bf16 v[84:87], v[20:23], a[20:23], v[84:87]
    v_mul_f32 v98, v98, v132
    v_mul_f32 v99, v99, v132
    v_mfma_f32_16x16x32_bf16 v[88:91], v[20:23], a[24:27], v[88:91]
    buffer_load_dwordx4 v2, s[4:7], s61 offen offset:3072 lds
    v_mfma_f32_16x16x32_bf16 v[92:95], v[20:23], a[28:31], v[92:95]
    s_waitcnt lgkmcnt(3)
    s_add_u32 m0, s49, 118784
    s_add_u32 s61, s48, 266240
    v_mfma_f32_16x16x32_bf16 v[64:67], v[24:27], a[32:35], v[64:67]
    ds_read_b128 v[16:19], v4 offset:8192
    v_mul_f32 v96, v96, v112
    v_mfma_f32_16x16x32_bf16 v[68:71], v[24:27], a[36:39], v[68:71]
    v_mul_f32 v97, v97, v113
    v_mul_f32 v98, v98, v114
    v_mfma_f32_16x16x32_bf16 v[72:75], v[24:27], a[40:43], v[72:75]
    buffer_load_dwordx4 v2, s[4:7], s61 offen offset:0 lds
    v_mfma_f32_16x16x32_bf16 v[76:79], v[24:27], a[44:47], v[76:79]
    s_waitcnt lgkmcnt(3)
    v_mul_f32 v99, v99, v115
    v_cvt_pk_bf16_f32 v194, v96, v97
    v_mfma_f32_16x16x32_bf16 v[80:83], v[28:31], a[32:35], v[80:83]
    ds_read_b128 v[20:23], v4 offset:9216
    v_cvt_pk_bf16_f32 v195, v98, v99
    v_mfma_f32_16x16x32_bf16 v[84:87], v[28:31], a[36:39], v[84:87]
    s_add_u32 s66, s51, 16384
    v_mfma_f32_16x16x32_bf16 v[88:91], v[28:31], a[40:43], v[88:91]
    buffer_store_dwordx4 v[192:195], v2, s[4:7], s66 offen offset:0 sc1
    v_mfma_f32_16x16x32_bf16 v[92:95], v[28:31], a[44:47], v[92:95]
    s_waitcnt lgkmcnt(3)
    v_fmac_f32 v100, v136, v129
    v_fmac_f32 v101, v137, v129
    v_mfma_f32_16x16x32_bf16 v[64:67], v[8:11], a[48:51], v[64:67]
    ds_read_b128 v[24:27], v4 offset:10240
    v_fmac_f32 v102, v138, v129
    v_mfma_f32_16x16x32_bf16 v[68:71], v[8:11], a[52:55], v[68:71]
    v_fmac_f32 v103, v139, v129
    v_fmac_f32 v116, v140, v129
    v_mfma_f32_16x16x32_bf16 v[72:75], v[8:11], a[56:59], v[72:75]
    v_fmac_f32 v117, v141, v129
    v_fmac_f32 v118, v142, v129
    v_mfma_f32_16x16x32_bf16 v[76:79], v[8:11], a[60:63], v[76:79]
    s_waitcnt lgkmcnt(3)
    v_fmac_f32 v119, v143, v129
    v_mul_f32 v100, v100, v133
    v_mfma_f32_16x16x32_bf16 v[80:83], v[12:15], a[48:51], v[80:83]
    ds_read_b128 v[28:31], v4 offset:11264
    v_mul_f32 v101, v101, v133
    v_mfma_f32_16x16x32_bf16 v[84:87], v[12:15], a[52:55], v[84:87]
    v_mul_f32 v102, v102, v133
    v_mul_f32 v103, v103, v133
    v_mfma_f32_16x16x32_bf16 v[88:91], v[12:15], a[56:59], v[88:91]
    v_mul_f32 v100, v100, v116
    v_mul_f32 v101, v101, v117
    v_mfma_f32_16x16x32_bf16 v[92:95], v[12:15], a[60:63], v[92:95]
    s_waitcnt lgkmcnt(3)
    v_mul_f32 v102, v102, v118
    v_mul_f32 v103, v103, v119
    v_mfma_f32_16x16x32_bf16 v[64:67], v[16:19], a[64:67], v[64:67]
    ds_read_b128 v[8:11], v4 offset:12288
    v_cvt_pk_bf16_f32 v198, v100, v101
    v_mfma_f32_16x16x32_bf16 v[68:71], v[16:19], a[68:71], v[68:71]
    v_cvt_pk_bf16_f32 v199, v102, v103
    v_mfma_f32_16x16x32_bf16 v[72:75], v[16:19], a[72:75], v[72:75]
    buffer_store_dwordx4 v[196:199], v2, s[4:7], s66 offen offset:1024 sc1
    v_mfma_f32_16x16x32_bf16 v[76:79], v[16:19], a[76:79], v[76:79]
    s_waitcnt lgkmcnt(3)
    v_fmac_f32 v104, v136, v130
    v_fmac_f32 v105, v137, v130
    v_mfma_f32_16x16x32_bf16 v[80:83], v[20:23], a[64:67], v[80:83]
    ds_read_b128 v[12:15], v4 offset:13312
    v_fmac_f32 v106, v138, v130
    v_mfma_f32_16x16x32_bf16 v[84:87], v[20:23], a[68:71], v[84:87]
    v_fmac_f32 v107, v139, v130
    v_fmac_f32 v120, v140, v130
    v_mfma_f32_16x16x32_bf16 v[88:91], v[20:23], a[72:75], v[88:91]
    v_fmac_f32 v121, v141, v130
    v_fmac_f32 v122, v142, v130
    v_mfma_f32_16x16x32_bf16 v[92:95], v[20:23], a[76:79], v[92:95]
    s_waitcnt lgkmcnt(3)
    v_fmac_f32 v123, v143, v130
    v_mul_f32 v104, v104, v134
    v_mfma_f32_16x16x32_bf16 v[64:67], v[24:27], a[80:83], v[64:67]
    ds_read_b128 v[16:19], v4 offset:14336
    v_mul_f32 v105, v105, v134
    v_mfma_f32_16x16x32_bf16 v[68:71], v[24:27], a[84:87], v[68:71]
    v_mul_f32 v106, v106, v134
    v_mul_f32 v107, v107, v134
    v_mfma_f32_16x16x32_bf16 v[72:75], v[24:27], a[88:91], v[72:75]
    v_mul_f32 v104, v104, v120
    v_mul_f32 v105, v105, v121
    v_mfma_f32_16x16x32_bf16 v[76:79], v[24:27], a[92:95], v[76:79]
    s_waitcnt lgkmcnt(3)
    v_mul_f32 v106, v106, v122
    v_mul_f32 v107, v107, v123
    v_mfma_f32_16x16x32_bf16 v[80:83], v[28:31], a[80:83], v[80:83]
    ds_read_b128 v[20:23], v4 offset:15360
    v_cvt_pk_bf16_f32 v202, v104, v105
    v_mfma_f32_16x16x32_bf16 v[84:87], v[28:31], a[84:87], v[84:87]
    v_cvt_pk_bf16_f32 v203, v106, v107
    v_mfma_f32_16x16x32_bf16 v[88:91], v[28:31], a[88:91], v[88:91]
    buffer_store_dwordx4 v[200:203], v2, s[4:7], s66 offen offset:2048 sc1
    v_mfma_f32_16x16x32_bf16 v[92:95], v[28:31], a[92:95], v[92:95]
    s_waitcnt lgkmcnt(3)
    v_fmac_f32 v108, v136, v131
    v_fmac_f32 v109, v137, v131
    v_mfma_f32_16x16x32_bf16 v[64:67], v[8:11], a[96:99], v[64:67]
    ds_read_b128 v[24:27], v4 offset:16384
    v_fmac_f32 v110, v138, v131
    v_mfma_f32_16x16x32_bf16 v[68:71], v[8:11], a[100:103], v[68:71]
    v_fmac_f32 v111, v139, v131
    v_fmac_f32 v124, v140, v131
    v_mfma_f32_16x16x32_bf16 v[72:75], v[8:11], a[104:107], v[72:75]
    v_fmac_f32 v125, v141, v131
    v_fmac_f32 v126, v142, v131
    v_mfma_f32_16x16x32_bf16 v[76:79], v[8:11], a[108:111], v[76:79]
    s_waitcnt lgkmcnt(3)
    v_fmac_f32 v127, v143, v131
    v_mul_f32 v108, v108, v135
    v_mfma_f32_16x16x32_bf16 v[80:83], v[12:15], a[96:99], v[80:83]
    ds_read_b128 v[28:31], v4 offset:17408
    v_mul_f32 v109, v109, v135
    v_mfma_f32_16x16x32_bf16 v[84:87], v[12:15], a[100:103], v[84:87]
    v_mul_f32 v110, v110, v135
    v_mul_f32 v111, v111, v135
    v_mfma_f32_16x16x32_bf16 v[88:91], v[12:15], a[104:107], v[88:91]
    v_mul_f32 v108, v108, v124
    v_mul_f32 v109, v109, v125
    v_mfma_f32_16x16x32_bf16 v[92:95], v[12:15], a[108:111], v[92:95]
    s_waitcnt lgkmcnt(3)
    v_mul_f32 v110, v110, v126
    v_mul_f32 v111, v111, v127
    v_mfma_f32_16x16x32_bf16 v[64:67], v[16:19], a[112:115], v[64:67]
    ds_read_b128 v[8:11], v4 offset:18432
    v_cvt_pk_bf16_f32 v206, v108, v109
    v_mfma_f32_16x16x32_bf16 v[68:71], v[16:19], a[116:119], v[68:71]
    v_cvt_pk_bf16_f32 v207, v110, v111
    v_mfma_f32_16x16x32_bf16 v[72:75], v[16:19], a[120:123], v[72:75]
    buffer_store_dwordx4 v[204:207], v2, s[4:7], s66 offen offset:3072 sc1
    v_mfma_f32_16x16x32_bf16 v[76:79], v[16:19], a[124:127], v[76:79]
    s_waitcnt lgkmcnt(3)
    v_mfma_f32_16x16x32_bf16 v[80:83], v[20:23], a[112:115], v[80:83]
    ds_read_b128 v[12:15], v4 offset:19456
    v_mfma_f32_16x16x32_bf16 v[84:87], v[20:23], a[116:119], v[84:87]
    v_mfma_f32_16x16x32_bf16 v[88:91], v[20:23], a[120:123], v[88:91]
    v_mfma_f32_16x16x32_bf16 v[92:95], v[20:23], a[124:127], v[92:95]
    s_waitcnt lgkmcnt(3)
    v_mfma_f32_16x16x32_bf16 v[64:67], v[24:27], a[128:131], v[64:67]
    ds_read_b128 v[16:19], v4 offset:20480
    v_mfma_f32_16x16x32_bf16 v[68:71], v[24:27], a[132:135], v[68:71]
    v_mfma_f32_16x16x32_bf16 v[72:75], v[24:27], a[136:139], v[72:75]
    v_mfma_f32_16x16x32_bf16 v[76:79], v[24:27], a[140:143], v[76:79]
    s_waitcnt lgkmcnt(3)
    v_mfma_f32_16x16x32_bf16 v[80:83], v[28:31], a[128:131], v[80:83]
    ds_read_b128 v[20:23], v4 offset:21504
    v_mfma_f32_16x16x32_bf16 v[84:87], v[28:31], a[132:135], v[84:87]
    v_mfma_f32_16x16x32_bf16 v[88:91], v[28:31], a[136:139], v[88:91]
    v_mfma_f32_16x16x32_bf16 v[92:95], v[28:31], a[140:143], v[92:95]
    s_waitcnt lgkmcnt(3)
    v_mfma_f32_16x16x32_bf16 v[64:67], v[8:11], a[144:147], v[64:67]
    ds_read_b128 v[24:27], v4 offset:22528
    v_mfma_f32_16x16x32_bf16 v[68:71], v[8:11], a[148:151], v[68:71]
    v_mfma_f32_16x16x32_bf16 v[72:75], v[8:11], a[152:155], v[72:75]
    v_mfma_f32_16x16x32_bf16 v[76:79], v[8:11], a[156:159], v[76:79]
    s_waitcnt lgkmcnt(3)
    v_mfma_f32_16x16x32_bf16 v[80:83], v[12:15], a[144:147], v[80:83]
    ds_read_b128 v[28:31], v4 offset:23552
    v_mfma_f32_16x16x32_bf16 v[84:87], v[12:15], a[148:151], v[84:87]
    v_mfma_f32_16x16x32_bf16 v[88:91], v[12:15], a[152:155], v[88:91]
    v_mfma_f32_16x16x32_bf16 v[92:95], v[12:15], a[156:159], v[92:95]
    s_waitcnt lgkmcnt(3)
    v_mfma_f32_16x16x32_bf16 v[64:67], v[16:19], a[160:163], v[64:67]
    ds_read_b128 v[8:11], v4 offset:24576
    v_mfma_f32_16x16x32_bf16 v[68:71], v[16:19], a[164:167], v[68:71]
    v_mfma_f32_16x16x32_bf16 v[72:75], v[16:19], a[168:171], v[72:75]
    v_mfma_f32_16x16x32_bf16 v[76:79], v[16:19], a[172:175], v[76:79]
    s_waitcnt lgkmcnt(3)
    v_mfma_f32_16x16x32_bf16 v[80:83], v[20:23], a[160:163], v[80:83]
    ds_read_b128 v[12:15], v4 offset:25600
    v_mfma_f32_16x16x32_bf16 v[84:87], v[20:23], a[164:167], v[84:87]
    v_mfma_f32_16x16x32_bf16 v[88:91], v[20:23], a[168:171], v[88:91]
    v_mfma_f32_16x16x32_bf16 v[92:95], v[20:23], a[172:175], v[92:95]
    s_waitcnt lgkmcnt(3)
    v_mfma_f32_16x16x32_bf16 v[64:67], v[24:27], a[176:179], v[64:67]
    ds_read_b128 v[16:19], v4 offset:26624
    v_mfma_f32_16x16x32_bf16 v[68:71], v[24:27], a[180:183], v[68:71]
    v_mfma_f32_16x16x32_bf16 v[72:75], v[24:27], a[184:187], v[72:75]
    v_mfma_f32_16x16x32_bf16 v[76:79], v[24:27], a[188:191], v[76:79]
    s_waitcnt lgkmcnt(3)
    v_mfma_f32_16x16x32_bf16 v[80:83], v[28:31], a[176:179], v[80:83]
    ds_read_b128 v[20:23], v4 offset:27648
    v_mfma_f32_16x16x32_bf16 v[84:87], v[28:31], a[180:183], v[84:87]
    v_mfma_f32_16x16x32_bf16 v[88:91], v[28:31], a[184:187], v[88:91]
    v_mfma_f32_16x16x32_bf16 v[92:95], v[28:31], a[188:191], v[92:95]
    s_waitcnt lgkmcnt(3)
    v_mfma_f32_16x16x32_bf16 v[64:67], v[8:11], a[192:195], v[64:67]
    ds_read_b128 v[24:27], v4 offset:28672
    v_mfma_f32_16x16x32_bf16 v[68:71], v[8:11], a[196:199], v[68:71]
    v_mfma_f32_16x16x32_bf16 v[72:75], v[8:11], a[200:203], v[72:75]
    v_mfma_f32_16x16x32_bf16 v[76:79], v[8:11], a[204:207], v[76:79]
    s_waitcnt lgkmcnt(3)
    v_mfma_f32_16x16x32_bf16 v[80:83], v[12:15], a[192:195], v[80:83]
    ds_read_b128 v[28:31], v4 offset:29696
    v_mfma_f32_16x16x32_bf16 v[84:87], v[12:15], a[196:199], v[84:87]
    v_mfma_f32_16x16x32_bf16 v[88:91], v[12:15], a[200:203], v[88:91]
    v_mfma_f32_16x16x32_bf16 v[92:95], v[12:15], a[204:207], v[92:95]
    s_waitcnt lgkmcnt(3)
    v_mfma_f32_16x16x32_bf16 v[64:67], v[16:19], a[208:211], v[64:67]
    ds_read_b128 v[8:11], v4 offset:30720
    v_mfma_f32_16x16x32_bf16 v[68:71], v[16:19], a[212:215], v[68:71]
    v_mfma_f32_16x16x32_bf16 v[72:75], v[16:19], a[216:219], v[72:75]
    v_mfma_f32_16x16x32_bf16 v[76:79], v[16:19], a[220:223], v[76:79]
    s_waitcnt lgkmcnt(3)
    v_mfma_f32_16x16x32_bf16 v[80:83], v[20:23], a[208:211], v[80:83]
    ds_read_b128 v[12:15], v4 offset:31744
    v_mfma_f32_16x16x32_bf16 v[84:87], v[20:23], a[212:215], v[84:87]
    v_mfma_f32_16x16x32_bf16 v[88:91], v[20:23], a[216:219], v[88:91]
    v_mfma_f32_16x16x32_bf16 v[92:95], v[20:23], a[220:223], v[92:95]
    s_waitcnt lgkmcnt(3)
    v_mfma_f32_16x16x32_bf16 v[64:67], v[24:27], a[224:227], v[64:67]
    ds_read_b128 v[16:19], v4 offset:32768
    v_mfma_f32_16x16x32_bf16 v[68:71], v[24:27], a[228:231], v[68:71]
    v_mfma_f32_16x16x32_bf16 v[72:75], v[24:27], a[232:235], v[72:75]
    v_mfma_f32_16x16x32_bf16 v[76:79], v[24:27], a[236:239], v[76:79]
    s_waitcnt lgkmcnt(3)
    v_mfma_f32_16x16x32_bf16 v[80:83], v[28:31], a[224:227], v[80:83]
    ds_read_b128 v[20:23], v4 offset:33792
    v_mfma_f32_16x16x32_bf16 v[84:87], v[28:31], a[228:231], v[84:87]
    v_mfma_f32_16x16x32_bf16 v[88:91], v[28:31], a[232:235], v[88:91]
    v_mfma_f32_16x16x32_bf16 v[92:95], v[28:31], a[236:239], v[92:95]
    s_waitcnt lgkmcnt(3)
    v_mfma_f32_16x16x32_bf16 v[64:67], v[8:11], a[240:243], v[64:67]
    ds_read_b128 v[24:27], v4 offset:34816
    v_mfma_f32_16x16x32_bf16 v[68:71], v[8:11], a[244:247], v[68:71]
    v_mfma_f32_16x16x32_bf16 v[72:75], v[8:11], a[248:251], v[72:75]
    v_mfma_f32_16x16x32_bf16 v[76:79], v[8:11], a[252:255], v[76:79]
    s_waitcnt lgkmcnt(3)
    ds_read_b128 v[144:147], v5 offset:640
    ds_read_b128 v[148:151], v5 offset:704
    v_mfma_f32_16x16x32_bf16 v[80:83], v[12:15], a[240:243], v[80:83]
    ds_read_b128 v[28:31], v4 offset:35840
    v_mfma_f32_16x16x32_bf16 v[84:87], v[12:15], a[244:247], v[84:87]
    v_mfma_f32_16x16x32_bf16 v[88:91], v[12:15], a[248:251], v[88:91]
    v_mfma_f32_16x16x32_bf16 v[92:95], v[12:15], a[252:255], v[92:95]
    s_waitcnt lgkmcnt(5)
    v_mfma_f32_16x16x32_bf16 v[64:67], v[16:19], v[32:35], v[64:67]
    s_barrier
    v_add_u32 v4, 0x9000, v4
    v_mfma_f32_16x16x32_bf16 v[68:71], v[16:19], v[36:39], v[68:71]
    s_add_u32 m0, s49, 0
    s_add_u32 s61, s48, 294912
    ds_read_b128 v[8:11], v4 offset:0
    v_mfma_f32_16x16x32_bf16 v[72:75], v[16:19], v[40:43], v[72:75]
    buffer_load_dwordx4 v2, s[4:7], s61 offen offset:0 lds
    v_mfma_f32_16x16x32_bf16 v[76:79], v[16:19], v[44:47], v[76:79]
    s_waitcnt lgkmcnt(5)
    v_mfma_f32_16x16x32_bf16 v[80:83], v[20:23], v[32:35], v[80:83]
    ds_read_b128 v[12:15], v4 offset:1024
    v_mfma_f32_16x16x32_bf16 v[84:87], v[20:23], v[36:39], v[84:87]
    v_mfma_f32_16x16x32_bf16 v[88:91], v[20:23], v[40:43], v[88:91]
    buffer_load_dwordx4 v2, s[4:7], s61 offen offset:1024 lds
    v_mfma_f32_16x16x32_bf16 v[92:95], v[20:23], v[44:47], v[92:95]
    s_waitcnt lgkmcnt(5)
    v_mfma_f32_16x16x32_bf16 v[64:67], v[24:27], v[48:51], v[64:67]
    ds_read_b128 v[16:19], v4 offset:2048
    v_mfma_f32_16x16x32_bf16 v[68:71], v[24:27], v[52:55], v[68:71]
    v_mfma_f32_16x16x32_bf16 v[72:75], v[24:27], v[56:59], v[72:75]
    buffer_load_dwordx4 v2, s[4:7], s61 offen offset:2048 lds
    v_mfma_f32_16x16x32_bf16 v[76:79], v[24:27], v[60:63], v[76:79]
    s_waitcnt lgkmcnt(3)
    v_mfma_f32_16x16x32_bf16 v[80:83], v[28:31], v[48:51], v[80:83]
    ds_read_b128 v[20:23], v4 offset:3072
    v_mfma_f32_16x16x32_bf16 v[84:87], v[28:31], v[52:55], v[84:87]
    v_mfma_f32_16x16x32_bf16 v[88:91], v[28:31], v[56:59], v[88:91]
    buffer_load_dwordx4 v2, s[4:7], s61 offen offset:3072 lds
    v_mfma_f32_16x16x32_bf16 v[92:95], v[28:31], v[60:63], v[92:95]
    s_waitcnt lgkmcnt(3)
    s_add_u32 m0, s49, 4096
    s_add_u32 s61, s48, 299008
    v_mfma_f32_16x16x32_bf16 v[96:99], v[8:11], a[0:3], 0
    ds_read_b128 v[24:27], v4 offset:4096
    v_mfma_f32_16x16x32_bf16 v[100:103], v[8:11], a[4:7], 0
    v_mfma_f32_16x16x32_bf16 v[104:107], v[8:11], a[8:11], 0
    buffer_load_dwordx4 v2, s[4:7], s61 offen offset:0 lds
    v_mfma_f32_16x16x32_bf16 v[108:111], v[8:11], a[12:15], 0
    s_waitcnt lgkmcnt(3)
    v_mfma_f32_16x16x32_bf16 v[112:115], v[12:15], a[0:3], 0
    ds_read_b128 v[28:31], v4 offset:5120
    v_mfma_f32_16x16x32_bf16 v[116:119], v[12:15], a[4:7], 0
    v_fmac_f32 v64, v144, v128
    v_fmac_f32 v65, v145, v128
    v_mfma_f32_16x16x32_bf16 v[120:123], v[12:15], a[8:11], 0
    buffer_load_dwordx4 v2, s[4:7], s61 offen offset:1024 lds
    v_mfma_f32_16x16x32_bf16 v[124:127], v[12:15], a[12:15], 0
    s_waitcnt lgkmcnt(3)
    v_fmac_f32 v66, v146, v128
    v_fmac_f32 v67, v147, v128
    v_mfma_f32_16x16x32_bf16 v[96:99], v[16:19], a[16:19], v[96:99]
    ds_read_b128 v[8:11], v4 offset:6144
    v_fmac_f32 v80, v148, v128
    v_mfma_f32_16x16x32_bf16 v[100:103], v[16:19], a[20:23], v[100:103]
    v_fmac_f32 v81, v149, v128
    v_fmac_f32 v82, v150, v128
    v_mfma_f32_16x16x32_bf16 v[104:107], v[16:19], a[24:27], v[104:107]
    buffer_load_dwordx4 v2, s[4:7], s61 offen offset:2048 lds
    v_mfma_f32_16x16x32_bf16 v[108:111], v[16:19], a[28:31], v[108:111]
    s_waitcnt lgkmcnt(3)
    v_fmac_f32 v83, v151, v128
    v_mul_f32 v64, v64, v132
    v_mfma_f32_16x16x32_bf16 v[112:115], v[20:23], a[16:19], v[112:115]
    ds_read_b128 v[12:15], v4 offset:7168
    v_mul_f32 v65, v65, v132
    v_mfma_f32_16x16x32_bf16 v[116:119], v[20:23], a[20:23], v[116:119]
    v_mul_f32 v66, v66, v132
    v_mul_f32 v67, v67, v132
    v_mfma_f32_16x16x32_bf16 v[120:123], v[20:23], a[24:27], v[120:123]
    buffer_load_dwordx4 v2, s[4:7], s61 offen offset:3072 lds
    v_mfma_f32_16x16x32_bf16 v[124:127], v[20:23], a[28:31], v[124:127]
    s_waitcnt lgkmcnt(3)
    s_add_u32 m0, s49, 8192
    s_add_u32 s61, s48, 303104
    v_mfma_f32_16x16x32_bf16 v[96:99], v[24:27], a[32:35], v[96:99]
    ds_read_b128 v[16:19], v4 offset:8192
    v_mul_f32 v64, v64, v80
    v_mfma_f32_16x16x32_bf16 v[100:103], v[24:27], a[36:39], v[100:103]
    v_mul_f32 v65, v65, v81
    v_mul_f32 v66, v66, v82
    v_mfma_f32_16x16x32_bf16 v[104:107], v[24:27], a[40:43], v[104:107]
    buffer_load_dwordx4 v2, s[4:7], s61 offen offset:0 lds
    v_mfma_f32_16x16x32_bf16 v[108:111], v[24:27], a[44:47], v[108:111]
    s_waitcnt lgkmcnt(3)
    v_mul_f32 v67, v67, v83
    v_cvt_pk_bf16_f32 v208, v64, v65
    v_mfma_f32_16x16x32_bf16 v[112:115], v[28:31], a[32:35], v[112:115]
    ds_read_b128 v[20:23], v4 offset:9216
    v_cvt_pk_bf16_f32 v209, v66, v67
    v_mfma_f32_16x16x32_bf16 v[116:119], v[28:31], a[36:39], v[116:119]
    v_fmac_f32 v68, v144, v129
    v_fmac_f32 v69, v145, v129
    v_mfma_f32_16x16x32_bf16 v[120:123], v[28:31], a[40:43], v[120:123]
    v_fmac_f32 v70, v146, v129
    v_fmac_f32 v71, v147, v129
    v_mfma_f32_16x16x32_bf16 v[124:127], v[28:31], a[44:47], v[124:127]
    s_waitcnt lgkmcnt(3)
    v_fmac_f32 v84, v148, v129
    v_fmac_f32 v85, v149, v129
    v_mfma_f32_16x16x32_bf16 v[96:99], v[8:11], a[48:51], v[96:99]
    ds_read_b128 v[24:27], v4 offset:10240
    v_fmac_f32 v86, v150, v129
    v_mfma_f32_16x16x32_bf16 v[100:103], v[8:11], a[52:55], v[100:103]
    v_fmac_f32 v87, v151, v129
    v_mul_f32 v68, v68, v133
    v_mfma_f32_16x16x32_bf16 v[104:107], v[8:11], a[56:59], v[104:107]
    v_mul_f32 v69, v69, v133
    v_mul_f32 v70, v70, v133
    v_mfma_f32_16x16x32_bf16 v[108:111], v[8:11], a[60:63], v[108:111]
    s_waitcnt lgkmcnt(3)
    v_mul_f32 v71, v71, v133
    v_mul_f32 v68, v68, v84
    v_mfma_f32_16x16x32_bf16 v[112:115], v[12:15], a[48:51], v[112:115]
    ds_read_b128 v[28:31], v4 offset:11264
    v_mul_f32 v69, v69, v85
    v_mfma_f32_16x16x32_bf16 v[116:119], v[12:15], a[52:55], v[116:119]
    v_mul_f32 v70, v70, v86
    v_mul_f32 v71, v71, v87
    v_mfma_f32_16x16x32_bf16 v[120:123], v[12:15], a[56:59], v[120:123]
    v_cvt_pk_bf16_f32 v212, v68, v69
    v_cvt_pk_bf16_f32 v213, v70, v71
    v_mfma_f32_16x16x32_bf16 v[124:127], v[12:15], a[60:63], v[124:127]
    s_waitcnt lgkmcnt(3)
    v_fmac_f32 v72, v144, v130
    v_fmac_f32 v73, v145, v130
    v_mfma_f32_16x16x32_bf16 v[96:99], v[16:19], a[64:67], v[96:99]
    ds_read_b128 v[8:11], v4 offset:12288
    v_fmac_f32 v74, v146, v130
    v_mfma_f32_16x16x32_bf16 v[100:103], v[16:19], a[68:71], v[100:103]
    v_fmac_f32 v75, v147, v130
    v_fmac_f32 v88, v148, v130
    v_mfma_f32_16x16x32_bf16 v[104:107], v[16:19], a[72:75], v[104:107]
    v_fmac_f32 v89, v149, v130
    v_fmac_f32 v90, v150, v130
    v_mfma_f32_16x16x32_bf16 v[108:111], v[16:19], a[76:79], v[108:111]
    s_waitcnt lgkmcnt(3)
    v_fmac_f32 v91, v151, v130
    v_mul_f32 v72, v72, v134
    v_mfma_f32_16x16x32_bf16 v[112:115], v[20:23], a[64:67], v[112:115]
    ds_read_b128 v[12:15], v4 offset:13312
    v_mul_f32 v73, v73, v134
    v_mfma_f32_16x16x32_bf16 v[116:119], v[20:23], a[68:71], v[116:119]
    v_mul_f32 v74, v74, v134
    v_mul_f32 v75, v75, v134
    v_mfma_f32_16x16x32_bf16 v[120:123], v[20:23], a[72:75], v[120:123]
    v_mul_f32 v72, v72, v88
    v_mul_f32 v73, v73, v89
    v_mfma_f32_16x16x32_bf16 v[124:127], v[20:23], a[76:79], v[124:127]
    s_waitcnt lgkmcnt(3)
    v_mul_f32 v74, v74, v90
    v_mul_f32 v75, v75, v91
    v_mfma_f32_16x16x32_bf16 v[96:99], v[24:27], a[80:83], v[96:99]
    ds_read_b128 v[16:19], v4 offset:14336
    v_cvt_pk_bf16_f32 v216, v72, v73
    v_mfma_f32_16x16x32_bf16 v[100:103], v[24:27], a[84:87], v[100:103]
    v_cvt_pk_bf16_f32 v217, v74, v75
    v_fmac_f32 v76, v144, v131
    v_mfma_f32_16x16x32_bf16 v[104:107], v[24:27], a[88:91], v[104:107]
    v_fmac_f32 v77, v145, v131
    v_fmac_f32 v78, v146, v131
    v_mfma_f32_16x16x32_bf16 v[108:111], v[24:27], a[92:95], v[108:111]
    s_waitcnt lgkmcnt(3)
    v_fmac_f32 v79, v147, v131
    v_fmac_f32 v92, v148, v131
    v_mfma_f32_16x16x32_bf16 v[112:115], v[28:31], a[80:83], v[112:115]
    ds_read_b128 v[20:23], v4 offset:15360
    v_fmac_f32 v93, v149, v131
    v_mfma_f32_16x16x32_bf16 v[116:119], v[28:31], a[84:87], v[116:119]
    v_fmac_f32 v94, v150, v131
    v_fmac_f32 v95, v151, v131
    v_mfma_f32_16x16x32_bf16 v[120:123], v[28:31], a[88:91], v[120:123]
    v_mul_f32 v76, v76, v135
    v_mul_f32 v77, v77, v135
    v_mfma_f32_16x16x32_bf16 v[124:127], v[28:31], a[92:95], v[124:127]
    s_waitcnt lgkmcnt(3)
    v_mul_f32 v78, v78, v135
    v_mul_f32 v79, v79, v135
    v_mfma_f32_16x16x32_bf16 v[96:99], v[8:11], a[96:99], v[96:99]
    ds_read_b128 v[24:27], v4 offset:16384
    v_mul_f32 v76, v76, v92
    v_mfma_f32_16x16x32_bf16 v[100:103], v[8:11], a[100:103], v[100:103]
    v_mul_f32 v77, v77, v93
    v_mul_f32 v78, v78, v94
    v_mfma_f32_16x16x32_bf16 v[104:107], v[8:11], a[104:107], v[104:107]
    v_mul_f32 v79, v79, v95
    v_cvt_pk_bf16_f32 v220, v76, v77
    v_mfma_f32_16x16x32_bf16 v[108:111], v[8:11], a[108:111], v[108:111]
    s_waitcnt lgkmcnt(3)
    v_cvt_pk_bf16_f32 v221, v78, v79
    v_mfma_f32_16x16x32_bf16 v[112:115], v[12:15], a[96:99], v[112:115]
    ds_read_b128 v[28:31], v4 offset:17408
    v_mfma_f32_16x16x32_bf16 v[116:119], v[12:15], a[100:103], v[116:119]
    v_mfma_f32_16x16x32_bf16 v[120:123], v[12:15], a[104:107], v[120:123]
    v_mfma_f32_16x16x32_bf16 v[124:127], v[12:15], a[108:111], v[124:127]
    s_waitcnt lgkmcnt(3)
    v_mfma_f32_16x16x32_bf16 v[96:99], v[16:19], a[112:115], v[96:99]
    ds_read_b128 v[8:11], v4 offset:18432
    v_mfma_f32_16x16x32_bf16 v[100:103], v[16:19], a[116:119], v[100:103]
    s_add_u32 s71, s67, 0
    v_mov_b32 v6, s98
    v_mov_b32 v7, s99
    v_mfma_f32_16x16x32_bf16 v[104:107], v[16:19], a[120:123], v[104:107]
    v_mfma_f32_16x16x32_bf16 v[108:111], v[16:19], a[124:127], v[108:111]
    s_waitcnt lgkmcnt(3)
    s_waitcnt vmcnt(9)
    v_mfma_f32_16x16x32_bf16 v[112:115], v[20:23], a[112:115], v[112:115]
    ds_read_b128 v[12:15], v4 offset:19456
    v_mfma_f32_16x16x32_bf16 v[116:119], v[20:23], a[116:119], v[116:119]
    s_mov_b64 exec, 1
    buffer_store_dwordx2 v[6:7], off, s[4:7], s71 sc1
    s_mov_b64 exec, -1
    v_mfma_f32_16x16x32_bf16 v[120:123], v[20:23], a[120:123], v[120:123]
    v_mfma_f32_16x16x32_bf16 v[124:127], v[20:23], a[124:127], v[124:127]
    s_waitcnt lgkmcnt(3)
    v_mfma_f32_16x16x32_bf16 v[96:99], v[24:27], a[128:131], v[96:99]
    ds_read_b128 v[16:19], v4 offset:20480
    v_mfma_f32_16x16x32_bf16 v[100:103], v[24:27], a[132:135], v[100:103]
    v_mfma_f32_16x16x32_bf16 v[104:107], v[24:27], a[136:139], v[104:107]
    v_mfma_f32_16x16x32_bf16 v[108:111], v[24:27], a[140:143], v[108:111]
    s_waitcnt lgkmcnt(3)
    v_mfma_f32_16x16x32_bf16 v[112:115], v[28:31], a[128:131], v[112:115]
    ds_read_b128 v[20:23], v4 offset:21504
    v_mfma_f32_16x16x32_bf16 v[116:119], v[28:31], a[132:135], v[116:119]
    v_mfma_f32_16x16x32_bf16 v[120:123], v[28:31], a[136:139], v[120:123]
    v_mfma_f32_16x16x32_bf16 v[124:127], v[28:31], a[140:143], v[124:127]
    s_waitcnt lgkmcnt(3)
    v_mfma_f32_16x16x32_bf16 v[96:99], v[8:11], a[144:147], v[96:99]
    ds_read_b128 v[24:27], v4 offset:22528
    v_mfma_f32_16x16x32_bf16 v[100:103], v[8:11], a[148:151], v[100:103]
    v_mfma_f32_16x16x32_bf16 v[104:107], v[8:11], a[152:155], v[104:107]
    v_mfma_f32_16x16x32_bf16 v[108:111], v[8:11], a[156:159], v[108:111]
    s_waitcnt lgkmcnt(3)
    v_mfma_f32_16x16x32_bf16 v[112:115], v[12:15], a[144:147], v[112:115]
    ds_read_b128 v[28:31], v4 offset:23552
    v_mfma_f32_16x16x32_bf16 v[116:119], v[12:15], a[148:151], v[116:119]
    v_mfma_f32_16x16x32_bf16 v[120:123], v[12:15], a[152:155], v[120:123]
    v_mfma_f32_16x16x32_bf16 v[124:127], v[12:15], a[156:159], v[124:127]
    s_waitcnt lgkmcnt(3)
    v_mfma_f32_16x16x32_bf16 v[96:99], v[16:19], a[160:163], v[96:99]
    ds_read_b128 v[8:11], v4 offset:24576
    v_mfma_f32_16x16x32_bf16 v[100:103], v[16:19], a[164:167], v[100:103]
    v_mfma_f32_16x16x32_bf16 v[104:107], v[16:19], a[168:171], v[104:107]
    v_mfma_f32_16x16x32_bf16 v[108:111], v[16:19], a[172:175], v[108:111]
    s_waitcnt lgkmcnt(3)
    v_mfma_f32_16x16x32_bf16 v[112:115], v[20:23], a[160:163], v[112:115]
    ds_read_b128 v[12:15], v4 offset:25600
    v_mfma_f32_16x16x32_bf16 v[116:119], v[20:23], a[164:167], v[116:119]
    v_mfma_f32_16x16x32_bf16 v[120:123], v[20:23], a[168:171], v[120:123]
    v_mfma_f32_16x16x32_bf16 v[124:127], v[20:23], a[172:175], v[124:127]
    s_waitcnt lgkmcnt(3)
    v_mfma_f32_16x16x32_bf16 v[96:99], v[24:27], a[176:179], v[96:99]
    ds_read_b128 v[16:19], v4 offset:26624
    v_mfma_f32_16x16x32_bf16 v[100:103], v[24:27], a[180:183], v[100:103]
    v_mfma_f32_16x16x32_bf16 v[104:107], v[24:27], a[184:187], v[104:107]
    v_mfma_f32_16x16x32_bf16 v[108:111], v[24:27], a[188:191], v[108:111]
    s_waitcnt lgkmcnt(3)
    v_mfma_f32_16x16x32_bf16 v[112:115], v[28:31], a[176:179], v[112:115]
    ds_read_b128 v[20:23], v4 offset:27648
    v_mfma_f32_16x16x32_bf16 v[116:119], v[28:31], a[180:183], v[116:119]
    v_mfma_f32_16x16x32_bf16 v[120:123], v[28:31], a[184:187], v[120:123]
    v_mfma_f32_16x16x32_bf16 v[124:127], v[28:31], a[188:191], v[124:127]
    s_waitcnt lgkmcnt(3)
    v_mfma_f32_16x16x32_bf16 v[96:99], v[8:11], a[192:195], v[96:99]
    ds_read_b128 v[24:27], v4 offset:28672
    v_mfma_f32_16x16x32_bf16 v[100:103], v[8:11], a[196:199], v[100:103]
    v_mfma_f32_16x16x32_bf16 v[104:107], v[8:11], a[200:203], v[104:107]
    v_mfma_f32_16x16x32_bf16 v[108:111], v[8:11], a[204:207], v[108:111]
    s_waitcnt lgkmcnt(3)
    v_mfma_f32_16x16x32_bf16 v[112:115], v[12:15], a[192:195], v[112:115]
    ds_read_b128 v[28:31], v4 offset:29696
    v_mfma_f32_16x16x32_bf16 v[116:119], v[12:15], a[196:199], v[116:119]
    v_mfma_f32_16x16x32_bf16 v[120:123], v[12:15], a[200:203], v[120:123]
    v_mfma_f32_16x16x32_bf16 v[124:127], v[12:15], a[204:207], v[124:127]
    s_waitcnt lgkmcnt(3)
    v_mfma_f32_16x16x32_bf16 v[96:99], v[16:19], a[208:211], v[96:99]
    ds_read_b128 v[8:11], v4 offset:30720
    v_mfma_f32_16x16x32_bf16 v[100:103], v[16:19], a[212:215], v[100:103]
    v_mfma_f32_16x16x32_bf16 v[104:107], v[16:19], a[216:219], v[104:107]
    v_mfma_f32_16x16x32_bf16 v[108:111], v[16:19], a[220:223], v[108:111]
    s_waitcnt lgkmcnt(3)
    v_mfma_f32_16x16x32_bf16 v[112:115], v[20:23], a[208:211], v[112:115]
    ds_read_b128 v[12:15], v4 offset:31744
    v_mfma_f32_16x16x32_bf16 v[116:119], v[20:23], a[212:215], v[116:119]
    v_mfma_f32_16x16x32_bf16 v[120:123], v[20:23], a[216:219], v[120:123]
    v_mfma_f32_16x16x32_bf16 v[124:127], v[20:23], a[220:223], v[124:127]
    s_waitcnt lgkmcnt(3)
    v_mfma_f32_16x16x32_bf16 v[96:99], v[24:27], a[224:227], v[96:99]
    ds_read_b128 v[16:19], v4 offset:32768
    v_mfma_f32_16x16x32_bf16 v[100:103], v[24:27], a[228:231], v[100:103]
    v_mfma_f32_16x16x32_bf16 v[104:107], v[24:27], a[232:235], v[104:107]
    v_mfma_f32_16x16x32_bf16 v[108:111], v[24:27], a[236:239], v[108:111]
    s_waitcnt lgkmcnt(3)
    v_mfma_f32_16x16x32_bf16 v[112:115], v[28:31], a[224:227], v[112:115]
    ds_read_b128 v[20:23], v4 offset:33792
    v_mfma_f32_16x16x32_bf16 v[116:119], v[28:31], a[228:231], v[116:119]
    v_mfma_f32_16x16x32_bf16 v[120:123], v[28:31], a[232:235], v[120:123]
    v_mfma_f32_16x16x32_bf16 v[124:127], v[28:31], a[236:239], v[124:127]
    s_waitcnt lgkmcnt(3)
    v_mfma_f32_16x16x32_bf16 v[96:99], v[8:11], a[240:243], v[96:99]
    ds_read_b128 v[24:27], v4 offset:34816
    v_mfma_f32_16x16x32_bf16 v[100:103], v[8:11], a[244:247], v[100:103]
    v_mfma_f32_16x16x32_bf16 v[104:107], v[8:11], a[248:251], v[104:107]
    v_mfma_f32_16x16x32_bf16 v[108:111], v[8:11], a[252:255], v[108:111]
    s_waitcnt lgkmcnt(3)
    ds_read_b128 v[136:139], v5 offset:768
    ds_read_b128 v[140:143], v5 offset:832
    v_mfma_f32_16x16x32_bf16 v[112:115], v[12:15], a[240:243], v[112:115]
    ds_read_b128 v[28:31], v4 offset:35840
    v_mfma_f32_16x16x32_bf16 v[116:119], v[12:15], a[244:247], v[116:119]
    v_mfma_f32_16x16x32_bf16 v[120:123], v[12:15], a[248:251], v[120:123]
    v_mfma_f32_16x16x32_bf16 v[124:127], v[12:15], a[252:255], v[124:127]
    s_waitcnt lgkmcnt(5)
    v_mfma_f32_16x16x32_bf16 v[96:99], v[16:19], v[32:35], v[96:99]
    s_barrier
    v_add_u32 v4, 0x9000, v4
    v_mfma_f32_16x16x32_bf16 v[100:103], v[16:19], v[36:39], v[100:103]
    s_add_u32 m0, s49, 36864
    s_add_u32 s61, s48, 331776
    ds_read_b128 v[8:11], v4 offset:0
    v_mfma_f32_16x16x32_bf16 v[104:107], v[16:19], v[40:43], v[104:107]
    buffer_load_dwordx4 v2, s[4:7], s61 offen offset:0 lds
    v_mfma_f32_16x16x32_bf16 v[108:111], v[16:19], v[44:47], v[108:111]
    s_waitcnt lgkmcnt(5)
    v_mfma_f32_16x16x32_bf16 v[112:115], v[20:23], v[32:35], v[112:115]
    ds_read_b128 v[12:15], v4 offset:1024
    v_mfma_f32_16x16x32_bf16 v[116:119], v[20:23], v[36:39], v[116:119]
    v_mfma_f32_16x16x32_bf16 v[120:123], v[20:23], v[40:43], v[120:123]
    buffer_load_dwordx4 v2, s[4:7], s61 offen offset:1024 lds
    v_mfma_f32_16x16x32_bf16 v[124:127], v[20:23], v[44:47], v[124:127]
    s_waitcnt lgkmcnt(5)
    v_mfma_f32_16x16x32_bf16 v[96:99], v[24:27], v[48:51], v[96:99]
    ds_read_b128 v[16:19], v4 offset:2048
    v_mfma_f32_16x16x32_bf16 v[100:103], v[24:27], v[52:55], v[100:103]
    v_mfma_f32_16x16x32_bf16 v[104:107], v[24:27], v[56:59], v[104:107]
    buffer_load_dwordx4 v2, s[4:7], s61 offen offset:2048 lds
    v_mfma_f32_16x16x32_bf16 v[108:111], v[24:27], v[60:63], v[108:111]
    s_waitcnt lgkmcnt(3)
    v_mfma_f32_16x16x32_bf16 v[112:115], v[28:31], v[48:51], v[112:115]
    ds_read_b128 v[20:23], v4 offset:3072
    v_mfma_f32_16x16x32_bf16 v[116:119], v[28:31], v[52:55], v[116:119]
    v_mfma_f32_16x16x32_bf16 v[120:123], v[28:31], v[56:59], v[120:123]
    buffer_load_dwordx4 v2, s[4:7], s61 offen offset:3072 lds
    v_mfma_f32_16x16x32_bf16 v[124:127], v[28:31], v[60:63], v[124:127]
    s_waitcnt lgkmcnt(3)
    s_add_u32 m0, s49, 40960
    s_add_u32 s61, s48, 335872
    v_mfma_f32_16x16x32_bf16 v[64:67], v[8:11], a[0:3], 0
    ds_read_b128 v[24:27], v4 offset:4096
    v_mfma_f32_16x16x32_bf16 v[68:71], v[8:11], a[4:7], 0
    v_mfma_f32_16x16x32_bf16 v[72:75], v[8:11], a[8:11], 0
    buffer_load_dwordx4 v2, s[4:7], s61 offen offset:0 lds
    v_mfma_f32_16x16x32_bf16 v[76:79], v[8:11], a[12:15], 0
    s_waitcnt lgkmcnt(3)
    v_mfma_f32_16x16x32_bf16 v[80:83], v[12:15], a[0:3], 0
    ds_read_b128 v[28:31], v4 offset:5120
    v_mfma_f32_16x16x32_bf16 v[84:87], v[12:15], a[4:7], 0
    v_fmac_f32 v96, v136, v128
    v_fmac_f32 v97, v137, v128
    v_mfma_f32_16x16x32_bf16 v[88:91], v[12:15], a[8:11], 0
    buffer_load_dwordx4 v2, s[4:7], s61 offen offset:1024 lds
    v_mfma_f32_16x16x32_bf16 v[92:95], v[12:15], a[12:15], 0
    s_waitcnt lgkmcnt(3)
    v_fmac_f32 v98, v138, v128
    v_fmac_f32 v99, v139, v128
    v_mfma_f32_16x16x32_bf16 v[64:67], v[16:19], a[16:19], v[64:67]
    ds_read_b128 v[8:11], v4 offset:6144
    v_fmac_f32 v112, v140, v128
    v_mfma_f32_16x16x32_bf16 v[68:71], v[16:19], a[20:23], v[68:71]
    v_fmac_f32 v113, v141, v128
    v_fmac_f32 v114, v142, v128
    v_mfma_f32_16x16x32_bf16 v[72:75], v[16:19], a[24:27], v[72:75]
    buffer_load_dwordx4 v2, s[4:7], s61 offen offset:2048 lds
    v_mfma_f32_16x16x32_bf16 v[76:79], v[16:19], a[28:31], v[76:79]
    s_waitcnt lgkmcnt(3)
    v_fmac_f32 v115, v143, v128
    v_mul_f32 v96, v96, v132
    v_mfma_f32_16x16x32_bf16 v[80:83], v[20:23], a[16:19], v[80:83]
    ds_read_b128 v[12:15], v4 offset:7168
    v_mul_f32 v97, v97, v132
    v_mfma_f32_16x16x32_bf16 v[84:87], v[20:23], a[20:23], v[84:87]
    v_mul_f32 v98, v98, v132
    v_mul_f32 v99, v99, v132
    v_mfma_f32_16x16x32_bf16 v[88:91], v[20:23], a[24:27], v[88:91]
    buffer_load_dwordx4 v2, s[4:7], s61 offen offset:3072 lds
    v_mfma_f32_16x16x32_bf16 v[92:95], v[20:23], a[28:31], v[92:95]
    s_waitcnt lgkmcnt(3)
    s_add_u32 m0, s49, 45056
    s_add_u32 s61, s48, 339968
    v_mfma_f32_16x16x32_bf16 v[64:67], v[24:27], a[32:35], v[64:67]
    ds_read_b128 v[16:19], v4 offset:8192
    v_mul_f32 v96, v96, v112
    v_mfma_f32_16x16x32_bf16 v[68:71], v[24:27], a[36:39], v[68:71]
    v_mul_f32 v97, v97, v113
    v_mul_f32 v98, v98, v114
    v_mfma_f32_16x16x32_bf16 v[72:75], v[24:27], a[40:43], v[72:75]
    buffer_load_dwordx4 v2, s[4:7], s61 offen offset:0 lds
    v_mfma_f32_16x16x32_bf16 v[76:79], v[24:27], a[44:47], v[76:79]
    s_waitcnt lgkmcnt(3)
    v_mul_f32 v99, v99, v115
    v_cvt_pk_bf16_f32 v210, v96, v97
    v_mfma_f32_16x16x32_bf16 v[80:83], v[28:31], a[32:35], v[80:83]
    ds_read_b128 v[20:23], v4 offset:9216
    v_cvt_pk_bf16_f32 v211, v98, v99
    v_mfma_f32_16x16x32_bf16 v[84:87], v[28:31], a[36:39], v[84:87]
    s_add_u32 s66, s51, 32768
    v_mfma_f32_16x16x32_bf16 v[88:91], v[28:31], a[40:43], v[88:91]
    buffer_store_dwordx4 v[208:211], v2, s[4:7], s66 offen offset:0 sc1
    v_mfma_f32_16x16x32_bf16 v[92:95], v[28:31], a[44:47], v[92:95]
    s_waitcnt lgkmcnt(3)
    v_fmac_f32 v100, v136, v129
    v_fmac_f32 v101, v137, v129
    v_mfma_f32_16x16x32_bf16 v[64:67], v[8:11], a[48:51], v[64:67]
    ds_read_b128 v[24:27], v4 offset:10240
    v_fmac_f32 v102, v138, v129
    v_mfma_f32_16x16x32_bf16 v[68:71], v[8:11], a[52:55], v[68:71]
    v_fmac_f32 v103, v139, v129
    v_fmac_f32 v116, v140, v129
    v_mfma_f32_16x16x32_bf16 v[72:75], v[8:11], a[56:59], v[72:75]
    v_fmac_f32 v117, v141, v129
    v_fmac_f32 v118, v142, v129
    v_mfma_f32_16x16x32_bf16 v[76:79], v[8:11], a[60:63], v[76:79]
    s_waitcnt lgkmcnt(3)
    v_fmac_f32 v119, v143, v129
    v_mul_f32 v100, v100, v133
    v_mfma_f32_16x16x32_bf16 v[80:83], v[12:15], a[48:51], v[80:83]
    ds_read_b128 v[28:31], v4 offset:11264
    v_mul_f32 v101, v101, v133
    v_mfma_f32_16x16x32_bf16 v[84:87], v[12:15], a[52:55], v[84:87]
    v_mul_f32 v102, v102, v133
    v_mul_f32 v103, v103, v133
    v_mfma_f32_16x16x32_bf16 v[88:91], v[12:15], a[56:59], v[88:91]
    v_mul_f32 v100, v100, v116
    v_mul_f32 v101, v101, v117
    v_mfma_f32_16x16x32_bf16 v[92:95], v[12:15], a[60:63], v[92:95]
    s_waitcnt lgkmcnt(3)
    v_mul_f32 v102, v102, v118
    v_mul_f32 v103, v103, v119
    v_mfma_f32_16x16x32_bf16 v[64:67], v[16:19], a[64:67], v[64:67]
    ds_read_b128 v[8:11], v4 offset:12288
    v_cvt_pk_bf16_f32 v214, v100, v101
    v_mfma_f32_16x16x32_bf16 v[68:71], v[16:19], a[68:71], v[68:71]
    v_cvt_pk_bf16_f32 v215, v102, v103
    v_mfma_f32_16x16x32_bf16 v[72:75], v[16:19], a[72:75], v[72:75]
    buffer_store_dwordx4 v[212:215], v2, s[4:7], s66 offen offset:1024 sc1
    v_mfma_f32_16x16x32_bf16 v[76:79], v[16:19], a[76:79], v[76:79]
    s_waitcnt lgkmcnt(3)
    v_fmac_f32 v104, v136, v130
    v_fmac_f32 v105, v137, v130
    v_mfma_f32_16x16x32_bf16 v[80:83], v[20:23], a[64:67], v[80:83]
    ds_read_b128 v[12:15], v4 offset:13312
    v_fmac_f32 v106, v138, v130
    v_mfma_f32_16x16x32_bf16 v[84:87], v[20:23], a[68:71], v[84:87]
    v_fmac_f32 v107, v139, v130
    v_fmac_f32 v120, v140, v130
    v_mfma_f32_16x16x32_bf16 v[88:91], v[20:23], a[72:75], v[88:91]
    v_fmac_f32 v121, v141, v130
    v_fmac_f32 v122, v142, v130
    v_mfma_f32_16x16x32_bf16 v[92:95], v[20:23], a[76:79], v[92:95]
    s_waitcnt lgkmcnt(3)
    v_fmac_f32 v123, v143, v130
    v_mul_f32 v104, v104, v134
    v_mfma_f32_16x16x32_bf16 v[64:67], v[24:27], a[80:83], v[64:67]
    ds_read_b128 v[16:19], v4 offset:14336
    v_mul_f32 v105, v105, v134
    v_mfma_f32_16x16x32_bf16 v[68:71], v[24:27], a[84:87], v[68:71]
    v_mul_f32 v106, v106, v134
    v_mul_f32 v107, v107, v134
    v_mfma_f32_16x16x32_bf16 v[72:75], v[24:27], a[88:91], v[72:75]
    v_mul_f32 v104, v104, v120
    v_mul_f32 v105, v105, v121
    v_mfma_f32_16x16x32_bf16 v[76:79], v[24:27], a[92:95], v[76:79]
    s_waitcnt lgkmcnt(3)
    v_mul_f32 v106, v106, v122
    v_mul_f32 v107, v107, v123
    v_mfma_f32_16x16x32_bf16 v[80:83], v[28:31], a[80:83], v[80:83]
    ds_read_b128 v[20:23], v4 offset:15360
    v_cvt_pk_bf16_f32 v218, v104, v105
    v_mfma_f32_16x16x32_bf16 v[84:87], v[28:31], a[84:87], v[84:87]
    v_cvt_pk_bf16_f32 v219, v106, v107
    v_mfma_f32_16x16x32_bf16 v[88:91], v[28:31], a[88:91], v[88:91]
    buffer_store_dwordx4 v[216:219], v2, s[4:7], s66 offen offset:2048 sc1
    v_mfma_f32_16x16x32_bf16 v[92:95], v[28:31], a[92:95], v[92:95]
    s_waitcnt lgkmcnt(3)
    v_fmac_f32 v108, v136, v131
    v_fmac_f32 v109, v137, v131
    v_mfma_f32_16x16x32_bf16 v[64:67], v[8:11], a[96:99], v[64:67]
    ds_read_b128 v[24:27], v4 offset:16384
    v_fmac_f32 v110, v138, v131
    v_mfma_f32_16x16x32_bf16 v[68:71], v[8:11], a[100:103], v[68:71]
    v_fmac_f32 v111, v139, v131
    v_fmac_f32 v124, v140, v131
    v_mfma_f32_16x16x32_bf16 v[72:75], v[8:11], a[104:107], v[72:75]
    v_fmac_f32 v125, v141, v131
    v_fmac_f32 v126, v142, v131
    v_mfma_f32_16x16x32_bf16 v[76:79], v[8:11], a[108:111], v[76:79]
    s_waitcnt lgkmcnt(3)
    v_fmac_f32 v127, v143, v131
    v_mul_f32 v108, v108, v135
    v_mfma_f32_16x16x32_bf16 v[80:83], v[12:15], a[96:99], v[80:83]
    ds_read_b128 v[28:31], v4 offset:17408
    v_mul_f32 v109, v109, v135
    v_mfma_f32_16x16x32_bf16 v[84:87], v[12:15], a[100:103], v[84:87]
    v_mul_f32 v110, v110, v135
    v_mul_f32 v111, v111, v135
    v_mfma_f32_16x16x32_bf16 v[88:91], v[12:15], a[104:107], v[88:91]
    v_mul_f32 v108, v108, v124
    v_mul_f32 v109, v109, v125
    v_mfma_f32_16x16x32_bf16 v[92:95], v[12:15], a[108:111], v[92:95]
    s_waitcnt lgkmcnt(3)
    v_mul_f32 v110, v110, v126
    v_mul_f32 v111, v111, v127
    v_mfma_f32_16x16x32_bf16 v[64:67], v[16:19], a[112:115], v[64:67]
    ds_read_b128 v[8:11], v4 offset:18432
    v_cvt_pk_bf16_f32 v222, v108, v109
    v_mfma_f32_16x16x32_bf16 v[68:71], v[16:19], a[116:119], v[68:71]
    v_cvt_pk_bf16_f32 v223, v110, v111
    v_mfma_f32_16x16x32_bf16 v[72:75], v[16:19], a[120:123], v[72:75]
    buffer_store_dwordx4 v[220:223], v2, s[4:7], s66 offen offset:3072 sc1
    v_mfma_f32_16x16x32_bf16 v[76:79], v[16:19], a[124:127], v[76:79]
    s_waitcnt lgkmcnt(3)
    v_mfma_f32_16x16x32_bf16 v[80:83], v[20:23], a[112:115], v[80:83]
    ds_read_b128 v[12:15], v4 offset:19456
    v_mfma_f32_16x16x32_bf16 v[84:87], v[20:23], a[116:119], v[84:87]
    v_mfma_f32_16x16x32_bf16 v[88:91], v[20:23], a[120:123], v[88:91]
    v_mfma_f32_16x16x32_bf16 v[92:95], v[20:23], a[124:127], v[92:95]
    s_waitcnt lgkmcnt(3)
    v_and_b32 v0, 3, v1
    v_lshlrev_b32 v0, 3, v0
    v_mfma_f32_16x16x32_bf16 v[64:67], v[24:27], a[128:131], v[64:67]
    s_mov_b32 s55, s52
    ds_read_b128 v[16:19], v4 offset:20480
    v_mfma_f32_16x16x32_bf16 v[68:71], v[24:27], a[132:135], v[68:71]
    v_mfma_f32_16x16x32_bf16 v[72:75], v[24:27], a[136:139], v[72:75]
    v_mfma_f32_16x16x32_bf16 v[76:79], v[24:27], a[140:143], v[76:79]
    s_waitcnt lgkmcnt(3)
    v_mfma_f32_16x16x32_bf16 v[80:83], v[28:31], a[128:131], v[80:83]
    ds_read_b128 v[20:23], v4 offset:21504
    v_mfma_f32_16x16x32_bf16 v[84:87], v[28:31], a[132:135], v[84:87]
    v_mfma_f32_16x16x32_bf16 v[88:91], v[28:31], a[136:139], v[88:91]
    v_mfma_f32_16x16x32_bf16 v[92:95], v[28:31], a[140:143], v[92:95]
    s_waitcnt lgkmcnt(3)
    v_mfma_f32_16x16x32_bf16 v[64:67], v[8:11], a[144:147], v[64:67]
    ds_read_b128 v[24:27], v4 offset:22528
    v_mfma_f32_16x16x32_bf16 v[68:71], v[8:11], a[148:151], v[68:71]
    v_mfma_f32_16x16x32_bf16 v[72:75], v[8:11], a[152:155], v[72:75]
    v_mfma_f32_16x16x32_bf16 v[76:79], v[8:11], a[156:159], v[76:79]
    s_waitcnt lgkmcnt(3)
    v_mfma_f32_16x16x32_bf16 v[80:83], v[12:15], a[144:147], v[80:83]
    ds_read_b128 v[28:31], v4 offset:23552
    v_mfma_f32_16x16x32_bf16 v[84:87], v[12:15], a[148:151], v[84:87]
    v_mfma_f32_16x16x32_bf16 v[88:91], v[12:15], a[152:155], v[88:91]
    v_mfma_f32_16x16x32_bf16 v[92:95], v[12:15], a[156:159], v[92:95]
    s_waitcnt lgkmcnt(3)
    v_mfma_f32_16x16x32_bf16 v[64:67], v[16:19], a[160:163], v[64:67]
    ds_read_b128 v[8:11], v4 offset:24576
    v_mfma_f32_16x16x32_bf16 v[68:71], v[16:19], a[164:167], v[68:71]
    v_mfma_f32_16x16x32_bf16 v[72:75], v[16:19], a[168:171], v[72:75]
    v_mfma_f32_16x16x32_bf16 v[76:79], v[16:19], a[172:175], v[76:79]
    s_waitcnt lgkmcnt(3)
    v_mfma_f32_16x16x32_bf16 v[80:83], v[20:23], a[160:163], v[80:83]
    ds_read_b128 v[12:15], v4 offset:25600
    v_mfma_f32_16x16x32_bf16 v[84:87], v[20:23], a[164:167], v[84:87]
    buffer_load_dwordx2 v[6:7], v0, s[4:7], s55 offen sc1
    v_mfma_f32_16x16x32_bf16 v[88:91], v[20:23], a[168:171], v[88:91]
    v_mfma_f32_16x16x32_bf16 v[92:95], v[20:23], a[172:175], v[92:95]
    s_waitcnt lgkmcnt(3)
    v_mfma_f32_16x16x32_bf16 v[64:67], v[24:27], a[176:179], v[64:67]
    ds_read_b128 v[16:19], v4 offset:26624
    v_mfma_f32_16x16x32_bf16 v[68:71], v[24:27], a[180:183], v[68:71]
    v_mfma_f32_16x16x32_bf16 v[72:75], v[24:27], a[184:187], v[72:75]
    v_mfma_f32_16x16x32_bf16 v[76:79], v[24:27], a[188:191], v[76:79]
    s_waitcnt lgkmcnt(3)
    v_mfma_f32_16x16x32_bf16 v[80:83], v[28:31], a[176:179], v[80:83]
    ds_read_b128 v[20:23], v4 offset:27648
    v_mfma_f32_16x16x32_bf16 v[84:87], v[28:31], a[180:183], v[84:87]
    v_mfma_f32_16x16x32_bf16 v[88:91], v[28:31], a[184:187], v[88:91]
    v_mfma_f32_16x16x32_bf16 v[92:95], v[28:31], a[188:191], v[92:95]
    s_waitcnt lgkmcnt(3)
    v_mfma_f32_16x16x32_bf16 v[64:67], v[8:11], a[192:195], v[64:67]
    ds_read_b128 v[24:27], v4 offset:28672
    v_mfma_f32_16x16x32_bf16 v[68:71], v[8:11], a[196:199], v[68:71]
    v_mfma_f32_16x16x32_bf16 v[72:75], v[8:11], a[200:203], v[72:75]
    v_mfma_f32_16x16x32_bf16 v[76:79], v[8:11], a[204:207], v[76:79]
    s_waitcnt lgkmcnt(3)
    v_mfma_f32_16x16x32_bf16 v[80:83], v[12:15], a[192:195], v[80:83]
    ds_read_b128 v[28:31], v4 offset:29696
    v_mfma_f32_16x16x32_bf16 v[84:87], v[12:15], a[196:199], v[84:87]
    v_mfma_f32_16x16x32_bf16 v[88:91], v[12:15], a[200:203], v[88:91]
    v_mfma_f32_16x16x32_bf16 v[92:95], v[12:15], a[204:207], v[92:95]
    s_waitcnt lgkmcnt(3)
    v_mfma_f32_16x16x32_bf16 v[64:67], v[16:19], a[208:211], v[64:67]
    ds_read_b128 v[8:11], v4 offset:30720
    v_mfma_f32_16x16x32_bf16 v[68:71], v[16:19], a[212:215], v[68:71]
    v_mfma_f32_16x16x32_bf16 v[72:75], v[16:19], a[216:219], v[72:75]
    v_mfma_f32_16x16x32_bf16 v[76:79], v[16:19], a[220:223], v[76:79]
    s_waitcnt lgkmcnt(3)
    v_mfma_f32_16x16x32_bf16 v[80:83], v[20:23], a[208:211], v[80:83]
    ds_read_b128 v[12:15], v4 offset:31744
    v_mfma_f32_16x16x32_bf16 v[84:87], v[20:23], a[212:215], v[84:87]
    v_mfma_f32_16x16x32_bf16 v[88:91], v[20:23], a[216:219], v[88:91]
    v_mfma_f32_16x16x32_bf16 v[92:95], v[20:23], a[220:223], v[92:95]
    s_waitcnt lgkmcnt(3)
    v_mfma_f32_16x16x32_bf16 v[64:67], v[24:27], a[224:227], v[64:67]
    ds_read_b128 v[16:19], v4 offset:32768
    v_mfma_f32_16x16x32_bf16 v[68:71], v[24:27], a[228:231], v[68:71]
    v_mfma_f32_16x16x32_bf16 v[72:75], v[24:27], a[232:235], v[72:75]
    v_mfma_f32_16x16x32_bf16 v[76:79], v[24:27], a[236:239], v[76:79]
    s_waitcnt lgkmcnt(3)
    v_mfma_f32_16x16x32_bf16 v[80:83], v[28:31], a[224:227], v[80:83]
    ds_read_b128 v[20:23], v4 offset:33792
    v_mfma_f32_16x16x32_bf16 v[84:87], v[28:31], a[228:231], v[84:87]
    v_mfma_f32_16x16x32_bf16 v[88:91], v[28:31], a[232:235], v[88:91]
    v_mfma_f32_16x16x32_bf16 v[92:95], v[28:31], a[236:239], v[92:95]
    s_waitcnt lgkmcnt(3)
    v_mfma_f32_16x16x32_bf16 v[64:67], v[8:11], a[240:243], v[64:67]
    ds_read_b128 v[24:27], v4 offset:34816
    v_mfma_f32_16x16x32_bf16 v[68:71], v[8:11], a[244:247], v[68:71]
    v_mfma_f32_16x16x32_bf16 v[72:75], v[8:11], a[248:251], v[72:75]
    v_mfma_f32_16x16x32_bf16 v[76:79], v[8:11], a[252:255], v[76:79]
    s_waitcnt lgkmcnt(3)
    ds_read_b128 v[144:147], v5 offset:896
    ds_read_b128 v[148:151], v5 offset:960
    v_mfma_f32_16x16x32_bf16 v[80:83], v[12:15], a[240:243], v[80:83]
    s_waitcnt vmcnt(0)
    v_cmp_eq_u64 vcc, s[98:99], v[6:7]
    s_nop 0
    s_cmp_eq_u64 vcc, exec
    s_cbranch_scc0 L_p0_slow_86
L_p0_back_87:
    v_mfma_f32_16x16x32_bf16 v[84:87], v[12:15], a[244:247], v[84:87]
    s_add_u32 s60, s56, s65
    ds_read_b128 v[28:31], v4 offset:35840
    v_mfma_f32_16x16x32_bf16 v[88:91], v[12:15], a[248:251], v[88:91]
    buffer_load_dwordx2 v[242:243], v3, s[4:7], s60 offen offset:0 sc1
    v_mfma_f32_16x16x32_bf16 v[92:95], v[12:15], a[252:255], v[92:95]
    s_waitcnt lgkmcnt(5)
    v_mfma_f32_16x16x32_bf16 v[64:67], v[16:19], v[32:35], v[64:67]
    s_barrier
    v_add_u32 v4, 0xfffe5000, v4
    v_mfma_f32_16x16x32_bf16 v[68:71], v[16:19], v[36:39], v[68:71]
    s_add_u32 m0, s49, 73728
    s_add_u32 s61, s48, 368640
    ds_read_b128 v[8:11], v4 offset:0
    v_mfma_f32_16x16x32_bf16 v[72:75], v[16:19], v[40:43], v[72:75]
    buffer_load_dwordx4 v2, s[4:7], s61 offen offset:0 lds
    v_mfma_f32_16x16x32_bf16 v[76:79], v[16:19], v[44:47], v[76:79]
    s_waitcnt lgkmcnt(5)
    v_mfma_f32_16x16x32_bf16 v[80:83], v[20:23], v[32:35], v[80:83]
    ds_read_b128 v[12:15], v4 offset:1024
    v_mfma_f32_16x16x32_bf16 v[84:87], v[20:23], v[36:39], v[84:87]
    v_mfma_f32_16x16x32_bf16 v[88:91], v[20:23], v[40:43], v[88:91]
    buffer_load_dwordx4 v2, s[4:7], s61 offen offset:1024 lds
    v_mfma_f32_16x16x32_bf16 v[92:95], v[20:23], v[44:47], v[92:95]
    s_waitcnt lgkmcnt(5)
    v_mfma_f32_16x16x32_bf16 v[64:67], v[24:27], v[48:51], v[64:67]
    ds_read_b128 v[16:19], v4 offset:2048
    v_mfma_f32_16x16x32_bf16 v[68:71], v[24:27], v[52:55], v[68:71]
    s_add_u32 s71, s67, 32
    v_mov_b32 v6, s98
    v_mov_b32 v7, s99
    v_mfma_f32_16x16x32_bf16 v[72:75], v[24:27], v[56:59], v[72:75]
    buffer_load_dwordx4 v2, s[4:7], s61 offen offset:2048 lds
    v_mfma_f32_16x16x32_bf16 v[76:79], v[24:27], v[60:63], v[76:79]
    s_waitcnt lgkmcnt(3)
    v_mfma_f32_16x16x32_bf16 v[80:83], v[28:31], v[48:51], v[80:83]
    ds_read_b128 v[20:23], v4 offset:3072
    v_mfma_f32_16x16x32_bf16 v[84:87], v[28:31], v[52:55], v[84:87]
    v_mfma_f32_16x16x32_bf16 v[88:91], v[28:31], v[56:59], v[88:91]
    s_mov_b64 exec, 1
    buffer_store_dwordx2 v[6:7], off, s[4:7], s71 sc1
    s_mov_b64 exec, -1
    v_mfma_f32_16x16x32_bf16 v[92:95], v[28:31], v[60:63], v[92:95]
    s_waitcnt lgkmcnt(3)
    v_mfma_f32_16x16x32_bf16 v[96:99], v[8:11], a[0:3], 0
    ds_read_b128 v[24:27], v4 offset:4096
    v_mfma_f32_16x16x32_bf16 v[100:103], v[8:11], a[4:7], 0
    v_mfma_f32_16x16x32_bf16 v[104:107], v[8:11], a[8:11], 0
    buffer_load_dwordx4 v2, s[4:7], s61 offen offset:3072 lds
    v_mfma_f32_16x16x32_bf16 v[108:111], v[8:11], a[12:15], 0
    s_waitcnt lgkmcnt(3)
    s_add_u32 m0, s49, 77824
    s_add_u32 s61, s48, 372736
    v_mfma_f32_16x16x32_bf16 v[112:115], v[12:15], a[0:3], 0
    ds_read_b128 v[28:31], v4 offset:5120
    v_mfma_f32_16x16x32_bf16 v[116:119], v[12:15], a[4:7], 0
    v_fmac_f32 v64, v144, v128
    v_fmac_f32 v65, v145, v128
    v_mfma_f32_16x16x32_bf16 v[120:123], v[12:15], a[8:11], 0
    buffer_load_dwordx4 v2, s[4:7], s61 offen offset:0 lds
    v_mfma_f32_16x16x32_bf16 v[124:127], v[12:15], a[12:15], 0
    s_waitcnt lgkmcnt(3)
    v_fmac_f32 v66, v146, v128
    v_fmac_f32 v67, v147, v128
    v_mfma_f32_16x16x32_bf16 v[96:99], v[16:19], a[16:19], v[96:99]
    ds_read_b128 v[8:11], v4 offset:6144
    v_fmac_f32 v80, v148, v128
    v_mfma_f32_16x16x32_bf16 v[100:103], v[16:19], a[20:23], v[100:103]
    v_fmac_f32 v81, v149, v128
    v_fmac_f32 v82, v150, v128
    v_mfma_f32_16x16x32_bf16 v[104:107], v[16:19], a[24:27], v[104:107]
    buffer_load_dwordx4 v2, s[4:7], s61 offen offset:1024 lds
    v_mfma_f32_16x16x32_bf16 v[108:111], v[16:19], a[28:31], v[108:111]
    s_waitcnt lgkmcnt(3)
    v_fmac_f32 v83, v151, v128
    v_mul_f32 v64, v64, v132
    v_mfma_f32_16x16x32_bf16 v[112:115], v[20:23], a[16:19], v[112:115]
    ds_read_b128 v[12:15], v4 offset:7168
    v_mul_f32 v65, v65, v132
    v_mfma_f32_16x16x32_bf16 v[116:119], v[20:23], a[20:23], v[116:119]
    v_mul_f32 v66, v66, v132
    v_mul_f32 v67, v67, v132
    v_mfma_f32_16x16x32_bf16 v[120:123], v[20:23], a[24:27], v[120:123]
    buffer_load_dwordx4 v2, s[4:7], s61 offen offset:2048 lds
    v_mfma_f32_16x16x32_bf16 v[124:127], v[20:23], a[28:31], v[124:127]
    s_waitcnt lgkmcnt(3)
    v_mul_f32 v64, v64, v80
    v_mul_f32 v65, v65, v81
    v_mfma_f32_16x16x32_bf16 v[96:99], v[24:27], a[32:35], v[96:99]
    ds_read_b128 v[16:19], v4 offset:8192
    v_mul_f32 v66, v66, v82
    v_mfma_f32_16x16x32_bf16 v[100:103], v[24:27], a[36:39], v[100:103]
    v_mul_f32 v67, v67, v83
    v_cvt_pk_bf16_f32 v224, v64, v65
    v_mfma_f32_16x16x32_bf16 v[104:107], v[24:27], a[40:43], v[104:107]
    buffer_load_dwordx4 v2, s[4:7], s61 offen offset:3072 lds
    v_mfma_f32_16x16x32_bf16 v[108:111], v[24:27], a[44:47], v[108:111]
    s_waitcnt lgkmcnt(3)
    s_add_u32 m0, s49, 81920
    s_add_u32 s61, s48, 376832
    v_mfma_f32_16x16x32_bf16 v[112:115], v[28:31], a[32:35], v[112:115]
    ds_read_b128 v[20:23], v4 offset:9216
    v_cvt_pk_bf16_f32 v225, v66, v67
    v_mfma_f32_16x16x32_bf16 v[116:119], v[28:31], a[36:39], v[116:119]
    v_fmac_f32 v68, v144, v129
    v_fmac_f32 v69, v145, v129
    v_mfma_f32_16x16x32_bf16 v[120:123], v[28:31], a[40:43], v[120:123]
    buffer_load_dwordx4 v2, s[4:7], s61 offen offset:0 lds
    v_mfma_f32_16x16x32_bf16 v[124:127], v[28:31], a[44:47], v[124:127]
    s_waitcnt lgkmcnt(3)
    v_fmac_f32 v70, v146, v129
    v_fmac_f32 v71, v147, v129
    v_mfma_f32_16x16x32_bf16 v[96:99], v[8:11], a[48:51], v[96:99]
    ds_read_b128 v[24:27], v4 offset:10240
    v_fmac_f32 v84, v148, v129
    v_mfma_f32_16x16x32_bf16 v[100:103], v[8:11], a[52:55], v[100:103]
    v_fmac_f32 v85, v149, v129
    v_fmac_f32 v86, v150, v129
    v_mfma_f32_16x16x32_bf16 v[104:107], v[8:11], a[56:59], v[104:107]
    buffer_load_dwordx2 v[246:247], v3, s[4:7], s60 offen offset:512 sc1
    v_mfma_f32_16x16x32_bf16 v[108:111], v[8:11], a[60:63], v[108:111]
    s_waitcnt lgkmcnt(3)
    v_fmac_f32 v87, v151, v129
    v_mul_f32 v68, v68, v133
    v_mfma_f32_16x16x32_bf16 v[112:115], v[12:15], a[48:51], v[112:115]
    ds_read_b128 v[28:31], v4 offset:11264
    v_mul_f32 v69, v69, v133
    v_mfma_f32_16x16x32_bf16 v[116:119], v[12:15], a[52:55], v[116:119]
    v_mul_f32 v70, v70, v133
    v_mul_f32 v71, v71, v133
    v_mfma_f32_16x16x32_bf16 v[120:123], v[12:15], a[56:59], v[120:123]
    buffer_load_dwordx2 v[250:251], v3, s[4:7], s60 offen offset:1024 sc1
    v_mfma_f32_16x16x32_bf16 v[124:127], v[12:15], a[60:63], v[124:127]
    s_waitcnt lgkmcnt(3)
    v_mul_f32 v68, v68, v84
    v_mul_f32 v69, v69, v85
    v_mfma_f32_16x16x32_bf16 v[96:99], v[16:19], a[64:67], v[96:99]
    ds_read_b128 v[8:11], v4 offset:12288
    v_mul_f32 v70, v70, v86
    v_mfma_f32_16x16x32_bf16 v[100:103], v[16:19], a[68:71], v[100:103]
    v_mul_f32 v71, v71, v87
    v_cvt_pk_bf16_f32 v228, v68, v69
    v_mfma_f32_16x16x32_bf16 v[104:107], v[16:19], a[72:75], v[104:107]
    buffer_load_dwordx2 v[254:255], v3, s[4:7], s60 offen offset:1536 sc1
    v_mfma_f32_16x16x32_bf16 v[108:111], v[16:19], a[76:79], v[108:111]
    s_waitcnt lgkmcnt(3)
    s_add_u32 s60, s57, s65
    v_cvt_pk_bf16_f32 v229, v70, v71
    v_mfma_f32_16x16x32_bf16 v[112:115], v[20:23], a[64:67], v[112:115]
    ds_read_b128 v[12:15], v4 offset:13312
    v_fmac_f32 v72, v144, v130
    v_mfma_f32_16x16x32_bf16 v[116:119], v[20:23], a[68:71], v[116:119]
    v_fmac_f32 v73, v145, v130
    v_fmac_f32 v74, v146, v130
    v_mfma_f32_16x16x32_bf16 v[120:123], v[20:23], a[72:75], v[120:123]
    buffer_load_dwordx2 a[0:1], v3, s[4:7], s60 offen offset:0 sc1
    v_mfma_f32_16x16x32_bf16 v[124:127], v[20:23], a[76:79], v[124:127]
    s_waitcnt lgkmcnt(3)
    v_fmac_f32 v75, v147, v130
    v_fmac_f32 v88, v148, v130
    v_mfma_f32_16x16x32_bf16 v[96:99], v[24:27], a[80:83], v[96:99]
    ds_read_b128 v[16:19], v4 offset:14336
    v_fmac_f32 v89, v149, v130
    v_mfma_f32_16x16x32_bf16 v[100:103], v[24:27], a[84:87], v[100:103]
    v_fmac_f32 v90, v150, v130
    v_fmac_f32 v91, v151, v130
    v_mfma_f32_16x16x32_bf16 v[104:107], v[24:27], a[88:91], v[104:107]
    buffer_load_dwordx2 a[4:5], v3, s[4:7], s60 offen offset:512 sc1
    v_mfma_f32_16x16x32_bf16 v[108:111], v[24:27], a[92:95], v[108:111]
    s_waitcnt lgkmcnt(3)
    v_mul_f32 v72, v72, v134
    v_mul_f32 v73, v73, v134
    v_mfma_f32_16x16x32_bf16 v[112:115], v[28:31], a[80:83], v[112:115]
    ds_read_b128 v[20:23], v4 offset:15360
    v_mul_f32 v74, v74, v134
    v_mfma_f32_16x16x32_bf16 v[116:119], v[28:31], a[84:87], v[116:119]
    v_mul_f32 v75, v75, v134
    v_mul_f32 v72, v72, v88
    v_mfma_f32_16x16x32_bf16 v[120:123], v[28:31], a[88:91], v[120:123]
    buffer_load_dwordx2 a[8:9], v3, s[4:7], s60 offen offset:1024 sc1
    v_mfma_f32_16x16x32_bf16 v[124:127], v[28:31], a[92:95], v[124:127]
    s_waitcnt lgkmcnt(3)
    v_mul_f32 v73, v73, v89
    v_mul_f32 v74, v74, v90
    v_mfma_f32_16x16x32_bf16 v[96:99], v[8:11], a[96:99], v[96:99]
    ds_read_b128 v[24:27], v4 offset:16384
    v_mul_f32 v75, v75, v91
    v_mfma_f32_16x16x32_bf16 v[100:103], v[8:11], a[100:103], v[100:103]
    v_cvt_pk_bf16_f32 v232, v72, v73
    v_cvt_pk_bf16_f32 v233, v74, v75
    v_mfma_f32_16x16x32_bf16 v[104:107], v[8:11], a[104:107], v[104:107]
    buffer_load_dwordx2 a[12:13], v3, s[4:7], s60 offen offset:1536 sc1
    v_mfma_f32_16x16x32_bf16 v[108:111], v[8:11], a[108:111], v[108:111]
    s_waitcnt lgkmcnt(3)
    s_add_u32 s60, s58, s65
    v_fmac_f32 v76, v144, v131
    v_mfma_f32_16x16x32_bf16 v[112:115], v[12:15], a[96:99], v[112:115]
    ds_read_b128 v[28:31], v4 offset:17408
    v_fmac_f32 v77, v145, v131
    v_mfma_f32_16x16x32_bf16 v[116:119], v[12:15], a[100:103], v[116:119]
    v_fmac_f32 v78, v146, v131
    v_fmac_f32 v79, v147, v131
    v_mfma_f32_16x16x32_bf16 v[120:123], v[12:15], a[104:107], v[120:123]
    buffer_load_dwordx2 a[2:3], v3, s[4:7], s60 offen offset:0 sc1
    v_mfma_f32_16x16x32_bf16 v[124:127], v[12:15], a[108:111], v[124:127]
    s_waitcnt lgkmcnt(3)
    v_fmac_f32 v92, v148, v131
    v_fmac_f32 v93, v149, v131
    v_mfma_f32_16x16x32_bf16 v[96:99], v[16:19], a[112:115], v[96:99]
    ds_read_b128 v[8:11], v4 offset:18432
    v_fmac_f32 v94, v150, v131
    v_mfma_f32_16x16x32_bf16 v[100:103], v[16:19], a[116:119], v[100:103]
    v_fmac_f32 v95, v151, v131
    v_mul_f32 v76, v76, v135
    v_mfma_f32_16x16x32_bf16 v[104:107], v[16:19], a[120:123], v[104:107]
    buffer_load_dwordx2 a[6:7], v3, s[4:7], s60 offen offset:512 sc1
    v_mfma_f32_16x16x32_bf16 v[108:111], v[16:19], a[124:127], v[108:111]
    s_waitcnt lgkmcnt(3)
    v_mul_f32 v77, v77, v135
    v_mul_f32 v78, v78, v135
    v_mfma_f32_16x16x32_bf16 v[112:115], v[20:23], a[112:115], v[112:115]
    ds_read_b128 v[12:15], v4 offset:19456
    v_mul_f32 v79, v79, v135
    v_mfma_f32_16x16x32_bf16 v[116:119], v[20:23], a[116:119], v[116:119]
    v_mul_f32 v76, v76, v92
    v_mul_f32 v77, v77, v93
    v_mfma_f32_16x16x32_bf16 v[120:123], v[20:23], a[120:123], v[120:123]
    buffer_load_dwordx2 a[10:11], v3, s[4:7], s60 offen offset:1024 sc1
    v_mfma_f32_16x16x32_bf16 v[124:127], v[20:23], a[124:127], v[124:127]
    s_waitcnt lgkmcnt(3)
    v_mul_f32 v78, v78, v94
    v_mul_f32 v79, v79, v95
    v_mfma_f32_16x16x32_bf16 v[96:99], v[24:27], a[128:131], v[96:99]
    ds_read_b128 v[16:19], v4 offset:20480
    v_cvt_pk_bf16_f32 v236, v76, v77
    v_mfma_f32_16x16x32_bf16 v[100:103], v[24:27], a[132:135], v[100:103]
    v_cvt_pk_bf16_f32 v237, v78, v79
    v_mfma_f32_16x16x32_bf16 v[104:107], v[24:27], a[136:139], v[104:107]
    buffer_load_dwordx2 a[14:15], v3, s[4:7], s60 offen offset:1536 sc1
    v_mfma_f32_16x16x32_bf16 v[108:111], v[24:27], a[140:143], v[108:111]
    s_waitcnt lgkmcnt(3)
    s_add_u32 s60, s56, 0
    v_mfma_f32_16x16x32_bf16 v[112:115], v[28:31], a[128:131], v[112:115]
    ds_read_b128 v[20:23], v4 offset:21504
    v_mfma_f32_16x16x32_bf16 v[116:119], v[28:31], a[132:135], v[116:119]
    v_mfma_f32_16x16x32_bf16 v[120:123], v[28:31], a[136:139], v[120:123]
    buffer_load_dwordx4 a[16:19], v2, s[4:7], s60 offen offset:0 sc1
    v_mfma_f32_16x16x32_bf16 v[124:127], v[28:31], a[140:143], v[124:127]
    s_waitcnt lgkmcnt(3)
    v_mfma_f32_16x16x32_bf16 v[96:99], v[8:11], a[144:147], v[96:99]
    ds_read_b128 v[24:27], v4 offset:22528
    v_mfma_f32_16x16x32_bf16 v[100:103], v[8:11], a[148:151], v[100:103]
    v_mfma_f32_16x16x32_bf16 v[104:107], v[8:11], a[152:155], v[104:107]
    buffer_load_dwordx4 a[20:23], v2, s[4:7], s60 offen offset:1024 sc1
    v_mfma_f32_16x16x32_bf16 v[108:111], v[8:11], a[156:159], v[108:111]
    s_waitcnt lgkmcnt(3)
    v_mfma_f32_16x16x32_bf16 v[112:115], v[12:15], a[144:147], v[112:115]
    ds_read_b128 v[28:31], v4 offset:23552
    v_mfma_f32_16x16x32_bf16 v[116:119], v[12:15], a[148:151], v[116:119]
    v_mfma_f32_16x16x32_bf16 v[120:123], v[12:15], a[152:155], v[120:123]
    buffer_load_dwordx4 a[24:27], v2, s[4:7], s60 offen offset:2048 sc1
    v_mfma_f32_16x16x32_bf16 v[124:127], v[12:15], a[156:159], v[124:127]
    s_waitcnt lgkmcnt(3)
    v_mfma_f32_16x16x32_bf16 v[96:99], v[16:19], a[160:163], v[96:99]
    ds_read_b128 v[8:11], v4 offset:24576
    v_mfma_f32_16x16x32_bf16 v[100:103], v[16:19], a[164:167], v[100:103]
    v_mfma_f32_16x16x32_bf16 v[104:107], v[16:19], a[168:171], v[104:107]
    buffer_load_dwordx4 a[28:31], v2, s[4:7], s60 offen offset:3072 sc1
    v_mfma_f32_16x16x32_bf16 v[108:111], v[16:19], a[172:175], v[108:111]
    s_waitcnt lgkmcnt(3)
    s_add_u32 s60, s57, 0
    v_mfma_f32_16x16x32_bf16 v[112:115], v[20:23], a[160:163], v[112:115]
    ds_read_b128 v[12:15], v4 offset:25600
    v_mfma_f32_16x16x32_bf16 v[116:119], v[20:23], a[164:167], v[116:119]
    v_mfma_f32_16x16x32_bf16 v[120:123], v[20:23], a[168:171], v[120:123]
    buffer_load_dwordx4 a[32:35], v2, s[4:7], s60 offen offset:0 sc1
    v_mfma_f32_16x16x32_bf16 v[124:127], v[20:23], a[172:175], v[124:127]
    s_waitcnt lgkmcnt(3)
    v_mfma_f32_16x16x32_bf16 v[96:99], v[24:27], a[176:179], v[96:99]
    ds_read_b128 v[16:19], v4 offset:26624
    v_mfma_f32_16x16x32_bf16 v[100:103], v[24:27], a[180:183], v[100:103]
    v_mfma_f32_16x16x32_bf16 v[104:107], v[24:27], a[184:187], v[104:107]
    buffer_load_dwordx4 a[36:39], v2, s[4:7], s60 offen offset:1024 sc1
    v_mfma_f32_16x16x32_bf16 v[108:111], v[24:27], a[188:191], v[108:111]
    s_waitcnt lgkmcnt(3)
    v_mfma_f32_16x16x32_bf16 v[112:115], v[28:31], a[176:179], v[112:115]
    ds_read_b128 v[20:23], v4 offset:27648
    v_mfma_f32_16x16x32_bf16 v[116:119], v[28:31], a[180:183], v[116:119]
    v_mfma_f32_16x16x32_bf16 v[120:123], v[28:31], a[184:187], v[120:123]
    buffer_load_dwordx4 a[40:43], v2, s[4:7], s60 offen offset:2048 sc1
    v_mfma_f32_16x16x32_bf16 v[124:127], v[28:31], a[188:191], v[124:127]
    s_waitcnt lgkmcnt(3)
    v_mfma_f32_16x16x32_bf16 v[96:99], v[8:11], a[192:195], v[96:99]
    ds_read_b128 v[24:27], v4 offset:28672
    v_mfma_f32_16x16x32_bf16 v[100:103], v[8:11], a[196:199], v[100:103]
    v_mfma_f32_16x16x32_bf16 v[104:107], v[8:11], a[200:203], v[104:107]
    buffer_load_dwordx4 a[44:47], v2, s[4:7], s60 offen offset:3072 sc1
    v_mfma_f32_16x16x32_bf16 v[108:111], v[8:11], a[204:207], v[108:111]
    s_waitcnt lgkmcnt(3)
    s_add_u32 s60, s58, 0
    v_mfma_f32_16x16x32_bf16 v[112:115], v[12:15], a[192:195], v[112:115]
    ds_read_b128 v[28:31], v4 offset:29696
    v_mfma_f32_16x16x32_bf16 v[116:119], v[12:15], a[196:199], v[116:119]
    v_mfma_f32_16x16x32_bf16 v[120:123], v[12:15], a[200:203], v[120:123]
    buffer_load_dwordx4 a[48:51], v2, s[4:7], s60 offen offset:0 sc1
    v_mfma_f32_16x16x32_bf16 v[124:127], v[12:15], a[204:207], v[124:127]
    s_waitcnt lgkmcnt(3)
    v_mfma_f32_16x16x32_bf16 v[96:99], v[16:19], a[208:211], v[96:99]
    ds_read_b128 v[8:11], v4 offset:30720
    v_mfma_f32_16x16x32_bf16 v[100:103], v[16:19], a[212:215], v[100:103]
    v_mfma_f32_16x16x32_bf16 v[104:107], v[16:19], a[216:219], v[104:107]
    buffer_load_dwordx4 a[52:55], v2, s[4:7], s60 offen offset:1024 sc1
    v_mfma_f32_16x16x32_bf16 v[108:111], v[16:19], a[220:223], v[108:111]
    s_waitcnt lgkmcnt(3)
    v_mfma_f32_16x16x32_bf16 v[112:115], v[20:23], a[208:211], v[112:115]
    ds_read_b128 v[12:15], v4 offset:31744
    v_mfma_f32_16x16x32_bf16 v[116:119], v[20:23], a[212:215], v[116:119]
    v_mfma_f32_16x16x32_bf16 v[120:123], v[20:23], a[216:219], v[120:123]
    buffer_load_dwordx4 a[56:59], v2, s[4:7], s60 offen offset:2048 sc1
    v_mfma_f32_16x16x32_bf16 v[124:127], v[20:23], a[220:223], v[124:127]
    s_waitcnt lgkmcnt(3)
    v_mfma_f32_16x16x32_bf16 v[96:99], v[24:27], a[224:227], v[96:99]
    ds_read_b128 v[16:19], v4 offset:32768
    v_mfma_f32_16x16x32_bf16 v[100:103], v[24:27], a[228:231], v[100:103]
    v_mfma_f32_16x16x32_bf16 v[104:107], v[24:27], a[232:235], v[104:107]
    buffer_load_dwordx4 a[60:63], v2, s[4:7], s60 offen offset:3072 sc1
    v_mfma_f32_16x16x32_bf16 v[108:111], v[24:27], a[236:239], v[108:111]
    s_waitcnt lgkmcnt(3)
    s_add_u32 s60, s56, 16384
    v_mfma_f32_16x16x32_bf16 v[112:115], v[28:31], a[224:227], v[112:115]
    ds_read_b128 v[20:23], v4 offset:33792
    v_mfma_f32_16x16x32_bf16 v[116:119], v[28:31], a[228:231], v[116:119]
    v_mfma_f32_16x16x32_bf16 v[120:123], v[28:31], a[232:235], v[120:123]
    buffer_load_dwordx4 a[64:67], v2, s[4:7], s60 offen offset:0 sc1
    v_mfma_f32_16x16x32_bf16 v[124:127], v[28:31], a[236:239], v[124:127]
    s_waitcnt lgkmcnt(3)
    v_mfma_f32_16x16x32_bf16 v[96:99], v[8:11], a[240:243], v[96:99]
    ds_read_b128 v[24:27], v4 offset:34816
    v_mfma_f32_16x16x32_bf16 v[100:103], v[8:11], a[244:247], v[100:103]
    v_mfma_f32_16x16x32_bf16 v[104:107], v[8:11], a[248:251], v[104:107]
    buffer_load_dwordx4 a[68:71], v2, s[4:7], s60 offen offset:1024 sc1
    v_mfma_f32_16x16x32_bf16 v[108:111], v[8:11], a[252:255], v[108:111]
    s_waitcnt lgkmcnt(3)
    ds_read_b128 v[136:139], v5 offset:1024
    ds_read_b128 v[140:143], v5 offset:1088
    v_mfma_f32_16x16x32_bf16 v[112:115], v[12:15], a[240:243], v[112:115]
    ds_read_b128 v[28:31], v4 offset:35840
    v_mfma_f32_16x16x32_bf16 v[116:119], v[12:15], a[244:247], v[116:119]
    v_mfma_f32_16x16x32_bf16 v[120:123], v[12:15], a[248:251], v[120:123]
    buffer_load_dwordx4 a[72:75], v2, s[4:7], s60 offen offset:2048 sc1
    v_mfma_f32_16x16x32_bf16 v[124:127], v[12:15], a[252:255], v[124:127]
    s_waitcnt lgkmcnt(5)
    v_mfma_f32_16x16x32_bf16 v[96:99], v[16:19], v[32:35], v[96:99]
    s_barrier
    v_add_u32 v4, 0x9000, v4
    v_mfma_f32_16x16x32_bf16 v[100:103], v[16:19], v[36:39], v[100:103]
    s_add_u32 m0, s49, 110592
    s_add_u32 s61, s48, 405504
    ds_read_b128 v[8:11], v4 offset:0
    v_mfma_f32_16x16x32_bf16 v[104:107], v[16:19], v[40:43], v[104:107]
    buffer_load_dwordx4 a[76:79], v2, s[4:7], s60 offen offset:3072 sc1
    v_mfma_f32_16x16x32_bf16 v[108:111], v[16:19], v[44:47], v[108:111]
    s_waitcnt lgkmcnt(5)
    s_add_u32 s60, s57, 16384
    v_mfma_f32_16x16x32_bf16 v[112:115], v[20:23], v[32:35], v[112:115]
    ds_read_b128 v[12:15], v4 offset:1024
    v_mfma_f32_16x16x32_bf16 v[116:119], v[20:23], v[36:39], v[116:119]
    v_mfma_f32_16x16x32_bf16 v[120:123], v[20:23], v[40:43], v[120:123]
    buffer_load_dwordx4 a[80:83], v2, s[4:7], s60 offen offset:0 sc1
    v_mfma_f32_16x16x32_bf16 v[124:127], v[20:23], v[44:47], v[124:127]
    s_waitcnt lgkmcnt(5)
    v_mfma_f32_16x16x32_bf16 v[96:99], v[24:27], v[48:51], v[96:99]
    ds_read_b128 v[16:19], v4 offset:2048
    v_mfma_f32_16x16x32_bf16 v[100:103], v[24:27], v[52:55], v[100:103]
    v_mfma_f32_16x16x32_bf16 v[104:107], v[24:27], v[56:59], v[104:107]
    buffer_load_dwordx4 a[84:87], v2, s[4:7], s60 offen offset:1024 sc1
    v_mfma_f32_16x16x32_bf16 v[108:111], v[24:27], v[60:63], v[108:111]
    s_waitcnt lgkmcnt(3)
    v_mfma_f32_16x16x32_bf16 v[112:115], v[28:31], v[48:51], v[112:115]
    ds_read_b128 v[20:23], v4 offset:3072
    v_mfma_f32_16x16x32_bf16 v[116:119], v[28:31], v[52:55], v[116:119]
    v_mfma_f32_16x16x32_bf16 v[120:123], v[28:31], v[56:59], v[120:123]
    buffer_load_dwordx4 a[88:91], v2, s[4:7], s60 offen offset:2048 sc1
    v_mfma_f32_16x16x32_bf16 v[124:127], v[28:31], v[60:63], v[124:127]
    s_waitcnt lgkmcnt(3)
    v_mfma_f32_16x16x32_bf16 v[32:35], v[8:11], v[176:179], 0
    ds_read_b128 v[24:27], v4 offset:4096
    v_mfma_f32_16x16x32_bf16 v[40:43], v[8:11], v[180:183], 0
    v_mfma_f32_16x16x32_bf16 v[48:51], v[8:11], v[184:187], 0
    buffer_load_dwordx4 a[92:95], v2, s[4:7], s60 offen offset:3072 sc1
    v_mfma_f32_16x16x32_bf16 v[56:59], v[8:11], v[188:191], 0
    s_waitcnt lgkmcnt(3)
    s_add_u32 s60, s58, 16384
    v_mfma_f32_16x16x32_bf16 v[36:39], v[12:15], v[176:179], 0
    ds_read_b128 v[28:31], v4 offset:5120
    v_mfma_f32_16x16x32_bf16 v[44:47], v[12:15], v[180:183], 0
    v_fmac_f32 v96, v136, v128
    v_fmac_f32 v97, v137, v128
    v_mfma_f32_16x16x32_bf16 v[52:55], v[12:15], v[184:187], 0
    v_fmac_f32 v98, v138, v128
    v_fmac_f32 v99, v139, v128
    v_mfma_f32_16x16x32_bf16 v[60:63], v[12:15], v[188:191], 0
    s_waitcnt lgkmcnt(3)
    v_fmac_f32 v112, v140, v128
    v_fmac_f32 v113, v141, v128
    v_mfma_f32_16x16x32_bf16 v[64:67], v[16:19], v[176:179], 0
    ds_read_b128 v[8:11], v4 offset:6144
    v_fmac_f32 v114, v142, v128
    v_mfma_f32_16x16x32_bf16 v[72:75], v[16:19], v[180:183], 0
    v_fmac_f32 v115, v143, v128
    v_mul_f32 v96, v96, v132
    v_mfma_f32_16x16x32_bf16 v[80:83], v[16:19], v[184:187], 0
    v_mul_f32 v97, v97, v132
    v_mul_f32 v98, v98, v132
    v_mfma_f32_16x16x32_bf16 v[88:91], v[16:19], v[188:191], 0
    s_waitcnt lgkmcnt(3)
    v_mul_f32 v99, v99, v132
    v_mul_f32 v96, v96, v112
    v_mfma_f32_16x16x32_bf16 v[68:71], v[20:23], v[176:179], 0
    ds_read_b128 v[12:15], v4 offset:7168
    v_mul_f32 v97, v97, v113
    v_mfma_f32_16x16x32_bf16 v[76:79], v[20:23], v[180:183], 0
    v_mul_f32 v98, v98, v114
    v_mul_f32 v99, v99, v115
    v_mfma_f32_16x16x32_bf16 v[84:87], v[20:23], v[184:187], 0
    v_cvt_pk_bf16_f32 v226, v96, v97
    v_cvt_pk_bf16_f32 v227, v98, v99
    v_mfma_f32_16x16x32_bf16 v[92:95], v[20:23], v[188:191], 0
    s_waitcnt lgkmcnt(3)
    s_add_u32 s66, s51, 49152
    v_mfma_f32_16x16x32_bf16 v[160:163], v[24:27], v[176:179], 0
    ds_read_b128 v[16:19], v4 offset:8192
    v_mfma_f32_16x16x32_bf16 v[164:167], v[24:27], v[180:183], 0
    buffer_store_dwordx4 v[224:227], v2, s[4:7], s66 offen offset:0 sc1
    v_mfma_f32_16x16x32_bf16 v[168:171], v[24:27], v[184:187], 0
    v_fmac_f32 v100, v136, v129
    v_fmac_f32 v101, v137, v129
    v_mfma_f32_16x16x32_bf16 v[172:175], v[24:27], v[188:191], 0
    s_waitcnt lgkmcnt(3)
    v_fmac_f32 v102, v138, v129
    v_fmac_f32 v103, v139, v129
    v_mfma_f32_16x16x32_bf16 v[32:35], v[28:31], v[192:195], v[32:35]
    ds_read_b128 v[20:23], v4 offset:9216
    v_fmac_f32 v116, v140, v129
    v_mfma_f32_16x16x32_bf16 v[40:43], v[28:31], v[196:199], v[40:43]
    v_fmac_f32 v117, v141, v129
    v_fmac_f32 v118, v142, v129
    v_mfma_f32_16x16x32_bf16 v[48:51], v[28:31], v[200:203], v[48:51]
    v_fmac_f32 v119, v143, v129
    v_mul_f32 v100, v100, v133
    v_mfma_f32_16x16x32_bf16 v[56:59], v[28:31], v[204:207], v[56:59]
    s_waitcnt lgkmcnt(3)
    v_mul_f32 v101, v101, v133
    v_mul_f32 v102, v102, v133
    v_mfma_f32_16x16x32_bf16 v[36:39], v[8:11], v[192:195], v[36:39]
    ds_read_b128 v[24:27], v4 offset:10240
    v_mul_f32 v103, v103, v133
    v_mfma_f32_16x16x32_bf16 v[44:47], v[8:11], v[196:199], v[44:47]
    v_mul_f32 v100, v100, v116
    v_mul_f32 v101, v101, v117
    v_mfma_f32_16x16x32_bf16 v[52:55], v[8:11], v[200:203], v[52:55]
    v_mul_f32 v102, v102, v118
    v_mul_f32 v103, v103, v119
    v_mfma_f32_16x16x32_bf16 v[60:63], v[8:11], v[204:207], v[60:63]
    s_waitcnt lgkmcnt(3)
    v_cvt_pk_bf16_f32 v230, v100, v101
    v_cvt_pk_bf16_f32 v231, v102, v103
    v_mfma_f32_16x16x32_bf16 v[64:67], v[12:15], v[192:195], v[64:67]
    ds_read_b128 v[28:31], v4 offset:11264
    v_mfma_f32_16x16x32_bf16 v[72:75], v[12:15], v[196:199], v[72:75]
    buffer_store_dwordx4 v[228:231], v2, s[4:7], s66 offen offset:1024 sc1
    v_mfma_f32_16x16x32_bf16 v[80:83], v[12:15], v[200:203], v[80:83]
    v_fmac_f32 v104, v136, v130
    v_fmac_f32 v105, v137, v130
    v_mfma_f32_16x16x32_bf16 v[88:91], v[12:15], v[204:207], v[88:91]
    s_waitcnt lgkmcnt(3)
    v_fmac_f32 v106, v138, v130
    v_fmac_f32 v107, v139, v130
    v_mfma_f32_16x16x32_bf16 v[68:71], v[16:19], v[192:195], v[68:71]
    ds_read_b128 v[8:11], v4 offset:12288
    v_fmac_f32 v120, v140, v130
    v_mfma_f32_16x16x32_bf16 v[76:79], v[16:19], v[196:199], v[76:79]
    v_fmac_f32 v121, v141, v130
    v_fmac_f32 v122, v142, v130
    v_mfma_f32_16x16x32_bf16 v[84:87], v[16:19], v[200:203], v[84:87]
    v_fmac_f32 v123, v143, v130
    v_mul_f32 v104, v104, v134
    v_mfma_f32_16x16x32_bf16 v[92:95], v[16:19], v[204:207], v[92:95]
    s_waitcnt lgkmcnt(3)
    v_mul_f32 v105, v105, v134
    v_mul_f32 v106, v106, v134
    v_mfma_f32_16x16x32_bf16 v[160:163], v[20:23], v[192:195], v[160:163]
    ds_read_b128 v[12:15], v4 offset:13312
    v_mul_f32 v107, v107, v134
    v_mfma_f32_16x16x32_bf16 v[164:167], v[20:23], v[196:199], v[164:167]
    v_mul_f32 v104, v104, v120
    v_mul_f32 v105, v105, v121
    v_mfma_f32_16x16x32_bf16 v[168:171], v[20:23], v[200:203], v[168:171]
    v_mul_f32 v106, v106, v122
    v_mul_f32 v107, v107, v123
    v_mfma_f32_16x16x32_bf16 v[172:175], v[20:23], v[204:207], v[172:175]
    s_waitcnt lgkmcnt(3)
    v_cvt_pk_bf16_f32 v234, v104, v105
    v_cvt_pk_bf16_f32 v235, v106, v107
    v_mfma_f32_16x16x32_bf16 v[32:35], v[24:27], v[208:211], v[32:35]
    ds_read_b128 v[16:19], v4 offset:14336
    v_mfma_f32_16x16x32_bf16 v[40:43], v[24:27], v[212:215], v[40:43]
    buffer_store_dwordx4 v[232:235], v2, s[4:7], s66 offen offset:2048 sc1
    v_mfma_f32_16x16x32_bf16 v[48:51], v[24:27], v[216:219], v[48:51]
    v_fmac_f32 v108, v136, v131
    v_fmac_f32 v109, v137, v131
    v_mfma_f32_16x16x32_bf16 v[56:59], v[24:27], v[220:223], v[56:59]
    s_waitcnt lgkmcnt(3)
    v_fmac_f32 v110, v138, v131
    v_fmac_f32 v111, v139, v131
    v_mfma_f32_16x16x32_bf16 v[36:39], v[28:31], v[208:211], v[36:39]
    ds_read_b128 v[20:23], v4 offset:15360
    v_fmac_f32 v124, v140, v131
    v_mfma_f32_16x16x32_bf16 v[44:47], v[28:31], v[212:215], v[44:47]
    v_fmac_f32 v125, v141, v131
    v_fmac_f32 v126, v142, v131
    v_mfma_f32_16x16x32_bf16 v[52:55], v[28:31], v[216:219], v[52:55]
    v_fmac_f32 v127, v143, v131
    v_mul_f32 v108, v108, v135
    v_mfma_f32_16x16x32_bf16 v[60:63], v[28:31], v[220:223], v[60:63]
    s_waitcnt lgkmcnt(3)
    v_mul_f32 v109, v109, v135
    v_mul_f32 v110, v110, v135
    v_mfma_f32_16x16x32_bf16 v[64:67], v[8:11], v[208:211], v[64:67]
    ds_read_b128 v[24:27], v4 offset:16384
    v_mul_f32 v111, v111, v135
    v_mfma_f32_16x16x32_bf16 v[72:75], v[8:11], v[212:215], v[72:75]
    v_mul_f32 v108, v108, v124
    v_mul_f32 v109, v109, v125
    v_mfma_f32_16x16x32_bf16 v[80:83], v[8:11], v[216:219], v[80:83]
    v_mul_f32 v110, v110, v126
    v_mul_f32 v111, v111, v127
    v_mfma_f32_16x16x32_bf16 v[88:91], v[8:11], v[220:223], v[88:91]
    s_waitcnt lgkmcnt(3)
    v_cvt_pk_bf16_f32 v238, v108, v109
    v_cvt_pk_bf16_f32 v239, v110, v111
    v_mfma_f32_16x16x32_bf16 v[68:71], v[12:15], v[208:211], v[68:71]
    ds_read_b128 v[28:31], v4 offset:17408
    v_mfma_f32_16x16x32_bf16 v[76:79], v[12:15], v[212:215], v[76:79]
    buffer_store_dwordx4 v[236:239], v2, s[4:7], s66 offen offset:3072 sc1
    v_mfma_f32_16x16x32_bf16 v[84:87], v[12:15], v[216:219], v[84:87]
    v_mfma_f32_16x16x32_bf16 v[92:95], v[12:15], v[220:223], v[92:95]
    s_waitcnt lgkmcnt(3)
    v_mfma_f32_16x16x32_bf16 v[160:163], v[16:19], v[208:211], v[160:163]
    ds_read_b128 v[8:11], v4 offset:18432
    v_mfma_f32_16x16x32_bf16 v[164:167], v[16:19], v[212:215], v[164:167]
    buffer_load_dwordx4 a[96:99], v2, s[4:7], s60 offen offset:0 sc1
    v_mfma_f32_16x16x32_bf16 v[168:171], v[16:19], v[216:219], v[168:171]
    v_mfma_f32_16x16x32_bf16 v[172:175], v[16:19], v[220:223], v[172:175]
    s_waitcnt lgkmcnt(3)
    v_mfma_f32_16x16x32_bf16 v[96:99], v[20:23], v[176:179], 0
    ds_read_b128 v[12:15], v4 offset:19456
    v_mfma_f32_16x16x32_bf16 v[104:107], v[20:23], v[180:183], 0
    buffer_load_dwordx4 a[100:103], v2, s[4:7], s60 offen offset:1024 sc1
    v_mfma_f32_16x16x32_bf16 v[112:115], v[20:23], v[184:187], 0
    buffer_load_dwordx4 a[104:107], v2, s[4:7], s60 offen offset:2048 sc1
    buffer_load_dwordx4 a[108:111], v2, s[4:7], s60 offen offset:3072 sc1
    s_add_u32 s55, s52, 32
    buffer_load_dwordx2 v[6:7], v0, s[4:7], s55 offen sc1
    v_mfma_f32_16x16x32_bf16 v[120:123], v[20:23], v[188:191], 0
    s_waitcnt lgkmcnt(3)
    v_mfma_f32_16x16x32_bf16 v[100:103], v[24:27], v[176:179], 0
    ds_read_b128 v[16:19], v4 offset:20480
    v_mfma_f32_16x16x32_bf16 v[108:111], v[24:27], v[180:183], 0
    v_mfma_f32_16x16x32_bf16 v[116:119], v[24:27], v[184:187], 0
    buffer_load_dwordx4 v2, s[4:7], s61 offen offset:0 lds
    v_mfma_f32_16x16x32_bf16 v[124:127], v[24:27], v[188:191], 0
    s_waitcnt lgkmcnt(3)
    v_mfma_f32_16x16x32_bf16 v[128:131], v[28:31], v[176:179], 0
    ds_read_b128 v[20:23], v4 offset:21504
    v_mfma_f32_16x16x32_bf16 v[136:139], v[28:31], v[180:183], 0
    v_mfma_f32_16x16x32_bf16 v[144:147], v[28:31], v[184:187], 0
    buffer_load_dwordx4 v2, s[4:7], s61 offen offset:1024 lds
    v_mfma_f32_16x16x32_bf16 v[152:155], v[28:31], v[188:191], 0
    s_waitcnt lgkmcnt(3)
    v_mfma_f32_16x16x32_bf16 v[132:135], v[8:11], v[176:179], 0
    ds_read_b128 v[24:27], v4 offset:22528
    v_mfma_f32_16x16x32_bf16 v[140:143], v[8:11], v[180:183], 0
    v_mfma_f32_16x16x32_bf16 v[148:151], v[8:11], v[184:187], 0
    buffer_load_dwordx4 v2, s[4:7], s61 offen offset:2048 lds
    v_mfma_f32_16x16x32_bf16 v[156:159], v[8:11], v[188:191], 0
    s_waitcnt lgkmcnt(3)
    v_mfma_f32_16x16x32_bf16 v[96:99], v[12:15], v[192:195], v[96:99]
    ds_read_b128 v[28:31], v4 offset:23552
    v_mfma_f32_16x16x32_bf16 v[104:107], v[12:15], v[196:199], v[104:107]
    v_mfma_f32_16x16x32_bf16 v[112:115], v[12:15], v[200:203], v[112:115]
    buffer_load_dwordx4 v2, s[4:7], s61 offen offset:3072 lds
    v_mfma_f32_16x16x32_bf16 v[120:123], v[12:15], v[204:207], v[120:123]
    s_waitcnt lgkmcnt(3)
    s_add_u32 m0, s49, 114688
    s_add_u32 s61, s48, 409600
    v_mfma_f32_16x16x32_bf16 v[100:103], v[16:19], v[192:195], v[100:103]
    ds_read_b128 v[8:11], v4 offset:24576
    v_mfma_f32_16x16x32_bf16 v[108:111], v[16:19], v[196:199], v[108:111]
    v_mfma_f32_16x16x32_bf16 v[116:119], v[16:19], v[200:203], v[116:119]
    buffer_load_dwordx4 v2, s[4:7], s61 offen offset:0 lds
    v_mfma_f32_16x16x32_bf16 v[124:127], v[16:19], v[204:207], v[124:127]
    s_waitcnt lgkmcnt(3)
    v_mfma_f32_16x16x32_bf16 v[128:131], v[20:23], v[192:195], v[128:131]
    ds_read_b128 v[12:15], v4 offset:25600
    v_mfma_f32_16x16x32_bf16 v[136:139], v[20:23], v[196:199], v[136:139]
    v_mfma_f32_16x16x32_bf16 v[144:147], v[20:23], v[200:203], v[144:147]
    buffer_load_dwordx4 v2, s[4:7], s61 offen offset:1024 lds
    v_mfma_f32_16x16x32_bf16 v[152:155], v[20:23], v[204:207], v[152:155]
    s_waitcnt lgkmcnt(3)
    v_mfma_f32_16x16x32_bf16 v[132:135], v[24:27], v[192:195], v[132:135]
    ds_read_b128 v[16:19], v4 offset:26624
    v_mfma_f32_16x16x32_bf16 v[140:143], v[24:27], v[196:199], v[140:143]
    v_mfma_f32_16x16x32_bf16 v[148:151], v[24:27], v[200:203], v[148:151]
    buffer_load_dwordx4 v2, s[4:7], s61 offen offset:2048 lds
    v_mfma_f32_16x16x32_bf16 v[156:159], v[24:27], v[204:207], v[156:159]
    s_waitcnt lgkmcnt(3)
    v_mfma_f32_16x16x32_bf16 v[96:99], v[28:31], v[208:211], v[96:99]
    ds_read_b128 v[20:23], v4 offset:27648
    v_mfma_f32_16x16x32_bf16 v[104:107], v[28:31], v[212:215], v[104:107]
    v_mfma_f32_16x16x32_bf16 v[112:115], v[28:31], v[216:219], v[112:115]
    buffer_load_dwordx4 v2, s[4:7], s61 offen offset:3072 lds
    v_mfma_f32_16x16x32_bf16 v[120:123], v[28:31], v[220:223], v[120:123]
    s_waitcnt lgkmcnt(3)
    s_add_u32 m0, s49, 118784
    s_add_u32 s61, s48, 413696
    v_mfma_f32_16x16x32_bf16 v[100:103], v[8:11], v[208:211], v[100:103]
    ds_read_b128 v[24:27], v4 offset:28672
    v_mfma_f32_16x16x32_bf16 v[108:111], v[8:11], v[212:215], v[108:111]
    v_mfma_f32_16x16x32_bf16 v[116:119], v[8:11], v[216:219], v[116:119]
    buffer_load_dwordx4 v2, s[4:7], s61 offen offset:0 lds
    v_mfma_f32_16x16x32_bf16 v[124:127], v[8:11], v[220:223], v[124:127]
    s_waitcnt lgkmcnt(3)
    v_mfma_f32_16x16x32_bf16 v[128:131], v[12:15], v[208:211], v[128:131]
    s_waitcnt vmcnt(9)
    v_cmp_eq_u64 vcc, s[98:99], v[6:7]
    s_nop 0
    s_cmp_eq_u64 vcc, exec
    s_cbranch_scc0 L_p1_slow_89
L_p1_back_90:
    v_mfma_f32_16x16x32_bf16 v[136:139], v[12:15], v[212:215], v[136:139]
    s_add_u32 s60, s56, 32768
    ds_read_b128 v[28:31], v4 offset:29696
    v_mfma_f32_16x16x32_bf16 v[144:147], v[12:15], v[216:219], v[144:147]
    buffer_load_dwordx4 a[112:115], v2, s[4:7], s60 offen offset:0 sc1
    v_mfma_f32_16x16x32_bf16 v[152:155], v[12:15], v[220:223], v[152:155]
    s_waitcnt lgkmcnt(3)
    v_mfma_f32_16x16x32_bf16 v[132:135], v[16:19], v[208:211], v[132:135]
    ds_read_b128 v[8:11], v4 offset:30720
    v_mfma_f32_16x16x32_bf16 v[140:143], v[16:19], v[212:215], v[140:143]
    v_mfma_f32_16x16x32_bf16 v[148:151], v[16:19], v[216:219], v[148:151]
    buffer_load_dwordx4 a[116:119], v2, s[4:7], s60 offen offset:1024 sc1
    v_mfma_f32_16x16x32_bf16 v[156:159], v[16:19], v[220:223], v[156:159]
    s_waitcnt lgkmcnt(3)
    v_mfma_f32_16x16x32_bf16 v[32:35], v[20:23], v[224:227], v[32:35]
    ds_read_b128 v[12:15], v4 offset:31744
    v_mfma_f32_16x16x32_bf16 v[40:43], v[20:23], v[228:231], v[40:43]
    v_mfma_f32_16x16x32_bf16 v[48:51], v[20:23], v[232:235], v[48:51]
    buffer_load_dwordx4 a[120:123], v2, s[4:7], s60 offen offset:2048 sc1
    v_mfma_f32_16x16x32_bf16 v[56:59], v[20:23], v[236:239], v[56:59]
    s_waitcnt lgkmcnt(3)
    v_mfma_f32_16x16x32_bf16 v[36:39], v[24:27], v[224:227], v[36:39]
    ds_read_b128 v[16:19], v4 offset:32768
    v_mfma_f32_16x16x32_bf16 v[44:47], v[24:27], v[228:231], v[44:47]
    s_add_u32 s71, s67, 64
    v_mov_b32 v6, s98
    v_mov_b32 v7, s99
    v_mfma_f32_16x16x32_bf16 v[52:55], v[24:27], v[232:235], v[52:55]
    buffer_load_dwordx4 a[124:127], v2, s[4:7], s60 offen offset:3072 sc1
    v_mfma_f32_16x16x32_bf16 v[60:63], v[24:27], v[236:239], v[60:63]
    s_waitcnt lgkmcnt(3)
    s_add_u32 s60, s57, 32768
    v_mfma_f32_16x16x32_bf16 v[64:67], v[28:31], v[224:227], v[64:67]
    ds_read_b128 v[20:23], v4 offset:33792
    v_mfma_f32_16x16x32_bf16 v[72:75], v[28:31], v[228:231], v[72:75]
    v_mfma_f32_16x16x32_bf16 v[80:83], v[28:31], v[232:235], v[80:83]
    s_mov_b64 exec, 1
    buffer_store_dwordx2 v[6:7], off, s[4:7], s71 sc1
    s_mov_b64 exec, -1
    v_mfma_f32_16x16x32_bf16 v[88:91], v[28:31], v[236:239], v[88:91]
    s_waitcnt lgkmcnt(3)
    v_mfma_f32_16x16x32_bf16 v[68:71], v[8:11], v[224:227], v[68:71]
    ds_read_b128 v[24:27], v4 offset:34816
    v_mfma_f32_16x16x32_bf16 v[76:79], v[8:11], v[228:231], v[76:79]
    v_mfma_f32_16x16x32_bf16 v[84:87], v[8:11], v[232:235], v[84:87]
    buffer_load_dwordx4 a[128:131], v2, s[4:7], s60 offen offset:0 sc1
    v_mfma_f32_16x16x32_bf16 v[92:95], v[8:11], v[236:239], v[92:95]
    s_waitcnt lgkmcnt(3)
    v_mfma_f32_16x16x32_bf16 v[96:99], v[12:15], v[224:227], v[96:99]
    ds_read_b128 v[28:31], v4 offset:35840
    v_mfma_f32_16x16x32_bf16 v[104:107], v[12:15], v[228:231], v[104:107]
    v_mfma_f32_16x16x32_bf16 v[112:115], v[12:15], v[232:235], v[112:115]
    buffer_load_dwordx4 a[132:135], v2, s[4:7], s60 offen offset:1024 sc1
    v_mfma_f32_16x16x32_bf16 v[120:123], v[12:15], v[236:239], v[120:123]
    s_waitcnt lgkmcnt(3)
    v_mfma_f32_16x16x32_bf16 v[100:103], v[16:19], v[224:227], v[100:103]
    s_barrier
    v_add_u32 v4, 0x9000, v4
    v_mfma_f32_16x16x32_bf16 v[108:111], v[16:19], v[228:231], v[108:111]
    s_add_u32 m0, s49, 0
    s_add_u32 s61, s48, 442368
    ds_read_b128 v[8:11], v4 offset:0
    v_mfma_f32_16x16x32_bf16 v[116:119], v[16:19], v[232:235], v[116:119]
    buffer_load_dwordx4 a[136:139], v2, s[4:7], s60 offen offset:2048 sc1
    v_mfma_f32_16x16x32_bf16 v[124:127], v[16:19], v[236:239], v[124:127]
    s_waitcnt lgkmcnt(3)
    v_mfma_f32_16x16x32_bf16 v[128:131], v[20:23], v[224:227], v[128:131]
    ds_read_b128 v[12:15], v4 offset:1024
    v_mfma_f32_16x16x32_bf16 v[136:139], v[20:23], v[228:231], v[136:139]
    v_mfma_f32_16x16x32_bf16 v[144:147], v[20:23], v[232:235], v[144:147]
    buffer_load_dwordx4 a[140:143], v2, s[4:7], s60 offen offset:3072 sc1
    v_mfma_f32_16x16x32_bf16 v[152:155], v[20:23], v[236:239], v[152:155]
    s_waitcnt lgkmcnt(3)
    s_add_u32 s60, s58, 32768
    v_mfma_f32_16x16x32_bf16 v[132:135], v[24:27], v[224:227], v[132:135]
    ds_read_b128 v[16:19], v4 offset:2048
    v_mfma_f32_16x16x32_bf16 v[140:143], v[24:27], v[228:231], v[140:143]
    v_mfma_f32_16x16x32_bf16 v[148:151], v[24:27], v[232:235], v[148:151]
    buffer_load_dwordx4 a[144:147], v2, s[4:7], s60 offen offset:0 sc1
    v_mfma_f32_16x16x32_bf16 v[156:159], v[24:27], v[236:239], v[156:159]
    s_waitcnt lgkmcnt(3)
    v_mfma_f32_16x16x32_bf16 v[160:163], v[28:31], v[224:227], v[160:163]
    ds_read_b128 v[20:23], v4 offset:3072
    v_mfma_f32_16x16x32_bf16 v[164:167], v[28:31], v[228:231], v[164:167]
    v_mfma_f32_16x16x32_bf16 v[168:171], v[28:31], v[232:235], v[168:171]
    buffer_load_dwordx4 a[148:151], v2, s[4:7], s60 offen offset:1024 sc1
    v_mfma_f32_16x16x32_bf16 v[172:175], v[28:31], v[236:239], v[172:175]
    s_waitcnt lgkmcnt(3)
    v_mfma_f32_16x16x32_bf16 v[32:35], v[8:11], v[240:243], v[32:35]
    ds_read_b128 v[24:27], v4 offset:4096
    v_mfma_f32_16x16x32_bf16 v[40:43], v[8:11], v[244:247], v[40:43]
    v_mfma_f32_16x16x32_bf16 v[48:51], v[8:11], v[248:251], v[48:51]
    buffer_load_dwordx4 a[152:155], v2, s[4:7], s60 offen offset:2048 sc1
    v_mfma_f32_16x16x32_bf16 v[56:59], v[8:11], v[252:255], v[56:59]
    s_waitcnt lgkmcnt(3)
    v_mfma_f32_16x16x32_bf16 v[36:39], v[12:15], v[240:243], v[36:39]
    ds_read_b128 v[28:31], v4 offset:5120
    v_mfma_f32_16x16x32_bf16 v[44:47], v[12:15], v[244:247], v[44:47]
    v_mfma_f32_16x16x32_bf16 v[52:55], v[12:15], v[248:251], v[52:55]
    buffer_load_dwordx4 a[156:159], v2, s[4:7], s60 offen offset:3072 sc1
    v_mfma_f32_16x16x32_bf16 v[60:63], v[12:15], v[252:255], v[60:63]
    s_waitcnt lgkmcnt(3)
    v_mfma_f32_16x16x32_bf16 v[64:67], v[16:19], v[240:243], v[64:67]
    ds_read_b128 v[8:11], v4 offset:6144
    v_mfma_f32_16x16x32_bf16 v[72:75], v[16:19], v[244:247], v[72:75]
    v_mfma_f32_16x16x32_bf16 v[80:83], v[16:19], v[248:251], v[80:83]
    buffer_load_dwordx4 v2, s[4:7], s61 offen offset:0 lds
    v_mfma_f32_16x16x32_bf16 v[88:91], v[16:19], v[252:255], v[88:91]
    s_waitcnt lgkmcnt(3)
    v_mfma_f32_16x16x32_bf16 v[68:71], v[20:23], v[240:243], v[68:71]
    ds_read_b128 v[12:15], v4 offset:7168
    v_mfma_f32_16x16x32_bf16 v[76:79], v[20:23], v[244:247], v[76:79]
    v_mfma_f32_16x16x32_bf16 v[84:87], v[20:23], v[248:251], v[84:87]
    buffer_load_dwordx4 v2, s[4:7], s61 offen offset:1024 lds
    v_mfma_f32_16x16x32_bf16 v[92:95], v[20:23], v[252:255], v[92:95]
    s_waitcnt lgkmcnt(3)
    v_mfma_f32_16x16x32_bf16 v[96:99], v[24:27], v[240:243], v[96:99]
    ds_read_b128 v[16:19], v4 offset:8192
    v_mfma_f32_16x16x32_bf16 v[104:107], v[24:27], v[244:247], v[104:107]
    v_mfma_f32_16x16x32_bf16 v[112:115], v[24:27], v[248:251], v[112:115]
    buffer_load_dwordx4 v2, s[4:7], s61 offen offset:2048 lds
    v_mfma_f32_16x16x32_bf16 v[120:123], v[24:27], v[252:255], v[120:123]
    s_waitcnt lgkmcnt(3)
    v_mfma_f32_16x16x32_bf16 v[100:103], v[28:31], v[240:243], v[100:103]
    ds_read_b128 v[20:23], v4 offset:9216
    v_mfma_f32_16x16x32_bf16 v[108:111], v[28:31], v[244:247], v[108:111]
    v_mfma_f32_16x16x32_bf16 v[116:119], v[28:31], v[248:251], v[116:119]
    buffer_load_dwordx4 v2, s[4:7], s61 offen offset:3072 lds
    v_mfma_f32_16x16x32_bf16 v[124:127], v[28:31], v[252:255], v[124:127]
    s_waitcnt lgkmcnt(3)
    s_add_u32 m0, s49, 4096
    s_add_u32 s61, s48, 446464
    v_mfma_f32_16x16x32_bf16 v[128:131], v[8:11], v[240:243], v[128:131]
    ds_read_b128 v[24:27], v4 offset:10240
    v_mfma_f32_16x16x32_bf16 v[136:139], v[8:11], v[244:247], v[136:139]
    v_mfma_f32_16x16x32_bf16 v[144:147], v[8:11], v[248:251], v[144:147]
    buffer_load_dwordx4 v2, s[4:7], s61 offen offset:0 lds
    v_mfma_f32_16x16x32_bf16 v[152:155], v[8:11], v[252:255], v[152:155]
    s_waitcnt lgkmcnt(3)
    v_mfma_f32_16x16x32_bf16 v[132:135], v[12:15], v[240:243], v[132:135]
    ds_read_b128 v[28:31], v4 offset:11264
    v_mfma_f32_16x16x32_bf16 v[140:143], v[12:15], v[244:247], v[140:143]
    v_mfma_f32_16x16x32_bf16 v[148:151], v[12:15], v[248:251], v[148:151]
    buffer_load_dwordx4 v2, s[4:7], s61 offen offset:1024 lds
    v_mfma_f32_16x16x32_bf16 v[156:159], v[12:15], v[252:255], v[156:159]
    s_waitcnt lgkmcnt(3)
    v_mfma_f32_16x16x32_bf16 v[160:163], v[16:19], v[240:243], v[160:163]
    ds_read_b128 v[8:11], v4 offset:12288
    v_mfma_f32_16x16x32_bf16 v[164:167], v[16:19], v[244:247], v[164:167]
    v_mfma_f32_16x16x32_bf16 v[168:171], v[16:19], v[248:251], v[168:171]
    buffer_load_dwordx4 v2, s[4:7], s61 offen offset:2048 lds
    v_mfma_f32_16x16x32_bf16 v[172:175], v[16:19], v[252:255], v[172:175]
    s_waitcnt lgkmcnt(3)
    v_mfma_f32_16x16x32_bf16 v[32:35], v[20:23], a[0:3], v[32:35]
    ds_read_b128 v[12:15], v4 offset:13312
    v_mfma_f32_16x16x32_bf16 v[40:43], v[20:23], a[4:7], v[40:43]
    v_mfma_f32_16x16x32_bf16 v[48:51], v[20:23], a[8:11], v[48:51]
    buffer_load_dwordx4 v2, s[4:7], s61 offen offset:3072 lds
    v_mfma_f32_16x16x32_bf16 v[56:59], v[20:23], a[12:15], v[56:59]
    s_waitcnt lgkmcnt(3)
    s_add_u32 m0, s49, 8192
    s_add_u32 s61, s48, 450560
    v_mfma_f32_16x16x32_bf16 v[36:39], v[24:27], a[0:3], v[36:39]
    ds_read_b128 v[16:19], v4 offset:14336
    v_mfma_f32_16x16x32_bf16 v[44:47], v[24:27], a[4:7], v[44:47]
    v_mfma_f32_16x16x32_bf16 v[52:55], v[24:27], a[8:11], v[52:55]
    buffer_load_dwordx4 v2, s[4:7], s61 offen offset:0 lds
    v_mfma_f32_16x16x32_bf16 v[60:63], v[24:27], a[12:15], v[60:63]
    s_waitcnt lgkmcnt(3)
    v_mfma_f32_16x16x32_bf16 v[64:67], v[28:31], a[0:3], v[64:67]
    ds_read_b128 v[20:23], v4 offset:15360
    v_mfma_f32_16x16x32_bf16 v[72:75], v[28:31], a[4:7], v[72:75]
    v_mfma_f32_16x16x32_bf16 v[80:83], v[28:31], a[8:11], v[80:83]
    v_mfma_f32_16x16x32_bf16 v[88:91], v[28:31], a[12:15], v[88:91]
    s_waitcnt lgkmcnt(3)
    v_mfma_f32_16x16x32_bf16 v[68:71], v[8:11], a[0:3], v[68:71]
    ds_read_b128 v[24:27], v4 offset:16384
    v_mfma_f32_16x16x32_bf16 v[76:79], v[8:11], a[4:7], v[76:79]
    v_mfma_f32_16x16x32_bf16 v[84:87], v[8:11], a[8:11], v[84:87]
    v_mfma_f32_16x16x32_bf16 v[92:95], v[8:11], a[12:15], v[92:95]
    s_waitcnt lgkmcnt(3)
    v_mfma_f32_16x16x32_bf16 v[96:99], v[12:15], a[0:3], v[96:99]
    ds_read_b128 v[28:31], v4 offset:17408
    v_mfma_f32_16x16x32_bf16 v[104:107], v[12:15], a[4:7], v[104:107]
    v_mfma_f32_16x16x32_bf16 v[112:115], v[12:15], a[8:11], v[112:115]
    v_mfma_f32_16x16x32_bf16 v[120:123], v[12:15], a[12:15], v[120:123]
    s_waitcnt lgkmcnt(3)
    v_mfma_f32_16x16x32_bf16 v[100:103], v[16:19], a[0:3], v[100:103]
    ds_read_b128 v[8:11], v4 offset:18432
    v_mfma_f32_16x16x32_bf16 v[108:111], v[16:19], a[4:7], v[108:111]
    s_add_u32 s55, s52, 64
    v_mfma_f32_16x16x32_bf16 v[116:119], v[16:19], a[8:11], v[116:119]
    v_mfma_f32_16x16x32_bf16 v[124:127], v[16:19], a[12:15], v[124:127]
    s_waitcnt lgkmcnt(3)
    v_mfma_f32_16x16x32_bf16 v[128:131], v[20:23], a[0:3], v[128:131]
    ds_read_b128 v[12:15], v4 offset:19456
    v_mfma_f32_16x16x32_bf16 v[136:139], v[20:23], a[4:7], v[136:139]
    v_mfma_f32_16x16x32_bf16 v[144:147], v[20:23], a[8:11], v[144:147]
    v_mfma_f32_16x16x32_bf16 v[152:155], v[20:23], a[12:15], v[152:155]
    s_waitcnt lgkmcnt(3)
    v_mfma_f32_16x16x32_bf16 v[132:135], v[24:27], a[0:3], v[132:135]
    ds_read_b128 v[16:19], v4 offset:20480
    v_mfma_f32_16x16x32_bf16 v[140:143], v[24:27], a[4:7], v[140:143]
    v_mfma_f32_16x16x32_bf16 v[148:151], v[24:27], a[8:11], v[148:151]
    v_mfma_f32_16x16x32_bf16 v[156:159], v[24:27], a[12:15], v[156:159]
    s_waitcnt lgkmcnt(3)
    v_mfma_f32_16x16x32_bf16 v[160:163], v[28:31], a[0:3], v[160:163]
    ds_read_b128 v[20:23], v4 offset:21504
    v_mfma_f32_16x16x32_bf16 v[164:167], v[28:31], a[4:7], v[164:167]
    buffer_load_dwordx2 v[6:7], v0, s[4:7], s55 offen sc1
    v_mfma_f32_16x16x32_bf16 v[168:171], v[28:31], a[8:11], v[168:171]
    v_mfma_f32_16x16x32_bf16 v[172:175], v[28:31], a[12:15], v[172:175]
    s_waitcnt lgkmcnt(3)
    v_mfma_f32_16x16x32_bf16 v[32:35], v[8:11], a[16:19], v[32:35]
    ds_read_b128 v[24:27], v4 offset:22528
    v_mfma_f32_16x16x32_bf16 v[40:43], v[8:11], a[20:23], v[40:43]
    v_mfma_f32_16x16x32_bf16 v[48:51], v[8:11], a[24:27], v[48:51]
    v_mfma_f32_16x16x32_bf16 v[56:59], v[8:11], a[28:31], v[56:59]
    s_waitcnt lgkmcnt(3)
    v_mfma_f32_16x16x32_bf16 v[36:39], v[12:15], a[16:19], v[36:39]
    ds_read_b128 v[28:31], v4 offset:23552
    v_mfma_f32_16x16x32_bf16 v[44:47], v[12:15], a[20:23], v[44:47]
    v_mfma_f32_16x16x32_bf16 v[52:55], v[12:15], a[24:27], v[52:55]
    v_mfma_f32_16x16x32_bf16 v[60:63], v[12:15], a[28:31], v[60:63]
    s_waitcnt lgkmcnt(3)
    v_mfma_f32_16x16x32_bf16 v[64:67], v[16:19], a[16:19], v[64:67]
    ds_read_b128 v[8:11], v4 offset:24576
    v_mfma_f32_16x16x32_bf16 v[72:75], v[16:19], a[20:23], v[72:75]
    v_mfma_f32_16x16x32_bf16 v[80:83], v[16:19], a[24:27], v[80:83]
    v_mfma_f32_16x16x32_bf16 v[88:91], v[16:19], a[28:31], v[88:91]
    s_waitcnt lgkmcnt(3)
    v_mfma_f32_16x16x32_bf16 v[68:71], v[20:23], a[16:19], v[68:71]
    ds_read_b128 v[12:15], v4 offset:25600
    v_mfma_f32_16x16x32_bf16 v[76:79], v[20:23], a[20:23], v[76:79]
    v_mfma_f32_16x16x32_bf16 v[84:87], v[20:23], a[24:27], v[84:87]
    v_mfma_f32_16x16x32_bf16 v[92:95], v[20:23], a[28:31], v[92:95]
    s_waitcnt lgkmcnt(3)
    v_mfma_f32_16x16x32_bf16 v[96:99], v[24:27], a[16:19], v[96:99]
    ds_read_b128 v[16:19], v4 offset:26624
    v_mfma_f32_16x16x32_bf16 v[104:107], v[24:27], a[20:23], v[104:107]
    v_mfma_f32_16x16x32_bf16 v[112:115], v[24:27], a[24:27], v[112:115]
    v_mfma_f32_16x16x32_bf16 v[120:123], v[24:27], a[28:31], v[120:123]
    s_waitcnt lgkmcnt(3)
    v_mfma_f32_16x16x32_bf16 v[100:103], v[28:31], a[16:19], v[100:103]
    ds_read_b128 v[20:23], v4 offset:27648
    v_mfma_f32_16x16x32_bf16 v[108:111], v[28:31], a[20:23], v[108:111]
    v_mfma_f32_16x16x32_bf16 v[116:119], v[28:31], a[24:27], v[116:119]
    v_mfma_f32_16x16x32_bf16 v[124:127], v[28:31], a[28:31], v[124:127]
    s_waitcnt lgkmcnt(3)
    v_mfma_f32_16x16x32_bf16 v[128:131], v[8:11], a[16:19], v[128:131]
    ds_read_b128 v[24:27], v4 offset:28672
    v_mfma_f32_16x16x32_bf16 v[136:139], v[8:11], a[20:23], v[136:139]
    v_mfma_f32_16x16x32_bf16 v[144:147], v[8:11], a[24:27], v[144:147]
    v_mfma_f32_16x16x32_bf16 v[152:155], v[8:11], a[28:31], v[152:155]
    s_waitcnt lgkmcnt(3)
    v_mfma_f32_16x16x32_bf16 v[132:135], v[12:15], a[16:19], v[132:135]
    ds_read_b128 v[28:31], v4 offset:29696
    v_mfma_f32_16x16x32_bf16 v[140:143], v[12:15], a[20:23], v[140:143]
    v_mfma_f32_16x16x32_bf16 v[148:151], v[12:15], a[24:27], v[148:151]
    v_mfma_f32_16x16x32_bf16 v[156:159], v[12:15], a[28:31], v[156:159]
    s_waitcnt lgkmcnt(3)
    v_mfma_f32_16x16x32_bf16 v[160:163], v[16:19], a[16:19], v[160:163]
    ds_read_b128 v[8:11], v4 offset:30720
    v_mfma_f32_16x16x32_bf16 v[164:167], v[16:19], a[20:23], v[164:167]
    v_mfma_f32_16x16x32_bf16 v[168:171], v[16:19], a[24:27], v[168:171]
    v_mfma_f32_16x16x32_bf16 v[172:175], v[16:19], a[28:31], v[172:175]
    s_waitcnt lgkmcnt(3)
    v_mfma_f32_16x16x32_bf16 v[32:35], v[20:23], a[32:35], v[32:35]
    s_waitcnt vmcnt(0)
    v_cmp_eq_u64 vcc, s[98:99], v[6:7]
    s_nop 0
    s_cmp_eq_u64 vcc, exec
    s_cbranch_scc0 L_p2_slow_92
L_p2_back_93:
    v_mfma_f32_16x16x32_bf16 v[40:43], v[20:23], a[36:39], v[40:43]
    s_add_u32 s60, s56, 49152
    ds_read_b128 v[12:15], v4 offset:31744
    v_mfma_f32_16x16x32_bf16 v[48:51], v[20:23], a[40:43], v[48:51]
    buffer_load_dwordx4 a[160:163], v2, s[4:7], s60 offen offset:0 sc1
    v_mfma_f32_16x16x32_bf16 v[56:59], v[20:23], a[44:47], v[56:59]
    s_waitcnt lgkmcnt(3)
    s_and_b32 s68, s46, 1
    s_mul_i32 s69, s68, 5120
    v_mfma_f32_16x16x32_bf16 v[36:39], v[24:27], a[32:35], v[36:39]
    s_add_u32 s69, s69, s53
    s_lshl_b32 s68, s68, 9
    ds_read_b128 v[16:19], v4 offset:32768
    v_mfma_f32_16x16x32_bf16 v[44:47], v[24:27], a[36:39], v[44:47]
    s_add_u32 s68, s68, s53
    v_and_b32 v0, 15, v1
    v_lshlrev_b32 v0, 5, v0
    v_mfma_f32_16x16x32_bf16 v[52:55], v[24:27], a[40:43], v[52:55]
    buffer_load_dwordx4 a[164:167], v2, s[4:7], s60 offen offset:1024 sc1
    v_mfma_f32_16x16x32_bf16 v[60:63], v[24:27], a[44:47], v[60:63]
    s_waitcnt lgkmcnt(3)
    v_lshrrev_b32 v5, 4, v1
    v_lshl_add_u32 v0, v5, 3, v0
    v_mfma_f32_16x16x32_bf16 v[64:67], v[28:31], a[32:35], v[64:67]
    ds_read_b128 v[20:23], v4 offset:33792
    v_mfma_f32_16x16x32_bf16 v[72:75], v[28:31], a[36:39], v[72:75]
    v_mfma_f32_16x16x32_bf16 v[80:83], v[28:31], a[40:43], v[80:83]
    buffer_load_dwordx4 a[168:171], v2, s[4:7], s60 offen offset:2048 sc1
    v_mfma_f32_16x16x32_bf16 v[88:91], v[28:31], a[44:47], v[88:91]
    s_waitcnt lgkmcnt(3)
    v_mfma_f32_16x16x32_bf16 v[68:71], v[8:11], a[32:35], v[68:71]
    ds_read_b128 v[24:27], v4 offset:34816
    v_mfma_f32_16x16x32_bf16 v[76:79], v[8:11], a[36:39], v[76:79]
    v_mfma_f32_16x16x32_bf16 v[84:87], v[8:11], a[40:43], v[84:87]
    buffer_load_dwordx4 a[172:175], v2, s[4:7], s60 offen offset:3072 sc1
    v_mfma_f32_16x16x32_bf16 v[92:95], v[8:11], a[44:47], v[92:95]
    s_waitcnt lgkmcnt(3)
    s_add_u32 s60, s57, 49152
    v_mfma_f32_16x16x32_bf16 v[96:99], v[12:15], a[32:35], v[96:99]
    ds_read_b128 v[28:31], v4 offset:35840
    v_mfma_f32_16x16x32_bf16 v[104:107], v[12:15], a[36:39], v[104:107]
    v_mfma_f32_16x16x32_bf16 v[112:115], v[12:15], a[40:43], v[112:115]
    buffer_load_dwordx4 a[176:179], v2, s[4:7], s60 offen offset:0 sc1
    v_mfma_f32_16x16x32_bf16 v[120:123], v[12:15], a[44:47], v[120:123]
    s_waitcnt lgkmcnt(3)
    v_mfma_f32_16x16x32_bf16 v[100:103], v[16:19], a[32:35], v[100:103]
    s_barrier
    v_add_u32 v4, 0x9000, v4
    v_mfma_f32_16x16x32_bf16 v[108:111], v[16:19], a[36:39], v[108:111]
    s_add_u32 m0, s63, 36864
    s_add_u32 s61, s62, 479232
    ds_read_b128 v[8:11], v4 offset:0
    v_mfma_f32_16x16x32_bf16 v[116:119], v[16:19], a[40:43], v[116:119]
    buffer_load_dwordx4 a[180:183], v2, s[4:7], s60 offen offset:1024 sc1
    v_mfma_f32_16x16x32_bf16 v[124:127], v[16:19], a[44:47], v[124:127]
    s_waitcnt lgkmcnt(3)
    v_mfma_f32_16x16x32_bf16 v[128:131], v[20:23], a[32:35], v[128:131]
    ds_read_b128 v[12:15], v4 offset:1024
    v_mfma_f32_16x16x32_bf16 v[136:139], v[20:23], a[36:39], v[136:139]
    v_mfma_f32_16x16x32_bf16 v[144:147], v[20:23], a[40:43], v[144:147]
    buffer_load_dwordx4 a[184:187], v2, s[4:7], s60 offen offset:2048 sc1
    v_mfma_f32_16x16x32_bf16 v[152:155], v[20:23], a[44:47], v[152:155]
    s_waitcnt lgkmcnt(3)
    v_mfma_f32_16x16x32_bf16 v[132:135], v[24:27], a[32:35], v[132:135]
    ds_read_b128 v[16:19], v4 offset:2048
    v_mfma_f32_16x16x32_bf16 v[140:143], v[24:27], a[36:39], v[140:143]
    v_mfma_f32_16x16x32_bf16 v[148:151], v[24:27], a[40:43], v[148:151]
    buffer_load_dwordx4 a[188:191], v2, s[4:7], s60 offen offset:3072 sc1
    v_mfma_f32_16x16x32_bf16 v[156:159], v[24:27], a[44:47], v[156:159]
    s_waitcnt lgkmcnt(3)
    s_add_u32 s60, s58, 49152
    v_mfma_f32_16x16x32_bf16 v[160:163], v[28:31], a[32:35], v[160:163]
    ds_read_b128 v[20:23], v4 offset:3072
    v_mfma_f32_16x16x32_bf16 v[164:167], v[28:31], a[36:39], v[164:167]
    v_mfma_f32_16x16x32_bf16 v[168:171], v[28:31], a[40:43], v[168:171]
    buffer_load_dwordx4 a[192:195], v2, s[4:7], s60 offen offset:0 sc1
    v_mfma_f32_16x16x32_bf16 v[172:175], v[28:31], a[44:47], v[172:175]
    s_waitcnt lgkmcnt(3)
    v_mfma_f32_16x16x32_bf16 v[32:35], v[8:11], a[48:51], v[32:35]
    ds_read_b128 v[24:27], v4 offset:4096
    v_mfma_f32_16x16x32_bf16 v[40:43], v[8:11], a[52:55], v[40:43]
    v_mfma_f32_16x16x32_bf16 v[48:51], v[8:11], a[56:59], v[48:51]
    buffer_load_dwordx4 a[196:199], v2, s[4:7], s60 offen offset:1024 sc1
    v_mfma_f32_16x16x32_bf16 v[56:59], v[8:11], a[60:63], v[56:59]
    s_waitcnt lgkmcnt(3)
    v_mfma_f32_16x16x32_bf16 v[36:39], v[12:15], a[48:51], v[36:39]
    ds_read_b128 v[28:31], v4 offset:5120
    v_mfma_f32_16x16x32_bf16 v[44:47], v[12:15], a[52:55], v[44:47]
    v_mfma_f32_16x16x32_bf16 v[52:55], v[12:15], a[56:59], v[52:55]
    buffer_load_dwordx4 a[200:203], v2, s[4:7], s60 offen offset:2048 sc1
    v_mfma_f32_16x16x32_bf16 v[60:63], v[12:15], a[60:63], v[60:63]
    s_waitcnt lgkmcnt(3)
    v_mfma_f32_16x16x32_bf16 v[64:67], v[16:19], a[48:51], v[64:67]
    ds_read_b128 v[8:11], v4 offset:6144
    v_mfma_f32_16x16x32_bf16 v[72:75], v[16:19], a[52:55], v[72:75]
    v_mfma_f32_16x16x32_bf16 v[80:83], v[16:19], a[56:59], v[80:83]
    buffer_load_dwordx4 a[204:207], v2, s[4:7], s60 offen offset:3072 sc1
    v_mfma_f32_16x16x32_bf16 v[88:91], v[16:19], a[60:63], v[88:91]
    s_waitcnt lgkmcnt(3)
    v_mfma_f32_16x16x32_bf16 v[68:71], v[20:23], a[48:51], v[68:71]
    ds_read_b128 v[12:15], v4 offset:7168
    v_mfma_f32_16x16x32_bf16 v[76:79], v[20:23], a[52:55], v[76:79]
    v_mfma_f32_16x16x32_bf16 v[84:87], v[20:23], a[56:59], v[84:87]
    buffer_load_dwordx4 v2, s[4:7], s61 offen offset:0 lds
    v_mfma_f32_16x16x32_bf16 v[92:95], v[20:23], a[60:63], v[92:95]
    s_waitcnt lgkmcnt(3)
    v_mfma_f32_16x16x32_bf16 v[96:99], v[24:27], a[48:51], v[96:99]
    ds_read_b128 v[16:19], v4 offset:8192
    v_mfma_f32_16x16x32_bf16 v[104:107], v[24:27], a[52:55], v[104:107]
    v_mfma_f32_16x16x32_bf16 v[112:115], v[24:27], a[56:59], v[112:115]
    buffer_load_dwordx4 v2, s[4:7], s61 offen offset:1024 lds
    v_mfma_f32_16x16x32_bf16 v[120:123], v[24:27], a[60:63], v[120:123]
    s_waitcnt lgkmcnt(3)
    v_mfma_f32_16x16x32_bf16 v[100:103], v[28:31], a[48:51], v[100:103]
    ds_read_b128 v[20:23], v4 offset:9216
    v_mfma_f32_16x16x32_bf16 v[108:111], v[28:31], a[52:55], v[108:111]
    v_mfma_f32_16x16x32_bf16 v[116:119], v[28:31], a[56:59], v[116:119]
    buffer_load_dwordx4 v2, s[4:7], s61 offen offset:2048 lds
    v_mfma_f32_16x16x32_bf16 v[124:127], v[28:31], a[60:63], v[124:127]
    s_waitcnt lgkmcnt(3)
    v_mfma_f32_16x16x32_bf16 v[128:131], v[8:11], a[48:51], v[128:131]
    ds_read_b128 v[24:27], v4 offset:10240
    v_mfma_f32_16x16x32_bf16 v[136:139], v[8:11], a[52:55], v[136:139]
    v_mfma_f32_16x16x32_bf16 v[144:147], v[8:11], a[56:59], v[144:147]
    buffer_load_dwordx4 v2, s[4:7], s61 offen offset:3072 lds
    v_mfma_f32_16x16x32_bf16 v[152:155], v[8:11], a[60:63], v[152:155]
    s_waitcnt lgkmcnt(3)
    s_add_u32 m0, s63, 40960
    s_add_u32 s61, s62, 483328
    v_mfma_f32_16x16x32_bf16 v[132:135], v[12:15], a[48:51], v[132:135]
    ds_read_b128 v[28:31], v4 offset:11264
    v_mfma_f32_16x16x32_bf16 v[140:143], v[12:15], a[52:55], v[140:143]
    v_mfma_f32_16x16x32_bf16 v[148:151], v[12:15], a[56:59], v[148:151]
    buffer_load_dwordx4 v2, s[4:7], s61 offen offset:0 lds
    v_mfma_f32_16x16x32_bf16 v[156:159], v[12:15], a[60:63], v[156:159]
    s_waitcnt lgkmcnt(3)
    v_mfma_f32_16x16x32_bf16 v[160:163], v[16:19], a[48:51], v[160:163]
    ds_read_b128 v[8:11], v4 offset:12288
    v_mfma_f32_16x16x32_bf16 v[164:167], v[16:19], a[52:55], v[164:167]
    v_mfma_f32_16x16x32_bf16 v[168:171], v[16:19], a[56:59], v[168:171]
    v_mfma_f32_16x16x32_bf16 v[172:175], v[16:19], a[60:63], v[172:175]
    s_waitcnt lgkmcnt(3)
    v_mfma_f32_16x16x32_bf16 v[32:35], v[20:23], a[64:67], v[32:35]
    ds_read_b128 v[12:15], v4 offset:13312
    v_mfma_f32_16x16x32_bf16 v[40:43], v[20:23], a[68:71], v[40:43]
    v_mfma_f32_16x16x32_bf16 v[48:51], v[20:23], a[72:75], v[48:51]
    v_mfma_f32_16x16x32_bf16 v[56:59], v[20:23], a[76:79], v[56:59]
    s_waitcnt lgkmcnt(3)
    v_mfma_f32_16x16x32_bf16 v[36:39], v[24:27], a[64:67], v[36:39]
    ds_read_b128 v[16:19], v4 offset:14336
    v_mfma_f32_16x16x32_bf16 v[44:47], v[24:27], a[68:71], v[44:47]
    v_mfma_f32_16x16x32_bf16 v[52:55], v[24:27], a[72:75], v[52:55]
    v_mfma_f32_16x16x32_bf16 v[60:63], v[24:27], a[76:79], v[60:63]
    s_waitcnt lgkmcnt(3)
    v_mfma_f32_16x16x32_bf16 v[32:35], v[28:31], a[80:83], v[32:35]
    s_and_b32 s62, s22, 15
    s_mul_i32 s62, s62, 129024
    ds_read_b128 v[20:23], v4 offset:15360
    v_mfma_f32_16x16x32_bf16 v[40:43], v[28:31], a[84:87], v[40:43]
    s_add_u32 s62, s62, 0
    v_mfma_f32_16x16x32_bf16 v[48:51], v[28:31], a[88:91], v[48:51]
    s_cmp_lg_u32 s101, 0
    s_cselect_b32 s62, 0x10000000, s62
    v_mfma_f32_16x16x32_bf16 v[56:59], v[28:31], a[92:95], v[56:59]
    s_waitcnt lgkmcnt(3)
    s_add_u32 s61, s63, 36864
    s_add_u32 m0, s61, 18432
    v_mfma_f32_16x16x32_bf16 v[36:39], v[8:11], a[80:83], v[36:39]
    s_add_u32 s61, s61, s62
    ds_read_b128 v[24:27], v4 offset:16384
    v_mfma_f32_16x16x32_bf16 v[44:47], v[8:11], a[84:87], v[44:47]
    buffer_load_dwordx4 v2, s[4:7], s61 offen offset:0 lds
    v_mfma_f32_16x16x32_bf16 v[52:55], v[8:11], a[88:91], v[52:55]
    v_mfma_f32_16x16x32_bf16 v[60:63], v[8:11], a[92:95], v[60:63]
    s_waitcnt lgkmcnt(3)
    v_mfma_f32_16x16x32_bf16 v[32:35], v[12:15], a[96:99], v[32:35]
    ds_read_b128 v[28:31], v4 offset:17408
    v_mfma_f32_16x16x32_bf16 v[40:43], v[12:15], a[100:103], v[40:43]
    buffer_load_dwordx4 v2, s[4:7], s61 offen offset:1024 lds
    v_mfma_f32_16x16x32_bf16 v[48:51], v[12:15], a[104:107], v[48:51]
    v_mfma_f32_16x16x32_bf16 v[56:59], v[12:15], a[108:111], v[56:59]
    s_waitcnt lgkmcnt(3)
    v_mfma_f32_16x16x32_bf16 v[36:39], v[16:19], a[96:99], v[36:39]
    ds_read_b128 v[8:11], v4 offset:18432
    v_mfma_f32_16x16x32_bf16 v[44:47], v[16:19], a[100:103], v[44:47]
    buffer_load_dwordx4 v2, s[4:7], s61 offen offset:2048 lds
    v_mfma_f32_16x16x32_bf16 v[52:55], v[16:19], a[104:107], v[52:55]
    v_mfma_f32_16x16x32_bf16 v[60:63], v[16:19], a[108:111], v[60:63]
    s_waitcnt lgkmcnt(3)
    v_mfma_f32_16x16x32_bf16 v[32:35], v[20:23], a[112:115], v[32:35]
    ds_read_b128 v[12:15], v4 offset:19456
    v_mfma_f32_16x16x32_bf16 v[40:43], v[20:23], a[116:119], v[40:43]
    buffer_load_dwordx4 v2, s[4:7], s61 offen offset:3072 lds
    v_mfma_f32_16x16x32_bf16 v[48:51], v[20:23], a[120:123], v[48:51]
    s_add_u32 s61, s63, 40960
    s_add_u32 m0, s61, 18432
    s_add_u32 s61, s61, s62
    v_mfma_f32_16x16x32_bf16 v[56:59], v[20:23], a[124:127], v[56:59]
    s_waitcnt lgkmcnt(3)
    v_mfma_f32_16x16x32_bf16 v[36:39], v[24:27], a[112:115], v[36:39]
    ds_read_b128 v[16:19], v4 offset:20480
    v_mfma_f32_16x16x32_bf16 v[44:47], v[24:27], a[116:119], v[44:47]
    buffer_load_dwordx4 v2, s[4:7], s61 offen offset:0 lds
    v_mfma_f32_16x16x32_bf16 v[52:55], v[24:27], a[120:123], v[52:55]
    v_mfma_f32_16x16x32_bf16 v[60:63], v[24:27], a[124:127], v[60:63]
    s_waitcnt lgkmcnt(3)
    v_mfma_f32_16x16x32_bf16 v[32:35], v[28:31], a[128:131], v[32:35]
    ds_read_b128 v[20:23], v4 offset:21504
    v_mfma_f32_16x16x32_bf16 v[40:43], v[28:31], a[132:135], v[40:43]
    v_mfma_f32_16x16x32_bf16 v[48:51], v[28:31], a[136:139], v[48:51]
    v_mfma_f32_16x16x32_bf16 v[56:59], v[28:31], a[140:143], v[56:59]
    s_waitcnt lgkmcnt(3)
    v_mfma_f32_16x16x32_bf16 v[36:39], v[8:11], a[128:131], v[36:39]
    ds_read_b128 v[24:27], v4 offset:22528
    v_mfma_f32_16x16x32_bf16 v[44:47], v[8:11], a[132:135], v[44:47]
    v_mfma_f32_16x16x32_bf16 v[52:55], v[8:11], a[136:139], v[52:55]
    v_mfma_f32_16x16x32_bf16 v[60:63], v[8:11], a[140:143], v[60:63]
    s_waitcnt lgkmcnt(3)
    v_mfma_f32_16x16x32_bf16 v[32:35], v[12:15], a[144:147], v[32:35]
    ds_read_b128 v[28:31], v4 offset:23552
    v_mfma_f32_16x16x32_bf16 v[40:43], v[12:15], a[148:151], v[40:43]
    v_mfma_f32_16x16x32_bf16 v[48:51], v[12:15], a[152:155], v[48:51]
    v_mfma_f32_16x16x32_bf16 v[56:59], v[12:15], a[156:159], v[56:59]
    s_waitcnt lgkmcnt(3)
    v_mfma_f32_16x16x32_bf16 v[36:39], v[16:19], a[144:147], v[36:39]
    ds_read_b128 v[8:11], v4 offset:24576
    v_mfma_f32_16x16x32_bf16 v[44:47], v[16:19], a[148:151], v[44:47]
    v_mfma_f32_16x16x32_bf16 v[52:55], v[16:19], a[152:155], v[52:55]
    v_mfma_f32_16x16x32_bf16 v[60:63], v[16:19], a[156:159], v[60:63]
    s_waitcnt vmcnt(21) lgkmcnt(3)
    v_mfma_f32_16x16x32_bf16 v[32:35], v[20:23], a[160:163], v[32:35]
    s_waitcnt vmcnt(20)
    ds_read_b128 v[12:15], v4 offset:25600
    v_mfma_f32_16x16x32_bf16 v[40:43], v[20:23], a[164:167], v[40:43]
    s_waitcnt vmcnt(19)
    v_mfma_f32_16x16x32_bf16 v[48:51], v[20:23], a[168:171], v[48:51]
    s_waitcnt vmcnt(18)
    v_mfma_f32_16x16x32_bf16 v[56:59], v[20:23], a[172:175], v[56:59]
    s_waitcnt lgkmcnt(3)
    v_mfma_f32_16x16x32_bf16 v[36:39], v[24:27], a[160:163], v[36:39]
    ds_read_b128 v[16:19], v4 offset:26624
    v_mfma_f32_16x16x32_bf16 v[44:47], v[24:27], a[164:167], v[44:47]
    v_mfma_f32_16x16x32_bf16 v[52:55], v[24:27], a[168:171], v[52:55]
    v_mfma_f32_16x16x32_bf16 v[60:63], v[24:27], a[172:175], v[60:63]
    s_waitcnt vmcnt(17) lgkmcnt(3)
    v_mfma_f32_16x16x32_bf16 v[32:35], v[28:31], a[176:179], v[32:35]
    s_waitcnt vmcnt(16)
    ds_read_b128 v[20:23], v4 offset:27648
    v_mfma_f32_16x16x32_bf16 v[40:43], v[28:31], a[180:183], v[40:43]
    s_waitcnt vmcnt(15)
    v_mfma_f32_16x16x32_bf16 v[48:51], v[28:31], a[184:187], v[48:51]
    s_waitcnt vmcnt(14)
    v_mfma_f32_16x16x32_bf16 v[56:59], v[28:31], a[188:191], v[56:59]
    s_waitcnt lgkmcnt(3)
    v_mfma_f32_16x16x32_bf16 v[36:39], v[8:11], a[176:179], v[36:39]
    ds_read_b128 v[24:27], v4 offset:28672
    v_mfma_f32_16x16x32_bf16 v[44:47], v[8:11], a[180:183], v[44:47]
    v_mfma_f32_16x16x32_bf16 v[52:55], v[8:11], a[184:187], v[52:55]
    v_mfma_f32_16x16x32_bf16 v[60:63], v[8:11], a[188:191], v[60:63]
    s_waitcnt vmcnt(13) lgkmcnt(3)
    v_mfma_f32_16x16x32_bf16 v[32:35], v[12:15], a[192:195], v[32:35]
    s_waitcnt vmcnt(12)
    ds_read_b128 v[28:31], v4 offset:29696
    v_mfma_f32_16x16x32_bf16 v[40:43], v[12:15], a[196:199], v[40:43]
    s_waitcnt vmcnt(11)
    v_mfma_f32_16x16x32_bf16 v[48:51], v[12:15], a[200:203], v[48:51]
    s_waitcnt vmcnt(10)
    v_mfma_f32_16x16x32_bf16 v[56:59], v[12:15], a[204:207], v[56:59]
    s_waitcnt lgkmcnt(3)
    v_mfma_f32_16x16x32_bf16 v[36:39], v[16:19], a[192:195], v[36:39]
    ds_read_b128 v[8:11], v4 offset:30720
    v_mfma_f32_16x16x32_bf16 v[44:47], v[16:19], a[196:199], v[44:47]
    v_mfma_f32_16x16x32_bf16 v[52:55], v[16:19], a[200:203], v[52:55]
    v_mfma_f32_16x16x32_bf16 v[60:63], v[16:19], a[204:207], v[60:63]
    s_waitcnt lgkmcnt(3)
    v_mfma_f32_16x16x32_bf16 v[64:67], v[20:23], a[64:67], v[64:67]
    ds_read_b128 v[12:15], v4 offset:31744
    v_mfma_f32_16x16x32_bf16 v[72:75], v[20:23], a[68:71], v[72:75]
    v_mfma_f32_16x16x32_bf16 v[80:83], v[20:23], a[72:75], v[80:83]
    v_mfma_f32_16x16x32_bf16 v[88:91], v[20:23], a[76:79], v[88:91]
    s_waitcnt lgkmcnt(3)
    v_cvt_pk_bf16_f32 v32, v32, v33
    v_cvt_pk_bf16_f32 v33, v34, v35
    v_mfma_f32_16x16x32_bf16 v[68:71], v[24:27], a[64:67], v[68:71]
    ds_read_b128 v[16:19], v4 offset:32768
    v_cvt_pk_bf16_f32 v34, v36, v37
    v_mfma_f32_16x16x32_bf16 v[76:79], v[24:27], a[68:71], v[76:79]
    v_cvt_pk_bf16_f32 v35, v38, v39
    v_mfma_f32_16x16x32_bf16 v[84:87], v[24:27], a[72:75], v[84:87]
    s_add_u32 s70, s69, 0
    v_mfma_f32_16x16x32_bf16 v[92:95], v[24:27], a[76:79], v[92:95]
    s_waitcnt lgkmcnt(3)
    v_mfma_f32_16x16x32_bf16 v[64:67], v[28:31], a[80:83], v[64:67]
    ds_read_b128 v[20:23], v4 offset:33792
    v_mfma_f32_16x16x32_bf16 v[72:75], v[28:31], a[84:87], v[72:75]
    buffer_store_dwordx4 v[32:35], v2, s[4:7], s70 offen sc1
    v_mfma_f32_16x16x32_bf16 v[80:83], v[28:31], a[88:91], v[80:83]
    v_cvt_pk_bf16_f32 v40, v40, v41
    v_cvt_pk_bf16_f32 v41, v42, v43
    v_mfma_f32_16x16x32_bf16 v[88:91], v[28:31], a[92:95], v[88:91]
    s_waitcnt lgkmcnt(3)
    v_cvt_pk_bf16_f32 v42, v44, v45
    v_cvt_pk_bf16_f32 v43, v46, v47
    v_mfma_f32_16x16x32_bf16 v[68:71], v[8:11], a[80:83], v[68:71]
    s_add_u32 s70, s69, 18432
    ds_read_b128 v[24:27], v4 offset:34816
    v_mfma_f32_16x16x32_bf16 v[76:79], v[8:11], a[84:87], v[76:79]
    buffer_store_dwordx4 v[40:43], v2, s[4:7], s70 offen sc1
    v_mfma_f32_16x16x32_bf16 v[84:87], v[8:11], a[88:91], v[84:87]
    v_cvt_pk_bf16_f32 v48, v48, v49
    v_cvt_pk_bf16_f32 v49, v50, v51
    v_mfma_f32_16x16x32_bf16 v[92:95], v[8:11], a[92:95], v[92:95]
    s_waitcnt lgkmcnt(3)
    v_cvt_pk_bf16_f32 v50, v52, v53
    v_cvt_pk_bf16_f32 v51, v54, v55
    v_mfma_f32_16x16x32_bf16 v[64:67], v[12:15], a[96:99], v[64:67]
    s_add_u32 s70, s69, 36864
    ds_read_b128 v[28:31], v4 offset:35840
    v_mfma_f32_16x16x32_bf16 v[72:75], v[12:15], a[100:103], v[72:75]
    buffer_store_dwordx4 v[48:51], v2, s[4:7], s70 offen sc1
    v_mfma_f32_16x16x32_bf16 v[80:83], v[12:15], a[104:107], v[80:83]
    v_cvt_pk_bf16_f32 v56, v56, v57
    v_cvt_pk_bf16_f32 v57, v58, v59
    v_mfma_f32_16x16x32_bf16 v[88:91], v[12:15], a[108:111], v[88:91]
    s_waitcnt lgkmcnt(3)
    v_cvt_pk_bf16_f32 v58, v60, v61
    v_cvt_pk_bf16_f32 v59, v62, v63
    v_mfma_f32_16x16x32_bf16 v[68:71], v[16:19], a[96:99], v[68:71]
    s_barrier
    v_add_u32 v4, 0xfffe5000, v4
    v_mfma_f32_16x16x32_bf16 v[76:79], v[16:19], a[100:103], v[76:79]
    s_add_u32 s70, s69, 55296
    s_add_u32 s61, s49, 55296
    ds_read_b128 v[8:11], v4 offset:0
    v_mfma_f32_16x16x32_bf16 v[84:87], v[16:19], a[104:107], v[84:87]
    buffer_store_dwordx4 v[56:59], v2, s[4:7], s70 offen sc1
    v_mfma_f32_16x16x32_bf16 v[92:95], v[16:19], a[108:111], v[92:95]
    s_waitcnt lgkmcnt(3)
    s_add_u32 m0, s61, 18432
    s_add_u32 s61, s61, s62
    v_mfma_f32_16x16x32_bf16 v[64:67], v[20:23], a[112:115], v[64:67]
    ds_read_b128 v[12:15], v4 offset:1024
    v_mfma_f32_16x16x32_bf16 v[72:75], v[20:23], a[116:119], v[72:75]
    v_mfma_f32_16x16x32_bf16 v[80:83], v[20:23], a[120:123], v[80:83]
    buffer_load_dwordx4 v2, s[4:7], s61 offen offset:0 lds
    v_mfma_f32_16x16x32_bf16 v[88:91], v[20:23], a[124:127], v[88:91]
    s_waitcnt lgkmcnt(3)
    v_mfma_f32_16x16x32_bf16 v[68:71], v[24:27], a[112:115], v[68:71]
    ds_read_b128 v[16:19], v4 offset:2048
    v_mfma_f32_16x16x32_bf16 v[76:79], v[24:27], a[116:119], v[76:79]
    v_mfma_f32_16x16x32_bf16 v[84:87], v[24:27], a[120:123], v[84:87]
    buffer_load_dwordx4 v2, s[4:7], s61 offen offset:1024 lds
    v_mfma_f32_16x16x32_bf16 v[92:95], v[24:27], a[124:127], v[92:95]
    s_waitcnt lgkmcnt(3)
    v_mfma_f32_16x16x32_bf16 v[64:67], v[28:31], a[128:131], v[64:67]
    ds_read_b128 v[20:23], v4 offset:3072
    v_mfma_f32_16x16x32_bf16 v[72:75], v[28:31], a[132:135], v[72:75]
    v_mfma_f32_16x16x32_bf16 v[80:83], v[28:31], a[136:139], v[80:83]
    buffer_load_dwordx4 v2, s[4:7], s61 offen offset:2048 lds
    v_mfma_f32_16x16x32_bf16 v[88:91], v[28:31], a[140:143], v[88:91]
    s_waitcnt lgkmcnt(3)
    v_mfma_f32_16x16x32_bf16 v[68:71], v[8:11], a[128:131], v[68:71]
    ds_read_b128 v[24:27], v4 offset:4096
    v_mfma_f32_16x16x32_bf16 v[76:79], v[8:11], a[132:135], v[76:79]
    v_mfma_f32_16x16x32_bf16 v[84:87], v[8:11], a[136:139], v[84:87]
    buffer_load_dwordx4 v2, s[4:7], s61 offen offset:3072 lds
    v_mfma_f32_16x16x32_bf16 v[92:95], v[8:11], a[140:143], v[92:95]
    s_waitcnt lgkmcnt(3)
    s_add_u32 s61, s49, 59392
    s_add_u32 m0, s61, 18432
    v_mfma_f32_16x16x32_bf16 v[64:67], v[12:15], a[144:147], v[64:67]
    s_add_u32 s61, s61, s62
    ds_read_b128 v[28:31], v4 offset:5120
    v_mfma_f32_16x16x32_bf16 v[72:75], v[12:15], a[148:151], v[72:75]
    v_mfma_f32_16x16x32_bf16 v[80:83], v[12:15], a[152:155], v[80:83]
    buffer_load_dwordx4 v2, s[4:7], s61 offen offset:0 lds
    v_mfma_f32_16x16x32_bf16 v[88:91], v[12:15], a[156:159], v[88:91]
    s_waitcnt lgkmcnt(3)
    v_mfma_f32_16x16x32_bf16 v[68:71], v[16:19], a[144:147], v[68:71]
    ds_read_b128 v[8:11], v4 offset:6144
    v_mfma_f32_16x16x32_bf16 v[76:79], v[16:19], a[148:151], v[76:79]
    v_mfma_f32_16x16x32_bf16 v[84:87], v[16:19], a[152:155], v[84:87]
    buffer_load_dwordx4 v2, s[4:7], s61 offen offset:1024 lds
    v_mfma_f32_16x16x32_bf16 v[92:95], v[16:19], a[156:159], v[92:95]
    s_waitcnt lgkmcnt(3)
    v_mfma_f32_16x16x32_bf16 v[64:67], v[20:23], a[160:163], v[64:67]
    ds_read_b128 v[12:15], v4 offset:7168
    v_mfma_f32_16x16x32_bf16 v[72:75], v[20:23], a[164:167], v[72:75]
    v_mfma_f32_16x16x32_bf16 v[80:83], v[20:23], a[168:171], v[80:83]
    buffer_load_dwordx4 v2, s[4:7], s61 offen offset:2048 lds
    v_mfma_f32_16x16x32_bf16 v[88:91], v[20:23], a[172:175], v[88:91]
    s_waitcnt lgkmcnt(3)
    v_mfma_f32_16x16x32_bf16 v[68:71], v[24:27], a[160:163], v[68:71]
    ds_read_b128 v[16:19], v4 offset:8192
    v_mfma_f32_16x16x32_bf16 v[76:79], v[24:27], a[164:167], v[76:79]
    v_mfma_f32_16x16x32_bf16 v[84:87], v[24:27], a[168:171], v[84:87]
    buffer_load_dwordx4 v2, s[4:7], s61 offen offset:3072 lds
    v_mfma_f32_16x16x32_bf16 v[92:95], v[24:27], a[172:175], v[92:95]
    s_waitcnt lgkmcnt(3)
    s_add_u32 s61, s49, 63488
    s_add_u32 m0, s61, 18432
    v_mfma_f32_16x16x32_bf16 v[64:67], v[28:31], a[176:179], v[64:67]
    s_add_u32 s61, s61, s62
    ds_read_b128 v[20:23], v4 offset:9216
    v_mfma_f32_16x16x32_bf16 v[72:75], v[28:31], a[180:183], v[72:75]
    v_mfma_f32_16x16x32_bf16 v[80:83], v[28:31], a[184:187], v[80:83]
    buffer_load_dwordx4 v2, s[4:7], s61 offen offset:0 lds
    v_mfma_f32_16x16x32_bf16 v[88:91], v[28:31], a[188:191], v[88:91]
    s_waitcnt lgkmcnt(3)
    v_mfma_f32_16x16x32_bf16 v[68:71], v[8:11], a[176:179], v[68:71]
    ds_read_b128 v[24:27], v4 offset:10240
    v_mfma_f32_16x16x32_bf16 v[76:79], v[8:11], a[180:183], v[76:79]
    v_mfma_f32_16x16x32_bf16 v[84:87], v[8:11], a[184:187], v[84:87]
    v_mfma_f32_16x16x32_bf16 v[92:95], v[8:11], a[188:191], v[92:95]
    s_waitcnt lgkmcnt(3)
    v_mfma_f32_16x16x32_bf16 v[64:67], v[12:15], a[192:195], v[64:67]
    ds_read_b128 v[28:31], v4 offset:11264
    v_mfma_f32_16x16x32_bf16 v[72:75], v[12:15], a[196:199], v[72:75]
    v_mfma_f32_16x16x32_bf16 v[80:83], v[12:15], a[200:203], v[80:83]
    v_mfma_f32_16x16x32_bf16 v[88:91], v[12:15], a[204:207], v[88:91]
    s_waitcnt lgkmcnt(3)
    v_mfma_f32_16x16x32_bf16 v[68:71], v[16:19], a[192:195], v[68:71]
    ds_read_b128 v[8:11], v4 offset:12288
    v_mfma_f32_16x16x32_bf16 v[76:79], v[16:19], a[196:199], v[76:79]
    v_mfma_f32_16x16x32_bf16 v[84:87], v[16:19], a[200:203], v[84:87]
    v_mfma_f32_16x16x32_bf16 v[92:95], v[16:19], a[204:207], v[92:95]
    s_waitcnt lgkmcnt(3)
    v_mfma_f32_16x16x32_bf16 v[96:99], v[20:23], a[64:67], v[96:99]
    ds_read_b128 v[12:15], v4 offset:13312
    v_mfma_f32_16x16x32_bf16 v[104:107], v[20:23], a[68:71], v[104:107]
    v_mfma_f32_16x16x32_bf16 v[112:115], v[20:23], a[72:75], v[112:115]
    v_mfma_f32_16x16x32_bf16 v[120:123], v[20:23], a[76:79], v[120:123]
    s_waitcnt lgkmcnt(3)
    v_cvt_pk_bf16_f32 v64, v64, v65
    v_cvt_pk_bf16_f32 v65, v66, v67
    v_mfma_f32_16x16x32_bf16 v[100:103], v[24:27], a[64:67], v[100:103]
    ds_read_b128 v[16:19], v4 offset:14336
    v_cvt_pk_bf16_f32 v66, v68, v69
    v_mfma_f32_16x16x32_bf16 v[108:111], v[24:27], a[68:71], v[108:111]
    v_cvt_pk_bf16_f32 v67, v70, v71
    v_mfma_f32_16x16x32_bf16 v[116:119], v[24:27], a[72:75], v[116:119]
    s_add_u32 s70, s69, 1024
    v_mfma_f32_16x16x32_bf16 v[124:127], v[24:27], a[76:79], v[124:127]
    s_waitcnt lgkmcnt(3)
    v_mfma_f32_16x16x32_bf16 v[96:99], v[28:31], a[80:83], v[96:99]
    ds_read_b128 v[20:23], v4 offset:15360
    v_mfma_f32_16x16x32_bf16 v[104:107], v[28:31], a[84:87], v[104:107]
    buffer_store_dwordx4 v[64:67], v2, s[4:7], s70 offen sc1
    v_mfma_f32_16x16x32_bf16 v[112:115], v[28:31], a[88:91], v[112:115]
    v_cvt_pk_bf16_f32 v72, v72, v73
    v_cvt_pk_bf16_f32 v73, v74, v75
    v_mfma_f32_16x16x32_bf16 v[120:123], v[28:31], a[92:95], v[120:123]
    s_waitcnt lgkmcnt(3)
    v_cvt_pk_bf16_f32 v74, v76, v77
    v_cvt_pk_bf16_f32 v75, v78, v79
    v_mfma_f32_16x16x32_bf16 v[100:103], v[8:11], a[80:83], v[100:103]
    s_add_u32 s70, s69, 19456
    ds_read_b128 v[24:27], v4 offset:16384
    v_mfma_f32_16x16x32_bf16 v[108:111], v[8:11], a[84:87], v[108:111]
    buffer_store_dwordx4 v[72:75], v2, s[4:7], s70 offen sc1
    v_mfma_f32_16x16x32_bf16 v[116:119], v[8:11], a[88:91], v[116:119]
    v_cvt_pk_bf16_f32 v80, v80, v81
    v_cvt_pk_bf16_f32 v81, v82, v83
    v_mfma_f32_16x16x32_bf16 v[124:127], v[8:11], a[92:95], v[124:127]
    s_waitcnt lgkmcnt(3)
    v_cvt_pk_bf16_f32 v82, v84, v85
    v_cvt_pk_bf16_f32 v83, v86, v87
    v_mfma_f32_16x16x32_bf16 v[96:99], v[12:15], a[96:99], v[96:99]
    s_add_u32 s70, s69, 37888
    ds_read_b128 v[28:31], v4 offset:17408
    v_mfma_f32_16x16x32_bf16 v[104:107], v[12:15], a[100:103], v[104:107]
    buffer_store_dwordx4 v[80:83], v2, s[4:7], s70 offen sc1
    v_mfma_f32_16x16x32_bf16 v[112:115], v[12:15], a[104:107], v[112:115]
    v_cvt_pk_bf16_f32 v88, v88, v89
    v_cvt_pk_bf16_f32 v89, v90, v91
    v_mfma_f32_16x16x32_bf16 v[120:123], v[12:15], a[108:111], v[120:123]
    s_waitcnt lgkmcnt(3)
    v_cvt_pk_bf16_f32 v90, v92, v93
    v_cvt_pk_bf16_f32 v91, v94, v95
    v_mfma_f32_16x16x32_bf16 v[100:103], v[16:19], a[96:99], v[100:103]
    s_add_u32 s70, s69, 56320
    ds_read_b128 v[8:11], v4 offset:18432
    v_mfma_f32_16x16x32_bf16 v[108:111], v[16:19], a[100:103], v[108:111]
    buffer_store_dwordx4 v[88:91], v2, s[4:7], s70 offen sc1
    v_mfma_f32_16x16x32_bf16 v[116:119], v[16:19], a[104:107], v[116:119]
    v_mfma_f32_16x16x32_bf16 v[124:127], v[16:19], a[108:111], v[124:127]
    s_waitcnt lgkmcnt(3)
    v_mfma_f32_16x16x32_bf16 v[96:99], v[20:23], a[112:115], v[96:99]
    ds_read_b128 v[12:15], v4 offset:19456
    v_mfma_f32_16x16x32_bf16 v[104:107], v[20:23], a[116:119], v[104:107]
    v_mfma_f32_16x16x32_bf16 v[112:115], v[20:23], a[120:123], v[112:115]
    v_mfma_f32_16x16x32_bf16 v[120:123], v[20:23], a[124:127], v[120:123]
    s_waitcnt lgkmcnt(3)
    v_mfma_f32_16x16x32_bf16 v[100:103], v[24:27], a[112:115], v[100:103]
    ds_read_b128 v[16:19], v4 offset:20480
    v_mfma_f32_16x16x32_bf16 v[108:111], v[24:27], a[116:119], v[108:111]
    v_mfma_f32_16x16x32_bf16 v[116:119], v[24:27], a[120:123], v[116:119]
    v_mfma_f32_16x16x32_bf16 v[124:127], v[24:27], a[124:127], v[124:127]
    s_waitcnt lgkmcnt(3)
    v_mfma_f32_16x16x32_bf16 v[96:99], v[28:31], a[128:131], v[96:99]
    ds_read_b128 v[20:23], v4 offset:21504
    v_mfma_f32_16x16x32_bf16 v[104:107], v[28:31], a[132:135], v[104:107]
    v_mfma_f32_16x16x32_bf16 v[112:115], v[28:31], a[136:139], v[112:115]
    v_mfma_f32_16x16x32_bf16 v[120:123], v[28:31], a[140:143], v[120:123]
    s_waitcnt lgkmcnt(3)
    v_mfma_f32_16x16x32_bf16 v[100:103], v[8:11], a[128:131], v[100:103]
    ds_read_b128 v[24:27], v4 offset:22528
    v_mfma_f32_16x16x32_bf16 v[108:111], v[8:11], a[132:135], v[108:111]
    v_mfma_f32_16x16x32_bf16 v[116:119], v[8:11], a[136:139], v[116:119]
    v_mfma_f32_16x16x32_bf16 v[124:127], v[8:11], a[140:143], v[124:127]
    s_waitcnt lgkmcnt(3)
    v_mfma_f32_16x16x32_bf16 v[96:99], v[12:15], a[144:147], v[96:99]
    ds_read_b128 v[28:31], v4 offset:23552
    v_mfma_f32_16x16x32_bf16 v[104:107], v[12:15], a[148:151], v[104:107]
    v_mfma_f32_16x16x32_bf16 v[112:115], v[12:15], a[152:155], v[112:115]
    v_mfma_f32_16x16x32_bf16 v[120:123], v[12:15], a[156:159], v[120:123]
    s_waitcnt lgkmcnt(3)
    v_mfma_f32_16x16x32_bf16 v[100:103], v[16:19], a[144:147], v[100:103]
    ds_read_b128 v[8:11], v4 offset:24576
    v_mfma_f32_16x16x32_bf16 v[108:111], v[16:19], a[148:151], v[108:111]
    v_mfma_f32_16x16x32_bf16 v[116:119], v[16:19], a[152:155], v[116:119]
    v_mfma_f32_16x16x32_bf16 v[124:127], v[16:19], a[156:159], v[124:127]
    s_waitcnt lgkmcnt(3)
    v_mfma_f32_16x16x32_bf16 v[96:99], v[20:23], a[160:163], v[96:99]
    ds_read_b128 v[12:15], v4 offset:25600
    v_mfma_f32_16x16x32_bf16 v[104:107], v[20:23], a[164:167], v[104:107]
    v_mfma_f32_16x16x32_bf16 v[112:115], v[20:23], a[168:171], v[112:115]
    v_mfma_f32_16x16x32_bf16 v[120:123], v[20:23], a[172:175], v[120:123]
    s_waitcnt lgkmcnt(3)
    v_mfma_f32_16x16x32_bf16 v[100:103], v[24:27], a[160:163], v[100:103]
    ds_read_b128 v[16:19], v4 offset:26624
    v_mfma_f32_16x16x32_bf16 v[108:111], v[24:27], a[164:167], v[108:111]
    v_mfma_f32_16x16x32_bf16 v[116:119], v[24:27], a[168:171], v[116:119]
    v_mfma_f32_16x16x32_bf16 v[124:127], v[24:27], a[172:175], v[124:127]
    s_waitcnt lgkmcnt(3)
    v_mfma_f32_16x16x32_bf16 v[96:99], v[28:31], a[176:179], v[96:99]
    ds_read_b128 v[20:23], v4 offset:27648
    v_mfma_f32_16x16x32_bf16 v[104:107], v[28:31], a[180:183], v[104:107]
    v_mfma_f32_16x16x32_bf16 v[112:115], v[28:31], a[184:187], v[112:115]
    v_mfma_f32_16x16x32_bf16 v[120:123], v[28:31], a[188:191], v[120:123]
    s_waitcnt lgkmcnt(3)
    v_mfma_f32_16x16x32_bf16 v[100:103], v[8:11], a[176:179], v[100:103]
    ds_read_b128 v[24:27], v4 offset:28672
    v_mfma_f32_16x16x32_bf16 v[108:111], v[8:11], a[180:183], v[108:111]
    v_mfma_f32_16x16x32_bf16 v[116:119], v[8:11], a[184:187], v[116:119]
    v_mfma_f32_16x16x32_bf16 v[124:127], v[8:11], a[188:191], v[124:127]
    s_waitcnt lgkmcnt(3)
    v_mfma_f32_16x16x32_bf16 v[96:99], v[12:15], a[192:195], v[96:99]
    ds_read_b128 v[28:31], v4 offset:29696
    v_mfma_f32_16x16x32_bf16 v[104:107], v[12:15], a[196:199], v[104:107]
    v_mfma_f32_16x16x32_bf16 v[112:115], v[12:15], a[200:203], v[112:115]
    v_mfma_f32_16x16x32_bf16 v[120:123], v[12:15], a[204:207], v[120:123]
    s_waitcnt lgkmcnt(3)
    v_mfma_f32_16x16x32_bf16 v[100:103], v[16:19], a[192:195], v[100:103]
    ds_read_b128 v[8:11], v4 offset:30720
    v_mfma_f32_16x16x32_bf16 v[108:111], v[16:19], a[196:199], v[108:111]
    v_mfma_f32_16x16x32_bf16 v[116:119], v[16:19], a[200:203], v[116:119]
    v_mfma_f32_16x16x32_bf16 v[124:127], v[16:19], a[204:207], v[124:127]
    s_waitcnt lgkmcnt(3)
    v_mfma_f32_16x16x32_bf16 v[128:131], v[20:23], a[64:67], v[128:131]
    ds_read_b128 v[12:15], v4 offset:31744
    v_mfma_f32_16x16x32_bf16 v[136:139], v[20:23], a[68:71], v[136:139]
    v_mfma_f32_16x16x32_bf16 v[144:147], v[20:23], a[72:75], v[144:147]
    v_mfma_f32_16x16x32_bf16 v[152:155], v[20:23], a[76:79], v[152:155]
    s_waitcnt lgkmcnt(3)
    v_cvt_pk_bf16_f32 v96, v96, v97
    v_cvt_pk_bf16_f32 v97, v98, v99
    v_mfma_f32_16x16x32_bf16 v[132:135], v[24:27], a[64:67], v[132:135]
    ds_read_b128 v[16:19], v4 offset:32768
    v_cvt_pk_bf16_f32 v98, v100, v101
    v_mfma_f32_16x16x32_bf16 v[140:143], v[24:27], a[68:71], v[140:143]
    v_cvt_pk_bf16_f32 v99, v102, v103
    v_mfma_f32_16x16x32_bf16 v[148:151], v[24:27], a[72:75], v[148:151]
    s_add_u32 s70, s69, 2048
    v_mfma_f32_16x16x32_bf16 v[156:159], v[24:27], a[76:79], v[156:159]
    s_waitcnt lgkmcnt(3)
    v_mfma_f32_16x16x32_bf16 v[128:131], v[28:31], a[80:83], v[128:131]
    ds_read_b128 v[20:23], v4 offset:33792
    v_mfma_f32_16x16x32_bf16 v[136:139], v[28:31], a[84:87], v[136:139]
    buffer_store_dwordx4 v[96:99], v2, s[4:7], s70 offen sc1
    v_mfma_f32_16x16x32_bf16 v[144:147], v[28:31], a[88:91], v[144:147]
    v_cvt_pk_bf16_f32 v104, v104, v105
    v_cvt_pk_bf16_f32 v105, v106, v107
    v_mfma_f32_16x16x32_bf16 v[152:155], v[28:31], a[92:95], v[152:155]
    s_waitcnt lgkmcnt(3)
    v_cvt_pk_bf16_f32 v106, v108, v109
    v_cvt_pk_bf16_f32 v107, v110, v111
    v_mfma_f32_16x16x32_bf16 v[132:135], v[8:11], a[80:83], v[132:135]
    s_add_u32 s70, s69, 20480
    ds_read_b128 v[24:27], v4 offset:34816
    v_mfma_f32_16x16x32_bf16 v[140:143], v[8:11], a[84:87], v[140:143]
    buffer_store_dwordx4 v[104:107], v2, s[4:7], s70 offen sc1
    v_mfma_f32_16x16x32_bf16 v[148:151], v[8:11], a[88:91], v[148:151]
    v_cvt_pk_bf16_f32 v112, v112, v113
    v_cvt_pk_bf16_f32 v113, v114, v115
    v_mfma_f32_16x16x32_bf16 v[156:159], v[8:11], a[92:95], v[156:159]
    s_waitcnt lgkmcnt(3)
    v_cvt_pk_bf16_f32 v114, v116, v117
    v_cvt_pk_bf16_f32 v115, v118, v119
    v_mfma_f32_16x16x32_bf16 v[128:131], v[12:15], a[96:99], v[128:131]
    s_add_u32 s70, s69, 38912
    ds_read_b128 v[28:31], v4 offset:35840
    v_mfma_f32_16x16x32_bf16 v[136:139], v[12:15], a[100:103], v[136:139]
    buffer_store_dwordx4 v[112:115], v2, s[4:7], s70 offen sc1
    v_mfma_f32_16x16x32_bf16 v[144:147], v[12:15], a[104:107], v[144:147]
    v_cvt_pk_bf16_f32 v120, v120, v121
    v_cvt_pk_bf16_f32 v121, v122, v123
    v_mfma_f32_16x16x32_bf16 v[152:155], v[12:15], a[108:111], v[152:155]
    s_waitcnt lgkmcnt(3)
    v_cvt_pk_bf16_f32 v122, v124, v125
    v_cvt_pk_bf16_f32 v123, v126, v127
    v_mfma_f32_16x16x32_bf16 v[132:135], v[16:19], a[96:99], v[132:135]
    s_waitcnt vmcnt(25)
    s_barrier
    v_add_u32 v4, 0x9000, v4
    v_mfma_f32_16x16x32_bf16 v[140:143], v[16:19], a[100:103], v[140:143]
    s_add_u32 s70, s69, 57344
    s_add_u32 s61, s49, 92160
    ds_read_b128 v[8:11], v4 offset:0
    v_mfma_f32_16x16x32_bf16 v[148:151], v[16:19], a[104:107], v[148:151]
    buffer_store_dwordx4 v[120:123], v2, s[4:7], s70 offen sc1
    v_mfma_f32_16x16x32_bf16 v[156:159], v[16:19], a[108:111], v[156:159]
    s_waitcnt lgkmcnt(3)
    s_add_u32 m0, s61, 18432
    s_add_u32 s61, s61, s62
    v_mfma_f32_16x16x32_bf16 v[128:131], v[20:23], a[112:115], v[128:131]
    ds_read_b128 v[12:15], v4 offset:1024
    v_mfma_f32_16x16x32_bf16 v[136:139], v[20:23], a[116:119], v[136:139]
    v_mfma_f32_16x16x32_bf16 v[144:147], v[20:23], a[120:123], v[144:147]
    buffer_load_dwordx4 v2, s[4:7], s61 offen offset:0 lds
    v_mfma_f32_16x16x32_bf16 v[152:155], v[20:23], a[124:127], v[152:155]
    s_waitcnt lgkmcnt(3)
    v_mfma_f32_16x16x32_bf16 v[132:135], v[24:27], a[112:115], v[132:135]
    ds_read_b128 v[16:19], v4 offset:2048
    v_mfma_f32_16x16x32_bf16 v[140:143], v[24:27], a[116:119], v[140:143]
    v_mfma_f32_16x16x32_bf16 v[148:151], v[24:27], a[120:123], v[148:151]
    buffer_load_dwordx4 v2, s[4:7], s61 offen offset:1024 lds
    v_mfma_f32_16x16x32_bf16 v[156:159], v[24:27], a[124:127], v[156:159]
    s_waitcnt lgkmcnt(3)
    v_mfma_f32_16x16x32_bf16 v[128:131], v[28:31], a[128:131], v[128:131]
    ds_read_b128 v[20:23], v4 offset:3072
    v_mfma_f32_16x16x32_bf16 v[136:139], v[28:31], a[132:135], v[136:139]
    v_mfma_f32_16x16x32_bf16 v[144:147], v[28:31], a[136:139], v[144:147]
    buffer_load_dwordx4 v2, s[4:7], s61 offen offset:2048 lds
    v_mfma_f32_16x16x32_bf16 v[152:155], v[28:31], a[140:143], v[152:155]
    s_waitcnt lgkmcnt(3)
    v_mfma_f32_16x16x32_bf16 v[132:135], v[8:11], a[128:131], v[132:135]
    ds_read_b128 v[24:27], v4 offset:4096
    v_mfma_f32_16x16x32_bf16 v[140:143], v[8:11], a[132:135], v[140:143]
    v_mfma_f32_16x16x32_bf16 v[148:151], v[8:11], a[136:139], v[148:151]
    buffer_load_dwordx4 v2, s[4:7], s61 offen offset:3072 lds
    v_mfma_f32_16x16x32_bf16 v[156:159], v[8:11], a[140:143], v[156:159]
    s_waitcnt lgkmcnt(3)
    s_add_u32 s61, s49, 96256
    s_add_u32 m0, s61, 18432
    v_mfma_f32_16x16x32_bf16 v[128:131], v[12:15], a[144:147], v[128:131]
    s_add_u32 s61, s61, s62
    ds_read_b128 v[28:31], v4 offset:5120
    v_mfma_f32_16x16x32_bf16 v[136:139], v[12:15], a[148:151], v[136:139]
    v_mfma_f32_16x16x32_bf16 v[144:147], v[12:15], a[152:155], v[144:147]
    buffer_load_dwordx4 v2, s[4:7], s61 offen offset:0 lds
    v_mfma_f32_16x16x32_bf16 v[152:155], v[12:15], a[156:159], v[152:155]
    s_waitcnt lgkmcnt(3)
    v_mfma_f32_16x16x32_bf16 v[132:135], v[16:19], a[144:147], v[132:135]
    ds_read_b128 v[8:11], v4 offset:6144
    v_mfma_f32_16x16x32_bf16 v[140:143], v[16:19], a[148:151], v[140:143]
    v_mfma_f32_16x16x32_bf16 v[148:151], v[16:19], a[152:155], v[148:151]
    buffer_load_dwordx4 v2, s[4:7], s61 offen offset:1024 lds
    v_mfma_f32_16x16x32_bf16 v[156:159], v[16:19], a[156:159], v[156:159]
    s_waitcnt lgkmcnt(3)
    v_mfma_f32_16x16x32_bf16 v[128:131], v[20:23], a[160:163], v[128:131]
    ds_read_b128 v[12:15], v4 offset:7168
    v_mfma_f32_16x16x32_bf16 v[136:139], v[20:23], a[164:167], v[136:139]
    v_mfma_f32_16x16x32_bf16 v[144:147], v[20:23], a[168:171], v[144:147]
    buffer_load_dwordx4 v2, s[4:7], s61 offen offset:2048 lds
    v_mfma_f32_16x16x32_bf16 v[152:155], v[20:23], a[172:175], v[152:155]
    s_waitcnt lgkmcnt(3)
    v_mfma_f32_16x16x32_bf16 v[132:135], v[24:27], a[160:163], v[132:135]
    ds_read_b128 v[16:19], v4 offset:8192
    v_mfma_f32_16x16x32_bf16 v[140:143], v[24:27], a[164:167], v[140:143]
    v_mfma_f32_16x16x32_bf16 v[148:151], v[24:27], a[168:171], v[148:151]
    buffer_load_dwordx4 v2, s[4:7], s61 offen offset:3072 lds
    v_mfma_f32_16x16x32_bf16 v[156:159], v[24:27], a[172:175], v[156:159]
    s_waitcnt lgkmcnt(3)
    s_add_u32 s61, s49, 100352
    s_add_u32 m0, s61, 18432
    v_mfma_f32_16x16x32_bf16 v[128:131], v[28:31], a[176:179], v[128:131]
    s_add_u32 s61, s61, s62
    ds_read_b128 v[20:23], v4 offset:9216
    v_mfma_f32_16x16x32_bf16 v[136:139], v[28:31], a[180:183], v[136:139]
    v_mfma_f32_16x16x32_bf16 v[144:147], v[28:31], a[184:187], v[144:147]
    buffer_load_dwordx4 v2, s[4:7], s61 offen offset:0 lds
    v_mfma_f32_16x16x32_bf16 v[152:155], v[28:31], a[188:191], v[152:155]
    s_waitcnt lgkmcnt(3)
    v_mfma_f32_16x16x32_bf16 v[132:135], v[8:11], a[176:179], v[132:135]
    ds_read_b128 v[24:27], v4 offset:10240
    v_mfma_f32_16x16x32_bf16 v[140:143], v[8:11], a[180:183], v[140:143]
    v_mfma_f32_16x16x32_bf16 v[148:151], v[8:11], a[184:187], v[148:151]
    v_mfma_f32_16x16x32_bf16 v[156:159], v[8:11], a[188:191], v[156:159]
    s_waitcnt lgkmcnt(3)
    v_mfma_f32_16x16x32_bf16 v[128:131], v[12:15], a[192:195], v[128:131]
    ds_read_b128 v[28:31], v4 offset:11264
    v_mfma_f32_16x16x32_bf16 v[136:139], v[12:15], a[196:199], v[136:139]
    v_mfma_f32_16x16x32_bf16 v[144:147], v[12:15], a[200:203], v[144:147]
    v_mfma_f32_16x16x32_bf16 v[152:155], v[12:15], a[204:207], v[152:155]
    s_waitcnt lgkmcnt(3)
    v_mfma_f32_16x16x32_bf16 v[132:135], v[16:19], a[192:195], v[132:135]
    ds_read_b128 v[8:11], v4 offset:12288
    v_mfma_f32_16x16x32_bf16 v[140:143], v[16:19], a[196:199], v[140:143]
    v_mfma_f32_16x16x32_bf16 v[148:151], v[16:19], a[200:203], v[148:151]
    v_mfma_f32_16x16x32_bf16 v[156:159], v[16:19], a[204:207], v[156:159]
    s_waitcnt lgkmcnt(3)
    v_mfma_f32_16x16x32_bf16 v[160:163], v[20:23], a[64:67], v[160:163]
    ds_read_b128 v[12:15], v4 offset:13312
    v_mfma_f32_16x16x32_bf16 v[164:167], v[20:23], a[68:71], v[164:167]
    v_mfma_f32_16x16x32_bf16 v[168:171], v[20:23], a[72:75], v[168:171]
    v_mfma_f32_16x16x32_bf16 v[172:175], v[20:23], a[76:79], v[172:175]
    s_waitcnt lgkmcnt(3)
    v_cvt_pk_bf16_f32 v128, v128, v129
    v_cvt_pk_bf16_f32 v129, v130, v131
    v_mfma_f32_16x16x32_bf16 v[160:163], v[24:27], a[80:83], v[160:163]
    ds_read_b128 v[16:19], v4 offset:14336
    v_cvt_pk_bf16_f32 v130, v132, v133
    v_mfma_f32_16x16x32_bf16 v[164:167], v[24:27], a[84:87], v[164:167]
    v_cvt_pk_bf16_f32 v131, v134, v135
    v_mfma_f32_16x16x32_bf16 v[168:171], v[24:27], a[88:91], v[168:171]
    s_add_u32 s70, s69, 3072
    v_mfma_f32_16x16x32_bf16 v[172:175], v[24:27], a[92:95], v[172:175]
    s_waitcnt lgkmcnt(3)
    v_mfma_f32_16x16x32_bf16 v[160:163], v[28:31], a[96:99], v[160:163]
    ds_read_b128 v[20:23], v4 offset:15360
    v_mfma_f32_16x16x32_bf16 v[164:167], v[28:31], a[100:103], v[164:167]
    buffer_store_dwordx4 v[128:131], v2, s[4:7], s70 offen sc1
    v_mfma_f32_16x16x32_bf16 v[168:171], v[28:31], a[104:107], v[168:171]
    v_cvt_pk_bf16_f32 v136, v136, v137
    v_cvt_pk_bf16_f32 v137, v138, v139
    v_mfma_f32_16x16x32_bf16 v[172:175], v[28:31], a[108:111], v[172:175]
    s_waitcnt lgkmcnt(3)
    v_cvt_pk_bf16_f32 v138, v140, v141
    v_cvt_pk_bf16_f32 v139, v142, v143
    v_mfma_f32_16x16x32_bf16 v[160:163], v[8:11], a[112:115], v[160:163]
    s_add_u32 s70, s69, 21504
    ds_read_b128 v[24:27], v4 offset:16384
    v_mfma_f32_16x16x32_bf16 v[164:167], v[8:11], a[116:119], v[164:167]
    buffer_store_dwordx4 v[136:139], v2, s[4:7], s70 offen sc1
    v_mfma_f32_16x16x32_bf16 v[168:171], v[8:11], a[120:123], v[168:171]
    v_cvt_pk_bf16_f32 v144, v144, v145
    v_cvt_pk_bf16_f32 v145, v146, v147
    v_mfma_f32_16x16x32_bf16 v[172:175], v[8:11], a[124:127], v[172:175]
    s_waitcnt lgkmcnt(3)
    v_cvt_pk_bf16_f32 v146, v148, v149
    v_cvt_pk_bf16_f32 v147, v150, v151
    v_mfma_f32_16x16x32_bf16 v[160:163], v[12:15], a[128:131], v[160:163]
    s_add_u32 s70, s69, 39936
    ds_read_b128 v[28:31], v4 offset:17408
    v_mfma_f32_16x16x32_bf16 v[164:167], v[12:15], a[132:135], v[164:167]
    buffer_store_dwordx4 v[144:147], v2, s[4:7], s70 offen sc1
    v_mfma_f32_16x16x32_bf16 v[168:171], v[12:15], a[136:139], v[168:171]
    v_cvt_pk_bf16_f32 v152, v152, v153
    v_cvt_pk_bf16_f32 v153, v154, v155
    v_mfma_f32_16x16x32_bf16 v[172:175], v[12:15], a[140:143], v[172:175]
    s_waitcnt lgkmcnt(3)
    v_cvt_pk_bf16_f32 v154, v156, v157
    v_cvt_pk_bf16_f32 v155, v158, v159
    v_mfma_f32_16x16x32_bf16 v[160:163], v[16:19], a[144:147], v[160:163]
    s_add_u32 s70, s69, 58368
    v_mfma_f32_16x16x32_bf16 v[164:167], v[16:19], a[148:151], v[164:167]
    buffer_store_dwordx4 v[152:155], v2, s[4:7], s70 offen sc1
    v_mfma_f32_16x16x32_bf16 v[168:171], v[16:19], a[152:155], v[168:171]
    v_mfma_f32_16x16x32_bf16 v[172:175], v[16:19], a[156:159], v[172:175]
    s_waitcnt lgkmcnt(2)
    v_mfma_f32_16x16x32_bf16 v[160:163], v[20:23], a[160:163], v[160:163]
    v_mfma_f32_16x16x32_bf16 v[164:167], v[20:23], a[164:167], v[164:167]
    v_mfma_f32_16x16x32_bf16 v[168:171], v[20:23], a[168:171], v[168:171]
    v_mfma_f32_16x16x32_bf16 v[172:175], v[20:23], a[172:175], v[172:175]
    s_waitcnt lgkmcnt(1)
    v_mfma_f32_16x16x32_bf16 v[160:163], v[24:27], a[176:179], v[160:163]
    v_mfma_f32_16x16x32_bf16 v[164:167], v[24:27], a[180:183], v[164:167]
    v_mfma_f32_16x16x32_bf16 v[168:171], v[24:27], a[184:187], v[168:171]
    v_mfma_f32_16x16x32_bf16 v[172:175], v[24:27], a[188:191], v[172:175]
    s_waitcnt lgkmcnt(0)
    v_mfma_f32_16x16x32_bf16 v[160:163], v[28:31], a[192:195], v[160:163]
    v_mfma_f32_16x16x32_bf16 v[164:167], v[28:31], a[196:199], v[164:167]
    v_mfma_f32_16x16x32_bf16 v[168:171], v[28:31], a[200:203], v[168:171]
    v_mfma_f32_16x16x32_bf16 v[172:175], v[28:31], a[204:207], v[172:175]
    s_nop 4
    v_cvt_pk_bf16_f32 v160, v160, v161
    v_cvt_pk_bf16_f32 v161, v162, v163
    s_add_u32 s70, s68, 4096
    buffer_store_dwordx2 v[160:161], v0, s[4:7], s70 offen sc1
    v_cvt_pk_bf16_f32 v164, v164, v165
    v_cvt_pk_bf16_f32 v165, v166, v167
    s_add_u32 s70, s68, 22528
    buffer_store_dwordx2 v[164:165], v0, s[4:7], s70 offen sc1
    v_cvt_pk_bf16_f32 v168, v168, v169
    v_cvt_pk_bf16_f32 v169, v170, v171
    s_add_u32 s70, s68, 40960
    buffer_store_dwordx2 v[168:169], v0, s[4:7], s70 offen sc1
    v_cvt_pk_bf16_f32 v172, v172, v173
    v_cvt_pk_bf16_f32 v173, v174, v175
    s_add_u32 s70, s68, 59392
    buffer_store_dwordx2 v[172:173], v0, s[4:7], s70 offen sc1
    s_lshl_b32 s60, s44, 2
    s_add_u32 s60, s60, s20
    s_lshl_b32 s60, s60, 5
    s_add_u32 s60, s60, s47
    s_lshl_b32 s60, s60, 3
    s_add_u32 s60, s60, s101
    s_add_u32 s60, s60, 4046848
    v_mov_b32 v6, s98
    v_mov_b32 v7, s99
    s_waitcnt vmcnt(0)
    s_mov_b64 exec, 1
    buffer_store_dwordx2 v[6:7], off, s[4:7], s60 sc1
    s_mov_b64 exec, -1
    s_cmp_lg_u32 s101, 0
    s_cbranch_scc1 L_red1_45
    s_barrier
    s_lshl_b32 s47, s21, 5
    s_add_u32 s47, s47, s22
    v_and_b32 v8, 7, v1
    v_lshrrev_b32 v9, 3, v1
    s_lshl_b32 s48, s47, 3
    v_add_u32 v3, s48, v8
    v_mul_u32_u24 v3, 1152, v3
    s_mul_i32 s48, s20, 384
    v_lshl_add_u32 v3, v9, 4, v3
    v_add_u32 v3, s48, v3
    s_lshr_b32 s48, s47, 1
    s_mul_i32 s48, s48, 18432
    s_and_b32 s49, s47, 1
    s_lshl_b32 s49, s49, 7
    s_add_u32 s48, s48, s49
    s_mul_i32 s49, s20, 6144
    s_add_u32 s48, s48, s49
    v_lshlrev_b32 v8, 4, v8
    v_lshl_add_u32 v8, v9, 8, v8
    v_add_u32 v4, s48, v8
    v_lshrrev_b32 v8, 3, v1
    v_and_b32 v9, 7, v1
    s_and_b32 s48, s47, 1
    s_lshl_b32 s48, s48, 3
    v_add_u32 v9, s48, v9
    v_lshlrev_b32 v9, 4, v9
    v_bfe_u32 v10, v8, 1, 1
    v_and_b32 v11, 1, v8
    v_lshl_add_u32 v9, v11, 4, v9
    v_lshl_add_u32 v9, v10, 9, v9
    v_and_b32 v10, 3, v8
    v_lshlrev_b32 v10, 8, v10
    v_sub_u32 v9, v9, v10
    s_mul_i32 s48, s20, 6
    v_lshrrev_b32 v8, 2, v8
    v_add_u32 v8, s48, v8
    v_add_u32 v10, 0, v8
    v_cmp_eq_u32 vcc, 4, v10
    v_cmp_eq_u32 s[56:57], 13, v10
    s_nop 0
    s_or_b64 vcc, vcc, s[56:57]
    v_cndmask_b32 v10, 0, v9, vcc
    v_add3_u32 v5, v4, v10, 0
    v_add_u32 v5, 0, v5
    v_add_u32 v10, 2, v8
    v_cmp_eq_u32 vcc, 4, v10
    v_cmp_eq_u32 s[56:57], 13, v10
    s_nop 0
    s_or_b64 vcc, vcc, s[56:57]
    v_cndmask_b32 v10, 0, v9, vcc
    v_add3_u32 v6, v4, v10, 0
    v_add_u32 v6, 2048, v6
    v_add_u32 v10, 4, v8
    v_cmp_eq_u32 vcc, 4, v10
    v_cmp_eq_u32 s[56:57], 13, v10
    s_nop 0
    s_or_b64 vcc, vcc, s[56:57]
    v_cndmask_b32 v10, 0, v9, vcc
    v_add3_u32 v7, v4, v10, 0
    v_add_u32 v7, 4096, v7
    s_cmp_eq_u32 s20, 3
    s_cbranch_scc1 L_w3a_95
    s_mov_b32 s48, 25690112
    buffer_load_dwordx4 v[16:19], v4, s[4:7], s48 offen offset:0 sc1
    buffer_load_dwordx4 v[52:55], v4, s[4:7], s48 offen offset:2048 sc1
    s_add_u32 s48, s48, 4096
    buffer_load_dwordx4 v[88:91], v4, s[4:7], s48 offen offset:0 sc1
    s_lshr_b32 s49, s47, 3
    s_lshl_b32 s49, s49, 8
    s_add_u32 s49, s49, 4046848
    v_and_b32 v10, 31, v1
    v_lshlrev_b32 v10, 3, v10
    buffer_load_dwordx2 v[8:9], v10, s[4:7], s49 offen sc1
    s_waitcnt vmcnt(0)
    v_cmp_eq_u64 vcc, s[98:99], v[8:9]
    s_nop 0
    s_cmp_eq_u64 vcc, exec
    s_cbranch_scc0 L_pp_slow_96
L_pp_back_97:
    s_mov_b32 s48, 50331648
    buffer_load_dwordx4 v[20:23], v5, s[4:7], s48 offen sc1
    buffer_load_dwordx4 v[56:59], v6, s[4:7], s48 offen sc1
    buffer_load_dwordx4 v[92:95], v7, s[4:7], s48 offen sc1
    s_mov_b32 s48, 52690944
    buffer_load_dwordx4 v[24:27], v5, s[4:7], s48 offen sc1
    buffer_load_dwordx4 v[60:63], v6, s[4:7], s48 offen sc1
    buffer_load_dwordx4 v[96:99], v7, s[4:7], s48 offen sc1
    s_mov_b32 s48, 55050240
    buffer_load_dwordx4 v[28:31], v5, s[4:7], s48 offen sc1
    buffer_load_dwordx4 v[64:67], v6, s[4:7], s48 offen sc1
    buffer_load_dwordx4 v[100:103], v7, s[4:7], s48 offen sc1
    s_mov_b32 s48, 57409536
    buffer_load_dwordx4 v[32:35], v5, s[4:7], s48 offen sc1
    buffer_load_dwordx4 v[68:71], v6, s[4:7], s48 offen sc1
    buffer_load_dwordx4 v[104:107], v7, s[4:7], s48 offen sc1
    s_mov_b32 s48, 59768832
    buffer_load_dwordx4 v[36:39], v5, s[4:7], s48 offen sc1
    buffer_load_dwordx4 v[72:75], v6, s[4:7], s48 offen sc1
    buffer_load_dwordx4 v[108:111], v7, s[4:7], s48 offen sc1
    s_mov_b32 s48, 62128128
    buffer_load_dwordx4 v[40:43], v5, s[4:7], s48 offen sc1
    buffer_load_dwordx4 v[76:79], v6, s[4:7], s48 offen sc1
    buffer_load_dwordx4 v[112:115], v7, s[4:7], s48 offen sc1
    s_mov_b32 s48, 64487424
    buffer_load_dwordx4 v[44:47], v5, s[4:7], s48 offen sc1
    buffer_load_dwordx4 v[80:83], v6, s[4:7], s48 offen sc1
    buffer_load_dwordx4 v[116:119], v7, s[4:7], s48 offen sc1
    s_mov_b32 s48, 66846720
    buffer_load_dwordx4 v[48:51], v5, s[4:7], s48 offen sc1
    buffer_load_dwordx4 v[84:87], v6, s[4:7], s48 offen sc1
    buffer_load_dwordx4 v[120:123], v7, s[4:7], s48 offen sc1
    v_lshlrev_b32 v128, 16, v16
    v_and_b32 v129, 0xffff0000, v16
    v_lshlrev_b32 v130, 16, v17
    v_and_b32 v131, 0xffff0000, v17
    v_lshlrev_b32 v132, 16, v18
    v_and_b32 v133, 0xffff0000, v18
    v_lshlrev_b32 v134, 16, v19
    v_and_b32 v135, 0xffff0000, v19
    v_lshlrev_b32 v136, 16, v52
    v_and_b32 v137, 0xffff0000, v52
    v_lshlrev_b32 v138, 16, v53
    v_and_b32 v139, 0xffff0000, v53
    v_lshlrev_b32 v140, 16, v54
    v_and_b32 v141, 0xffff0000, v54
    v_lshlrev_b32 v142, 16, v55
    v_and_b32 v143, 0xffff0000, v55
    v_lshlrev_b32 v144, 16, v88
    v_and_b32 v145, 0xffff0000, v88
    v_lshlrev_b32 v146, 16, v89
    v_and_b32 v147, 0xffff0000, v89
    v_lshlrev_b32 v148, 16, v90
    v_and_b32 v149, 0xffff0000, v90
    v_lshlrev_b32 v150, 16, v91
    v_and_b32 v151, 0xffff0000, v91
    v_mov_b32 v12, 0x3f80
    v_mov_b32 v13, 0x3f800000
    s_waitcnt vmcnt(23)
    v_dot2c_f32_bf16 v128, v20, v12
    v_dot2c_f32_bf16 v129, v20, v13
    v_dot2c_f32_bf16 v130, v21, v12
    v_dot2c_f32_bf16 v131, v21, v13
    v_dot2c_f32_bf16 v132, v22, v12
    v_dot2c_f32_bf16 v133, v22, v13
    v_dot2c_f32_bf16 v134, v23, v12
    v_dot2c_f32_bf16 v135, v23, v13
    s_waitcnt vmcnt(22)
    v_dot2c_f32_bf16 v136, v56, v12
    v_dot2c_f32_bf16 v137, v56, v13
    v_dot2c_f32_bf16 v138, v57, v12
    v_dot2c_f32_bf16 v139, v57, v13
    v_dot2c_f32_bf16 v140, v58, v12
    v_dot2c_f32_bf16 v141, v58, v13
    v_dot2c_f32_bf16 v142, v59, v12
    v_dot2c_f32_bf16 v143, v59, v13
    s_waitcnt vmcnt(21)
    v_dot2c_f32_bf16 v144, v92, v12
    v_dot2c_f32_bf16 v145, v92, v13
    v_dot2c_f32_bf16 v146, v93, v12
    v_dot2c_f32_bf16 v147, v93, v13
    v_dot2c_f32_bf16 v148, v94, v12
    v_dot2c_f32_bf16 v149, v94, v13
    v_dot2c_f32_bf16 v150, v95, v12
    v_dot2c_f32_bf16 v151, v95, v13
    s_waitcnt vmcnt(20)
    v_dot2c_f32_bf16 v128, v24, v12
    v_dot2c_f32_bf16 v129, v24, v13
    v_dot2c_f32_bf16 v130, v25, v12
    v_dot2c_f32_bf16 v131, v25, v13
    v_dot2c_f32_bf16 v132, v26, v12
    v_dot2c_f32_bf16 v133, v26, v13
    v_dot2c_f32_bf16 v134, v27, v12
    v_dot2c_f32_bf16 v135, v27, v13
    s_waitcnt vmcnt(19)
    v_dot2c_f32_bf16 v136, v60, v12
    v_dot2c_f32_bf16 v137, v60, v13
    v_dot2c_f32_bf16 v138, v61, v12
    v_dot2c_f32_bf16 v139, v61, v13
    v_dot2c_f32_bf16 v140, v62, v12
    v_dot2c_f32_bf16 v141, v62, v13
    v_dot2c_f32_bf16 v142, v63, v12
    v_dot2c_f32_bf16 v143, v63, v13
    s_waitcnt vmcnt(18)
    v_dot2c_f32_bf16 v144, v96, v12
    v_dot2c_f32_bf16 v145, v96, v13
    v_dot2c_f32_bf16 v146, v97, v12
    v_dot2c_f32_bf16 v147, v97, v13
    v_dot2c_f32_bf16 v148, v98, v12
    v_dot2c_f32_bf16 v149, v98, v13
    v_dot2c_f32_bf16 v150, v99, v12
    v_dot2c_f32_bf16 v151, v99, v13
    s_waitcnt vmcnt(17)
    v_dot2c_f32_bf16 v128, v28, v12
    v_dot2c_f32_bf16 v129, v28, v13
    v_dot2c_f32_bf16 v130, v29, v12
    v_dot2c_f32_bf16 v131, v29, v13
    v_dot2c_f32_bf16 v132, v30, v12
    v_dot2c_f32_bf16 v133, v30, v13
    v_dot2c_f32_bf16 v134, v31, v12
    v_dot2c_f32_bf16 v135, v31, v13
    s_waitcnt vmcnt(16)
    v_dot2c_f32_bf16 v136, v64, v12
    v_dot2c_f32_bf16 v137, v64, v13
    v_dot2c_f32_bf16 v138, v65, v12
    v_dot2c_f32_bf16 v139, v65, v13
    v_dot2c_f32_bf16 v140, v66, v12
    v_dot2c_f32_bf16 v141, v66, v13
    v_dot2c_f32_bf16 v142, v67, v12
    v_dot2c_f32_bf16 v143, v67, v13
    s_waitcnt vmcnt(15)
    v_dot2c_f32_bf16 v144, v100, v12
    v_dot2c_f32_bf16 v145, v100, v13
    v_dot2c_f32_bf16 v146, v101, v12
    v_dot2c_f32_bf16 v147, v101, v13
    v_dot2c_f32_bf16 v148, v102, v12
    v_dot2c_f32_bf16 v149, v102, v13
    v_dot2c_f32_bf16 v150, v103, v12
    v_dot2c_f32_bf16 v151, v103, v13
    s_waitcnt vmcnt(14)
    v_dot2c_f32_bf16 v128, v32, v12
    v_dot2c_f32_bf16 v129, v32, v13
    v_dot2c_f32_bf16 v130, v33, v12
    v_dot2c_f32_bf16 v131, v33, v13
    v_dot2c_f32_bf16 v132, v34, v12
    v_dot2c_f32_bf16 v133, v34, v13
    v_dot2c_f32_bf16 v134, v35, v12
    v_dot2c_f32_bf16 v135, v35, v13
    s_waitcnt vmcnt(13)
    v_dot2c_f32_bf16 v136, v68, v12
    v_dot2c_f32_bf16 v137, v68, v13
    v_dot2c_f32_bf16 v138, v69, v12
    v_dot2c_f32_bf16 v139, v69, v13
    v_dot2c_f32_bf16 v140, v70, v12
    v_dot2c_f32_bf16 v141, v70, v13
    v_dot2c_f32_bf16 v142, v71, v12
    v_dot2c_f32_bf16 v143, v71, v13
    s_waitcnt vmcnt(12)
    v_dot2c_f32_bf16 v144, v104, v12
    v_dot2c_f32_bf16 v145, v104, v13
    v_dot2c_f32_bf16 v146, v105, v12
    v_dot2c_f32_bf16 v147, v105, v13
    v_dot2c_f32_bf16 v148, v106, v12
    v_dot2c_f32_bf16 v149, v106, v13
    v_dot2c_f32_bf16 v150, v107, v12
    v_dot2c_f32_bf16 v151, v107, v13
    s_waitcnt vmcnt(11)
    v_dot2c_f32_bf16 v128, v36, v12
    v_dot2c_f32_bf16 v129, v36, v13
    v_dot2c_f32_bf16 v130, v37, v12
    v_dot2c_f32_bf16 v131, v37, v13
    v_dot2c_f32_bf16 v132, v38, v12
    v_dot2c_f32_bf16 v133, v38, v13
    v_dot2c_f32_bf16 v134, v39, v12
    v_dot2c_f32_bf16 v135, v39, v13
    s_waitcnt vmcnt(10)
    v_dot2c_f32_bf16 v136, v72, v12
    v_dot2c_f32_bf16 v137, v72, v13
    v_dot2c_f32_bf16 v138, v73, v12
    v_dot2c_f32_bf16 v139, v73, v13
    v_dot2c_f32_bf16 v140, v74, v12
    v_dot2c_f32_bf16 v141, v74, v13
    v_dot2c_f32_bf16 v142, v75, v12
    v_dot2c_f32_bf16 v143, v75, v13
    s_waitcnt vmcnt(9)
    v_dot2c_f32_bf16 v144, v108, v12
    v_dot2c_f32_bf16 v145, v108, v13
    v_dot2c_f32_bf16 v146, v109, v12
    v_dot2c_f32_bf16 v147, v109, v13
    v_dot2c_f32_bf16 v148, v110, v12
    v_dot2c_f32_bf16 v149, v110, v13
    v_dot2c_f32_bf16 v150, v111, v12
    v_dot2c_f32_bf16 v151, v111, v13
    s_waitcnt vmcnt(8)
    v_dot2c_f32_bf16 v128, v40, v12
    v_dot2c_f32_bf16 v129, v40, v13
    v_dot2c_f32_bf16 v130, v41, v12
    v_dot2c_f32_bf16 v131, v41, v13
    v_dot2c_f32_bf16 v132, v42, v12
    v_dot2c_f32_bf16 v133, v42, v13
    v_dot2c_f32_bf16 v134, v43, v12
    v_dot2c_f32_bf16 v135, v43, v13
    s_waitcnt vmcnt(7)
    v_dot2c_f32_bf16 v136, v76, v12
    v_dot2c_f32_bf16 v137, v76, v13
    v_dot2c_f32_bf16 v138, v77, v12
    v_dot2c_f32_bf16 v139, v77, v13
    v_dot2c_f32_bf16 v140, v78, v12
    v_dot2c_f32_bf16 v141, v78, v13
    v_dot2c_f32_bf16 v142, v79, v12
    v_dot2c_f32_bf16 v143, v79, v13
    s_waitcnt vmcnt(6)
    v_dot2c_f32_bf16 v144, v112, v12
    v_dot2c_f32_bf16 v145, v112, v13
    v_dot2c_f32_bf16 v146, v113, v12
    v_dot2c_f32_bf16 v147, v113, v13
    v_dot2c_f32_bf16 v148, v114, v12
    v_dot2c_f32_bf16 v149, v114, v13
    v_dot2c_f32_bf16 v150, v115, v12
    v_dot2c_f32_bf16 v151, v115, v13
    s_waitcnt vmcnt(5)
    v_dot2c_f32_bf16 v128, v44, v12
    v_dot2c_f32_bf16 v129, v44, v13
    v_dot2c_f32_bf16 v130, v45, v12
    v_dot2c_f32_bf16 v131, v45, v13
    v_dot2c_f32_bf16 v132, v46, v12
    v_dot2c_f32_bf16 v133, v46, v13
    v_dot2c_f32_bf16 v134, v47, v12
    v_dot2c_f32_bf16 v135, v47, v13
    s_waitcnt vmcnt(4)
    v_dot2c_f32_bf16 v136, v80, v12
    v_dot2c_f32_bf16 v137, v80, v13
    v_dot2c_f32_bf16 v138, v81, v12
    v_dot2c_f32_bf16 v139, v81, v13
    v_dot2c_f32_bf16 v140, v82, v12
    v_dot2c_f32_bf16 v141, v82, v13
    v_dot2c_f32_bf16 v142, v83, v12
    v_dot2c_f32_bf16 v143, v83, v13
    s_waitcnt vmcnt(3)
    v_dot2c_f32_bf16 v144, v116, v12
    v_dot2c_f32_bf16 v145, v116, v13
    v_dot2c_f32_bf16 v146, v117, v12
    v_dot2c_f32_bf16 v147, v117, v13
    v_dot2c_f32_bf16 v148, v118, v12
    v_dot2c_f32_bf16 v149, v118, v13
    v_dot2c_f32_bf16 v150, v119, v12
    v_dot2c_f32_bf16 v151, v119, v13
    s_waitcnt vmcnt(2)
    v_dot2c_f32_bf16 v128, v48, v12
    v_dot2c_f32_bf16 v129, v48, v13
    v_dot2c_f32_bf16 v130, v49, v12
    v_dot2c_f32_bf16 v131, v49, v13
    v_dot2c_f32_bf16 v132, v50, v12
    v_dot2c_f32_bf16 v133, v50, v13
    v_dot2c_f32_bf16 v134, v51, v12
    v_dot2c_f32_bf16 v135, v51, v13
    s_waitcnt vmcnt(1)
    v_dot2c_f32_bf16 v136, v84, v12
    v_dot2c_f32_bf16 v137, v84, v13
    v_dot2c_f32_bf16 v138, v85, v12
    v_dot2c_f32_bf16 v139, v85, v13
    v_dot2c_f32_bf16 v140, v86, v12
    v_dot2c_f32_bf16 v141, v86, v13
    v_dot2c_f32_bf16 v142, v87, v12
    v_dot2c_f32_bf16 v143, v87, v13
    s_waitcnt vmcnt(0)
    v_dot2c_f32_bf16 v144, v120, v12
    v_dot2c_f32_bf16 v145, v120, v13
    v_dot2c_f32_bf16 v146, v121, v12
    v_dot2c_f32_bf16 v147, v121, v13
    v_dot2c_f32_bf16 v148, v122, v12
    v_dot2c_f32_bf16 v149, v122, v13
    v_dot2c_f32_bf16 v150, v123, v12
    v_dot2c_f32_bf16 v151, v123, v13
    s_add_u32 s16, s42, 28311552
    s_addc_u32 s17, s43, 0
    s_mov_b32 s18, 0x240000
    s_mov_b32 s19, 0x20000
    v_cvt_pk_bf16_f32 v160, v128, v129
    v_cvt_pk_bf16_f32 v161, v130, v131
    v_cvt_pk_bf16_f32 v162, v132, v133
    v_cvt_pk_bf16_f32 v163, v134, v135
    buffer_store_dwordx4 v[160:163], v3, s[16:19], 0 offen offset:0 sc1
    v_cvt_pk_bf16_f32 v164, v136, v137
    v_cvt_pk_bf16_f32 v165, v138, v139
    v_cvt_pk_bf16_f32 v166, v140, v141
    v_cvt_pk_bf16_f32 v167, v142, v143
    buffer_store_dwordx4 v[164:167], v3, s[16:19], 0 offen offset:128 sc1
    v_cvt_pk_bf16_f32 v168, v144, v145
    v_cvt_pk_bf16_f32 v169, v146, v147
    v_cvt_pk_bf16_f32 v170, v148, v149
    v_cvt_pk_bf16_f32 v171, v150, v151
    buffer_store_dwordx4 v[168:171], v3, s[16:19], 0 offen offset:256 sc1
    v_lshlrev_b32 v128, 16, v160
    v_and_b32 v129, 0xffff0000, v160
    v_lshlrev_b32 v130, 16, v161
    v_and_b32 v131, 0xffff0000, v161
    v_lshlrev_b32 v132, 16, v162
    v_and_b32 v133, 0xffff0000, v162
    v_lshlrev_b32 v134, 16, v163
    v_and_b32 v135, 0xffff0000, v163
    v_lshlrev_b32 v136, 16, v164
    v_and_b32 v137, 0xffff0000, v164
    v_lshlrev_b32 v138, 16, v165
    v_and_b32 v139, 0xffff0000, v165
    v_lshlrev_b32 v140, 16, v166
    v_and_b32 v141, 0xffff0000, v166
    v_lshlrev_b32 v142, 16, v167
    v_and_b32 v143, 0xffff0000, v167
    v_lshlrev_b32 v144, 16, v168
    v_and_b32 v145, 0xffff0000, v168
    v_lshlrev_b32 v146, 16, v169
    v_and_b32 v147, 0xffff0000, v169
    v_lshlrev_b32 v148, 16, v170
    v_and_b32 v149, 0xffff0000, v170
    v_lshlrev_b32 v150, 16, v171
    v_and_b32 v151, 0xffff0000, v171
    v_add_f32 v152, v128, v129
    v_add_f32 v8, v130, v131
    v_add_f32 v152, v152, v132
    v_add_f32 v8, v8, v133
    v_add_f32 v152, v152, v134
    v_add_f32 v8, v8, v135
    v_add_f32 v152, v152, v136
    v_add_f32 v8, v8, v137
    v_add_f32 v152, v152, v138
    v_add_f32 v8, v8, v139
    v_add_f32 v152, v152, v140
    v_add_f32 v8, v8, v141
    v_add_f32 v152, v152, v142
    v_add_f32 v8, v8, v143
    v_add_f32 v152, v152, v144
    v_add_f32 v8, v8, v145
    v_add_f32 v152, v152, v146
    v_add_f32 v8, v8, v147
    v_add_f32 v152, v152, v148
    v_add_f32 v8, v8, v149
    v_add_f32 v152, v152, v150
    v_add_f32 v8, v8, v151
    v_add_f32 v152, v152, v8
    s_nop 1
    v_add_f32_dpp v152, v152, v152 row_ror:8 row_mask:0xf bank_mask:0xf
    v_mov_b32 v8, v152
    s_nop 1
    v_permlane16_swap_b32 v152, v8
    v_add_f32 v152, v152, v8
    v_mov_b32 v8, v152
    s_nop 1
    v_permlane32_swap_b32 v152, v8
    v_add_f32 v152, v152, v8
    v_mul_f32 v9, 0x3baaaaab, v152
    v_sub_f32 v8, v128, v9
    v_mul_f32 v153, v8, v8
    v_sub_f32 v11, v129, v9
    v_fmac_f32 v153, v11, v11
    v_sub_f32 v10, v130, v9
    v_fmac_f32 v153, v10, v10
    v_sub_f32 v11, v131, v9
    v_fmac_f32 v153, v11, v11
    v_sub_f32 v10, v132, v9
    v_fmac_f32 v153, v10, v10
    v_sub_f32 v11, v133, v9
    v_fmac_f32 v153, v11, v11
    v_sub_f32 v10, v134, v9
    v_fmac_f32 v153, v10, v10
    v_sub_f32 v11, v135, v9
    v_fmac_f32 v153, v11, v11
    v_sub_f32 v10, v136, v9
    v_fmac_f32 v153, v10, v10
    v_sub_f32 v11, v137, v9
    v_fmac_f32 v153, v11, v11
    v_sub_f32 v10, v138, v9
    v_fmac_f32 v153, v10, v10
    v_sub_f32 v11, v139, v9
    v_fmac_f32 v153, v11, v11
    v_sub_f32 v10, v140, v9
    v_fmac_f32 v153, v10, v10
    v_sub_f32 v11, v141, v9
    v_fmac_f32 v153, v11, v11
    v_sub_f32 v10, v142, v9
    v_fmac_f32 v153, v10, v10
    v_sub_f32 v11, v143, v9
    v_fmac_f32 v153, v11, v11
    v_sub_f32 v10, v144, v9
    v_fmac_f32 v153, v10, v10
    v_sub_f32 v11, v145, v9
    v_fmac_f32 v153, v11, v11
    v_sub_f32 v10, v146, v9
    v_fmac_f32 v153, v10, v10
    v_sub_f32 v11, v147, v9
    v_fmac_f32 v153, v11, v11
    v_sub_f32 v10, v148, v9
    v_fmac_f32 v153, v10, v10
    v_sub_f32 v11, v149, v9
    v_fmac_f32 v153, v11, v11
    v_sub_f32 v10, v150, v9
    v_fmac_f32 v153, v10, v10
    v_sub_f32 v11, v151, v9
    v_fmac_f32 v153, v11, v11
    s_nop 1
    v_add_f32_dpp v153, v153, v153 row_ror:8 row_mask:0xf bank_mask:0xf
    v_mov_b32 v8, v153
    s_nop 1
    v_permlane16_swap_b32 v153, v8
    v_add_f32 v153, v153, v8
    v_mov_b32 v8, v153
    s_nop 1
    v_permlane32_swap_b32 v153, v8
    v_add_f32 v153, v153, v8
    v_and_b32 v8, 7, v1
    s_mul_i32 s46, s20, 64
    s_add_u32 s46, s46, 160896
    v_lshl_add_u32 v8, v8, 3, s46
    ds_write_b64 v8, v[152:153]
    s_waitcnt lgkmcnt(0)
    s_branch L_join_99
L_w3a_95:
    s_and_b32 s44, s22, 15
    s_mul_i32 s44, s44, 129024
    s_add_u32 s44, s44, 0
    s_mov_b32 m0, 18432
    s_add_u32 s45, s44, 0
    buffer_load_dwordx4 v2, s[4:7], s45 offen offset:0 lds
    buffer_load_dwordx4 v2, s[4:7], s45 offen offset:1024 lds
    buffer_load_dwordx4 v2, s[4:7], s45 offen offset:2048 lds
    buffer_load_dwordx4 v2, s[4:7], s45 offen offset:3072 lds
    s_mov_b32 m0, 22528
    s_add_u32 s45, s44, 4096
    buffer_load_dwordx4 v2, s[4:7], s45 offen offset:0 lds
    buffer_load_dwordx4 v2, s[4:7], s45 offen offset:1024 lds
    buffer_load_dwordx4 v2, s[4:7], s45 offen offset:2048 lds
    buffer_load_dwordx4 v2, s[4:7], s45 offen offset:3072 lds
    s_mov_b32 m0, 26624
    s_add_u32 s45, s44, 8192
    buffer_load_dwordx4 v2, s[4:7], s45 offen offset:0 lds
    buffer_load_dwordx4 v2, s[4:7], s45 offen offset:1024 lds
    buffer_load_dwordx4 v2, s[4:7], s45 offen offset:2048 lds
    buffer_load_dwordx4 v2, s[4:7], s45 offen offset:3072 lds
    s_mov_b32 m0, 30720
    s_add_u32 s45, s44, 12288
    buffer_load_dwordx4 v2, s[4:7], s45 offen offset:0 lds
    buffer_load_dwordx4 v2, s[4:7], s45 offen offset:1024 lds
    buffer_load_dwordx4 v2, s[4:7], s45 offen offset:2048 lds
    buffer_load_dwordx4 v2, s[4:7], s45 offen offset:3072 lds
    s_mov_b32 m0, 34816
    s_add_u32 s45, s44, 16384
    buffer_load_dwordx4 v2, s[4:7], s45 offen offset:0 lds
    buffer_load_dwordx4 v2, s[4:7], s45 offen offset:1024 lds
    buffer_load_dwordx4 v2, s[4:7], s45 offen offset:2048 lds
    buffer_load_dwordx4 v2, s[4:7], s45 offen offset:3072 lds
    s_mov_b32 m0, 38912
    s_add_u32 s45, s44, 20480
    buffer_load_dwordx4 v2, s[4:7], s45 offen offset:0 lds
    buffer_load_dwordx4 v2, s[4:7], s45 offen offset:1024 lds
    buffer_load_dwordx4 v2, s[4:7], s45 offen offset:2048 lds
    buffer_load_dwordx4 v2, s[4:7], s45 offen offset:3072 lds
    s_mov_b32 m0, 43008
    s_add_u32 s45, s44, 24576
    buffer_load_dwordx4 v2, s[4:7], s45 offen offset:0 lds
    buffer_load_dwordx4 v2, s[4:7], s45 offen offset:1024 lds
    buffer_load_dwordx4 v2, s[4:7], s45 offen offset:2048 lds
    buffer_load_dwordx4 v2, s[4:7], s45 offen offset:3072 lds
    s_mov_b32 m0, 47104
    s_add_u32 s45, s44, 28672
    buffer_load_dwordx4 v2, s[4:7], s45 offen offset:0 lds
    buffer_load_dwordx4 v2, s[4:7], s45 offen offset:1024 lds
    buffer_load_dwordx4 v2, s[4:7], s45 offen offset:2048 lds
    buffer_load_dwordx4 v2, s[4:7], s45 offen offset:3072 lds
    s_mov_b32 m0, 51200
    s_add_u32 s45, s44, 32768
    buffer_load_dwordx4 v2, s[4:7], s45 offen offset:0 lds
    buffer_load_dwordx4 v2, s[4:7], s45 offen offset:1024 lds
    buffer_load_dwordx4 v2, s[4:7], s45 offen offset:2048 lds
    buffer_load_dwordx4 v2, s[4:7], s45 offen offset:3072 lds
L_join_99:
    s_barrier
    s_cmp_eq_u32 s20, 3
    s_cbranch_scc1 L_w3b_100
    v_and_b32 v8, 7, v1
    v_lshlrev_b32 v8, 3, v8
    v_add_u32 v8, 160896, v8
    ds_read_b64 v[152:153], v8 offset:0
    ds_read_b64 v[154:155], v8 offset:64
    ds_read_b64 v[156:157], v8 offset:128
    s_waitcnt lgkmcnt(1)
    v_add_f32 v8, v152, v154
    s_waitcnt lgkmcnt(0)
    v_add_f32 v8, v8, v156
    v_mul_f32 v8, 0x3ae38e39, v8
    v_add_f32 v9, v153, v155
    v_add_f32 v9, v9, v157
    v_mul_f32 v10, 0x3baaaaab, v152
    v_sub_f32 v10, v10, v8
    v_mul_f32 v10, v10, v10
    v_fmac_f32 v9, 0x43400000, v10
    v_mul_f32 v10, 0x3baaaaab, v154
    v_sub_f32 v10, v10, v8
    v_mul_f32 v10, v10, v10
    v_fmac_f32 v9, 0x43400000, v10
    v_mul_f32 v10, 0x3baaaaab, v156
    v_sub_f32 v10, v10, v8
    v_mul_f32 v10, v10, v10
    v_fmac_f32 v9, 0x43400000, v10
    v_mul_f32 v9, 0x3ae38e39, v9
    v_cvt_pk_bf16_f32 v9, v9, v9
    v_lshlrev_b32 v9, 16, v9
    v_add_f32 v9, 0x3727c5ac, v9
    v_cvt_pk_bf16_f32 v9, v9, v9
    v_lshlrev_b32 v9, 16, v9
    v_sqrt_f32 v9, v9
    s_nop 0
    v_cvt_pk_bf16_f32 v9, v9, v9
    v_lshlrev_b32 v9, 16, v9
    v_rcp_f32 v9, v9
    v_cvt_pk_bf16_f32 v8, v8, v8
    v_lshlrev_b32 v8, 16, v8
    v_sub_f32 v128, v128, v8
    v_sub_f32 v129, v129, v8
    v_cvt_pk_bf16_f32 v10, v128, v129
    v_lshlrev_b32 v128, 16, v10
    v_and_b32 v129, 0xffff0000, v10
    v_mul_f32 v128, v128, v9
    v_mul_f32 v129, v129, v9
    v_cvt_pk_bf16_f32 v16, v128, v129
    v_sub_f32 v130, v130, v8
    v_sub_f32 v131, v131, v8
    v_cvt_pk_bf16_f32 v10, v130, v131
    v_lshlrev_b32 v130, 16, v10
    v_and_b32 v131, 0xffff0000, v10
    v_mul_f32 v130, v130, v9
    v_mul_f32 v131, v131, v9
    v_cvt_pk_bf16_f32 v17, v130, v131
    v_sub_f32 v132, v132, v8
    v_sub_f32 v133, v133, v8
    v_cvt_pk_bf16_f32 v10, v132, v133
    v_lshlrev_b32 v132, 16, v10
    v_and_b32 v133, 0xffff0000, v10
    v_mul_f32 v132, v132, v9
    v_mul_f32 v133, v133, v9
    v_cvt_pk_bf16_f32 v18, v132, v133
    v_sub_f32 v134, v134, v8
    v_sub_f32 v135, v135, v8
    v_cvt_pk_bf16_f32 v10, v134, v135
    v_lshlrev_b32 v134, 16, v10
    v_and_b32 v135, 0xffff0000, v10
    v_mul_f32 v134, v134, v9
    v_mul_f32 v135, v135, v9
    v_cvt_pk_bf16_f32 v19, v134, v135
    v_sub_f32 v136, v136, v8
    v_sub_f32 v137, v137, v8
    v_cvt_pk_bf16_f32 v10, v136, v137
    v_lshlrev_b32 v136, 16, v10
    v_and_b32 v137, 0xffff0000, v10
    v_mul_f32 v136, v136, v9
    v_mul_f32 v137, v137, v9
    v_cvt_pk_bf16_f32 v20, v136, v137
    v_sub_f32 v138, v138, v8
    v_sub_f32 v139, v139, v8
    v_cvt_pk_bf16_f32 v10, v138, v139
    v_lshlrev_b32 v138, 16, v10
    v_and_b32 v139, 0xffff0000, v10
    v_mul_f32 v138, v138, v9
    v_mul_f32 v139, v139, v9
    v_cvt_pk_bf16_f32 v21, v138, v139
    v_sub_f32 v140, v140, v8
    v_sub_f32 v141, v141, v8
    v_cvt_pk_bf16_f32 v10, v140, v141
    v_lshlrev_b32 v140, 16, v10
    v_and_b32 v141, 0xffff0000, v10
    v_mul_f32 v140, v140, v9
    v_mul_f32 v141, v141, v9
    v_cvt_pk_bf16_f32 v22, v140, v141
    v_sub_f32 v142, v142, v8
    v_sub_f32 v143, v143, v8
    v_cvt_pk_bf16_f32 v10, v142, v143
    v_lshlrev_b32 v142, 16, v10
    v_and_b32 v143, 0xffff0000, v10
    v_mul_f32 v142, v142, v9
    v_mul_f32 v143, v143, v9
    v_cvt_pk_bf16_f32 v23, v142, v143
    v_sub_f32 v144, v144, v8
    v_sub_f32 v145, v145, v8
    v_cvt_pk_bf16_f32 v10, v144, v145
    v_lshlrev_b32 v144, 16, v10
    v_and_b32 v145, 0xffff0000, v10
    v_mul_f32 v144, v144, v9
    v_mul_f32 v145, v145, v9
    v_cvt_pk_bf16_f32 v24, v144, v145
    v_sub_f32 v146, v146, v8
    v_sub_f32 v147, v147, v8
    v_cvt_pk_bf16_f32 v10, v146, v147
    v_lshlrev_b32 v146, 16, v10
    v_and_b32 v147, 0xffff0000, v10
    v_mul_f32 v146, v146, v9
    v_mul_f32 v147, v147, v9
    v_cvt_pk_bf16_f32 v25, v146, v147
    v_sub_f32 v148, v148, v8
    v_sub_f32 v149, v149, v8
    v_cvt_pk_bf16_f32 v10, v148, v149
    v_lshlrev_b32 v148, 16, v10
    v_and_b32 v149, 0xffff0000, v10
    v_mul_f32 v148, v148, v9
    v_mul_f32 v149, v149, v9
    v_cvt_pk_bf16_f32 v26, v148, v149
    v_sub_f32 v150, v150, v8
    v_sub_f32 v151, v151, v8
    v_cvt_pk_bf16_f32 v10, v150, v151
    v_lshlrev_b32 v150, 16, v10
    v_and_b32 v151, 0xffff0000, v10
    v_mul_f32 v150, v150, v9
    v_mul_f32 v151, v151, v9
    v_cvt_pk_bf16_f32 v27, v150, v151
    s_mov_b32 s46, 71303168
    buffer_store_dwordx4 v[16:19], v4, s[4:7], s46 offen offset:0 sc1
    buffer_store_dwordx4 v[20:23], v4, s[4:7], s46 offen offset:2048 sc1
    s_add_u32 s46, s46, 4096
    buffer_store_dwordx4 v[24:27], v4, s[4:7], s46 offen offset:0 sc1
    s_lshl_b32 s46, s47, 2
    s_add_u32 s46, s46, s20
    s_lshl_b32 s46, s46, 3
    s_add_u32 s46, s46, 3940352
    v_mov_b32 v8, s98
    v_mov_b32 v9, s99
    s_waitcnt vmcnt(0)
    s_mov_b64 exec, 1
    buffer_store_dwordx2 v[8:9], off, s[4:7], s46 sc1
    s_mov_b64 exec, -1
L_w3b_100:
    s_lshr_b32 s44, s22, 4
    s_lshl_b32 s52, s21, 1
    s_add_u32 s44, s44, s52
    s_and_b32 s45, s22, 15
    s_mul_i32 s48, s20, 21
    s_lshr_b32 s48, s48, 1
    s_lshl_b32 s48, s48, 10
    s_mul_i32 s47, s45, 129024
    s_add_u32 s47, s47, s48
    s_add_u32 s47, s47, 0
    s_lshl_b32 s46, s44, 3
    s_max_u32 s52, s46, 1
    s_sub_u32 s52, s52, 1
    s_mul_i32 s49, s52, 18432
    s_mul_i32 s50, s20, 9
    s_lshr_b32 s50, s50, 1
    s_lshl_b32 s50, s50, 10
    s_add_u32 s49, s49, s50
    s_add_u32 s49, s49, 71303168
    s_add_u32 s50, s50, 0
    s_lshl_b32 s54, s52, 6
    s_lshl_b32 s52, s20, 1
    s_add_u32 s46, s46, s52
    s_mul_i32 s51, s46, 18432
    s_add_u32 s51, s51, 71303168
    s_lshl_b32 s55, s46, 6
    v_and_b32 v6, 3, v1
    v_min_u32 v6, 2, v6
    v_and_b32 v7, 12, v1
    v_add_lshl_u32 v8, v6, v7, 3
    v_add_u32 v8, s55, v8
    v_and_b32 v7, 4, v1
    v_add_lshl_u32 v9, v6, v7, 3
    v_add_u32 v9, s54, v9
    v_and_b32 v7, 16, v1
    v_cmp_eq_u32 vcc, 0, v7
    s_nop 1
    v_cndmask_b32 v8, v9, v8, vcc
    s_min_u32 s52, s22, 23
    s_mul_i32 s52, s52, 10923
    s_lshr_b32 s52, s52, 16
    s_lshl_b32 s53, s21, 2
    s_add_u32 s52, s52, s53
    s_lshl_b32 s52, s52, 2
    s_add_u32 s52, s52, s20
    s_lshl_b32 s52, s52, 6
    v_and_b32 v7, 4, v1
    v_add_lshl_u32 v7, v6, v7, 3
    v_add_u32 v7, s52, v7
    v_cmp_gt_u32 vcc, 32, v1
    s_nop 1
    v_cndmask_b32 v8, v7, v8, vcc
    s_mov_b32 s52, 3940352
    s_min_u32 s56, s20, 2
    s_add_u32 s57, s56, 2
    s_add_u32 s56, s56, 4
    s_cmp_ge_u32 s20, 2
    s_cselect_b32 s57, 6, s57
    s_lshl_b32 s57, s57, 10
    s_lshl_b32 s56, s56, 10
    v_add_u32 v3, 18432, v2
    v_add_u32 v4, s57, v3
    v_add_u32 v5, s56, v3
    v_add_u32 v10, 0, v2
    s_waitcnt vmcnt(0)
    s_waitcnt vmcnt(0)
    s_barrier
    ds_read_b128 v[88:91], v3 offset:0
    ds_read_b128 v[92:95], v3 offset:1024
    ds_read_b128 v[96:99], v3 offset:2048
    ds_read_b128 v[100:103], v3 offset:3072
    ds_read_b128 v[112:115], v3 offset:6144
    ds_read_b128 v[104:107], v3 offset:4096
    ds_read_b128 v[108:111], v3 offset:5120
    v_mov_b32 v11, v8
    s_mov_b32 s23, s52
    buffer_load_dwordx2 v[12:13], v11, s[4:7], s23 offen sc1
    v_and_b32 v6, 15, v1
    v_lshrrev_b32 v7, 4, v1
    v_lshlrev_b32 v7, 2, v7
    v_sub_u32 v6, v6, v7
    v_mov_b32 v8, 0xf149f2ca
    s_or_b32 s52, s44, s20
    s_cmp_eq_u32 s52, 0
    s_cselect_b64 s[56:57], -1, 0
    v_subrev_u32 v7, 0, v6
    v_and_b32 v9, 0xfffffff1, v7
    v_cmp_eq_u32 vcc, 0, v9
    v_add_u32 v7, 16, v7
    v_and_b32 v9, 0xfffffff1, v7
    v_cndmask_b32_e64 v168, v8, 0, vcc
    v_cmp_eq_u32 vcc, 0, v9
    s_nop 1
    v_cndmask_b32_e64 v172, v8, 0, vcc
    v_cndmask_b32_e64 v176, v172, v8, s[56:57]
    v_subrev_u32 v7, 1, v6
    v_and_b32 v9, 0xfffffff1, v7
    v_cmp_eq_u32 vcc, 0, v9
    v_add_u32 v7, 16, v7
    v_and_b32 v9, 0xfffffff1, v7
    v_cndmask_b32_e64 v169, v8, 0, vcc
    v_cmp_eq_u32 vcc, 0, v9
    s_nop 1
    v_cndmask_b32_e64 v173, v8, 0, vcc
    v_cndmask_b32_e64 v177, v173, v8, s[56:57]
    v_subrev_u32 v7, 2, v6
    v_and_b32 v9, 0xfffffff1, v7
    v_cmp_eq_u32 vcc, 0, v9
    v_add_u32 v7, 16, v7
    v_and_b32 v9, 0xfffffff1, v7
    v_cndmask_b32_e64 v170, v8, 0, vcc
    v_cmp_eq_u32 vcc, 0, v9
    s_nop 1
    v_cndmask_b32_e64 v174, v8, 0, vcc
    v_cndmask_b32_e64 v178, v174, v8, s[56:57]
    v_subrev_u32 v7, 3, v6
    v_and_b32 v9, 0xfffffff1, v7
    v_cmp_eq_u32 vcc, 0, v9
    v_add_u32 v7, 16, v7
    v_and_b32 v9, 0xfffffff1, v7
    v_cndmask_b32_e64 v171, v8, 0, vcc
    v_cmp_eq_u32 vcc, 0, v9
    s_nop 1
    v_cndmask_b32_e64 v175, v8, 0, vcc
    v_cndmask_b32_e64 v179, v175, v8, s[56:57]
    s_mul_i32 s53, s45, 2304
    s_add_u32 s53, s53, s51
    s_waitcnt vmcnt(0)
    v_cmp_eq_u64 vcc, s[98:99], v[12:13]
    s_nop 0
    s_cmp_eq_u64 vcc, exec
    s_cbranch_scc0 L_px_slow_101
L_px_back_102:
    s_add_u32 s54, s51, 0
    buffer_load_dwordx4 a[0:3], v2, s[4:7], s54 offen offset:0 sc1
    s_add_u32 s55, s51, 18432
    buffer_load_dwordx4 a[72:75], v2, s[4:7], s55 offen offset:0 sc1
    buffer_load_dwordx4 a[4:7], v2, s[4:7], s54 offen offset:1024 sc1
    buffer_load_dwordx4 a[76:79], v2, s[4:7], s55 offen offset:1024 sc1
    buffer_load_dwordx4 a[8:11], v2, s[4:7], s54 offen offset:2048 sc1
    buffer_load_dwordx4 a[80:83], v2, s[4:7], s55 offen offset:2048 sc1
    s_waitcnt vmcnt(5) lgkmcnt(6)
    s_add_u32 m0, s50, 0
    s_add_u32 s53, s49, 0
    v_mfma_f32_16x16x32_bf16 v[16:19], v[88:91], a[0:3], 0
    buffer_load_dwordx4 v2, s[4:7], s53 offen offset:0 sc1 lds
    s_waitcnt vmcnt(5)
    v_mfma_f32_16x16x32_bf16 v[48:51], v[88:91], a[72:75], 0
    s_waitcnt lgkmcnt(5)
    ds_read_b128 v[116:119], v3 offset:7168
    ds_read_b128 v[120:123], v3 offset:8192
    v_mfma_f32_16x16x32_bf16 v[20:23], v[92:95], a[0:3], 0
    v_mfma_f32_16x16x32_bf16 v[52:55], v[92:95], a[72:75], 0
    s_waitcnt lgkmcnt(6)
    ds_read_b128 v[124:127], v3 offset:9216
    v_mfma_f32_16x16x32_bf16 v[24:27], v[96:99], a[0:3], 0
    buffer_load_dwordx4 v2, s[4:7], s53 offen offset:1024 sc1 lds
    v_mfma_f32_16x16x32_bf16 v[56:59], v[96:99], a[72:75], 0
    s_waitcnt lgkmcnt(6)
    ds_read_b128 v[128:131], v3 offset:10240
    v_mfma_f32_16x16x32_bf16 v[28:31], v[100:103], a[0:3], 0
    v_mfma_f32_16x16x32_bf16 v[60:63], v[100:103], a[72:75], 0
    buffer_load_dwordx4 v2, s[4:7], s53 offen offset:2048 sc1 lds
    buffer_load_dwordx4 v2, s[4:7], s53 offen offset:3072 sc1 lds
    s_add_u32 m0, s50, 4096
    s_add_u32 s53, s49, 4096
    buffer_load_dwordx4 v2, s[4:7], s53 offen offset:0 sc1 lds
    buffer_load_dwordx4 a[12:15], v2, s[4:7], s54 offen offset:3072 sc1
    buffer_load_dwordx4 a[84:87], v2, s[4:7], s55 offen offset:3072 sc1
    s_waitcnt lgkmcnt(6)
    v_mfma_f32_16x16x32_bf16 v[32:35], v[112:115], a[0:3], 0
    s_add_u32 s54, s51, 4096
    ds_read_b128 v[140:143], v3 offset:13312
    v_mfma_f32_16x16x32_bf16 v[64:67], v[112:115], a[72:75], 0
    ds_read_b128 v[132:135], v3 offset:11264
    v_mfma_f32_16x16x32_bf16 v[44:47], a[0:3], v[112:115], 0
    v_mfma_f32_16x16x32_bf16 v[76:79], a[72:75], v[112:115], 0
    s_waitcnt lgkmcnt(7)
    ds_read_b128 v[136:139], v3 offset:12288
    v_mfma_f32_16x16x32_bf16 v[36:39], a[0:3], v[104:107], 0
    buffer_load_dwordx4 a[16:19], v2, s[4:7], s54 offen offset:0 sc1
    v_mfma_f32_16x16x32_bf16 v[68:71], a[72:75], v[104:107], 0
    s_waitcnt lgkmcnt(7)
    s_add_u32 s55, s51, 22528
    v_mfma_f32_16x16x32_bf16 v[40:43], a[0:3], v[108:111], 0
    v_mfma_f32_16x16x32_bf16 v[72:75], a[72:75], v[108:111], 0
    s_waitcnt vmcnt(11) lgkmcnt(6)
    v_mfma_f32_16x16x32_bf16 v[16:19], v[116:119], a[4:7], v[16:19]
    buffer_load_dwordx4 a[88:91], v2, s[4:7], s55 offen offset:0 sc1
    s_waitcnt vmcnt(11)
    v_mfma_f32_16x16x32_bf16 v[48:51], v[116:119], a[76:79], v[48:51]
    s_waitcnt lgkmcnt(5)
    ds_read_b128 v[88:91], v3 offset:14336
    ds_read_b128 v[92:95], v3 offset:15360
    v_mfma_f32_16x16x32_bf16 v[20:23], v[120:123], a[4:7], v[20:23]
    v_mfma_f32_16x16x32_bf16 v[52:55], v[120:123], a[76:79], v[52:55]
    s_waitcnt lgkmcnt(6)
    ds_read_b128 v[96:99], v3 offset:16384
    v_mfma_f32_16x16x32_bf16 v[24:27], v[124:127], a[4:7], v[24:27]
    buffer_load_dwordx4 a[20:23], v2, s[4:7], s54 offen offset:1024 sc1
    v_mfma_f32_16x16x32_bf16 v[56:59], v[124:127], a[76:79], v[56:59]
    s_waitcnt lgkmcnt(6)
    ds_read_b128 v[100:103], v3 offset:17408
    v_mfma_f32_16x16x32_bf16 v[28:31], v[128:131], a[4:7], v[28:31]
    v_mfma_f32_16x16x32_bf16 v[60:63], v[128:131], a[76:79], v[60:63]
    s_waitcnt lgkmcnt(6)
    ds_read_b128 v[112:115], v3 offset:20480
    v_mfma_f32_16x16x32_bf16 v[32:35], v[140:143], a[4:7], v[32:35]
    buffer_load_dwordx4 a[92:95], v2, s[4:7], s55 offen offset:1024 sc1
    v_mfma_f32_16x16x32_bf16 v[64:67], v[140:143], a[76:79], v[64:67]
    ds_read_b128 v[104:107], v3 offset:18432
    v_mfma_f32_16x16x32_bf16 v[44:47], a[4:7], v[140:143], v[44:47]
    v_mfma_f32_16x16x32_bf16 v[76:79], a[76:79], v[140:143], v[76:79]
    s_waitcnt lgkmcnt(7)
    ds_read_b128 v[108:111], v3 offset:19456
    v_mfma_f32_16x16x32_bf16 v[36:39], a[4:7], v[132:135], v[36:39]
    buffer_load_dwordx4 a[24:27], v2, s[4:7], s54 offen offset:2048 sc1
    v_mfma_f32_16x16x32_bf16 v[68:71], a[76:79], v[132:135], v[68:71]
    s_waitcnt lgkmcnt(7)
    v_mfma_f32_16x16x32_bf16 v[40:43], a[4:7], v[136:139], v[40:43]
    v_mfma_f32_16x16x32_bf16 v[72:75], a[76:79], v[136:139], v[72:75]
    s_waitcnt vmcnt(13) lgkmcnt(6)
    v_mfma_f32_16x16x32_bf16 v[16:19], v[88:91], a[8:11], v[16:19]
    buffer_load_dwordx4 a[96:99], v2, s[4:7], s55 offen offset:2048 sc1
    s_waitcnt vmcnt(13)
    v_mfma_f32_16x16x32_bf16 v[48:51], v[88:91], a[80:83], v[48:51]
    s_waitcnt lgkmcnt(5)
    ds_read_b128 v[116:119], v3 offset:21504
    ds_read_b128 v[120:123], v3 offset:22528
    v_mfma_f32_16x16x32_bf16 v[20:23], v[92:95], a[8:11], v[20:23]
    v_mfma_f32_16x16x32_bf16 v[52:55], v[92:95], a[80:83], v[52:55]
    s_waitcnt lgkmcnt(6)
    ds_read_b128 v[124:127], v3 offset:23552
    v_mfma_f32_16x16x32_bf16 v[24:27], v[96:99], a[8:11], v[24:27]
    buffer_load_dwordx4 a[28:31], v2, s[4:7], s54 offen offset:3072 sc1
    v_mfma_f32_16x16x32_bf16 v[56:59], v[96:99], a[80:83], v[56:59]
    s_waitcnt lgkmcnt(6)
    ds_read_b128 v[128:131], v3 offset:24576
    v_mfma_f32_16x16x32_bf16 v[28:31], v[100:103], a[8:11], v[28:31]
    v_mfma_f32_16x16x32_bf16 v[60:63], v[100:103], a[80:83], v[60:63]
    s_waitcnt lgkmcnt(6)
    ds_read_b128 v[140:143], v3 offset:27648
    v_mfma_f32_16x16x32_bf16 v[32:35], v[112:115], a[8:11], v[32:35]
    buffer_load_dwordx4 a[100:103], v2, s[4:7], s55 offen offset:3072 sc1
    v_mfma_f32_16x16x32_bf16 v[64:67], v[112:115], a[80:83], v[64:67]
    s_add_u32 s54, s51, 8192
    ds_read_b128 v[132:135], v3 offset:25600
    v_mfma_f32_16x16x32_bf16 v[44:47], a[8:11], v[112:115], v[44:47]
    v_mfma_f32_16x16x32_bf16 v[76:79], a[80:83], v[112:115], v[76:79]
    s_waitcnt lgkmcnt(7)
    ds_read_b128 v[136:139], v3 offset:26624
    v_mfma_f32_16x16x32_bf16 v[36:39], a[8:11], v[104:107], v[36:39]
    buffer_load_dwordx4 a[32:35], v2, s[4:7], s54 offen offset:0 sc1
    v_mfma_f32_16x16x32_bf16 v[68:71], a[80:83], v[104:107], v[68:71]
    s_waitcnt lgkmcnt(7)
    s_add_u32 s55, s51, 26624
    v_mfma_f32_16x16x32_bf16 v[40:43], a[8:11], v[108:111], v[40:43]
    v_mfma_f32_16x16x32_bf16 v[72:75], a[80:83], v[108:111], v[72:75]
    s_waitcnt vmcnt(10) lgkmcnt(6)
    v_mfma_f32_16x16x32_bf16 v[16:19], v[116:119], a[12:15], v[16:19]
    buffer_load_dwordx4 a[104:107], v2, s[4:7], s55 offen offset:0 sc1
    s_waitcnt vmcnt(10)
    v_mfma_f32_16x16x32_bf16 v[48:51], v[116:119], a[84:87], v[48:51]
    s_waitcnt lgkmcnt(5)
    ds_read_b128 v[88:91], v3 offset:28672
    ds_read_b128 v[92:95], v3 offset:29696
    v_mfma_f32_16x16x32_bf16 v[20:23], v[120:123], a[12:15], v[20:23]
    v_mfma_f32_16x16x32_bf16 v[52:55], v[120:123], a[84:87], v[52:55]
    s_waitcnt lgkmcnt(6)
    ds_read_b128 v[96:99], v3 offset:30720
    v_mfma_f32_16x16x32_bf16 v[24:27], v[124:127], a[12:15], v[24:27]
    buffer_load_dwordx4 a[36:39], v2, s[4:7], s54 offen offset:1024 sc1
    v_mfma_f32_16x16x32_bf16 v[56:59], v[124:127], a[84:87], v[56:59]
    s_waitcnt lgkmcnt(6)
    ds_read_b128 v[100:103], v3 offset:31744
    v_mfma_f32_16x16x32_bf16 v[28:31], v[128:131], a[12:15], v[28:31]
    v_mfma_f32_16x16x32_bf16 v[60:63], v[128:131], a[84:87], v[60:63]
    s_waitcnt lgkmcnt(6)
    ds_read_b128 v[112:115], v3 offset:34816
    v_mfma_f32_16x16x32_bf16 v[32:35], v[140:143], a[12:15], v[32:35]
    buffer_load_dwordx4 a[108:111], v2, s[4:7], s55 offen offset:1024 sc1
    v_mfma_f32_16x16x32_bf16 v[64:67], v[140:143], a[84:87], v[64:67]
    ds_read_b128 v[104:107], v3 offset:32768
    v_mfma_f32_16x16x32_bf16 v[44:47], a[12:15], v[140:143], v[44:47]
    v_mfma_f32_16x16x32_bf16 v[76:79], a[84:87], v[140:143], v[76:79]
    s_waitcnt lgkmcnt(7)
    ds_read_b128 v[108:111], v3 offset:33792
    v_mfma_f32_16x16x32_bf16 v[36:39], a[12:15], v[132:135], v[36:39]
    buffer_load_dwordx4 a[40:43], v2, s[4:7], s54 offen offset:2048 sc1
    v_mfma_f32_16x16x32_bf16 v[68:71], a[84:87], v[132:135], v[68:71]
    s_waitcnt lgkmcnt(7)
    v_mfma_f32_16x16x32_bf16 v[40:43], a[12:15], v[136:139], v[40:43]
    v_mfma_f32_16x16x32_bf16 v[72:75], a[84:87], v[136:139], v[72:75]
    s_waitcnt vmcnt(12) lgkmcnt(6)
    v_mfma_f32_16x16x32_bf16 v[16:19], v[88:91], a[16:19], v[16:19]
    buffer_load_dwordx4 a[112:115], v2, s[4:7], s55 offen offset:2048 sc1
    s_waitcnt vmcnt(12)
    v_mfma_f32_16x16x32_bf16 v[48:51], v[88:91], a[88:91], v[48:51]
    s_waitcnt lgkmcnt(5)
    ds_read_b128 v[116:119], v3 offset:35840
    ds_read_b128 v[120:123], v3 offset:36864
    v_mfma_f32_16x16x32_bf16 v[20:23], v[92:95], a[16:19], v[20:23]
    v_mfma_f32_16x16x32_bf16 v[52:55], v[92:95], a[88:91], v[52:55]
    s_waitcnt lgkmcnt(6)
    ds_read_b128 v[124:127], v3 offset:37888
    v_mfma_f32_16x16x32_bf16 v[24:27], v[96:99], a[16:19], v[24:27]
    buffer_load_dwordx4 a[44:47], v2, s[4:7], s54 offen offset:3072 sc1
    v_mfma_f32_16x16x32_bf16 v[56:59], v[96:99], a[88:91], v[56:59]
    s_waitcnt lgkmcnt(6)
    ds_read_b128 v[128:131], v3 offset:38912
    v_mfma_f32_16x16x32_bf16 v[28:31], v[100:103], a[16:19], v[28:31]
    v_mfma_f32_16x16x32_bf16 v[60:63], v[100:103], a[88:91], v[60:63]
    s_waitcnt lgkmcnt(6)
    ds_read_b128 v[140:143], v3 offset:41984
    v_mfma_f32_16x16x32_bf16 v[32:35], v[112:115], a[16:19], v[32:35]
    buffer_load_dwordx4 a[116:119], v2, s[4:7], s55 offen offset:3072 sc1
    v_mfma_f32_16x16x32_bf16 v[64:67], v[112:115], a[88:91], v[64:67]
    s_add_u32 s54, s51, 12288
    ds_read_b128 v[132:135], v3 offset:39936
    v_mfma_f32_16x16x32_bf16 v[44:47], a[16:19], v[112:115], v[44:47]
    v_mfma_f32_16x16x32_bf16 v[76:79], a[88:91], v[112:115], v[76:79]
    s_waitcnt lgkmcnt(7)
    ds_read_b128 v[136:139], v3 offset:40960
    v_mfma_f32_16x16x32_bf16 v[36:39], a[16:19], v[104:107], v[36:39]
    buffer_load_dwordx4 a[48:51], v2, s[4:7], s54 offen offset:0 sc1
    v_mfma_f32_16x16x32_bf16 v[68:71], a[88:91], v[104:107], v[68:71]
    s_waitcnt lgkmcnt(7)
    s_add_u32 s55, s51, 30720
    v_mfma_f32_16x16x32_bf16 v[40:43], a[16:19], v[108:111], v[40:43]
    v_mfma_f32_16x16x32_bf16 v[72:75], a[88:91], v[108:111], v[72:75]
    s_waitcnt vmcnt(14) lgkmcnt(6)
    v_mfma_f32_16x16x32_bf16 v[16:19], v[116:119], a[20:23], v[16:19]
    s_waitcnt vmcnt(13)
    s_barrier
    ds_read_b128 v[88:91], v3 offset:43008
    v_mfma_f32_16x16x32_bf16 v[48:51], v[116:119], a[92:95], v[48:51]
    s_waitcnt lgkmcnt(6)
    ds_read_b128 v[92:95], v3 offset:44032
    ds_read_b128 v[144:147], v10 offset:0
    v_mfma_f32_16x16x32_bf16 v[20:23], v[120:123], a[20:23], v[20:23]
    buffer_load_dwordx4 a[120:123], v2, s[4:7], s55 offen offset:0 sc1
    v_mfma_f32_16x16x32_bf16 v[52:55], v[120:123], a[92:95], v[52:55]
    s_waitcnt lgkmcnt(7)
    ds_read_b128 v[96:99], v3 offset:45056
    ds_read_b128 v[148:151], v4 offset:0
    v_mfma_f32_16x16x32_bf16 v[24:27], v[124:127], a[20:23], v[24:27]
    ds_read_b128 v[152:155], v5 offset:0
    ds_read_b128 v[156:159], v10 offset:1024
    v_mfma_f32_16x16x32_bf16 v[56:59], v[124:127], a[92:95], v[56:59]
    s_waitcnt lgkmcnt(10)
    ds_read_b128 v[100:103], v3 offset:46080
    ds_read_b128 v[160:163], v4 offset:7168
    v_mfma_f32_16x16x32_bf16 v[28:31], v[128:131], a[20:23], v[28:31]
    buffer_load_dwordx4 a[52:55], v2, s[4:7], s54 offen offset:1024 sc1
    v_mfma_f32_16x16x32_bf16 v[60:63], v[128:131], a[92:95], v[60:63]
    s_waitcnt lgkmcnt(11)
    ds_read_b128 v[112:115], v3 offset:49152
    ds_read_b128 v[164:167], v5 offset:7168
    v_mfma_f32_16x16x32_bf16 v[32:35], v[140:143], a[20:23], v[32:35]
    v_mfma_f32_16x16x32_bf16 v[64:67], v[140:143], a[92:95], v[64:67]
    ds_read_b128 v[104:107], v3 offset:47104
    v_mfma_f32_16x16x32_bf16 v[44:47], a[20:23], v[140:143], v[44:47]
    buffer_load_dwordx4 a[124:127], v2, s[4:7], s55 offen offset:1024 sc1
    v_mfma_f32_16x16x32_bf16 v[76:79], a[92:95], v[140:143], v[76:79]
    s_waitcnt lgkmcnt(13)
    ds_read_b128 v[108:111], v3 offset:48128
    v_mfma_f32_16x16x32_bf16 v[36:39], a[20:23], v[132:135], v[36:39]
    v_mfma_f32_16x16x32_bf16 v[68:71], a[92:95], v[132:135], v[68:71]
    s_waitcnt lgkmcnt(13)
    v_mfma_f32_16x16x32_bf16 v[40:43], a[20:23], v[136:139], v[40:43]
    buffer_load_dwordx4 a[56:59], v2, s[4:7], s54 offen offset:2048 sc1
    v_mfma_f32_16x16x32_bf16 v[72:75], a[92:95], v[136:139], v[72:75]
    s_waitcnt vmcnt(16) lgkmcnt(12)
    v_mfma_f32_16x16x32_bf16 v[16:19], v[88:91], a[24:27], v[16:19]
    s_waitcnt vmcnt(15)
    ds_read_b128 v[116:119], v3 offset:50176
    v_mfma_f32_16x16x32_bf16 v[48:51], v[88:91], a[96:99], v[48:51]
    s_waitcnt lgkmcnt(12)
    ds_read_b128 v[120:123], v3 offset:51200
    v_mfma_f32_16x16x32_bf16 v[20:23], v[92:95], a[24:27], v[20:23]
    buffer_load_dwordx4 a[128:131], v2, s[4:7], s55 offen offset:2048 sc1
    v_mfma_f32_16x16x32_bf16 v[52:55], v[92:95], a[96:99], v[52:55]
    s_waitcnt lgkmcnt(11)
    ds_read_b128 v[124:127], v3 offset:52224
    v_mfma_f32_16x16x32_bf16 v[24:27], v[96:99], a[24:27], v[24:27]
    v_mfma_f32_16x16x32_bf16 v[56:59], v[96:99], a[96:99], v[56:59]
    s_waitcnt lgkmcnt(8)
    ds_read_b128 v[128:131], v3 offset:53248
    v_mfma_f32_16x16x32_bf16 v[28:31], v[100:103], a[24:27], v[28:31]
    buffer_load_dwordx4 a[60:63], v2, s[4:7], s54 offen offset:3072 sc1
    v_mfma_f32_16x16x32_bf16 v[60:63], v[100:103], a[96:99], v[60:63]
    s_waitcnt lgkmcnt(7)
    ds_read_b128 v[140:143], v3 offset:56320
    v_mfma_f32_16x16x32_bf16 v[32:35], v[112:115], a[24:27], v[32:35]
    v_mfma_f32_16x16x32_bf16 v[64:67], v[112:115], a[96:99], v[64:67]
    ds_read_b128 v[132:135], v3 offset:54272
    v_mfma_f32_16x16x32_bf16 v[44:47], a[24:27], v[112:115], v[44:47]
    buffer_load_dwordx4 a[132:135], v2, s[4:7], s55 offen offset:3072 sc1
    v_mfma_f32_16x16x32_bf16 v[76:79], a[96:99], v[112:115], v[76:79]
    s_waitcnt lgkmcnt(7)
    s_add_u32 s54, s51, 16384
    ds_read_b128 v[136:139], v3 offset:55296
    v_mfma_f32_16x16x32_bf16 v[36:39], a[24:27], v[104:107], v[36:39]
    v_mfma_f32_16x16x32_bf16 v[68:71], a[96:99], v[104:107], v[68:71]
    s_waitcnt lgkmcnt(7)
    v_mfma_f32_16x16x32_bf16 v[40:43], a[24:27], v[108:111], v[40:43]
    buffer_load_dwordx4 a[64:67], v2, s[4:7], s54 offen offset:0 sc1
    v_mfma_f32_16x16x32_bf16 v[72:75], a[96:99], v[108:111], v[72:75]
    s_add_u32 s55, s51, 34816
    v_mfma_f32_16x16x32_bf16 v[80:83], v[148:151], v[144:147], 0
    v_mfma_f32_16x16x32_bf16 v[84:87], v[144:147], v[152:155], 0
    s_waitcnt vmcnt(18) lgkmcnt(6)
    ds_read_b128 v[144:147], v10 offset:2048
    ds_read_b128 v[148:151], v4 offset:14336
    v_mfma_f32_16x16x32_bf16 v[16:19], v[116:119], a[28:31], v[16:19]
    buffer_load_dwordx4 a[136:139], v2, s[4:7], s55 offen offset:0 sc1
    s_waitcnt vmcnt(18)
    v_mfma_f32_16x16x32_bf16 v[48:51], v[116:119], a[100:103], v[48:51]
    s_waitcnt lgkmcnt(7)
    ds_read_b128 v[88:91], v3 offset:57344
    ds_read_b128 v[92:95], v3 offset:58368
    v_mfma_f32_16x16x32_bf16 v[20:23], v[120:123], a[28:31], v[20:23]
    ds_read_b128 v[152:155], v5 offset:14336
    v_mfma_f32_16x16x32_bf16 v[52:55], v[120:123], a[100:103], v[52:55]
    s_waitcnt lgkmcnt(9)
    ds_read_b128 v[96:99], v3 offset:59392
    v_mfma_f32_16x16x32_bf16 v[24:27], v[124:127], a[28:31], v[24:27]
    buffer_load_dwordx4 a[68:71], v2, s[4:7], s54 offen offset:1024 sc1
    v_mfma_f32_16x16x32_bf16 v[56:59], v[124:127], a[100:103], v[56:59]
    s_waitcnt lgkmcnt(9)
    ds_read_b128 v[100:103], v3 offset:60416
    v_mfma_f32_16x16x32_bf16 v[28:31], v[128:131], a[28:31], v[28:31]
    v_mfma_f32_16x16x32_bf16 v[60:63], v[128:131], a[100:103], v[60:63]
    s_waitcnt lgkmcnt(9)
    ds_read_b128 v[112:115], v3 offset:63488
    v_mfma_f32_16x16x32_bf16 v[32:35], v[140:143], a[28:31], v[32:35]
    buffer_load_dwordx4 a[140:143], v2, s[4:7], s55 offen offset:1024 sc1
    v_mfma_f32_16x16x32_bf16 v[64:67], v[140:143], a[100:103], v[64:67]
    s_lshl_b32 s53, s22, 2
    s_add_u32 s53, s53, s20
    s_mul_i32 s53, s53, 5248
    v_mfma_f32_16x16x32_bf16 v[44:47], a[28:31], v[140:143], v[44:47]
    s_add_u32 s53, s53, 2097152
    ds_read_b128 v[104:107], v3 offset:61440
    v_min_u32 v11, 40, v1
    v_mfma_f32_16x16x32_bf16 v[76:79], a[100:103], v[140:143], v[76:79]
    s_waitcnt lgkmcnt(10)
    ds_read_b128 v[108:111], v3 offset:62464
    v_lshlrev_b32 v11, 7, v11
    v_mfma_f32_16x16x32_bf16 v[36:39], a[28:31], v[132:135], v[36:39]
    buffer_load_dword v13, v11, s[4:7], s53 offen
    v_mfma_f32_16x16x32_bf16 v[68:71], a[100:103], v[132:135], v[68:71]
    s_waitcnt lgkmcnt(10)
    s_and_b32 s53, s21, 3
    s_lshl_b32 s53, s53, 3
    v_mfma_f32_16x16x32_bf16 v[40:43], a[28:31], v[136:139], v[40:43]
    s_and_b32 s54, s22, 7
    s_add_u32 s53, s53, s54
    s_mul_i32 s53, s53, 497664
    v_mfma_f32_16x16x32_bf16 v[72:75], a[100:103], v[136:139], v[72:75]
    s_lshr_b32 s54, s22, 3
    s_lshl_b32 s54, s54, 2
    v_mfma_f32_16x16x32_bf16 v[80:83], v[160:163], v[156:159], v[80:83]
    s_add_u32 s54, s54, s20
    s_mul_i32 s54, s54, 9216
    v_mfma_f32_16x16x32_bf16 v[84:87], v[156:159], v[164:167], v[84:87]
    s_waitcnt vmcnt(20) lgkmcnt(7)
    s_add_u32 s53, s53, s54
    s_add_u32 s53, s53, 4194304
    v_mfma_f32_16x16x32_bf16 v[16:19], v[88:91], a[32:35], v[16:19]
    s_waitcnt vmcnt(19)
    ds_read_b128 v[156:159], v10 offset:3072
    v_add_u32 v3, 64512, v3
    v_mfma_f32_16x16x32_bf16 v[48:51], v[88:91], a[104:107], v[48:51]
    s_waitcnt lgkmcnt(7)
    ds_read_b128 v[116:119], v3 offset:0
    ds_read_b128 v[160:163], v4 offset:21504
    v_mfma_f32_16x16x32_bf16 v[20:23], v[92:95], a[32:35], v[20:23]
    ds_read_b128 v[164:167], v5 offset:21504
    v_min_u32 v11, 63, v1
    v_mfma_f32_16x16x32_bf16 v[52:55], v[92:95], a[104:107], v[52:55]
    s_waitcnt lgkmcnt(8)
    ds_read_b128 v[120:123], v3 offset:1024
    v_lshlrev_b32 v11, 7, v11
    v_mfma_f32_16x16x32_bf16 v[24:27], v[96:99], a[32:35], v[24:27]
    buffer_load_dword v14, v11, s[4:7], s53 offen
    v_mfma_f32_16x16x32_bf16 v[56:59], v[96:99], a[104:107], v[56:59]
    s_waitcnt lgkmcnt(8)
    ds_read_b128 v[124:127], v3 offset:2048
    v_add_u32 v11, 1024, v11
    v_mfma_f32_16x16x32_bf16 v[28:31], v[100:103], a[32:35], v[28:31]
    v_mfma_f32_16x16x32_bf16 v[60:63], v[100:103], a[104:107], v[60:63]
    s_waitcnt lgkmcnt(8)
    ds_read_b128 v[128:131], v3 offset:3072
    v_mfma_f32_16x16x32_bf16 v[32:35], v[112:115], a[32:35], v[32:35]
    buffer_load_dword v15, v11, s[4:7], s53 offen
    v_mfma_f32_16x16x32_bf16 v[64:67], v[112:115], a[104:107], v[64:67]
    ds_read_b128 v[140:143], v3 offset:6144
    v_mfma_f32_16x16x32_bf16 v[44:47], a[32:35], v[112:115], v[44:47]
    v_mfma_f32_16x16x32_bf16 v[76:79], a[104:107], v[112:115], v[76:79]
    s_waitcnt lgkmcnt(9)
    ds_read_b128 v[132:135], v3 offset:4096
    v_mfma_f32_16x16x32_bf16 v[36:39], a[32:35], v[104:107], v[36:39]
    v_mfma_f32_16x16x32_bf16 v[68:71], a[104:107], v[104:107], v[68:71]
    s_waitcnt lgkmcnt(9)
    ds_read_b128 v[136:139], v3 offset:5120
    v_mfma_f32_16x16x32_bf16 v[40:43], a[32:35], v[108:111], v[40:43]
    v_mfma_f32_16x16x32_bf16 v[72:75], a[104:107], v[108:111], v[72:75]
    v_mfma_f32_16x16x32_bf16 v[80:83], v[148:151], v[144:147], v[80:83]
    v_mfma_f32_16x16x32_bf16 v[84:87], v[144:147], v[152:155], v[84:87]
    s_waitcnt vmcnt(20) lgkmcnt(8)
    ds_read_b128 v[144:147], v10 offset:4096
    ds_read_b128 v[148:151], v4 offset:28672
    v_mfma_f32_16x16x32_bf16 v[16:19], v[116:119], a[36:39], v[16:19]
    s_waitcnt vmcnt(19)
    ds_read_b128 v[88:91], v3 offset:7168
    ds_read_b128 v[152:155], v5 offset:28672
    v_mfma_f32_16x16x32_bf16 v[48:51], v[116:119], a[108:111], v[48:51]
    s_waitcnt lgkmcnt(9)
    ds_read_b128 v[92:95], v3 offset:8192
    v_mfma_f32_16x16x32_bf16 v[20:23], v[120:123], a[36:39], v[20:23]
    v_mfma_f32_16x16x32_bf16 v[52:55], v[120:123], a[108:111], v[52:55]
    s_waitcnt lgkmcnt(9)
    ds_read_b128 v[96:99], v3 offset:9216
    v_mfma_f32_16x16x32_bf16 v[24:27], v[124:127], a[36:39], v[24:27]
    v_mfma_f32_16x16x32_bf16 v[56:59], v[124:127], a[108:111], v[56:59]
    s_waitcnt lgkmcnt(9)
    ds_read_b128 v[100:103], v3 offset:10240
    v_mfma_f32_16x16x32_bf16 v[28:31], v[128:131], a[36:39], v[28:31]
    v_mfma_f32_16x16x32_bf16 v[60:63], v[128:131], a[108:111], v[60:63]
    s_waitcnt lgkmcnt(9)
    ds_read_b128 v[112:115], v3 offset:13312
    v_mfma_f32_16x16x32_bf16 v[32:35], v[140:143], a[36:39], v[32:35]
    v_mfma_f32_16x16x32_bf16 v[64:67], v[140:143], a[108:111], v[64:67]
    ds_read_b128 v[104:107], v3 offset:11264
    v_mfma_f32_16x16x32_bf16 v[44:47], a[36:39], v[140:143], v[44:47]
    v_mfma_f32_16x16x32_bf16 v[76:79], a[108:111], v[140:143], v[76:79]
    s_waitcnt lgkmcnt(10)
    ds_read_b128 v[108:111], v3 offset:12288
    v_mfma_f32_16x16x32_bf16 v[36:39], a[36:39], v[132:135], v[36:39]
    v_mfma_f32_16x16x32_bf16 v[68:71], a[108:111], v[132:135], v[68:71]
    s_waitcnt lgkmcnt(10)
    v_mfma_f32_16x16x32_bf16 v[40:43], a[36:39], v[136:139], v[40:43]
    v_mfma_f32_16x16x32_bf16 v[72:75], a[108:111], v[136:139], v[72:75]
    v_mfma_f32_16x16x32_bf16 v[80:83], v[160:163], v[156:159], v[80:83]
    v_mfma_f32_16x16x32_bf16 v[84:87], v[156:159], v[164:167], v[84:87]
    s_waitcnt vmcnt(18) lgkmcnt(7)
    ds_read_b128 v[156:159], v10 offset:5120
    ds_read_b128 v[160:163], v4 offset:35840
    v_mfma_f32_16x16x32_bf16 v[16:19], v[88:91], a[40:43], v[16:19]
    s_waitcnt vmcnt(17)
    ds_read_b128 v[116:119], v3 offset:14336
    ds_read_b128 v[164:167], v5 offset:35840
    v_mfma_f32_16x16x32_bf16 v[48:51], v[88:91], a[112:115], v[48:51]
    s_waitcnt lgkmcnt(9)
    ds_read_b128 v[120:123], v3 offset:15360
    v_mfma_f32_16x16x32_bf16 v[20:23], v[92:95], a[40:43], v[20:23]
    v_mfma_f32_16x16x32_bf16 v[52:55], v[92:95], a[112:115], v[52:55]
    s_waitcnt lgkmcnt(9)
    ds_read_b128 v[124:127], v3 offset:16384
    v_mfma_f32_16x16x32_bf16 v[24:27], v[96:99], a[40:43], v[24:27]
    v_mfma_f32_16x16x32_bf16 v[56:59], v[96:99], a[112:115], v[56:59]
    s_waitcnt lgkmcnt(9)
    ds_read_b128 v[128:131], v3 offset:17408
    v_mfma_f32_16x16x32_bf16 v[28:31], v[100:103], a[40:43], v[28:31]
    v_mfma_f32_16x16x32_bf16 v[60:63], v[100:103], a[112:115], v[60:63]
    s_waitcnt lgkmcnt(9)
    ds_read_b128 v[140:143], v3 offset:20480
    v_mfma_f32_16x16x32_bf16 v[32:35], v[112:115], a[40:43], v[32:35]
    v_mfma_f32_16x16x32_bf16 v[64:67], v[112:115], a[112:115], v[64:67]
    ds_read_b128 v[132:135], v3 offset:18432
    v_mfma_f32_16x16x32_bf16 v[44:47], a[40:43], v[112:115], v[44:47]
    v_mfma_f32_16x16x32_bf16 v[76:79], a[112:115], v[112:115], v[76:79]
    s_waitcnt lgkmcnt(10)
    ds_read_b128 v[136:139], v3 offset:19456
    v_mfma_f32_16x16x32_bf16 v[36:39], a[40:43], v[104:107], v[36:39]
    v_mfma_f32_16x16x32_bf16 v[68:71], a[112:115], v[104:107], v[68:71]
    s_waitcnt lgkmcnt(10)
    v_mfma_f32_16x16x32_bf16 v[40:43], a[40:43], v[108:111], v[40:43]
    v_mfma_f32_16x16x32_bf16 v[72:75], a[112:115], v[108:111], v[72:75]
    v_mfma_f32_16x16x32_bf16 v[80:83], v[148:151], v[144:147], v[80:83]
    v_mfma_f32_16x16x32_bf16 v[84:87], v[144:147], v[152:155], v[84:87]
    s_waitcnt vmcnt(16) lgkmcnt(7)
    ds_read_b128 v[144:147], v10 offset:6144
    ds_read_b128 v[148:151], v4 offset:43008
    v_mfma_f32_16x16x32_bf16 v[16:19], v[116:119], a[44:47], v[16:19]
    s_waitcnt vmcnt(15)
    ds_read_b128 v[88:91], v3 offset:21504
    ds_read_b128 v[152:155], v5 offset:43008
    v_mfma_f32_16x16x32_bf16 v[48:51], v[116:119], a[116:119], v[48:51]
    s_waitcnt lgkmcnt(9)
    ds_read_b128 v[92:95], v3 offset:22528
    v_mfma_f32_16x16x32_bf16 v[20:23], v[120:123], a[44:47], v[20:23]
    v_mfma_f32_16x16x32_bf16 v[52:55], v[120:123], a[116:119], v[52:55]
    s_waitcnt lgkmcnt(9)
    ds_read_b128 v[96:99], v3 offset:23552
    v_mfma_f32_16x16x32_bf16 v[24:27], v[124:127], a[44:47], v[24:27]
    v_mfma_f32_16x16x32_bf16 v[56:59], v[124:127], a[116:119], v[56:59]
    s_waitcnt lgkmcnt(9)
    ds_read_b128 v[100:103], v3 offset:24576
    v_mfma_f32_16x16x32_bf16 v[28:31], v[128:131], a[44:47], v[28:31]
    v_mfma_f32_16x16x32_bf16 v[60:63], v[128:131], a[116:119], v[60:63]
    s_waitcnt lgkmcnt(9)
    ds_read_b128 v[112:115], v3 offset:27648
    v_mfma_f32_16x16x32_bf16 v[32:35], v[140:143], a[44:47], v[32:35]
    v_mfma_f32_16x16x32_bf16 v[64:67], v[140:143], a[116:119], v[64:67]
    ds_read_b128 v[104:107], v3 offset:25600
    v_mfma_f32_16x16x32_bf16 v[44:47], a[44:47], v[140:143], v[44:47]
    v_mfma_f32_16x16x32_bf16 v[76:79], a[116:119], v[140:143], v[76:79]
    s_waitcnt lgkmcnt(10)
    ds_read_b128 v[108:111], v3 offset:26624
    v_mfma_f32_16x16x32_bf16 v[36:39], a[44:47], v[132:135], v[36:39]
    v_mfma_f32_16x16x32_bf16 v[68:71], a[116:119], v[132:135], v[68:71]
    s_waitcnt lgkmcnt(10)
    v_mfma_f32_16x16x32_bf16 v[40:43], a[44:47], v[136:139], v[40:43]
    v_mfma_f32_16x16x32_bf16 v[72:75], a[116:119], v[136:139], v[72:75]
    v_mfma_f32_16x16x32_bf16 v[80:83], v[160:163], v[156:159], v[80:83]
    v_mfma_f32_16x16x32_bf16 v[84:87], v[156:159], v[164:167], v[84:87]
    s_waitcnt vmcnt(14) lgkmcnt(7)
    ds_read_b128 v[156:159], v10 offset:7168
    ds_read_b128 v[160:163], v4 offset:50176
    v_mfma_f32_16x16x32_bf16 v[16:19], v[88:91], a[48:51], v[16:19]
    s_waitcnt vmcnt(13)
    ds_read_b128 v[164:167], v5 offset:50176
    ds_read_b128 v[116:119], v3 offset:28672
    v_mfma_f32_16x16x32_bf16 v[48:51], v[88:91], a[120:123], v[48:51]
    s_waitcnt lgkmcnt(9)
    ds_read_b128 v[120:123], v3 offset:29696
    v_mfma_f32_16x16x32_bf16 v[20:23], v[92:95], a[48:51], v[20:23]
    v_mfma_f32_16x16x32_bf16 v[52:55], v[92:95], a[120:123], v[52:55]
    s_waitcnt lgkmcnt(9)
    ds_read_b128 v[124:127], v3 offset:30720
    v_mfma_f32_16x16x32_bf16 v[24:27], v[96:99], a[48:51], v[24:27]
    v_mfma_f32_16x16x32_bf16 v[56:59], v[96:99], a[120:123], v[56:59]
    s_waitcnt lgkmcnt(9)
    ds_read_b128 v[128:131], v3 offset:31744
    v_mfma_f32_16x16x32_bf16 v[28:31], v[100:103], a[48:51], v[28:31]
    v_mfma_f32_16x16x32_bf16 v[60:63], v[100:103], a[120:123], v[60:63]
    ds_read_b128 v[140:143], v3 offset:34816
    v_mfma_f32_16x16x32_bf16 v[80:83], v[148:151], v[144:147], v[80:83]
    v_mfma_f32_16x16x32_bf16 v[84:87], v[144:147], v[152:155], v[84:87]
    s_waitcnt lgkmcnt(10)
    ds_read_b128 v[132:135], v3 offset:32768
    ds_read_b128 v[144:147], v10 offset:8192
    v_mfma_f32_16x16x32_bf16 v[32:35], v[112:115], a[48:51], v[32:35]
    ds_read_b128 v[148:151], v4 offset:57344
    ds_read_b128 v[152:155], v5 offset:57344
    v_mfma_f32_16x16x32_bf16 v[64:67], v[112:115], a[120:123], v[64:67]
    ds_read_b128 v[136:139], v3 offset:33792
    v_mfma_f32_16x16x32_bf16 v[44:47], a[48:51], v[112:115], v[44:47]
    v_mfma_f32_16x16x32_bf16 v[76:79], a[120:123], v[112:115], v[76:79]
    s_waitcnt lgkmcnt(14)
    v_mfma_f32_16x16x32_bf16 v[36:39], a[48:51], v[104:107], v[36:39]
    v_mfma_f32_16x16x32_bf16 v[68:71], a[120:123], v[104:107], v[68:71]
    s_waitcnt lgkmcnt(13)
    v_mfma_f32_16x16x32_bf16 v[40:43], a[48:51], v[108:111], v[40:43]
    v_mfma_f32_16x16x32_bf16 v[72:75], a[120:123], v[108:111], v[72:75]
    s_waitcnt lgkmcnt(11)
    v_mfma_f32_16x16x32_bf16 v[80:83], v[160:163], v[156:159], v[80:83]
    s_waitcnt lgkmcnt(10)
    v_mfma_f32_16x16x32_bf16 v[84:87], v[156:159], v[164:167], v[84:87]
    s_waitcnt vmcnt(12) lgkmcnt(9)
    v_add_u32 v4, 64512, v4
    v_add_u32 v5, 64512, v5
    v_mfma_f32_16x16x32_bf16 v[16:19], v[116:119], a[52:55], v[16:19]
    s_waitcnt vmcnt(11)
    ds_read_b128 v[156:159], v10 offset:9216
    ds_read_b128 v[160:163], v4 offset:0
    v_mfma_f32_16x16x32_bf16 v[48:51], v[116:119], a[124:127], v[48:51]
    s_waitcnt lgkmcnt(10)
    ds_read_b128 v[164:167], v5 offset:0
    ds_read_b128 v[88:91], v3 offset:35840
    v_mfma_f32_16x16x32_bf16 v[20:23], v[120:123], a[52:55], v[20:23]
    ds_read_b128 v[92:95], v3 offset:36864
    v_mfma_f32_16x16x32_bf16 v[52:55], v[120:123], a[124:127], v[52:55]
    s_waitcnt lgkmcnt(12)
    ds_read_b128 v[96:99], v3 offset:37888
    v_mfma_f32_16x16x32_bf16 v[24:27], v[124:127], a[52:55], v[24:27]
    v_mfma_f32_16x16x32_bf16 v[56:59], v[124:127], a[124:127], v[56:59]
    s_waitcnt lgkmcnt(12)
    ds_read_b128 v[100:103], v3 offset:38912
    v_mfma_f32_16x16x32_bf16 v[28:31], v[128:131], a[52:55], v[28:31]
    v_mfma_f32_16x16x32_bf16 v[60:63], v[128:131], a[124:127], v[60:63]
    s_waitcnt lgkmcnt(9)
    ds_read_b128 v[112:115], v3 offset:41984
    v_mfma_f32_16x16x32_bf16 v[80:83], v[148:151], v[144:147], v[80:83]
    s_waitcnt lgkmcnt(9)
    v_mfma_f32_16x16x32_bf16 v[84:87], v[144:147], v[152:155], v[84:87]
    ds_read_b128 v[104:107], v3 offset:39936
    ds_read_b128 v[144:147], v10 offset:10240
    v_mfma_f32_16x16x32_bf16 v[32:35], v[140:143], a[52:55], v[32:35]
    ds_read_b128 v[148:151], v4 offset:7168
    ds_read_b128 v[152:155], v5 offset:7168
    v_mfma_f32_16x16x32_bf16 v[64:67], v[140:143], a[124:127], v[64:67]
    ds_read_b128 v[108:111], v3 offset:40960
    v_mfma_f32_16x16x32_bf16 v[44:47], a[52:55], v[140:143], v[44:47]
    v_mfma_f32_16x16x32_bf16 v[76:79], a[124:127], v[140:143], v[76:79]
    v_mfma_f32_16x16x32_bf16 v[36:39], a[52:55], v[132:135], v[36:39]
    v_mfma_f32_16x16x32_bf16 v[68:71], a[124:127], v[132:135], v[68:71]
    s_waitcnt lgkmcnt(13)
    v_mfma_f32_16x16x32_bf16 v[40:43], a[52:55], v[136:139], v[40:43]
    v_mfma_f32_16x16x32_bf16 v[72:75], a[124:127], v[136:139], v[72:75]
    s_waitcnt lgkmcnt(11)
    v_mfma_f32_16x16x32_bf16 v[80:83], v[160:163], v[156:159], v[80:83]
    s_waitcnt lgkmcnt(10)
    v_mfma_f32_16x16x32_bf16 v[84:87], v[156:159], v[164:167], v[84:87]
    s_waitcnt vmcnt(10) lgkmcnt(9)
    ds_read_b128 v[156:159], v10 offset:11264
    ds_read_b128 v[160:163], v4 offset:14336
    v_mfma_f32_16x16x32_bf16 v[16:19], v[88:91], a[56:59], v[16:19]
    s_waitcnt vmcnt(9)
    ds_read_b128 v[164:167], v5 offset:14336
    ds_read_b128 v[116:119], v3 offset:43008
    v_mfma_f32_16x16x32_bf16 v[48:51], v[88:91], a[128:131], v[48:51]
    s_waitcnt lgkmcnt(12)
    ds_read_b128 v[120:123], v3 offset:44032
    v_mfma_f32_16x16x32_bf16 v[20:23], v[92:95], a[56:59], v[20:23]
    v_mfma_f32_16x16x32_bf16 v[52:55], v[92:95], a[128:131], v[52:55]
    s_waitcnt lgkmcnt(12)
    ds_read_b128 v[124:127], v3 offset:45056
    v_mfma_f32_16x16x32_bf16 v[24:27], v[96:99], a[56:59], v[24:27]
    v_mfma_f32_16x16x32_bf16 v[56:59], v[96:99], a[128:131], v[56:59]
    s_waitcnt lgkmcnt(12)
    ds_read_b128 v[128:131], v3 offset:46080
    v_mfma_f32_16x16x32_bf16 v[28:31], v[100:103], a[56:59], v[28:31]
    v_mfma_f32_16x16x32_bf16 v[60:63], v[100:103], a[128:131], v[60:63]
    s_waitcnt lgkmcnt(9)
    ds_read_b128 v[140:143], v3 offset:49152
    v_mfma_f32_16x16x32_bf16 v[80:83], v[148:151], v[144:147], v[80:83]
    s_waitcnt lgkmcnt(9)
    v_mfma_f32_16x16x32_bf16 v[84:87], v[144:147], v[152:155], v[84:87]
    ds_read_b128 v[132:135], v3 offset:47104
    ds_read_b128 v[144:147], v10 offset:12288
    v_mfma_f32_16x16x32_bf16 v[32:35], v[112:115], a[56:59], v[32:35]
    ds_read_b128 v[148:151], v4 offset:21504
    ds_read_b128 v[152:155], v5 offset:21504
    v_mfma_f32_16x16x32_bf16 v[64:67], v[112:115], a[128:131], v[64:67]
    ds_read_b128 v[136:139], v3 offset:48128
    v_mfma_f32_16x16x32_bf16 v[44:47], a[56:59], v[112:115], v[44:47]
    v_mfma_f32_16x16x32_bf16 v[76:79], a[128:131], v[112:115], v[76:79]
    v_mfma_f32_16x16x32_bf16 v[36:39], a[56:59], v[104:107], v[36:39]
    v_mfma_f32_16x16x32_bf16 v[68:71], a[128:131], v[104:107], v[68:71]
    s_waitcnt lgkmcnt(13)
    v_mfma_f32_16x16x32_bf16 v[40:43], a[56:59], v[108:111], v[40:43]
    v_mfma_f32_16x16x32_bf16 v[72:75], a[128:131], v[108:111], v[72:75]
    s_waitcnt lgkmcnt(11)
    v_mfma_f32_16x16x32_bf16 v[80:83], v[160:163], v[156:159], v[80:83]
    s_waitcnt lgkmcnt(10)
    v_mfma_f32_16x16x32_bf16 v[84:87], v[156:159], v[164:167], v[84:87]
    s_waitcnt vmcnt(8) lgkmcnt(9)
    ds_read_b128 v[156:159], v10 offset:13312
    ds_read_b128 v[160:163], v4 offset:28672
    v_mfma_f32_16x16x32_bf16 v[16:19], v[116:119], a[60:63], v[16:19]
    s_waitcnt vmcnt(7)
    ds_read_b128 v[164:167], v5 offset:28672
    ds_read_b128 v[88:91], v3 offset:50176
    v_mfma_f32_16x16x32_bf16 v[48:51], v[116:119], a[132:135], v[48:51]
    s_waitcnt lgkmcnt(12)
    ds_read_b128 v[92:95], v3 offset:51200
    v_mfma_f32_16x16x32_bf16 v[20:23], v[120:123], a[60:63], v[20:23]
    v_mfma_f32_16x16x32_bf16 v[52:55], v[120:123], a[132:135], v[52:55]
    s_waitcnt lgkmcnt(12)
    ds_read_b128 v[96:99], v3 offset:52224
    v_mfma_f32_16x16x32_bf16 v[24:27], v[124:127], a[60:63], v[24:27]
    v_mfma_f32_16x16x32_bf16 v[56:59], v[124:127], a[132:135], v[56:59]
    s_waitcnt lgkmcnt(12)
    ds_read_b128 v[100:103], v3 offset:53248
    v_mfma_f32_16x16x32_bf16 v[28:31], v[128:131], a[60:63], v[28:31]
    v_mfma_f32_16x16x32_bf16 v[60:63], v[128:131], a[132:135], v[60:63]
    s_waitcnt lgkmcnt(9)
    ds_read_b128 v[112:115], v3 offset:56320
    v_mfma_f32_16x16x32_bf16 v[80:83], v[148:151], v[144:147], v[80:83]
    s_waitcnt lgkmcnt(9)
    v_mfma_f32_16x16x32_bf16 v[84:87], v[144:147], v[152:155], v[84:87]
    ds_read_b128 v[104:107], v3 offset:54272
    ds_read_b128 v[144:147], v10 offset:14336
    v_mfma_f32_16x16x32_bf16 v[32:35], v[140:143], a[60:63], v[32:35]
    ds_read_b128 v[148:151], v4 offset:35840
    ds_read_b128 v[152:155], v5 offset:35840
    v_mfma_f32_16x16x32_bf16 v[64:67], v[140:143], a[132:135], v[64:67]
    ds_read_b128 v[108:111], v3 offset:55296
    v_mfma_f32_16x16x32_bf16 v[44:47], a[60:63], v[140:143], v[44:47]
    v_mfma_f32_16x16x32_bf16 v[76:79], a[132:135], v[140:143], v[76:79]
    v_mfma_f32_16x16x32_bf16 v[36:39], a[60:63], v[132:135], v[36:39]
    v_mfma_f32_16x16x32_bf16 v[68:71], a[132:135], v[132:135], v[68:71]
    s_waitcnt lgkmcnt(13)
    v_mfma_f32_16x16x32_bf16 v[40:43], a[60:63], v[136:139], v[40:43]
    v_mfma_f32_16x16x32_bf16 v[72:75], a[132:135], v[136:139], v[72:75]
    s_waitcnt lgkmcnt(11)
    v_mfma_f32_16x16x32_bf16 v[80:83], v[160:163], v[156:159], v[80:83]
    s_waitcnt lgkmcnt(10)
    v_mfma_f32_16x16x32_bf16 v[84:87], v[156:159], v[164:167], v[84:87]
    s_waitcnt vmcnt(6) lgkmcnt(9)
    ds_read_b128 v[156:159], v10 offset:15360
    ds_read_b128 v[160:163], v4 offset:43008
    v_mfma_f32_16x16x32_bf16 v[16:19], v[88:91], a[64:67], v[16:19]
    s_waitcnt vmcnt(5)
    ds_read_b128 v[164:167], v5 offset:43008
    ds_read_b128 v[116:119], v3 offset:57344
    v_mfma_f32_16x16x32_bf16 v[48:51], v[88:91], a[136:139], v[48:51]
    s_waitcnt lgkmcnt(12)
    ds_read_b128 v[120:123], v3 offset:58368
    v_mfma_f32_16x16x32_bf16 v[20:23], v[92:95], a[64:67], v[20:23]
    v_mfma_f32_16x16x32_bf16 v[52:55], v[92:95], a[136:139], v[52:55]
    s_waitcnt lgkmcnt(12)
    ds_read_b128 v[124:127], v3 offset:59392
    v_mfma_f32_16x16x32_bf16 v[24:27], v[96:99], a[64:67], v[24:27]
    v_mfma_f32_16x16x32_bf16 v[56:59], v[96:99], a[136:139], v[56:59]
    s_waitcnt lgkmcnt(12)
    ds_read_b128 v[128:131], v3 offset:60416
    v_mfma_f32_16x16x32_bf16 v[28:31], v[100:103], a[64:67], v[28:31]
    v_mfma_f32_16x16x32_bf16 v[60:63], v[100:103], a[136:139], v[60:63]
    s_waitcnt lgkmcnt(9)
    ds_read_b128 v[140:143], v3 offset:63488
    v_mfma_f32_16x16x32_bf16 v[80:83], v[148:151], v[144:147], v[80:83]
    s_waitcnt lgkmcnt(9)
    v_mfma_f32_16x16x32_bf16 v[84:87], v[144:147], v[152:155], v[84:87]
    ds_read_b128 v[132:135], v3 offset:61440
    ds_read_b128 v[144:147], v10 offset:16384
    v_mfma_f32_16x16x32_bf16 v[32:35], v[112:115], a[64:67], v[32:35]
    ds_read_b128 v[148:151], v4 offset:50176
    ds_read_b128 v[152:155], v5 offset:50176
    v_mfma_f32_16x16x32_bf16 v[64:67], v[112:115], a[136:139], v[64:67]
    ds_read_b128 v[136:139], v3 offset:62464
    v_mfma_f32_16x16x32_bf16 v[44:47], a[64:67], v[112:115], v[44:47]
    v_mfma_f32_16x16x32_bf16 v[76:79], a[136:139], v[112:115], v[76:79]
    v_mfma_f32_16x16x32_bf16 v[36:39], a[64:67], v[104:107], v[36:39]
    v_mfma_f32_16x16x32_bf16 v[68:71], a[136:139], v[104:107], v[68:71]
    s_waitcnt lgkmcnt(13)
    v_mfma_f32_16x16x32_bf16 v[40:43], a[64:67], v[108:111], v[40:43]
    v_mfma_f32_16x16x32_bf16 v[72:75], a[136:139], v[108:111], v[72:75]
    s_waitcnt lgkmcnt(11)
    v_mfma_f32_16x16x32_bf16 v[80:83], v[160:163], v[156:159], v[80:83]
    s_waitcnt lgkmcnt(10)
    v_mfma_f32_16x16x32_bf16 v[84:87], v[156:159], v[164:167], v[84:87]
    s_waitcnt vmcnt(4) lgkmcnt(9)
    ds_read_b128 v[156:159], v10 offset:17408
    ds_read_b128 v[160:163], v4 offset:57344
    v_mfma_f32_16x16x32_bf16 v[16:19], v[116:119], a[68:71], v[16:19]
    s_waitcnt vmcnt(3)
    ds_read_b128 v[164:167], v5 offset:57344
    v_mfma_f32_16x16x32_bf16 v[48:51], v[116:119], a[140:143], v[48:51]
    s_waitcnt lgkmcnt(11)
    v_mfma_f32_16x16x32_bf16 v[20:23], v[120:123], a[68:71], v[20:23]
    v_mfma_f32_16x16x32_bf16 v[52:55], v[120:123], a[140:143], v[52:55]
    s_waitcnt lgkmcnt(10)
    v_mfma_f32_16x16x32_bf16 v[24:27], v[124:127], a[68:71], v[24:27]
    v_mfma_f32_16x16x32_bf16 v[56:59], v[124:127], a[140:143], v[56:59]
    s_waitcnt lgkmcnt(9)
    v_mfma_f32_16x16x32_bf16 v[28:31], v[128:131], a[68:71], v[28:31]
    v_mfma_f32_16x16x32_bf16 v[60:63], v[128:131], a[140:143], v[60:63]
    s_waitcnt lgkmcnt(5)
    v_mfma_f32_16x16x32_bf16 v[80:83], v[148:151], v[144:147], v[80:83]
    s_waitcnt lgkmcnt(4)
    v_mfma_f32_16x16x32_bf16 v[84:87], v[144:147], v[152:155], v[84:87]
    v_mfma_f32_16x16x32_bf16 v[32:35], v[140:143], a[68:71], v[32:35]
    v_mfma_f32_16x16x32_bf16 v[64:67], v[140:143], a[140:143], v[64:67]
    v_mfma_f32_16x16x32_bf16 v[44:47], a[68:71], v[140:143], v[44:47]
    v_mfma_f32_16x16x32_bf16 v[76:79], a[140:143], v[140:143], v[76:79]
    v_mfma_f32_16x16x32_bf16 v[36:39], a[68:71], v[132:135], v[36:39]
    v_mfma_f32_16x16x32_bf16 v[68:71], a[140:143], v[132:135], v[68:71]
    s_waitcnt lgkmcnt(3)
    v_mfma_f32_16x16x32_bf16 v[40:43], a[68:71], v[136:139], v[40:43]
    v_mfma_f32_16x16x32_bf16 v[72:75], a[140:143], v[136:139], v[72:75]
    s_waitcnt lgkmcnt(1)
    v_mfma_f32_16x16x32_bf16 v[80:83], v[160:163], v[156:159], v[80:83]
    s_waitcnt lgkmcnt(0)
    v_mfma_f32_16x16x32_bf16 v[84:87], v[156:159], v[164:167], v[84:87]
    v_lshlrev_b32 v6, 3, v1
    v_add_u32 v6, 148608, v6
    s_mul_i32 s52, s20, 3072
    v_add_u32 v7, s52, v6
    v_cvt_pk_bf16_f32 v100, v56, v57
    v_cvt_pk_bf16_f32 v101, v58, v59
    v_cvt_pk_bf16_f32 v104, v60, v61
    v_cvt_pk_bf16_f32 v105, v62, v63
    v_cvt_pk_bf16_f32 v134, v64, v65
    v_cvt_pk_bf16_f32 v137, v66, v67
    v_mov_b32 v102, 0
    v_mov_b32 v103, 0
    v_cvt_pk_bf16_f32 v110, v68, v69
    v_cvt_pk_bf16_f32 v111, v70, v71
    v_cvt_pk_bf16_f32 v116, v72, v73
    v_cvt_pk_bf16_f32 v117, v74, v75
    v_cvt_pk_bf16_f32 v122, v76, v77
    v_cvt_pk_bf16_f32 v123, v78, v79
    v_permlane32_swap_b32 v134, v102
    v_permlane32_swap_b32 v137, v103
    s_cmp_eq_u32 s20, 3
    s_cbranch_scc1 L_w3_104
    ds_write_b64 v7, v[100:101] offset:3072
    ds_write_b64 v7, v[102:103] offset:3584
    ds_write_b64 v7, v[104:105] offset:4096
    ds_write_b64 v7, v[110:111] offset:4608
    ds_write_b64 v7, v[116:117] offset:5120
    ds_write_b64 v7, v[122:123] offset:5632
L_w3_104:
    v_cvt_pk_bf16_f32 v140, v80, v81
    v_cvt_pk_bf16_f32 v141, v82, v83
    v_cvt_pk_bf16_f32 v142, v84, v85
    v_cvt_pk_bf16_f32 v143, v86, v87
    s_min_u32 s52, s20, 2
    s_lshl_b32 s53, s52, 1
    s_cmp_ge_u32 s20, 2
    s_cselect_b32 s53, 1, s53
    s_lshl_b32 s53, s53, 9
    s_add_u32 s52, s52, 3
    s_lshl_b32 s52, s52, 9
    v_add_u32 v8, s53, v6
    v_add_u32 v9, s52, v6
    s_cmp_lt_u32 s20, 2
    s_cbranch_scc1 L_noswap_105
    v_mov_b32 v10, 0
    v_mov_b32 v11, 0
    s_nop 1
    v_permlane32_swap_b32 v140, v10
    v_permlane32_swap_b32 v141, v11
    v_mov_b32 v140, v10
    v_mov_b32 v141, v11
L_noswap_105:
    ds_write_b64 v8, v[140:141]
    ds_write_b64 v9, v[142:143]
    v_cvt_pk_bf16_f32 v132, v48, v49
    v_cvt_pk_bf16_f32 v133, v50, v51
    v_cvt_pk_bf16_f32 v138, v52, v53
    v_cvt_pk_bf16_f32 v139, v54, v55
    v_mov_b32 v135, 0
    v_mov_b32 v136, 0
    v_cvt_pk_bf16_f32 v94, v24, v25
    v_cvt_pk_bf16_f32 v95, v26, v27
    v_cvt_pk_bf16_f32 v98, v28, v29
    v_cvt_pk_bf16_f32 v99, v30, v31
    v_cvt_pk_bf16_f32 v126, v32, v33
    v_cvt_pk_bf16_f32 v129, v34, v35
    v_mov_b32 v96, 0
    v_mov_b32 v97, 0
    v_cvt_pk_bf16_f32 v108, v36, v37
    v_cvt_pk_bf16_f32 v109, v38, v39
    v_cvt_pk_bf16_f32 v114, v40, v41
    v_cvt_pk_bf16_f32 v115, v42, v43
    v_cvt_pk_bf16_f32 v120, v44, v45
    v_cvt_pk_bf16_f32 v121, v46, v47
    v_permlane32_swap_b32 v126, v96
    v_permlane32_swap_b32 v129, v97
    v_cvt_pk_bf16_f32 v124, v16, v17
    v_cvt_pk_bf16_f32 v125, v18, v19
    v_cvt_pk_bf16_f32 v130, v20, v21
    v_cvt_pk_bf16_f32 v131, v22, v23
    v_mov_b32 v127, 0
    v_mov_b32 v128, 0
    v_mov_b32 v12, 0x3f803f80
    s_waitcnt vmcnt(2)
    v_mov_b32 v13, 0x3f803f80
    s_waitcnt vmcnt(1)
    v_mov_b32 v14, 0x3f803f80
    s_waitcnt vmcnt(0)
    v_mov_b32 v15, 0x3f803f80
    v_mfma_f32_16x16x32_bf16 v[32:35], v[94:97], v[132:135], v[172:175]
    v_mfma_f32_16x16x32_bf16 v[36:39], v[100:103], v[132:135], v[168:171]
    v_mfma_f32_16x16x32_bf16 v[20:23], v[94:97], v[124:127], v[168:171]
    v_mfma_f32_16x16x32_bf16 v[40:43], v[96:99], v[136:139], v[172:175]
    v_mfma_f32_16x16x32_bf16 v[44:47], v[102:105], v[136:139], v[168:171]
    v_mfma_f32_16x16x32_bf16 v[28:31], v[96:99], v[128:131], v[168:171]
    s_waitcnt lgkmcnt(0)
    s_barrier
    ds_read_b64 v[88:89], v7 offset:0
    ds_read_b64 v[90:91], v7 offset:512
    ds_read_b64 v[92:93], v7 offset:1024
    ds_read_b64 v[106:107], v7 offset:1536
    ds_read_b64 v[112:113], v7 offset:2048
    ds_read_b64 v[118:119], v7 offset:2560
    s_mov_b32 s52, 0x3eae1a93
    s_waitcnt lgkmcnt(4)
    v_mfma_f32_16x16x32_bf16 v[16:19], v[88:91], v[124:127], v[176:179]
    s_waitcnt lgkmcnt(3)
    v_mfma_f32_16x16x32_bf16 v[24:27], v[90:93], v[128:131], v[176:179]
    v_max3_f32 v48, v32, v33, v34
    v_max3_f32 v49, v40, v41, v42
    s_nop 3
    v_max3_f32 v50, v16, v17, v18
    s_nop 0
    v_max3_f32 v51, v24, v25, v26
    v_max3_f32 v48, v48, v35, v36
    v_max3_f32 v49, v49, v43, v44
    v_max3_f32 v50, v50, v19, v20
    v_max3_f32 v51, v51, v27, v28
    v_max3_f32 v48, v48, v37, v38
    v_max3_f32 v49, v49, v45, v46
    v_max3_f32 v50, v50, v21, v22
    v_max3_f32 v51, v51, v29, v30
    v_max_f32 v48, v48, v39
    v_max_f32 v49, v49, v47
    v_max_f32 v50, v50, v23
    v_max_f32 v51, v51, v31
    v_mov_b32 v52, v48
    v_mov_b32 v53, v49
    v_mov_b32 v54, v50
    v_mov_b32 v55, v51
    v_permlane16_swap_b32 v48, v52
    v_permlane16_swap_b32 v49, v53
    v_permlane16_swap_b32 v50, v54
    v_permlane16_swap_b32 v51, v55
    v_max_f32 v48, v48, v52
    v_max_f32 v49, v49, v53
    v_max_f32 v50, v50, v54
    v_max_f32 v51, v51, v55
    v_mov_b32 v52, v48
    v_mov_b32 v53, v49
    v_mov_b32 v54, v50
    v_mov_b32 v55, v51
    v_permlane32_swap_b32 v48, v52
    v_permlane32_swap_b32 v49, v53
    v_permlane32_swap_b32 v50, v54
    v_permlane32_swap_b32 v51, v55
    v_max_f32 v48, v48, v52
    v_max_f32 v49, v49, v53
    v_max_f32 v50, v50, v54
    v_max_f32 v51, v51, v55
    v_mul_f32 v48, s52, v48
    v_mul_f32 v49, s52, v49
    v_mul_f32 v50, s52, v50
    v_mul_f32 v51, s52, v51
    v_fma_f32 v32, v32, s52, -v48
    v_fma_f32 v40, v40, s52, -v49
    v_fma_f32 v16, v16, s52, -v50
    v_fma_f32 v24, v24, s52, -v51
    v_fma_f32 v33, v33, s52, -v48
    v_fma_f32 v41, v41, s52, -v49
    v_fma_f32 v17, v17, s52, -v50
    v_fma_f32 v25, v25, s52, -v51
    v_fma_f32 v34, v34, s52, -v48
    v_fma_f32 v42, v42, s52, -v49
    v_fma_f32 v18, v18, s52, -v50
    v_fma_f32 v26, v26, s52, -v51
    v_fma_f32 v35, v35, s52, -v48
    v_fma_f32 v43, v43, s52, -v49
    v_fma_f32 v19, v19, s52, -v50
    v_fma_f32 v27, v27, s52, -v51
    v_fma_f32 v36, v36, s52, -v48
    v_fma_f32 v44, v44, s52, -v49
    v_fma_f32 v20, v20, s52, -v50
    v_fma_f32 v28, v28, s52, -v51
    v_fma_f32 v37, v37, s52, -v48
    v_fma_f32 v45, v45, s52, -v49
    v_fma_f32 v21, v21, s52, -v50
    v_fma_f32 v29, v29, s52, -v51
    v_fma_f32 v38, v38, s52, -v48
    v_fma_f32 v46, v46, s52, -v49
    v_fma_f32 v22, v22, s52, -v50
    v_fma_f32 v30, v30, s52, -v51
    v_fma_f32 v39, v39, s52, -v48
    v_fma_f32 v47, v47, s52, -v49
    v_fma_f32 v23, v23, s52, -v50
    v_fma_f32 v31, v31, s52, -v51
    v_exp_f32 v32, v32
    v_exp_f32 v40, v40
    v_exp_f32 v16, v16
    v_exp_f32 v24, v24
    v_exp_f32 v33, v33
    v_exp_f32 v41, v41
    v_exp_f32 v17, v17
    v_exp_f32 v25, v25
    v_exp_f32 v34, v34
    v_exp_f32 v42, v42
    v_exp_f32 v18, v18
    v_exp_f32 v26, v26
    v_exp_f32 v35, v35
    v_exp_f32 v43, v43
    v_exp_f32 v19, v19
    v_exp_f32 v27, v27
    v_exp_f32 v36, v36
    v_exp_f32 v44, v44
    v_exp_f32 v20, v20
    v_exp_f32 v28, v28
    v_exp_f32 v37, v37
    v_exp_f32 v45, v45
    v_exp_f32 v21, v21
    v_exp_f32 v29, v29
    v_exp_f32 v38, v38
    v_exp_f32 v46, v46
    v_exp_f32 v22, v22
    v_exp_f32 v30, v30
    v_exp_f32 v39, v39
    v_exp_f32 v47, v47
    v_exp_f32 v23, v23
    v_exp_f32 v31, v31
    v_cvt_pk_bf16_f32 v56, v32, v33
    v_cvt_pk_bf16_f32 v60, v40, v41
    v_cvt_pk_bf16_f32 v64, v16, v17
    v_cvt_pk_bf16_f32 v68, v24, v25
    v_cvt_pk_bf16_f32 v57, v34, v35
    v_cvt_pk_bf16_f32 v61, v42, v43
    v_cvt_pk_bf16_f32 v65, v18, v19
    v_cvt_pk_bf16_f32 v69, v26, v27
    v_cvt_pk_bf16_f32 v58, v36, v37
    v_cvt_pk_bf16_f32 v62, v44, v45
    v_cvt_pk_bf16_f32 v66, v20, v21
    v_cvt_pk_bf16_f32 v70, v28, v29
    v_cvt_pk_bf16_f32 v59, v38, v39
    v_cvt_pk_bf16_f32 v63, v46, v47
    v_cvt_pk_bf16_f32 v67, v22, v23
    v_cvt_pk_bf16_f32 v71, v30, v31
    v_mfma_f32_16x16x32_bf16 v[188:191], v[12:15], v[56:59], 0
    v_mfma_f32_16x16x32_bf16 v[180:183], v[108:111], v[56:59], 0
    v_mfma_f32_16x16x32_bf16 v[184:187], v[120:123], v[56:59], 0
    v_mfma_f32_16x16x32_bf16 v[200:203], v[12:15], v[60:63], 0
    v_mfma_f32_16x16x32_bf16 v[192:195], v[114:117], v[60:63], 0
    v_mfma_f32_16x16x32_bf16 v[196:199], v[120:123], v[60:63], 0
    v_mfma_f32_16x16x32_bf16 v[212:215], v[12:15], v[64:67], 0
    s_waitcnt lgkmcnt(2)
    v_mfma_f32_16x16x32_bf16 v[204:207], v[106:109], v[64:67], 0
    s_waitcnt lgkmcnt(0)
    v_mfma_f32_16x16x32_bf16 v[208:211], v[118:121], v[64:67], 0
    v_mfma_f32_16x16x32_bf16 v[224:227], v[12:15], v[68:71], 0
    v_mfma_f32_16x16x32_bf16 v[216:219], v[112:115], v[68:71], 0
    v_mfma_f32_16x16x32_bf16 v[220:223], v[118:121], v[68:71], 0
    s_lshl_b32 s53, s46, 4
    s_add_u32 s53, s53, s45
    s_lshl_b32 s54, s53, 10
    s_add_u32 s54, s54, 73662464
    s_lshl_b32 s55, s53, 7
    s_add_u32 s55, s55, 75759488
    v_lshlrev_b32 v6, 3, v1
    v_rcp_f32 v188, v188
    v_rcp_f32 v200, v200
    v_rcp_f32 v212, v212
    v_rcp_f32 v224, v224
    v_mul_f32 v180, v180, v188
    v_mul_f32 v181, v181, v188
    v_mul_f32 v182, v182, v188
    v_mul_f32 v183, v183, v188
    v_mul_f32 v184, v184, v188
    v_mul_f32 v185, v185, v188
    v_cvt_pk_bf16_f32 v76, v180, v181
    v_cvt_pk_bf16_f32 v77, v182, v183
    v_cvt_pk_bf16_f32 v82, v184, v185
    v_mul_f32 v192, v192, v200
    v_mul_f32 v193, v193, v200
    v_mul_f32 v194, v194, v200
    v_mul_f32 v195, v195, v200
    v_mul_f32 v198, v198, v200
    v_mul_f32 v199, v199, v200
    v_cvt_pk_bf16_f32 v78, v192, v193
    v_cvt_pk_bf16_f32 v79, v194, v195
    v_cvt_pk_bf16_f32 v83, v198, v199
    s_add_u32 s53, s54, 16384
    buffer_store_dwordx4 v[76:79], v2, s[4:7], s53 offen sc1
    v_mul_f32 v204, v204, v212
    v_mul_f32 v205, v205, v212
    v_mul_f32 v206, v206, v212
    v_mul_f32 v207, v207, v212
    v_mul_f32 v208, v208, v212
    v_mul_f32 v209, v209, v212
    v_cvt_pk_bf16_f32 v72, v204, v205
    v_cvt_pk_bf16_f32 v73, v206, v207
    v_cvt_pk_bf16_f32 v80, v208, v209
    v_mul_f32 v216, v216, v224
    v_mul_f32 v217, v217, v224
    v_mul_f32 v218, v218, v224
    v_mul_f32 v219, v219, v224
    v_mul_f32 v222, v222, v224
    v_mul_f32 v223, v223, v224
    v_cvt_pk_bf16_f32 v74, v216, v217
    v_cvt_pk_bf16_f32 v75, v218, v219
    v_cvt_pk_bf16_f32 v81, v222, v223
    s_add_u32 s53, s54, 0
    buffer_store_dwordx4 v[72:75], v2, s[4:7], s53 offen sc1
    s_mov_b32 exec_lo, 0xffff0000
    s_mov_b32 exec_hi, 0
    buffer_store_dwordx2 v[80:81], v6, s[4:7], s55 offen offset:0 sc1
    buffer_store_dwordx2 v[82:83], v6, s[4:7], s55 offen offset:2048 sc1
    s_mov_b64 exec, -1
    s_lshl_b32 s52, s44, 2
    s_add_u32 s52, s52, s20
    s_lshl_b32 s52, s52, 4
    s_add_u32 s52, s52, s45
    s_lshl_b32 s52, s52, 3
    s_add_u32 s52, s52, 3956736
    v_mov_b32 v8, s98
    v_mov_b32 v9, s99
    s_waitcnt vmcnt(0)
    s_mov_b64 exec, 1
    buffer_store_dwordx2 v[8:9], off, s[4:7], s52 sc1
    s_mov_b64 exec, -1
    s_cmp_ge_u32 s22, 24
    s_cbranch_scc1 L_next_46
    s_mul_i32 s44, s22, 10923
    s_lshr_b32 s44, s44, 16
    s_mul_i32 s52, s44, 6
    s_sub_u32 s45, s22, s52
    s_lshl_b32 s52, s21, 2
    s_add_u32 s44, s44, s52
    s_lshl_b32 s46, s44, 2
    s_add_u32 s46, s46, s20
    s_mul_i32 s47, s45, 110592
    s_mul_i32 s48, s20, 3072
    s_add_u32 s47, s47, s48
    s_add_u32 s47, s47, 2097152
    s_lshl_b32 s49, s46, 14
    s_add_u32 s49, s49, 73662464
    s_lshl_b32 s50, s46, 11
    s_add_u32 s50, s50, 75759616
    v_and_b32 v3, 15, v1
    v_lshrrev_b32 v4, 4, v1
    v_lshlrev_b32 v5, 3, v3
    v_lshl_add_u32 v5, v4, 8, v5
    s_lshl_b32 s52, s46, 4
    v_add_u32 v6, s52, v3
    v_lshlrev_b32 v7, 3, v6
    v_mul_u32_u24 v6, 1152, v6
    v_lshl_add_u32 v6, v4, 4, v6
    s_mul_i32 s51, s45, 192
    s_add_u32 s8, s42, 28311552
    s_addc_u32 s9, s43, 0
    s_mov_b32 s10, 0x240000
    s_mov_b32 s11, 0x20000
    s_mov_b32 m0, s48
    s_nop 0
    buffer_load_dwordx4 v2, s[4:7], s47 offen offset:0 lds
    buffer_load_dwordx4 v2, s[4:7], s47 offen offset:1024 lds
    buffer_load_dwordx4 v2, s[4:7], s47 offen offset:2048 lds
    s_add_u32 s48, s48, 12288
    s_add_u32 s47, s47, 12288
    s_mov_b32 m0, s48
    s_nop 0
    buffer_load_dwordx4 v2, s[4:7], s47 offen offset:0 lds
    buffer_load_dwordx4 v2, s[4:7], s47 offen offset:1024 lds
    buffer_load_dwordx4 v2, s[4:7], s47 offen offset:2048 lds
    s_add_u32 s48, s48, 12288
    s_add_u32 s47, s47, 12288
    s_mov_b32 m0, s48
    s_nop 0
    buffer_load_dwordx4 v2, s[4:7], s47 offen offset:0 lds
    buffer_load_dwordx4 v2, s[4:7], s47 offen offset:1024 lds
    buffer_load_dwordx4 v2, s[4:7], s47 offen offset:2048 lds
    s_add_u32 s48, s48, 12288
    s_add_u32 s47, s47, 12288
    s_mov_b32 m0, s48
    s_nop 0
    buffer_load_dwordx4 v2, s[4:7], s47 offen offset:0 lds
    buffer_load_dwordx4 v2, s[4:7], s47 offen offset:1024 lds
    buffer_load_dwordx4 v2, s[4:7], s47 offen offset:2048 lds
    s_add_u32 s48, s48, 12288
    s_add_u32 s47, s47, 12288
    s_mov_b32 m0, s48
    s_nop 0
    buffer_load_dwordx4 v2, s[4:7], s47 offen offset:0 lds
    buffer_load_dwordx4 v2, s[4:7], s47 offen offset:1024 lds
    buffer_load_dwordx4 v2, s[4:7], s47 offen offset:2048 lds
    s_add_u32 s48, s48, 12288
    s_add_u32 s47, s47, 12288
    s_mov_b32 m0, s48
    s_nop 0
    buffer_load_dwordx4 v2, s[4:7], s47 offen offset:0 lds
    buffer_load_dwordx4 v2, s[4:7], s47 offen offset:1024 lds
    buffer_load_dwordx4 v2, s[4:7], s47 offen offset:2048 lds
    s_add_u32 s48, s48, 12288
    s_add_u32 s47, s47, 12288
    s_mov_b32 m0, s48
    s_nop 0
    buffer_load_dwordx4 v2, s[4:7], s47 offen offset:0 lds
    buffer_load_dwordx4 v2, s[4:7], s47 offen offset:1024 lds
    buffer_load_dwordx4 v2, s[4:7], s47 offen offset:2048 lds
    s_add_u32 s48, s48, 12288
    s_add_u32 s47, s47, 12288
    s_mov_b32 m0, s48
    s_nop 0
    buffer_load_dwordx4 v2, s[4:7], s47 offen offset:0 lds
    buffer_load_dwordx4 v2, s[4:7], s47 offen offset:1024 lds
    buffer_load_dwordx4 v2, s[4:7], s47 offen offset:2048 lds
    s_add_u32 s48, s48, 12288
    s_add_u32 s47, s47, 12288
    s_mov_b32 m0, s48
    s_nop 0
    buffer_load_dwordx4 v2, s[4:7], s47 offen offset:0 lds
    buffer_load_dwordx4 v2, s[4:7], s47 offen offset:1024 lds
    buffer_load_dwordx4 v2, s[4:7], s47 offen offset:2048 lds
    s_add_u32 s48, s48, 12288
    s_add_u32 s47, s47, 12288
    s_lshr_b32 s52, s46, 1
    s_lshl_b32 s52, s52, 7
    s_add_u32 s52, s52, 3956736
    v_and_b32 v10, 15, v1
    v_lshlrev_b32 v10, 3, v10
    s_mul_i32 s53, s45, 2816
    s_min_u32 s53, s53, 13568
    s_add_u32 s53, s53, s49
    buffer_load_dwordx4 v[160:163], v6, s[8:11], s51 offen offset:0 sc1
    buffer_load_dwordx4 v[164:167], v6, s[8:11], s51 offen offset:64 sc1
    buffer_load_dwordx4 v[168:171], v6, s[8:11], s51 offen offset:128 sc1
    v_mov_b32 v8, v2
    s_waitcnt vmcnt(3)
    s_barrier
    buffer_load_dwordx2 v[12:13], v10, s[4:7], s52 offen sc1
    ds_read_b128 a[0:3], v8 offset:0
    ds_read_b128 a[4:7], v8 offset:1024
    ds_read_b128 a[8:11], v8 offset:2048
    ds_read_b128 a[12:15], v8 offset:3072
    ds_read_b128 a[16:19], v8 offset:4096
    ds_read_b128 a[20:23], v8 offset:5120
    ds_read_b128 a[24:27], v8 offset:6144
    ds_read_b128 a[28:31], v8 offset:7168
    ds_read_b128 a[32:35], v8 offset:8192
    ds_read_b128 a[36:39], v8 offset:9216
    ds_read_b128 a[40:43], v8 offset:10240
    ds_read_b128 a[44:47], v8 offset:11264
    ds_read_b128 a[48:51], v8 offset:12288
    ds_read_b128 a[52:55], v8 offset:13312
    ds_read_b128 a[56:59], v8 offset:14336
    ds_read_b128 a[60:63], v8 offset:15360
    ds_read_b128 a[64:67], v8 offset:16384
    ds_read_b128 a[68:71], v8 offset:17408
    ds_read_b128 a[72:75], v8 offset:18432
    ds_read_b128 a[76:79], v8 offset:19456
    ds_read_b128 a[80:83], v8 offset:20480
    ds_read_b128 a[84:87], v8 offset:21504
    ds_read_b128 a[88:91], v8 offset:22528
    ds_read_b128 a[92:95], v8 offset:23552
    ds_read_b128 v[112:115], v8 offset:24576
    ds_read_b128 v[116:119], v8 offset:25600
    ds_read_b128 v[120:123], v8 offset:26624
    ds_read_b128 v[124:127], v8 offset:27648
    ds_read_b128 v[128:131], v8 offset:28672
    ds_read_b128 v[132:135], v8 offset:29696
    ds_read_b128 v[136:139], v8 offset:30720
    ds_read_b128 v[140:143], v8 offset:31744
    ds_read_b128 v[144:147], v8 offset:32768
    ds_read_b128 v[148:151], v8 offset:33792
    s_waitcnt vmcnt(0)
    v_cmp_eq_u64 vcc, s[98:99], v[12:13]
    s_nop 0
    s_cmp_eq_u64 vcc, exec
    s_cbranch_scc0 L_po_slow_106
L_po_back_107:
    buffer_load_dwordx4 v[16:19], v2, s[4:7], s49 offen offset:0 sc1
    buffer_load_dwordx4 v[20:23], v2, s[4:7], s49 offen offset:1024 sc1
    buffer_load_dwordx4 v[24:27], v2, s[4:7], s49 offen offset:2048 sc1
    buffer_load_dwordx4 v[28:31], v2, s[4:7], s49 offen offset:3072 sc1
    s_add_u32 s49, s49, 4096
    buffer_load_dwordx4 v[32:35], v2, s[4:7], s49 offen offset:0 sc1
    buffer_load_dwordx4 v[36:39], v2, s[4:7], s49 offen offset:1024 sc1
    buffer_load_dwordx4 v[40:43], v2, s[4:7], s49 offen offset:2048 sc1
    buffer_load_dwordx4 v[44:47], v2, s[4:7], s49 offen offset:3072 sc1
    s_waitcnt vmcnt(7) lgkmcnt(15)
    s_add_u32 s49, s49, 4096
    v_mfma_f32_16x16x32_bf16 v[88:91], a[0:3], v[16:19], 0
    buffer_load_dwordx4 v[48:51], v2, s[4:7], s49 offen offset:0 sc1
    s_waitcnt lgkmcnt(15)
    v_mfma_f32_16x16x32_bf16 v[92:95], a[4:7], v[16:19], 0
    s_waitcnt lgkmcnt(15)
    v_mfma_f32_16x16x32_bf16 v[96:99], a[8:11], v[16:19], 0
    s_waitcnt lgkmcnt(15)
    v_mfma_f32_16x16x32_bf16 v[100:103], a[12:15], v[16:19], 0
    buffer_load_dwordx4 v[52:55], v2, s[4:7], s49 offen offset:1024 sc1
    s_waitcnt lgkmcnt(15)
    v_mfma_f32_16x16x32_bf16 v[104:107], a[16:19], v[16:19], 0
    s_waitcnt lgkmcnt(15)
    v_mfma_f32_16x16x32_bf16 v[108:111], a[20:23], v[16:19], 0
    s_waitcnt vmcnt(8) lgkmcnt(15)
    v_mfma_f32_16x16x32_bf16 v[88:91], a[24:27], v[20:23], v[88:91]
    buffer_load_dwordx4 v[56:59], v2, s[4:7], s49 offen offset:2048 sc1
    s_waitcnt lgkmcnt(15)
    v_mfma_f32_16x16x32_bf16 v[92:95], a[28:31], v[20:23], v[92:95]
    s_waitcnt lgkmcnt(15)
    v_mfma_f32_16x16x32_bf16 v[96:99], a[32:35], v[20:23], v[96:99]
    s_waitcnt lgkmcnt(15)
    v_mfma_f32_16x16x32_bf16 v[100:103], a[36:39], v[20:23], v[100:103]
    buffer_load_dwordx4 v[60:63], v2, s[4:7], s49 offen offset:3072 sc1
    s_waitcnt lgkmcnt(15)
    v_mfma_f32_16x16x32_bf16 v[104:107], a[40:43], v[20:23], v[104:107]
    s_waitcnt lgkmcnt(15)
    s_add_u32 s49, s49, 4096
    v_mfma_f32_16x16x32_bf16 v[108:111], a[44:47], v[20:23], v[108:111]
    s_waitcnt vmcnt(9) lgkmcnt(15)
    v_mfma_f32_16x16x32_bf16 v[88:91], a[48:51], v[24:27], v[88:91]
    buffer_load_dwordx4 v[64:67], v2, s[4:7], s49 offen offset:0 sc1
    s_waitcnt lgkmcnt(15)
    v_mfma_f32_16x16x32_bf16 v[92:95], a[52:55], v[24:27], v[92:95]
    s_waitcnt lgkmcnt(15)
    v_mfma_f32_16x16x32_bf16 v[96:99], a[56:59], v[24:27], v[96:99]
    s_waitcnt lgkmcnt(15)
    v_mfma_f32_16x16x32_bf16 v[100:103], a[60:63], v[24:27], v[100:103]
    buffer_load_dwordx4 v[68:71], v2, s[4:7], s49 offen offset:1024 sc1
    s_waitcnt lgkmcnt(15)
    v_mfma_f32_16x16x32_bf16 v[104:107], a[64:67], v[24:27], v[104:107]
    s_waitcnt lgkmcnt(15)
    v_mfma_f32_16x16x32_bf16 v[108:111], a[68:71], v[24:27], v[108:111]
    s_waitcnt vmcnt(10) lgkmcnt(15)
    v_mfma_f32_16x16x32_bf16 v[88:91], a[72:75], v[28:31], v[88:91]
    buffer_load_dwordx4 v[72:75], v2, s[4:7], s49 offen offset:2048 sc1
    s_waitcnt lgkmcnt(14)
    v_mfma_f32_16x16x32_bf16 v[92:95], a[76:79], v[28:31], v[92:95]
    s_waitcnt lgkmcnt(13)
    v_mfma_f32_16x16x32_bf16 v[96:99], a[80:83], v[28:31], v[96:99]
    s_waitcnt lgkmcnt(12)
    v_mfma_f32_16x16x32_bf16 v[100:103], a[84:87], v[28:31], v[100:103]
    buffer_load_dwordx4 v[76:79], v2, s[4:7], s49 offen offset:3072 sc1
    s_waitcnt lgkmcnt(11)
    v_mfma_f32_16x16x32_bf16 v[104:107], a[88:91], v[28:31], v[104:107]
    s_waitcnt lgkmcnt(10)
    v_mfma_f32_16x16x32_bf16 v[108:111], a[92:95], v[28:31], v[108:111]
    s_waitcnt vmcnt(11) lgkmcnt(9)
    v_mfma_f32_16x16x32_bf16 v[88:91], v[112:115], v[32:35], v[88:91]
    s_waitcnt lgkmcnt(8)
    ds_read_b128 v[152:155], v8 offset:34816
    v_mfma_f32_16x16x32_bf16 v[92:95], v[116:119], v[32:35], v[92:95]
    s_waitcnt lgkmcnt(8)
    ds_read_b128 v[156:159], v8 offset:35840
    v_mfma_f32_16x16x32_bf16 v[96:99], v[120:123], v[32:35], v[96:99]
    s_waitcnt lgkmcnt(8)
    ds_read_b128 v[112:115], v8 offset:36864
    v_mfma_f32_16x16x32_bf16 v[100:103], v[124:127], v[32:35], v[100:103]
    s_waitcnt lgkmcnt(8)
    ds_read_b128 v[116:119], v8 offset:37888
    v_mfma_f32_16x16x32_bf16 v[104:107], v[128:131], v[32:35], v[104:107]
    s_waitcnt lgkmcnt(8)
    ds_read_b128 v[120:123], v8 offset:38912
    v_mfma_f32_16x16x32_bf16 v[108:111], v[132:135], v[32:35], v[108:111]
    s_waitcnt vmcnt(10) lgkmcnt(8)
    ds_read_b128 v[124:127], v8 offset:39936
    v_mfma_f32_16x16x32_bf16 v[88:91], v[136:139], v[36:39], v[88:91]
    s_waitcnt lgkmcnt(8)
    ds_read_b128 v[128:131], v8 offset:40960
    v_mfma_f32_16x16x32_bf16 v[92:95], v[140:143], v[36:39], v[92:95]
    s_waitcnt lgkmcnt(8)
    ds_read_b128 v[132:135], v8 offset:41984
    v_mfma_f32_16x16x32_bf16 v[96:99], v[144:147], v[36:39], v[96:99]
    s_waitcnt lgkmcnt(8)
    ds_read_b128 v[136:139], v8 offset:43008
    v_mfma_f32_16x16x32_bf16 v[100:103], v[148:151], v[36:39], v[100:103]
    s_waitcnt lgkmcnt(8)
    ds_read_b128 v[140:143], v8 offset:44032
    v_mfma_f32_16x16x32_bf16 v[104:107], v[152:155], v[36:39], v[104:107]
    s_waitcnt lgkmcnt(8)
    ds_read_b128 v[144:147], v8 offset:45056
    v_mfma_f32_16x16x32_bf16 v[108:111], v[156:159], v[36:39], v[108:111]
    s_waitcnt vmcnt(9) lgkmcnt(8)
    ds_read_b128 v[148:151], v8 offset:46080
    v_mfma_f32_16x16x32_bf16 v[88:91], v[112:115], v[40:43], v[88:91]
    s_waitcnt lgkmcnt(8)
    ds_read_b128 v[152:155], v8 offset:47104
    v_mfma_f32_16x16x32_bf16 v[92:95], v[116:119], v[40:43], v[92:95]
    s_waitcnt lgkmcnt(8)
    ds_read_b128 v[156:159], v8 offset:48128
    v_mfma_f32_16x16x32_bf16 v[96:99], v[120:123], v[40:43], v[96:99]
    s_waitcnt lgkmcnt(8)
    ds_read_b128 v[112:115], v8 offset:49152
    v_mfma_f32_16x16x32_bf16 v[100:103], v[124:127], v[40:43], v[100:103]
    s_waitcnt lgkmcnt(8)
    ds_read_b128 v[116:119], v8 offset:50176
    v_mfma_f32_16x16x32_bf16 v[104:107], v[128:131], v[40:43], v[104:107]
    s_waitcnt lgkmcnt(8)
    ds_read_b128 v[120:123], v8 offset:51200
    v_mfma_f32_16x16x32_bf16 v[108:111], v[132:135], v[40:43], v[108:111]
    s_waitcnt vmcnt(8) lgkmcnt(8)
    ds_read_b128 v[124:127], v8 offset:52224
    v_mfma_f32_16x16x32_bf16 v[88:91], v[136:139], v[44:47], v[88:91]
    s_waitcnt lgkmcnt(8)
    ds_read_b128 v[128:131], v8 offset:53248
    v_mfma_f32_16x16x32_bf16 v[92:95], v[140:143], v[44:47], v[92:95]
    s_waitcnt lgkmcnt(8)
    ds_read_b128 v[132:135], v8 offset:54272
    v_mfma_f32_16x16x32_bf16 v[96:99], v[144:147], v[44:47], v[96:99]
    s_waitcnt lgkmcnt(8)
    ds_read_b128 v[136:139], v8 offset:55296
    v_mfma_f32_16x16x32_bf16 v[100:103], v[148:151], v[44:47], v[100:103]
    s_waitcnt lgkmcnt(8)
    ds_read_b128 v[140:143], v8 offset:56320
    v_mfma_f32_16x16x32_bf16 v[104:107], v[152:155], v[44:47], v[104:107]
    s_waitcnt lgkmcnt(8)
    ds_read_b128 v[144:147], v8 offset:57344
    v_mfma_f32_16x16x32_bf16 v[108:111], v[156:159], v[44:47], v[108:111]
    s_waitcnt vmcnt(7) lgkmcnt(8)
    ds_read_b128 v[148:151], v8 offset:58368
    v_mfma_f32_16x16x32_bf16 v[88:91], v[112:115], v[48:51], v[88:91]
    s_waitcnt lgkmcnt(8)
    ds_read_b128 v[152:155], v8 offset:59392
    v_mfma_f32_16x16x32_bf16 v[92:95], v[116:119], v[48:51], v[92:95]
    s_waitcnt lgkmcnt(8)
    ds_read_b128 v[156:159], v8 offset:60416
    v_mfma_f32_16x16x32_bf16 v[96:99], v[120:123], v[48:51], v[96:99]
    s_waitcnt lgkmcnt(8)
    v_add_u32 v8, 61440, v8
    ds_read_b128 v[112:115], v8 offset:0
    v_mfma_f32_16x16x32_bf16 v[100:103], v[124:127], v[48:51], v[100:103]
    s_waitcnt lgkmcnt(8)
    ds_read_b128 v[116:119], v8 offset:1024
    v_mfma_f32_16x16x32_bf16 v[104:107], v[128:131], v[48:51], v[104:107]
    s_waitcnt lgkmcnt(8)
    ds_read_b128 v[120:123], v8 offset:2048
    v_mfma_f32_16x16x32_bf16 v[108:111], v[132:135], v[48:51], v[108:111]
    s_waitcnt vmcnt(6) lgkmcnt(8)
    ds_read_b128 v[124:127], v8 offset:3072
    v_mfma_f32_16x16x32_bf16 v[88:91], v[136:139], v[52:55], v[88:91]
    s_waitcnt lgkmcnt(8)
    ds_read_b128 v[128:131], v8 offset:4096
    v_mfma_f32_16x16x32_bf16 v[92:95], v[140:143], v[52:55], v[92:95]
    s_waitcnt lgkmcnt(8)
    ds_read_b128 v[132:135], v8 offset:5120
    v_mfma_f32_16x16x32_bf16 v[96:99], v[144:147], v[52:55], v[96:99]
    s_waitcnt lgkmcnt(8)
    ds_read_b128 v[136:139], v8 offset:6144
    v_mfma_f32_16x16x32_bf16 v[100:103], v[148:151], v[52:55], v[100:103]
    s_waitcnt lgkmcnt(8)
    ds_read_b128 v[140:143], v8 offset:7168
    v_mfma_f32_16x16x32_bf16 v[104:107], v[152:155], v[52:55], v[104:107]
    s_waitcnt lgkmcnt(8)
    ds_read_b128 v[144:147], v8 offset:8192
    v_mfma_f32_16x16x32_bf16 v[108:111], v[156:159], v[52:55], v[108:111]
    s_waitcnt vmcnt(5) lgkmcnt(8)
    ds_read_b128 v[148:151], v8 offset:9216
    v_mfma_f32_16x16x32_bf16 v[88:91], v[112:115], v[56:59], v[88:91]
    s_waitcnt lgkmcnt(8)
    ds_read_b128 v[152:155], v8 offset:10240
    v_mfma_f32_16x16x32_bf16 v[92:95], v[116:119], v[56:59], v[92:95]
    s_waitcnt lgkmcnt(8)
    ds_read_b128 v[156:159], v8 offset:11264
    v_mfma_f32_16x16x32_bf16 v[96:99], v[120:123], v[56:59], v[96:99]
    s_waitcnt lgkmcnt(8)
    ds_read_b128 v[112:115], v8 offset:12288
    v_mfma_f32_16x16x32_bf16 v[100:103], v[124:127], v[56:59], v[100:103]
    s_waitcnt lgkmcnt(8)
    ds_read_b128 v[116:119], v8 offset:13312
    v_mfma_f32_16x16x32_bf16 v[104:107], v[128:131], v[56:59], v[104:107]
    s_waitcnt lgkmcnt(8)
    ds_read_b128 v[120:123], v8 offset:14336
    v_mfma_f32_16x16x32_bf16 v[108:111], v[132:135], v[56:59], v[108:111]
    ds_read_b128 v[124:127], v8 offset:15360
    buffer_load_dwordx2 v[80:81], v5, s[4:7], s50 offen offset:0 sc1
    buffer_load_dwordx2 v[82:83], v5, s[4:7], s50 offen offset:128 sc1
    s_waitcnt vmcnt(6) lgkmcnt(9)
    v_mfma_f32_16x16x32_bf16 v[88:91], v[136:139], v[60:63], v[88:91]
    s_waitcnt lgkmcnt(8)
    ds_read_b128 v[128:131], v8 offset:16384
    v_mfma_f32_16x16x32_bf16 v[92:95], v[140:143], v[60:63], v[92:95]
    s_waitcnt lgkmcnt(8)
    ds_read_b128 v[132:135], v8 offset:17408
    v_mfma_f32_16x16x32_bf16 v[96:99], v[144:147], v[60:63], v[96:99]
    s_waitcnt lgkmcnt(8)
    ds_read_b128 v[136:139], v8 offset:18432
    v_mfma_f32_16x16x32_bf16 v[100:103], v[148:151], v[60:63], v[100:103]
    s_waitcnt lgkmcnt(8)
    ds_read_b128 v[140:143], v8 offset:19456
    v_mfma_f32_16x16x32_bf16 v[104:107], v[152:155], v[60:63], v[104:107]
    s_waitcnt lgkmcnt(8)
    ds_read_b128 v[144:147], v8 offset:20480
    v_mfma_f32_16x16x32_bf16 v[108:111], v[156:159], v[60:63], v[108:111]
    ds_read_b128 v[148:151], v8 offset:21504
    buffer_load_dwordx2 v[84:85], v5, s[4:7], s50 offen offset:1024 sc1
    buffer_load_dwordx2 v[86:87], v5, s[4:7], s50 offen offset:1152 sc1
    s_waitcnt vmcnt(7) lgkmcnt(9)
    v_mfma_f32_16x16x32_bf16 v[88:91], v[112:115], v[64:67], v[88:91]
    s_waitcnt lgkmcnt(8)
    ds_read_b128 v[152:155], v8 offset:22528
    v_mfma_f32_16x16x32_bf16 v[92:95], v[116:119], v[64:67], v[92:95]
    s_waitcnt lgkmcnt(8)
    ds_read_b128 v[156:159], v8 offset:23552
    v_mfma_f32_16x16x32_bf16 v[96:99], v[120:123], v[64:67], v[96:99]
    s_waitcnt lgkmcnt(8)
    ds_read_b128 v[112:115], v8 offset:24576
    v_mfma_f32_16x16x32_bf16 v[100:103], v[124:127], v[64:67], v[100:103]
    s_waitcnt lgkmcnt(8)
    ds_read_b128 v[116:119], v8 offset:25600
    v_mfma_f32_16x16x32_bf16 v[104:107], v[128:131], v[64:67], v[104:107]
    s_waitcnt lgkmcnt(8)
    ds_read_b128 v[120:123], v8 offset:26624
    v_mfma_f32_16x16x32_bf16 v[108:111], v[132:135], v[64:67], v[108:111]
    s_waitcnt vmcnt(6) lgkmcnt(8)
    ds_read_b128 v[124:127], v8 offset:27648
    v_mfma_f32_16x16x32_bf16 v[88:91], v[136:139], v[68:71], v[88:91]
    s_waitcnt lgkmcnt(8)
    ds_read_b128 v[128:131], v8 offset:28672
    v_mfma_f32_16x16x32_bf16 v[92:95], v[140:143], v[68:71], v[92:95]
    s_waitcnt lgkmcnt(8)
    ds_read_b128 v[132:135], v8 offset:29696
    v_mfma_f32_16x16x32_bf16 v[96:99], v[144:147], v[68:71], v[96:99]
    s_waitcnt lgkmcnt(8)
    ds_read_b128 v[136:139], v8 offset:30720
    v_mfma_f32_16x16x32_bf16 v[100:103], v[148:151], v[68:71], v[100:103]
    s_waitcnt lgkmcnt(8)
    ds_read_b128 v[140:143], v8 offset:31744
    v_mfma_f32_16x16x32_bf16 v[104:107], v[152:155], v[68:71], v[104:107]
    s_waitcnt lgkmcnt(8)
    ds_read_b128 v[144:147], v8 offset:32768
    v_mfma_f32_16x16x32_bf16 v[108:111], v[156:159], v[68:71], v[108:111]
    s_waitcnt vmcnt(5) lgkmcnt(8)
    ds_read_b128 v[148:151], v8 offset:33792
    v_mfma_f32_16x16x32_bf16 v[88:91], v[112:115], v[72:75], v[88:91]
    s_waitcnt lgkmcnt(8)
    ds_read_b128 v[152:155], v8 offset:34816
    v_mfma_f32_16x16x32_bf16 v[92:95], v[116:119], v[72:75], v[92:95]
    s_waitcnt lgkmcnt(8)
    ds_read_b128 v[156:159], v8 offset:35840
    v_mfma_f32_16x16x32_bf16 v[96:99], v[120:123], v[72:75], v[96:99]
    s_waitcnt lgkmcnt(8)
    ds_read_b128 v[112:115], v8 offset:36864
    v_mfma_f32_16x16x32_bf16 v[100:103], v[124:127], v[72:75], v[100:103]
    s_waitcnt lgkmcnt(8)
    ds_read_b128 v[116:119], v8 offset:37888
    v_mfma_f32_16x16x32_bf16 v[104:107], v[128:131], v[72:75], v[104:107]
    s_waitcnt lgkmcnt(8)
    ds_read_b128 v[120:123], v8 offset:38912
    v_mfma_f32_16x16x32_bf16 v[108:111], v[132:135], v[72:75], v[108:111]
    s_waitcnt vmcnt(4) lgkmcnt(8)
    ds_read_b128 v[124:127], v8 offset:39936
    v_mfma_f32_16x16x32_bf16 v[88:91], v[136:139], v[76:79], v[88:91]
    s_waitcnt lgkmcnt(8)
    ds_read_b128 v[128:131], v8 offset:40960
    v_mfma_f32_16x16x32_bf16 v[92:95], v[140:143], v[76:79], v[92:95]
    s_waitcnt lgkmcnt(8)
    ds_read_b128 v[132:135], v8 offset:41984
    v_mfma_f32_16x16x32_bf16 v[96:99], v[144:147], v[76:79], v[96:99]
    s_waitcnt lgkmcnt(8)
    ds_read_b128 v[136:139], v8 offset:43008
    v_mfma_f32_16x16x32_bf16 v[100:103], v[148:151], v[76:79], v[100:103]
    s_waitcnt lgkmcnt(8)
    ds_read_b128 v[140:143], v8 offset:44032
    v_mfma_f32_16x16x32_bf16 v[104:107], v[152:155], v[76:79], v[104:107]
    s_waitcnt lgkmcnt(8)
    ds_read_b128 v[144:147], v8 offset:45056
    v_mfma_f32_16x16x32_bf16 v[108:111], v[156:159], v[76:79], v[108:111]
    s_waitcnt vmcnt(2) lgkmcnt(8)
    ds_read_b128 v[148:151], v8 offset:46080
    v_mfma_f32_16x16x32_bf16 v[88:91], v[112:115], v[80:83], v[88:91]
    s_waitcnt lgkmcnt(8)
    ds_read_b128 v[152:155], v8 offset:47104
    v_mfma_f32_16x16x32_bf16 v[92:95], v[116:119], v[80:83], v[92:95]
    s_waitcnt lgkmcnt(8)
    ds_read_b128 v[156:159], v8 offset:48128
    v_mfma_f32_16x16x32_bf16 v[96:99], v[120:123], v[80:83], v[96:99]
    s_waitcnt lgkmcnt(8)
    v_mfma_f32_16x16x32_bf16 v[100:103], v[124:127], v[80:83], v[100:103]
    s_waitcnt lgkmcnt(7)
    v_mfma_f32_16x16x32_bf16 v[104:107], v[128:131], v[80:83], v[104:107]
    s_waitcnt lgkmcnt(6)
    v_mfma_f32_16x16x32_bf16 v[108:111], v[132:135], v[80:83], v[108:111]
    s_waitcnt vmcnt(0) lgkmcnt(5)
    v_mfma_f32_16x16x32_bf16 v[88:91], v[136:139], v[84:87], v[88:91]
    s_waitcnt lgkmcnt(4)
    v_mfma_f32_16x16x32_bf16 v[92:95], v[140:143], v[84:87], v[92:95]
    s_waitcnt lgkmcnt(3)
    v_mfma_f32_16x16x32_bf16 v[96:99], v[144:147], v[84:87], v[96:99]
    s_waitcnt lgkmcnt(2)
    v_mfma_f32_16x16x32_bf16 v[100:103], v[148:151], v[84:87], v[100:103]
    s_waitcnt lgkmcnt(1)
    v_mfma_f32_16x16x32_bf16 v[104:107], v[152:155], v[84:87], v[104:107]
    s_waitcnt lgkmcnt(0)
    v_mfma_f32_16x16x32_bf16 v[108:111], v[156:159], v[84:87], v[108:111]
    v_lshlrev_b32 v16, 16, v160
    v_and_b32 v17, 0xffff0000, v160
    v_lshlrev_b32 v18, 16, v161
    v_and_b32 v19, 0xffff0000, v161
    v_lshlrev_b32 v20, 16, v162
    v_and_b32 v21, 0xffff0000, v162
    v_lshlrev_b32 v22, 16, v163
    v_and_b32 v23, 0xffff0000, v163
    v_lshlrev_b32 v24, 16, v164
    v_and_b32 v25, 0xffff0000, v164
    v_lshlrev_b32 v26, 16, v165
    v_and_b32 v27, 0xffff0000, v165
    v_lshlrev_b32 v28, 16, v166
    v_and_b32 v29, 0xffff0000, v166
    v_lshlrev_b32 v30, 16, v167
    v_and_b32 v31, 0xffff0000, v167
    v_lshlrev_b32 v32, 16, v168
    v_and_b32 v33, 0xffff0000, v168
    v_lshlrev_b32 v34, 16, v169
    v_and_b32 v35, 0xffff0000, v169
    v_lshlrev_b32 v36, 16, v170
    v_and_b32 v37, 0xffff0000, v170
    v_lshlrev_b32 v38, 16, v171
    v_and_b32 v39, 0xffff0000, v171
    v_add_f32 v16, v16, v88
    v_add_f32 v17, v17, v89
    v_add_f32 v18, v18, v90
    v_add_f32 v19, v19, v91
    v_add_f32 v20, v20, v92
    v_add_f32 v21, v21, v93
    v_add_f32 v22, v22, v94
    v_add_f32 v23, v23, v95
    v_add_f32 v24, v24, v96
    v_add_f32 v25, v25, v97
    v_add_f32 v26, v26, v98
    v_add_f32 v27, v27, v99
    v_add_f32 v28, v28, v100
    v_add_f32 v29, v29, v101
    v_add_f32 v30, v30, v102
    v_add_f32 v31, v31, v103
    v_add_f32 v32, v32, v104
    v_add_f32 v33, v33, v105
    v_add_f32 v34, v34, v106
    v_add_f32 v35, v35, v107
    v_add_f32 v36, v36, v108
    v_add_f32 v37, v37, v109
    v_add_f32 v38, v38, v110
    v_add_f32 v39, v39, v111
    s_mul_i32 s52, s46, 18
    s_mul_i32 s53, s45, 3
    s_add_u32 s52, s52, s53
    s_lshl_b32 s52, s52, 10
    s_add_u32 s52, s52, 76021760
    v_cvt_pk_bf16_f32 v40, v16, v17
    v_cvt_pk_bf16_f32 v41, v18, v19
    v_cvt_pk_bf16_f32 v42, v20, v21
    v_cvt_pk_bf16_f32 v43, v22, v23
    buffer_store_dwordx4 v[40:43], v2, s[4:7], s52 offen offset:0 sc1
    v_cvt_pk_bf16_f32 v44, v24, v25
    v_cvt_pk_bf16_f32 v45, v26, v27
    v_cvt_pk_bf16_f32 v46, v28, v29
    v_cvt_pk_bf16_f32 v47, v30, v31
    buffer_store_dwordx4 v[44:47], v2, s[4:7], s52 offen offset:1024 sc1
    v_cvt_pk_bf16_f32 v48, v32, v33
    v_cvt_pk_bf16_f32 v49, v34, v35
    v_cvt_pk_bf16_f32 v50, v36, v37
    v_cvt_pk_bf16_f32 v51, v38, v39
    buffer_store_dwordx4 v[48:51], v2, s[4:7], s52 offen offset:2048 sc1
    v_lshlrev_b32 v16, 16, v40
    v_and_b32 v17, 0xffff0000, v40
    v_lshlrev_b32 v18, 16, v41
    v_and_b32 v19, 0xffff0000, v41
    v_lshlrev_b32 v20, 16, v42
    v_and_b32 v21, 0xffff0000, v42
    v_lshlrev_b32 v22, 16, v43
    v_and_b32 v23, 0xffff0000, v43
    v_lshlrev_b32 v24, 16, v44
    v_and_b32 v25, 0xffff0000, v44
    v_lshlrev_b32 v26, 16, v45
    v_and_b32 v27, 0xffff0000, v45
    v_lshlrev_b32 v28, 16, v46
    v_and_b32 v29, 0xffff0000, v46
    v_lshlrev_b32 v30, 16, v47
    v_and_b32 v31, 0xffff0000, v47
    v_lshlrev_b32 v32, 16, v48
    v_and_b32 v33, 0xffff0000, v48
    v_lshlrev_b32 v34, 16, v49
    v_and_b32 v35, 0xffff0000, v49
    v_lshlrev_b32 v36, 16, v50
    v_and_b32 v37, 0xffff0000, v50
    v_lshlrev_b32 v38, 16, v51
    v_and_b32 v39, 0xffff0000, v51
    v_add_f32 v56, v16, v17
    v_add_f32 v58, v18, v19
    v_add_f32 v56, v56, v20
    v_add_f32 v58, v58, v21
    v_add_f32 v56, v56, v22
    v_add_f32 v58, v58, v23
    v_add_f32 v56, v56, v24
    v_add_f32 v58, v58, v25
    v_add_f32 v56, v56, v26
    v_add_f32 v58, v58, v27
    v_add_f32 v56, v56, v28
    v_add_f32 v58, v58, v29
    v_add_f32 v56, v56, v30
    v_add_f32 v58, v58, v31
    v_add_f32 v56, v56, v32
    v_add_f32 v58, v58, v33
    v_add_f32 v56, v56, v34
    v_add_f32 v58, v58, v35
    v_add_f32 v56, v56, v36
    v_add_f32 v58, v58, v37
    v_add_f32 v56, v56, v38
    v_add_f32 v58, v58, v39
    v_add_f32 v56, v56, v58
    v_mov_b32 v58, v56
    s_nop 1
    v_permlane16_swap_b32 v56, v58
    v_add_f32 v56, v56, v58
    v_mov_b32 v58, v56
    s_nop 1
    v_permlane32_swap_b32 v56, v58
    v_add_f32 v56, v56, v58
    v_mul_f32 v59, 0x3c2aaaab, v56
    v_sub_f32 v58, v16, v59
    v_mul_f32 v57, v58, v58
    v_sub_f32 v61, v17, v59
    v_fmac_f32 v57, v61, v61
    v_sub_f32 v60, v18, v59
    v_fmac_f32 v57, v60, v60
    v_sub_f32 v61, v19, v59
    v_fmac_f32 v57, v61, v61
    v_sub_f32 v60, v20, v59
    v_fmac_f32 v57, v60, v60
    v_sub_f32 v61, v21, v59
    v_fmac_f32 v57, v61, v61
    v_sub_f32 v60, v22, v59
    v_fmac_f32 v57, v60, v60
    v_sub_f32 v61, v23, v59
    v_fmac_f32 v57, v61, v61
    v_sub_f32 v60, v24, v59
    v_fmac_f32 v57, v60, v60
    v_sub_f32 v61, v25, v59
    v_fmac_f32 v57, v61, v61
    v_sub_f32 v60, v26, v59
    v_fmac_f32 v57, v60, v60
    v_sub_f32 v61, v27, v59
    v_fmac_f32 v57, v61, v61
    v_sub_f32 v60, v28, v59
    v_fmac_f32 v57, v60, v60
    v_sub_f32 v61, v29, v59
    v_fmac_f32 v57, v61, v61
    v_sub_f32 v60, v30, v59
    v_fmac_f32 v57, v60, v60
    v_sub_f32 v61, v31, v59
    v_fmac_f32 v57, v61, v61
    v_sub_f32 v60, v32, v59
    v_fmac_f32 v57, v60, v60
    v_sub_f32 v61, v33, v59
    v_fmac_f32 v57, v61, v61
    v_sub_f32 v60, v34, v59
    v_fmac_f32 v57, v60, v60
    v_sub_f32 v61, v35, v59
    v_fmac_f32 v57, v61, v61
    v_sub_f32 v60, v36, v59
    v_fmac_f32 v57, v60, v60
    v_sub_f32 v61, v37, v59
    v_fmac_f32 v57, v61, v61
    v_sub_f32 v60, v38, v59
    v_fmac_f32 v57, v60, v60
    v_sub_f32 v61, v39, v59
    v_fmac_f32 v57, v61, v61
    v_mov_b32 v58, v57
    s_nop 1
    v_permlane16_swap_b32 v57, v58
    v_add_f32 v57, v57, v58
    v_mov_b32 v58, v57
    s_nop 1
    v_permlane32_swap_b32 v57, v58
    v_add_f32 v57, v57, v58
    s_lshl_b32 s52, s45, 14
    s_add_u32 s52, s52, 78381056
    s_mov_b32 exec_lo, 0xffff
    s_mov_b32 exec_hi, 0
    buffer_store_dwordx2 v[56:57], v7, s[4:7], s52 offen sc1
    s_mov_b64 exec, -1
    s_lshl_b32 s52, s46, 3
    s_add_u32 s52, s52, s45
    s_lshl_b32 s52, s52, 3
    s_add_u32 s52, s52, 3973120
    v_mov_b32 v8, s98
    v_mov_b32 v9, s99
    s_waitcnt vmcnt(0)
    s_mov_b64 exec, 1
    buffer_store_dwordx2 v[8:9], off, s[4:7], s52 sc1
    s_mov_b64 exec, -1
L_next_46:
    s_mov_b32 s100, 71303168
    s_mov_b32 s101, 0x2000
    s_branch L_ffn_44
L_red1_45:
    s_lshl_b32 s47, s21, 5
    s_add_u32 s47, s47, s22
    v_and_b32 v8, 7, v1
    v_lshrrev_b32 v9, 3, v1
    s_lshl_b32 s48, s47, 3
    v_add_u32 v3, s48, v8
    v_mul_u32_u24 v3, 1152, v3
    s_mul_i32 s48, s20, 384
    v_lshl_add_u32 v3, v9, 4, v3
    v_add_u32 v3, s48, v3
    s_lshr_b32 s48, s47, 1
    s_mul_i32 s48, s48, 18432
    s_and_b32 s49, s47, 1
    s_lshl_b32 s49, s49, 7
    s_add_u32 s48, s48, s49
    s_mul_i32 s49, s20, 6144
    s_add_u32 s48, s48, s49
    v_lshlrev_b32 v8, 4, v8
    v_lshl_add_u32 v8, v9, 8, v8
    v_add_u32 v4, s48, v8
    v_lshrrev_b32 v8, 3, v1
    v_and_b32 v9, 7, v1
    s_and_b32 s48, s47, 1
    s_lshl_b32 s48, s48, 3
    v_add_u32 v9, s48, v9
    v_lshlrev_b32 v9, 4, v9
    v_bfe_u32 v10, v8, 1, 1
    v_and_b32 v11, 1, v8
    v_lshl_add_u32 v9, v11, 4, v9
    v_lshl_add_u32 v9, v10, 9, v9
    v_and_b32 v10, 3, v8
    v_lshlrev_b32 v10, 8, v10
    v_sub_u32 v9, v9, v10
    s_mul_i32 s48, s20, 6
    v_lshrrev_b32 v8, 2, v8
    v_add_u32 v8, s48, v8
    v_add_u32 v10, 0, v8
    v_cmp_eq_u32 vcc, 4, v10
    v_cmp_eq_u32 s[56:57], 13, v10
    s_nop 0
    s_or_b64 vcc, vcc, s[56:57]
    v_cndmask_b32 v10, 0, v9, vcc
    v_add3_u32 v5, v4, v10, 0
    v_add_u32 v5, 0, v5
    v_add_u32 v10, 2, v8
    v_cmp_eq_u32 vcc, 4, v10
    v_cmp_eq_u32 s[56:57], 13, v10
    s_nop 0
    s_or_b64 vcc, vcc, s[56:57]
    v_cndmask_b32 v10, 0, v9, vcc
    v_add3_u32 v6, v4, v10, 0
    v_add_u32 v6, 2048, v6
    v_add_u32 v10, 4, v8
    v_cmp_eq_u32 vcc, 4, v10
    v_cmp_eq_u32 s[56:57], 13, v10
    s_nop 0
    s_or_b64 vcc, vcc, s[56:57]
    v_cndmask_b32 v10, 0, v9, vcc
    v_add3_u32 v7, v4, v10, 0
    v_add_u32 v7, 4096, v7
    s_cmp_eq_u32 s20, 3
    s_cbranch_scc1 L_w3a_109
    s_mov_b32 s48, 76021760
    buffer_load_dwordx4 v[16:19], v4, s[4:7], s48 offen offset:0 sc1
    buffer_load_dwordx4 v[52:55], v4, s[4:7], s48 offen offset:2048 sc1
    s_add_u32 s48, s48, 4096
    buffer_load_dwordx4 v[88:91], v4, s[4:7], s48 offen offset:0 sc1
    s_lshr_b32 s49, s47, 3
    s_lshl_b32 s49, s49, 8
    s_add_u32 s49, s49, 4055040
    v_and_b32 v10, 31, v1
    v_lshlrev_b32 v10, 3, v10
    buffer_load_dwordx2 v[8:9], v10, s[4:7], s49 offen sc1
    s_waitcnt vmcnt(0)
    v_cmp_eq_u64 vcc, s[98:99], v[8:9]
    s_nop 0
    s_cmp_eq_u64 vcc, exec
    s_cbranch_scc0 L_pp_slow_110
L_pp_back_111:
    s_mov_b32 s48, 100663296
    buffer_load_dwordx4 v[20:23], v5, s[4:7], s48 offen sc1
    buffer_load_dwordx4 v[56:59], v6, s[4:7], s48 offen sc1
    buffer_load_dwordx4 v[92:95], v7, s[4:7], s48 offen sc1
    s_mov_b32 s48, 103022592
    buffer_load_dwordx4 v[24:27], v5, s[4:7], s48 offen sc1
    buffer_load_dwordx4 v[60:63], v6, s[4:7], s48 offen sc1
    buffer_load_dwordx4 v[96:99], v7, s[4:7], s48 offen sc1
    s_mov_b32 s48, 105381888
    buffer_load_dwordx4 v[28:31], v5, s[4:7], s48 offen sc1
    buffer_load_dwordx4 v[64:67], v6, s[4:7], s48 offen sc1
    buffer_load_dwordx4 v[100:103], v7, s[4:7], s48 offen sc1
    s_mov_b32 s48, 107741184
    buffer_load_dwordx4 v[32:35], v5, s[4:7], s48 offen sc1
    buffer_load_dwordx4 v[68:71], v6, s[4:7], s48 offen sc1
    buffer_load_dwordx4 v[104:107], v7, s[4:7], s48 offen sc1
    s_mov_b32 s48, 110100480
    buffer_load_dwordx4 v[36:39], v5, s[4:7], s48 offen sc1
    buffer_load_dwordx4 v[72:75], v6, s[4:7], s48 offen sc1
    buffer_load_dwordx4 v[108:111], v7, s[4:7], s48 offen sc1
    s_mov_b32 s48, 112459776
    buffer_load_dwordx4 v[40:43], v5, s[4:7], s48 offen sc1
    buffer_load_dwordx4 v[76:79], v6, s[4:7], s48 offen sc1
    buffer_load_dwordx4 v[112:115], v7, s[4:7], s48 offen sc1
    s_mov_b32 s48, 114819072
    buffer_load_dwordx4 v[44:47], v5, s[4:7], s48 offen sc1
    buffer_load_dwordx4 v[80:83], v6, s[4:7], s48 offen sc1
    buffer_load_dwordx4 v[116:119], v7, s[4:7], s48 offen sc1
    s_mov_b32 s48, 117178368
    buffer_load_dwordx4 v[48:51], v5, s[4:7], s48 offen sc1
    buffer_load_dwordx4 v[84:87], v6, s[4:7], s48 offen sc1
    buffer_load_dwordx4 v[120:123], v7, s[4:7], s48 offen sc1
    v_lshlrev_b32 v128, 16, v16
    v_and_b32 v129, 0xffff0000, v16
    v_lshlrev_b32 v130, 16, v17
    v_and_b32 v131, 0xffff0000, v17
    v_lshlrev_b32 v132, 16, v18
    v_and_b32 v133, 0xffff0000, v18
    v_lshlrev_b32 v134, 16, v19
    v_and_b32 v135, 0xffff0000, v19
    v_lshlrev_b32 v136, 16, v52
    v_and_b32 v137, 0xffff0000, v52
    v_lshlrev_b32 v138, 16, v53
    v_and_b32 v139, 0xffff0000, v53
    v_lshlrev_b32 v140, 16, v54
    v_and_b32 v141, 0xffff0000, v54
    v_lshlrev_b32 v142, 16, v55
    v_and_b32 v143, 0xffff0000, v55
    v_lshlrev_b32 v144, 16, v88
    v_and_b32 v145, 0xffff0000, v88
    v_lshlrev_b32 v146, 16, v89
    v_and_b32 v147, 0xffff0000, v89
    v_lshlrev_b32 v148, 16, v90
    v_and_b32 v149, 0xffff0000, v90
    v_lshlrev_b32 v150, 16, v91
    v_and_b32 v151, 0xffff0000, v91
    v_mov_b32 v12, 0x3f80
    v_mov_b32 v13, 0x3f800000
    s_waitcnt vmcnt(23)
    v_dot2c_f32_bf16 v128, v20, v12
    v_dot2c_f32_bf16 v129, v20, v13
    v_dot2c_f32_bf16 v130, v21, v12
    v_dot2c_f32_bf16 v131, v21, v13
    v_dot2c_f32_bf16 v132, v22, v12
    v_dot2c_f32_bf16 v133, v22, v13
    v_dot2c_f32_bf16 v134, v23, v12
    v_dot2c_f32_bf16 v135, v23, v13
    s_waitcnt vmcnt(22)
    v_dot2c_f32_bf16 v136, v56, v12
    v_dot2c_f32_bf16 v137, v56, v13
    v_dot2c_f32_bf16 v138, v57, v12
    v_dot2c_f32_bf16 v139, v57, v13
    v_dot2c_f32_bf16 v140, v58, v12
    v_dot2c_f32_bf16 v141, v58, v13
    v_dot2c_f32_bf16 v142, v59, v12
    v_dot2c_f32_bf16 v143, v59, v13
    s_waitcnt vmcnt(21)
    v_dot2c_f32_bf16 v144, v92, v12
    v_dot2c_f32_bf16 v145, v92, v13
    v_dot2c_f32_bf16 v146, v93, v12
    v_dot2c_f32_bf16 v147, v93, v13
    v_dot2c_f32_bf16 v148, v94, v12
    v_dot2c_f32_bf16 v149, v94, v13
    v_dot2c_f32_bf16 v150, v95, v12
    v_dot2c_f32_bf16 v151, v95, v13
    s_waitcnt vmcnt(20)
    v_dot2c_f32_bf16 v128, v24, v12
    v_dot2c_f32_bf16 v129, v24, v13
    v_dot2c_f32_bf16 v130, v25, v12
    v_dot2c_f32_bf16 v131, v25, v13
    v_dot2c_f32_bf16 v132, v26, v12
    v_dot2c_f32_bf16 v133, v26, v13
    v_dot2c_f32_bf16 v134, v27, v12
    v_dot2c_f32_bf16 v135, v27, v13
    s_waitcnt vmcnt(19)
    v_dot2c_f32_bf16 v136, v60, v12
    v_dot2c_f32_bf16 v137, v60, v13
    v_dot2c_f32_bf16 v138, v61, v12
    v_dot2c_f32_bf16 v139, v61, v13
    v_dot2c_f32_bf16 v140, v62, v12
    v_dot2c_f32_bf16 v141, v62, v13
    v_dot2c_f32_bf16 v142, v63, v12
    v_dot2c_f32_bf16 v143, v63, v13
    s_waitcnt vmcnt(18)
    v_dot2c_f32_bf16 v144, v96, v12
    v_dot2c_f32_bf16 v145, v96, v13
    v_dot2c_f32_bf16 v146, v97, v12
    v_dot2c_f32_bf16 v147, v97, v13
    v_dot2c_f32_bf16 v148, v98, v12
    v_dot2c_f32_bf16 v149, v98, v13
    v_dot2c_f32_bf16 v150, v99, v12
    v_dot2c_f32_bf16 v151, v99, v13
    s_waitcnt vmcnt(17)
    v_dot2c_f32_bf16 v128, v28, v12
    v_dot2c_f32_bf16 v129, v28, v13
    v_dot2c_f32_bf16 v130, v29, v12
    v_dot2c_f32_bf16 v131, v29, v13
    v_dot2c_f32_bf16 v132, v30, v12
    v_dot2c_f32_bf16 v133, v30, v13
    v_dot2c_f32_bf16 v134, v31, v12
    v_dot2c_f32_bf16 v135, v31, v13
    s_waitcnt vmcnt(16)
    v_dot2c_f32_bf16 v136, v64, v12
    v_dot2c_f32_bf16 v137, v64, v13
    v_dot2c_f32_bf16 v138, v65, v12
    v_dot2c_f32_bf16 v139, v65, v13
    v_dot2c_f32_bf16 v140, v66, v12
    v_dot2c_f32_bf16 v141, v66, v13
    v_dot2c_f32_bf16 v142, v67, v12
    v_dot2c_f32_bf16 v143, v67, v13
    s_waitcnt vmcnt(15)
    v_dot2c_f32_bf16 v144, v100, v12
    v_dot2c_f32_bf16 v145, v100, v13
    v_dot2c_f32_bf16 v146, v101, v12
    v_dot2c_f32_bf16 v147, v101, v13
    v_dot2c_f32_bf16 v148, v102, v12
    v_dot2c_f32_bf16 v149, v102, v13
    v_dot2c_f32_bf16 v150, v103, v12
    v_dot2c_f32_bf16 v151, v103, v13
    s_waitcnt vmcnt(14)
    v_dot2c_f32_bf16 v128, v32, v12
    v_dot2c_f32_bf16 v129, v32, v13
    v_dot2c_f32_bf16 v130, v33, v12
    v_dot2c_f32_bf16 v131, v33, v13
    v_dot2c_f32_bf16 v132, v34, v12
    v_dot2c_f32_bf16 v133, v34, v13
    v_dot2c_f32_bf16 v134, v35, v12
    v_dot2c_f32_bf16 v135, v35, v13
    s_waitcnt vmcnt(13)
    v_dot2c_f32_bf16 v136, v68, v12
    v_dot2c_f32_bf16 v137, v68, v13
    v_dot2c_f32_bf16 v138, v69, v12
    v_dot2c_f32_bf16 v139, v69, v13
    v_dot2c_f32_bf16 v140, v70, v12
    v_dot2c_f32_bf16 v141, v70, v13
    v_dot2c_f32_bf16 v142, v71, v12
    v_dot2c_f32_bf16 v143, v71, v13
    s_waitcnt vmcnt(12)
    v_dot2c_f32_bf16 v144, v104, v12
    v_dot2c_f32_bf16 v145, v104, v13
    v_dot2c_f32_bf16 v146, v105, v12
    v_dot2c_f32_bf16 v147, v105, v13
    v_dot2c_f32_bf16 v148, v106, v12
    v_dot2c_f32_bf16 v149, v106, v13
    v_dot2c_f32_bf16 v150, v107, v12
    v_dot2c_f32_bf16 v151, v107, v13
    s_waitcnt vmcnt(11)
    v_dot2c_f32_bf16 v128, v36, v12
    v_dot2c_f32_bf16 v129, v36, v13
    v_dot2c_f32_bf16 v130, v37, v12
    v_dot2c_f32_bf16 v131, v37, v13
    v_dot2c_f32_bf16 v132, v38, v12
    v_dot2c_f32_bf16 v133, v38, v13
    v_dot2c_f32_bf16 v134, v39, v12
    v_dot2c_f32_bf16 v135, v39, v13
    s_waitcnt vmcnt(10)
    v_dot2c_f32_bf16 v136, v72, v12
    v_dot2c_f32_bf16 v137, v72, v13
    v_dot2c_f32_bf16 v138, v73, v12
    v_dot2c_f32_bf16 v139, v73, v13
    v_dot2c_f32_bf16 v140, v74, v12
    v_dot2c_f32_bf16 v141, v74, v13
    v_dot2c_f32_bf16 v142, v75, v12
    v_dot2c_f32_bf16 v143, v75, v13
    s_waitcnt vmcnt(9)
    v_dot2c_f32_bf16 v144, v108, v12
    v_dot2c_f32_bf16 v145, v108, v13
    v_dot2c_f32_bf16 v146, v109, v12
    v_dot2c_f32_bf16 v147, v109, v13
    v_dot2c_f32_bf16 v148, v110, v12
    v_dot2c_f32_bf16 v149, v110, v13
    v_dot2c_f32_bf16 v150, v111, v12
    v_dot2c_f32_bf16 v151, v111, v13
    s_waitcnt vmcnt(8)
    v_dot2c_f32_bf16 v128, v40, v12
    v_dot2c_f32_bf16 v129, v40, v13
    v_dot2c_f32_bf16 v130, v41, v12
    v_dot2c_f32_bf16 v131, v41, v13
    v_dot2c_f32_bf16 v132, v42, v12
    v_dot2c_f32_bf16 v133, v42, v13
    v_dot2c_f32_bf16 v134, v43, v12
    v_dot2c_f32_bf16 v135, v43, v13
    s_waitcnt vmcnt(7)
    v_dot2c_f32_bf16 v136, v76, v12
    v_dot2c_f32_bf16 v137, v76, v13
    v_dot2c_f32_bf16 v138, v77, v12
    v_dot2c_f32_bf16 v139, v77, v13
    v_dot2c_f32_bf16 v140, v78, v12
    v_dot2c_f32_bf16 v141, v78, v13
    v_dot2c_f32_bf16 v142, v79, v12
    v_dot2c_f32_bf16 v143, v79, v13
    s_waitcnt vmcnt(6)
    v_dot2c_f32_bf16 v144, v112, v12
    v_dot2c_f32_bf16 v145, v112, v13
    v_dot2c_f32_bf16 v146, v113, v12
    v_dot2c_f32_bf16 v147, v113, v13
    v_dot2c_f32_bf16 v148, v114, v12
    v_dot2c_f32_bf16 v149, v114, v13
    v_dot2c_f32_bf16 v150, v115, v12
    v_dot2c_f32_bf16 v151, v115, v13
    s_waitcnt vmcnt(5)
    v_dot2c_f32_bf16 v128, v44, v12
    v_dot2c_f32_bf16 v129, v44, v13
    v_dot2c_f32_bf16 v130, v45, v12
    v_dot2c_f32_bf16 v131, v45, v13
    v_dot2c_f32_bf16 v132, v46, v12
    v_dot2c_f32_bf16 v133, v46, v13
    v_dot2c_f32_bf16 v134, v47, v12
    v_dot2c_f32_bf16 v135, v47, v13
    s_waitcnt vmcnt(4)
    v_dot2c_f32_bf16 v136, v80, v12
    v_dot2c_f32_bf16 v137, v80, v13
    v_dot2c_f32_bf16 v138, v81, v12
    v_dot2c_f32_bf16 v139, v81, v13
    v_dot2c_f32_bf16 v140, v82, v12
    v_dot2c_f32_bf16 v141, v82, v13
    v_dot2c_f32_bf16 v142, v83, v12
    v_dot2c_f32_bf16 v143, v83, v13
    s_waitcnt vmcnt(3)
    v_dot2c_f32_bf16 v144, v116, v12
    v_dot2c_f32_bf16 v145, v116, v13
    v_dot2c_f32_bf16 v146, v117, v12
    v_dot2c_f32_bf16 v147, v117, v13
    v_dot2c_f32_bf16 v148, v118, v12
    v_dot2c_f32_bf16 v149, v118, v13
    v_dot2c_f32_bf16 v150, v119, v12
    v_dot2c_f32_bf16 v151, v119, v13
    s_waitcnt vmcnt(2)
    v_dot2c_f32_bf16 v128, v48, v12
    v_dot2c_f32_bf16 v129, v48, v13
    v_dot2c_f32_bf16 v130, v49, v12
    v_dot2c_f32_bf16 v131, v49, v13
    v_dot2c_f32_bf16 v132, v50, v12
    v_dot2c_f32_bf16 v133, v50, v13
    v_dot2c_f32_bf16 v134, v51, v12
    v_dot2c_f32_bf16 v135, v51, v13
    s_waitcnt vmcnt(1)
    v_dot2c_f32_bf16 v136, v84, v12
    v_dot2c_f32_bf16 v137, v84, v13
    v_dot2c_f32_bf16 v138, v85, v12
    v_dot2c_f32_bf16 v139, v85, v13
    v_dot2c_f32_bf16 v140, v86, v12
    v_dot2c_f32_bf16 v141, v86, v13
    v_dot2c_f32_bf16 v142, v87, v12
    v_dot2c_f32_bf16 v143, v87, v13
    s_waitcnt vmcnt(0)
    v_dot2c_f32_bf16 v144, v120, v12
    v_dot2c_f32_bf16 v145, v120, v13
    v_dot2c_f32_bf16 v146, v121, v12
    v_dot2c_f32_bf16 v147, v121, v13
    v_dot2c_f32_bf16 v148, v122, v12
    v_dot2c_f32_bf16 v149, v122, v13
    v_dot2c_f32_bf16 v150, v123, v12
    v_dot2c_f32_bf16 v151, v123, v13
    s_mov_b32 s16, s38
    s_mov_b32 s17, s39
    s_mov_b32 s18, 0x240000
    s_mov_b32 s19, 0x20000
    v_cvt_pk_bf16_f32 v160, v128, v129
    v_cvt_pk_bf16_f32 v161, v130, v131
    v_cvt_pk_bf16_f32 v162, v132, v133
    v_cvt_pk_bf16_f32 v163, v134, v135
    buffer_store_dwordx4 v[160:163], v3, s[16:19], 0 offen offset:0
    v_cvt_pk_bf16_f32 v164, v136, v137
    v_cvt_pk_bf16_f32 v165, v138, v139
    v_cvt_pk_bf16_f32 v166, v140, v141
    v_cvt_pk_bf16_f32 v167, v142, v143
    buffer_store_dwordx4 v[164:167], v3, s[16:19], 0 offen offset:128
    v_cvt_pk_bf16_f32 v168, v144, v145
    v_cvt_pk_bf16_f32 v169, v146, v147
    v_cvt_pk_bf16_f32 v170, v148, v149
    v_cvt_pk_bf16_f32 v171, v150, v151
    buffer_store_dwordx4 v[168:171], v3, s[16:19], 0 offen offset:256
L_w3a_109:
    s_waitcnt vmcnt(0) lgkmcnt(0)
interleave_layers__sliding_local_dilated__glu_gated_bilinear__prompt_kernel_end:
    s_endpgm
L_pn_slow_27:
    s_mov_b32 s97, 0x40000
L_pn_spin_29:
    global_load_dwordx2 v[6:7], v5, s[40:41] sc1
    s_waitcnt vmcnt(0)
    v_cmp_ne_u64 vcc, 0, v[6:7]
    s_sub_u32 s97, s97, 1
    s_cbranch_scc1 L_pn_back_28
    s_cmp_eq_u64 vcc, exec
    s_cbranch_scc1 L_pn_back_28
    s_branch L_pn_spin_29
L_pwo_slow_35:
    s_mov_b32 s97, 0x40000
L_pwo_spin_37:
    buffer_load_dwordx2 v[14:15], v13, s[4:7], s23 offen sc1
    s_waitcnt vmcnt(0)
    v_cmp_eq_u64 vcc, s[98:99], v[14:15]
    s_sub_u32 s97, s97, 1
    s_cbranch_scc1 L_pwo_back_36
    s_cmp_eq_u64 vcc, exec
    s_cbranch_scc1 L_pwo_back_36
    s_branch L_pwo_spin_37
L_px_slow_38:
    s_mov_b32 s97, 0x40000
L_px_spin_40:
    buffer_load_dwordx2 v[12:13], v11, s[4:7], s23 offen sc1
    s_waitcnt vmcnt(0)
    v_cmp_eq_u64 vcc, s[98:99], v[12:13]
    s_sub_u32 s97, s97, 1
    s_cbranch_scc1 L_px_back_39
    s_cmp_eq_u64 vcc, exec
    s_cbranch_scc1 L_px_back_39
    s_branch L_px_spin_40
L_po_slow_52:
    s_mov_b32 s97, 0x40000
L_po_spin_54:
    buffer_load_dwordx2 v[12:13], v10, s[4:7], s52 offen sc1
    s_waitcnt vmcnt(0)
    v_cmp_eq_u64 vcc, s[98:99], v[12:13]
    s_sub_u32 s97, s97, 1
    s_cbranch_scc1 L_po_back_53
    s_cmp_eq_u64 vcc, exec
    s_cbranch_scc1 L_po_back_53
    s_branch L_po_spin_54
L_pw_slow_75:
    s_mov_b32 s97, 0x40000
L_pw_spin_77:
    buffer_load_dwordx2 v[6:7], v0, s[4:7], s64 offen sc1
    s_waitcnt vmcnt(0)
    v_cmp_eq_u64 vcc, s[98:99], v[6:7]
    s_sub_u32 s97, s97, 1
    s_cbranch_scc1 L_pw_back_76
    s_cmp_eq_u64 vcc, exec
    s_cbranch_scc1 L_pw_back_76
    s_branch L_pw_spin_77
L_p1_slow_80:
    s_mov_b32 s97, 0x40000
L_p1_spin_82:
    buffer_load_dwordx2 v[6:7], v0, s[4:7], s55 offen sc1
    s_waitcnt vmcnt(0)
    v_cmp_eq_u64 vcc, s[98:99], v[6:7]
    s_sub_u32 s97, s97, 1
    s_cbranch_scc1 L_p1_back_81
    s_cmp_eq_u64 vcc, exec
    s_cbranch_scc1 L_p1_back_81
    s_branch L_p1_spin_82
L_pd_slow_83:
    s_mov_b32 s97, 0x40000
L_pd_spin_85:
    buffer_load_dwordx2 v[6:7], v0, s[4:7], s55 offen sc1
    s_waitcnt vmcnt(0)
    v_cmp_eq_u64 vcc, s[98:99], v[6:7]
    s_sub_u32 s97, s97, 1
    s_cbranch_scc1 L_pd_back_84
    s_cmp_eq_u64 vcc, exec
    s_cbranch_scc1 L_pd_back_84
    s_branch L_pd_spin_85
L_p0_slow_86:
    s_mov_b32 s97, 0x40000
L_p0_spin_88:
    buffer_load_dwordx2 v[6:7], v0, s[4:7], s55 offen sc1
    s_waitcnt vmcnt(0)
    v_cmp_eq_u64 vcc, s[98:99], v[6:7]
    s_sub_u32 s97, s97, 1
    s_cbranch_scc1 L_p0_back_87
    s_cmp_eq_u64 vcc, exec
    s_cbranch_scc1 L_p0_back_87
    s_branch L_p0_spin_88
L_p1_slow_89:
    s_mov_b32 s97, 0x40000
L_p1_spin_91:
    buffer_load_dwordx2 v[6:7], v0, s[4:7], s55 offen sc1
    s_waitcnt vmcnt(0)
    v_cmp_eq_u64 vcc, s[98:99], v[6:7]
    s_sub_u32 s97, s97, 1
    s_cbranch_scc1 L_p1_back_90
    s_cmp_eq_u64 vcc, exec
    s_cbranch_scc1 L_p1_back_90
    s_branch L_p1_spin_91
L_p2_slow_92:
    s_mov_b32 s97, 0x40000
L_p2_spin_94:
    buffer_load_dwordx2 v[6:7], v0, s[4:7], s55 offen sc1
    s_waitcnt vmcnt(0)
    v_cmp_eq_u64 vcc, s[98:99], v[6:7]
    s_sub_u32 s97, s97, 1
    s_cbranch_scc1 L_p2_back_93
    s_cmp_eq_u64 vcc, exec
    s_cbranch_scc1 L_p2_back_93
    s_branch L_p2_spin_94
L_pp_slow_96:
    s_mov_b32 s97, 0x40000
L_pp_spin_98:
    buffer_load_dwordx2 v[8:9], v10, s[4:7], s49 offen sc1
    s_waitcnt vmcnt(0)
    v_cmp_eq_u64 vcc, s[98:99], v[8:9]
    s_sub_u32 s97, s97, 1
    s_cbranch_scc1 L_pp_back_97
    s_cmp_eq_u64 vcc, exec
    s_cbranch_scc1 L_pp_back_97
    s_branch L_pp_spin_98
L_px_slow_101:
    s_mov_b32 s97, 0x40000
L_px_spin_103:
    buffer_load_dwordx2 v[12:13], v11, s[4:7], s23 offen sc1
    s_waitcnt vmcnt(0)
    v_cmp_eq_u64 vcc, s[98:99], v[12:13]
    s_sub_u32 s97, s97, 1
    s_cbranch_scc1 L_px_back_102
    s_cmp_eq_u64 vcc, exec
    s_cbranch_scc1 L_px_back_102
    s_branch L_px_spin_103
L_po_slow_106:
    s_mov_b32 s97, 0x40000
L_po_spin_108:
    buffer_load_dwordx2 v[12:13], v10, s[4:7], s52 offen sc1
    s_waitcnt vmcnt(0)
    v_cmp_eq_u64 vcc, s[98:99], v[12:13]
    s_sub_u32 s97, s97, 1
    s_cbranch_scc1 L_po_back_107
    s_cmp_eq_u64 vcc, exec
    s_cbranch_scc1 L_po_back_107
    s_branch L_po_spin_108
L_pp_slow_110:
    s_mov_b32 s97, 0x40000
L_pp_spin_112:
    buffer_load_dwordx2 v[8:9], v10, s[4:7], s49 offen sc1
    s_waitcnt vmcnt(0)
    v_cmp_eq_u64 vcc, s[98:99], v[8:9]
    s_sub_u32 s97, s97, 1
    s_cbranch_scc1 L_pp_back_111
    s_cmp_eq_u64 vcc, exec
    s_cbranch_scc1 L_pp_back_111
    s_branch L_pp_spin_112
interleave_layers__sliding_local_dilated__glu_gated_bilinear__prompt_kernel_last:
    s_endpgm
.section .rodata,"a"
.p2align 6
.amdhsa_kernel interleave_layers__sliding_local_dilated__glu_gated_bilinear__prompt_kernel
  .amdhsa_next_free_vgpr 512
  .amdhsa_next_free_sgpr 102
  .amdhsa_accum_offset 256
  .amdhsa_group_segment_fixed_size 0
  .amdhsa_kernarg_size 80
  .amdhsa_user_sgpr_count 2
  .amdhsa_user_sgpr_kernarg_segment_ptr 1
  .amdhsa_system_sgpr_workgroup_id_x 1
  .amdhsa_float_denorm_mode_32 3
.end_amdhsa_kernel
```

```asm
; @launch grid=(256,1,1) block=(256,1,1) lds=163840
.amdgcn_target "amdgcn-amd-amdhsa--gfx950"
.text
.globl interleave_layers__sliding_local_dilated__glu_gated_bilinear__prompt_kernel
.p2align 8
.type interleave_layers__sliding_local_dilated__glu_gated_bilinear__prompt_kernel,@function
interleave_layers__sliding_local_dilated__glu_gated_bilinear__prompt_kernel:
    s_cmp_ge_u32 s2, 256
    s_cbranch_scc1 interleave_layers__sliding_local_dilated__glu_gated_bilinear__prompt_kernel_end
    s_load_dwordx16 s[24:39], s[0:1], 0
    s_load_dwordx4 s[40:43], s[0:1], 64
    v_lshrrev_b32 v1, 6, v0
    s_and_b32 s21, s2, 7
    v_readfirstlane_b32 s20, v1
    s_lshr_b32 s22, s2, 3
    v_and_b32 v1, 63, v0
    v_lshlrev_b32 v2, 4, v1
    s_lshl_b32 s23, s22, 2
    s_add_u32 s23, s23, s20
    s_mul_i32 s23, s23, 5
    v_add_lshl_u32 v219, v1, s23, 7
    s_getpc_b64 s[16:17]
L_pc_1:
    v_min_u32 v219, interleave_layers__sliding_local_dilated__glu_gated_bilinear__prompt_kernel_last-L_pc_1, v219
    s_mov_b64 exec, 31
    global_load_dword v219, v219, s[16:17]
    s_mov_b64 exec, -1
    s_waitcnt lgkmcnt(0)
    s_mov_b32 s4, s42
    s_mov_b32 s5, s43
    s_mov_b32 s6, 0x10000000
    s_mov_b32 s7, 0x20000
    s_mov_b32 s100, 20971520
    s_mov_b32 s101, 0
    s_mov_b32 s8, s24
    s_mov_b32 s9, s25
    s_mov_b32 s10, 0x240000
    s_mov_b32 s11, 0x20000
    s_mov_b32 s12, s26
    s_mov_b32 s13, s27
    s_mov_b32 s14, 0x1e6000
    s_mov_b32 s15, 0x20000
    v_mov_b32 v3, 0
    v_mov_b32 v4, 0
    v_mov_b32 v5, 0
    s_or_b32 s44, s2, s20
    s_cmp_lg_u32 s44, 0
    s_cbranch_scc1 L_nonce_2
    s_memrealtime s[44:45]
    s_waitcnt lgkmcnt(0)
    v_mov_b32 v6, s44
    v_mov_b32 v7, s45
    s_mov_b64 exec, 1
    global_store_dwordx2 v5, v[6:7], s[40:41] sc1
    s_mov_b64 exec, -1
L_nonce_2:
    s_cmp_eq_u32 s20, 3
    s_cbranch_scc1 L_w3_3
    s_lshl_b32 s47, s21, 5
    s_add_u32 s47, s47, s22
    v_and_b32 v6, 7, v1
    v_lshrrev_b32 v7, 3, v1
    s_lshl_b32 s48, s47, 3
    v_add_u32 v3, s48, v6
    v_mul_u32_u24 v3, 1152, v3
    s_mul_i32 s48, s20, 384
    v_lshl_add_u32 v3, v7, 4, v3
    v_add_u32 v3, s48, v3
    s_lshr_b32 s48, s47, 1
    s_mul_i32 s48, s48, 18432
    s_and_b32 s49, s47, 1
    s_lshl_b32 s49, s49, 7
    s_add_u32 s48, s48, s49
    s_mul_i32 s49, s20, 6144
    s_add_u32 s48, s48, s49
    v_lshlrev_b32 v6, 4, v6
    v_lshl_add_u32 v6, v7, 8, v6
    v_add_u32 v4, s48, v6
    buffer_load_dwordx4 v[8:11], v3, s[8:11], 0 offen offset:0 nt
    buffer_load_dwordx4 v[12:15], v3, s[8:11], 0 offen offset:128 nt
    buffer_load_dwordx4 v[16:19], v3, s[8:11], 0 offen offset:256 nt
    s_branch L_uend_4
L_w3_3:
    s_mov_b32 s55, 0
    s_mov_b32 s56, 0
    s_mov_b32 s57, 8192
    s_mul_i32 s67, s21, 36
    s_add_u32 s67, s67, s22
    s_lshr_b32 s0, s67, 4
    s_and_b32 s67, s67, 15
    s_mul_i32 s67, s67, 18
    s_add_u32 s67, s67, s0
    s_mul_i32 s44, s67, 3641
    s_lshr_b32 s44, s44, 16
    s_mul_i32 s45, s44, 18
    s_sub_u32 s45, s67, s45
    s_mul_i32 s46, s44, 72
    s_and_b32 s47, s46, 8
    s_and_b32 s46, s46, -16
    s_mul_i32 s48, s45, 110592
    s_add_u32 s46, s46, s48
    s_mov_b32 s48, 3216
    s_mul_i32 s51, s67, 7168
    s_mov_b32 s12, s26
    s_mov_b32 s13, s27
    s_mov_b32 s14, 0x1e6000
    s_mov_b32 s15, 0x20000
    v_add_u32 v64, 0, v1
    v_mul_u32_u24 v65, 4370, v64
    v_lshrrev_b32 v65, 16, v65
    v_mad_i32_i24 v66, v65, -15, v64
    v_mul_u32_u24 v66, 13108, v66
    v_lshrrev_b32 v66, 16, v66
    v_mul_u32_u24 v66, 1072, v66
    v_mad_u32_u24 v65, v65, s48, v66
    v_lshl_add_u32 v64, v64, 4, v65
    s_add_u32 m0, s56, 0
    s_nop 0
    buffer_load_dwordx4 v64, s[12:15], s46 offen nt lds
    v_add_u32 v64, 64, v1
    v_mul_u32_u24 v65, 4370, v64
    v_lshrrev_b32 v65, 16, v65
    v_mad_i32_i24 v66, v65, -15, v64
    v_mul_u32_u24 v66, 13108, v66
    v_lshrrev_b32 v66, 16, v66
    v_mul_u32_u24 v66, 1072, v66
    v_mad_u32_u24 v65, v65, s48, v66
    v_lshl_add_u32 v64, v64, 4, v65
    s_add_u32 m0, s56, 1024
    s_nop 0
    buffer_load_dwordx4 v64, s[12:15], s46 offen nt lds
    v_add_u32 v64, 128, v1
    v_mul_u32_u24 v65, 4370, v64
    v_lshrrev_b32 v65, 16, v65
    v_mad_i32_i24 v66, v65, -15, v64
    v_mul_u32_u24 v66, 13108, v66
    v_lshrrev_b32 v66, 16, v66
    v_mul_u32_u24 v66, 1072, v66
    v_mad_u32_u24 v65, v65, s48, v66
    v_lshl_add_u32 v64, v64, 4, v65
    s_add_u32 m0, s56, 2048
    s_nop 0
    buffer_load_dwordx4 v64, s[12:15], s46 offen nt lds
    v_add_u32 v64, 192, v1
    v_mul_u32_u24 v65, 4370, v64
    v_lshrrev_b32 v65, 16, v65
    v_mad_i32_i24 v66, v65, -15, v64
    v_mul_u32_u24 v66, 13108, v66
    v_lshrrev_b32 v66, 16, v66
    v_mul_u32_u24 v66, 1072, v66
    v_mad_u32_u24 v65, v65, s48, v66
    v_lshl_add_u32 v64, v64, 4, v65
    s_add_u32 m0, s56, 3072
    s_nop 0
    buffer_load_dwordx4 v64, s[12:15], s46 offen nt lds
    v_add_u32 v64, 256, v1
    v_mul_u32_u24 v65, 4370, v64
    v_lshrrev_b32 v65, 16, v65
    v_mad_i32_i24 v66, v65, -15, v64
    v_mul_u32_u24 v66, 13108, v66
    v_lshrrev_b32 v66, 16, v66
    v_mul_u32_u24 v66, 1072, v66
    v_mad_u32_u24 v65, v65, s48, v66
    v_lshl_add_u32 v64, v64, 4, v65
    s_add_u32 m0, s56, 4096
    s_nop 0
    buffer_load_dwordx4 v64, s[12:15], s46 offen nt lds
    v_add_u32 v64, 320, v1
    v_mul_u32_u24 v65, 4370, v64
    v_lshrrev_b32 v65, 16, v65
    v_mad_i32_i24 v66, v65, -15, v64
    v_mul_u32_u24 v66, 13108, v66
    v_lshrrev_b32 v66, 16, v66
    v_mul_u32_u24 v66, 1072, v66
    v_mad_u32_u24 v65, v65, s48, v66
    v_lshl_add_u32 v64, v64, 4, v65
    s_add_u32 m0, s56, 5120
    s_nop 0
    buffer_load_dwordx4 v64, s[12:15], s46 offen nt lds
    v_add_u32 v64, 384, v1
    v_mul_u32_u24 v65, 4370, v64
    v_lshrrev_b32 v65, 16, v65
    v_mad_i32_i24 v66, v65, -15, v64
    v_mul_u32_u24 v66, 13108, v66
    v_lshrrev_b32 v66, 16, v66
    v_mul_u32_u24 v66, 1072, v66
    v_mad_u32_u24 v65, v65, s48, v66
    v_lshl_add_u32 v64, v64, 4, v65
    s_add_u32 m0, s56, 6144
    s_nop 0
    buffer_load_dwordx4 v64, s[12:15], s46 offen nt lds
    v_add_u32 v64, 448, v1
    v_mul_u32_u24 v65, 4370, v64
    v_lshrrev_b32 v65, 16, v65
    v_mad_i32_i24 v66, v65, -15, v64
    v_mul_u32_u24 v66, 13108, v66
    v_lshrrev_b32 v66, 16, v66
    v_mul_u32_u24 v66, 1072, v66
    v_mad_u32_u24 v65, v65, s48, v66
    v_lshl_add_u32 v64, v64, 4, v65
    s_add_u32 m0, s56, 7168
    s_nop 0
    buffer_load_dwordx4 v64, s[12:15], s46 offen nt lds
    s_lshl_b32 s0, s44, 5
    s_add_u32 s0, s0, s45
    s_lshl_b32 s0, s0, 3
    s_add_u32 s0, s0, 4063232
    s_cmp_ge_u32 s22, 4
    s_cbranch_scc1 L_uw_5
    s_mov_b32 s55, 1
    s_mul_i32 s67, s21, 36
    s_add_u32 s67, s67, s22
    s_add_u32 s67, s67, 32
    s_lshr_b32 s1, s67, 4
    s_and_b32 s67, s67, 15
    s_mul_i32 s67, s67, 18
    s_add_u32 s67, s67, s1
    s_mul_i32 s84, s67, 3641
    s_lshr_b32 s84, s84, 16
    s_mul_i32 s85, s84, 18
    s_sub_u32 s85, s67, s85
    s_mul_i32 s86, s84, 72
    s_and_b32 s87, s86, 8
    s_and_b32 s86, s86, -16
    s_mul_i32 s88, s85, 110592
    s_add_u32 s86, s86, s88
    s_mov_b32 s88, 3216
    s_mul_i32 s91, s67, 7168
    s_mov_b32 s12, s26
    s_mov_b32 s13, s27
    s_mov_b32 s14, 0x1e6000
    s_mov_b32 s15, 0x20000
    v_add_u32 v64, 0, v1
    v_mul_u32_u24 v65, 4370, v64
    v_lshrrev_b32 v65, 16, v65
    v_mad_i32_i24 v66, v65, -15, v64
    v_mul_u32_u24 v66, 13108, v66
    v_lshrrev_b32 v66, 16, v66
    v_mul_u32_u24 v66, 1072, v66
    v_mad_u32_u24 v65, v65, s88, v66
    v_lshl_add_u32 v64, v64, 4, v65
    s_add_u32 m0, s57, 0
    s_nop 0
    buffer_load_dwordx4 v64, s[12:15], s86 offen nt lds
    v_add_u32 v64, 64, v1
    v_mul_u32_u24 v65, 4370, v64
    v_lshrrev_b32 v65, 16, v65
    v_mad_i32_i24 v66, v65, -15, v64
    v_mul_u32_u24 v66, 13108, v66
    v_lshrrev_b32 v66, 16, v66
    v_mul_u32_u24 v66, 1072, v66
    v_mad_u32_u24 v65, v65, s88, v66
    v_lshl_add_u32 v64, v64, 4, v65
    s_add_u32 m0, s57, 1024
    s_nop 0
    buffer_load_dwordx4 v64, s[12:15], s86 offen nt lds
    v_add_u32 v64, 128, v1
    v_mul_u32_u24 v65, 4370, v64
    v_lshrrev_b32 v65, 16, v65
    v_mad_i32_i24 v66, v65, -15, v64
    v_mul_u32_u24 v66, 13108, v66
    v_lshrrev_b32 v66, 16, v66
    v_mul_u32_u24 v66, 1072, v66
    v_mad_u32_u24 v65, v65, s88, v66
    v_lshl_add_u32 v64, v64, 4, v65
    s_add_u32 m0, s57, 2048
    s_nop 0
    buffer_load_dwordx4 v64, s[12:15], s86 offen nt lds
    v_add_u32 v64, 192, v1
    v_mul_u32_u24 v65, 4370, v64
    v_lshrrev_b32 v65, 16, v65
    v_mad_i32_i24 v66, v65, -15, v64
    v_mul_u32_u24 v66, 13108, v66
    v_lshrrev_b32 v66, 16, v66
    v_mul_u32_u24 v66, 1072, v66
    v_mad_u32_u24 v65, v65, s88, v66
    v_lshl_add_u32 v64, v64, 4, v65
    s_add_u32 m0, s57, 3072
    s_nop 0
    buffer_load_dwordx4 v64, s[12:15], s86 offen nt lds
    v_add_u32 v64, 256, v1
    v_mul_u32_u24 v65, 4370, v64
    v_lshrrev_b32 v65, 16, v65
    v_mad_i32_i24 v66, v65, -15, v64
    v_mul_u32_u24 v66, 13108, v66
    v_lshrrev_b32 v66, 16, v66
    v_mul_u32_u24 v66, 1072, v66
    v_mad_u32_u24 v65, v65, s88, v66
    v_lshl_add_u32 v64, v64, 4, v65
    s_add_u32 m0, s57, 4096
    s_nop 0
    buffer_load_dwordx4 v64, s[12:15], s86 offen nt lds
    v_add_u32 v64, 320, v1
    v_mul_u32_u24 v65, 4370, v64
    v_lshrrev_b32 v65, 16, v65
    v_mad_i32_i24 v66, v65, -15, v64
    v_mul_u32_u24 v66, 13108, v66
    v_lshrrev_b32 v66, 16, v66
    v_mul_u32_u24 v66, 1072, v66
    v_mad_u32_u24 v65, v65, s88, v66
    v_lshl_add_u32 v64, v64, 4, v65
    s_add_u32 m0, s57, 5120
    s_nop 0
    buffer_load_dwordx4 v64, s[12:15], s86 offen nt lds
    v_add_u32 v64, 384, v1
    v_mul_u32_u24 v65, 4370, v64
    v_lshrrev_b32 v65, 16, v65
    v_mad_i32_i24 v66, v65, -15, v64
    v_mul_u32_u24 v66, 13108, v66
    v_lshrrev_b32 v66, 16, v66
    v_mul_u32_u24 v66, 1072, v66
    v_mad_u32_u24 v65, v65, s88, v66
    v_lshl_add_u32 v64, v64, 4, v65
    s_add_u32 m0, s57, 6144
    s_nop 0
    buffer_load_dwordx4 v64, s[12:15], s86 offen nt lds
    v_add_u32 v64, 448, v1
    v_mul_u32_u24 v65, 4370, v64
    v_lshrrev_b32 v65, 16, v65
    v_mad_i32_i24 v66, v65, -15, v64
    v_mul_u32_u24 v66, 13108, v66
    v_lshrrev_b32 v66, 16, v66
    v_mul_u32_u24 v66, 1072, v66
    v_mad_u32_u24 v65, v65, s88, v66
    v_lshl_add_u32 v64, v64, 4, v65
    s_add_u32 m0, s57, 7168
    s_nop 0
    buffer_load_dwordx4 v64, s[12:15], s86 offen nt lds
    s_lshl_b32 s1, s84, 5
    s_add_u32 s1, s1, s85
    s_lshl_b32 s1, s1, 3
    s_add_u32 s1, s1, 4063232
    s_branch L_uend_4
L_uw_5:
    s_cmp_ge_u32 s22, 18
    s_cbranch_scc1 L_uend_4
    s_mul_i32 s67, s21, 14
    s_add_u32 s67, s67, s22
    s_sub_u32 s67, s67, 4
    s_cmp_ge_u32 s67, 108
    s_cbranch_scc1 L_uend_4
    s_mov_b32 s55, 2
    s_mul_i32 s84, s67, 3641
    s_lshr_b32 s84, s84, 16
    s_mul_i32 s85, s84, 18
    s_sub_u32 s85, s67, s85
    s_mul_i32 s86, s85, 41472
    s_sub_u32 s87, s85, 16
    s_mul_i32 s87, s87, 331776
    s_add_u32 s87, s87, 18432
    s_cmp_lt_u32 s85, 16
    s_cselect_b32 s86, s86, s87
    s_mov_b32 s88, 82944
    s_mov_b32 s89, 41472
    s_cselect_b32 s88, 4608, s88
    s_cselect_b32 s89, 23040, s89
    s_mul_i32 s87, s84, 192
    s_add_u32 s86, s86, s87
    s_mov_b32 s90, 1152
    s_mul_i32 s91, s67, 6144
    s_mov_b32 s12, s28
    s_mov_b32 s13, s29
    s_mov_b32 s14, 0xa2000
    s_mov_b32 s15, 0x20000
    v_add_u32 v64, 0, v1
    v_mul_u32_u24 v65, 5462, v64
    v_lshrrev_b32 v65, 16, v65
    v_mul_u32_u24 v66, 12, v65
    v_sub_u32 v64, v64, v66
    v_lshlrev_b32 v64, 4, v64
    v_lshrrev_b32 v66, 3, v65
    v_mul_lo_u32 v66, v66, s88
    v_bfe_u32 v67, v65, 2, 1
    v_mul_lo_u32 v67, v67, s89
    v_and_b32 v65, 3, v65
    v_mul_lo_u32 v65, v65, s90
    v_add3_u32 v64, v64, v66, v67
    v_add3_u32 v64, v64, v65, s86
    s_add_u32 m0, s57, 0
    s_nop 0
    buffer_load_dwordx4 v64, s[12:15], 0 offen nt lds
    v_add_u32 v64, 64, v1
    v_mul_u32_u24 v65, 5462, v64
    v_lshrrev_b32 v65, 16, v65
    v_mul_u32_u24 v66, 12, v65
    v_sub_u32 v64, v64, v66
    v_lshlrev_b32 v64, 4, v64
    v_lshrrev_b32 v66, 3, v65
    v_mul_lo_u32 v66, v66, s88
    v_bfe_u32 v67, v65, 2, 1
    v_mul_lo_u32 v67, v67, s89
    v_and_b32 v65, 3, v65
    v_mul_lo_u32 v65, v65, s90
    v_add3_u32 v64, v64, v66, v67
    v_add3_u32 v64, v64, v65, s86
    s_add_u32 m0, s57, 1024
    s_nop 0
    buffer_load_dwordx4 v64, s[12:15], 0 offen nt lds
    v_add_u32 v64, 128, v1
    v_mul_u32_u24 v65, 5462, v64
    v_lshrrev_b32 v65, 16, v65
    v_mul_u32_u24 v66, 12, v65
    v_sub_u32 v64, v64, v66
    v_lshlrev_b32 v64, 4, v64
    v_lshrrev_b32 v66, 3, v65
    v_mul_lo_u32 v66, v66, s88
    v_bfe_u32 v67, v65, 2, 1
    v_mul_lo_u32 v67, v67, s89
    v_and_b32 v65, 3, v65
    v_mul_lo_u32 v65, v65, s90
    v_add3_u32 v64, v64, v66, v67
    v_add3_u32 v64, v64, v65, s86
    s_add_u32 m0, s57, 2048
    s_nop 0
    buffer_load_dwordx4 v64, s[12:15], 0 offen nt lds
    v_add_u32 v64, 192, v1
    v_mul_u32_u24 v65, 5462, v64
    v_lshrrev_b32 v65, 16, v65
    v_mul_u32_u24 v66, 12, v65
    v_sub_u32 v64, v64, v66
    v_lshlrev_b32 v64, 4, v64
    v_lshrrev_b32 v66, 3, v65
    v_mul_lo_u32 v66, v66, s88
    v_bfe_u32 v67, v65, 2, 1
    v_mul_lo_u32 v67, v67, s89
    v_and_b32 v65, 3, v65
    v_mul_lo_u32 v65, v65, s90
    v_add3_u32 v64, v64, v66, v67
    v_add3_u32 v64, v64, v65, s86
    s_add_u32 m0, s57, 3072
    s_nop 0
    buffer_load_dwordx4 v64, s[12:15], 0 offen nt lds
    v_add_u32 v64, 256, v1
    v_mul_u32_u24 v65, 5462, v64
    v_lshrrev_b32 v65, 16, v65
    v_mul_u32_u24 v66, 12, v65
    v_sub_u32 v64, v64, v66
    v_lshlrev_b32 v64, 4, v64
    v_lshrrev_b32 v66, 3, v65
    v_mul_lo_u32 v66, v66, s88
    v_bfe_u32 v67, v65, 2, 1
    v_mul_lo_u32 v67, v67, s89
    v_and_b32 v65, 3, v65
    v_mul_lo_u32 v65, v65, s90
    v_add3_u32 v64, v64, v66, v67
    v_add3_u32 v64, v64, v65, s86
    s_add_u32 m0, s57, 4096
    s_nop 0
    buffer_load_dwordx4 v64, s[12:15], 0 offen nt lds
    v_add_u32 v64, 320, v1
    v_mul_u32_u24 v65, 5462, v64
    v_lshrrev_b32 v65, 16, v65
    v_mul_u32_u24 v66, 12, v65
    v_sub_u32 v64, v64, v66
    v_lshlrev_b32 v64, 4, v64
    v_lshrrev_b32 v66, 3, v65
    v_mul_lo_u32 v66, v66, s88
    v_bfe_u32 v67, v65, 2, 1
    v_mul_lo_u32 v67, v67, s89
    v_and_b32 v65, 3, v65
    v_mul_lo_u32 v65, v65, s90
    v_add3_u32 v64, v64, v66, v67
    v_add3_u32 v64, v64, v65, s86
    s_add_u32 m0, s57, 5120
    s_nop 0
    buffer_load_dwordx4 v64, s[12:15], 0 offen nt lds
    s_lshl_b32 s1, s84, 5
    s_add_u32 s1, s1, s85
    s_lshl_b32 s1, s1, 3
    s_add_u32 s1, s1, 4067328
L_uend_4:
    v_add_u32 v64, 0, v1
    v_mul_u32_u24 v65, 3641, v64
    v_lshrrev_b32 v65, 16, v65
    v_mul_u32_u24 v66, 18, v65
    v_sub_u32 v64, v64, v66
    v_lshl_or_b32 v220, v64, 8, v65
    v_add_u32 v64, 64, v1
    v_mul_u32_u24 v65, 3641, v64
    v_lshrrev_b32 v65, 16, v65
    v_mul_u32_u24 v66, 18, v65
    v_sub_u32 v64, v64, v66
    v_lshl_or_b32 v221, v64, 8, v65
    v_add_u32 v64, 128, v1
    v_mul_u32_u24 v65, 3641, v64
    v_lshrrev_b32 v65, 16, v65
    v_mul_u32_u24 v66, 18, v65
    v_sub_u32 v64, v64, v66
    v_lshl_or_b32 v222, v64, 8, v65
    v_add_u32 v64, 192, v1
    v_mul_u32_u24 v65, 3641, v64
    v_lshrrev_b32 v65, 16, v65
    v_mul_u32_u24 v66, 18, v65
    v_sub_u32 v64, v64, v66
    v_lshl_or_b32 v223, v64, 8, v65
    v_add_u32 v64, 256, v1
    v_mul_u32_u24 v65, 3641, v64
    v_lshrrev_b32 v65, 16, v65
    v_mul_u32_u24 v66, 18, v65
    v_sub_u32 v64, v64, v66
    v_lshl_or_b32 v224, v64, 8, v65
    v_add_u32 v64, 320, v1
    v_mul_u32_u24 v65, 3641, v64
    v_lshrrev_b32 v65, 16, v65
    v_mul_u32_u24 v66, 18, v65
    v_sub_u32 v64, v64, v66
    v_lshl_or_b32 v225, v64, 8, v65
    v_add_u32 v64, 384, v1
    v_mul_u32_u24 v65, 3641, v64
    v_lshrrev_b32 v65, 16, v65
    v_mul_u32_u24 v66, 18, v65
    v_sub_u32 v64, v64, v66
    v_lshl_or_b32 v226, v64, 8, v65
    v_add_u32 v64, 448, v1
    v_mul_u32_u24 v65, 3641, v64
    v_lshrrev_b32 v65, 16, v65
    v_mul_u32_u24 v66, 18, v65
    v_sub_u32 v64, v64, v66
    v_lshl_or_b32 v227, v64, 8, v65
    v_add_u32 v64, 512, v1
    v_mul_u32_u24 v65, 3641, v64
    v_lshrrev_b32 v65, 16, v65
    v_mul_u32_u24 v66, 18, v65
    v_sub_u32 v64, v64, v66
    v_lshl_or_b32 v228, v64, 8, v65
    s_lshl_b32 s3, s21, 7
    s_lshl_b32 s52, s22, 2
    s_add_u32 s53, s52, s20
    s_add_u32 s3, s3, s53
    s_lshr_b32 s52, s3, 5
    s_and_b32 s3, s3, 31
    s_mul_i32 s3, s3, 36
    s_add_u32 s3, s3, s52
    s_cmp_ge_u32 s3, 1152
    s_cbranch_scc1 L_ud_6
    s_mul_i32 s64, s3, 1821
    s_lshr_b32 s64, s64, 16
    s_mul_i32 s92, s64, 36
    s_sub_u32 s92, s3, s92
    s_and_b32 s93, s92, 1
    s_lshr_b32 s94, s92, 1
    s_cmp_eq_u32 s93, 0
    s_cselect_b32 s16, s32, s34
    s_cselect_b32 s17, s33, s35
    s_mul_i32 s58, s94, 294912
    s_mul_i32 s95, s64, 288
    s_add_u32 s58, s58, s95
    s_mov_b32 s59, 73728
    s_mov_b32 s60, 36864
    s_mov_b32 s61, 9216
    s_branch L_udone_7
L_ud_6:
    s_sub_u32 s92, s3, 1152
    s_mul_i32 s64, s92, 3641
    s_lshr_b32 s64, s64, 16
    s_mul_i32 s93, s64, 18
    s_sub_u32 s92, s92, s93
    s_and_b32 s93, s64, 3
    s_and_b32 s94, s93, 1
    s_mov_b32 s16, s36
    s_mov_b32 s17, s37
    s_mov_b32 s61, 1152
    s_cmp_eq_u32 s94, 0
    s_mov_b32 s97, -165888
    s_cselect_b32 s97, 165888, s97
    s_mov_b32 s59, 9216
    s_mov_b32 s60, 4608
    s_cmp_ge_u32 s92, 4
    s_cbranch_scc1 L_ush_8
    s_mov_b32 s95, s93
    s_lshl_b32 s96, s92, 5
    s_branch L_urows_10
L_ush_8:
    s_cmp_ge_u32 s92, 6
    s_cbranch_scc1 L_urm_9
    s_sub_u32 s95, s92, 4
    s_lshl_b32 s95, s95, 1
    s_xor_b32 s95, s95, s93
    s_mov_b32 s96, 128
    s_mov_b32 s59, 4608
    s_mov_b32 s60, s97
    s_branch L_urows_10
L_urm_9:
    s_sub_u32 s95, s92, 6
    s_mul_i32 s96, s95, 21846
    s_lshr_b32 s96, s96, 16
    s_mul_i32 s97, s96, 3
    s_sub_u32 s95, s95, s97
    s_add_u32 s95, s95, 1
    s_xor_b32 s95, s95, s93
    s_lshl_b32 s96, s96, 5
L_urows_10:
    s_mul_i32 s95, s95, 144
    s_add_u32 s95, s95, s96
    s_lshr_b32 s96, s64, 2
    s_mul_i32 s96, s96, 576
    s_add_u32 s95, s95, s96
    s_mul_i32 s95, s95, 1152
    s_mul_i32 s96, s93, 288
    s_add_u32 s58, s95, s96
L_udone_7:
    s_mov_b32 s18, 0x510000
    s_mov_b32 s19, 0x20000
    v_bfe_u32 v64, v220, 3, 2
    v_mul_u32_u24 v64, s59, v64
    v_bfe_u32 v65, v220, 2, 1
    v_mul_lo_u32 v65, v65, s60
    v_and_b32 v66, 3, v220
    v_mul_u32_u24 v66, s61, v66
    v_add3_u32 v64, v64, v65, v66
    v_lshrrev_b32 v65, 8, v220
    v_lshl_add_u32 v64, v65, 4, v64
    v_add_u32 v229, s58, v64
    v_bfe_u32 v64, v221, 3, 2
    v_mul_u32_u24 v64, s59, v64
    v_bfe_u32 v65, v221, 2, 1
    v_mul_lo_u32 v65, v65, s60
    v_and_b32 v66, 3, v221
    v_mul_u32_u24 v66, s61, v66
    v_add3_u32 v64, v64, v65, v66
    v_lshrrev_b32 v65, 8, v221
    v_lshl_add_u32 v64, v65, 4, v64
    v_add_u32 v230, s58, v64
    v_bfe_u32 v64, v222, 3, 2
    v_mul_u32_u24 v64, s59, v64
    v_bfe_u32 v65, v222, 2, 1
    v_mul_lo_u32 v65, v65, s60
    v_and_b32 v66, 3, v222
    v_mul_u32_u24 v66, s61, v66
    v_add3_u32 v64, v64, v65, v66
    v_lshrrev_b32 v65, 8, v222
    v_lshl_add_u32 v64, v65, 4, v64
    v_add_u32 v231, s58, v64
    v_bfe_u32 v64, v223, 3, 2
    v_mul_u32_u24 v64, s59, v64
    v_bfe_u32 v65, v223, 2, 1
    v_mul_lo_u32 v65, v65, s60
    v_and_b32 v66, 3, v223
    v_mul_u32_u24 v66, s61, v66
    v_add3_u32 v64, v64, v65, v66
    v_lshrrev_b32 v65, 8, v223
    v_lshl_add_u32 v64, v65, 4, v64
    v_add_u32 v232, s58, v64
    v_bfe_u32 v64, v224, 3, 2
    v_mul_u32_u24 v64, s59, v64
    v_bfe_u32 v65, v224, 2, 1
    v_mul_lo_u32 v65, v65, s60
    v_and_b32 v66, 3, v224
    v_mul_u32_u24 v66, s61, v66
    v_add3_u32 v64, v64, v65, v66
    v_lshrrev_b32 v65, 8, v224
    v_lshl_add_u32 v64, v65, 4, v64
    v_add_u32 v233, s58, v64
    v_bfe_u32 v64, v225, 3, 2
    v_mul_u32_u24 v64, s59, v64
    v_bfe_u32 v65, v225, 2, 1
    v_mul_lo_u32 v65, v65, s60
    v_and_b32 v66, 3, v225
    v_mul_u32_u24 v66, s61, v66
    v_add3_u32 v64, v64, v65, v66
    v_lshrrev_b32 v65, 8, v225
    v_lshl_add_u32 v64, v65, 4, v64
    v_add_u32 v234, s58, v64
    v_bfe_u32 v64, v226, 3, 2
    v_mul_u32_u24 v64, s59, v64
    v_bfe_u32 v65, v226, 2, 1
    v_mul_lo_u32 v65, v65, s60
    v_and_b32 v66, 3, v226
    v_mul_u32_u24 v66, s61, v66
    v_add3_u32 v64, v64, v65, v66
    v_lshrrev_b32 v65, 8, v226
    v_lshl_add_u32 v64, v65, 4, v64
    v_add_u32 v235, s58, v64
    v_bfe_u32 v64, v227, 3, 2
    v_mul_u32_u24 v64, s59, v64
    v_bfe_u32 v65, v227, 2, 1
    v_mul_lo_u32 v65, v65, s60
    v_and_b32 v66, 3, v227
    v_mul_u32_u24 v66, s61, v66
    v_add3_u32 v64, v64, v65, v66
    v_lshrrev_b32 v65, 8, v227
    v_lshl_add_u32 v64, v65, 4, v64
    v_add_u32 v236, s58, v64
    v_bfe_u32 v64, v228, 3, 2
    v_mul_u32_u24 v64, s59, v64
    v_bfe_u32 v65, v228, 2, 1
    v_mul_lo_u32 v65, v65, s60
    v_and_b32 v66, 3, v228
    v_mul_u32_u24 v66, s61, v66
    v_add3_u32 v64, v64, v65, v66
    v_lshrrev_b32 v65, 8, v228
    v_lshl_add_u32 v64, v65, 4, v64
    v_add_u32 v237, s58, v64
    s_mov_b32 s30, -1
    s_mov_b32 s31, -1
    s_mul_i32 s54, s21, 72
    s_add_u32 s54, s54, 1152
    s_cmp_ge_u32 s22, 24
    s_cbranch_scc1 L_ui_11
    s_cmp_lg_u32 s20, 3
    s_cbranch_scc1 L_ue_14
    s_add_u32 s30, s54, s22
    s_add_u32 s30, s30, 48
    s_branch L_ub_13
L_ui_11:
    s_sub_u32 s53, s53, 96
    s_add_u32 s31, s54, s53
    s_add_u32 s30, s31, -16
    s_add_u32 s31, s31, 16
    s_cmp_ge_u32 s53, 16
    s_cbranch_scc1 L_ud_12
    s_lshl_b32 s30, s21, 4
    s_add_u32 s30, s30, s53
    s_add_u32 s30, s30, 1024
    s_lshr_b32 s52, s30, 5
    s_and_b32 s30, s30, 31
    s_mul_i32 s30, s30, 36
    s_add_u32 s30, s30, s52
L_ud_12:
L_ub_13:
L_ue_14:
    v_mov_b32 v238, 0
    v_mov_b32 v239, 0
    v_mov_b32 v240, 0
    v_mov_b32 v241, 0
    v_mov_b32 v242, 0
    v_mov_b32 v243, 0
    v_mov_b32 v244, 0
    v_mov_b32 v245, 0
    v_mov_b32 v246, 0
    s_mov_b32 s14, 0
    s_cmp_eq_u32 s30, -1
    s_cbranch_scc1 L_absent_15
    s_cmp_ge_u32 s30, 1152
    s_cbranch_scc1 L_ud_16
    s_mul_i32 s64, s30, 1821
    s_lshr_b32 s64, s64, 16
    s_mul_i32 s92, s64, 36
    s_sub_u32 s92, s30, s92
    s_and_b32 s93, s92, 1
    s_lshr_b32 s94, s92, 1
    s_cmp_eq_u32 s93, 0
    s_cselect_b32 s12, s32, s34
    s_cselect_b32 s13, s33, s35
    s_mul_i32 s58, s94, 294912
    s_mul_i32 s95, s64, 288
    s_add_u32 s58, s58, s95
    s_mov_b32 s59, 73728
    s_mov_b32 s60, 36864
    s_mov_b32 s61, 9216
    s_branch L_udone_17
L_ud_16:
    s_sub_u32 s92, s30, 1152
    s_mul_i32 s64, s92, 3641
    s_lshr_b32 s64, s64, 16
    s_mul_i32 s93, s64, 18
    s_sub_u32 s92, s92, s93
    s_and_b32 s93, s64, 3
    s_and_b32 s94, s93, 1
    s_mov_b32 s12, s36
    s_mov_b32 s13, s37
    s_mov_b32 s61, 1152
    s_cmp_eq_u32 s94, 0
    s_mov_b32 s97, -165888
    s_cselect_b32 s97, 165888, s97
    s_mov_b32 s59, 9216
    s_mov_b32 s60, 4608
    s_cmp_ge_u32 s92, 4
    s_cbranch_scc1 L_ush_18
    s_mov_b32 s95, s93
    s_lshl_b32 s96, s92, 5
    s_branch L_urows_20
L_ush_18:
    s_cmp_ge_u32 s92, 6
    s_cbranch_scc1 L_urm_19
    s_sub_u32 s95, s92, 4
    s_lshl_b32 s95, s95, 1
    s_xor_b32 s95, s95, s93
    s_mov_b32 s96, 128
    s_mov_b32 s59, 4608
    s_mov_b32 s60, s97
    s_branch L_urows_20
L_urm_19:
    s_sub_u32 s95, s92, 6
    s_mul_i32 s96, s95, 21846
    s_lshr_b32 s96, s96, 16
    s_mul_i32 s97, s96, 3
    s_sub_u32 s95, s95, s97
    s_add_u32 s95, s95, 1
    s_xor_b32 s95, s95, s93
    s_lshl_b32 s96, s96, 5
L_urows_20:
    s_mul_i32 s95, s95, 144
    s_add_u32 s95, s95, s96
    s_lshr_b32 s96, s64, 2
    s_mul_i32 s96, s96, 576
    s_add_u32 s95, s95, s96
    s_mul_i32 s95, s95, 1152
    s_mul_i32 s96, s93, 288
    s_add_u32 s58, s95, s96
L_udone_17:
    s_mov_b32 s14, 0x510000
    s_mov_b32 s15, 0x20000
    v_bfe_u32 v64, v220, 3, 2
    v_mul_u32_u24 v64, s59, v64
    v_bfe_u32 v65, v220, 2, 1
    v_mul_lo_u32 v65, v65, s60
    v_and_b32 v66, 3, v220
    v_mul_u32_u24 v66, s61, v66
    v_add3_u32 v64, v64, v65, v66
    v_lshrrev_b32 v65, 8, v220
    v_lshl_add_u32 v64, v65, 4, v64
    v_add_u32 v238, s58, v64
    v_bfe_u32 v64, v221, 3, 2
    v_mul_u32_u24 v64, s59, v64
    v_bfe_u32 v65, v221, 2, 1
    v_mul_lo_u32 v65, v65, s60
    v_and_b32 v66, 3, v221
    v_mul_u32_u24 v66, s61, v66
    v_add3_u32 v64, v64, v65, v66
    v_lshrrev_b32 v65, 8, v221
    v_lshl_add_u32 v64, v65, 4, v64
    v_add_u32 v239, s58, v64
    v_bfe_u32 v64, v222, 3, 2
    v_mul_u32_u24 v64, s59, v64
    v_bfe_u32 v65, v222, 2, 1
    v_mul_lo_u32 v65, v65, s60
    v_and_b32 v66, 3, v222
    v_mul_u32_u24 v66, s61, v66
    v_add3_u32 v64, v64, v65, v66
    v_lshrrev_b32 v65, 8, v222
    v_lshl_add_u32 v64, v65, 4, v64
    v_add_u32 v240, s58, v64
    v_bfe_u32 v64, v223, 3, 2
    v_mul_u32_u24 v64, s59, v64
    v_bfe_u32 v65, v223, 2, 1
    v_mul_lo_u32 v65, v65, s60
    v_and_b32 v66, 3, v223
    v_mul_u32_u24 v66, s61, v66
    v_add3_u32 v64, v64, v65, v66
    v_lshrrev_b32 v65, 8, v223
    v_lshl_add_u32 v64, v65, 4, v64
    v_add_u32 v241, s58, v64
    v_bfe_u32 v64, v224, 3, 2
    v_mul_u32_u24 v64, s59, v64
    v_bfe_u32 v65, v224, 2, 1
    v_mul_lo_u32 v65, v65, s60
    v_and_b32 v66, 3, v224
    v_mul_u32_u24 v66, s61, v66
    v_add3_u32 v64, v64, v65, v66
    v_lshrrev_b32 v65, 8, v224
    v_lshl_add_u32 v64, v65, 4, v64
    v_add_u32 v242, s58, v64
    v_bfe_u32 v64, v225, 3, 2
    v_mul_u32_u24 v64, s59, v64
    v_bfe_u32 v65, v225, 2, 1
    v_mul_lo_u32 v65, v65, s60
    v_and_b32 v66, 3, v225
    v_mul_u32_u24 v66, s61, v66
    v_add3_u32 v64, v64, v65, v66
    v_lshrrev_b32 v65, 8, v225
    v_lshl_add_u32 v64, v65, 4, v64
    v_add_u32 v243, s58, v64
    v_bfe_u32 v64, v226, 3, 2
    v_mul_u32_u24 v64, s59, v64
    v_bfe_u32 v65, v226, 2, 1
    v_mul_lo_u32 v65, v65, s60
    v_and_b32 v66, 3, v226
    v_mul_u32_u24 v66, s61, v66
    v_add3_u32 v64, v64, v65, v66
    v_lshrrev_b32 v65, 8, v226
    v_lshl_add_u32 v64, v65, 4, v64
    v_add_u32 v244, s58, v64
    v_bfe_u32 v64, v227, 3, 2
    v_mul_u32_u24 v64, s59, v64
    v_bfe_u32 v65, v227, 2, 1
    v_mul_lo_u32 v65, v65, s60
    v_and_b32 v66, 3, v227
    v_mul_u32_u24 v66, s61, v66
    v_add3_u32 v64, v64, v65, v66
    v_lshrrev_b32 v65, 8, v227
    v_lshl_add_u32 v64, v65, 4, v64
    v_add_u32 v245, s58, v64
    v_bfe_u32 v64, v228, 3, 2
    v_mul_u32_u24 v64, s59, v64
    v_bfe_u32 v65, v228, 2, 1
    v_mul_lo_u32 v65, v65, s60
    v_and_b32 v66, 3, v228
    v_mul_u32_u24 v66, s61, v66
    v_add3_u32 v64, v64, v65, v66
    v_lshrrev_b32 v65, 8, v228
    v_lshl_add_u32 v64, v65, 4, v64
    v_add_u32 v246, s58, v64
L_absent_15:
    v_mov_b32 v247, 0
    v_mov_b32 v248, 0
    v_mov_b32 v249, 0
    v_mov_b32 v250, 0
    v_mov_b32 v251, 0
    v_mov_b32 v252, 0
    v_mov_b32 v253, 0
    v_mov_b32 v254, 0
    v_mov_b32 v255, 0
    s_mov_b32 s10, 0
    s_cmp_eq_u32 s31, -1
    s_cbranch_scc1 L_absent_21
    s_cmp_ge_u32 s31, 1152
    s_cbranch_scc1 L_ud_22
    s_mul_i32 s64, s31, 1821
    s_lshr_b32 s64, s64, 16
    s_mul_i32 s92, s64, 36
    s_sub_u32 s92, s31, s92
    s_and_b32 s93, s92, 1
    s_lshr_b32 s94, s92, 1
    s_cmp_eq_u32 s93, 0
    s_cselect_b32 s8, s32, s34
    s_cselect_b32 s9, s33, s35
    s_mul_i32 s58, s94, 294912
    s_mul_i32 s95, s64, 288
    s_add_u32 s58, s58, s95
    s_mov_b32 s59, 73728
    s_mov_b32 s60, 36864
    s_mov_b32 s61, 9216
    s_branch L_udone_23
L_ud_22:
    s_sub_u32 s92, s31, 1152
    s_mul_i32 s64, s92, 3641
    s_lshr_b32 s64, s64, 16
    s_mul_i32 s93, s64, 18
    s_sub_u32 s92, s92, s93
    s_and_b32 s93, s64, 3
    s_and_b32 s94, s93, 1
    s_mov_b32 s8, s36
    s_mov_b32 s9, s37
    s_mov_b32 s61, 1152
    s_cmp_eq_u32 s94, 0
    s_mov_b32 s97, -165888
    s_cselect_b32 s97, 165888, s97
    s_mov_b32 s59, 9216
    s_mov_b32 s60, 4608
    s_cmp_ge_u32 s92, 4
    s_cbranch_scc1 L_ush_24
    s_mov_b32 s95, s93
    s_lshl_b32 s96, s92, 5
    s_branch L_urows_26
L_ush_24:
    s_cmp_ge_u32 s92, 6
    s_cbranch_scc1 L_urm_25
    s_sub_u32 s95, s92, 4
    s_lshl_b32 s95, s95, 1
    s_xor_b32 s95, s95, s93
    s_mov_b32 s96, 128
    s_mov_b32 s59, 4608
    s_mov_b32 s60, s97
    s_branch L_urows_26
L_urm_25:
    s_sub_u32 s95, s92, 6
    s_mul_i32 s96, s95, 21846
    s_lshr_b32 s96, s96, 16
    s_mul_i32 s97, s96, 3
    s_sub_u32 s95, s95, s97
    s_add_u32 s95, s95, 1
    s_xor_b32 s95, s95, s93
    s_lshl_b32 s96, s96, 5
L_urows_26:
    s_mul_i32 s95, s95, 144
    s_add_u32 s95, s95, s96
    s_lshr_b32 s96, s64, 2
    s_mul_i32 s96, s96, 576
    s_add_u32 s95, s95, s96
    s_mul_i32 s95, s95, 1152
    s_mul_i32 s96, s93, 288
    s_add_u32 s58, s95, s96
L_udone_23:
    s_mov_b32 s10, 0x510000
    s_mov_b32 s11, 0x20000
    v_bfe_u32 v64, v220, 3, 2
    v_mul_u32_u24 v64, s59, v64
    v_bfe_u32 v65, v220, 2, 1
    v_mul_lo_u32 v65, v65, s60
    v_and_b32 v66, 3, v220
    v_mul_u32_u24 v66, s61, v66
    v_add3_u32 v64, v64, v65, v66
    v_lshrrev_b32 v65, 8, v220
    v_lshl_add_u32 v64, v65, 4, v64
    v_add_u32 v247, s58, v64
    v_bfe_u32 v64, v221, 3, 2
    v_mul_u32_u24 v64, s59, v64
    v_bfe_u32 v65, v221, 2, 1
    v_mul_lo_u32 v65, v65, s60
    v_and_b32 v66, 3, v221
    v_mul_u32_u24 v66, s61, v66
    v_add3_u32 v64, v64, v65, v66
    v_lshrrev_b32 v65, 8, v221
    v_lshl_add_u32 v64, v65, 4, v64
    v_add_u32 v248, s58, v64
    v_bfe_u32 v64, v222, 3, 2
    v_mul_u32_u24 v64, s59, v64
    v_bfe_u32 v65, v222, 2, 1
    v_mul_lo_u32 v65, v65, s60
    v_and_b32 v66, 3, v222
    v_mul_u32_u24 v66, s61, v66
    v_add3_u32 v64, v64, v65, v66
    v_lshrrev_b32 v65, 8, v222
    v_lshl_add_u32 v64, v65, 4, v64
    v_add_u32 v249, s58, v64
    v_bfe_u32 v64, v223, 3, 2
    v_mul_u32_u24 v64, s59, v64
    v_bfe_u32 v65, v223, 2, 1
    v_mul_lo_u32 v65, v65, s60
    v_and_b32 v66, 3, v223
    v_mul_u32_u24 v66, s61, v66
    v_add3_u32 v64, v64, v65, v66
    v_lshrrev_b32 v65, 8, v223
    v_lshl_add_u32 v64, v65, 4, v64
    v_add_u32 v250, s58, v64
    v_bfe_u32 v64, v224, 3, 2
    v_mul_u32_u24 v64, s59, v64
    v_bfe_u32 v65, v224, 2, 1
    v_mul_lo_u32 v65, v65, s60
    v_and_b32 v66, 3, v224
    v_mul_u32_u24 v66, s61, v66
    v_add3_u32 v64, v64, v65, v66
    v_lshrrev_b32 v65, 8, v224
    v_lshl_add_u32 v64, v65, 4, v64
    v_add_u32 v251, s58, v64
    v_bfe_u32 v64, v225, 3, 2
    v_mul_u32_u24 v64, s59, v64
    v_bfe_u32 v65, v225, 2, 1
    v_mul_lo_u32 v65, v65, s60
    v_and_b32 v66, 3, v225
    v_mul_u32_u24 v66, s61, v66
    v_add3_u32 v64, v64, v65, v66
    v_lshrrev_b32 v65, 8, v225
    v_lshl_add_u32 v64, v65, 4, v64
    v_add_u32 v252, s58, v64
    v_bfe_u32 v64, v226, 3, 2
    v_mul_u32_u24 v64, s59, v64
    v_bfe_u32 v65, v226, 2, 1
    v_mul_lo_u32 v65, v65, s60
    v_and_b32 v66, 3, v226
    v_mul_u32_u24 v66, s61, v66
    v_add3_u32 v64, v64, v65, v66
    v_lshrrev_b32 v65, 8, v226
    v_lshl_add_u32 v64, v65, 4, v64
    v_add_u32 v253, s58, v64
    v_bfe_u32 v64, v227, 3, 2
    v_mul_u32_u24 v64, s59, v64
    v_bfe_u32 v65, v227, 2, 1
    v_mul_lo_u32 v65, v65, s60
    v_and_b32 v66, 3, v227
    v_mul_u32_u24 v66, s61, v66
    v_add3_u32 v64, v64, v65, v66
    v_lshrrev_b32 v65, 8, v227
    v_lshl_add_u32 v64, v65, 4, v64
    v_add_u32 v254, s58, v64
    v_bfe_u32 v64, v228, 3, 2
    v_mul_u32_u24 v64, s59, v64
    v_bfe_u32 v65, v228, 2, 1
    v_mul_lo_u32 v65, v65, s60
    v_and_b32 v66, 3, v228
    v_mul_u32_u24 v66, s61, v66
    v_add3_u32 v64, v64, v65, v66
    v_lshrrev_b32 v65, 8, v228
    v_lshl_add_u32 v64, v65, 4, v64
    v_add_u32 v255, s58, v64
L_absent_21:
    s_cmp_eq_u32 s20, 3
    s_cbranch_scc1 L_w3_30
    s_waitcnt vmcnt(0)
    v_lshlrev_b32 v20, 16, v8
    v_and_b32 v21, 0xffff0000, v8
    v_lshlrev_b32 v22, 16, v9
    v_and_b32 v23, 0xffff0000, v9
    v_lshlrev_b32 v24, 16, v10
    v_and_b32 v25, 0xffff0000, v10
    v_lshlrev_b32 v26, 16, v11
    v_and_b32 v27, 0xffff0000, v11
    v_lshlrev_b32 v28, 16, v12
    v_and_b32 v29, 0xffff0000, v12
    v_lshlrev_b32 v30, 16, v13
    v_and_b32 v31, 0xffff0000, v13
    v_lshlrev_b32 v32, 16, v14
    v_and_b32 v33, 0xffff0000, v14
    v_lshlrev_b32 v34, 16, v15
    v_and_b32 v35, 0xffff0000, v15
    v_lshlrev_b32 v36, 16, v16
    v_and_b32 v37, 0xffff0000, v16
    v_lshlrev_b32 v38, 16, v17
    v_and_b32 v39, 0xffff0000, v17
    v_lshlrev_b32 v40, 16, v18
    v_and_b32 v41, 0xffff0000, v18
    v_lshlrev_b32 v42, 16, v19
    v_and_b32 v43, 0xffff0000, v19
    v_add_f32 v44, v20, v21
    v_add_f32 v64, v22, v23
    v_add_f32 v44, v44, v24
    v_add_f32 v64, v64, v25
    v_add_f32 v44, v44, v26
    v_add_f32 v64, v64, v27
    v_add_f32 v44, v44, v28
    v_add_f32 v64, v64, v29
    v_add_f32 v44, v44, v30
    v_add_f32 v64, v64, v31
    v_add_f32 v44, v44, v32
    v_add_f32 v64, v64, v33
    v_add_f32 v44, v44, v34
    v_add_f32 v64, v64, v35
    v_add_f32 v44, v44, v36
    v_add_f32 v64, v64, v37
    v_add_f32 v44, v44, v38
    v_add_f32 v64, v64, v39
    v_add_f32 v44, v44, v40
    v_add_f32 v64, v64, v41
    v_add_f32 v44, v44, v42
    v_add_f32 v64, v64, v43
    v_add_f32 v44, v44, v64
    s_nop 1
    v_add_f32_dpp v44, v44, v44 row_ror:8 row_mask:0xf bank_mask:0xf
    v_mov_b32 v64, v44
    s_nop 1
    v_permlane16_swap_b32 v44, v64
    v_add_f32 v44, v44, v64
    v_mov_b32 v64, v44
    s_nop 1
    v_permlane32_swap_b32 v44, v64
    v_add_f32 v44, v44, v64
    v_mul_f32 v65, 0x3baaaaab, v44
    v_sub_f32 v64, v20, v65
    v_mul_f32 v45, v64, v64
    v_sub_f32 v67, v21, v65
    v_fmac_f32 v45, v67, v67
    v_sub_f32 v66, v22, v65
    v_fmac_f32 v45, v66, v66
    v_sub_f32 v67, v23, v65
    v_fmac_f32 v45, v67, v67
    v_sub_f32 v66, v24, v65
    v_fmac_f32 v45, v66, v66
    v_sub_f32 v67, v25, v65
    v_fmac_f32 v45, v67, v67
    v_sub_f32 v66, v26, v65
    v_fmac_f32 v45, v66, v66
    v_sub_f32 v67, v27, v65
    v_fmac_f32 v45, v67, v67
    v_sub_f32 v66, v28, v65
    v_fmac_f32 v45, v66, v66
    v_sub_f32 v67, v29, v65
    v_fmac_f32 v45, v67, v67
    v_sub_f32 v66, v30, v65
    v_fmac_f32 v45, v66, v66
    v_sub_f32 v67, v31, v65
    v_fmac_f32 v45, v67, v67
    v_sub_f32 v66, v32, v65
    v_fmac_f32 v45, v66, v66
    v_sub_f32 v67, v33, v65
    v_fmac_f32 v45, v67, v67
    v_sub_f32 v66, v34, v65
    v_fmac_f32 v45, v66, v66
    v_sub_f32 v67, v35, v65
    v_fmac_f32 v45, v67, v67
    v_sub_f32 v66, v36, v65
    v_fmac_f32 v45, v66, v66
    v_sub_f32 v67, v37, v65
    v_fmac_f32 v45, v67, v67
    v_sub_f32 v66, v38, v65
    v_fmac_f32 v45, v66, v66
    v_sub_f32 v67, v39, v65
    v_fmac_f32 v45, v67, v67
    v_sub_f32 v66, v40, v65
    v_fmac_f32 v45, v66, v66
    v_sub_f32 v67, v41, v65
    v_fmac_f32 v45, v67, v67
    v_sub_f32 v66, v42, v65
    v_fmac_f32 v45, v66, v66
    v_sub_f32 v67, v43, v65
    v_fmac_f32 v45, v67, v67
    s_nop 1
    v_add_f32_dpp v45, v45, v45 row_ror:8 row_mask:0xf bank_mask:0xf
    v_mov_b32 v64, v45
    s_nop 1
    v_permlane16_swap_b32 v45, v64
    v_add_f32 v45, v45, v64
    v_mov_b32 v64, v45
    s_nop 1
    v_permlane32_swap_b32 v45, v64
    v_add_f32 v45, v45, v64
    v_and_b32 v64, 7, v1
    s_mul_i32 s46, s20, 64
    s_add_u32 s46, s46, 160896
    v_lshl_add_u32 v64, v64, 3, s46
    ds_write_b64 v64, v[44:45]
    s_waitcnt lgkmcnt(0)
L_w3_30:
    s_barrier
    global_load_dwordx2 v[6:7], v5, s[40:41] sc1
    s_cmp_eq_u32 s20, 3
    s_cbranch_scc1 L_w3_31
    v_and_b32 v64, 7, v1
    v_lshlrev_b32 v64, 3, v64
    v_add_u32 v64, 160896, v64
    ds_read_b64 v[44:45], v64 offset:0
    ds_read_b64 v[46:47], v64 offset:64
    ds_read_b64 v[48:49], v64 offset:128
    s_waitcnt lgkmcnt(1)
    v_add_f32 v64, v44, v46
    s_waitcnt lgkmcnt(0)
    v_add_f32 v64, v64, v48
    v_mul_f32 v64, 0x3ae38e39, v64
    v_add_f32 v65, v45, v47
    v_add_f32 v65, v65, v49
    v_mul_f32 v66, 0x3baaaaab, v44
    v_sub_f32 v66, v66, v64
    v_mul_f32 v66, v66, v66
    v_fmac_f32 v65, 0x43400000, v66
    v_mul_f32 v66, 0x3baaaaab, v46
    v_sub_f32 v66, v66, v64
    v_mul_f32 v66, v66, v66
    v_fmac_f32 v65, 0x43400000, v66
    v_mul_f32 v66, 0x3baaaaab, v48
    v_sub_f32 v66, v66, v64
    v_mul_f32 v66, v66, v66
    v_fmac_f32 v65, 0x43400000, v66
    v_mul_f32 v65, 0x3ae38e39, v65
    v_cvt_pk_bf16_f32 v65, v65, v65
    v_lshlrev_b32 v65, 16, v65
    v_add_f32 v65, 0x3727c5ac, v65
    v_cvt_pk_bf16_f32 v65, v65, v65
    v_lshlrev_b32 v65, 16, v65
    v_sqrt_f32 v65, v65
    s_nop 0
    v_cvt_pk_bf16_f32 v65, v65, v65
    v_lshlrev_b32 v65, 16, v65
    v_rcp_f32 v65, v65
    v_cvt_pk_bf16_f32 v64, v64, v64
    v_lshlrev_b32 v64, 16, v64
    v_sub_f32 v20, v20, v64
    v_sub_f32 v21, v21, v64
    v_cvt_pk_bf16_f32 v66, v20, v21
    v_lshlrev_b32 v20, 16, v66
    v_and_b32 v21, 0xffff0000, v66
    v_mul_f32 v20, v20, v65
    v_mul_f32 v21, v21, v65
    v_cvt_pk_bf16_f32 v52, v20, v21
    v_sub_f32 v22, v22, v64
    v_sub_f32 v23, v23, v64
    v_cvt_pk_bf16_f32 v66, v22, v23
    v_lshlrev_b32 v22, 16, v66
    v_and_b32 v23, 0xffff0000, v66
    v_mul_f32 v22, v22, v65
    v_mul_f32 v23, v23, v65
    v_cvt_pk_bf16_f32 v53, v22, v23
    v_sub_f32 v24, v24, v64
    v_sub_f32 v25, v25, v64
    v_cvt_pk_bf16_f32 v66, v24, v25
    v_lshlrev_b32 v24, 16, v66
    v_and_b32 v25, 0xffff0000, v66
    v_mul_f32 v24, v24, v65
    v_mul_f32 v25, v25, v65
    v_cvt_pk_bf16_f32 v54, v24, v25
    v_sub_f32 v26, v26, v64
    v_sub_f32 v27, v27, v64
    v_cvt_pk_bf16_f32 v66, v26, v27
    v_lshlrev_b32 v26, 16, v66
    v_and_b32 v27, 0xffff0000, v66
    v_mul_f32 v26, v26, v65
    v_mul_f32 v27, v27, v65
    v_cvt_pk_bf16_f32 v55, v26, v27
    v_sub_f32 v28, v28, v64
    v_sub_f32 v29, v29, v64
    v_cvt_pk_bf16_f32 v66, v28, v29
    v_lshlrev_b32 v28, 16, v66
    v_and_b32 v29, 0xffff0000, v66
    v_mul_f32 v28, v28, v65
    v_mul_f32 v29, v29, v65
    v_cvt_pk_bf16_f32 v56, v28, v29
    v_sub_f32 v30, v30, v64
    v_sub_f32 v31, v31, v64
    v_cvt_pk_bf16_f32 v66, v30, v31
    v_lshlrev_b32 v30, 16, v66
    v_and_b32 v31, 0xffff0000, v66
    v_mul_f32 v30, v30, v65
    v_mul_f32 v31, v31, v65
    v_cvt_pk_bf16_f32 v57, v30, v31
    v_sub_f32 v32, v32, v64
    v_sub_f32 v33, v33, v64
    v_cvt_pk_bf16_f32 v66, v32, v33
    v_lshlrev_b32 v32, 16, v66
    v_and_b32 v33, 0xffff0000, v66
    v_mul_f32 v32, v32, v65
    v_mul_f32 v33, v33, v65
    v_cvt_pk_bf16_f32 v58, v32, v33
    v_sub_f32 v34, v34, v64
    v_sub_f32 v35, v35, v64
    v_cvt_pk_bf16_f32 v66, v34, v35
    v_lshlrev_b32 v34, 16, v66
    v_and_b32 v35, 0xffff0000, v66
    v_mul_f32 v34, v34, v65
    v_mul_f32 v35, v35, v65
    v_cvt_pk_bf16_f32 v59, v34, v35
    v_sub_f32 v36, v36, v64
    v_sub_f32 v37, v37, v64
    v_cvt_pk_bf16_f32 v66, v36, v37
    v_lshlrev_b32 v36, 16, v66
    v_and_b32 v37, 0xffff0000, v66
    v_mul_f32 v36, v36, v65
    v_mul_f32 v37, v37, v65
    v_cvt_pk_bf16_f32 v60, v36, v37
    v_sub_f32 v38, v38, v64
    v_sub_f32 v39, v39, v64
    v_cvt_pk_bf16_f32 v66, v38, v39
    v_lshlrev_b32 v38, 16, v66
    v_and_b32 v39, 0xffff0000, v66
    v_mul_f32 v38, v38, v65
    v_mul_f32 v39, v39, v65
    v_cvt_pk_bf16_f32 v61, v38, v39
    v_sub_f32 v40, v40, v64
    v_sub_f32 v41, v41, v64
    v_cvt_pk_bf16_f32 v66, v40, v41
    v_lshlrev_b32 v40, 16, v66
    v_and_b32 v41, 0xffff0000, v66
    v_mul_f32 v40, v40, v65
    v_mul_f32 v41, v41, v65
    v_cvt_pk_bf16_f32 v62, v40, v41
    v_sub_f32 v42, v42, v64
    v_sub_f32 v43, v43, v64
    v_cvt_pk_bf16_f32 v66, v42, v43
    v_lshlrev_b32 v42, 16, v66
    v_and_b32 v43, 0xffff0000, v66
    v_mul_f32 v42, v42, v65
    v_mul_f32 v43, v43, v65
    v_cvt_pk_bf16_f32 v63, v42, v43
    s_mov_b32 s46, 20971520
    buffer_store_dwordx4 v[52:55], v4, s[4:7], s46 offen offset:0 sc1
    buffer_store_dwordx4 v[56:59], v4, s[4:7], s46 offen offset:2048 sc1
    s_add_u32 s46, s46, 4096
    buffer_store_dwordx4 v[60:63], v4, s[4:7], s46 offen offset:0 sc1
    s_lshl_b32 s0, s47, 2
    s_add_u32 s0, s0, s20
    s_lshl_b32 s0, s0, 3
    s_add_u32 s0, s0, 3932160
    s_mov_b32 s55, 0
    s_branch L_ln_32
L_w3_31:
    v_lshrrev_b32 v64, 4, v1
    v_bfe_u32 v66, v1, 2, 2
    v_lshl_add_u32 v64, v64, 3, v66
    v_mul_u32_u24 v64, 240, v64
    v_add_u32 v64, s56, v64
    v_and_b32 v66, 3, v1
    v_add_u32 v64, s47, v64
    v_and_b32 v67, 1, v66
    v_mul_u32_u24 v67, 160, v67
    v_lshrrev_b32 v65, 1, v66
    v_mul_u32_u24 v65, 80, v65
    v_add3_u32 v65, v65, v67, v64
    v_cmp_eq_u32 vcc, 3, v66
    s_nop 1
    v_cndmask_b32 v65, v65, v64, vcc
    v_lshl_add_u32 v64, v66, 3, v64
    s_waitcnt vmcnt(1)
    ds_read_b64_tr_b16 v[72:73], v64 offset:0
    ds_read_b64_tr_b16 v[74:75], v64 offset:960
    ds_read_b64_tr_b16 v[76:77], v64 offset:40
    ds_read_b64_tr_b16 v[78:79], v64 offset:1000
    ds_read_b64_tr_b16 v[80:81], v64 offset:80
    ds_read_b64_tr_b16 v[82:83], v64 offset:1040
    ds_read_b64_tr_b16 v[84:85], v64 offset:120
    ds_read_b64_tr_b16 v[86:87], v64 offset:1080
    ds_read_b64_tr_b16 v[88:89], v64 offset:160
    ds_read_b64_tr_b16 v[90:91], v64 offset:1120
    ds_read_b64_tr_b16 v[92:93], v64 offset:200
    ds_read_b64_tr_b16 v[94:95], v64 offset:1160
    ds_read_b64_tr_b16 v[96:97], v65 offset:32
    ds_read_b64_tr_b16 v[98:99], v65 offset:992
    v_and_b32 v66, 15, v1
    v_cmp_gt_u32 vcc, 12, v66
    s_waitcnt lgkmcnt(1)
    s_nop 0
    v_cndmask_b32 v96, 0, v96, vcc
    v_cndmask_b32 v97, 0, v97, vcc
    s_waitcnt lgkmcnt(0)
    v_cndmask_b32 v98, 0, v98, vcc
    v_cndmask_b32 v99, 0, v99, vcc
    s_add_u32 s51, s51, 0
    buffer_store_dwordx4 v[72:75], v2, s[4:7], s51 offen offset:0 sc1
    buffer_store_dwordx4 v[76:79], v2, s[4:7], s51 offen offset:1024 sc1
    buffer_store_dwordx4 v[80:83], v2, s[4:7], s51 offen offset:2048 sc1
    buffer_store_dwordx4 v[84:87], v2, s[4:7], s51 offen offset:3072 sc1
    s_add_u32 s51, s51, 4096
    buffer_store_dwordx4 v[88:91], v2, s[4:7], s51 offen offset:0 sc1
    buffer_store_dwordx4 v[92:95], v2, s[4:7], s51 offen offset:1024 sc1
    buffer_store_dwordx4 v[96:99], v2, s[4:7], s51 offen offset:2048 sc1
    s_cmp_eq_u32 s55, 0
    s_cbranch_scc1 L_ln_32
    s_cmp_eq_u32 s55, 2
    s_cbranch_scc1 L_fw_33
    v_lshrrev_b32 v64, 4, v1
    v_bfe_u32 v66, v1, 2, 2
    v_lshl_add_u32 v64, v64, 3, v66
    v_mul_u32_u24 v64, 240, v64
    v_add_u32 v64, s57, v64
    v_and_b32 v66, 3, v1
    v_add_u32 v64, s87, v64
    v_and_b32 v67, 1, v66
    v_mul_u32_u24 v67, 160, v67
    v_lshrrev_b32 v65, 1, v66
    v_mul_u32_u24 v65, 80, v65
    v_add3_u32 v65, v65, v67, v64
    v_cmp_eq_u32 vcc, 3, v66
    s_nop 1
    v_cndmask_b32 v65, v65, v64, vcc
    v_lshl_add_u32 v64, v66, 3, v64
    s_waitcnt vmcnt(8)
    ds_read_b64_tr_b16 v[100:101], v64 offset:0
    ds_read_b64_tr_b16 v[102:103], v64 offset:960
    ds_read_b64_tr_b16 v[104:105], v64 offset:40
    ds_read_b64_tr_b16 v[106:107], v64 offset:1000
    ds_read_b64_tr_b16 v[108:109], v64 offset:80
    ds_read_b64_tr_b16 v[110:111], v64 offset:1040
    ds_read_b64_tr_b16 v[112:113], v64 offset:120
    ds_read_b64_tr_b16 v[114:115], v64 offset:1080
    ds_read_b64_tr_b16 v[116:117], v64 offset:160
    ds_read_b64_tr_b16 v[118:119], v64 offset:1120
    ds_read_b64_tr_b16 v[120:121], v64 offset:200
    ds_read_b64_tr_b16 v[122:123], v64 offset:1160
    ds_read_b64_tr_b16 v[124:125], v65 offset:32
    ds_read_b64_tr_b16 v[126:127], v65 offset:992
    v_and_b32 v66, 15, v1
    v_cmp_gt_u32 vcc, 12, v66
    s_waitcnt lgkmcnt(1)
    s_nop 0
    v_cndmask_b32 v124, 0, v124, vcc
    v_cndmask_b32 v125, 0, v125, vcc
    s_waitcnt lgkmcnt(0)
    v_cndmask_b32 v126, 0, v126, vcc
    v_cndmask_b32 v127, 0, v127, vcc
    s_add_u32 s91, s91, 0
    buffer_store_dwordx4 v[100:103], v2, s[4:7], s91 offen offset:0 sc1
    buffer_store_dwordx4 v[104:107], v2, s[4:7], s91 offen offset:1024 sc1
    buffer_store_dwordx4 v[108:111], v2, s[4:7], s91 offen offset:2048 sc1
    buffer_store_dwordx4 v[112:115], v2, s[4:7], s91 offen offset:3072 sc1
    s_add_u32 s91, s91, 4096
    buffer_store_dwordx4 v[116:119], v2, s[4:7], s91 offen offset:0 sc1
    buffer_store_dwordx4 v[120:123], v2, s[4:7], s91 offen offset:1024 sc1
    buffer_store_dwordx4 v[124:127], v2, s[4:7], s91 offen offset:2048 sc1
    s_branch L_ln_32
L_fw_33:
    v_lshrrev_b32 v64, 4, v1
    v_bfe_u32 v66, v1, 2, 2
    v_lshl_add_u32 v64, v64, 3, v66
    v_mul_u32_u24 v64, 192, v64
    v_add_u32 v64, s57, v64
    v_and_b32 v66, 3, v1
    v_lshl_add_u32 v64, v66, 4, v64
    s_waitcnt vmcnt(8)
    ds_read_b64_tr_b16 v[100:101], v64 offset:0
    ds_read_b64_tr_b16 v[102:103], v64 offset:768
    ds_read_b64_tr_b16 v[104:105], v64 offset:8
    ds_read_b64_tr_b16 v[106:107], v64 offset:776
    ds_read_b64_tr_b16 v[108:109], v64 offset:64
    ds_read_b64_tr_b16 v[110:111], v64 offset:832
    ds_read_b64_tr_b16 v[112:113], v64 offset:72
    ds_read_b64_tr_b16 v[114:115], v64 offset:840
    ds_read_b64_tr_b16 v[116:117], v64 offset:128
    ds_read_b64_tr_b16 v[118:119], v64 offset:896
    ds_read_b64_tr_b16 v[120:121], v64 offset:136
    ds_read_b64_tr_b16 v[122:123], v64 offset:904
    s_add_u32 s91, s91, 2097152
    s_waitcnt lgkmcnt(10)
    buffer_store_dwordx4 v[100:103], v2, s[4:7], s91 offen offset:0 sc1
    s_waitcnt lgkmcnt(8)
    buffer_store_dwordx4 v[104:107], v2, s[4:7], s91 offen offset:1024 sc1
    s_waitcnt lgkmcnt(6)
    buffer_store_dwordx4 v[108:111], v2, s[4:7], s91 offen offset:2048 sc1
    s_waitcnt lgkmcnt(4)
    buffer_store_dwordx4 v[112:115], v2, s[4:7], s91 offen offset:3072 sc1
    s_add_u32 s91, s91, 4096
    s_waitcnt lgkmcnt(2)
    buffer_store_dwordx4 v[116:119], v2, s[4:7], s91 offen offset:0 sc1
    s_waitcnt lgkmcnt(0)
    buffer_store_dwordx4 v[120:123], v2, s[4:7], s91 offen offset:1024 sc1
L_ln_32:
    s_waitcnt vmcnt(0)
    v_cmp_ne_u64 vcc, 0, v[6:7]
    s_nop 0
    s_cmp_eq_u64 vcc, exec
    s_cbranch_scc0 L_pn_slow_27
L_pn_back_28:
    v_readfirstlane_b32 s98, v6
    v_readfirstlane_b32 s99, v7
    s_nop 0
    v_mov_b32 v6, s98
    v_mov_b32 v7, s99
    s_waitcnt vmcnt(0)
    s_mov_b64 exec, 1
    buffer_store_dwordx2 v[6:7], off, s[4:7], s0 sc1
    s_mov_b64 exec, -1
    s_cmp_eq_u32 s55, 0
    s_cbranch_scc1 L_norole_34
    s_mov_b64 exec, 1
    buffer_store_dwordx2 v[6:7], off, s[4:7], s1 sc1
    s_mov_b64 exec, -1
L_norole_34:
    s_lshr_b32 s44, s22, 4
    s_lshl_b32 s52, s21, 1
    s_add_u32 s44, s44, s52
    s_and_b32 s45, s22, 15
    s_mul_i32 s48, s20, 21
    s_lshr_b32 s48, s48, 1
    s_lshl_b32 s48, s48, 10
    s_mul_i32 s47, s45, 129024
    s_add_u32 s47, s47, s48
    s_add_u32 s47, s47, 0
    buffer_load_dwordx4 a[144:147], v229, s[16:19], 0 offen nt
    buffer_load_dwordx4 a[148:151], v230, s[16:19], 0 offen nt
    buffer_load_dwordx4 a[152:155], v231, s[16:19], 0 offen nt
    buffer_load_dwordx4 a[156:159], v232, s[16:19], 0 offen nt
    buffer_load_dwordx4 a[160:163], v233, s[16:19], 0 offen nt
    buffer_load_dwordx4 a[164:167], v234, s[16:19], 0 offen nt
    buffer_load_dwordx4 a[168:171], v235, s[16:19], 0 offen nt
    buffer_load_dwordx4 a[172:175], v236, s[16:19], 0 offen nt
    buffer_load_dwordx4 a[176:179], v237, s[16:19], 0 offen nt
    s_mul_i32 s55, s20, 9216
    s_add_u32 s55, s55, 110592
    v_add_u32 v64, s55, v2
    s_waitcnt vmcnt(8)
    ds_write_b128 v64, a[144:147] offset:0
    s_waitcnt vmcnt(7)
    ds_write_b128 v64, a[148:151] offset:1024
    s_waitcnt vmcnt(6)
    ds_write_b128 v64, a[152:155] offset:2048
    s_waitcnt vmcnt(5)
    ds_write_b128 v64, a[156:159] offset:3072
    s_waitcnt vmcnt(4)
    ds_write_b128 v64, a[160:163] offset:4096
    s_waitcnt vmcnt(3)
    ds_write_b128 v64, a[164:167] offset:5120
    s_waitcnt vmcnt(2)
    ds_write_b128 v64, a[168:171] offset:6144
    s_waitcnt vmcnt(1)
    ds_write_b128 v64, a[172:175] offset:7168
    s_waitcnt vmcnt(0)
    ds_write_b128 v64, a[176:179] offset:8192
    s_cmp_ge_u32 s3, 1152
    s_cbranch_scc1 L_ud_35
    s_mul_i32 s64, s3, 1821
    s_lshr_b32 s64, s64, 16
    s_mul_i32 s92, s64, 36
    s_sub_u32 s92, s3, s92
    s_and_b32 s93, s92, 1
    s_lshr_b32 s94, s92, 1
    s_mov_b32 s62, 0
    s_mov_b32 s63, 256
    s_mul_i32 s95, s64, 486
    s_add_u32 s95, s95, s92
    s_lshl_b32 s95, s95, 10
    s_add_u32 s69, s95, 4194304
    s_add_u32 s67, s69, 36864
    s_add_u32 s68, s69, 184320
    s_mov_b32 s70, 36864
    s_mov_b32 s71, 73728
    s_lshl_b32 s95, s64, 1
    s_add_u32 s95, s95, s93
    s_mul_i32 s95, s95, 18
    s_add_u32 s95, s95, s94
    s_mul_i32 s95, s95, 576
    s_add_u32 s65, s95, 2883584
    s_mov_b32 s66, s92
    s_branch L_udone_36
L_ud_35:
    s_sub_u32 s92, s3, 1152
    s_mul_i32 s64, s92, 3641
    s_lshr_b32 s64, s64, 16
    s_mul_i32 s93, s64, 18
    s_sub_u32 s92, s92, s93
    s_and_b32 s93, s64, 3
    s_and_b32 s94, s93, 1
    s_mov_b32 s65, 0
    s_lshl_b32 s62, s94, 5
    s_cmp_eq_u32 s94, 0
    s_cselect_b32 s63, 256, 0
    s_add_u32 s66, s92, 36
    s_mul_i32 s95, s64, 486
    s_add_u32 s95, s95, 324
    s_lshl_b32 s95, s95, 10
    s_add_u32 s95, s95, 4194304
    s_cmp_ge_u32 s92, 3
    s_cbranch_scc1 L_ub_37
    s_sub_u32 s96, s92, 0
    s_mov_b32 s70, 1024
    s_mov_b32 s71, 2048
    s_mul_i32 s97, s96, 5120
    s_add_u32 s97, s97, 0
    s_add_u32 s67, s97, s95
    s_mul_i32 s97, s96, 4096
    s_add_u32 s97, s97, 15360
    s_add_u32 s68, s97, s95
    s_mul_i32 s97, s96, 5120
    s_add_u32 s97, s97, 4096
    s_add_u32 s69, s97, s95
    s_branch L_udone_36
L_ub_37:
    s_cmp_ge_u32 s92, 9
    s_cbranch_scc1 L_uc_38
    s_sub_u32 s96, s92, 3
    s_mov_b32 s70, 1024
    s_mov_b32 s71, 2048
    s_mul_i32 s97, s96, 9216
    s_add_u32 s97, s97, 27648
    s_add_u32 s67, s97, s95
    s_mul_i32 s97, s96, 9216
    s_add_u32 s97, s97, 31744
    s_add_u32 s68, s97, s95
    s_mul_i32 s97, s96, 9216
    s_add_u32 s97, s97, 35840
    s_add_u32 s69, s97, s95
    s_branch L_udone_36
L_uc_38:
    s_sub_u32 s96, s92, 9
    s_mov_b32 s70, 1024
    s_mov_b32 s71, 18432
    s_mul_i32 s97, s96, 2048
    s_add_u32 s97, s97, 82944
    s_add_u32 s67, s97, s95
    s_mul_i32 s97, s96, 2048
    s_add_u32 s97, s97, 119808
    s_add_u32 s68, s97, s95
    s_mul_i32 s97, s96, 1024
    s_add_u32 s97, s97, 156672
    s_add_u32 s69, s97, s95
L_udone_36:
    s_lshl_b32 s95, s64, 6
    s_add_u32 s95, s95, s66
    s_lshl_b32 s95, s95, 3
    s_add_u32 s66, s95, 4071424
    v_lshrrev_b32 v64, 4, v1
    v_bfe_u32 v66, v1, 2, 2
    v_lshl_add_u32 v64, v64, 3, v66
    v_mul_u32_u24 v64, 288, v64
    v_add_u32 v64, s55, v64
    v_and_b32 v66, 3, v1
    v_lshl_add_u32 v65, v66, 3, v64
    v_add_u32 v65, s63, v65
    v_lshl_add_u32 v64, v66, 4, v64
    v_add_u32 v64, s62, v64
    ds_read_b64_tr_b16 v[180:181], v64 offset:0
    ds_read_b64_tr_b16 v[182:183], v64 offset:1152
    ds_read_b64_tr_b16 v[184:185], v64 offset:8
    ds_read_b64_tr_b16 v[186:187], v64 offset:1160
    ds_read_b64_tr_b16 v[188:189], v64 offset:64
    ds_read_b64_tr_b16 v[190:191], v64 offset:1216
    ds_read_b64_tr_b16 v[192:193], v64 offset:72
    ds_read_b64_tr_b16 v[194:195], v64 offset:1224
    ds_read_b64_tr_b16 v[196:197], v64 offset:128
    ds_read_b64_tr_b16 v[198:199], v64 offset:1280
    ds_read_b64_tr_b16 v[200:201], v64 offset:136
    ds_read_b64_tr_b16 v[202:203], v64 offset:1288
    ds_read_b64_tr_b16 v[204:205], v64 offset:192
    ds_read_b64_tr_b16 v[206:207], v64 offset:1344
    ds_read_b64_tr_b16 v[208:209], v64 offset:200
    ds_read_b64_tr_b16 v[210:211], v64 offset:1352
    ds_read_b64_tr_b16 v[212:213], v65 offset:0
    ds_read_b64_tr_b16 v[214:215], v65 offset:1152
    s_cmp_eq_u32 s65, 0
    s_cbranch_scc1 L_nocs_39
    v_mov_b32 v68, 0x3f803f80
    v_mov_b32 v69, 0x3f803f80
    v_mov_b32 v70, 0x3f803f80
    v_mov_b32 v71, 0x3f803f80
    s_waitcnt lgkmcnt(15)
    s_nop 0
    v_mfma_f32_16x16x32_bf16 v[72:75], v[180:183], v[68:71], 0
    s_waitcnt lgkmcnt(14)
    v_mfma_f32_16x16x32_bf16 v[76:79], v[184:187], v[68:71], 0
    s_waitcnt lgkmcnt(12)
    v_mfma_f32_16x16x32_bf16 v[80:83], v[188:191], v[68:71], 0
    s_waitcnt lgkmcnt(10)
    v_mfma_f32_16x16x32_bf16 v[84:87], v[192:195], v[68:71], 0
    s_waitcnt lgkmcnt(8)
    v_mfma_f32_16x16x32_bf16 v[88:91], v[196:199], v[68:71], 0
    s_waitcnt lgkmcnt(6)
    v_mfma_f32_16x16x32_bf16 v[92:95], v[200:203], v[68:71], 0
    s_waitcnt lgkmcnt(4)
    v_mfma_f32_16x16x32_bf16 v[96:99], v[204:207], v[68:71], 0
    s_waitcnt lgkmcnt(2)
    v_mfma_f32_16x16x32_bf16 v[100:103], v[208:211], v[68:71], 0
    s_waitcnt lgkmcnt(0)
    v_mfma_f32_16x16x32_bf16 v[104:107], v[212:215], v[68:71], 0
    v_and_b32 v66, 15, v1
    v_add_u32 v67, 1, v66
    v_cmp_gt_u32 vcc, 8, v66
    v_and_b32 v64, 48, v1
    s_nop 0
    v_cndmask_b32 v67, 0, v67, vcc
    v_lshlrev_b32 v67, 6, v67
    v_add_u32 v67, v67, v64
    v_cmp_eq_u32 vcc, 1, v66
    s_nop 1
    v_cndmask_b32 v72, v72, v76, vcc
    v_cndmask_b32 v73, v73, v77, vcc
    v_cndmask_b32 v74, v74, v78, vcc
    v_cndmask_b32 v75, v75, v79, vcc
    v_cmp_eq_u32 vcc, 2, v66
    s_nop 1
    v_cndmask_b32 v72, v72, v80, vcc
    v_cndmask_b32 v73, v73, v81, vcc
    v_cndmask_b32 v74, v74, v82, vcc
    v_cndmask_b32 v75, v75, v83, vcc
    v_cmp_eq_u32 vcc, 3, v66
    s_nop 1
    v_cndmask_b32 v72, v72, v84, vcc
    v_cndmask_b32 v73, v73, v85, vcc
    v_cndmask_b32 v74, v74, v86, vcc
    v_cndmask_b32 v75, v75, v87, vcc
    v_cmp_eq_u32 vcc, 4, v66
    s_nop 1
    v_cndmask_b32 v72, v72, v88, vcc
    v_cndmask_b32 v73, v73, v89, vcc
    v_cndmask_b32 v74, v74, v90, vcc
    v_cndmask_b32 v75, v75, v91, vcc
    v_cmp_eq_u32 vcc, 5, v66
    s_nop 1
    v_cndmask_b32 v72, v72, v92, vcc
    v_cndmask_b32 v73, v73, v93, vcc
    v_cndmask_b32 v74, v74, v94, vcc
    v_cndmask_b32 v75, v75, v95, vcc
    v_cmp_eq_u32 vcc, 6, v66
    s_nop 1
    v_cndmask_b32 v72, v72, v96, vcc
    v_cndmask_b32 v73, v73, v97, vcc
    v_cndmask_b32 v74, v74, v98, vcc
    v_cndmask_b32 v75, v75, v99, vcc
    v_cmp_eq_u32 vcc, 7, v66
    s_nop 1
    v_cndmask_b32 v72, v72, v100, vcc
    v_cndmask_b32 v73, v73, v101, vcc
    v_cndmask_b32 v74, v74, v102, vcc
    v_cndmask_b32 v75, v75, v103, vcc
    v_cmp_eq_u32 vcc, 8, v66
    s_nop 1
    v_cndmask_b32 v72, v72, v104, vcc
    v_cndmask_b32 v73, v73, v105, vcc
    v_cndmask_b32 v74, v74, v106, vcc
    v_cndmask_b32 v75, v75, v107, vcc
    s_mov_b32 exec_lo, 0x01ff01ff
    s_mov_b32 exec_hi, 0x01ff01ff
    buffer_store_dwordx4 v[72:75], v67, s[4:7], s65 offen sc1
    s_mov_b64 exec, -1
L_nocs_39:
    s_mov_b32 s0, s66
    s_lshl_b32 s46, s44, 3
    s_max_u32 s52, s46, 1
    s_sub_u32 s52, s52, 1
    s_mul_i32 s49, s52, 18432
    s_mul_i32 s50, s20, 9
    s_lshr_b32 s50, s50, 1
    s_lshl_b32 s50, s50, 10
    s_add_u32 s49, s49, s50
    s_add_u32 s49, s49, 20971520
    s_add_u32 s50, s50, 0
    s_lshl_b32 s54, s52, 6
    s_lshl_b32 s52, s20, 1
    s_add_u32 s46, s46, s52
    s_mul_i32 s51, s46, 18432
    s_add_u32 s51, s51, 20971520
    s_lshl_b32 s55, s46, 6
    v_and_b32 v6, 3, v1
    v_min_u32 v6, 2, v6
    v_and_b32 v7, 12, v1
    v_add_lshl_u32 v8, v6, v7, 3
    v_add_u32 v8, s55, v8
    v_and_b32 v7, 4, v1
    v_add_lshl_u32 v9, v6, v7, 3
    v_add_u32 v9, s54, v9
    v_and_b32 v7, 16, v1
    v_cmp_eq_u32 vcc, 0, v7
    s_nop 1
    v_cndmask_b32 v8, v9, v8, vcc
    v_subrev_u32 v7, 32, v1
    v_min_u32 v7, 17, v7
    s_lshl_b32 s52, s45, 8
    s_add_u32 s52, s52, 131072
    v_lshl_add_u32 v7, v7, 3, s52
    v_cmp_gt_u32 vcc, 32, v1
    s_nop 1
    v_cndmask_b32 v8, v7, v8, vcc
    s_mov_b32 s52, 3932160
    s_min_u32 s56, s20, 2
    s_add_u32 s57, s56, 2
    s_add_u32 s56, s56, 4
    s_cmp_ge_u32 s20, 2
    s_cselect_b32 s57, 6, s57
    s_lshl_b32 s57, s57, 10
    s_lshl_b32 s56, s56, 10
    v_add_u32 v3, 18432, v2
    v_add_u32 v4, s57, v3
    v_add_u32 v5, s56, v3
    v_add_u32 v10, 0, v2
    v_mov_b32 v11, v8
    s_mov_b32 s23, s52
    buffer_load_dwordx2 v[12:13], v11, s[4:7], s23 offen sc1
    v_and_b32 v6, 15, v1
    v_lshrrev_b32 v7, 4, v1
    v_lshlrev_b32 v7, 2, v7
    v_sub_u32 v6, v6, v7
    v_mov_b32 v8, 0xf149f2ca
    s_or_b32 s52, s44, s20
    s_cmp_eq_u32 s52, 0
    s_cselect_b64 s[56:57], -1, 0
    v_subrev_u32 v7, 0, v6
    v_and_b32 v9, 0xfffffff1, v7
    v_cmp_eq_u32 vcc, 0, v9
    v_add_u32 v7, 16, v7
    v_and_b32 v9, 0xfffffff1, v7
    v_cndmask_b32_e64 v168, v8, 0, vcc
    v_cmp_eq_u32 vcc, 0, v9
    s_nop 1
    v_cndmask_b32_e64 v172, v8, 0, vcc
    v_cndmask_b32_e64 v176, v172, v8, s[56:57]
    v_subrev_u32 v7, 1, v6
    v_and_b32 v9, 0xfffffff1, v7
    v_cmp_eq_u32 vcc, 0, v9
    v_add_u32 v7, 16, v7
    v_and_b32 v9, 0xfffffff1, v7
    v_cndmask_b32_e64 v169, v8, 0, vcc
    v_cmp_eq_u32 vcc, 0, v9
    s_nop 1
    v_cndmask_b32_e64 v173, v8, 0, vcc
    v_cndmask_b32_e64 v177, v173, v8, s[56:57]
    v_subrev_u32 v7, 2, v6
    v_and_b32 v9, 0xfffffff1, v7
    v_cmp_eq_u32 vcc, 0, v9
    v_add_u32 v7, 16, v7
    v_and_b32 v9, 0xfffffff1, v7
    v_cndmask_b32_e64 v170, v8, 0, vcc
    v_cmp_eq_u32 vcc, 0, v9
    s_nop 1
    v_cndmask_b32_e64 v174, v8, 0, vcc
    v_cndmask_b32_e64 v178, v174, v8, s[56:57]
    v_subrev_u32 v7, 3, v6
    v_and_b32 v9, 0xfffffff1, v7
    v_cmp_eq_u32 vcc, 0, v9
    v_add_u32 v7, 16, v7
    v_and_b32 v9, 0xfffffff1, v7
    v_cndmask_b32_e64 v171, v8, 0, vcc
    v_cmp_eq_u32 vcc, 0, v9
    s_nop 1
    v_cndmask_b32_e64 v175, v8, 0, vcc
    v_cndmask_b32_e64 v179, v175, v8, s[56:57]
    s_mul_i32 s53, s45, 2304
    s_add_u32 s53, s53, s51
    s_waitcnt vmcnt(0)
    v_cmp_eq_u64 vcc, s[98:99], v[12:13]
    s_nop 0
    s_cmp_eq_u64 vcc, exec
    s_cbranch_scc0 L_px_slow_43
L_px_back_44:
    s_barrier
    s_add_u32 m0, s48, 18432
    s_add_u32 s53, s47, 0
    buffer_load_dwordx4 v2, s[4:7], s53 offen offset:0 lds
    buffer_load_dwordx4 v2, s[4:7], s53 offen offset:1024 lds
    buffer_load_dwordx4 v2, s[4:7], s53 offen offset:2048 lds
    buffer_load_dwordx4 v2, s[4:7], s53 offen offset:3072 lds
    s_add_u32 m0, s48, 22528
    s_add_u32 s53, s47, 4096
    buffer_load_dwordx4 v2, s[4:7], s53 offen offset:0 lds
    buffer_load_dwordx4 v2, s[4:7], s53 offen offset:1024 lds
    buffer_load_dwordx4 v2, s[4:7], s53 offen offset:2048 lds
    buffer_load_dwordx4 v2, s[4:7], s53 offen offset:3072 lds
    s_add_u32 m0, s48, 26624
    s_add_u32 s53, s47, 8192
    buffer_load_dwordx4 v2, s[4:7], s53 offen offset:0 lds
    buffer_load_dwordx4 v2, s[4:7], s53 offen offset:1024 lds
    buffer_load_dwordx4 v2, s[4:7], s53 offen offset:2048 lds
    s_add_u32 s54, s51, 0
    buffer_load_dwordx4 a[0:3], v2, s[4:7], s54 offen offset:0 sc1
    s_add_u32 s55, s51, 18432
    buffer_load_dwordx4 a[72:75], v2, s[4:7], s55 offen offset:0 sc1
    buffer_load_dwordx4 a[4:7], v2, s[4:7], s54 offen offset:1024 sc1
    buffer_load_dwordx4 a[76:79], v2, s[4:7], s55 offen offset:1024 sc1
    buffer_load_dwordx4 a[8:11], v2, s[4:7], s54 offen offset:2048 sc1
    buffer_load_dwordx4 a[80:83], v2, s[4:7], s55 offen offset:2048 sc1
    buffer_load_dwordx4 a[12:15], v2, s[4:7], s54 offen offset:3072 sc1
    buffer_load_dwordx4 a[84:87], v2, s[4:7], s55 offen offset:3072 sc1
    s_add_u32 s54, s51, 4096
    buffer_load_dwordx4 a[16:19], v2, s[4:7], s54 offen offset:0 sc1
    s_add_u32 s55, s51, 22528
    buffer_load_dwordx4 a[88:91], v2, s[4:7], s55 offen offset:0 sc1
    buffer_load_dwordx4 a[20:23], v2, s[4:7], s54 offen offset:1024 sc1
    buffer_load_dwordx4 a[92:95], v2, s[4:7], s55 offen offset:1024 sc1
    s_add_u32 m0, s48, 61440
    s_add_u32 s53, s47, 43008
    buffer_load_dwordx4 v2, s[4:7], s53 offen offset:0 lds
    buffer_load_dwordx4 v2, s[4:7], s53 offen offset:1024 lds
    buffer_load_dwordx4 v2, s[4:7], s53 offen offset:2048 lds
    buffer_load_dwordx4 v2, s[4:7], s53 offen offset:3072 lds
    s_add_u32 m0, s48, 65536
    s_add_u32 s53, s47, 47104
    buffer_load_dwordx4 v2, s[4:7], s53 offen offset:0 lds
    buffer_load_dwordx4 v2, s[4:7], s53 offen offset:1024 lds
    buffer_load_dwordx4 v2, s[4:7], s53 offen offset:2048 lds
    buffer_load_dwordx4 v2, s[4:7], s53 offen offset:3072 lds
    s_add_u32 m0, s48, 69632
    s_add_u32 s53, s47, 51200
    buffer_load_dwordx4 v2, s[4:7], s53 offen offset:0 lds
    buffer_load_dwordx4 v2, s[4:7], s53 offen offset:1024 lds
    buffer_load_dwordx4 v2, s[4:7], s53 offen offset:2048 lds
    s_waitcnt vmcnt(23)
    s_barrier
    ds_read_b128 v[88:91], v3 offset:0
    ds_read_b128 v[92:95], v3 offset:1024
    ds_read_b128 v[96:99], v3 offset:2048
    ds_read_b128 v[100:103], v3 offset:3072
    ds_read_b128 v[112:115], v3 offset:6144
    ds_read_b128 v[104:107], v3 offset:4096
    ds_read_b128 v[108:111], v3 offset:5120
    s_waitcnt vmcnt(22) lgkmcnt(6)
    s_add_u32 m0, s50, 0
    s_add_u32 s53, s49, 0
    v_mfma_f32_16x16x32_bf16 v[16:19], v[88:91], a[0:3], 0
    buffer_load_dwordx4 v2, s[4:7], s53 offen offset:0 sc1 lds
    s_waitcnt vmcnt(22)
    v_mfma_f32_16x16x32_bf16 v[48:51], v[88:91], a[72:75], 0
    s_waitcnt lgkmcnt(5)
    ds_read_b128 v[116:119], v3 offset:7168
    ds_read_b128 v[120:123], v3 offset:8192
    v_mfma_f32_16x16x32_bf16 v[20:23], v[92:95], a[0:3], 0
    v_mfma_f32_16x16x32_bf16 v[52:55], v[92:95], a[72:75], 0
    s_waitcnt lgkmcnt(6)
    ds_read_b128 v[124:127], v3 offset:9216
    v_mfma_f32_16x16x32_bf16 v[24:27], v[96:99], a[0:3], 0
    buffer_load_dwordx4 v2, s[4:7], s53 offen offset:1024 sc1 lds
    v_mfma_f32_16x16x32_bf16 v[56:59], v[96:99], a[72:75], 0
    s_waitcnt lgkmcnt(6)
    ds_read_b128 v[128:131], v3 offset:10240
    v_mfma_f32_16x16x32_bf16 v[28:31], v[100:103], a[0:3], 0
    v_mfma_f32_16x16x32_bf16 v[60:63], v[100:103], a[72:75], 0
    s_waitcnt lgkmcnt(6)
    ds_read_b128 v[140:143], v3 offset:13312
    v_mfma_f32_16x16x32_bf16 v[32:35], v[112:115], a[0:3], 0
    buffer_load_dwordx4 v2, s[4:7], s53 offen offset:2048 sc1 lds
    v_mfma_f32_16x16x32_bf16 v[64:67], v[112:115], a[72:75], 0
    ds_read_b128 v[132:135], v3 offset:11264
    v_mfma_f32_16x16x32_bf16 v[44:47], a[0:3], v[112:115], 0
    v_mfma_f32_16x16x32_bf16 v[76:79], a[72:75], v[112:115], 0
    s_waitcnt lgkmcnt(7)
    ds_read_b128 v[136:139], v3 offset:12288
    v_mfma_f32_16x16x32_bf16 v[36:39], a[0:3], v[104:107], 0
    buffer_load_dwordx4 v2, s[4:7], s53 offen offset:3072 sc1 lds
    v_mfma_f32_16x16x32_bf16 v[68:71], a[72:75], v[104:107], 0
    s_waitcnt lgkmcnt(7)
    s_add_u32 m0, s50, 4096
    s_add_u32 s53, s49, 4096
    v_mfma_f32_16x16x32_bf16 v[40:43], a[0:3], v[108:111], 0
    v_mfma_f32_16x16x32_bf16 v[72:75], a[72:75], v[108:111], 0
    s_waitcnt vmcnt(24) lgkmcnt(6)
    v_mfma_f32_16x16x32_bf16 v[16:19], v[116:119], a[4:7], v[16:19]
    buffer_load_dwordx4 v2, s[4:7], s53 offen offset:0 sc1 lds
    s_waitcnt vmcnt(24)
    v_mfma_f32_16x16x32_bf16 v[48:51], v[116:119], a[76:79], v[48:51]
    s_waitcnt lgkmcnt(5)
    ds_read_b128 v[88:91], v3 offset:14336
    ds_read_b128 v[92:95], v3 offset:15360
    v_mfma_f32_16x16x32_bf16 v[20:23], v[120:123], a[4:7], v[20:23]
    v_mfma_f32_16x16x32_bf16 v[52:55], v[120:123], a[76:79], v[52:55]
    s_waitcnt lgkmcnt(6)
    ds_read_b128 v[96:99], v3 offset:16384
    v_mfma_f32_16x16x32_bf16 v[24:27], v[124:127], a[4:7], v[24:27]
    buffer_load_dwordx4 a[24:27], v2, s[4:7], s54 offen offset:2048 sc1
    v_mfma_f32_16x16x32_bf16 v[56:59], v[124:127], a[76:79], v[56:59]
    s_waitcnt lgkmcnt(6)
    ds_read_b128 v[100:103], v3 offset:17408
    v_mfma_f32_16x16x32_bf16 v[28:31], v[128:131], a[4:7], v[28:31]
    v_mfma_f32_16x16x32_bf16 v[60:63], v[128:131], a[76:79], v[60:63]
    s_waitcnt lgkmcnt(6)
    ds_read_b128 v[112:115], v3 offset:20480
    v_mfma_f32_16x16x32_bf16 v[32:35], v[140:143], a[4:7], v[32:35]
    buffer_load_dwordx4 a[96:99], v2, s[4:7], s55 offen offset:2048 sc1
    v_mfma_f32_16x16x32_bf16 v[64:67], v[140:143], a[76:79], v[64:67]
    ds_read_b128 v[104:107], v3 offset:18432
    v_mfma_f32_16x16x32_bf16 v[44:47], a[4:7], v[140:143], v[44:47]
    v_mfma_f32_16x16x32_bf16 v[76:79], a[76:79], v[140:143], v[76:79]
    s_waitcnt lgkmcnt(7)
    ds_read_b128 v[108:111], v3 offset:19456
    v_mfma_f32_16x16x32_bf16 v[36:39], a[4:7], v[132:135], v[36:39]
    buffer_load_dwordx4 a[28:31], v2, s[4:7], s54 offen offset:3072 sc1
    v_mfma_f32_16x16x32_bf16 v[68:71], a[76:79], v[132:135], v[68:71]
    s_waitcnt lgkmcnt(7)
    v_mfma_f32_16x16x32_bf16 v[40:43], a[4:7], v[136:139], v[40:43]
    v_mfma_f32_16x16x32_bf16 v[72:75], a[76:79], v[136:139], v[72:75]
    s_waitcnt vmcnt(26) lgkmcnt(6)
    v_mfma_f32_16x16x32_bf16 v[16:19], v[88:91], a[8:11], v[16:19]
    buffer_load_dwordx4 a[100:103], v2, s[4:7], s55 offen offset:3072 sc1
    s_waitcnt vmcnt(26)
    v_mfma_f32_16x16x32_bf16 v[48:51], v[88:91], a[80:83], v[48:51]
    s_waitcnt lgkmcnt(5)
    s_add_u32 s54, s51, 8192
    ds_read_b128 v[116:119], v3 offset:21504
    v_mfma_f32_16x16x32_bf16 v[20:23], v[92:95], a[8:11], v[20:23]
    ds_read_b128 v[120:123], v3 offset:22528
    v_mfma_f32_16x16x32_bf16 v[52:55], v[92:95], a[80:83], v[52:55]
    s_waitcnt lgkmcnt(6)
    ds_read_b128 v[124:127], v3 offset:23552
    v_mfma_f32_16x16x32_bf16 v[24:27], v[96:99], a[8:11], v[24:27]
    buffer_load_dwordx4 a[32:35], v2, s[4:7], s54 offen offset:0 sc1
    v_mfma_f32_16x16x32_bf16 v[56:59], v[96:99], a[80:83], v[56:59]
    s_waitcnt lgkmcnt(6)
    s_add_u32 s55, s51, 26624
    ds_read_b128 v[128:131], v3 offset:24576
    v_mfma_f32_16x16x32_bf16 v[28:31], v[100:103], a[8:11], v[28:31]
    v_mfma_f32_16x16x32_bf16 v[60:63], v[100:103], a[80:83], v[60:63]
    s_waitcnt lgkmcnt(6)
    ds_read_b128 v[140:143], v3 offset:27648
    v_mfma_f32_16x16x32_bf16 v[32:35], v[112:115], a[8:11], v[32:35]
    buffer_store_dwordx4 v[180:183], v2, s[4:7], s67 offen sc1
    v_mfma_f32_16x16x32_bf16 v[64:67], v[112:115], a[80:83], v[64:67]
    ds_read_b128 v[132:135], v3 offset:25600
    v_mfma_f32_16x16x32_bf16 v[44:47], a[8:11], v[112:115], v[44:47]
    v_mfma_f32_16x16x32_bf16 v[76:79], a[80:83], v[112:115], v[76:79]
    s_waitcnt lgkmcnt(7)
    ds_read_b128 v[136:139], v3 offset:26624
    v_mfma_f32_16x16x32_bf16 v[36:39], a[8:11], v[104:107], v[36:39]
    buffer_load_dwordx4 a[104:107], v2, s[4:7], s55 offen offset:0 sc1
    v_mfma_f32_16x16x32_bf16 v[68:71], a[80:83], v[104:107], v[68:71]
    s_waitcnt lgkmcnt(7)
    v_mfma_f32_16x16x32_bf16 v[40:43], a[8:11], v[108:111], v[40:43]
    v_mfma_f32_16x16x32_bf16 v[72:75], a[80:83], v[108:111], v[72:75]
    s_waitcnt vmcnt(28) lgkmcnt(6)
    v_mfma_f32_16x16x32_bf16 v[16:19], v[116:119], a[12:15], v[16:19]
    buffer_load_dwordx4 a[36:39], v2, s[4:7], s54 offen offset:1024 sc1
    s_waitcnt vmcnt(28)
    v_mfma_f32_16x16x32_bf16 v[48:51], v[116:119], a[84:87], v[48:51]
    s_waitcnt lgkmcnt(5)
    ds_read_b128 v[88:91], v3 offset:28672
    ds_read_b128 v[92:95], v3 offset:29696
    v_mfma_f32_16x16x32_bf16 v[20:23], v[120:123], a[12:15], v[20:23]
    v_mfma_f32_16x16x32_bf16 v[52:55], v[120:123], a[84:87], v[52:55]
    s_waitcnt lgkmcnt(6)
    ds_read_b128 v[96:99], v3 offset:30720
    v_mfma_f32_16x16x32_bf16 v[24:27], v[124:127], a[12:15], v[24:27]
    buffer_load_dwordx4 a[108:111], v2, s[4:7], s55 offen offset:1024 sc1
    v_mfma_f32_16x16x32_bf16 v[56:59], v[124:127], a[84:87], v[56:59]
    s_waitcnt lgkmcnt(6)
    ds_read_b128 v[100:103], v3 offset:31744
    v_mfma_f32_16x16x32_bf16 v[28:31], v[128:131], a[12:15], v[28:31]
    v_mfma_f32_16x16x32_bf16 v[60:63], v[128:131], a[84:87], v[60:63]
    s_waitcnt lgkmcnt(6)
    ds_read_b128 v[112:115], v3 offset:34816
    v_mfma_f32_16x16x32_bf16 v[32:35], v[140:143], a[12:15], v[32:35]
    buffer_load_dwordx4 a[40:43], v2, s[4:7], s54 offen offset:2048 sc1
    v_mfma_f32_16x16x32_bf16 v[64:67], v[140:143], a[84:87], v[64:67]
    ds_read_b128 v[104:107], v3 offset:32768
    v_mfma_f32_16x16x32_bf16 v[44:47], a[12:15], v[140:143], v[44:47]
    v_mfma_f32_16x16x32_bf16 v[76:79], a[84:87], v[140:143], v[76:79]
    s_waitcnt lgkmcnt(7)
    ds_read_b128 v[108:111], v3 offset:33792
    v_mfma_f32_16x16x32_bf16 v[36:39], a[12:15], v[132:135], v[36:39]
    buffer_load_dwordx4 a[112:115], v2, s[4:7], s55 offen offset:2048 sc1
    v_mfma_f32_16x16x32_bf16 v[68:71], a[84:87], v[132:135], v[68:71]
    s_waitcnt lgkmcnt(7)
    v_mfma_f32_16x16x32_bf16 v[40:43], a[12:15], v[136:139], v[40:43]
    v_mfma_f32_16x16x32_bf16 v[72:75], a[84:87], v[136:139], v[72:75]
    s_waitcnt vmcnt(30) lgkmcnt(6)
    s_add_u32 s92, s67, s70
    v_mfma_f32_16x16x32_bf16 v[16:19], v[88:91], a[16:19], v[16:19]
    buffer_store_dwordx4 v[184:187], v2, s[4:7], s92 offen sc1
    s_waitcnt vmcnt(30)
    v_mfma_f32_16x16x32_bf16 v[48:51], v[88:91], a[88:91], v[48:51]
    s_waitcnt lgkmcnt(5)
    ds_read_b128 v[116:119], v3 offset:35840
    ds_read_b128 v[120:123], v3 offset:36864
    v_mfma_f32_16x16x32_bf16 v[20:23], v[92:95], a[16:19], v[20:23]
    v_mfma_f32_16x16x32_bf16 v[52:55], v[92:95], a[88:91], v[52:55]
    s_waitcnt lgkmcnt(6)
    ds_read_b128 v[124:127], v3 offset:37888
    v_mfma_f32_16x16x32_bf16 v[24:27], v[96:99], a[16:19], v[24:27]
    buffer_load_dwordx4 a[44:47], v2, s[4:7], s54 offen offset:3072 sc1
    v_mfma_f32_16x16x32_bf16 v[56:59], v[96:99], a[88:91], v[56:59]
    s_waitcnt lgkmcnt(6)
    ds_read_b128 v[128:131], v3 offset:38912
    v_mfma_f32_16x16x32_bf16 v[28:31], v[100:103], a[16:19], v[28:31]
    v_mfma_f32_16x16x32_bf16 v[60:63], v[100:103], a[88:91], v[60:63]
    s_waitcnt lgkmcnt(6)
    ds_read_b128 v[140:143], v3 offset:41984
    v_mfma_f32_16x16x32_bf16 v[32:35], v[112:115], a[16:19], v[32:35]
    buffer_load_dwordx4 a[116:119], v2, s[4:7], s55 offen offset:3072 sc1
    v_mfma_f32_16x16x32_bf16 v[64:67], v[112:115], a[88:91], v[64:67]
    s_add_u32 m0, s48, 104448
    s_add_u32 s53, s47, 86016
    ds_read_b128 v[132:135], v3 offset:39936
    v_mfma_f32_16x16x32_bf16 v[44:47], a[16:19], v[112:115], v[44:47]
    v_mfma_f32_16x16x32_bf16 v[76:79], a[88:91], v[112:115], v[76:79]
    s_waitcnt lgkmcnt(7)
    ds_read_b128 v[136:139], v3 offset:40960
    v_mfma_f32_16x16x32_bf16 v[36:39], a[16:19], v[104:107], v[36:39]
    buffer_load_dwordx4 v2, s[4:7], s53 offen offset:0 lds
    v_mfma_f32_16x16x32_bf16 v[68:71], a[88:91], v[104:107], v[68:71]
    s_waitcnt lgkmcnt(7)
    v_mfma_f32_16x16x32_bf16 v[40:43], a[16:19], v[108:111], v[40:43]
    v_mfma_f32_16x16x32_bf16 v[72:75], a[88:91], v[108:111], v[72:75]
    s_waitcnt vmcnt(32) lgkmcnt(6)
    v_mfma_f32_16x16x32_bf16 v[16:19], v[116:119], a[20:23], v[16:19]
    s_waitcnt vmcnt(31)
    s_waitcnt vmcnt(20)
    s_waitcnt vmcnt(15)
    s_barrier
    v_mfma_f32_16x16x32_bf16 v[48:51], v[116:119], a[92:95], v[48:51]
    s_waitcnt lgkmcnt(5)
    ds_read_b128 v[88:91], v3 offset:43008
    ds_read_b128 v[92:95], v3 offset:44032
    v_mfma_f32_16x16x32_bf16 v[20:23], v[120:123], a[20:23], v[20:23]
    buffer_load_dwordx4 v2, s[4:7], s53 offen offset:1024 lds
    v_mfma_f32_16x16x32_bf16 v[52:55], v[120:123], a[92:95], v[52:55]
    s_waitcnt lgkmcnt(6)
    ds_read_b128 v[96:99], v3 offset:45056
    ds_read_b128 v[144:147], v10 offset:0
    v_mfma_f32_16x16x32_bf16 v[24:27], v[124:127], a[20:23], v[24:27]
    ds_read_b128 v[148:151], v4 offset:0
    ds_read_b128 v[152:155], v5 offset:0
    v_mfma_f32_16x16x32_bf16 v[56:59], v[124:127], a[92:95], v[56:59]
    s_waitcnt lgkmcnt(9)
    ds_read_b128 v[100:103], v3 offset:46080
    ds_read_b128 v[156:159], v10 offset:1024
    v_mfma_f32_16x16x32_bf16 v[28:31], v[128:131], a[20:23], v[28:31]
    buffer_load_dwordx4 v2, s[4:7], s53 offen offset:2048 lds
    v_mfma_f32_16x16x32_bf16 v[60:63], v[128:131], a[92:95], v[60:63]
    s_waitcnt lgkmcnt(10)
    s_add_u32 s92, s67, s71
    ds_read_b128 v[112:115], v3 offset:49152
    v_mfma_f32_16x16x32_bf16 v[32:35], v[140:143], a[20:23], v[32:35]
    ds_read_b128 v[160:163], v4 offset:7168
    ds_read_b128 v[164:167], v5 offset:7168
    v_mfma_f32_16x16x32_bf16 v[64:67], v[140:143], a[92:95], v[64:67]
    ds_read_b128 v[104:107], v3 offset:47104
    v_mfma_f32_16x16x32_bf16 v[44:47], a[20:23], v[140:143], v[44:47]
    buffer_store_dwordx4 v[188:191], v2, s[4:7], s92 offen sc1
    v_mfma_f32_16x16x32_bf16 v[76:79], a[92:95], v[140:143], v[76:79]
    s_waitcnt lgkmcnt(13)
    ds_read_b128 v[108:111], v3 offset:48128
    v_mfma_f32_16x16x32_bf16 v[36:39], a[20:23], v[132:135], v[36:39]
    v_mfma_f32_16x16x32_bf16 v[68:71], a[92:95], v[132:135], v[68:71]
    s_waitcnt lgkmcnt(13)
    v_mfma_f32_16x16x32_bf16 v[40:43], a[20:23], v[136:139], v[40:43]
    buffer_load_dwordx4 v2, s[4:7], s53 offen offset:3072 lds
    v_mfma_f32_16x16x32_bf16 v[72:75], a[92:95], v[136:139], v[72:75]
    s_waitcnt vmcnt(18) lgkmcnt(12)
    s_add_u32 m0, s48, 108544
    s_add_u32 s53, s47, 90112
    v_mfma_f32_16x16x32_bf16 v[16:19], v[88:91], a[24:27], v[16:19]
    s_waitcnt vmcnt(17)
    ds_read_b128 v[116:119], v3 offset:50176
    v_mfma_f32_16x16x32_bf16 v[48:51], v[88:91], a[96:99], v[48:51]
    s_waitcnt lgkmcnt(12)
    ds_read_b128 v[120:123], v3 offset:51200
    v_mfma_f32_16x16x32_bf16 v[20:23], v[92:95], a[24:27], v[20:23]
    buffer_load_dwordx4 v2, s[4:7], s53 offen offset:0 lds
    v_mfma_f32_16x16x32_bf16 v[52:55], v[92:95], a[96:99], v[52:55]
    s_waitcnt lgkmcnt(12)
    ds_read_b128 v[124:127], v3 offset:52224
    v_mfma_f32_16x16x32_bf16 v[24:27], v[96:99], a[24:27], v[24:27]
    v_mfma_f32_16x16x32_bf16 v[56:59], v[96:99], a[96:99], v[56:59]
    s_waitcnt lgkmcnt(9)
    ds_read_b128 v[128:131], v3 offset:53248
    v_mfma_f32_16x16x32_bf16 v[28:31], v[100:103], a[24:27], v[28:31]
    buffer_load_dwordx4 v2, s[4:7], s53 offen offset:1024 lds
    v_mfma_f32_16x16x32_bf16 v[60:63], v[100:103], a[96:99], v[60:63]
    s_waitcnt lgkmcnt(8)
    ds_read_b128 v[140:143], v3 offset:56320
    v_mfma_f32_16x16x32_bf16 v[32:35], v[112:115], a[24:27], v[32:35]
    v_mfma_f32_16x16x32_bf16 v[64:67], v[112:115], a[96:99], v[64:67]
    ds_read_b128 v[132:135], v3 offset:54272
    v_mfma_f32_16x16x32_bf16 v[44:47], a[24:27], v[112:115], v[44:47]
    buffer_load_dwordx4 v2, s[4:7], s53 offen offset:2048 lds
    v_mfma_f32_16x16x32_bf16 v[76:79], a[96:99], v[112:115], v[76:79]
    s_waitcnt lgkmcnt(7)
    ds_read_b128 v[136:139], v3 offset:55296
    v_mfma_f32_16x16x32_bf16 v[36:39], a[24:27], v[104:107], v[36:39]
    v_mfma_f32_16x16x32_bf16 v[68:71], a[96:99], v[104:107], v[68:71]
    s_waitcnt lgkmcnt(7)
    v_mfma_f32_16x16x32_bf16 v[40:43], a[24:27], v[108:111], v[40:43]
    buffer_load_dwordx4 v2, s[4:7], s53 offen offset:3072 lds
    v_mfma_f32_16x16x32_bf16 v[72:75], a[96:99], v[108:111], v[72:75]
    s_add_u32 s92, s92, s70
    s_add_u32 m0, s48, 112640
    v_mfma_f32_16x16x32_bf16 v[80:83], v[148:151], v[144:147], 0
    s_add_u32 s53, s47, 94208
    v_mfma_f32_16x16x32_bf16 v[84:87], v[144:147], v[152:155], 0
    s_waitcnt vmcnt(20) lgkmcnt(6)
    ds_read_b128 v[144:147], v10 offset:2048
    ds_read_b128 v[148:151], v4 offset:14336
    v_mfma_f32_16x16x32_bf16 v[16:19], v[116:119], a[28:31], v[16:19]
    buffer_store_dwordx4 v[192:195], v2, s[4:7], s92 offen sc1
    s_waitcnt vmcnt(20)
    v_mfma_f32_16x16x32_bf16 v[48:51], v[116:119], a[100:103], v[48:51]
    s_waitcnt lgkmcnt(7)
    ds_read_b128 v[88:91], v3 offset:57344
    ds_read_b128 v[92:95], v3 offset:58368
    v_mfma_f32_16x16x32_bf16 v[20:23], v[120:123], a[28:31], v[20:23]
    ds_read_b128 v[152:155], v5 offset:14336
    v_mfma_f32_16x16x32_bf16 v[52:55], v[120:123], a[100:103], v[52:55]
    s_waitcnt lgkmcnt(9)
    ds_read_b128 v[96:99], v3 offset:59392
    v_mfma_f32_16x16x32_bf16 v[24:27], v[124:127], a[28:31], v[24:27]
    buffer_load_dwordx4 v2, s[4:7], s53 offen offset:0 lds
    v_mfma_f32_16x16x32_bf16 v[56:59], v[124:127], a[100:103], v[56:59]
    s_waitcnt lgkmcnt(9)
    ds_read_b128 v[100:103], v3 offset:60416
    v_mfma_f32_16x16x32_bf16 v[28:31], v[128:131], a[28:31], v[28:31]
    v_mfma_f32_16x16x32_bf16 v[60:63], v[128:131], a[100:103], v[60:63]
    s_waitcnt lgkmcnt(9)
    ds_read_b128 v[112:115], v3 offset:63488
    v_mfma_f32_16x16x32_bf16 v[32:35], v[140:143], a[28:31], v[32:35]
    buffer_load_dwordx4 v2, s[4:7], s53 offen offset:1024 lds
    v_mfma_f32_16x16x32_bf16 v[64:67], v[140:143], a[100:103], v[64:67]
    ds_read_b128 v[104:107], v3 offset:61440
    v_mfma_f32_16x16x32_bf16 v[44:47], a[28:31], v[140:143], v[44:47]
    v_mfma_f32_16x16x32_bf16 v[76:79], a[100:103], v[140:143], v[76:79]
    s_waitcnt lgkmcnt(10)
    ds_read_b128 v[108:111], v3 offset:62464
    v_mfma_f32_16x16x32_bf16 v[36:39], a[28:31], v[132:135], v[36:39]
    buffer_load_dwordx4 v2, s[4:7], s53 offen offset:2048 lds
    v_mfma_f32_16x16x32_bf16 v[68:71], a[100:103], v[132:135], v[68:71]
    s_waitcnt lgkmcnt(10)
    s_add_u32 s54, s51, 12288
    v_mfma_f32_16x16x32_bf16 v[40:43], a[28:31], v[136:139], v[40:43]
    v_mfma_f32_16x16x32_bf16 v[72:75], a[100:103], v[136:139], v[72:75]
    v_mfma_f32_16x16x32_bf16 v[80:83], v[160:163], v[156:159], v[80:83]
    v_mfma_f32_16x16x32_bf16 v[84:87], v[156:159], v[164:167], v[84:87]
    s_waitcnt vmcnt(22) lgkmcnt(7)
    ds_read_b128 v[156:159], v10 offset:3072
    ds_read_b128 v[160:163], v4 offset:21504
    v_mfma_f32_16x16x32_bf16 v[16:19], v[88:91], a[32:35], v[16:19]
    buffer_load_dwordx4 a[48:51], v2, s[4:7], s54 offen offset:0 sc1
    s_waitcnt vmcnt(21)
    v_mfma_f32_16x16x32_bf16 v[48:51], v[88:91], a[104:107], v[48:51]
    s_waitcnt lgkmcnt(8)
    s_add_u32 s55, s51, 30720
    v_add_u32 v3, 64512, v3
    v_mfma_f32_16x16x32_bf16 v[20:23], v[92:95], a[32:35], v[20:23]
    ds_read_b128 v[116:119], v3 offset:0
    ds_read_b128 v[164:167], v5 offset:21504
    v_mfma_f32_16x16x32_bf16 v[52:55], v[92:95], a[104:107], v[52:55]
    s_waitcnt lgkmcnt(8)
    ds_read_b128 v[120:123], v3 offset:1024
    v_mfma_f32_16x16x32_bf16 v[24:27], v[96:99], a[32:35], v[24:27]
    buffer_store_dwordx4 v[196:199], v2, s[4:7], s68 offen sc1
    v_mfma_f32_16x16x32_bf16 v[56:59], v[96:99], a[104:107], v[56:59]
    s_waitcnt lgkmcnt(8)
    ds_read_b128 v[124:127], v3 offset:2048
    v_mfma_f32_16x16x32_bf16 v[28:31], v[100:103], a[32:35], v[28:31]
    v_mfma_f32_16x16x32_bf16 v[60:63], v[100:103], a[104:107], v[60:63]
    s_waitcnt lgkmcnt(8)
    ds_read_b128 v[128:131], v3 offset:3072
    v_mfma_f32_16x16x32_bf16 v[32:35], v[112:115], a[32:35], v[32:35]
    buffer_load_dwordx4 a[120:123], v2, s[4:7], s55 offen offset:0 sc1
    v_mfma_f32_16x16x32_bf16 v[64:67], v[112:115], a[104:107], v[64:67]
    ds_read_b128 v[140:143], v3 offset:6144
    v_mfma_f32_16x16x32_bf16 v[44:47], a[32:35], v[112:115], v[44:47]
    v_mfma_f32_16x16x32_bf16 v[76:79], a[104:107], v[112:115], v[76:79]
    s_waitcnt lgkmcnt(9)
    ds_read_b128 v[132:135], v3 offset:4096
    v_mfma_f32_16x16x32_bf16 v[36:39], a[32:35], v[104:107], v[36:39]
    buffer_load_dwordx4 a[52:55], v2, s[4:7], s54 offen offset:1024 sc1
    v_mfma_f32_16x16x32_bf16 v[68:71], a[104:107], v[104:107], v[68:71]
    s_waitcnt lgkmcnt(9)
    ds_read_b128 v[136:139], v3 offset:5120
    v_mfma_f32_16x16x32_bf16 v[40:43], a[32:35], v[108:111], v[40:43]
    v_mfma_f32_16x16x32_bf16 v[72:75], a[104:107], v[108:111], v[72:75]
    v_mfma_f32_16x16x32_bf16 v[80:83], v[148:151], v[144:147], v[80:83]
    v_mfma_f32_16x16x32_bf16 v[84:87], v[144:147], v[152:155], v[84:87]
    s_waitcnt vmcnt(23) lgkmcnt(7)
    ds_read_b128 v[144:147], v10 offset:4096
    ds_read_b128 v[148:151], v4 offset:28672
    v_mfma_f32_16x16x32_bf16 v[16:19], v[116:119], a[36:39], v[16:19]
    buffer_load_dwordx4 a[124:127], v2, s[4:7], s55 offen offset:1024 sc1
    s_waitcnt vmcnt(23)
    v_mfma_f32_16x16x32_bf16 v[48:51], v[116:119], a[108:111], v[48:51]
    s_waitcnt lgkmcnt(7)
    ds_read_b128 v[88:91], v3 offset:7168
    ds_read_b128 v[92:95], v3 offset:8192
    v_mfma_f32_16x16x32_bf16 v[20:23], v[120:123], a[36:39], v[20:23]
    ds_read_b128 v[152:155], v5 offset:28672
    v_mfma_f32_16x16x32_bf16 v[52:55], v[120:123], a[108:111], v[52:55]
    s_waitcnt lgkmcnt(9)
    ds_read_b128 v[96:99], v3 offset:9216
    v_mfma_f32_16x16x32_bf16 v[24:27], v[124:127], a[36:39], v[24:27]
    buffer_load_dwordx4 a[56:59], v2, s[4:7], s54 offen offset:2048 sc1
    v_mfma_f32_16x16x32_bf16 v[56:59], v[124:127], a[108:111], v[56:59]
    s_waitcnt lgkmcnt(9)
    ds_read_b128 v[100:103], v3 offset:10240
    v_mfma_f32_16x16x32_bf16 v[28:31], v[128:131], a[36:39], v[28:31]
    v_mfma_f32_16x16x32_bf16 v[60:63], v[128:131], a[108:111], v[60:63]
    s_waitcnt lgkmcnt(9)
    ds_read_b128 v[112:115], v3 offset:13312
    v_mfma_f32_16x16x32_bf16 v[32:35], v[140:143], a[36:39], v[32:35]
    buffer_load_dwordx4 a[128:131], v2, s[4:7], s55 offen offset:2048 sc1
    v_mfma_f32_16x16x32_bf16 v[64:67], v[140:143], a[108:111], v[64:67]
    s_add_u32 s92, s68, s70
    ds_read_b128 v[104:107], v3 offset:11264
    v_mfma_f32_16x16x32_bf16 v[44:47], a[36:39], v[140:143], v[44:47]
    v_mfma_f32_16x16x32_bf16 v[76:79], a[108:111], v[140:143], v[76:79]
    s_waitcnt lgkmcnt(10)
    ds_read_b128 v[108:111], v3 offset:12288
    v_mfma_f32_16x16x32_bf16 v[36:39], a[36:39], v[132:135], v[36:39]
    buffer_store_dwordx4 v[200:203], v2, s[4:7], s92 offen sc1
    v_mfma_f32_16x16x32_bf16 v[68:71], a[108:111], v[132:135], v[68:71]
    s_waitcnt lgkmcnt(10)
    v_mfma_f32_16x16x32_bf16 v[40:43], a[36:39], v[136:139], v[40:43]
    v_mfma_f32_16x16x32_bf16 v[72:75], a[108:111], v[136:139], v[72:75]
    v_mfma_f32_16x16x32_bf16 v[80:83], v[160:163], v[156:159], v[80:83]
    v_mfma_f32_16x16x32_bf16 v[84:87], v[156:159], v[164:167], v[84:87]
    s_waitcnt vmcnt(25) lgkmcnt(7)
    ds_read_b128 v[156:159], v10 offset:5120
    ds_read_b128 v[160:163], v4 offset:35840
    v_mfma_f32_16x16x32_bf16 v[16:19], v[88:91], a[40:43], v[16:19]
    buffer_load_dwordx4 a[60:63], v2, s[4:7], s54 offen offset:3072 sc1
    s_waitcnt vmcnt(25)
    v_mfma_f32_16x16x32_bf16 v[48:51], v[88:91], a[112:115], v[48:51]
    s_waitcnt lgkmcnt(8)
    ds_read_b128 v[116:119], v3 offset:14336
    ds_read_b128 v[120:123], v3 offset:15360
    v_mfma_f32_16x16x32_bf16 v[20:23], v[92:95], a[40:43], v[20:23]
    ds_read_b128 v[164:167], v5 offset:35840
    v_mfma_f32_16x16x32_bf16 v[52:55], v[92:95], a[112:115], v[52:55]
    s_waitcnt lgkmcnt(9)
    ds_read_b128 v[124:127], v3 offset:16384
    v_mfma_f32_16x16x32_bf16 v[24:27], v[96:99], a[40:43], v[24:27]
    buffer_load_dwordx4 a[132:135], v2, s[4:7], s55 offen offset:3072 sc1
    v_mfma_f32_16x16x32_bf16 v[56:59], v[96:99], a[112:115], v[56:59]
    s_waitcnt lgkmcnt(9)
    s_add_u32 s54, s51, 16384
    ds_read_b128 v[128:131], v3 offset:17408
    v_mfma_f32_16x16x32_bf16 v[28:31], v[100:103], a[40:43], v[28:31]
    v_mfma_f32_16x16x32_bf16 v[60:63], v[100:103], a[112:115], v[60:63]
    s_waitcnt lgkmcnt(9)
    ds_read_b128 v[140:143], v3 offset:20480
    v_mfma_f32_16x16x32_bf16 v[32:35], v[112:115], a[40:43], v[32:35]
    buffer_load_dwordx4 a[64:67], v2, s[4:7], s54 offen offset:0 sc1
    v_mfma_f32_16x16x32_bf16 v[64:67], v[112:115], a[112:115], v[64:67]
    s_add_u32 s55, s51, 34816
    ds_read_b128 v[132:135], v3 offset:18432
    v_mfma_f32_16x16x32_bf16 v[44:47], a[40:43], v[112:115], v[44:47]
    v_mfma_f32_16x16x32_bf16 v[76:79], a[112:115], v[112:115], v[76:79]
    s_waitcnt lgkmcnt(10)
    ds_read_b128 v[136:139], v3 offset:19456
    v_mfma_f32_16x16x32_bf16 v[36:39], a[40:43], v[104:107], v[36:39]
    buffer_load_dwordx4 a[136:139], v2, s[4:7], s55 offen offset:0 sc1
    v_mfma_f32_16x16x32_bf16 v[68:71], a[112:115], v[104:107], v[68:71]
    s_waitcnt lgkmcnt(10)
    v_mfma_f32_16x16x32_bf16 v[40:43], a[40:43], v[108:111], v[40:43]
    v_mfma_f32_16x16x32_bf16 v[72:75], a[112:115], v[108:111], v[72:75]
    s_add_u32 s92, s68, s71
    v_mfma_f32_16x16x32_bf16 v[80:83], v[148:151], v[144:147], v[80:83]
    v_mfma_f32_16x16x32_bf16 v[84:87], v[144:147], v[152:155], v[84:87]
    s_waitcnt vmcnt(26) lgkmcnt(7)
    ds_read_b128 v[144:147], v10 offset:6144
    ds_read_b128 v[148:151], v4 offset:43008
    v_mfma_f32_16x16x32_bf16 v[16:19], v[116:119], a[44:47], v[16:19]
    s_waitcnt vmcnt(25)
    s_waitcnt vmcnt(12)
    s_barrier
    ds_read_b128 v[88:91], v3 offset:21504
    v_mfma_f32_16x16x32_bf16 v[48:51], v[116:119], a[116:119], v[48:51]
    buffer_store_dwordx4 v[204:207], v2, s[4:7], s92 offen sc1
    s_waitcnt lgkmcnt(9)
    v_mfma_f32_16x16x32_bf16 v[20:23], v[120:123], a[44:47], v[20:23]
    ds_read_b128 v[92:95], v3 offset:22528
    ds_read_b128 v[152:155], v5 offset:43008
    v_mfma_f32_16x16x32_bf16 v[52:55], v[120:123], a[116:119], v[52:55]
    s_waitcnt lgkmcnt(9)
    ds_read_b128 v[96:99], v3 offset:23552
    v_mfma_f32_16x16x32_bf16 v[24:27], v[124:127], a[44:47], v[24:27]
    v_mfma_f32_16x16x32_bf16 v[56:59], v[124:127], a[116:119], v[56:59]
    s_waitcnt lgkmcnt(9)
    ds_read_b128 v[100:103], v3 offset:24576
    v_mfma_f32_16x16x32_bf16 v[28:31], v[128:131], a[44:47], v[28:31]
    buffer_load_dwordx4 a[68:71], v2, s[4:7], s54 offen offset:1024 sc1
    v_mfma_f32_16x16x32_bf16 v[60:63], v[128:131], a[116:119], v[60:63]
    s_waitcnt lgkmcnt(9)
    ds_read_b128 v[112:115], v3 offset:27648
    v_mfma_f32_16x16x32_bf16 v[32:35], v[140:143], a[44:47], v[32:35]
    v_mfma_f32_16x16x32_bf16 v[64:67], v[140:143], a[116:119], v[64:67]
    ds_read_b128 v[104:107], v3 offset:25600
    v_mfma_f32_16x16x32_bf16 v[44:47], a[44:47], v[140:143], v[44:47]
    buffer_load_dwordx4 a[140:143], v2, s[4:7], s55 offen offset:1024 sc1
    v_mfma_f32_16x16x32_bf16 v[76:79], a[116:119], v[140:143], v[76:79]
    s_waitcnt lgkmcnt(10)
    ds_read_b128 v[108:111], v3 offset:26624
    v_mfma_f32_16x16x32_bf16 v[36:39], a[44:47], v[132:135], v[36:39]
    v_mfma_f32_16x16x32_bf16 v[68:71], a[116:119], v[132:135], v[68:71]
    s_waitcnt lgkmcnt(10)
    v_mfma_f32_16x16x32_bf16 v[40:43], a[44:47], v[136:139], v[40:43]
    buffer_load_dwordx4 a[180:183], v238, s[12:15], 0 offen nt
    v_mfma_f32_16x16x32_bf16 v[72:75], a[116:119], v[136:139], v[72:75]
    v_mfma_f32_16x16x32_bf16 v[80:83], v[160:163], v[156:159], v[80:83]
    v_mfma_f32_16x16x32_bf16 v[84:87], v[156:159], v[164:167], v[84:87]
    s_waitcnt vmcnt(15) lgkmcnt(7)
    ds_read_b128 v[156:159], v10 offset:7168
    ds_read_b128 v[160:163], v4 offset:50176
    v_mfma_f32_16x16x32_bf16 v[16:19], v[88:91], a[48:51], v[16:19]
    buffer_load_dwordx4 a[184:187], v239, s[12:15], 0 offen nt
    s_waitcnt vmcnt(14)
    v_mfma_f32_16x16x32_bf16 v[48:51], v[88:91], a[120:123], v[48:51]
    s_waitcnt lgkmcnt(8)
    ds_read_b128 v[164:167], v5 offset:50176
    ds_read_b128 v[116:119], v3 offset:28672
    v_mfma_f32_16x16x32_bf16 v[20:23], v[92:95], a[48:51], v[20:23]
    ds_read_b128 v[120:123], v3 offset:29696
    v_mfma_f32_16x16x32_bf16 v[52:55], v[92:95], a[120:123], v[52:55]
    s_waitcnt lgkmcnt(9)
    s_add_u32 s92, s92, s70
    ds_read_b128 v[124:127], v3 offset:30720
    v_mfma_f32_16x16x32_bf16 v[24:27], v[96:99], a[48:51], v[24:27]
    buffer_store_dwordx4 v[208:211], v2, s[4:7], s92 offen sc1
    v_mfma_f32_16x16x32_bf16 v[56:59], v[96:99], a[120:123], v[56:59]
    s_waitcnt lgkmcnt(9)
    ds_read_b128 v[128:131], v3 offset:31744
    v_mfma_f32_16x16x32_bf16 v[28:31], v[100:103], a[48:51], v[28:31]
    v_mfma_f32_16x16x32_bf16 v[60:63], v[100:103], a[120:123], v[60:63]
    ds_read_b128 v[140:143], v3 offset:34816
    v_mfma_f32_16x16x32_bf16 v[80:83], v[148:151], v[144:147], v[80:83]
    v_mfma_f32_16x16x32_bf16 v[84:87], v[144:147], v[152:155], v[84:87]
    s_waitcnt lgkmcnt(10)
    ds_read_b128 v[132:135], v3 offset:32768
    ds_read_b128 v[144:147], v10 offset:8192
    v_mfma_f32_16x16x32_bf16 v[32:35], v[112:115], a[48:51], v[32:35]
    buffer_load_dwordx4 a[188:191], v240, s[12:15], 0 offen nt
    v_mfma_f32_16x16x32_bf16 v[64:67], v[112:115], a[120:123], v[64:67]
    ds_read_b128 v[136:139], v3 offset:33792
    ds_read_b128 v[148:151], v4 offset:57344
    v_mfma_f32_16x16x32_bf16 v[44:47], a[48:51], v[112:115], v[44:47]
    ds_read_b128 v[152:155], v5 offset:57344
    v_mfma_f32_16x16x32_bf16 v[76:79], a[120:123], v[112:115], v[76:79]
    s_waitcnt lgkmcnt(14)
    v_mfma_f32_16x16x32_bf16 v[36:39], a[48:51], v[104:107], v[36:39]
    buffer_load_dwordx4 a[192:195], v241, s[12:15], 0 offen nt
    v_mfma_f32_16x16x32_bf16 v[68:71], a[120:123], v[104:107], v[68:71]
    s_waitcnt lgkmcnt(13)
    v_mfma_f32_16x16x32_bf16 v[40:43], a[48:51], v[108:111], v[40:43]
    v_mfma_f32_16x16x32_bf16 v[72:75], a[120:123], v[108:111], v[72:75]
    s_waitcnt lgkmcnt(11)
    v_mfma_f32_16x16x32_bf16 v[80:83], v[160:163], v[156:159], v[80:83]
    s_waitcnt lgkmcnt(10)
    v_mfma_f32_16x16x32_bf16 v[84:87], v[156:159], v[164:167], v[84:87]
    s_waitcnt vmcnt(16) lgkmcnt(9)
    v_add_u32 v4, 64512, v4
    v_add_u32 v5, 64512, v5
    v_mfma_f32_16x16x32_bf16 v[16:19], v[116:119], a[52:55], v[16:19]
    buffer_load_dwordx4 a[196:199], v242, s[12:15], 0 offen nt
    s_waitcnt vmcnt(16)
    v_mfma_f32_16x16x32_bf16 v[48:51], v[116:119], a[124:127], v[48:51]
    s_waitcnt lgkmcnt(8)
    ds_read_b128 v[156:159], v10 offset:9216
    ds_read_b128 v[160:163], v4 offset:0
    v_mfma_f32_16x16x32_bf16 v[20:23], v[120:123], a[52:55], v[20:23]
    ds_read_b128 v[164:167], v5 offset:0
    ds_read_b128 v[88:91], v3 offset:35840
    v_mfma_f32_16x16x32_bf16 v[52:55], v[120:123], a[124:127], v[52:55]
    s_waitcnt lgkmcnt(11)
    ds_read_b128 v[92:95], v3 offset:36864
    ds_read_b128 v[96:99], v3 offset:37888
    v_mfma_f32_16x16x32_bf16 v[24:27], v[124:127], a[52:55], v[24:27]
    buffer_load_dwordx4 a[200:203], v243, s[12:15], 0 offen nt
    v_mfma_f32_16x16x32_bf16 v[56:59], v[124:127], a[124:127], v[56:59]
    s_waitcnt lgkmcnt(12)
    ds_read_b128 v[100:103], v3 offset:38912
    v_mfma_f32_16x16x32_bf16 v[28:31], v[128:131], a[52:55], v[28:31]
    v_mfma_f32_16x16x32_bf16 v[60:63], v[128:131], a[124:127], v[60:63]
    s_waitcnt lgkmcnt(8)
    ds_read_b128 v[112:115], v3 offset:41984
    v_mfma_f32_16x16x32_bf16 v[80:83], v[148:151], v[144:147], v[80:83]
    s_waitcnt lgkmcnt(8)
    v_mfma_f32_16x16x32_bf16 v[84:87], v[144:147], v[152:155], v[84:87]
    ds_read_b128 v[104:107], v3 offset:39936
    ds_read_b128 v[144:147], v10 offset:10240
    v_mfma_f32_16x16x32_bf16 v[32:35], v[140:143], a[52:55], v[32:35]
    buffer_store_dwordx4 v[212:215], v2, s[4:7], s69 offen sc1
    v_mfma_f32_16x16x32_bf16 v[64:67], v[140:143], a[124:127], v[64:67]
    ds_read_b128 v[108:111], v3 offset:40960
    ds_read_b128 v[148:151], v4 offset:7168
    v_mfma_f32_16x16x32_bf16 v[44:47], a[52:55], v[140:143], v[44:47]
    ds_read_b128 v[152:155], v5 offset:7168
    v_mfma_f32_16x16x32_bf16 v[76:79], a[124:127], v[140:143], v[76:79]
    v_mfma_f32_16x16x32_bf16 v[36:39], a[52:55], v[132:135], v[36:39]
    buffer_load_dwordx4 a[204:207], v244, s[12:15], 0 offen nt
    v_mfma_f32_16x16x32_bf16 v[68:71], a[124:127], v[132:135], v[68:71]
    v_mfma_f32_16x16x32_bf16 v[40:43], a[52:55], v[136:139], v[40:43]
    v_mfma_f32_16x16x32_bf16 v[72:75], a[124:127], v[136:139], v[72:75]
    s_waitcnt lgkmcnt(11)
    v_mfma_f32_16x16x32_bf16 v[80:83], v[160:163], v[156:159], v[80:83]
    s_waitcnt lgkmcnt(10)
    v_mfma_f32_16x16x32_bf16 v[84:87], v[156:159], v[164:167], v[84:87]
    s_waitcnt vmcnt(18) lgkmcnt(9)
    ds_read_b128 v[156:159], v10 offset:11264
    ds_read_b128 v[160:163], v4 offset:14336
    v_mfma_f32_16x16x32_bf16 v[16:19], v[88:91], a[56:59], v[16:19]
    buffer_load_dwordx4 a[208:211], v245, s[12:15], 0 offen nt
    s_waitcnt vmcnt(18)
    v_mfma_f32_16x16x32_bf16 v[48:51], v[88:91], a[128:131], v[48:51]
    s_waitcnt lgkmcnt(10)
    ds_read_b128 v[164:167], v5 offset:14336
    ds_read_b128 v[116:119], v3 offset:43008
    v_mfma_f32_16x16x32_bf16 v[20:23], v[92:95], a[56:59], v[20:23]
    ds_read_b128 v[120:123], v3 offset:44032
    v_mfma_f32_16x16x32_bf16 v[52:55], v[92:95], a[128:131], v[52:55]
    s_waitcnt lgkmcnt(12)
    ds_read_b128 v[124:127], v3 offset:45056
    v_mfma_f32_16x16x32_bf16 v[24:27], v[96:99], a[56:59], v[24:27]
    buffer_load_dwordx4 a[212:215], v246, s[12:15], 0 offen nt
    v_mfma_f32_16x16x32_bf16 v[56:59], v[96:99], a[128:131], v[56:59]
    s_waitcnt lgkmcnt(12)
    ds_read_b128 v[128:131], v3 offset:46080
    v_mfma_f32_16x16x32_bf16 v[28:31], v[100:103], a[56:59], v[28:31]
    v_mfma_f32_16x16x32_bf16 v[60:63], v[100:103], a[128:131], v[60:63]
    s_waitcnt lgkmcnt(8)
    ds_read_b128 v[140:143], v3 offset:49152
    v_mfma_f32_16x16x32_bf16 v[80:83], v[148:151], v[144:147], v[80:83]
    s_waitcnt lgkmcnt(8)
    v_mfma_f32_16x16x32_bf16 v[84:87], v[144:147], v[152:155], v[84:87]
    ds_read_b128 v[132:135], v3 offset:47104
    ds_read_b128 v[144:147], v10 offset:12288
    v_mfma_f32_16x16x32_bf16 v[32:35], v[112:115], a[56:59], v[32:35]
    buffer_load_dwordx4 a[216:219], v247, s[8:11], 0 offen nt
    v_mfma_f32_16x16x32_bf16 v[64:67], v[112:115], a[128:131], v[64:67]
    ds_read_b128 v[136:139], v3 offset:48128
    ds_read_b128 v[148:151], v4 offset:21504
    v_mfma_f32_16x16x32_bf16 v[44:47], a[56:59], v[112:115], v[44:47]
    ds_read_b128 v[152:155], v5 offset:21504
    v_mfma_f32_16x16x32_bf16 v[76:79], a[128:131], v[112:115], v[76:79]
    v_mfma_f32_16x16x32_bf16 v[36:39], a[56:59], v[104:107], v[36:39]
    buffer_load_dwordx4 a[220:223], v248, s[8:11], 0 offen nt
    v_mfma_f32_16x16x32_bf16 v[68:71], a[128:131], v[104:107], v[68:71]
    v_mfma_f32_16x16x32_bf16 v[40:43], a[56:59], v[108:111], v[40:43]
    v_mfma_f32_16x16x32_bf16 v[72:75], a[128:131], v[108:111], v[72:75]
    s_waitcnt lgkmcnt(11)
    v_mfma_f32_16x16x32_bf16 v[80:83], v[160:163], v[156:159], v[80:83]
    s_waitcnt lgkmcnt(10)
    v_mfma_f32_16x16x32_bf16 v[84:87], v[156:159], v[164:167], v[84:87]
    s_waitcnt vmcnt(19) lgkmcnt(9)
    ds_read_b128 v[156:159], v10 offset:13312
    ds_read_b128 v[160:163], v4 offset:28672
    v_mfma_f32_16x16x32_bf16 v[16:19], v[116:119], a[60:63], v[16:19]
    buffer_load_dwordx4 a[224:227], v249, s[8:11], 0 offen nt
    s_waitcnt vmcnt(19)
    v_mfma_f32_16x16x32_bf16 v[48:51], v[116:119], a[132:135], v[48:51]
    s_waitcnt lgkmcnt(10)
    ds_read_b128 v[164:167], v5 offset:28672
    ds_read_b128 v[88:91], v3 offset:50176
    v_mfma_f32_16x16x32_bf16 v[20:23], v[120:123], a[60:63], v[20:23]
    ds_read_b128 v[92:95], v3 offset:51200
    v_mfma_f32_16x16x32_bf16 v[52:55], v[120:123], a[132:135], v[52:55]
    s_waitcnt lgkmcnt(12)
    ds_read_b128 v[96:99], v3 offset:52224
    v_mfma_f32_16x16x32_bf16 v[24:27], v[124:127], a[60:63], v[24:27]
    buffer_load_dwordx4 a[228:231], v250, s[8:11], 0 offen nt
    v_mfma_f32_16x16x32_bf16 v[56:59], v[124:127], a[132:135], v[56:59]
    s_waitcnt lgkmcnt(12)
    ds_read_b128 v[100:103], v3 offset:53248
    v_mfma_f32_16x16x32_bf16 v[28:31], v[128:131], a[60:63], v[28:31]
    v_mfma_f32_16x16x32_bf16 v[60:63], v[128:131], a[132:135], v[60:63]
    s_waitcnt lgkmcnt(8)
    ds_read_b128 v[112:115], v3 offset:56320
    v_mfma_f32_16x16x32_bf16 v[80:83], v[148:151], v[144:147], v[80:83]
    s_waitcnt lgkmcnt(8)
    v_mfma_f32_16x16x32_bf16 v[84:87], v[144:147], v[152:155], v[84:87]
    ds_read_b128 v[104:107], v3 offset:54272
    ds_read_b128 v[144:147], v10 offset:14336
    v_mfma_f32_16x16x32_bf16 v[32:35], v[140:143], a[60:63], v[32:35]
    buffer_load_dwordx4 a[232:235], v251, s[8:11], 0 offen nt
    v_mfma_f32_16x16x32_bf16 v[64:67], v[140:143], a[132:135], v[64:67]
    ds_read_b128 v[108:111], v3 offset:55296
    ds_read_b128 v[148:151], v4 offset:35840
    v_mfma_f32_16x16x32_bf16 v[44:47], a[60:63], v[140:143], v[44:47]
    ds_read_b128 v[152:155], v5 offset:35840
    v_mfma_f32_16x16x32_bf16 v[76:79], a[132:135], v[140:143], v[76:79]
    v_mfma_f32_16x16x32_bf16 v[36:39], a[60:63], v[132:135], v[36:39]
    buffer_load_dwordx4 a[236:239], v252, s[8:11], 0 offen nt
    v_mfma_f32_16x16x32_bf16 v[68:71], a[132:135], v[132:135], v[68:71]
    v_mfma_f32_16x16x32_bf16 v[40:43], a[60:63], v[136:139], v[40:43]
    v_mfma_f32_16x16x32_bf16 v[72:75], a[132:135], v[136:139], v[72:75]
    s_waitcnt lgkmcnt(11)
    v_mfma_f32_16x16x32_bf16 v[80:83], v[160:163], v[156:159], v[80:83]
    s_waitcnt lgkmcnt(10)
    v_mfma_f32_16x16x32_bf16 v[84:87], v[156:159], v[164:167], v[84:87]
    s_waitcnt vmcnt(21) lgkmcnt(9)
    ds_read_b128 v[156:159], v10 offset:15360
    ds_read_b128 v[160:163], v4 offset:43008
    v_mfma_f32_16x16x32_bf16 v[16:19], v[88:91], a[64:67], v[16:19]
    buffer_load_dwordx4 a[240:243], v253, s[8:11], 0 offen nt
    s_waitcnt vmcnt(21)
    v_mfma_f32_16x16x32_bf16 v[48:51], v[88:91], a[136:139], v[48:51]
    s_waitcnt lgkmcnt(10)
    ds_read_b128 v[164:167], v5 offset:43008
    ds_read_b128 v[116:119], v3 offset:57344
    v_mfma_f32_16x16x32_bf16 v[20:23], v[92:95], a[64:67], v[20:23]
    ds_read_b128 v[120:123], v3 offset:58368
    v_mfma_f32_16x16x32_bf16 v[52:55], v[92:95], a[136:139], v[52:55]
    s_waitcnt lgkmcnt(12)
    ds_read_b128 v[124:127], v3 offset:59392
    v_mfma_f32_16x16x32_bf16 v[24:27], v[96:99], a[64:67], v[24:27]
    buffer_load_dwordx4 a[244:247], v254, s[8:11], 0 offen nt
    v_mfma_f32_16x16x32_bf16 v[56:59], v[96:99], a[136:139], v[56:59]
    s_waitcnt lgkmcnt(12)
    ds_read_b128 v[128:131], v3 offset:60416
    v_mfma_f32_16x16x32_bf16 v[28:31], v[100:103], a[64:67], v[28:31]
    v_mfma_f32_16x16x32_bf16 v[60:63], v[100:103], a[136:139], v[60:63]
    s_waitcnt lgkmcnt(8)
    ds_read_b128 v[140:143], v3 offset:63488
    v_mfma_f32_16x16x32_bf16 v[80:83], v[148:151], v[144:147], v[80:83]
    s_waitcnt lgkmcnt(8)
    v_mfma_f32_16x16x32_bf16 v[84:87], v[144:147], v[152:155], v[84:87]
    ds_read_b128 v[132:135], v3 offset:61440
    ds_read_b128 v[144:147], v10 offset:16384
    v_mfma_f32_16x16x32_bf16 v[32:35], v[112:115], a[64:67], v[32:35]
    buffer_load_dwordx4 a[248:251], v255, s[8:11], 0 offen nt
    v_mfma_f32_16x16x32_bf16 v[64:67], v[112:115], a[136:139], v[64:67]
    ds_read_b128 v[136:139], v3 offset:62464
    ds_read_b128 v[148:151], v4 offset:50176
    v_mfma_f32_16x16x32_bf16 v[44:47], a[64:67], v[112:115], v[44:47]
    ds_read_b128 v[152:155], v5 offset:50176
    v_mfma_f32_16x16x32_bf16 v[76:79], a[136:139], v[112:115], v[76:79]
    v_mfma_f32_16x16x32_bf16 v[36:39], a[64:67], v[104:107], v[36:39]
    v_mfma_f32_16x16x32_bf16 v[68:71], a[136:139], v[104:107], v[68:71]
    v_mfma_f32_16x16x32_bf16 v[40:43], a[64:67], v[108:111], v[40:43]
    v_mfma_f32_16x16x32_bf16 v[72:75], a[136:139], v[108:111], v[72:75]
    s_waitcnt lgkmcnt(11)
    v_mfma_f32_16x16x32_bf16 v[80:83], v[160:163], v[156:159], v[80:83]
    s_waitcnt lgkmcnt(10)
    v_mfma_f32_16x16x32_bf16 v[84:87], v[156:159], v[164:167], v[84:87]
    s_waitcnt vmcnt(21) lgkmcnt(9)
    ds_read_b128 v[156:159], v10 offset:17408
    ds_read_b128 v[160:163], v4 offset:57344
    v_mfma_f32_16x16x32_bf16 v[16:19], v[116:119], a[68:71], v[16:19]
    s_waitcnt vmcnt(20)
    ds_read_b128 v[164:167], v5 offset:57344
    v_mfma_f32_16x16x32_bf16 v[48:51], v[116:119], a[140:143], v[48:51]
    s_waitcnt lgkmcnt(11)
    v_mfma_f32_16x16x32_bf16 v[20:23], v[120:123], a[68:71], v[20:23]
    v_mfma_f32_16x16x32_bf16 v[52:55], v[120:123], a[140:143], v[52:55]
    s_waitcnt lgkmcnt(10)
    v_mfma_f32_16x16x32_bf16 v[24:27], v[124:127], a[68:71], v[24:27]
    v_mfma_f32_16x16x32_bf16 v[56:59], v[124:127], a[140:143], v[56:59]
    s_waitcnt lgkmcnt(9)
    v_mfma_f32_16x16x32_bf16 v[28:31], v[128:131], a[68:71], v[28:31]
    v_mfma_f32_16x16x32_bf16 v[60:63], v[128:131], a[140:143], v[60:63]
    s_waitcnt lgkmcnt(4)
    v_mfma_f32_16x16x32_bf16 v[80:83], v[148:151], v[144:147], v[80:83]
    s_waitcnt lgkmcnt(3)
    v_mfma_f32_16x16x32_bf16 v[84:87], v[144:147], v[152:155], v[84:87]
    v_mfma_f32_16x16x32_bf16 v[32:35], v[140:143], a[68:71], v[32:35]
    v_mfma_f32_16x16x32_bf16 v[64:67], v[140:143], a[140:143], v[64:67]
    v_mfma_f32_16x16x32_bf16 v[44:47], a[68:71], v[140:143], v[44:47]
    v_mfma_f32_16x16x32_bf16 v[76:79], a[140:143], v[140:143], v[76:79]
    v_mfma_f32_16x16x32_bf16 v[36:39], a[68:71], v[132:135], v[36:39]
    v_mfma_f32_16x16x32_bf16 v[68:71], a[140:143], v[132:135], v[68:71]
    v_mfma_f32_16x16x32_bf16 v[40:43], a[68:71], v[136:139], v[40:43]
    v_mfma_f32_16x16x32_bf16 v[72:75], a[140:143], v[136:139], v[72:75]
    s_waitcnt lgkmcnt(1)
    v_mfma_f32_16x16x32_bf16 v[80:83], v[160:163], v[156:159], v[80:83]
    s_waitcnt lgkmcnt(0)
    v_mfma_f32_16x16x32_bf16 v[84:87], v[156:159], v[164:167], v[84:87]
    v_lshlrev_b32 v6, 3, v1
    v_add_u32 v6, 148608, v6
    s_mul_i32 s52, s20, 3072
    v_add_u32 v7, s52, v6
    v_cvt_pk_bf16_f32 v100, v56, v57
    v_cvt_pk_bf16_f32 v101, v58, v59
    v_cvt_pk_bf16_f32 v104, v60, v61
    v_cvt_pk_bf16_f32 v105, v62, v63
    v_cvt_pk_bf16_f32 v134, v64, v65
    v_cvt_pk_bf16_f32 v137, v66, v67
    v_mov_b32 v102, 0
    v_mov_b32 v103, 0
    v_cvt_pk_bf16_f32 v110, v68, v69
    v_cvt_pk_bf16_f32 v111, v70, v71
    v_cvt_pk_bf16_f32 v116, v72, v73
    v_cvt_pk_bf16_f32 v117, v74, v75
    v_cvt_pk_bf16_f32 v122, v76, v77
    v_cvt_pk_bf16_f32 v123, v78, v79
    v_permlane32_swap_b32 v134, v102
    v_permlane32_swap_b32 v137, v103
    s_cmp_eq_u32 s20, 3
    s_cbranch_scc1 L_w3_46
    ds_write_b64 v7, v[100:101] offset:3072
    ds_write_b64 v7, v[102:103] offset:3584
    ds_write_b64 v7, v[104:105] offset:4096
    ds_write_b64 v7, v[110:111] offset:4608
    ds_write_b64 v7, v[116:117] offset:5120
    ds_write_b64 v7, v[122:123] offset:5632
L_w3_46:
    v_cvt_pk_bf16_f32 v140, v80, v81
    v_cvt_pk_bf16_f32 v141, v82, v83
    v_cvt_pk_bf16_f32 v142, v84, v85
    v_cvt_pk_bf16_f32 v143, v86, v87
    s_min_u32 s52, s20, 2
    s_lshl_b32 s53, s52, 1
    s_cmp_ge_u32 s20, 2
    s_cselect_b32 s53, 1, s53
    s_lshl_b32 s53, s53, 9
    s_add_u32 s52, s52, 3
    s_lshl_b32 s52, s52, 9
    v_add_u32 v8, s53, v6
    v_add_u32 v9, s52, v6
    s_cmp_lt_u32 s20, 2
    s_cbranch_scc1 L_noswap_47
    v_mov_b32 v10, 0
    v_mov_b32 v11, 0
    s_nop 1
    v_permlane32_swap_b32 v140, v10
    v_permlane32_swap_b32 v141, v11
    v_mov_b32 v140, v10
    v_mov_b32 v141, v11
L_noswap_47:
    ds_write_b64 v8, v[140:141]
    ds_write_b64 v9, v[142:143]
    v_cvt_pk_bf16_f32 v132, v48, v49
    v_cvt_pk_bf16_f32 v133, v50, v51
    v_cvt_pk_bf16_f32 v138, v52, v53
    v_cvt_pk_bf16_f32 v139, v54, v55
    v_mov_b32 v135, 0
    v_mov_b32 v136, 0
    v_cvt_pk_bf16_f32 v94, v24, v25
    v_cvt_pk_bf16_f32 v95, v26, v27
    v_cvt_pk_bf16_f32 v98, v28, v29
    v_cvt_pk_bf16_f32 v99, v30, v31
    v_cvt_pk_bf16_f32 v126, v32, v33
    v_cvt_pk_bf16_f32 v129, v34, v35
    v_mov_b32 v96, 0
    v_mov_b32 v97, 0
    v_cvt_pk_bf16_f32 v108, v36, v37
    v_cvt_pk_bf16_f32 v109, v38, v39
    v_cvt_pk_bf16_f32 v114, v40, v41
    v_cvt_pk_bf16_f32 v115, v42, v43
    v_cvt_pk_bf16_f32 v120, v44, v45
    v_cvt_pk_bf16_f32 v121, v46, v47
    v_permlane32_swap_b32 v126, v96
    v_permlane32_swap_b32 v129, v97
    v_cvt_pk_bf16_f32 v124, v16, v17
    v_cvt_pk_bf16_f32 v125, v18, v19
    v_cvt_pk_bf16_f32 v130, v20, v21
    v_cvt_pk_bf16_f32 v131, v22, v23
    v_mov_b32 v127, 0
    v_mov_b32 v128, 0
    v_mov_b32 v12, 0x3f803f80
    v_mov_b32 v13, 0x3f803f80
    v_mov_b32 v14, 0x3f803f80
    v_mov_b32 v15, 0x3f803f80
    v_mfma_f32_16x16x32_bf16 v[32:35], v[94:97], v[132:135], v[172:175]
    v_mfma_f32_16x16x32_bf16 v[36:39], v[100:103], v[132:135], v[168:171]
    v_mfma_f32_16x16x32_bf16 v[20:23], v[94:97], v[124:127], v[168:171]
    v_mfma_f32_16x16x32_bf16 v[40:43], v[96:99], v[136:139], v[172:175]
    v_mfma_f32_16x16x32_bf16 v[44:47], v[102:105], v[136:139], v[168:171]
    v_mfma_f32_16x16x32_bf16 v[28:31], v[96:99], v[128:131], v[168:171]
    s_waitcnt lgkmcnt(0)
    s_barrier
    ds_read_b64 v[88:89], v7 offset:0
    ds_read_b64 v[90:91], v7 offset:512
    ds_read_b64 v[92:93], v7 offset:1024
    ds_read_b64 v[106:107], v7 offset:1536
    ds_read_b64 v[112:113], v7 offset:2048
    ds_read_b64 v[118:119], v7 offset:2560
    s_mov_b32 s52, 0x3eae1a93
    s_waitcnt lgkmcnt(4)
    v_mfma_f32_16x16x32_bf16 v[16:19], v[88:91], v[124:127], v[176:179]
    s_waitcnt lgkmcnt(3)
    v_mfma_f32_16x16x32_bf16 v[24:27], v[90:93], v[128:131], v[176:179]
    v_max3_f32 v48, v32, v33, v34
    v_max3_f32 v49, v40, v41, v42
    s_nop 3
    v_max3_f32 v50, v16, v17, v18
    s_nop 0
    v_max3_f32 v51, v24, v25, v26
    v_max3_f32 v48, v48, v35, v36
    v_max3_f32 v49, v49, v43, v44
    v_max3_f32 v50, v50, v19, v20
    v_max3_f32 v51, v51, v27, v28
    v_max3_f32 v48, v48, v37, v38
    v_max3_f32 v49, v49, v45, v46
    v_max3_f32 v50, v50, v21, v22
    v_max3_f32 v51, v51, v29, v30
    v_max_f32 v48, v48, v39
    v_max_f32 v49, v49, v47
    v_max_f32 v50, v50, v23
    v_max_f32 v51, v51, v31
    v_mov_b32 v52, v48
    v_mov_b32 v53, v49
    v_mov_b32 v54, v50
    v_mov_b32 v55, v51
    v_permlane16_swap_b32 v48, v52
    v_permlane16_swap_b32 v49, v53
    v_permlane16_swap_b32 v50, v54
    v_permlane16_swap_b32 v51, v55
    v_max_f32 v48, v48, v52
    v_max_f32 v49, v49, v53
    v_max_f32 v50, v50, v54
    v_max_f32 v51, v51, v55
    v_mov_b32 v52, v48
    v_mov_b32 v53, v49
    v_mov_b32 v54, v50
    v_mov_b32 v55, v51
    v_permlane32_swap_b32 v48, v52
    v_permlane32_swap_b32 v49, v53
    v_permlane32_swap_b32 v50, v54
    v_permlane32_swap_b32 v51, v55
    v_max_f32 v48, v48, v52
    v_max_f32 v49, v49, v53
    v_max_f32 v50, v50, v54
    v_max_f32 v51, v51, v55
    v_mul_f32 v48, s52, v48
    v_mul_f32 v49, s52, v49
    v_mul_f32 v50, s52, v50
    v_mul_f32 v51, s52, v51
    v_fma_f32 v32, v32, s52, -v48
    v_fma_f32 v40, v40, s52, -v49
    v_fma_f32 v16, v16, s52, -v50
    v_fma_f32 v24, v24, s52, -v51
    v_fma_f32 v33, v33, s52, -v48
    v_fma_f32 v41, v41, s52, -v49
    v_fma_f32 v17, v17, s52, -v50
    v_fma_f32 v25, v25, s52, -v51
    v_fma_f32 v34, v34, s52, -v48
    v_fma_f32 v42, v42, s52, -v49
    v_fma_f32 v18, v18, s52, -v50
    v_fma_f32 v26, v26, s52, -v51
    v_fma_f32 v35, v35, s52, -v48
    v_fma_f32 v43, v43, s52, -v49
    v_fma_f32 v19, v19, s52, -v50
    v_fma_f32 v27, v27, s52, -v51
    v_fma_f32 v36, v36, s52, -v48
    v_fma_f32 v44, v44, s52, -v49
    v_fma_f32 v20, v20, s52, -v50
    v_fma_f32 v28, v28, s52, -v51
    v_fma_f32 v37, v37, s52, -v48
    v_fma_f32 v45, v45, s52, -v49
    v_fma_f32 v21, v21, s52, -v50
    v_fma_f32 v29, v29, s52, -v51
    v_fma_f32 v38, v38, s52, -v48
    v_fma_f32 v46, v46, s52, -v49
    v_fma_f32 v22, v22, s52, -v50
    v_fma_f32 v30, v30, s52, -v51
    v_fma_f32 v39, v39, s52, -v48
    v_fma_f32 v47, v47, s52, -v49
    v_fma_f32 v23, v23, s52, -v50
    v_fma_f32 v31, v31, s52, -v51
    v_exp_f32 v32, v32
    v_exp_f32 v40, v40
    v_exp_f32 v16, v16
    v_exp_f32 v24, v24
    v_exp_f32 v33, v33
    v_exp_f32 v41, v41
    v_exp_f32 v17, v17
    v_exp_f32 v25, v25
    v_exp_f32 v34, v34
    v_exp_f32 v42, v42
    v_exp_f32 v18, v18
    v_exp_f32 v26, v26
    v_exp_f32 v35, v35
    v_exp_f32 v43, v43
    v_exp_f32 v19, v19
    v_exp_f32 v27, v27
    v_exp_f32 v36, v36
    v_exp_f32 v44, v44
    v_exp_f32 v20, v20
    v_exp_f32 v28, v28
    v_exp_f32 v37, v37
    v_exp_f32 v45, v45
    v_exp_f32 v21, v21
    v_exp_f32 v29, v29
    v_exp_f32 v38, v38
    v_exp_f32 v46, v46
    v_exp_f32 v22, v22
    v_exp_f32 v30, v30
    v_exp_f32 v39, v39
    v_exp_f32 v47, v47
    v_exp_f32 v23, v23
    v_exp_f32 v31, v31
    v_cvt_pk_bf16_f32 v56, v32, v33
    v_cvt_pk_bf16_f32 v60, v40, v41
    v_cvt_pk_bf16_f32 v64, v16, v17
    v_cvt_pk_bf16_f32 v68, v24, v25
    v_cvt_pk_bf16_f32 v57, v34, v35
    v_cvt_pk_bf16_f32 v61, v42, v43
    v_cvt_pk_bf16_f32 v65, v18, v19
    v_cvt_pk_bf16_f32 v69, v26, v27
    v_cvt_pk_bf16_f32 v58, v36, v37
    v_cvt_pk_bf16_f32 v62, v44, v45
    v_cvt_pk_bf16_f32 v66, v20, v21
    v_cvt_pk_bf16_f32 v70, v28, v29
    v_cvt_pk_bf16_f32 v59, v38, v39
    v_cvt_pk_bf16_f32 v63, v46, v47
    v_cvt_pk_bf16_f32 v67, v22, v23
    v_cvt_pk_bf16_f32 v71, v30, v31
    v_mfma_f32_16x16x32_bf16 v[188:191], v[12:15], v[56:59], 0
    v_mfma_f32_16x16x32_bf16 v[180:183], v[108:111], v[56:59], 0
    v_mfma_f32_16x16x32_bf16 v[184:187], v[120:123], v[56:59], 0
    v_mfma_f32_16x16x32_bf16 v[200:203], v[12:15], v[60:63], 0
    v_mfma_f32_16x16x32_bf16 v[192:195], v[114:117], v[60:63], 0
    v_mfma_f32_16x16x32_bf16 v[196:199], v[120:123], v[60:63], 0
    v_mfma_f32_16x16x32_bf16 v[212:215], v[12:15], v[64:67], 0
    s_waitcnt lgkmcnt(2)
    v_mfma_f32_16x16x32_bf16 v[204:207], v[106:109], v[64:67], 0
    s_waitcnt lgkmcnt(0)
    v_mfma_f32_16x16x32_bf16 v[208:211], v[118:121], v[64:67], 0
    v_mfma_f32_16x16x32_bf16 v[224:227], v[12:15], v[68:71], 0
    v_mfma_f32_16x16x32_bf16 v[216:219], v[112:115], v[68:71], 0
    v_mfma_f32_16x16x32_bf16 v[220:223], v[118:121], v[68:71], 0
    s_lshl_b32 s53, s46, 4
    s_add_u32 s53, s53, s45
    s_lshl_b32 s54, s53, 10
    s_add_u32 s54, s54, 23330816
    s_lshl_b32 s55, s53, 7
    s_add_u32 s55, s55, 25427840
    v_lshlrev_b32 v6, 3, v1
    v_rcp_f32 v188, v188
    v_rcp_f32 v200, v200
    v_rcp_f32 v212, v212
    v_rcp_f32 v224, v224
    v_mul_f32 v180, v180, v188
    v_mul_f32 v181, v181, v188
    v_mul_f32 v182, v182, v188
    v_mul_f32 v183, v183, v188
    v_mul_f32 v184, v184, v188
    v_mul_f32 v185, v185, v188
    v_cvt_pk_bf16_f32 v76, v180, v181
    v_cvt_pk_bf16_f32 v77, v182, v183
    v_cvt_pk_bf16_f32 v82, v184, v185
    v_mul_f32 v192, v192, v200
    v_mul_f32 v193, v193, v200
    v_mul_f32 v194, v194, v200
    v_mul_f32 v195, v195, v200
    v_mul_f32 v198, v198, v200
    v_mul_f32 v199, v199, v200
    v_cvt_pk_bf16_f32 v78, v192, v193
    v_cvt_pk_bf16_f32 v79, v194, v195
    v_cvt_pk_bf16_f32 v83, v198, v199
    s_add_u32 s53, s54, 16384
    buffer_store_dwordx4 v[76:79], v2, s[4:7], s53 offen sc1
    v_mul_f32 v204, v204, v212
    v_mul_f32 v205, v205, v212
    v_mul_f32 v206, v206, v212
    v_mul_f32 v207, v207, v212
    v_mul_f32 v208, v208, v212
    v_mul_f32 v209, v209, v212
    v_cvt_pk_bf16_f32 v72, v204, v205
    v_cvt_pk_bf16_f32 v73, v206, v207
    v_cvt_pk_bf16_f32 v80, v208, v209
    v_mul_f32 v216, v216, v224
    v_mul_f32 v217, v217, v224
    v_mul_f32 v218, v218, v224
    v_mul_f32 v219, v219, v224
    v_mul_f32 v222, v222, v224
    v_mul_f32 v223, v223, v224
    v_cvt_pk_bf16_f32 v74, v216, v217
    v_cvt_pk_bf16_f32 v75, v218, v219
    v_cvt_pk_bf16_f32 v81, v222, v223
    s_add_u32 s53, s54, 0
    buffer_store_dwordx4 v[72:75], v2, s[4:7], s53 offen sc1
    s_mov_b32 exec_lo, 0xffff0000
    s_mov_b32 exec_hi, 0
    buffer_store_dwordx2 v[80:81], v6, s[4:7], s55 offen offset:0 sc1
    buffer_store_dwordx2 v[82:83], v6, s[4:7], s55 offen offset:2048 sc1
    s_mov_b64 exec, -1
    s_lshl_b32 s52, s44, 2
    s_add_u32 s52, s52, s20
    s_lshl_b32 s52, s52, 4
    s_add_u32 s52, s52, s45
    s_lshl_b32 s52, s52, 3
    s_add_u32 s52, s52, 3948544
    s_mul_i32 s53, s22, 10923
    s_lshr_b32 s53, s53, 16
    s_mul_i32 s53, s53, 6
    s_sub_u32 s53, s22, s53
    s_lshl_b32 s53, s53, 8
    s_add_u32 s23, s53, 4067328
    v_min_u32 v13, 17, v1
    v_lshlrev_b32 v13, 3, v13
    buffer_load_dwordx2 v[14:15], v13, s[4:7], s23 offen sc1
    v_mov_b32 v8, s98
    v_mov_b32 v9, s99
    s_waitcnt vmcnt(1)
    s_mov_b64 exec, 1
    buffer_store_dwordx2 v[8:9], off, s[4:7], s52 sc1
    s_mov_b64 exec, -1
    s_mov_b64 exec, 1
    buffer_store_dwordx2 v[8:9], off, s[4:7], s0 sc1
    s_mov_b64 exec, -1
    s_cmp_ge_u32 s22, 24
    s_cbranch_scc1 L_idle0_48
    s_mul_i32 s44, s22, 10923
    s_lshr_b32 s44, s44, 16
    s_mul_i32 s52, s44, 6
    s_sub_u32 s45, s22, s52
    s_lshl_b32 s52, s21, 2
    s_add_u32 s44, s44, s52
    s_lshl_b32 s46, s44, 2
    s_add_u32 s46, s46, s20
    s_mul_i32 s47, s45, 110592
    s_mul_i32 s48, s20, 3072
    s_add_u32 s47, s47, s48
    s_add_u32 s47, s47, 2097152
    s_lshl_b32 s49, s46, 14
    s_add_u32 s49, s49, 23330816
    s_lshl_b32 s50, s46, 11
    s_add_u32 s50, s50, 25427968
    v_and_b32 v3, 15, v1
    v_lshrrev_b32 v4, 4, v1
    v_lshlrev_b32 v5, 3, v3
    v_lshl_add_u32 v5, v4, 8, v5
    s_lshl_b32 s52, s46, 4
    v_add_u32 v6, s52, v3
    v_lshlrev_b32 v7, 3, v6
    v_mul_u32_u24 v6, 1152, v6
    v_lshl_add_u32 v6, v4, 4, v6
    s_mul_i32 s51, s45, 192
    s_mov_b32 s8, s24
    s_mov_b32 s9, s25
    s_mov_b32 s10, 0x240000
    s_mov_b32 s11, 0x20000
    s_waitcnt vmcnt(2)
    v_cmp_eq_u64 vcc, s[98:99], v[14:15]
    s_nop 0
    s_cmp_eq_u64 vcc, exec
    s_cbranch_scc0 L_pwo_slow_40
L_pwo_back_41:
    s_mov_b32 m0, s48
    s_nop 0
    buffer_load_dwordx4 v2, s[4:7], s47 offen offset:0 lds
    buffer_load_dwordx4 v2, s[4:7], s47 offen offset:1024 lds
    buffer_load_dwordx4 v2, s[4:7], s47 offen offset:2048 lds
    s_add_u32 s48, s48, 12288
    s_add_u32 s47, s47, 12288
    s_mov_b32 m0, s48
    s_nop 0
    buffer_load_dwordx4 v2, s[4:7], s47 offen offset:0 lds
    buffer_load_dwordx4 v2, s[4:7], s47 offen offset:1024 lds
    buffer_load_dwordx4 v2, s[4:7], s47 offen offset:2048 lds
    s_add_u32 s48, s48, 12288
    s_add_u32 s47, s47, 12288
    s_mov_b32 m0, s48
    s_nop 0
    buffer_load_dwordx4 v2, s[4:7], s47 offen offset:0 lds
    buffer_load_dwordx4 v2, s[4:7], s47 offen offset:1024 lds
    buffer_load_dwordx4 v2, s[4:7], s47 offen offset:2048 lds
    s_add_u32 s48, s48, 12288
    s_add_u32 s47, s47, 12288
    s_mov_b32 m0, s48
    s_nop 0
    buffer_load_dwordx4 v2, s[4:7], s47 offen offset:0 lds
    buffer_load_dwordx4 v2, s[4:7], s47 offen offset:1024 lds
    buffer_load_dwordx4 v2, s[4:7], s47 offen offset:2048 lds
    s_add_u32 s48, s48, 12288
    s_add_u32 s47, s47, 12288
    s_mov_b32 m0, s48
    s_nop 0
    buffer_load_dwordx4 v2, s[4:7], s47 offen offset:0 lds
    buffer_load_dwordx4 v2, s[4:7], s47 offen offset:1024 lds
    buffer_load_dwordx4 v2, s[4:7], s47 offen offset:2048 lds
    s_add_u32 s48, s48, 12288
    s_add_u32 s47, s47, 12288
    s_mov_b32 m0, s48
    s_nop 0
    buffer_load_dwordx4 v2, s[4:7], s47 offen offset:0 lds
    buffer_load_dwordx4 v2, s[4:7], s47 offen offset:1024 lds
    buffer_load_dwordx4 v2, s[4:7], s47 offen offset:2048 lds
    s_add_u32 s48, s48, 12288
    s_add_u32 s47, s47, 12288
    s_mov_b32 m0, s48
    s_nop 0
    buffer_load_dwordx4 v2, s[4:7], s47 offen offset:0 lds
    buffer_load_dwordx4 v2, s[4:7], s47 offen offset:1024 lds
    buffer_load_dwordx4 v2, s[4:7], s47 offen offset:2048 lds
    s_add_u32 s48, s48, 12288
    s_add_u32 s47, s47, 12288
    s_mov_b32 m0, s48
    s_nop 0
    buffer_load_dwordx4 v2, s[4:7], s47 offen offset:0 lds
    buffer_load_dwordx4 v2, s[4:7], s47 offen offset:1024 lds
    buffer_load_dwordx4 v2, s[4:7], s47 offen offset:2048 lds
    s_add_u32 s48, s48, 12288
    s_add_u32 s47, s47, 12288
    s_mov_b32 m0, s48
    s_nop 0
    buffer_load_dwordx4 v2, s[4:7], s47 offen offset:0 lds
    buffer_load_dwordx4 v2, s[4:7], s47 offen offset:1024 lds
    buffer_load_dwordx4 v2, s[4:7], s47 offen offset:2048 lds
    s_add_u32 s48, s48, 12288
    s_add_u32 s47, s47, 12288
    s_lshr_b32 s52, s46, 1
    s_lshl_b32 s52, s52, 7
    s_add_u32 s52, s52, 3948544
    v_and_b32 v10, 15, v1
    v_lshlrev_b32 v10, 3, v10
    s_mul_i32 s53, s45, 2816
    s_min_u32 s53, s53, 13568
    s_add_u32 s53, s53, s49
    buffer_load_dwordx4 v[160:163], v6, s[8:11], s51 offen offset:0
    buffer_load_dwordx4 v[164:167], v6, s[8:11], s51 offen offset:64
    buffer_load_dwordx4 v[168:171], v6, s[8:11], s51 offen offset:128
    v_mov_b32 v8, v2
    s_waitcnt vmcnt(3)
    s_barrier
    buffer_load_dwordx2 v[12:13], v10, s[4:7], s52 offen sc1
    ds_read_b128 a[0:3], v8 offset:0
    ds_read_b128 a[4:7], v8 offset:1024
    ds_read_b128 a[8:11], v8 offset:2048
    ds_read_b128 a[12:15], v8 offset:3072
    ds_read_b128 a[16:19], v8 offset:4096
    ds_read_b128 a[20:23], v8 offset:5120
    ds_read_b128 a[24:27], v8 offset:6144
    ds_read_b128 a[28:31], v8 offset:7168
    ds_read_b128 a[32:35], v8 offset:8192
    ds_read_b128 a[36:39], v8 offset:9216
    ds_read_b128 a[40:43], v8 offset:10240
    ds_read_b128 a[44:47], v8 offset:11264
    ds_read_b128 a[48:51], v8 offset:12288
    ds_read_b128 a[52:55], v8 offset:13312
    ds_read_b128 a[56:59], v8 offset:14336
    ds_read_b128 a[60:63], v8 offset:15360
    ds_read_b128 a[64:67], v8 offset:16384
    ds_read_b128 a[68:71], v8 offset:17408
    ds_read_b128 a[72:75], v8 offset:18432
    ds_read_b128 a[76:79], v8 offset:19456
    ds_read_b128 a[80:83], v8 offset:20480
    ds_read_b128 a[84:87], v8 offset:21504
    ds_read_b128 a[88:91], v8 offset:22528
    ds_read_b128 a[92:95], v8 offset:23552
    ds_read_b128 v[112:115], v8 offset:24576
    ds_read_b128 v[116:119], v8 offset:25600
    ds_read_b128 v[120:123], v8 offset:26624
    ds_read_b128 v[124:127], v8 offset:27648
    ds_read_b128 v[128:131], v8 offset:28672
    ds_read_b128 v[132:135], v8 offset:29696
    ds_read_b128 v[136:139], v8 offset:30720
    ds_read_b128 v[140:143], v8 offset:31744
    ds_read_b128 v[144:147], v8 offset:32768
    ds_read_b128 v[148:151], v8 offset:33792
    s_waitcnt vmcnt(0)
    v_cmp_eq_u64 vcc, s[98:99], v[12:13]
    s_nop 0
    s_cmp_eq_u64 vcc, exec
    s_cbranch_scc0 L_po_slow_55
L_po_back_56:
    buffer_load_dwordx4 v[16:19], v2, s[4:7], s49 offen offset:0 sc1
    buffer_load_dwordx4 v[20:23], v2, s[4:7], s49 offen offset:1024 sc1
    buffer_load_dwordx4 v[24:27], v2, s[4:7], s49 offen offset:2048 sc1
    buffer_load_dwordx4 v[28:31], v2, s[4:7], s49 offen offset:3072 sc1
    s_add_u32 s49, s49, 4096
    buffer_load_dwordx4 v[32:35], v2, s[4:7], s49 offen offset:0 sc1
    buffer_load_dwordx4 v[36:39], v2, s[4:7], s49 offen offset:1024 sc1
    buffer_load_dwordx4 v[40:43], v2, s[4:7], s49 offen offset:2048 sc1
    buffer_load_dwordx4 v[44:47], v2, s[4:7], s49 offen offset:3072 sc1
    s_waitcnt vmcnt(7) lgkmcnt(15)
    s_add_u32 s49, s49, 4096
    v_mfma_f32_16x16x32_bf16 v[88:91], a[0:3], v[16:19], 0
    buffer_load_dwordx4 v[48:51], v2, s[4:7], s49 offen offset:0 sc1
    s_waitcnt lgkmcnt(15)
    v_mfma_f32_16x16x32_bf16 v[92:95], a[4:7], v[16:19], 0
    s_waitcnt lgkmcnt(15)
    v_mfma_f32_16x16x32_bf16 v[96:99], a[8:11], v[16:19], 0
    s_waitcnt lgkmcnt(15)
    v_mfma_f32_16x16x32_bf16 v[100:103], a[12:15], v[16:19], 0
    buffer_load_dwordx4 v[52:55], v2, s[4:7], s49 offen offset:1024 sc1
    s_waitcnt lgkmcnt(15)
    v_mfma_f32_16x16x32_bf16 v[104:107], a[16:19], v[16:19], 0
    s_waitcnt lgkmcnt(15)
    v_mfma_f32_16x16x32_bf16 v[108:111], a[20:23], v[16:19], 0
    s_waitcnt vmcnt(8) lgkmcnt(15)
    v_mfma_f32_16x16x32_bf16 v[88:91], a[24:27], v[20:23], v[88:91]
    buffer_load_dwordx4 v[56:59], v2, s[4:7], s49 offen offset:2048 sc1
    s_waitcnt lgkmcnt(15)
    v_mfma_f32_16x16x32_bf16 v[92:95], a[28:31], v[20:23], v[92:95]
    s_waitcnt lgkmcnt(15)
    v_mfma_f32_16x16x32_bf16 v[96:99], a[32:35], v[20:23], v[96:99]
    s_waitcnt lgkmcnt(15)
    v_mfma_f32_16x16x32_bf16 v[100:103], a[36:39], v[20:23], v[100:103]
    buffer_load_dwordx4 v[60:63], v2, s[4:7], s49 offen offset:3072 sc1
    s_waitcnt lgkmcnt(15)
    v_mfma_f32_16x16x32_bf16 v[104:107], a[40:43], v[20:23], v[104:107]
    s_waitcnt lgkmcnt(15)
    s_add_u32 s49, s49, 4096
    v_mfma_f32_16x16x32_bf16 v[108:111], a[44:47], v[20:23], v[108:111]
    s_waitcnt vmcnt(9) lgkmcnt(15)
    v_mfma_f32_16x16x32_bf16 v[88:91], a[48:51], v[24:27], v[88:91]
    buffer_load_dwordx4 v[64:67], v2, s[4:7], s49 offen offset:0 sc1
    s_waitcnt lgkmcnt(15)
    v_mfma_f32_16x16x32_bf16 v[92:95], a[52:55], v[24:27], v[92:95]
    s_waitcnt lgkmcnt(15)
    v_mfma_f32_16x16x32_bf16 v[96:99], a[56:59], v[24:27], v[96:99]
    s_waitcnt lgkmcnt(15)
    v_mfma_f32_16x16x32_bf16 v[100:103], a[60:63], v[24:27], v[100:103]
    buffer_load_dwordx4 v[68:71], v2, s[4:7], s49 offen offset:1024 sc1
    s_waitcnt lgkmcnt(15)
    v_mfma_f32_16x16x32_bf16 v[104:107], a[64:67], v[24:27], v[104:107]
    s_waitcnt lgkmcnt(15)
    v_mfma_f32_16x16x32_bf16 v[108:111], a[68:71], v[24:27], v[108:111]
    s_waitcnt vmcnt(10) lgkmcnt(15)
    v_mfma_f32_16x16x32_bf16 v[88:91], a[72:75], v[28:31], v[88:91]
    buffer_load_dwordx4 v[72:75], v2, s[4:7], s49 offen offset:2048 sc1
    s_waitcnt lgkmcnt(14)
    v_mfma_f32_16x16x32_bf16 v[92:95], a[76:79], v[28:31], v[92:95]
    s_waitcnt lgkmcnt(13)
    v_mfma_f32_16x16x32_bf16 v[96:99], a[80:83], v[28:31], v[96:99]
    s_waitcnt lgkmcnt(12)
    v_mfma_f32_16x16x32_bf16 v[100:103], a[84:87], v[28:31], v[100:103]
    buffer_load_dwordx4 v[76:79], v2, s[4:7], s49 offen offset:3072 sc1
    s_waitcnt lgkmcnt(11)
    v_mfma_f32_16x16x32_bf16 v[104:107], a[88:91], v[28:31], v[104:107]
    s_waitcnt lgkmcnt(10)
    v_mfma_f32_16x16x32_bf16 v[108:111], a[92:95], v[28:31], v[108:111]
    s_waitcnt vmcnt(11) lgkmcnt(9)
    v_mfma_f32_16x16x32_bf16 v[88:91], v[112:115], v[32:35], v[88:91]
    s_waitcnt lgkmcnt(8)
    ds_read_b128 v[152:155], v8 offset:34816
    v_mfma_f32_16x16x32_bf16 v[92:95], v[116:119], v[32:35], v[92:95]
    s_waitcnt lgkmcnt(8)
    ds_read_b128 v[156:159], v8 offset:35840
    v_mfma_f32_16x16x32_bf16 v[96:99], v[120:123], v[32:35], v[96:99]
    s_waitcnt lgkmcnt(8)
    ds_read_b128 v[112:115], v8 offset:36864
    v_mfma_f32_16x16x32_bf16 v[100:103], v[124:127], v[32:35], v[100:103]
    s_waitcnt lgkmcnt(8)
    ds_read_b128 v[116:119], v8 offset:37888
    v_mfma_f32_16x16x32_bf16 v[104:107], v[128:131], v[32:35], v[104:107]
    s_waitcnt lgkmcnt(8)
    ds_read_b128 v[120:123], v8 offset:38912
    v_mfma_f32_16x16x32_bf16 v[108:111], v[132:135], v[32:35], v[108:111]
    s_waitcnt vmcnt(10) lgkmcnt(8)
    ds_read_b128 v[124:127], v8 offset:39936
    v_mfma_f32_16x16x32_bf16 v[88:91], v[136:139], v[36:39], v[88:91]
    s_waitcnt lgkmcnt(8)
    ds_read_b128 v[128:131], v8 offset:40960
    v_mfma_f32_16x16x32_bf16 v[92:95], v[140:143], v[36:39], v[92:95]
    s_waitcnt lgkmcnt(8)
    ds_read_b128 v[132:135], v8 offset:41984
    v_mfma_f32_16x16x32_bf16 v[96:99], v[144:147], v[36:39], v[96:99]
    s_waitcnt lgkmcnt(8)
    ds_read_b128 v[136:139], v8 offset:43008
    v_mfma_f32_16x16x32_bf16 v[100:103], v[148:151], v[36:39], v[100:103]
    s_waitcnt lgkmcnt(8)
    ds_read_b128 v[140:143], v8 offset:44032
    v_mfma_f32_16x16x32_bf16 v[104:107], v[152:155], v[36:39], v[104:107]
    s_waitcnt lgkmcnt(8)
    ds_read_b128 v[144:147], v8 offset:45056
    v_mfma_f32_16x16x32_bf16 v[108:111], v[156:159], v[36:39], v[108:111]
    s_waitcnt vmcnt(9) lgkmcnt(8)
    ds_read_b128 v[148:151], v8 offset:46080
    v_mfma_f32_16x16x32_bf16 v[88:91], v[112:115], v[40:43], v[88:91]
    s_waitcnt lgkmcnt(8)
    ds_read_b128 v[152:155], v8 offset:47104
    v_mfma_f32_16x16x32_bf16 v[92:95], v[116:119], v[40:43], v[92:95]
    s_waitcnt lgkmcnt(8)
    ds_read_b128 v[156:159], v8 offset:48128
    v_mfma_f32_16x16x32_bf16 v[96:99], v[120:123], v[40:43], v[96:99]
    s_waitcnt lgkmcnt(8)
    ds_read_b128 v[112:115], v8 offset:49152
    v_mfma_f32_16x16x32_bf16 v[100:103], v[124:127], v[40:43], v[100:103]
    s_waitcnt lgkmcnt(8)
    ds_read_b128 v[116:119], v8 offset:50176
    v_mfma_f32_16x16x32_bf16 v[104:107], v[128:131], v[40:43], v[104:107]
    s_waitcnt lgkmcnt(8)
    ds_read_b128 v[120:123], v8 offset:51200
    v_mfma_f32_16x16x32_bf16 v[108:111], v[132:135], v[40:43], v[108:111]
    s_waitcnt vmcnt(8) lgkmcnt(8)
    ds_read_b128 v[124:127], v8 offset:52224
    v_mfma_f32_16x16x32_bf16 v[88:91], v[136:139], v[44:47], v[88:91]
    s_waitcnt lgkmcnt(8)
    ds_read_b128 v[128:131], v8 offset:53248
    v_mfma_f32_16x16x32_bf16 v[92:95], v[140:143], v[44:47], v[92:95]
    s_waitcnt lgkmcnt(8)
    ds_read_b128 v[132:135], v8 offset:54272
    v_mfma_f32_16x16x32_bf16 v[96:99], v[144:147], v[44:47], v[96:99]
    s_waitcnt lgkmcnt(8)
    ds_read_b128 v[136:139], v8 offset:55296
    v_mfma_f32_16x16x32_bf16 v[100:103], v[148:151], v[44:47], v[100:103]
    s_waitcnt lgkmcnt(8)
    ds_read_b128 v[140:143], v8 offset:56320
    v_mfma_f32_16x16x32_bf16 v[104:107], v[152:155], v[44:47], v[104:107]
    s_waitcnt lgkmcnt(8)
    ds_read_b128 v[144:147], v8 offset:57344
    v_mfma_f32_16x16x32_bf16 v[108:111], v[156:159], v[44:47], v[108:111]
    s_waitcnt vmcnt(7) lgkmcnt(8)
    ds_read_b128 v[148:151], v8 offset:58368
    v_mfma_f32_16x16x32_bf16 v[88:91], v[112:115], v[48:51], v[88:91]
    s_waitcnt lgkmcnt(8)
    ds_read_b128 v[152:155], v8 offset:59392
    v_mfma_f32_16x16x32_bf16 v[92:95], v[116:119], v[48:51], v[92:95]
    s_waitcnt lgkmcnt(8)
    ds_read_b128 v[156:159], v8 offset:60416
    v_mfma_f32_16x16x32_bf16 v[96:99], v[120:123], v[48:51], v[96:99]
    s_waitcnt lgkmcnt(8)
    v_add_u32 v8, 61440, v8
    ds_read_b128 v[112:115], v8 offset:0
    v_mfma_f32_16x16x32_bf16 v[100:103], v[124:127], v[48:51], v[100:103]
    s_waitcnt lgkmcnt(8)
    ds_read_b128 v[116:119], v8 offset:1024
    v_mfma_f32_16x16x32_bf16 v[104:107], v[128:131], v[48:51], v[104:107]
    s_waitcnt lgkmcnt(8)
    ds_read_b128 v[120:123], v8 offset:2048
    v_mfma_f32_16x16x32_bf16 v[108:111], v[132:135], v[48:51], v[108:111]
    s_waitcnt vmcnt(6) lgkmcnt(8)
    ds_read_b128 v[124:127], v8 offset:3072
    v_mfma_f32_16x16x32_bf16 v[88:91], v[136:139], v[52:55], v[88:91]
    s_waitcnt lgkmcnt(8)
    ds_read_b128 v[128:131], v8 offset:4096
    v_mfma_f32_16x16x32_bf16 v[92:95], v[140:143], v[52:55], v[92:95]
    s_waitcnt lgkmcnt(8)
    ds_read_b128 v[132:135], v8 offset:5120
    v_mfma_f32_16x16x32_bf16 v[96:99], v[144:147], v[52:55], v[96:99]
    s_waitcnt lgkmcnt(8)
    ds_read_b128 v[136:139], v8 offset:6144
    v_mfma_f32_16x16x32_bf16 v[100:103], v[148:151], v[52:55], v[100:103]
    s_waitcnt lgkmcnt(8)
    ds_read_b128 v[140:143], v8 offset:7168
    v_mfma_f32_16x16x32_bf16 v[104:107], v[152:155], v[52:55], v[104:107]
    s_waitcnt lgkmcnt(8)
    ds_read_b128 v[144:147], v8 offset:8192
    v_mfma_f32_16x16x32_bf16 v[108:111], v[156:159], v[52:55], v[108:111]
    s_waitcnt vmcnt(5) lgkmcnt(8)
    ds_read_b128 v[148:151], v8 offset:9216
    v_mfma_f32_16x16x32_bf16 v[88:91], v[112:115], v[56:59], v[88:91]
    s_waitcnt lgkmcnt(8)
    ds_read_b128 v[152:155], v8 offset:10240
    v_mfma_f32_16x16x32_bf16 v[92:95], v[116:119], v[56:59], v[92:95]
    s_waitcnt lgkmcnt(8)
    ds_read_b128 v[156:159], v8 offset:11264
    v_mfma_f32_16x16x32_bf16 v[96:99], v[120:123], v[56:59], v[96:99]
    s_waitcnt lgkmcnt(8)
    ds_read_b128 v[112:115], v8 offset:12288
    v_mfma_f32_16x16x32_bf16 v[100:103], v[124:127], v[56:59], v[100:103]
    s_waitcnt lgkmcnt(8)
    ds_read_b128 v[116:119], v8 offset:13312
    v_mfma_f32_16x16x32_bf16 v[104:107], v[128:131], v[56:59], v[104:107]
    s_waitcnt lgkmcnt(8)
    ds_read_b128 v[120:123], v8 offset:14336
    v_mfma_f32_16x16x32_bf16 v[108:111], v[132:135], v[56:59], v[108:111]
    ds_read_b128 v[124:127], v8 offset:15360
    buffer_load_dwordx2 v[80:81], v5, s[4:7], s50 offen offset:0 sc1
    buffer_load_dwordx2 v[82:83], v5, s[4:7], s50 offen offset:128 sc1
    s_waitcnt vmcnt(6) lgkmcnt(9)
    v_mfma_f32_16x16x32_bf16 v[88:91], v[136:139], v[60:63], v[88:91]
    s_waitcnt lgkmcnt(8)
    ds_read_b128 v[128:131], v8 offset:16384
    v_mfma_f32_16x16x32_bf16 v[92:95], v[140:143], v[60:63], v[92:95]
    s_waitcnt lgkmcnt(8)
    ds_read_b128 v[132:135], v8 offset:17408
    v_mfma_f32_16x16x32_bf16 v[96:99], v[144:147], v[60:63], v[96:99]
    s_waitcnt lgkmcnt(8)
    ds_read_b128 v[136:139], v8 offset:18432
    v_mfma_f32_16x16x32_bf16 v[100:103], v[148:151], v[60:63], v[100:103]
    s_waitcnt lgkmcnt(8)
    ds_read_b128 v[140:143], v8 offset:19456
    v_mfma_f32_16x16x32_bf16 v[104:107], v[152:155], v[60:63], v[104:107]
    s_waitcnt lgkmcnt(8)
    ds_read_b128 v[144:147], v8 offset:20480
    v_mfma_f32_16x16x32_bf16 v[108:111], v[156:159], v[60:63], v[108:111]
    ds_read_b128 v[148:151], v8 offset:21504
    buffer_load_dwordx2 v[84:85], v5, s[4:7], s50 offen offset:1024 sc1
    buffer_load_dwordx2 v[86:87], v5, s[4:7], s50 offen offset:1152 sc1
    s_waitcnt vmcnt(7) lgkmcnt(9)
    v_mfma_f32_16x16x32_bf16 v[88:91], v[112:115], v[64:67], v[88:91]
    s_waitcnt lgkmcnt(8)
    ds_read_b128 v[152:155], v8 offset:22528
    v_mfma_f32_16x16x32_bf16 v[92:95], v[116:119], v[64:67], v[92:95]
    s_waitcnt lgkmcnt(8)
    ds_read_b128 v[156:159], v8 offset:23552
    v_mfma_f32_16x16x32_bf16 v[96:99], v[120:123], v[64:67], v[96:99]
    s_waitcnt lgkmcnt(8)
    ds_read_b128 v[112:115], v8 offset:24576
    v_mfma_f32_16x16x32_bf16 v[100:103], v[124:127], v[64:67], v[100:103]
    s_waitcnt lgkmcnt(8)
    ds_read_b128 v[116:119], v8 offset:25600
    v_mfma_f32_16x16x32_bf16 v[104:107], v[128:131], v[64:67], v[104:107]
    s_waitcnt lgkmcnt(8)
    ds_read_b128 v[120:123], v8 offset:26624
    v_mfma_f32_16x16x32_bf16 v[108:111], v[132:135], v[64:67], v[108:111]
    s_waitcnt vmcnt(6) lgkmcnt(8)
    ds_read_b128 v[124:127], v8 offset:27648
    v_mfma_f32_16x16x32_bf16 v[88:91], v[136:139], v[68:71], v[88:91]
    s_waitcnt lgkmcnt(8)
    ds_read_b128 v[128:131], v8 offset:28672
    v_mfma_f32_16x16x32_bf16 v[92:95], v[140:143], v[68:71], v[92:95]
    s_waitcnt lgkmcnt(8)
    ds_read_b128 v[132:135], v8 offset:29696
    v_mfma_f32_16x16x32_bf16 v[96:99], v[144:147], v[68:71], v[96:99]
    s_waitcnt lgkmcnt(8)
    ds_read_b128 v[136:139], v8 offset:30720
    v_mfma_f32_16x16x32_bf16 v[100:103], v[148:151], v[68:71], v[100:103]
    s_waitcnt lgkmcnt(8)
    ds_read_b128 v[140:143], v8 offset:31744
    v_mfma_f32_16x16x32_bf16 v[104:107], v[152:155], v[68:71], v[104:107]
    s_waitcnt lgkmcnt(8)
    ds_read_b128 v[144:147], v8 offset:32768
    v_mfma_f32_16x16x32_bf16 v[108:111], v[156:159], v[68:71], v[108:111]
    s_waitcnt vmcnt(5) lgkmcnt(8)
    ds_read_b128 v[148:151], v8 offset:33792
    v_mfma_f32_16x16x32_bf16 v[88:91], v[112:115], v[72:75], v[88:91]
    s_waitcnt lgkmcnt(8)
    ds_read_b128 v[152:155], v8 offset:34816
    v_mfma_f32_16x16x32_bf16 v[92:95], v[116:119], v[72:75], v[92:95]
    s_waitcnt lgkmcnt(8)
    ds_read_b128 v[156:159], v8 offset:35840
    v_mfma_f32_16x16x32_bf16 v[96:99], v[120:123], v[72:75], v[96:99]
    s_waitcnt lgkmcnt(8)
    ds_read_b128 v[112:115], v8 offset:36864
    v_mfma_f32_16x16x32_bf16 v[100:103], v[124:127], v[72:75], v[100:103]
    s_waitcnt lgkmcnt(8)
    ds_read_b128 v[116:119], v8 offset:37888
    v_mfma_f32_16x16x32_bf16 v[104:107], v[128:131], v[72:75], v[104:107]
    s_waitcnt lgkmcnt(8)
    ds_read_b128 v[120:123], v8 offset:38912
    v_mfma_f32_16x16x32_bf16 v[108:111], v[132:135], v[72:75], v[108:111]
    s_waitcnt vmcnt(4) lgkmcnt(8)
    ds_read_b128 v[124:127], v8 offset:39936
    v_mfma_f32_16x16x32_bf16 v[88:91], v[136:139], v[76:79], v[88:91]
    s_waitcnt lgkmcnt(8)
    ds_read_b128 v[128:131], v8 offset:40960
    v_mfma_f32_16x16x32_bf16 v[92:95], v[140:143], v[76:79], v[92:95]
    s_waitcnt lgkmcnt(8)
    ds_read_b128 v[132:135], v8 offset:41984
    v_mfma_f32_16x16x32_bf16 v[96:99], v[144:147], v[76:79], v[96:99]
    s_waitcnt lgkmcnt(8)
    ds_read_b128 v[136:139], v8 offset:43008
    v_mfma_f32_16x16x32_bf16 v[100:103], v[148:151], v[76:79], v[100:103]
    s_waitcnt lgkmcnt(8)
    ds_read_b128 v[140:143], v8 offset:44032
    v_mfma_f32_16x16x32_bf16 v[104:107], v[152:155], v[76:79], v[104:107]
    s_waitcnt lgkmcnt(8)
    ds_read_b128 v[144:147], v8 offset:45056
    v_mfma_f32_16x16x32_bf16 v[108:111], v[156:159], v[76:79], v[108:111]
    s_waitcnt vmcnt(2) lgkmcnt(8)
    ds_read_b128 v[148:151], v8 offset:46080
    v_mfma_f32_16x16x32_bf16 v[88:91], v[112:115], v[80:83], v[88:91]
    s_waitcnt lgkmcnt(8)
    ds_read_b128 v[152:155], v8 offset:47104
    v_mfma_f32_16x16x32_bf16 v[92:95], v[116:119], v[80:83], v[92:95]
    s_waitcnt lgkmcnt(8)
    ds_read_b128 v[156:159], v8 offset:48128
    v_mfma_f32_16x16x32_bf16 v[96:99], v[120:123], v[80:83], v[96:99]
    s_waitcnt lgkmcnt(8)
    v_mfma_f32_16x16x32_bf16 v[100:103], v[124:127], v[80:83], v[100:103]
    s_waitcnt lgkmcnt(7)
    v_mfma_f32_16x16x32_bf16 v[104:107], v[128:131], v[80:83], v[104:107]
    s_waitcnt lgkmcnt(6)
    v_mfma_f32_16x16x32_bf16 v[108:111], v[132:135], v[80:83], v[108:111]
    s_waitcnt vmcnt(0) lgkmcnt(5)
    v_mfma_f32_16x16x32_bf16 v[88:91], v[136:139], v[84:87], v[88:91]
    s_waitcnt lgkmcnt(4)
    v_mfma_f32_16x16x32_bf16 v[92:95], v[140:143], v[84:87], v[92:95]
    s_waitcnt lgkmcnt(3)
    v_mfma_f32_16x16x32_bf16 v[96:99], v[144:147], v[84:87], v[96:99]
    s_waitcnt lgkmcnt(2)
    v_mfma_f32_16x16x32_bf16 v[100:103], v[148:151], v[84:87], v[100:103]
    s_waitcnt lgkmcnt(1)
    v_mfma_f32_16x16x32_bf16 v[104:107], v[152:155], v[84:87], v[104:107]
    s_waitcnt lgkmcnt(0)
    v_mfma_f32_16x16x32_bf16 v[108:111], v[156:159], v[84:87], v[108:111]
    v_lshlrev_b32 v16, 16, v160
    v_and_b32 v17, 0xffff0000, v160
    v_lshlrev_b32 v18, 16, v161
    v_and_b32 v19, 0xffff0000, v161
    v_lshlrev_b32 v20, 16, v162
    v_and_b32 v21, 0xffff0000, v162
    v_lshlrev_b32 v22, 16, v163
    v_and_b32 v23, 0xffff0000, v163
    v_lshlrev_b32 v24, 16, v164
    v_and_b32 v25, 0xffff0000, v164
    v_lshlrev_b32 v26, 16, v165
    v_and_b32 v27, 0xffff0000, v165
    v_lshlrev_b32 v28, 16, v166
    v_and_b32 v29, 0xffff0000, v166
    v_lshlrev_b32 v30, 16, v167
    v_and_b32 v31, 0xffff0000, v167
    v_lshlrev_b32 v32, 16, v168
    v_and_b32 v33, 0xffff0000, v168
    v_lshlrev_b32 v34, 16, v169
    v_and_b32 v35, 0xffff0000, v169
    v_lshlrev_b32 v36, 16, v170
    v_and_b32 v37, 0xffff0000, v170
    v_lshlrev_b32 v38, 16, v171
    v_and_b32 v39, 0xffff0000, v171
    v_add_f32 v16, v16, v88
    v_add_f32 v17, v17, v89
    v_add_f32 v18, v18, v90
    v_add_f32 v19, v19, v91
    v_add_f32 v20, v20, v92
    v_add_f32 v21, v21, v93
    v_add_f32 v22, v22, v94
    v_add_f32 v23, v23, v95
    v_add_f32 v24, v24, v96
    v_add_f32 v25, v25, v97
    v_add_f32 v26, v26, v98
    v_add_f32 v27, v27, v99
    v_add_f32 v28, v28, v100
    v_add_f32 v29, v29, v101
    v_add_f32 v30, v30, v102
    v_add_f32 v31, v31, v103
    v_add_f32 v32, v32, v104
    v_add_f32 v33, v33, v105
    v_add_f32 v34, v34, v106
    v_add_f32 v35, v35, v107
    v_add_f32 v36, v36, v108
    v_add_f32 v37, v37, v109
    v_add_f32 v38, v38, v110
    v_add_f32 v39, v39, v111
    s_mul_i32 s52, s46, 18
    s_mul_i32 s53, s45, 3
    s_add_u32 s52, s52, s53
    s_lshl_b32 s52, s52, 10
    s_add_u32 s52, s52, 25690112
    v_cvt_pk_bf16_f32 v40, v16, v17
    v_cvt_pk_bf16_f32 v41, v18, v19
    v_cvt_pk_bf16_f32 v42, v20, v21
    v_cvt_pk_bf16_f32 v43, v22, v23
    buffer_store_dwordx4 v[40:43], v2, s[4:7], s52 offen offset:0 sc1
    v_cvt_pk_bf16_f32 v44, v24, v25
    v_cvt_pk_bf16_f32 v45, v26, v27
    v_cvt_pk_bf16_f32 v46, v28, v29
    v_cvt_pk_bf16_f32 v47, v30, v31
    buffer_store_dwordx4 v[44:47], v2, s[4:7], s52 offen offset:1024 sc1
    v_cvt_pk_bf16_f32 v48, v32, v33
    v_cvt_pk_bf16_f32 v49, v34, v35
    v_cvt_pk_bf16_f32 v50, v36, v37
    v_cvt_pk_bf16_f32 v51, v38, v39
    buffer_store_dwordx4 v[48:51], v2, s[4:7], s52 offen offset:2048 sc1
    v_lshlrev_b32 v16, 16, v40
    v_and_b32 v17, 0xffff0000, v40
    v_lshlrev_b32 v18, 16, v41
    v_and_b32 v19, 0xffff0000, v41
    v_lshlrev_b32 v20, 16, v42
    v_and_b32 v21, 0xffff0000, v42
    v_lshlrev_b32 v22, 16, v43
    v_and_b32 v23, 0xffff0000, v43
    v_lshlrev_b32 v24, 16, v44
    v_and_b32 v25, 0xffff0000, v44
    v_lshlrev_b32 v26, 16, v45
    v_and_b32 v27, 0xffff0000, v45
    v_lshlrev_b32 v28, 16, v46
    v_and_b32 v29, 0xffff0000, v46
    v_lshlrev_b32 v30, 16, v47
    v_and_b32 v31, 0xffff0000, v47
    v_lshlrev_b32 v32, 16, v48
    v_and_b32 v33, 0xffff0000, v48
    v_lshlrev_b32 v34, 16, v49
    v_and_b32 v35, 0xffff0000, v49
    v_lshlrev_b32 v36, 16, v50
    v_and_b32 v37, 0xffff0000, v50
    v_lshlrev_b32 v38, 16, v51
    v_and_b32 v39, 0xffff0000, v51
    v_add_f32 v56, v16, v17
    v_add_f32 v58, v18, v19
    v_add_f32 v56, v56, v20
    v_add_f32 v58, v58, v21
    v_add_f32 v56, v56, v22
    v_add_f32 v58, v58, v23
    v_add_f32 v56, v56, v24
    v_add_f32 v58, v58, v25
    v_add_f32 v56, v56, v26
    v_add_f32 v58, v58, v27
    v_add_f32 v56, v56, v28
    v_add_f32 v58, v58, v29
    v_add_f32 v56, v56, v30
    v_add_f32 v58, v58, v31
    v_add_f32 v56, v56, v32
    v_add_f32 v58, v58, v33
    v_add_f32 v56, v56, v34
    v_add_f32 v58, v58, v35
    v_add_f32 v56, v56, v36
    v_add_f32 v58, v58, v37
    v_add_f32 v56, v56, v38
    v_add_f32 v58, v58, v39
    v_add_f32 v56, v56, v58
    v_mov_b32 v58, v56
    s_nop 1
    v_permlane16_swap_b32 v56, v58
    v_add_f32 v56, v56, v58
    v_mov_b32 v58, v56
    s_nop 1
    v_permlane32_swap_b32 v56, v58
    v_add_f32 v56, v56, v58
    v_mul_f32 v59, 0x3c2aaaab, v56
    v_sub_f32 v58, v16, v59
    v_mul_f32 v57, v58, v58
    v_sub_f32 v61, v17, v59
    v_fmac_f32 v57, v61, v61
    v_sub_f32 v60, v18, v59
    v_fmac_f32 v57, v60, v60
    v_sub_f32 v61, v19, v59
    v_fmac_f32 v57, v61, v61
    v_sub_f32 v60, v20, v59
    v_fmac_f32 v57, v60, v60
    v_sub_f32 v61, v21, v59
    v_fmac_f32 v57, v61, v61
    v_sub_f32 v60, v22, v59
    v_fmac_f32 v57, v60, v60
    v_sub_f32 v61, v23, v59
    v_fmac_f32 v57, v61, v61
    v_sub_f32 v60, v24, v59
    v_fmac_f32 v57, v60, v60
    v_sub_f32 v61, v25, v59
    v_fmac_f32 v57, v61, v61
    v_sub_f32 v60, v26, v59
    v_fmac_f32 v57, v60, v60
    v_sub_f32 v61, v27, v59
    v_fmac_f32 v57, v61, v61
    v_sub_f32 v60, v28, v59
    v_fmac_f32 v57, v60, v60
    v_sub_f32 v61, v29, v59
    v_fmac_f32 v57, v61, v61
    v_sub_f32 v60, v30, v59
    v_fmac_f32 v57, v60, v60
    v_sub_f32 v61, v31, v59
    v_fmac_f32 v57, v61, v61
    v_sub_f32 v60, v32, v59
    v_fmac_f32 v57, v60, v60
    v_sub_f32 v61, v33, v59
    v_fmac_f32 v57, v61, v61
    v_sub_f32 v60, v34, v59
    v_fmac_f32 v57, v60, v60
    v_sub_f32 v61, v35, v59
    v_fmac_f32 v57, v61, v61
    v_sub_f32 v60, v36, v59
    v_fmac_f32 v57, v60, v60
    v_sub_f32 v61, v37, v59
    v_fmac_f32 v57, v61, v61
    v_sub_f32 v60, v38, v59
    v_fmac_f32 v57, v60, v60
    v_sub_f32 v61, v39, v59
    v_fmac_f32 v57, v61, v61
    v_mov_b32 v58, v57
    s_nop 1
    v_permlane16_swap_b32 v57, v58
    v_add_f32 v57, v57, v58
    v_mov_b32 v58, v57
    s_nop 1
    v_permlane32_swap_b32 v57, v58
    v_add_f32 v57, v57, v58
    s_lshl_b32 s52, s45, 14
    s_add_u32 s52, s52, 28049408
    s_mov_b32 exec_lo, 0xffff
    s_mov_b32 exec_hi, 0
    buffer_store_dwordx2 v[56:57], v7, s[4:7], s52 offen sc1
    s_mov_b64 exec, -1
    s_lshl_b32 s52, s46, 3
    s_add_u32 s52, s52, s45
    s_lshl_b32 s52, s52, 3
    s_add_u32 s52, s52, 3964928
    s_and_b32 s23, s21, 3
    s_lshl_b32 s23, s23, 3
    s_and_b32 s1, s22, 7
    s_add_u32 s1, s1, s23
    s_lshl_b32 s1, s1, 9
    s_add_u32 s1, s1, 4071424
    v_min_u32 v14, 35, v1
    v_lshlrev_b32 v14, 3, v14
    buffer_load_dwordx2 v[12:13], v14, s[4:7], s1 offen sc1
    v_mov_b32 v8, s98
    v_mov_b32 v9, s99
    s_waitcnt vmcnt(1)
    s_mov_b64 exec, 1
    buffer_store_dwordx2 v[8:9], off, s[4:7], s52 sc1
    s_mov_b64 exec, -1
    s_mov_b32 s0, 0
    s_cmp_lg_u32 s20, 3
    s_cbranch_scc1 L_ffn_49
    s_mul_i32 s55, s20, 9216
    s_add_u32 s55, s55, 110592
    v_add_u32 v64, s55, v2
    ds_write_b128 v64, a[180:183] offset:0
    ds_write_b128 v64, a[184:187] offset:1024
    ds_write_b128 v64, a[188:191] offset:2048
    ds_write_b128 v64, a[192:195] offset:3072
    ds_write_b128 v64, a[196:199] offset:4096
    ds_write_b128 v64, a[200:203] offset:5120
    ds_write_b128 v64, a[204:207] offset:6144
    ds_write_b128 v64, a[208:211] offset:7168
    ds_write_b128 v64, a[212:215] offset:8192
    s_cmp_ge_u32 s30, 1152
    s_cbranch_scc1 L_ud_58
    s_mul_i32 s64, s30, 1821
    s_lshr_b32 s64, s64, 16
    s_mul_i32 s92, s64, 36
    s_sub_u32 s92, s30, s92
    s_and_b32 s93, s92, 1
    s_lshr_b32 s94, s92, 1
    s_mov_b32 s62, 0
    s_mov_b32 s63, 256
    s_mul_i32 s95, s64, 486
    s_add_u32 s95, s95, s92
    s_lshl_b32 s95, s95, 10
    s_add_u32 s69, s95, 4194304
    s_add_u32 s67, s69, 36864
    s_add_u32 s68, s69, 184320
    s_mov_b32 s70, 36864
    s_mov_b32 s71, 73728
    s_lshl_b32 s95, s64, 1
    s_add_u32 s95, s95, s93
    s_mul_i32 s95, s95, 18
    s_add_u32 s95, s95, s94
    s_mul_i32 s95, s95, 576
    s_add_u32 s65, s95, 2883584
    s_mov_b32 s66, s92
    s_branch L_udone_59
L_ud_58:
    s_sub_u32 s92, s30, 1152
    s_mul_i32 s64, s92, 3641
    s_lshr_b32 s64, s64, 16
    s_mul_i32 s93, s64, 18
    s_sub_u32 s92, s92, s93
    s_and_b32 s93, s64, 3
    s_and_b32 s94, s93, 1
    s_mov_b32 s65, 0
    s_lshl_b32 s62, s94, 5
    s_cmp_eq_u32 s94, 0
    s_cselect_b32 s63, 256, 0
    s_add_u32 s66, s92, 36
    s_mul_i32 s95, s64, 486
    s_add_u32 s95, s95, 324
    s_lshl_b32 s95, s95, 10
    s_add_u32 s95, s95, 4194304
    s_cmp_ge_u32 s92, 3
    s_cbranch_scc1 L_ub_60
    s_sub_u32 s96, s92, 0
    s_mov_b32 s70, 1024
    s_mov_b32 s71, 2048
    s_mul_i32 s97, s96, 5120
    s_add_u32 s97, s97, 0
    s_add_u32 s67, s97, s95
    s_mul_i32 s97, s96, 4096
    s_add_u32 s97, s97, 15360
    s_add_u32 s68, s97, s95
    s_mul_i32 s97, s96, 5120
    s_add_u32 s97, s97, 4096
    s_add_u32 s69, s97, s95
    s_branch L_udone_59
L_ub_60:
    s_cmp_ge_u32 s92, 9
    s_cbranch_scc1 L_uc_61
    s_sub_u32 s96, s92, 3
    s_mov_b32 s70, 1024
    s_mov_b32 s71, 2048
    s_mul_i32 s97, s96, 9216
    s_add_u32 s97, s97, 27648
    s_add_u32 s67, s97, s95
    s_mul_i32 s97, s96, 9216
    s_add_u32 s97, s97, 31744
    s_add_u32 s68, s97, s95
    s_mul_i32 s97, s96, 9216
    s_add_u32 s97, s97, 35840
    s_add_u32 s69, s97, s95
    s_branch L_udone_59
L_uc_61:
    s_sub_u32 s96, s92, 9
    s_mov_b32 s70, 1024
    s_mov_b32 s71, 18432
    s_mul_i32 s97, s96, 2048
    s_add_u32 s97, s97, 82944
    s_add_u32 s67, s97, s95
    s_mul_i32 s97, s96, 2048
    s_add_u32 s97, s97, 119808
    s_add_u32 s68, s97, s95
    s_mul_i32 s97, s96, 1024
    s_add_u32 s97, s97, 156672
    s_add_u32 s69, s97, s95
L_udone_59:
    s_lshl_b32 s95, s64, 6
    s_add_u32 s95, s95, s66
    s_lshl_b32 s95, s95, 3
    s_add_u32 s66, s95, 4071424
    v_lshrrev_b32 v64, 4, v1
    v_bfe_u32 v66, v1, 2, 2
    v_lshl_add_u32 v64, v64, 3, v66
    v_mul_u32_u24 v64, 288, v64
    v_add_u32 v64, s55, v64
    v_and_b32 v66, 3, v1
    v_lshl_add_u32 v65, v66, 3, v64
    v_add_u32 v65, s63, v65
    v_lshl_add_u32 v64, v66, 4, v64
    v_add_u32 v64, s62, v64
    ds_read_b64_tr_b16 v[72:73], v64 offset:0
    ds_read_b64_tr_b16 v[74:75], v64 offset:1152
    ds_read_b64_tr_b16 v[76:77], v64 offset:8
    ds_read_b64_tr_b16 v[78:79], v64 offset:1160
    ds_read_b64_tr_b16 v[80:81], v64 offset:64
    ds_read_b64_tr_b16 v[82:83], v64 offset:1216
    ds_read_b64_tr_b16 v[84:85], v64 offset:72
    ds_read_b64_tr_b16 v[86:87], v64 offset:1224
    ds_read_b64_tr_b16 v[88:89], v64 offset:128
    ds_read_b64_tr_b16 v[90:91], v64 offset:1280
    ds_read_b64_tr_b16 v[92:93], v64 offset:136
    ds_read_b64_tr_b16 v[94:95], v64 offset:1288
    ds_read_b64_tr_b16 v[96:97], v64 offset:192
    ds_read_b64_tr_b16 v[98:99], v64 offset:1344
    ds_read_b64_tr_b16 v[100:101], v64 offset:200
    ds_read_b64_tr_b16 v[102:103], v64 offset:1352
    ds_read_b64_tr_b16 v[104:105], v65 offset:0
    ds_read_b64_tr_b16 v[106:107], v65 offset:1152
    s_waitcnt lgkmcnt(15)
    buffer_store_dwordx4 v[72:75], v2, s[4:7], s67 offen sc1
    s_add_u32 s92, s67, s70
    s_waitcnt lgkmcnt(14)
    buffer_store_dwordx4 v[76:79], v2, s[4:7], s92 offen sc1
    s_add_u32 s92, s67, s71
    s_waitcnt lgkmcnt(12)
    buffer_store_dwordx4 v[80:83], v2, s[4:7], s92 offen sc1
    s_add_u32 s92, s92, s70
    s_waitcnt lgkmcnt(10)
    buffer_store_dwordx4 v[84:87], v2, s[4:7], s92 offen sc1
    s_waitcnt lgkmcnt(8)
    buffer_store_dwordx4 v[88:91], v2, s[4:7], s68 offen sc1
    s_add_u32 s92, s68, s70
    s_waitcnt lgkmcnt(6)
    buffer_store_dwordx4 v[92:95], v2, s[4:7], s92 offen sc1
    s_add_u32 s92, s68, s71
    s_waitcnt lgkmcnt(4)
    buffer_store_dwordx4 v[96:99], v2, s[4:7], s92 offen sc1
    s_add_u32 s92, s92, s70
    s_waitcnt lgkmcnt(2)
    buffer_store_dwordx4 v[100:103], v2, s[4:7], s92 offen sc1
    s_waitcnt lgkmcnt(0)
    buffer_store_dwordx4 v[104:107], v2, s[4:7], s69 offen sc1
    s_cmp_eq_u32 s65, 0
    s_cbranch_scc1 L_nocs_62
    v_mov_b32 v68, 0x3f803f80
    v_mov_b32 v69, 0x3f803f80
    v_mov_b32 v70, 0x3f803f80
    v_mov_b32 v71, 0x3f803f80
    s_nop 1
    v_mfma_f32_16x16x32_bf16 v[108:111], v[72:75], v[68:71], 0
    v_mfma_f32_16x16x32_bf16 v[112:115], v[76:79], v[68:71], 0
    v_mfma_f32_16x16x32_bf16 v[116:119], v[80:83], v[68:71], 0
    v_mfma_f32_16x16x32_bf16 v[120:123], v[84:87], v[68:71], 0
    v_mfma_f32_16x16x32_bf16 v[124:127], v[88:91], v[68:71], 0
    v_mfma_f32_16x16x32_bf16 v[128:131], v[92:95], v[68:71], 0
    v_mfma_f32_16x16x32_bf16 v[132:135], v[96:99], v[68:71], 0
    v_mfma_f32_16x16x32_bf16 v[136:139], v[100:103], v[68:71], 0
    v_mfma_f32_16x16x32_bf16 v[140:143], v[104:107], v[68:71], 0
    v_and_b32 v66, 15, v1
    v_add_u32 v67, 1, v66
    v_cmp_gt_u32 vcc, 8, v66
    v_and_b32 v64, 48, v1
    s_nop 0
    v_cndmask_b32 v67, 0, v67, vcc
    v_lshlrev_b32 v67, 6, v67
    v_add_u32 v67, v67, v64
    v_cmp_eq_u32 vcc, 1, v66
    s_nop 1
    v_cndmask_b32 v108, v108, v112, vcc
    v_cndmask_b32 v109, v109, v113, vcc
    v_cndmask_b32 v110, v110, v114, vcc
    v_cndmask_b32 v111, v111, v115, vcc
    v_cmp_eq_u32 vcc, 2, v66
    s_nop 1
    v_cndmask_b32 v108, v108, v116, vcc
    v_cndmask_b32 v109, v109, v117, vcc
    v_cndmask_b32 v110, v110, v118, vcc
    v_cndmask_b32 v111, v111, v119, vcc
    v_cmp_eq_u32 vcc, 3, v66
    s_nop 1
    v_cndmask_b32 v108, v108, v120, vcc
    v_cndmask_b32 v109, v109, v121, vcc
    v_cndmask_b32 v110, v110, v122, vcc
    v_cndmask_b32 v111, v111, v123, vcc
    v_cmp_eq_u32 vcc, 4, v66
    s_nop 1
    v_cndmask_b32 v108, v108, v124, vcc
    v_cndmask_b32 v109, v109, v125, vcc
    v_cndmask_b32 v110, v110, v126, vcc
    v_cndmask_b32 v111, v111, v127, vcc
    v_cmp_eq_u32 vcc, 5, v66
    s_nop 1
    v_cndmask_b32 v108, v108, v128, vcc
    v_cndmask_b32 v109, v109, v129, vcc
    v_cndmask_b32 v110, v110, v130, vcc
    v_cndmask_b32 v111, v111, v131, vcc
    v_cmp_eq_u32 vcc, 6, v66
    s_nop 1
    v_cndmask_b32 v108, v108, v132, vcc
    v_cndmask_b32 v109, v109, v133, vcc
    v_cndmask_b32 v110, v110, v134, vcc
    v_cndmask_b32 v111, v111, v135, vcc
    v_cmp_eq_u32 vcc, 7, v66
    s_nop 1
    v_cndmask_b32 v108, v108, v136, vcc
    v_cndmask_b32 v109, v109, v137, vcc
    v_cndmask_b32 v110, v110, v138, vcc
    v_cndmask_b32 v111, v111, v139, vcc
    v_cmp_eq_u32 vcc, 8, v66
    s_nop 1
    v_cndmask_b32 v108, v108, v140, vcc
    v_cndmask_b32 v109, v109, v141, vcc
    v_cndmask_b32 v110, v110, v142, vcc
    v_cndmask_b32 v111, v111, v143, vcc
    s_mov_b32 exec_lo, 0x01ff01ff
    s_mov_b32 exec_hi, 0x01ff01ff
    buffer_store_dwordx4 v[108:111], v67, s[4:7], s65 offen sc1
    s_mov_b64 exec, -1
L_nocs_62:
    s_mov_b32 s0, s66
    s_branch L_ffn_49
L_idle0_48:
    s_mul_i32 s55, s20, 9216
    s_add_u32 s55, s55, 110592
    v_add_u32 v64, s55, v2
    ds_write_b128 v64, a[180:183] offset:0
    ds_write_b128 v64, a[184:187] offset:1024
    ds_write_b128 v64, a[188:191] offset:2048
    ds_write_b128 v64, a[192:195] offset:3072
    ds_write_b128 v64, a[196:199] offset:4096
    ds_write_b128 v64, a[200:203] offset:5120
    ds_write_b128 v64, a[204:207] offset:6144
    ds_write_b128 v64, a[208:211] offset:7168
    ds_write_b128 v64, a[212:215] offset:8192
    s_cmp_ge_u32 s30, 1152
    s_cbranch_scc1 L_ud_63
    s_mul_i32 s64, s30, 1821
    s_lshr_b32 s64, s64, 16
    s_mul_i32 s92, s64, 36
    s_sub_u32 s92, s30, s92
    s_and_b32 s93, s92, 1
    s_lshr_b32 s94, s92, 1
    s_mov_b32 s62, 0
    s_mov_b32 s63, 256
    s_mul_i32 s95, s64, 486
    s_add_u32 s95, s95, s92
    s_lshl_b32 s95, s95, 10
    s_add_u32 s69, s95, 4194304
    s_add_u32 s67, s69, 36864
    s_add_u32 s68, s69, 184320
    s_mov_b32 s70, 36864
    s_mov_b32 s71, 73728
    s_lshl_b32 s95, s64, 1
    s_add_u32 s95, s95, s93
    s_mul_i32 s95, s95, 18
    s_add_u32 s95, s95, s94
    s_mul_i32 s95, s95, 576
    s_add_u32 s65, s95, 2883584
    s_mov_b32 s66, s92
    s_branch L_udone_64
L_ud_63:
    s_sub_u32 s92, s30, 1152
    s_mul_i32 s64, s92, 3641
    s_lshr_b32 s64, s64, 16
    s_mul_i32 s93, s64, 18
    s_sub_u32 s92, s92, s93
    s_and_b32 s93, s64, 3
    s_and_b32 s94, s93, 1
    s_mov_b32 s65, 0
    s_lshl_b32 s62, s94, 5
    s_cmp_eq_u32 s94, 0
    s_cselect_b32 s63, 256, 0
    s_add_u32 s66, s92, 36
    s_mul_i32 s95, s64, 486
    s_add_u32 s95, s95, 324
    s_lshl_b32 s95, s95, 10
    s_add_u32 s95, s95, 4194304
    s_cmp_ge_u32 s92, 3
    s_cbranch_scc1 L_ub_65
    s_sub_u32 s96, s92, 0
    s_mov_b32 s70, 1024
    s_mov_b32 s71, 2048
    s_mul_i32 s97, s96, 5120
    s_add_u32 s97, s97, 0
    s_add_u32 s67, s97, s95
    s_mul_i32 s97, s96, 4096
    s_add_u32 s97, s97, 15360
    s_add_u32 s68, s97, s95
    s_mul_i32 s97, s96, 5120
    s_add_u32 s97, s97, 4096
    s_add_u32 s69, s97, s95
    s_branch L_udone_64
L_ub_65:
    s_cmp_ge_u32 s92, 9
    s_cbranch_scc1 L_uc_66
    s_sub_u32 s96, s92, 3
    s_mov_b32 s70, 1024
    s_mov_b32 s71, 2048
    s_mul_i32 s97, s96, 9216
    s_add_u32 s97, s97, 27648
    s_add_u32 s67, s97, s95
    s_mul_i32 s97, s96, 9216
    s_add_u32 s97, s97, 31744
    s_add_u32 s68, s97, s95
    s_mul_i32 s97, s96, 9216
    s_add_u32 s97, s97, 35840
    s_add_u32 s69, s97, s95
    s_branch L_udone_64
L_uc_66:
    s_sub_u32 s96, s92, 9
    s_mov_b32 s70, 1024
    s_mov_b32 s71, 18432
    s_mul_i32 s97, s96, 2048
    s_add_u32 s97, s97, 82944
    s_add_u32 s67, s97, s95
    s_mul_i32 s97, s96, 2048
    s_add_u32 s97, s97, 119808
    s_add_u32 s68, s97, s95
    s_mul_i32 s97, s96, 1024
    s_add_u32 s97, s97, 156672
    s_add_u32 s69, s97, s95
L_udone_64:
    s_lshl_b32 s95, s64, 6
    s_add_u32 s95, s95, s66
    s_lshl_b32 s95, s95, 3
    s_add_u32 s66, s95, 4071424
    v_lshrrev_b32 v64, 4, v1
    v_bfe_u32 v66, v1, 2, 2
    v_lshl_add_u32 v64, v64, 3, v66
    v_mul_u32_u24 v64, 288, v64
    v_add_u32 v64, s55, v64
    v_and_b32 v66, 3, v1
    v_lshl_add_u32 v65, v66, 3, v64
    v_add_u32 v65, s63, v65
    v_lshl_add_u32 v64, v66, 4, v64
    v_add_u32 v64, s62, v64
    ds_read_b64_tr_b16 v[72:73], v64 offset:0
    ds_read_b64_tr_b16 v[74:75], v64 offset:1152
    ds_read_b64_tr_b16 v[76:77], v64 offset:8
    ds_read_b64_tr_b16 v[78:79], v64 offset:1160
    ds_read_b64_tr_b16 v[80:81], v64 offset:64
    ds_read_b64_tr_b16 v[82:83], v64 offset:1216
    ds_read_b64_tr_b16 v[84:85], v64 offset:72
    ds_read_b64_tr_b16 v[86:87], v64 offset:1224
    ds_read_b64_tr_b16 v[88:89], v64 offset:128
    ds_read_b64_tr_b16 v[90:91], v64 offset:1280
    ds_read_b64_tr_b16 v[92:93], v64 offset:136
    ds_read_b64_tr_b16 v[94:95], v64 offset:1288
    ds_read_b64_tr_b16 v[96:97], v64 offset:192
    ds_read_b64_tr_b16 v[98:99], v64 offset:1344
    ds_read_b64_tr_b16 v[100:101], v64 offset:200
    ds_read_b64_tr_b16 v[102:103], v64 offset:1352
    ds_read_b64_tr_b16 v[104:105], v65 offset:0
    ds_read_b64_tr_b16 v[106:107], v65 offset:1152
    s_waitcnt lgkmcnt(15)
    buffer_store_dwordx4 v[72:75], v2, s[4:7], s67 offen sc1
    s_add_u32 s92, s67, s70
    s_waitcnt lgkmcnt(14)
    buffer_store_dwordx4 v[76:79], v2, s[4:7], s92 offen sc1
    s_add_u32 s92, s67, s71
    s_waitcnt lgkmcnt(12)
    buffer_store_dwordx4 v[80:83], v2, s[4:7], s92 offen sc1
    s_add_u32 s92, s92, s70
    s_waitcnt lgkmcnt(10)
    buffer_store_dwordx4 v[84:87], v2, s[4:7], s92 offen sc1
    s_waitcnt lgkmcnt(8)
    buffer_store_dwordx4 v[88:91], v2, s[4:7], s68 offen sc1
    s_add_u32 s92, s68, s70
    s_waitcnt lgkmcnt(6)
    buffer_store_dwordx4 v[92:95], v2, s[4:7], s92 offen sc1
    s_add_u32 s92, s68, s71
    s_waitcnt lgkmcnt(4)
    buffer_store_dwordx4 v[96:99], v2, s[4:7], s92 offen sc1
    s_add_u32 s92, s92, s70
    s_waitcnt lgkmcnt(2)
    buffer_store_dwordx4 v[100:103], v2, s[4:7], s92 offen sc1
    s_waitcnt lgkmcnt(0)
    buffer_store_dwordx4 v[104:107], v2, s[4:7], s69 offen sc1
    s_cmp_eq_u32 s65, 0
    s_cbranch_scc1 L_nocs_67
    v_mov_b32 v68, 0x3f803f80
    v_mov_b32 v69, 0x3f803f80
    v_mov_b32 v70, 0x3f803f80
    v_mov_b32 v71, 0x3f803f80
    s_nop 1
    v_mfma_f32_16x16x32_bf16 v[108:111], v[72:75], v[68:71], 0
    v_mfma_f32_16x16x32_bf16 v[112:115], v[76:79], v[68:71], 0
    v_mfma_f32_16x16x32_bf16 v[116:119], v[80:83], v[68:71], 0
    v_mfma_f32_16x16x32_bf16 v[120:123], v[84:87], v[68:71], 0
    v_mfma_f32_16x16x32_bf16 v[124:127], v[88:91], v[68:71], 0
    v_mfma_f32_16x16x32_bf16 v[128:131], v[92:95], v[68:71], 0
    v_mfma_f32_16x16x32_bf16 v[132:135], v[96:99], v[68:71], 0
    v_mfma_f32_16x16x32_bf16 v[136:139], v[100:103], v[68:71], 0
    v_mfma_f32_16x16x32_bf16 v[140:143], v[104:107], v[68:71], 0
    v_and_b32 v66, 15, v1
    v_add_u32 v67, 1, v66
    v_cmp_gt_u32 vcc, 8, v66
    v_and_b32 v64, 48, v1
    s_nop 0
    v_cndmask_b32 v67, 0, v67, vcc
    v_lshlrev_b32 v67, 6, v67
    v_add_u32 v67, v67, v64
    v_cmp_eq_u32 vcc, 1, v66
    s_nop 1
    v_cndmask_b32 v108, v108, v112, vcc
    v_cndmask_b32 v109, v109, v113, vcc
    v_cndmask_b32 v110, v110, v114, vcc
    v_cndmask_b32 v111, v111, v115, vcc
    v_cmp_eq_u32 vcc, 2, v66
    s_nop 1
    v_cndmask_b32 v108, v108, v116, vcc
    v_cndmask_b32 v109, v109, v117, vcc
    v_cndmask_b32 v110, v110, v118, vcc
    v_cndmask_b32 v111, v111, v119, vcc
    v_cmp_eq_u32 vcc, 3, v66
    s_nop 1
    v_cndmask_b32 v108, v108, v120, vcc
    v_cndmask_b32 v109, v109, v121, vcc
    v_cndmask_b32 v110, v110, v122, vcc
    v_cndmask_b32 v111, v111, v123, vcc
    v_cmp_eq_u32 vcc, 4, v66
    s_nop 1
    v_cndmask_b32 v108, v108, v124, vcc
    v_cndmask_b32 v109, v109, v125, vcc
    v_cndmask_b32 v110, v110, v126, vcc
    v_cndmask_b32 v111, v111, v127, vcc
    v_cmp_eq_u32 vcc, 5, v66
    s_nop 1
    v_cndmask_b32 v108, v108, v128, vcc
    v_cndmask_b32 v109, v109, v129, vcc
    v_cndmask_b32 v110, v110, v130, vcc
    v_cndmask_b32 v111, v111, v131, vcc
    v_cmp_eq_u32 vcc, 6, v66
    s_nop 1
    v_cndmask_b32 v108, v108, v132, vcc
    v_cndmask_b32 v109, v109, v133, vcc
    v_cndmask_b32 v110, v110, v134, vcc
    v_cndmask_b32 v111, v111, v135, vcc
    v_cmp_eq_u32 vcc, 7, v66
    s_nop 1
    v_cndmask_b32 v108, v108, v136, vcc
    v_cndmask_b32 v109, v109, v137, vcc
    v_cndmask_b32 v110, v110, v138, vcc
    v_cndmask_b32 v111, v111, v139, vcc
    v_cmp_eq_u32 vcc, 8, v66
    s_nop 1
    v_cndmask_b32 v108, v108, v140, vcc
    v_cndmask_b32 v109, v109, v141, vcc
    v_cndmask_b32 v110, v110, v142, vcc
    v_cndmask_b32 v111, v111, v143, vcc
    s_mov_b32 exec_lo, 0x01ff01ff
    s_mov_b32 exec_hi, 0x01ff01ff
    buffer_store_dwordx4 v[108:111], v67, s[4:7], s65 offen sc1
    s_mov_b64 exec, -1
L_nocs_67:
    s_mov_b32 s44, s66
    s_mul_i32 s55, s20, 9216
    s_add_u32 s55, s55, 110592
    v_add_u32 v64, s55, v2
    ds_write_b128 v64, a[216:219] offset:0
    ds_write_b128 v64, a[220:223] offset:1024
    ds_write_b128 v64, a[224:227] offset:2048
    ds_write_b128 v64, a[228:231] offset:3072
    ds_write_b128 v64, a[232:235] offset:4096
    ds_write_b128 v64, a[236:239] offset:5120
    ds_write_b128 v64, a[240:243] offset:6144
    ds_write_b128 v64, a[244:247] offset:7168
    ds_write_b128 v64, a[248:251] offset:8192
    s_cmp_ge_u32 s31, 1152
    s_cbranch_scc1 L_ud_68
    s_mul_i32 s64, s31, 1821
    s_lshr_b32 s64, s64, 16
    s_mul_i32 s92, s64, 36
    s_sub_u32 s92, s31, s92
    s_and_b32 s93, s92, 1
    s_lshr_b32 s94, s92, 1
    s_mov_b32 s62, 0
    s_mov_b32 s63, 256
    s_mul_i32 s95, s64, 486
    s_add_u32 s95, s95, s92
    s_lshl_b32 s95, s95, 10
    s_add_u32 s69, s95, 4194304
    s_add_u32 s67, s69, 36864
    s_add_u32 s68, s69, 184320
    s_mov_b32 s70, 36864
    s_mov_b32 s71, 73728
    s_lshl_b32 s95, s64, 1
    s_add_u32 s95, s95, s93
    s_mul_i32 s95, s95, 18
    s_add_u32 s95, s95, s94
    s_mul_i32 s95, s95, 576
    s_add_u32 s65, s95, 2883584
    s_mov_b32 s66, s92
    s_branch L_udone_69
L_ud_68:
    s_sub_u32 s92, s31, 1152
    s_mul_i32 s64, s92, 3641
    s_lshr_b32 s64, s64, 16
    s_mul_i32 s93, s64, 18
    s_sub_u32 s92, s92, s93
    s_and_b32 s93, s64, 3
    s_and_b32 s94, s93, 1
    s_mov_b32 s65, 0
    s_lshl_b32 s62, s94, 5
    s_cmp_eq_u32 s94, 0
    s_cselect_b32 s63, 256, 0
    s_add_u32 s66, s92, 36
    s_mul_i32 s95, s64, 486
    s_add_u32 s95, s95, 324
    s_lshl_b32 s95, s95, 10
    s_add_u32 s95, s95, 4194304
    s_cmp_ge_u32 s92, 3
    s_cbranch_scc1 L_ub_70
    s_sub_u32 s96, s92, 0
    s_mov_b32 s70, 1024
    s_mov_b32 s71, 2048
    s_mul_i32 s97, s96, 5120
    s_add_u32 s97, s97, 0
    s_add_u32 s67, s97, s95
    s_mul_i32 s97, s96, 4096
    s_add_u32 s97, s97, 15360
    s_add_u32 s68, s97, s95
    s_mul_i32 s97, s96, 5120
    s_add_u32 s97, s97, 4096
    s_add_u32 s69, s97, s95
    s_branch L_udone_69
L_ub_70:
    s_cmp_ge_u32 s92, 9
    s_cbranch_scc1 L_uc_71
    s_sub_u32 s96, s92, 3
    s_mov_b32 s70, 1024
    s_mov_b32 s71, 2048
    s_mul_i32 s97, s96, 9216
    s_add_u32 s97, s97, 27648
    s_add_u32 s67, s97, s95
    s_mul_i32 s97, s96, 9216
    s_add_u32 s97, s97, 31744
    s_add_u32 s68, s97, s95
    s_mul_i32 s97, s96, 9216
    s_add_u32 s97, s97, 35840
    s_add_u32 s69, s97, s95
    s_branch L_udone_69
L_uc_71:
    s_sub_u32 s96, s92, 9
    s_mov_b32 s70, 1024
    s_mov_b32 s71, 18432
    s_mul_i32 s97, s96, 2048
    s_add_u32 s97, s97, 82944
    s_add_u32 s67, s97, s95
    s_mul_i32 s97, s96, 2048
    s_add_u32 s97, s97, 119808
    s_add_u32 s68, s97, s95
    s_mul_i32 s97, s96, 1024
    s_add_u32 s97, s97, 156672
    s_add_u32 s69, s97, s95
L_udone_69:
    s_lshl_b32 s95, s64, 6
    s_add_u32 s95, s95, s66
    s_lshl_b32 s95, s95, 3
    s_add_u32 s66, s95, 4071424
    v_lshrrev_b32 v64, 4, v1
    v_bfe_u32 v66, v1, 2, 2
    v_lshl_add_u32 v64, v64, 3, v66
    v_mul_u32_u24 v64, 288, v64
    v_add_u32 v64, s55, v64
    v_and_b32 v66, 3, v1
    v_lshl_add_u32 v65, v66, 3, v64
    v_add_u32 v65, s63, v65
    v_lshl_add_u32 v64, v66, 4, v64
    v_add_u32 v64, s62, v64
    ds_read_b64_tr_b16 v[180:181], v64 offset:0
    ds_read_b64_tr_b16 v[182:183], v64 offset:1152
    ds_read_b64_tr_b16 v[184:185], v64 offset:8
    ds_read_b64_tr_b16 v[186:187], v64 offset:1160
    ds_read_b64_tr_b16 v[188:189], v64 offset:64
    ds_read_b64_tr_b16 v[190:191], v64 offset:1216
    ds_read_b64_tr_b16 v[192:193], v64 offset:72
    ds_read_b64_tr_b16 v[194:195], v64 offset:1224
    ds_read_b64_tr_b16 v[196:197], v64 offset:128
    ds_read_b64_tr_b16 v[198:199], v64 offset:1280
    ds_read_b64_tr_b16 v[200:201], v64 offset:136
    ds_read_b64_tr_b16 v[202:203], v64 offset:1288
    ds_read_b64_tr_b16 v[204:205], v64 offset:192
    ds_read_b64_tr_b16 v[206:207], v64 offset:1344
    ds_read_b64_tr_b16 v[208:209], v64 offset:200
    ds_read_b64_tr_b16 v[210:211], v64 offset:1352
    ds_read_b64_tr_b16 v[212:213], v65 offset:0
    ds_read_b64_tr_b16 v[214:215], v65 offset:1152
    s_cmp_eq_u32 s65, 0
    s_cbranch_scc1 L_nocs_72
    v_mov_b32 v68, 0x3f803f80
    v_mov_b32 v69, 0x3f803f80
    v_mov_b32 v70, 0x3f803f80
    v_mov_b32 v71, 0x3f803f80
    s_waitcnt lgkmcnt(15)
    s_nop 0
    v_mfma_f32_16x16x32_bf16 v[72:75], v[180:183], v[68:71], 0
    s_waitcnt lgkmcnt(14)
    v_mfma_f32_16x16x32_bf16 v[76:79], v[184:187], v[68:71], 0
    s_waitcnt lgkmcnt(12)
    v_mfma_f32_16x16x32_bf16 v[80:83], v[188:191], v[68:71], 0
    s_waitcnt lgkmcnt(10)
    v_mfma_f32_16x16x32_bf16 v[84:87], v[192:195], v[68:71], 0
    s_waitcnt lgkmcnt(8)
    v_mfma_f32_16x16x32_bf16 v[88:91], v[196:199], v[68:71], 0
    s_waitcnt lgkmcnt(6)
    v_mfma_f32_16x16x32_bf16 v[92:95], v[200:203], v[68:71], 0
    s_waitcnt lgkmcnt(4)
    v_mfma_f32_16x16x32_bf16 v[96:99], v[204:207], v[68:71], 0
    s_waitcnt lgkmcnt(2)
    v_mfma_f32_16x16x32_bf16 v[100:103], v[208:211], v[68:71], 0
    s_waitcnt lgkmcnt(0)
    v_mfma_f32_16x16x32_bf16 v[104:107], v[212:215], v[68:71], 0
    v_and_b32 v66, 15, v1
    v_add_u32 v67, 1, v66
    v_cmp_gt_u32 vcc, 8, v66
    v_and_b32 v64, 48, v1
    s_nop 0
    v_cndmask_b32 v67, 0, v67, vcc
    v_lshlrev_b32 v67, 6, v67
    v_add_u32 v67, v67, v64
    v_cmp_eq_u32 vcc, 1, v66
    s_nop 1
    v_cndmask_b32 v72, v72, v76, vcc
    v_cndmask_b32 v73, v73, v77, vcc
    v_cndmask_b32 v74, v74, v78, vcc
    v_cndmask_b32 v75, v75, v79, vcc
    v_cmp_eq_u32 vcc, 2, v66
    s_nop 1
    v_cndmask_b32 v72, v72, v80, vcc
    v_cndmask_b32 v73, v73, v81, vcc
    v_cndmask_b32 v74, v74, v82, vcc
    v_cndmask_b32 v75, v75, v83, vcc
    v_cmp_eq_u32 vcc, 3, v66
    s_nop 1
    v_cndmask_b32 v72, v72, v84, vcc
    v_cndmask_b32 v73, v73, v85, vcc
    v_cndmask_b32 v74, v74, v86, vcc
    v_cndmask_b32 v75, v75, v87, vcc
    v_cmp_eq_u32 vcc, 4, v66
    s_nop 1
    v_cndmask_b32 v72, v72, v88, vcc
    v_cndmask_b32 v73, v73, v89, vcc
    v_cndmask_b32 v74, v74, v90, vcc
    v_cndmask_b32 v75, v75, v91, vcc
    v_cmp_eq_u32 vcc, 5, v66
    s_nop 1
    v_cndmask_b32 v72, v72, v92, vcc
    v_cndmask_b32 v73, v73, v93, vcc
    v_cndmask_b32 v74, v74, v94, vcc
    v_cndmask_b32 v75, v75, v95, vcc
    v_cmp_eq_u32 vcc, 6, v66
    s_nop 1
    v_cndmask_b32 v72, v72, v96, vcc
    v_cndmask_b32 v73, v73, v97, vcc
    v_cndmask_b32 v74, v74, v98, vcc
    v_cndmask_b32 v75, v75, v99, vcc
    v_cmp_eq_u32 vcc, 7, v66
    s_nop 1
    v_cndmask_b32 v72, v72, v100, vcc
    v_cndmask_b32 v73, v73, v101, vcc
    v_cndmask_b32 v74, v74, v102, vcc
    v_cndmask_b32 v75, v75, v103, vcc
    v_cmp_eq_u32 vcc, 8, v66
    s_nop 1
    v_cndmask_b32 v72, v72, v104, vcc
    v_cndmask_b32 v73, v73, v105, vcc
    v_cndmask_b32 v74, v74, v106, vcc
    v_cndmask_b32 v75, v75, v107, vcc
    s_mov_b32 exec_lo, 0x01ff01ff
    s_mov_b32 exec_hi, 0x01ff01ff
    buffer_store_dwordx4 v[72:75], v67, s[4:7], s65 offen sc1
    s_mov_b64 exec, -1
L_nocs_72:
    v_mov_b32 v8, s98
    v_mov_b32 v9, s99
    s_waitcnt vmcnt(0)
    s_mov_b64 exec, 1
    buffer_store_dwordx2 v[8:9], off, s[4:7], s44 sc1
    s_mov_b64 exec, -1
    s_waitcnt lgkmcnt(15)
    buffer_store_dwordx4 v[180:183], v2, s[4:7], s67 offen sc1
    s_add_u32 s92, s67, s70
    s_waitcnt lgkmcnt(14)
    buffer_store_dwordx4 v[184:187], v2, s[4:7], s92 offen sc1
    s_add_u32 s92, s67, s71
    s_waitcnt lgkmcnt(12)
    buffer_store_dwordx4 v[188:191], v2, s[4:7], s92 offen sc1
    s_add_u32 s92, s92, s70
    s_waitcnt lgkmcnt(10)
    buffer_store_dwordx4 v[192:195], v2, s[4:7], s92 offen sc1
    s_waitcnt lgkmcnt(8)
    buffer_store_dwordx4 v[196:199], v2, s[4:7], s68 offen sc1
    s_add_u32 s92, s68, s70
    s_waitcnt lgkmcnt(6)
    buffer_store_dwordx4 v[200:203], v2, s[4:7], s92 offen sc1
    s_add_u32 s92, s68, s71
    s_waitcnt lgkmcnt(4)
    buffer_store_dwordx4 v[204:207], v2, s[4:7], s92 offen sc1
    s_add_u32 s92, s92, s70
    s_waitcnt lgkmcnt(2)
    buffer_store_dwordx4 v[208:211], v2, s[4:7], s92 offen sc1
    s_waitcnt lgkmcnt(0)
    buffer_store_dwordx4 v[212:215], v2, s[4:7], s69 offen sc1
    s_mov_b32 s0, s66
    s_and_b32 s23, s21, 3
    s_lshl_b32 s23, s23, 3
    s_and_b32 s1, s22, 7
    s_add_u32 s1, s1, s23
    s_lshl_b32 s1, s1, 9
    s_add_u32 s1, s1, 4071424
    v_min_u32 v14, 35, v1
    v_lshlrev_b32 v14, 3, v14
    buffer_load_dwordx2 v[12:13], v14, s[4:7], s1 offen sc1
L_ffn_49:
    s_barrier
    s_lshr_b32 s44, s22, 3
    s_and_b32 s60, s21, 4
    s_add_u32 s44, s44, s60
    s_and_b32 s60, s21, 3
    s_lshl_b32 s60, s60, 3
    s_and_b32 s47, s22, 7
    s_add_u32 s47, s47, s60
    s_lshl_b32 s64, s47, 9
    s_add_u32 s64, s64, 4071424
    s_lshr_b32 s45, s47, 2
    s_and_b32 s46, s47, 3
    s_mul_i32 s48, s47, 497664
    s_add_u32 s48, s48, 4194304
    s_mul_i32 s63, s20, 9
    s_lshr_b32 s63, s63, 1
    s_lshl_b32 s63, s63, 10
    s_add_u32 s62, s48, s63
    s_mul_i32 s49, s20, 9216
    s_add_u32 s48, s48, s49
    s_lshl_b32 s54, s44, 4
    s_lshl_b32 s60, s20, 2
    s_add_u32 s54, s54, s60
    s_mul_i32 s50, s54, 18432
    s_mul_i32 s53, s45, 2359296
    s_add_u32 s53, s53, s50
    s_add_u32 s50, s50, 4718592
    s_add_u32 s50, s50, s100
    s_lshr_b32 s60, s46, 1
    s_mul_i32 s60, s60, 9216
    s_add_u32 s53, s53, s60
    s_add_u32 s53, s53, 29360128
    s_add_u32 s53, s53, s100
    v_lshlrev_b32 v3, 3, v1
    v_mov_b32 v4, v2
    s_cmp_lg_u32 s101, 0
    s_cbranch_scc1 L_nopw_73
    s_waitcnt vmcnt(0)
    v_cmp_eq_u64 vcc, s[98:99], v[12:13]
    s_nop 0
    s_cmp_eq_u64 vcc, exec
    s_cbranch_scc0 L_pw_slow_52
L_pw_back_53:
L_nopw_73:
    s_add_u32 m0, s49, 0
    s_add_u32 s61, s48, 0
    buffer_load_dwordx4 v2, s[4:7], s61 offen offset:0 lds
    buffer_load_dwordx4 v2, s[4:7], s61 offen offset:1024 lds
    buffer_load_dwordx4 v2, s[4:7], s61 offen offset:2048 lds
    buffer_load_dwordx4 v2, s[4:7], s61 offen offset:3072 lds
    s_add_u32 m0, s49, 4096
    s_add_u32 s61, s48, 4096
    buffer_load_dwordx4 v2, s[4:7], s61 offen offset:0 lds
    buffer_load_dwordx4 v2, s[4:7], s61 offen offset:1024 lds
    buffer_load_dwordx4 v2, s[4:7], s61 offen offset:2048 lds
    buffer_load_dwordx4 v2, s[4:7], s61 offen offset:3072 lds
    s_add_u32 m0, s49, 8192
    s_add_u32 s61, s48, 8192
    buffer_load_dwordx4 v2, s[4:7], s61 offen offset:0 lds
    s_add_u32 m0, s49, 36864
    s_add_u32 s61, s48, 36864
    buffer_load_dwordx4 v2, s[4:7], s61 offen offset:0 lds
    buffer_load_dwordx4 v2, s[4:7], s61 offen offset:1024 lds
    buffer_load_dwordx4 v2, s[4:7], s61 offen offset:2048 lds
    buffer_load_dwordx4 v2, s[4:7], s61 offen offset:3072 lds
    s_add_u32 m0, s49, 40960
    s_add_u32 s61, s48, 40960
    buffer_load_dwordx4 v2, s[4:7], s61 offen offset:0 lds
    buffer_load_dwordx4 v2, s[4:7], s61 offen offset:1024 lds
    buffer_load_dwordx4 v2, s[4:7], s61 offen offset:2048 lds
    buffer_load_dwordx4 v2, s[4:7], s61 offen offset:3072 lds
    s_add_u32 m0, s49, 45056
    s_add_u32 s61, s48, 45056
    buffer_load_dwordx4 v2, s[4:7], s61 offen offset:0 lds
    s_add_u32 m0, s49, 73728
    s_add_u32 s61, s48, 73728
    buffer_load_dwordx4 v2, s[4:7], s61 offen offset:0 lds
    buffer_load_dwordx4 v2, s[4:7], s61 offen offset:1024 lds
    buffer_load_dwordx4 v2, s[4:7], s61 offen offset:2048 lds
    buffer_load_dwordx4 v2, s[4:7], s61 offen offset:3072 lds
    s_add_u32 m0, s49, 77824
    s_add_u32 s61, s48, 77824
    buffer_load_dwordx4 v2, s[4:7], s61 offen offset:0 lds
    buffer_load_dwordx4 v2, s[4:7], s61 offen offset:1024 lds
    buffer_load_dwordx4 v2, s[4:7], s61 offen offset:2048 lds
    buffer_load_dwordx4 v2, s[4:7], s61 offen offset:3072 lds
    s_add_u32 m0, s49, 81920
    s_add_u32 s61, s48, 81920
    buffer_load_dwordx4 v2, s[4:7], s61 offen offset:0 lds
    s_cmp_lg_u32 s101, 0
    s_cbranch_scc1 L_nocs_74
    s_cmp_ge_u32 s20, 2
    s_cbranch_scc1 L_nocs_74
    s_lshl_b32 s60, s47, 1
    s_add_u32 s60, s60, s20
    s_mul_i32 s60, s60, 10368
    s_add_u32 s60, s60, 2883584
    v_lshrrev_b32 v6, 2, v1
    v_lshlrev_b32 v6, 7, v6
    v_and_b32 v7, 3, v1
    v_lshl_add_u32 v6, v7, 4, v6
    s_lshl_b32 s61, s20, 6
    s_add_u32 s61, s61, 147456
    v_add_u32 v6, s61, v6
    s_mov_b32 exec_hi, 15
    buffer_load_dwordx4 v[64:67], v2, s[4:7], s60 offen offset:0 sc1
    buffer_load_dwordx4 v[68:71], v2, s[4:7], s60 offen offset:576 sc1
    buffer_load_dwordx4 v[72:75], v2, s[4:7], s60 offen offset:1152 sc1
    buffer_load_dwordx4 v[76:79], v2, s[4:7], s60 offen offset:1728 sc1
    buffer_load_dwordx4 v[80:83], v2, s[4:7], s60 offen offset:2304 sc1
    buffer_load_dwordx4 v[84:87], v2, s[4:7], s60 offen offset:2880 sc1
    s_add_u32 s60, s60, 3456
    buffer_load_dwordx4 v[88:91], v2, s[4:7], s60 offen offset:0 sc1
    buffer_load_dwordx4 v[92:95], v2, s[4:7], s60 offen offset:576 sc1
    buffer_load_dwordx4 v[96:99], v2, s[4:7], s60 offen offset:1152 sc1
    buffer_load_dwordx4 v[100:103], v2, s[4:7], s60 offen offset:1728 sc1
    buffer_load_dwordx4 v[104:107], v2, s[4:7], s60 offen offset:2304 sc1
    buffer_load_dwordx4 v[108:111], v2, s[4:7], s60 offen offset:2880 sc1
    s_add_u32 s60, s60, 3456
    buffer_load_dwordx4 v[112:115], v2, s[4:7], s60 offen offset:0 sc1
    buffer_load_dwordx4 v[116:119], v2, s[4:7], s60 offen offset:576 sc1
    buffer_load_dwordx4 v[120:123], v2, s[4:7], s60 offen offset:1152 sc1
    buffer_load_dwordx4 v[124:127], v2, s[4:7], s60 offen offset:1728 sc1
    buffer_load_dwordx4 v[128:131], v2, s[4:7], s60 offen offset:2304 sc1
    buffer_load_dwordx4 v[132:135], v2, s[4:7], s60 offen offset:2880 sc1
    s_waitcnt vmcnt(16)
    v_add_f32 v64, v64, v68
    v_add_f32 v65, v65, v69
    v_add_f32 v66, v66, v70
    v_add_f32 v67, v67, v71
    s_waitcnt vmcnt(15)
    v_add_f32 v64, v64, v72
    v_add_f32 v65, v65, v73
    v_add_f32 v66, v66, v74
    v_add_f32 v67, v67, v75
    s_waitcnt vmcnt(14)
    v_add_f32 v64, v64, v76
    v_add_f32 v65, v65, v77
    v_add_f32 v66, v66, v78
    v_add_f32 v67, v67, v79
    s_waitcnt vmcnt(13)
    v_add_f32 v64, v64, v80
    v_add_f32 v65, v65, v81
    v_add_f32 v66, v66, v82
    v_add_f32 v67, v67, v83
    s_waitcnt vmcnt(12)
    v_add_f32 v64, v64, v84
    v_add_f32 v65, v65, v85
    v_add_f32 v66, v66, v86
    v_add_f32 v67, v67, v87
    s_waitcnt vmcnt(11)
    v_add_f32 v64, v64, v88
    v_add_f32 v65, v65, v89
    v_add_f32 v66, v66, v90
    v_add_f32 v67, v67, v91
    s_waitcnt vmcnt(10)
    v_add_f32 v64, v64, v92
    v_add_f32 v65, v65, v93
    v_add_f32 v66, v66, v94
    v_add_f32 v67, v67, v95
    s_waitcnt vmcnt(9)
    v_add_f32 v64, v64, v96
    v_add_f32 v65, v65, v97
    v_add_f32 v66, v66, v98
    v_add_f32 v67, v67, v99
    s_waitcnt vmcnt(8)
    v_add_f32 v64, v64, v100
    v_add_f32 v65, v65, v101
    v_add_f32 v66, v66, v102
    v_add_f32 v67, v67, v103
    s_waitcnt vmcnt(7)
    v_add_f32 v64, v64, v104
    v_add_f32 v65, v65, v105
    v_add_f32 v66, v66, v106
    v_add_f32 v67, v67, v107
    s_waitcnt vmcnt(6)
    v_add_f32 v64, v64, v108
    v_add_f32 v65, v65, v109
    v_add_f32 v66, v66, v110
    v_add_f32 v67, v67, v111
    s_waitcnt vmcnt(5)
    v_add_f32 v64, v64, v112
    v_add_f32 v65, v65, v113
    v_add_f32 v66, v66, v114
    v_add_f32 v67, v67, v115
    s_waitcnt vmcnt(4)
    v_add_f32 v64, v64, v116
    v_add_f32 v65, v65, v117
    v_add_f32 v66, v66, v118
    v_add_f32 v67, v67, v119
    s_waitcnt vmcnt(3)
    v_add_f32 v64, v64, v120
    v_add_f32 v65, v65, v121
    v_add_f32 v66, v66, v122
    v_add_f32 v67, v67, v123
    s_waitcnt vmcnt(2)
    v_add_f32 v64, v64, v124
    v_add_f32 v65, v65, v125
    v_add_f32 v66, v66, v126
    v_add_f32 v67, v67, v127
    s_waitcnt vmcnt(1)
    v_add_f32 v64, v64, v128
    v_add_f32 v65, v65, v129
    v_add_f32 v66, v66, v130
    v_add_f32 v67, v67, v131
    s_waitcnt vmcnt(0)
    v_add_f32 v64, v64, v132
    v_add_f32 v65, v65, v133
    v_add_f32 v66, v66, v134
    v_add_f32 v67, v67, v135
    ds_write_b128 v6, v[64:67]
    s_mov_b64 exec, -1
    s_waitcnt lgkmcnt(0)
L_nocs_74:
    s_lshr_b32 s60, s54, 2
    s_lshl_b32 s60, s60, 8
    s_add_u32 s55, s101, 3964928
    v_and_b32 v7, 7, v1
    v_min_u32 v7, 5, v7
    v_and_b32 v6, 24, v1
    v_add_lshl_u32 v0, v7, v6, 3
    v_add_u32 v0, s60, v0
    s_lshl_b32 s60, s21, 4
    s_lshr_b32 s61, s22, 1
    s_add_u32 s60, s60, s61
    s_lshl_b32 s60, s60, 6
    v_lshl_add_u32 v7, v7, 3, s60
    v_cmp_gt_u32 vcc, 32, v1
    s_nop 1
    v_cndmask_b32 v0, v7, v0, vcc
    buffer_load_dwordx2 v[6:7], v0, s[4:7], s55 offen sc1
    s_lshl_b32 s60, s44, 5
    s_add_u32 s60, s60, s47
    s_mul_i32 s51, s60, 73728
    s_add_u32 s51, s51, 9699328
    s_add_u32 s51, s51, s100
    s_xor_b32 s61, s60, 1
    s_mul_i32 s56, s61, 73728
    s_add_u32 s56, s56, 9699328
    s_add_u32 s56, s56, s100
    s_xor_b32 s61, s60, 2
    s_mul_i32 s57, s61, 73728
    s_add_u32 s57, s57, 9699328
    s_add_u32 s57, s57, s100
    s_xor_b32 s61, s60, 3
    s_mul_i32 s58, s61, 73728
    s_add_u32 s58, s58, 9699328
    s_add_u32 s58, s58, s100
    s_lshr_b32 s52, s60, 2
    s_lshl_b32 s52, s52, 2
    s_add_u32 s52, s52, s20
    s_lshl_b32 s52, s52, 7
    s_lshl_b32 s61, s101, 2
    s_add_u32 s52, s52, s61
    s_add_u32 s52, s52, 3981312
    v_lshrrev_b32 v5, 4, v1
    v_lshlrev_b32 v5, 4, v5
    v_add_u32 v5, 147456, v5
    s_lshl_b32 s60, s20, 12
    s_add_u32 s51, s51, s60
    s_add_u32 s56, s56, s60
    s_add_u32 s57, s57, s60
    s_add_u32 s58, s58, s60
    s_lshl_b32 s65, s20, 11
    s_sub_u32 s65, 65536, s65
    s_lshl_b32 s67, s46, 3
    s_add_u32 s67, s67, s52
    s_waitcnt vmcnt(1)
    s_barrier
    ds_read_b128 v[8:11], v4 offset:0
    ds_read_b128 v[12:15], v4 offset:1024
    ds_read_b128 v[16:19], v4 offset:36864
    ds_read_b128 v[20:23], v4 offset:37888
    s_and_b32 s61, s22, 7
    s_mul_i32 s61, s61, 9216
    s_add_u32 s61, s61, s50
    s_waitcnt vmcnt(0)
    v_cmp_eq_u64 vcc, s[98:99], v[6:7]
    s_nop 0
    s_cmp_eq_u64 vcc, exec
    s_cbranch_scc0 L_p1_slow_75
L_p1_back_76:
    s_cmp_eq_u32 s0, 0
    s_cbranch_scc1 L_nopend_78
    v_mov_b32 v6, s98
    v_mov_b32 v7, s99
    s_mov_b64 exec, 1
    buffer_store_dwordx2 v[6:7], off, s[4:7], s0 sc1
    s_mov_b64 exec, -1
    s_mov_b32 s0, 0
L_nopend_78:
    s_add_u32 s59, s50, 0
    buffer_load_dwordx4 a[0:3], v2, s[4:7], s59 offen offset:0 sc1
    s_add_u32 s66, s50, 18432
    buffer_load_dwordx4 a[4:7], v2, s[4:7], s66 offen offset:0 sc1
    s_add_u32 s68, s50, 36864
    buffer_load_dwordx4 a[8:11], v2, s[4:7], s68 offen offset:0 sc1
    s_add_u32 s69, s50, 55296
    buffer_load_dwordx4 a[12:15], v2, s[4:7], s69 offen offset:0 sc1
    buffer_load_dwordx4 a[16:19], v2, s[4:7], s59 offen offset:1024 sc1
    buffer_load_dwordx4 a[20:23], v2, s[4:7], s66 offen offset:1024 sc1
    buffer_load_dwordx4 a[24:27], v2, s[4:7], s68 offen offset:1024 sc1
    buffer_load_dwordx4 a[28:31], v2, s[4:7], s69 offen offset:1024 sc1
    s_lshl_b32 s60, s54, 4
    v_add_u32 v6, s60, v1
    v_lshlrev_b32 v6, 3, v6
    s_add_u32 s55, s100, 7077888
    s_add_u32 s60, s55, 0
    buffer_load_dwordx2 v[152:153], v6, s[4:7], s60 offen sc1
    s_add_u32 s60, s55, 16384
    buffer_load_dwordx2 v[154:155], v6, s[4:7], s60 offen sc1
    s_add_u32 s60, s55, 32768
    buffer_load_dwordx2 v[156:157], v6, s[4:7], s60 offen sc1
    s_add_u32 s60, s55, 49152
    buffer_load_dwordx2 v[158:159], v6, s[4:7], s60 offen sc1
    s_add_u32 s60, s55, 65536
    buffer_load_dwordx2 v[160:161], v6, s[4:7], s60 offen sc1
    s_add_u32 s60, s55, 81920
    buffer_load_dwordx2 v[162:163], v6, s[4:7], s60 offen sc1
    v_add_u32 v7, 0x10000, v2
    buffer_load_dwordx4 a[32:35], v2, s[4:7], s59 offen offset:2048 sc1
    buffer_load_dwordx4 a[36:39], v2, s[4:7], s66 offen offset:2048 sc1
    buffer_load_dwordx4 a[40:43], v2, s[4:7], s68 offen offset:2048 sc1
    buffer_load_dwordx4 a[44:47], v2, s[4:7], s69 offen offset:2048 sc1
    s_waitcnt vmcnt(17) lgkmcnt(3)
    v_mfma_f32_16x16x32_bf16 v[208:211], v[8:11], a[0:3], 0
    s_waitcnt vmcnt(16)
    ds_read_b128 v[24:27], v7 offset:8192
    v_mfma_f32_16x16x32_bf16 v[212:215], v[8:11], a[4:7], 0
    s_waitcnt vmcnt(15)
    v_mfma_f32_16x16x32_bf16 v[216:219], v[8:11], a[8:11], 0
    s_waitcnt vmcnt(14)
    v_mfma_f32_16x16x32_bf16 v[220:223], v[8:11], a[12:15], 0
    s_waitcnt lgkmcnt(3)
    v_mfma_f32_16x16x32_bf16 v[224:227], v[12:15], a[0:3], 0
    ds_read_b128 v[28:31], v7 offset:9216
    v_mfma_f32_16x16x32_bf16 v[228:231], v[12:15], a[4:7], 0
    buffer_load_dwordx4 a[48:51], v2, s[4:7], s59 offen offset:3072 sc1
    v_mfma_f32_16x16x32_bf16 v[232:235], v[12:15], a[8:11], 0
    v_mfma_f32_16x16x32_bf16 v[236:239], v[12:15], a[12:15], 0
    s_waitcnt lgkmcnt(3)
    v_mfma_f32_16x16x32_bf16 v[64:67], v[16:19], a[0:3], 0
    ds_read_b128 v[8:11], v4 offset:2048
    v_mfma_f32_16x16x32_bf16 v[68:71], v[16:19], a[4:7], 0
    buffer_load_dwordx4 a[52:55], v2, s[4:7], s66 offen offset:3072 sc1
    v_mfma_f32_16x16x32_bf16 v[72:75], v[16:19], a[8:11], 0
    v_mfma_f32_16x16x32_bf16 v[76:79], v[16:19], a[12:15], 0
    buffer_load_dwordx4 a[56:59], v2, s[4:7], s68 offen offset:3072 sc1
    buffer_load_dwordx4 a[60:63], v2, s[4:7], s69 offen offset:3072 sc1
    s_waitcnt lgkmcnt(3)
    v_mfma_f32_16x16x32_bf16 v[80:83], v[20:23], a[0:3], 0
    s_add_u32 s59, s50, 4096
    ds_read_b128 v[12:15], v4 offset:3072
    v_mfma_f32_16x16x32_bf16 v[84:87], v[20:23], a[4:7], 0
    v_mfma_f32_16x16x32_bf16 v[88:91], v[20:23], a[8:11], 0
    v_mfma_f32_16x16x32_bf16 v[92:95], v[20:23], a[12:15], 0
    s_waitcnt lgkmcnt(3)
    v_mfma_f32_16x16x32_bf16 v[96:99], v[24:27], a[0:3], 0
    ds_read_b128 v[16:19], v4 offset:38912
    v_mfma_f32_16x16x32_bf16 v[100:103], v[24:27], a[4:7], 0
    buffer_load_dwordx4 a[64:67], v2, s[4:7], s59 offen offset:0 sc1
    v_mfma_f32_16x16x32_bf16 v[104:107], v[24:27], a[8:11], 0
    s_add_u32 s66, s50, 22528
    v_mfma_f32_16x16x32_bf16 v[108:111], v[24:27], a[12:15], 0
    s_waitcnt lgkmcnt(3)
    v_mfma_f32_16x16x32_bf16 v[112:115], v[28:31], a[0:3], 0
    ds_read_b128 v[20:23], v4 offset:39936
    v_mfma_f32_16x16x32_bf16 v[116:119], v[28:31], a[4:7], 0
    buffer_load_dwordx4 a[68:71], v2, s[4:7], s66 offen offset:0 sc1
    v_mfma_f32_16x16x32_bf16 v[120:123], v[28:31], a[8:11], 0
    s_add_u32 s68, s50, 40960
    v_mfma_f32_16x16x32_bf16 v[124:127], v[28:31], a[12:15], 0
    s_waitcnt vmcnt(19) lgkmcnt(3)
    v_mfma_f32_16x16x32_bf16 v[208:211], v[8:11], a[16:19], v[208:211]
    s_waitcnt vmcnt(18)
    ds_read_b128 v[24:27], v7 offset:10240
    v_mfma_f32_16x16x32_bf16 v[212:215], v[8:11], a[20:23], v[212:215]
    buffer_load_dwordx4 a[72:75], v2, s[4:7], s68 offen offset:0 sc1
    s_waitcnt vmcnt(18)
    v_mfma_f32_16x16x32_bf16 v[216:219], v[8:11], a[24:27], v[216:219]
    s_waitcnt vmcnt(17)
    s_add_u32 s69, s50, 59392
    v_mfma_f32_16x16x32_bf16 v[220:223], v[8:11], a[28:31], v[220:223]
    s_waitcnt lgkmcnt(3)
    v_mfma_f32_16x16x32_bf16 v[224:227], v[12:15], a[16:19], v[224:227]
    ds_read_b128 v[28:31], v7 offset:11264
    v_mfma_f32_16x16x32_bf16 v[228:231], v[12:15], a[20:23], v[228:231]
    buffer_load_dwordx4 a[76:79], v2, s[4:7], s69 offen offset:0 sc1
    v_mfma_f32_16x16x32_bf16 v[232:235], v[12:15], a[24:27], v[232:235]
    v_mfma_f32_16x16x32_bf16 v[236:239], v[12:15], a[28:31], v[236:239]
    s_waitcnt lgkmcnt(3)
    v_mfma_f32_16x16x32_bf16 v[64:67], v[16:19], a[16:19], v[64:67]
    ds_read_b128 v[8:11], v4 offset:4096
    v_mfma_f32_16x16x32_bf16 v[68:71], v[16:19], a[20:23], v[68:71]
    buffer_load_dwordx4 a[80:83], v2, s[4:7], s59 offen offset:1024 sc1
    v_mfma_f32_16x16x32_bf16 v[72:75], v[16:19], a[24:27], v[72:75]
    v_mfma_f32_16x16x32_bf16 v[76:79], v[16:19], a[28:31], v[76:79]
    s_waitcnt lgkmcnt(3)
    v_mfma_f32_16x16x32_bf16 v[80:83], v[20:23], a[16:19], v[80:83]
    ds_read_b128 v[12:15], v4 offset:5120
    v_mfma_f32_16x16x32_bf16 v[84:87], v[20:23], a[20:23], v[84:87]
    buffer_load_dwordx4 a[84:87], v2, s[4:7], s66 offen offset:1024 sc1
    v_mfma_f32_16x16x32_bf16 v[88:91], v[20:23], a[24:27], v[88:91]
    v_mfma_f32_16x16x32_bf16 v[92:95], v[20:23], a[28:31], v[92:95]
    s_waitcnt lgkmcnt(3)
    v_mfma_f32_16x16x32_bf16 v[96:99], v[24:27], a[16:19], v[96:99]
    ds_read_b128 v[16:19], v4 offset:40960
    v_mfma_f32_16x16x32_bf16 v[100:103], v[24:27], a[20:23], v[100:103]
    buffer_load_dwordx4 a[88:91], v2, s[4:7], s68 offen offset:1024 sc1
    v_mfma_f32_16x16x32_bf16 v[104:107], v[24:27], a[24:27], v[104:107]
    v_mfma_f32_16x16x32_bf16 v[108:111], v[24:27], a[28:31], v[108:111]
    s_waitcnt lgkmcnt(3)
    v_mfma_f32_16x16x32_bf16 v[112:115], v[28:31], a[16:19], v[112:115]
    ds_read_b128 v[20:23], v4 offset:41984
    v_mfma_f32_16x16x32_bf16 v[116:119], v[28:31], a[20:23], v[116:119]
    buffer_load_dwordx4 a[92:95], v2, s[4:7], s69 offen offset:1024 sc1
    v_mfma_f32_16x16x32_bf16 v[120:123], v[28:31], a[24:27], v[120:123]
    v_mfma_f32_16x16x32_bf16 v[124:127], v[28:31], a[28:31], v[124:127]
    s_waitcnt vmcnt(15) lgkmcnt(3)
    v_mfma_f32_16x16x32_bf16 v[208:211], v[8:11], a[32:35], v[208:211]
    s_waitcnt vmcnt(14)
    ds_read_b128 v[24:27], v7 offset:12288
    v_mfma_f32_16x16x32_bf16 v[212:215], v[8:11], a[36:39], v[212:215]
    buffer_load_dwordx4 a[96:99], v2, s[4:7], s59 offen offset:2048 sc1
    s_waitcnt vmcnt(14)
    v_mfma_f32_16x16x32_bf16 v[216:219], v[8:11], a[40:43], v[216:219]
    s_waitcnt vmcnt(13)
    v_mfma_f32_16x16x32_bf16 v[220:223], v[8:11], a[44:47], v[220:223]
    s_waitcnt lgkmcnt(3)
    v_mfma_f32_16x16x32_bf16 v[224:227], v[12:15], a[32:35], v[224:227]
    ds_read_b128 v[28:31], v7 offset:13312
    v_mfma_f32_16x16x32_bf16 v[228:231], v[12:15], a[36:39], v[228:231]
    buffer_load_dwordx4 a[100:103], v2, s[4:7], s66 offen offset:2048 sc1
    v_mfma_f32_16x16x32_bf16 v[232:235], v[12:15], a[40:43], v[232:235]
    v_mfma_f32_16x16x32_bf16 v[236:239], v[12:15], a[44:47], v[236:239]
    s_waitcnt lgkmcnt(3)
    v_mfma_f32_16x16x32_bf16 v[64:67], v[16:19], a[32:35], v[64:67]
    ds_read_b128 v[8:11], v4 offset:6144
    v_mfma_f32_16x16x32_bf16 v[68:71], v[16:19], a[36:39], v[68:71]
    buffer_load_dwordx4 a[104:107], v2, s[4:7], s68 offen offset:2048 sc1
    v_mfma_f32_16x16x32_bf16 v[72:75], v[16:19], a[40:43], v[72:75]
    v_mfma_f32_16x16x32_bf16 v[76:79], v[16:19], a[44:47], v[76:79]
    s_waitcnt lgkmcnt(3)
    v_mfma_f32_16x16x32_bf16 v[80:83], v[20:23], a[32:35], v[80:83]
    ds_read_b128 v[12:15], v4 offset:7168
    v_mfma_f32_16x16x32_bf16 v[84:87], v[20:23], a[36:39], v[84:87]
    buffer_load_dwordx4 a[108:111], v2, s[4:7], s69 offen offset:2048 sc1
    v_mfma_f32_16x16x32_bf16 v[88:91], v[20:23], a[40:43], v[88:91]
    v_mfma_f32_16x16x32_bf16 v[92:95], v[20:23], a[44:47], v[92:95]
    s_waitcnt lgkmcnt(3)
    v_mfma_f32_16x16x32_bf16 v[96:99], v[24:27], a[32:35], v[96:99]
    ds_read_b128 v[16:19], v4 offset:43008
    v_mfma_f32_16x16x32_bf16 v[100:103], v[24:27], a[36:39], v[100:103]
    buffer_load_dwordx4 a[112:115], v2, s[4:7], s59 offen offset:3072 sc1
    v_mfma_f32_16x16x32_bf16 v[104:107], v[24:27], a[40:43], v[104:107]
    v_mfma_f32_16x16x32_bf16 v[108:111], v[24:27], a[44:47], v[108:111]
    s_waitcnt lgkmcnt(3)
    v_mfma_f32_16x16x32_bf16 v[112:115], v[28:31], a[32:35], v[112:115]
    ds_read_b128 v[20:23], v4 offset:44032
    v_mfma_f32_16x16x32_bf16 v[116:119], v[28:31], a[36:39], v[116:119]
    buffer_load_dwordx4 a[116:119], v2, s[4:7], s66 offen offset:3072 sc1
    v_mfma_f32_16x16x32_bf16 v[120:123], v[28:31], a[40:43], v[120:123]
    v_mfma_f32_16x16x32_bf16 v[124:127], v[28:31], a[44:47], v[124:127]
    s_waitcnt vmcnt(17) lgkmcnt(3)
    v_mfma_f32_16x16x32_bf16 v[208:211], v[8:11], a[48:51], v[208:211]
    s_waitcnt vmcnt(16)
    ds_read_b128 v[24:27], v7 offset:14336
    v_mfma_f32_16x16x32_bf16 v[212:215], v[8:11], a[52:55], v[212:215]
    buffer_load_dwordx4 a[120:123], v2, s[4:7], s68 offen offset:3072 sc1
    s_waitcnt vmcnt(16)
    v_mfma_f32_16x16x32_bf16 v[216:219], v[8:11], a[56:59], v[216:219]
    s_waitcnt vmcnt(15)
    v_mfma_f32_16x16x32_bf16 v[220:223], v[8:11], a[60:63], v[220:223]
    s_waitcnt lgkmcnt(3)
    v_mfma_f32_16x16x32_bf16 v[224:227], v[12:15], a[48:51], v[224:227]
    ds_read_b128 v[28:31], v7 offset:15360
    v_mfma_f32_16x16x32_bf16 v[228:231], v[12:15], a[52:55], v[228:231]
    buffer_load_dwordx4 a[124:127], v2, s[4:7], s69 offen offset:3072 sc1
    v_mfma_f32_16x16x32_bf16 v[232:235], v[12:15], a[56:59], v[232:235]
    s_add_u32 s59, s50, 8192
    v_mfma_f32_16x16x32_bf16 v[236:239], v[12:15], a[60:63], v[236:239]
    s_waitcnt lgkmcnt(3)
    v_mfma_f32_16x16x32_bf16 v[64:67], v[16:19], a[48:51], v[64:67]
    ds_read_b128 v[8:11], v4 offset:8192
    v_mfma_f32_16x16x32_bf16 v[68:71], v[16:19], a[52:55], v[68:71]
    buffer_load_dwordx4 a[128:131], v2, s[4:7], s59 offen offset:0 sc1
    v_mfma_f32_16x16x32_bf16 v[72:75], v[16:19], a[56:59], v[72:75]
    s_add_u32 s66, s50, 26624
    v_mfma_f32_16x16x32_bf16 v[76:79], v[16:19], a[60:63], v[76:79]
    s_waitcnt lgkmcnt(3)
    v_mfma_f32_16x16x32_bf16 v[80:83], v[20:23], a[48:51], v[80:83]
    ds_read_b128 v[12:15], v4 offset:9216
    v_mfma_f32_16x16x32_bf16 v[84:87], v[20:23], a[52:55], v[84:87]
    buffer_load_dwordx4 a[132:135], v2, s[4:7], s66 offen offset:0 sc1
    v_mfma_f32_16x16x32_bf16 v[88:91], v[20:23], a[56:59], v[88:91]
    s_add_u32 s68, s50, 45056
    v_mfma_f32_16x16x32_bf16 v[92:95], v[20:23], a[60:63], v[92:95]
    s_waitcnt lgkmcnt(3)
    v_mfma_f32_16x16x32_bf16 v[96:99], v[24:27], a[48:51], v[96:99]
    ds_read_b128 v[16:19], v4 offset:45056
    v_mfma_f32_16x16x32_bf16 v[100:103], v[24:27], a[52:55], v[100:103]
    buffer_load_dwordx4 a[136:139], v2, s[4:7], s68 offen offset:0 sc1
    v_mfma_f32_16x16x32_bf16 v[104:107], v[24:27], a[56:59], v[104:107]
    s_add_u32 s69, s50, 63488
    v_mfma_f32_16x16x32_bf16 v[108:111], v[24:27], a[60:63], v[108:111]
    s_waitcnt lgkmcnt(3)
    v_mfma_f32_16x16x32_bf16 v[112:115], v[28:31], a[48:51], v[112:115]
    ds_read_b128 v[20:23], v4 offset:46080
    v_mfma_f32_16x16x32_bf16 v[116:119], v[28:31], a[52:55], v[116:119]
    buffer_load_dwordx4 a[140:143], v2, s[4:7], s69 offen offset:0 sc1
    v_mfma_f32_16x16x32_bf16 v[120:123], v[28:31], a[56:59], v[120:123]
    v_mfma_f32_16x16x32_bf16 v[124:127], v[28:31], a[60:63], v[124:127]
    s_waitcnt vmcnt(19) lgkmcnt(3)
    v_mfma_f32_16x16x32_bf16 v[208:211], v[8:11], a[64:67], v[208:211]
    s_waitcnt vmcnt(18)
    ds_read_b128 v[24:27], v7 offset:16384
    v_mfma_f32_16x16x32_bf16 v[212:215], v[8:11], a[68:71], v[212:215]
    buffer_load_dwordx4 a[144:147], v2, s[4:7], s59 offen offset:1024 sc1
    s_waitcnt vmcnt(18)
    v_mfma_f32_16x16x32_bf16 v[216:219], v[8:11], a[72:75], v[216:219]
    s_waitcnt vmcnt(17)
    v_mfma_f32_16x16x32_bf16 v[220:223], v[8:11], a[76:79], v[220:223]
    s_waitcnt lgkmcnt(3)
    v_mfma_f32_16x16x32_bf16 v[224:227], v[12:15], a[64:67], v[224:227]
    ds_read_b128 v[28:31], v7 offset:17408
    v_mfma_f32_16x16x32_bf16 v[228:231], v[12:15], a[68:71], v[228:231]
    buffer_load_dwordx4 a[148:151], v2, s[4:7], s66 offen offset:1024 sc1
    v_mfma_f32_16x16x32_bf16 v[232:235], v[12:15], a[72:75], v[232:235]
    v_mfma_f32_16x16x32_bf16 v[236:239], v[12:15], a[76:79], v[236:239]
    s_waitcnt lgkmcnt(3)
    v_mfma_f32_16x16x32_bf16 v[64:67], v[16:19], a[64:67], v[64:67]
    ds_read_b128 v[8:11], v4 offset:10240
    v_mfma_f32_16x16x32_bf16 v[68:71], v[16:19], a[68:71], v[68:71]
    buffer_load_dwordx4 a[152:155], v2, s[4:7], s68 offen offset:1024 sc1
    v_mfma_f32_16x16x32_bf16 v[72:75], v[16:19], a[72:75], v[72:75]
    v_mfma_f32_16x16x32_bf16 v[76:79], v[16:19], a[76:79], v[76:79]
    s_waitcnt lgkmcnt(3)
    v_mfma_f32_16x16x32_bf16 v[80:83], v[20:23], a[64:67], v[80:83]
    ds_read_b128 v[12:15], v4 offset:11264
    v_mfma_f32_16x16x32_bf16 v[84:87], v[20:23], a[68:71], v[84:87]
    buffer_load_dwordx4 a[156:159], v2, s[4:7], s69 offen offset:1024 sc1
    v_mfma_f32_16x16x32_bf16 v[88:91], v[20:23], a[72:75], v[88:91]
    v_mfma_f32_16x16x32_bf16 v[92:95], v[20:23], a[76:79], v[92:95]
    s_waitcnt lgkmcnt(3)
    v_mfma_f32_16x16x32_bf16 v[96:99], v[24:27], a[64:67], v[96:99]
    ds_read_b128 v[16:19], v4 offset:47104
    v_mfma_f32_16x16x32_bf16 v[100:103], v[24:27], a[68:71], v[100:103]
    buffer_load_dwordx4 a[160:163], v2, s[4:7], s59 offen offset:2048 sc1
    v_mfma_f32_16x16x32_bf16 v[104:107], v[24:27], a[72:75], v[104:107]
    v_mfma_f32_16x16x32_bf16 v[108:111], v[24:27], a[76:79], v[108:111]
    s_waitcnt lgkmcnt(3)
    v_mfma_f32_16x16x32_bf16 v[112:115], v[28:31], a[64:67], v[112:115]
    ds_read_b128 v[20:23], v4 offset:48128
    v_mfma_f32_16x16x32_bf16 v[116:119], v[28:31], a[68:71], v[116:119]
    buffer_load_dwordx4 a[164:167], v2, s[4:7], s66 offen offset:2048 sc1
    v_mfma_f32_16x16x32_bf16 v[120:123], v[28:31], a[72:75], v[120:123]
    v_mfma_f32_16x16x32_bf16 v[124:127], v[28:31], a[76:79], v[124:127]
    s_waitcnt vmcnt(21) lgkmcnt(3)
    v_mfma_f32_16x16x32_bf16 v[208:211], v[8:11], a[80:83], v[208:211]
    s_waitcnt vmcnt(20)
    ds_read_b128 v[24:27], v7 offset:18432
    v_mfma_f32_16x16x32_bf16 v[212:215], v[8:11], a[84:87], v[212:215]
    buffer_load_dwordx4 a[168:171], v2, s[4:7], s68 offen offset:2048 sc1
    s_waitcnt vmcnt(20)
    v_mfma_f32_16x16x32_bf16 v[216:219], v[8:11], a[88:91], v[216:219]
    s_waitcnt vmcnt(19)
    v_mfma_f32_16x16x32_bf16 v[220:223], v[8:11], a[92:95], v[220:223]
    s_waitcnt lgkmcnt(3)
    v_mfma_f32_16x16x32_bf16 v[224:227], v[12:15], a[80:83], v[224:227]
    ds_read_b128 v[28:31], v7 offset:19456
    v_mfma_f32_16x16x32_bf16 v[228:231], v[12:15], a[84:87], v[228:231]
    buffer_load_dwordx4 a[172:175], v2, s[4:7], s69 offen offset:2048 sc1
    v_mfma_f32_16x16x32_bf16 v[232:235], v[12:15], a[88:91], v[232:235]
    v_mfma_f32_16x16x32_bf16 v[236:239], v[12:15], a[92:95], v[236:239]
    s_waitcnt lgkmcnt(3)
    v_mfma_f32_16x16x32_bf16 v[64:67], v[16:19], a[80:83], v[64:67]
    ds_read_b128 v[8:11], v4 offset:12288
    v_mfma_f32_16x16x32_bf16 v[68:71], v[16:19], a[84:87], v[68:71]
    buffer_load_dwordx4 a[176:179], v2, s[4:7], s59 offen offset:3072 sc1
    v_mfma_f32_16x16x32_bf16 v[72:75], v[16:19], a[88:91], v[72:75]
    v_mfma_f32_16x16x32_bf16 v[76:79], v[16:19], a[92:95], v[76:79]
    s_waitcnt lgkmcnt(3)
    v_mfma_f32_16x16x32_bf16 v[80:83], v[20:23], a[80:83], v[80:83]
    ds_read_b128 v[12:15], v4 offset:13312
    v_mfma_f32_16x16x32_bf16 v[84:87], v[20:23], a[84:87], v[84:87]
    buffer_load_dwordx4 a[180:183], v2, s[4:7], s66 offen offset:3072 sc1
    v_mfma_f32_16x16x32_bf16 v[88:91], v[20:23], a[88:91], v[88:91]
    v_mfma_f32_16x16x32_bf16 v[92:95], v[20:23], a[92:95], v[92:95]
    s_waitcnt lgkmcnt(3)
    v_mfma_f32_16x16x32_bf16 v[96:99], v[24:27], a[80:83], v[96:99]
    ds_read_b128 v[16:19], v4 offset:49152
    v_mfma_f32_16x16x32_bf16 v[100:103], v[24:27], a[84:87], v[100:103]
    buffer_load_dwordx4 a[184:187], v2, s[4:7], s68 offen offset:3072 sc1
    v_mfma_f32_16x16x32_bf16 v[104:107], v[24:27], a[88:91], v[104:107]
    v_mfma_f32_16x16x32_bf16 v[108:111], v[24:27], a[92:95], v[108:111]
    s_waitcnt lgkmcnt(3)
    v_mfma_f32_16x16x32_bf16 v[112:115], v[28:31], a[80:83], v[112:115]
    ds_read_b128 v[20:23], v4 offset:50176
    v_mfma_f32_16x16x32_bf16 v[116:119], v[28:31], a[84:87], v[116:119]
    buffer_load_dwordx4 a[188:191], v2, s[4:7], s69 offen offset:3072 sc1
    v_mfma_f32_16x16x32_bf16 v[120:123], v[28:31], a[88:91], v[120:123]
    s_add_u32 s59, s50, 12288
    v_mfma_f32_16x16x32_bf16 v[124:127], v[28:31], a[92:95], v[124:127]
    s_waitcnt vmcnt(23) lgkmcnt(3)
    v_mfma_f32_16x16x32_bf16 v[208:211], v[8:11], a[96:99], v[208:211]
    s_waitcnt vmcnt(22)
    ds_read_b128 v[24:27], v7 offset:20480
    v_mfma_f32_16x16x32_bf16 v[212:215], v[8:11], a[100:103], v[212:215]
    buffer_load_dwordx4 a[192:195], v2, s[4:7], s59 offen offset:0 sc1
    s_waitcnt vmcnt(22)
    v_mfma_f32_16x16x32_bf16 v[216:219], v[8:11], a[104:107], v[216:219]
    s_waitcnt vmcnt(21)
    s_add_u32 s66, s50, 30720
    v_mfma_f32_16x16x32_bf16 v[220:223], v[8:11], a[108:111], v[220:223]
    s_waitcnt lgkmcnt(3)
    v_mfma_f32_16x16x32_bf16 v[224:227], v[12:15], a[96:99], v[224:227]
    ds_read_b128 v[28:31], v7 offset:21504
    v_mfma_f32_16x16x32_bf16 v[228:231], v[12:15], a[100:103], v[228:231]
    buffer_load_dwordx4 a[196:199], v2, s[4:7], s66 offen offset:0 sc1
    v_mfma_f32_16x16x32_bf16 v[232:235], v[12:15], a[104:107], v[232:235]
    s_add_u32 s68, s50, 49152
    v_mfma_f32_16x16x32_bf16 v[236:239], v[12:15], a[108:111], v[236:239]
    s_waitcnt lgkmcnt(3)
    v_mfma_f32_16x16x32_bf16 v[64:67], v[16:19], a[96:99], v[64:67]
    ds_read_b128 v[8:11], v4 offset:14336
    v_mfma_f32_16x16x32_bf16 v[68:71], v[16:19], a[100:103], v[68:71]
    buffer_load_dwordx4 a[200:203], v2, s[4:7], s68 offen offset:0 sc1
    v_mfma_f32_16x16x32_bf16 v[72:75], v[16:19], a[104:107], v[72:75]
    s_add_u32 s69, s50, 67584
    v_mfma_f32_16x16x32_bf16 v[76:79], v[16:19], a[108:111], v[76:79]
    s_waitcnt lgkmcnt(3)
    v_mfma_f32_16x16x32_bf16 v[80:83], v[20:23], a[96:99], v[80:83]
    ds_read_b128 v[12:15], v4 offset:15360
    v_mfma_f32_16x16x32_bf16 v[84:87], v[20:23], a[100:103], v[84:87]
    buffer_load_dwordx4 a[204:207], v2, s[4:7], s69 offen offset:0 sc1
    v_mfma_f32_16x16x32_bf16 v[88:91], v[20:23], a[104:107], v[88:91]
    v_mfma_f32_16x16x32_bf16 v[92:95], v[20:23], a[108:111], v[92:95]
    s_waitcnt lgkmcnt(3)
    v_mfma_f32_16x16x32_bf16 v[96:99], v[24:27], a[96:99], v[96:99]
    ds_read_b128 v[16:19], v4 offset:51200
    v_mfma_f32_16x16x32_bf16 v[100:103], v[24:27], a[100:103], v[100:103]
    buffer_load_dwordx4 a[208:211], v2, s[4:7], s59 offen offset:1024 sc1
    v_mfma_f32_16x16x32_bf16 v[104:107], v[24:27], a[104:107], v[104:107]
    v_mfma_f32_16x16x32_bf16 v[108:111], v[24:27], a[108:111], v[108:111]
    s_waitcnt lgkmcnt(3)
    v_mfma_f32_16x16x32_bf16 v[112:115], v[28:31], a[96:99], v[112:115]
    ds_read_b128 v[20:23], v4 offset:52224
    v_mfma_f32_16x16x32_bf16 v[116:119], v[28:31], a[100:103], v[116:119]
    buffer_load_dwordx4 a[212:215], v2, s[4:7], s66 offen offset:1024 sc1
    v_mfma_f32_16x16x32_bf16 v[120:123], v[28:31], a[104:107], v[120:123]
    v_mfma_f32_16x16x32_bf16 v[124:127], v[28:31], a[108:111], v[124:127]
    s_waitcnt vmcnt(25) lgkmcnt(3)
    v_mfma_f32_16x16x32_bf16 v[208:211], v[8:11], a[112:115], v[208:211]
    s_waitcnt vmcnt(24)
    ds_read_b128 v[24:27], v7 offset:22528
    v_mfma_f32_16x16x32_bf16 v[212:215], v[8:11], a[116:119], v[212:215]
    buffer_load_dwordx4 a[216:219], v2, s[4:7], s68 offen offset:1024 sc1
    s_waitcnt vmcnt(24)
    v_mfma_f32_16x16x32_bf16 v[216:219], v[8:11], a[120:123], v[216:219]
    s_waitcnt vmcnt(23)
    v_mfma_f32_16x16x32_bf16 v[220:223], v[8:11], a[124:127], v[220:223]
    s_waitcnt lgkmcnt(3)
    v_mfma_f32_16x16x32_bf16 v[224:227], v[12:15], a[112:115], v[224:227]
    ds_read_b128 v[28:31], v7 offset:23552
    v_mfma_f32_16x16x32_bf16 v[228:231], v[12:15], a[116:119], v[228:231]
    buffer_load_dwordx4 a[220:223], v2, s[4:7], s69 offen offset:1024 sc1
    v_mfma_f32_16x16x32_bf16 v[232:235], v[12:15], a[120:123], v[232:235]
    v_mfma_f32_16x16x32_bf16 v[236:239], v[12:15], a[124:127], v[236:239]
    s_waitcnt lgkmcnt(3)
    v_mfma_f32_16x16x32_bf16 v[64:67], v[16:19], a[112:115], v[64:67]
    ds_read_b128 v[8:11], v4 offset:16384
    v_mfma_f32_16x16x32_bf16 v[68:71], v[16:19], a[116:119], v[68:71]
    buffer_load_dwordx4 a[224:227], v2, s[4:7], s59 offen offset:2048 sc1
    v_mfma_f32_16x16x32_bf16 v[72:75], v[16:19], a[120:123], v[72:75]
    v_mfma_f32_16x16x32_bf16 v[76:79], v[16:19], a[124:127], v[76:79]
    s_waitcnt lgkmcnt(3)
    v_mfma_f32_16x16x32_bf16 v[80:83], v[20:23], a[112:115], v[80:83]
    ds_read_b128 v[12:15], v4 offset:17408
    v_mfma_f32_16x16x32_bf16 v[84:87], v[20:23], a[116:119], v[84:87]
    buffer_load_dwordx4 a[228:231], v2, s[4:7], s66 offen offset:2048 sc1
    v_mfma_f32_16x16x32_bf16 v[88:91], v[20:23], a[120:123], v[88:91]
    v_mfma_f32_16x16x32_bf16 v[92:95], v[20:23], a[124:127], v[92:95]
    s_waitcnt lgkmcnt(3)
    v_mfma_f32_16x16x32_bf16 v[96:99], v[24:27], a[112:115], v[96:99]
    ds_read_b128 v[16:19], v4 offset:53248
    v_mfma_f32_16x16x32_bf16 v[100:103], v[24:27], a[116:119], v[100:103]
    buffer_load_dwordx4 a[232:235], v2, s[4:7], s68 offen offset:2048 sc1
    v_mfma_f32_16x16x32_bf16 v[104:107], v[24:27], a[120:123], v[104:107]
    v_mfma_f32_16x16x32_bf16 v[108:111], v[24:27], a[124:127], v[108:111]
    s_waitcnt lgkmcnt(3)
    v_mfma_f32_16x16x32_bf16 v[112:115], v[28:31], a[112:115], v[112:115]
    ds_read_b128 v[20:23], v4 offset:54272
    v_mfma_f32_16x16x32_bf16 v[116:119], v[28:31], a[116:119], v[116:119]
    buffer_load_dwordx4 a[236:239], v2, s[4:7], s69 offen offset:2048 sc1
    v_mfma_f32_16x16x32_bf16 v[120:123], v[28:31], a[120:123], v[120:123]
    v_mfma_f32_16x16x32_bf16 v[124:127], v[28:31], a[124:127], v[124:127]
    s_waitcnt vmcnt(27) lgkmcnt(3)
    v_mfma_f32_16x16x32_bf16 v[208:211], v[8:11], a[128:131], v[208:211]
    s_waitcnt vmcnt(26)
    ds_read_b128 v[24:27], v7 offset:24576
    v_mfma_f32_16x16x32_bf16 v[212:215], v[8:11], a[132:135], v[212:215]
    buffer_load_dwordx4 a[240:243], v2, s[4:7], s59 offen offset:3072 sc1
    s_waitcnt vmcnt(26)
    v_mfma_f32_16x16x32_bf16 v[216:219], v[8:11], a[136:139], v[216:219]
    s_waitcnt vmcnt(25)
    v_mfma_f32_16x16x32_bf16 v[220:223], v[8:11], a[140:143], v[220:223]
    s_waitcnt lgkmcnt(3)
    v_mfma_f32_16x16x32_bf16 v[224:227], v[12:15], a[128:131], v[224:227]
    ds_read_b128 v[28:31], v7 offset:25600
    v_mfma_f32_16x16x32_bf16 v[228:231], v[12:15], a[132:135], v[228:231]
    buffer_load_dwordx4 a[244:247], v2, s[4:7], s66 offen offset:3072 sc1
    v_mfma_f32_16x16x32_bf16 v[232:235], v[12:15], a[136:139], v[232:235]
    v_mfma_f32_16x16x32_bf16 v[236:239], v[12:15], a[140:143], v[236:239]
    s_waitcnt lgkmcnt(3)
    s_add_u32 m0, s49, 110592
    s_add_u32 s61, s48, 110592
    v_mfma_f32_16x16x32_bf16 v[64:67], v[16:19], a[128:131], v[64:67]
    ds_read_b128 v[8:11], v4 offset:18432
    v_mfma_f32_16x16x32_bf16 v[68:71], v[16:19], a[132:135], v[68:71]
    buffer_load_dwordx4 a[248:251], v2, s[4:7], s68 offen offset:3072 sc1
    v_mfma_f32_16x16x32_bf16 v[72:75], v[16:19], a[136:139], v[72:75]
    v_mfma_f32_16x16x32_bf16 v[76:79], v[16:19], a[140:143], v[76:79]
    s_waitcnt lgkmcnt(3)
    v_mfma_f32_16x16x32_bf16 v[80:83], v[20:23], a[128:131], v[80:83]
    ds_read_b128 v[12:15], v4 offset:19456
    v_mfma_f32_16x16x32_bf16 v[84:87], v[20:23], a[132:135], v[84:87]
    buffer_load_dwordx4 a[252:255], v2, s[4:7], s69 offen offset:3072 sc1
    v_mfma_f32_16x16x32_bf16 v[88:91], v[20:23], a[136:139], v[88:91]
    s_add_u32 s59, s50, 16384
    v_mfma_f32_16x16x32_bf16 v[92:95], v[20:23], a[140:143], v[92:95]
    s_waitcnt lgkmcnt(3)
    v_mfma_f32_16x16x32_bf16 v[96:99], v[24:27], a[128:131], v[96:99]
    ds_read_b128 v[16:19], v4 offset:55296
    v_mfma_f32_16x16x32_bf16 v[100:103], v[24:27], a[132:135], v[100:103]
    buffer_load_dwordx4 v[32:35], v2, s[4:7], s59 offen offset:0 sc1
    v_mfma_f32_16x16x32_bf16 v[104:107], v[24:27], a[136:139], v[104:107]
    s_add_u32 s66, s50, 34816
    v_mfma_f32_16x16x32_bf16 v[108:111], v[24:27], a[140:143], v[108:111]
    s_waitcnt lgkmcnt(3)
    v_mfma_f32_16x16x32_bf16 v[112:115], v[28:31], a[128:131], v[112:115]
    ds_read_b128 v[20:23], v4 offset:56320
    v_mfma_f32_16x16x32_bf16 v[116:119], v[28:31], a[132:135], v[116:119]
    buffer_load_dwordx4 v[36:39], v2, s[4:7], s66 offen offset:0 sc1
    v_mfma_f32_16x16x32_bf16 v[120:123], v[28:31], a[136:139], v[120:123]
    s_add_u32 s68, s50, 53248
    v_mfma_f32_16x16x32_bf16 v[124:127], v[28:31], a[140:143], v[124:127]
    s_waitcnt vmcnt(29) lgkmcnt(3)
    v_mfma_f32_16x16x32_bf16 v[208:211], v[8:11], a[144:147], v[208:211]
    s_waitcnt vmcnt(28)
    ds_read_b128 v[24:27], v7 offset:26624
    v_mfma_f32_16x16x32_bf16 v[212:215], v[8:11], a[148:151], v[212:215]
    buffer_load_dwordx4 v[40:43], v2, s[4:7], s68 offen offset:0 sc1
    s_waitcnt vmcnt(28)
    v_mfma_f32_16x16x32_bf16 v[216:219], v[8:11], a[152:155], v[216:219]
    s_waitcnt vmcnt(27)
    s_add_u32 s69, s50, 71680
    v_mfma_f32_16x16x32_bf16 v[220:223], v[8:11], a[156:159], v[220:223]
    s_waitcnt lgkmcnt(3)
    v_mfma_f32_16x16x32_bf16 v[224:227], v[12:15], a[144:147], v[224:227]
    ds_read_b128 v[28:31], v7 offset:27648
    v_mfma_f32_16x16x32_bf16 v[228:231], v[12:15], a[148:151], v[228:231]
    buffer_load_dwordx4 v[44:47], v2, s[4:7], s69 offen offset:0 sc1
    v_mfma_f32_16x16x32_bf16 v[232:235], v[12:15], a[152:155], v[232:235]
    v_mfma_f32_16x16x32_bf16 v[236:239], v[12:15], a[156:159], v[236:239]
    s_waitcnt lgkmcnt(3)
    v_mfma_f32_16x16x32_bf16 v[64:67], v[16:19], a[144:147], v[64:67]
    ds_read_b128 v[8:11], v4 offset:20480
    v_mfma_f32_16x16x32_bf16 v[68:71], v[16:19], a[148:151], v[68:71]
    buffer_load_dwordx4 v2, s[4:7], s61 offen offset:0 lds
    v_mfma_f32_16x16x32_bf16 v[72:75], v[16:19], a[152:155], v[72:75]
    v_mfma_f32_16x16x32_bf16 v[76:79], v[16:19], a[156:159], v[76:79]
    s_waitcnt lgkmcnt(3)
    v_mfma_f32_16x16x32_bf16 v[80:83], v[20:23], a[144:147], v[80:83]
    ds_read_b128 v[12:15], v4 offset:21504
    v_mfma_f32_16x16x32_bf16 v[84:87], v[20:23], a[148:151], v[84:87]
    buffer_load_dwordx4 v2, s[4:7], s61 offen offset:1024 lds
    v_mfma_f32_16x16x32_bf16 v[88:91], v[20:23], a[152:155], v[88:91]
    v_mfma_f32_16x16x32_bf16 v[92:95], v[20:23], a[156:159], v[92:95]
    s_waitcnt lgkmcnt(3)
    v_mfma_f32_16x16x32_bf16 v[96:99], v[24:27], a[144:147], v[96:99]
    ds_read_b128 v[16:19], v4 offset:57344
    v_mfma_f32_16x16x32_bf16 v[100:103], v[24:27], a[148:151], v[100:103]
    buffer_load_dwordx4 v2, s[4:7], s61 offen offset:2048 lds
    v_mfma_f32_16x16x32_bf16 v[104:107], v[24:27], a[152:155], v[104:107]
    v_mfma_f32_16x16x32_bf16 v[108:111], v[24:27], a[156:159], v[108:111]
    s_waitcnt lgkmcnt(3)
    v_mfma_f32_16x16x32_bf16 v[112:115], v[28:31], a[144:147], v[112:115]
    ds_read_b128 v[20:23], v4 offset:58368
    v_mfma_f32_16x16x32_bf16 v[116:119], v[28:31], a[148:151], v[116:119]
    buffer_load_dwordx4 v2, s[4:7], s61 offen offset:3072 lds
    v_mfma_f32_16x16x32_bf16 v[120:123], v[28:31], a[152:155], v[120:123]
    s_add_u32 m0, s49, 114688
    s_add_u32 s61, s48, 114688
    v_mfma_f32_16x16x32_bf16 v[124:127], v[28:31], a[156:159], v[124:127]
    s_waitcnt vmcnt(31) lgkmcnt(3)
    v_mfma_f32_16x16x32_bf16 v[208:211], v[8:11], a[160:163], v[208:211]
    s_waitcnt vmcnt(30)
    ds_read_b128 v[24:27], v7 offset:28672
    v_mfma_f32_16x16x32_bf16 v[212:215], v[8:11], a[164:167], v[212:215]
    buffer_load_dwordx4 v2, s[4:7], s61 offen offset:0 lds
    s_waitcnt vmcnt(30)
    v_mfma_f32_16x16x32_bf16 v[216:219], v[8:11], a[168:171], v[216:219]
    s_waitcnt vmcnt(29)
    v_mfma_f32_16x16x32_bf16 v[220:223], v[8:11], a[172:175], v[220:223]
    s_waitcnt lgkmcnt(3)
    v_mfma_f32_16x16x32_bf16 v[224:227], v[12:15], a[160:163], v[224:227]
    ds_read_b128 v[28:31], v7 offset:29696
    v_mfma_f32_16x16x32_bf16 v[228:231], v[12:15], a[164:167], v[228:231]
    buffer_load_dwordx4 v2, s[4:7], s61 offen offset:1024 lds
    v_mfma_f32_16x16x32_bf16 v[232:235], v[12:15], a[168:171], v[232:235]
    v_mfma_f32_16x16x32_bf16 v[236:239], v[12:15], a[172:175], v[236:239]
    s_waitcnt lgkmcnt(3)
    v_mfma_f32_16x16x32_bf16 v[64:67], v[16:19], a[160:163], v[64:67]
    ds_read_b128 v[8:11], v4 offset:22528
    v_mfma_f32_16x16x32_bf16 v[68:71], v[16:19], a[164:167], v[68:71]
    buffer_load_dwordx4 v2, s[4:7], s61 offen offset:2048 lds
    v_mfma_f32_16x16x32_bf16 v[72:75], v[16:19], a[168:171], v[72:75]
    v_mfma_f32_16x16x32_bf16 v[76:79], v[16:19], a[172:175], v[76:79]
    s_waitcnt lgkmcnt(3)
    v_mfma_f32_16x16x32_bf16 v[80:83], v[20:23], a[160:163], v[80:83]
    ds_read_b128 v[12:15], v4 offset:23552
    v_mfma_f32_16x16x32_bf16 v[84:87], v[20:23], a[164:167], v[84:87]
    buffer_load_dwordx4 v2, s[4:7], s61 offen offset:3072 lds
    v_mfma_f32_16x16x32_bf16 v[88:91], v[20:23], a[168:171], v[88:91]
    s_add_u32 m0, s49, 118784
    s_add_u32 s61, s48, 118784
    v_mfma_f32_16x16x32_bf16 v[92:95], v[20:23], a[172:175], v[92:95]
    s_waitcnt lgkmcnt(3)
    v_mfma_f32_16x16x32_bf16 v[96:99], v[24:27], a[160:163], v[96:99]
    ds_read_b128 v[16:19], v4 offset:59392
    v_mfma_f32_16x16x32_bf16 v[100:103], v[24:27], a[164:167], v[100:103]
    buffer_load_dwordx4 v2, s[4:7], s61 offen offset:0 lds
    v_mfma_f32_16x16x32_bf16 v[104:107], v[24:27], a[168:171], v[104:107]
    v_mfma_f32_16x16x32_bf16 v[108:111], v[24:27], a[172:175], v[108:111]
    s_waitcnt lgkmcnt(3)
    v_mfma_f32_16x16x32_bf16 v[112:115], v[28:31], a[160:163], v[112:115]
    ds_read_b128 v[20:23], v4 offset:60416
    v_mfma_f32_16x16x32_bf16 v[116:119], v[28:31], a[164:167], v[116:119]
    buffer_load_dwordx4 v[48:51], v2, s[4:7], s59 offen offset:1024 sc1
    v_mfma_f32_16x16x32_bf16 v[120:123], v[28:31], a[168:171], v[120:123]
    v_mfma_f32_16x16x32_bf16 v[124:127], v[28:31], a[172:175], v[124:127]
    s_waitcnt vmcnt(33) lgkmcnt(3)
    v_mfma_f32_16x16x32_bf16 v[208:211], v[8:11], a[176:179], v[208:211]
    s_waitcnt vmcnt(32)
    ds_read_b128 v[24:27], v7 offset:30720
    v_mfma_f32_16x16x32_bf16 v[212:215], v[8:11], a[180:183], v[212:215]
    buffer_load_dwordx4 v[52:55], v2, s[4:7], s66 offen offset:1024 sc1
    s_waitcnt vmcnt(32)
    v_mfma_f32_16x16x32_bf16 v[216:219], v[8:11], a[184:187], v[216:219]
    s_waitcnt vmcnt(31)
    v_mfma_f32_16x16x32_bf16 v[220:223], v[8:11], a[188:191], v[220:223]
    s_waitcnt lgkmcnt(3)
    v_mfma_f32_16x16x32_bf16 v[224:227], v[12:15], a[176:179], v[224:227]
    ds_read_b128 v[28:31], v7 offset:31744
    v_mfma_f32_16x16x32_bf16 v[228:231], v[12:15], a[180:183], v[228:231]
    buffer_load_dwordx4 v[56:59], v2, s[4:7], s68 offen offset:1024 sc1
    v_mfma_f32_16x16x32_bf16 v[232:235], v[12:15], a[184:187], v[232:235]
    v_mfma_f32_16x16x32_bf16 v[236:239], v[12:15], a[188:191], v[236:239]
    s_waitcnt lgkmcnt(3)
    v_mfma_f32_16x16x32_bf16 v[64:67], v[16:19], a[176:179], v[64:67]
    ds_read_b128 v[8:11], v4 offset:24576
    v_mfma_f32_16x16x32_bf16 v[68:71], v[16:19], a[180:183], v[68:71]
    buffer_load_dwordx4 v[60:63], v2, s[4:7], s69 offen offset:1024 sc1
    v_mfma_f32_16x16x32_bf16 v[72:75], v[16:19], a[184:187], v[72:75]
    v_mfma_f32_16x16x32_bf16 v[76:79], v[16:19], a[188:191], v[76:79]
    s_waitcnt lgkmcnt(3)
    v_mfma_f32_16x16x32_bf16 v[80:83], v[20:23], a[176:179], v[80:83]
    ds_read_b128 v[12:15], v4 offset:25600
    v_mfma_f32_16x16x32_bf16 v[84:87], v[20:23], a[180:183], v[84:87]
    v_mfma_f32_16x16x32_bf16 v[88:91], v[20:23], a[184:187], v[88:91]
    v_mfma_f32_16x16x32_bf16 v[92:95], v[20:23], a[188:191], v[92:95]
    s_waitcnt lgkmcnt(3)
    v_mfma_f32_16x16x32_bf16 v[96:99], v[24:27], a[176:179], v[96:99]
    ds_read_b128 v[16:19], v4 offset:61440
    v_mfma_f32_16x16x32_bf16 v[100:103], v[24:27], a[180:183], v[100:103]
    v_mfma_f32_16x16x32_bf16 v[104:107], v[24:27], a[184:187], v[104:107]
    v_mfma_f32_16x16x32_bf16 v[108:111], v[24:27], a[188:191], v[108:111]
    s_waitcnt lgkmcnt(3)
    v_mfma_f32_16x16x32_bf16 v[112:115], v[28:31], a[176:179], v[112:115]
    ds_read_b128 v[20:23], v4 offset:62464
    v_mfma_f32_16x16x32_bf16 v[116:119], v[28:31], a[180:183], v[116:119]
    v_mfma_f32_16x16x32_bf16 v[120:123], v[28:31], a[184:187], v[120:123]
    v_mfma_f32_16x16x32_bf16 v[124:127], v[28:31], a[188:191], v[124:127]
    s_waitcnt vmcnt(32) lgkmcnt(3)
    v_mfma_f32_16x16x32_bf16 v[208:211], v[8:11], a[192:195], v[208:211]
    s_waitcnt vmcnt(31)
    ds_read_b128 v[24:27], v7 offset:32768
    v_mfma_f32_16x16x32_bf16 v[212:215], v[8:11], a[196:199], v[212:215]
    s_waitcnt vmcnt(30)
    v_mfma_f32_16x16x32_bf16 v[216:219], v[8:11], a[200:203], v[216:219]
    s_waitcnt vmcnt(29)
    v_mfma_f32_16x16x32_bf16 v[220:223], v[8:11], a[204:207], v[220:223]
    s_waitcnt lgkmcnt(3)
    v_mfma_f32_16x16x32_bf16 v[224:227], v[12:15], a[192:195], v[224:227]
    ds_read_b128 v[28:31], v7 offset:33792
    v_mfma_f32_16x16x32_bf16 v[228:231], v[12:15], a[196:199], v[228:231]
    v_mfma_f32_16x16x32_bf16 v[232:235], v[12:15], a[200:203], v[232:235]
    v_mfma_f32_16x16x32_bf16 v[236:239], v[12:15], a[204:207], v[236:239]
    s_waitcnt lgkmcnt(3)
    v_mfma_f32_16x16x32_bf16 v[64:67], v[16:19], a[192:195], v[64:67]
    ds_read_b128 v[8:11], v4 offset:26624
    v_mfma_f32_16x16x32_bf16 v[68:71], v[16:19], a[196:199], v[68:71]
    v_mfma_f32_16x16x32_bf16 v[72:75], v[16:19], a[200:203], v[72:75]
    v_mfma_f32_16x16x32_bf16 v[76:79], v[16:19], a[204:207], v[76:79]
    s_waitcnt lgkmcnt(3)
    v_mfma_f32_16x16x32_bf16 v[80:83], v[20:23], a[192:195], v[80:83]
    ds_read_b128 v[12:15], v4 offset:27648
    v_mfma_f32_16x16x32_bf16 v[84:87], v[20:23], a[196:199], v[84:87]
    v_mfma_f32_16x16x32_bf16 v[88:91], v[20:23], a[200:203], v[88:91]
    v_mfma_f32_16x16x32_bf16 v[92:95], v[20:23], a[204:207], v[92:95]
    s_waitcnt lgkmcnt(3)
    v_mfma_f32_16x16x32_bf16 v[96:99], v[24:27], a[192:195], v[96:99]
    ds_read_b128 v[16:19], v4 offset:63488
    v_mfma_f32_16x16x32_bf16 v[100:103], v[24:27], a[196:199], v[100:103]
    v_mfma_f32_16x16x32_bf16 v[104:107], v[24:27], a[200:203], v[104:107]
    v_mfma_f32_16x16x32_bf16 v[108:111], v[24:27], a[204:207], v[108:111]
    s_waitcnt lgkmcnt(3)
    v_mfma_f32_16x16x32_bf16 v[112:115], v[28:31], a[192:195], v[112:115]
    ds_read_b128 v[20:23], v4 offset:64512
    v_mfma_f32_16x16x32_bf16 v[116:119], v[28:31], a[196:199], v[116:119]
    v_mfma_f32_16x16x32_bf16 v[120:123], v[28:31], a[200:203], v[120:123]
    v_mfma_f32_16x16x32_bf16 v[124:127], v[28:31], a[204:207], v[124:127]
    s_waitcnt vmcnt(28) lgkmcnt(3)
    v_mfma_f32_16x16x32_bf16 v[208:211], v[8:11], a[208:211], v[208:211]
    s_waitcnt vmcnt(27)
    ds_read_b128 v[24:27], v7 offset:34816
    v_mfma_f32_16x16x32_bf16 v[212:215], v[8:11], a[212:215], v[212:215]
    s_waitcnt vmcnt(26)
    v_mfma_f32_16x16x32_bf16 v[216:219], v[8:11], a[216:219], v[216:219]
    s_waitcnt vmcnt(25)
    v_mfma_f32_16x16x32_bf16 v[220:223], v[8:11], a[220:223], v[220:223]
    s_waitcnt lgkmcnt(3)
    v_mfma_f32_16x16x32_bf16 v[224:227], v[12:15], a[208:211], v[224:227]
    ds_read_b128 v[28:31], v7 offset:35840
    v_mfma_f32_16x16x32_bf16 v[228:231], v[12:15], a[212:215], v[228:231]
    v_mfma_f32_16x16x32_bf16 v[232:235], v[12:15], a[216:219], v[232:235]
    v_mfma_f32_16x16x32_bf16 v[236:239], v[12:15], a[220:223], v[236:239]
    s_waitcnt lgkmcnt(3)
    v_mfma_f32_16x16x32_bf16 v[64:67], v[16:19], a[208:211], v[64:67]
    ds_read_b128 v[8:11], v4 offset:28672
    v_mfma_f32_16x16x32_bf16 v[68:71], v[16:19], a[212:215], v[68:71]
    v_mfma_f32_16x16x32_bf16 v[72:75], v[16:19], a[216:219], v[72:75]
    v_mfma_f32_16x16x32_bf16 v[76:79], v[16:19], a[220:223], v[76:79]
    s_waitcnt lgkmcnt(3)
    v_mfma_f32_16x16x32_bf16 v[80:83], v[20:23], a[208:211], v[80:83]
    ds_read_b128 v[12:15], v4 offset:29696
    v_mfma_f32_16x16x32_bf16 v[84:87], v[20:23], a[212:215], v[84:87]
    v_mfma_f32_16x16x32_bf16 v[88:91], v[20:23], a[216:219], v[88:91]
    v_mfma_f32_16x16x32_bf16 v[92:95], v[20:23], a[220:223], v[92:95]
    s_waitcnt lgkmcnt(3)
    v_mfma_f32_16x16x32_bf16 v[96:99], v[24:27], a[208:211], v[96:99]
    ds_read_b128 v[16:19], v7 offset:0
    v_mfma_f32_16x16x32_bf16 v[100:103], v[24:27], a[212:215], v[100:103]
    v_mfma_f32_16x16x32_bf16 v[104:107], v[24:27], a[216:219], v[104:107]
    v_mfma_f32_16x16x32_bf16 v[108:111], v[24:27], a[220:223], v[108:111]
    s_waitcnt lgkmcnt(3)
    v_mfma_f32_16x16x32_bf16 v[112:115], v[28:31], a[208:211], v[112:115]
    ds_read_b128 v[20:23], v7 offset:1024
    v_mfma_f32_16x16x32_bf16 v[116:119], v[28:31], a[212:215], v[116:119]
    v_mfma_f32_16x16x32_bf16 v[120:123], v[28:31], a[216:219], v[120:123]
    v_mfma_f32_16x16x32_bf16 v[124:127], v[28:31], a[220:223], v[124:127]
    s_waitcnt vmcnt(24) lgkmcnt(3)
    v_mfma_f32_16x16x32_bf16 v[208:211], v[8:11], a[224:227], v[208:211]
    s_waitcnt vmcnt(23)
    ds_read_b128 v[24:27], v7 offset:36864
    v_mfma_f32_16x16x32_bf16 v[212:215], v[8:11], a[228:231], v[212:215]
    s_waitcnt vmcnt(22)
    v_mfma_f32_16x16x32_bf16 v[216:219], v[8:11], a[232:235], v[216:219]
    s_waitcnt vmcnt(21)
    v_mfma_f32_16x16x32_bf16 v[220:223], v[8:11], a[236:239], v[220:223]
    s_waitcnt lgkmcnt(3)
    v_mfma_f32_16x16x32_bf16 v[224:227], v[12:15], a[224:227], v[224:227]
    ds_read_b128 v[28:31], v7 offset:37888
    v_mfma_f32_16x16x32_bf16 v[228:231], v[12:15], a[228:231], v[228:231]
    v_mfma_f32_16x16x32_bf16 v[232:235], v[12:15], a[232:235], v[232:235]
    v_mfma_f32_16x16x32_bf16 v[236:239], v[12:15], a[236:239], v[236:239]
    s_waitcnt lgkmcnt(3)
    v_mfma_f32_16x16x32_bf16 v[64:67], v[16:19], a[224:227], v[64:67]
    ds_read_b128 v[8:11], v4 offset:30720
    v_mfma_f32_16x16x32_bf16 v[68:71], v[16:19], a[228:231], v[68:71]
    v_mfma_f32_16x16x32_bf16 v[72:75], v[16:19], a[232:235], v[72:75]
    v_mfma_f32_16x16x32_bf16 v[76:79], v[16:19], a[236:239], v[76:79]
    s_waitcnt lgkmcnt(3)
    v_mfma_f32_16x16x32_bf16 v[80:83], v[20:23], a[224:227], v[80:83]
    ds_read_b128 v[12:15], v4 offset:31744
    v_mfma_f32_16x16x32_bf16 v[84:87], v[20:23], a[228:231], v[84:87]
    v_mfma_f32_16x16x32_bf16 v[88:91], v[20:23], a[232:235], v[88:91]
    v_mfma_f32_16x16x32_bf16 v[92:95], v[20:23], a[236:239], v[92:95]
    s_waitcnt lgkmcnt(3)
    v_mfma_f32_16x16x32_bf16 v[96:99], v[24:27], a[224:227], v[96:99]
    ds_read_b128 v[16:19], v7 offset:2048
    v_mfma_f32_16x16x32_bf16 v[100:103], v[24:27], a[228:231], v[100:103]
    v_mfma_f32_16x16x32_bf16 v[104:107], v[24:27], a[232:235], v[104:107]
    v_mfma_f32_16x16x32_bf16 v[108:111], v[24:27], a[236:239], v[108:111]
    s_waitcnt lgkmcnt(3)
    v_mfma_f32_16x16x32_bf16 v[112:115], v[28:31], a[224:227], v[112:115]
    ds_read_b128 v[20:23], v7 offset:3072
    v_mfma_f32_16x16x32_bf16 v[116:119], v[28:31], a[228:231], v[116:119]
    v_mfma_f32_16x16x32_bf16 v[120:123], v[28:31], a[232:235], v[120:123]
    v_mfma_f32_16x16x32_bf16 v[124:127], v[28:31], a[236:239], v[124:127]
    s_waitcnt vmcnt(20) lgkmcnt(3)
    v_mfma_f32_16x16x32_bf16 v[208:211], v[8:11], a[240:243], v[208:211]
    s_waitcnt vmcnt(19)
    ds_read_b128 v[24:27], v7 offset:38912
    v_mfma_f32_16x16x32_bf16 v[212:215], v[8:11], a[244:247], v[212:215]
    s_waitcnt vmcnt(18)
    v_mfma_f32_16x16x32_bf16 v[216:219], v[8:11], a[248:251], v[216:219]
    s_waitcnt vmcnt(17)
    v_mfma_f32_16x16x32_bf16 v[220:223], v[8:11], a[252:255], v[220:223]
    s_waitcnt lgkmcnt(3)
    v_mfma_f32_16x16x32_bf16 v[224:227], v[12:15], a[240:243], v[224:227]
    ds_read_b128 v[28:31], v7 offset:39936
    v_mfma_f32_16x16x32_bf16 v[228:231], v[12:15], a[244:247], v[228:231]
    v_mfma_f32_16x16x32_bf16 v[232:235], v[12:15], a[248:251], v[232:235]
    v_mfma_f32_16x16x32_bf16 v[236:239], v[12:15], a[252:255], v[236:239]
    s_waitcnt lgkmcnt(3)
    v_mfma_f32_16x16x32_bf16 v[64:67], v[16:19], a[240:243], v[64:67]
    ds_read_b128 v[8:11], v4 offset:32768
    v_mfma_f32_16x16x32_bf16 v[68:71], v[16:19], a[244:247], v[68:71]
    v_mfma_f32_16x16x32_bf16 v[72:75], v[16:19], a[248:251], v[72:75]
    v_mfma_f32_16x16x32_bf16 v[76:79], v[16:19], a[252:255], v[76:79]
    s_waitcnt lgkmcnt(3)
    v_mfma_f32_16x16x32_bf16 v[80:83], v[20:23], a[240:243], v[80:83]
    ds_read_b128 v[12:15], v4 offset:33792
    v_mfma_f32_16x16x32_bf16 v[84:87], v[20:23], a[244:247], v[84:87]
    v_mfma_f32_16x16x32_bf16 v[88:91], v[20:23], a[248:251], v[88:91]
    v_mfma_f32_16x16x32_bf16 v[92:95], v[20:23], a[252:255], v[92:95]
    s_waitcnt lgkmcnt(3)
    v_mfma_f32_16x16x32_bf16 v[96:99], v[24:27], a[240:243], v[96:99]
    ds_read_b128 v[16:19], v7 offset:4096
    v_mfma_f32_16x16x32_bf16 v[100:103], v[24:27], a[244:247], v[100:103]
    v_mfma_f32_16x16x32_bf16 v[104:107], v[24:27], a[248:251], v[104:107]
    v_mfma_f32_16x16x32_bf16 v[108:111], v[24:27], a[252:255], v[108:111]
    s_waitcnt lgkmcnt(3)
    v_mfma_f32_16x16x32_bf16 v[112:115], v[28:31], a[240:243], v[112:115]
    ds_read_b128 v[20:23], v7 offset:5120
    v_mfma_f32_16x16x32_bf16 v[116:119], v[28:31], a[244:247], v[116:119]
    v_add_f32 v166, v152, v154
    v_add_f32 v167, v153, v155
    v_mfma_f32_16x16x32_bf16 v[120:123], v[28:31], a[248:251], v[120:123]
    v_add_f32 v166, v166, v156
    v_add_f32 v167, v167, v157
    v_mfma_f32_16x16x32_bf16 v[124:127], v[28:31], a[252:255], v[124:127]
    s_waitcnt vmcnt(16) lgkmcnt(3)
    v_add_f32 v166, v166, v158
    v_add_f32 v167, v167, v159
    v_mfma_f32_16x16x32_bf16 v[208:211], v[8:11], v[32:35], v[208:211]
    s_waitcnt vmcnt(15)
    ds_read_b128 v[24:27], v7 offset:40960
    v_add_f32 v166, v166, v160
    v_mfma_f32_16x16x32_bf16 v[212:215], v[8:11], v[36:39], v[212:215]
    s_waitcnt vmcnt(14)
    v_add_f32 v167, v167, v161
    v_add_f32 v166, v166, v162
    v_mfma_f32_16x16x32_bf16 v[216:219], v[8:11], v[40:43], v[216:219]
    s_waitcnt vmcnt(13)
    v_add_f32 v167, v167, v163
    v_mul_f32 v166, 0xbae38e39, v166
    v_mfma_f32_16x16x32_bf16 v[220:223], v[8:11], v[44:47], v[220:223]
    s_waitcnt lgkmcnt(3)
    v_fmamk_f32 v165, v152, 0x3c2aaaab, v166
    v_mul_f32 v164, v165, v165
    v_mfma_f32_16x16x32_bf16 v[224:227], v[12:15], v[32:35], v[224:227]
    ds_read_b128 v[28:31], v7 offset:41984
    v_fmamk_f32 v165, v154, 0x3c2aaaab, v166
    v_mfma_f32_16x16x32_bf16 v[228:231], v[12:15], v[36:39], v[228:231]
    v_fmac_f32 v164, v165, v165
    v_fmamk_f32 v165, v156, 0x3c2aaaab, v166
    v_mfma_f32_16x16x32_bf16 v[232:235], v[12:15], v[40:43], v[232:235]
    v_fmac_f32 v164, v165, v165
    v_fmamk_f32 v165, v158, 0x3c2aaaab, v166
    v_mfma_f32_16x16x32_bf16 v[236:239], v[12:15], v[44:47], v[236:239]
    s_waitcnt lgkmcnt(3)
    v_fmac_f32 v164, v165, v165
    v_fmamk_f32 v165, v160, 0x3c2aaaab, v166
    v_mfma_f32_16x16x32_bf16 v[64:67], v[16:19], v[32:35], v[64:67]
    ds_read_b128 v[8:11], v4 offset:34816
    v_fmac_f32 v164, v165, v165
    v_mfma_f32_16x16x32_bf16 v[68:71], v[16:19], v[36:39], v[68:71]
    v_fmamk_f32 v165, v162, 0x3c2aaaab, v166
    v_fmac_f32 v164, v165, v165
    v_mfma_f32_16x16x32_bf16 v[72:75], v[16:19], v[40:43], v[72:75]
    v_fmac_f32 v167, 0x42c00000, v164
    v_mov_b32 v165, 0x3727c5ac
    v_mfma_f32_16x16x32_bf16 v[76:79], v[16:19], v[44:47], v[76:79]
    s_waitcnt lgkmcnt(3)
    v_fmac_f32 v165, 0x3ae38e39, v167
    v_rcp_f32 v167, v165
    v_mfma_f32_16x16x32_bf16 v[80:83], v[20:23], v[32:35], v[80:83]
    ds_read_b128 v[12:15], v4 offset:35840
    v_and_b32 v164, 15, v1
    v_mfma_f32_16x16x32_bf16 v[84:87], v[20:23], v[36:39], v[84:87]
    v_lshlrev_b32 v164, 2, v164
    v_mfma_f32_16x16x32_bf16 v[88:91], v[20:23], v[40:43], v[88:91]
    ds_bpermute_b32 v128, v164, v166 offset:0
    ds_bpermute_b32 v132, v164, v167 offset:0
    v_mfma_f32_16x16x32_bf16 v[92:95], v[20:23], v[44:47], v[92:95]
    s_waitcnt lgkmcnt(5)
    ds_bpermute_b32 v129, v164, v166 offset:64
    ds_bpermute_b32 v133, v164, v167 offset:64
    v_mfma_f32_16x16x32_bf16 v[96:99], v[24:27], v[32:35], v[96:99]
    ds_read_b128 v[16:19], v7 offset:6144
    ds_bpermute_b32 v130, v164, v166 offset:128
    v_mfma_f32_16x16x32_bf16 v[100:103], v[24:27], v[36:39], v[100:103]
    ds_bpermute_b32 v134, v164, v167 offset:128
    ds_bpermute_b32 v131, v164, v166 offset:192
    v_mfma_f32_16x16x32_bf16 v[104:107], v[24:27], v[40:43], v[104:107]
    ds_bpermute_b32 v135, v164, v167 offset:192
    v_mfma_f32_16x16x32_bf16 v[108:111], v[24:27], v[44:47], v[108:111]
    s_waitcnt lgkmcnt(11)
    v_mfma_f32_16x16x32_bf16 v[112:115], v[28:31], v[32:35], v[112:115]
    ds_read_b128 v[20:23], v7 offset:7168
    v_mfma_f32_16x16x32_bf16 v[116:119], v[28:31], v[36:39], v[116:119]
    v_mfma_f32_16x16x32_bf16 v[120:123], v[28:31], v[40:43], v[120:123]
    v_mfma_f32_16x16x32_bf16 v[124:127], v[28:31], v[44:47], v[124:127]
    s_waitcnt vmcnt(3) lgkmcnt(11)
    v_mfma_f32_16x16x32_bf16 v[208:211], v[8:11], v[48:51], v[208:211]
    s_waitcnt vmcnt(2)
    ds_read_b128 v[24:27], v7 offset:43008
    v_mfma_f32_16x16x32_bf16 v[212:215], v[8:11], v[52:55], v[212:215]
    s_waitcnt vmcnt(1)
    v_mfma_f32_16x16x32_bf16 v[216:219], v[8:11], v[56:59], v[216:219]
    s_waitcnt vmcnt(0)
    v_mfma_f32_16x16x32_bf16 v[220:223], v[8:11], v[60:63], v[220:223]
    s_waitcnt lgkmcnt(11)
    ds_read_b128 v[136:139], v5 offset:128
    ds_read_b128 v[140:143], v5 offset:192
    v_mfma_f32_16x16x32_bf16 v[224:227], v[12:15], v[48:51], v[224:227]
    ds_read_b128 v[28:31], v7 offset:44032
    ds_read_b128 v[144:147], v5 offset:256
    v_mfma_f32_16x16x32_bf16 v[228:231], v[12:15], v[52:55], v[228:231]
    ds_read_b128 v[148:151], v5 offset:320
    v_mfma_f32_16x16x32_bf16 v[232:235], v[12:15], v[56:59], v[232:235]
    v_mfma_f32_16x16x32_bf16 v[236:239], v[12:15], v[60:63], v[236:239]
    s_waitcnt lgkmcnt(11)
    v_mfma_f32_16x16x32_bf16 v[64:67], v[16:19], v[48:51], v[64:67]
    s_waitcnt lgkmcnt(0)
    s_barrier
    v_mfma_f32_16x16x32_bf16 v[68:71], v[16:19], v[52:55], v[68:71]
    s_add_u32 m0, s49, 0
    v_add_u32 v4, 0x1b000, v4
    ds_read_b128 v[8:11], v4 offset:0
    v_mfma_f32_16x16x32_bf16 v[72:75], v[16:19], v[56:59], v[72:75]
    s_add_u32 s61, s48, 147456
    v_mfma_f32_16x16x32_bf16 v[76:79], v[16:19], v[60:63], v[76:79]
    v_mfma_f32_16x16x32_bf16 v[80:83], v[20:23], v[48:51], v[80:83]
    ds_read_b128 v[12:15], v4 offset:1024
    v_mfma_f32_16x16x32_bf16 v[84:87], v[20:23], v[52:55], v[84:87]
    buffer_load_dwordx4 v2, s[4:7], s61 offen offset:0 lds
    v_mfma_f32_16x16x32_bf16 v[88:91], v[20:23], v[56:59], v[88:91]
    v_mfma_f32_16x16x32_bf16 v[92:95], v[20:23], v[60:63], v[92:95]
    v_mfma_f32_16x16x32_bf16 v[96:99], v[24:27], v[48:51], v[96:99]
    ds_read_b128 v[16:19], v4 offset:2048
    v_mfma_f32_16x16x32_bf16 v[100:103], v[24:27], v[52:55], v[100:103]
    buffer_load_dwordx4 v2, s[4:7], s61 offen offset:1024 lds
    v_mfma_f32_16x16x32_bf16 v[104:107], v[24:27], v[56:59], v[104:107]
    v_mfma_f32_16x16x32_bf16 v[108:111], v[24:27], v[60:63], v[108:111]
    v_mfma_f32_16x16x32_bf16 v[112:115], v[28:31], v[48:51], v[112:115]
    ds_read_b128 v[20:23], v4 offset:3072
    v_mfma_f32_16x16x32_bf16 v[116:119], v[28:31], v[52:55], v[116:119]
    buffer_load_dwordx4 v2, s[4:7], s61 offen offset:2048 lds
    v_mfma_f32_16x16x32_bf16 v[120:123], v[28:31], v[56:59], v[120:123]
    v_mfma_f32_16x16x32_bf16 v[124:127], v[28:31], v[60:63], v[124:127]
    s_waitcnt lgkmcnt(3)
    v_mfma_f32_16x16x32_bf16 v[192:195], v[8:11], a[0:3], 0
    ds_read_b128 v[24:27], v4 offset:4096
    v_mfma_f32_16x16x32_bf16 v[196:199], v[8:11], a[4:7], 0
    buffer_load_dwordx4 v2, s[4:7], s61 offen offset:3072 lds
    v_mfma_f32_16x16x32_bf16 v[200:203], v[8:11], a[8:11], 0
    s_add_u32 m0, s49, 4096
    s_add_u32 s61, s48, 151552
    v_mfma_f32_16x16x32_bf16 v[204:207], v[8:11], a[12:15], 0
    s_waitcnt lgkmcnt(3)
    v_mfma_f32_16x16x32_bf16 v[152:155], v[12:15], a[0:3], 0
    ds_read_b128 v[28:31], v4 offset:5120
    v_mfma_f32_16x16x32_bf16 v[156:159], v[12:15], a[4:7], 0
    buffer_load_dwordx4 v2, s[4:7], s61 offen offset:0 lds
    v_mfma_f32_16x16x32_bf16 v[160:163], v[12:15], a[8:11], 0
    v_fmac_f32 v64, v136, v128
    v_fmac_f32 v65, v137, v128
    v_mfma_f32_16x16x32_bf16 v[164:167], v[12:15], a[12:15], 0
    s_waitcnt lgkmcnt(3)
    v_fmac_f32 v66, v138, v128
    v_fmac_f32 v67, v139, v128
    v_mfma_f32_16x16x32_bf16 v[192:195], v[16:19], a[16:19], v[192:195]
    ds_read_b128 v[8:11], v4 offset:6144
    v_fmac_f32 v80, v140, v128
    v_mfma_f32_16x16x32_bf16 v[196:199], v[16:19], a[20:23], v[196:199]
    buffer_load_dwordx4 v2, s[4:7], s61 offen offset:1024 lds
    v_mfma_f32_16x16x32_bf16 v[200:203], v[16:19], a[24:27], v[200:203]
    v_fmac_f32 v81, v141, v128
    v_fmac_f32 v82, v142, v128
    v_mfma_f32_16x16x32_bf16 v[204:207], v[16:19], a[28:31], v[204:207]
    s_waitcnt lgkmcnt(3)
    v_fmac_f32 v83, v143, v128
    v_mul_f32 v64, v64, v132
    v_mfma_f32_16x16x32_bf16 v[152:155], v[20:23], a[16:19], v[152:155]
    ds_read_b128 v[12:15], v4 offset:7168
    v_mul_f32 v65, v65, v132
    v_mfma_f32_16x16x32_bf16 v[156:159], v[20:23], a[20:23], v[156:159]
    buffer_load_dwordx4 v2, s[4:7], s61 offen offset:2048 lds
    v_mfma_f32_16x16x32_bf16 v[160:163], v[20:23], a[24:27], v[160:163]
    v_mul_f32 v66, v66, v132
    v_mul_f32 v67, v67, v132
    v_mfma_f32_16x16x32_bf16 v[164:167], v[20:23], a[28:31], v[164:167]
    s_waitcnt lgkmcnt(3)
    v_mul_f32 v64, v64, v80
    v_mul_f32 v65, v65, v81
    v_mfma_f32_16x16x32_bf16 v[192:195], v[24:27], a[32:35], v[192:195]
    ds_read_b128 v[16:19], v4 offset:8192
    v_mul_f32 v66, v66, v82
    v_mfma_f32_16x16x32_bf16 v[196:199], v[24:27], a[36:39], v[196:199]
    buffer_load_dwordx4 v2, s[4:7], s61 offen offset:3072 lds
    v_mfma_f32_16x16x32_bf16 v[200:203], v[24:27], a[40:43], v[200:203]
    s_add_u32 m0, s49, 8192
    s_add_u32 s61, s48, 155648
    v_mul_f32 v67, v67, v83
    v_mfma_f32_16x16x32_bf16 v[204:207], v[24:27], a[44:47], v[204:207]
    s_waitcnt lgkmcnt(3)
    v_cvt_pk_bf16_f32 v176, v64, v65
    v_cvt_pk_bf16_f32 v177, v66, v67
    v_mfma_f32_16x16x32_bf16 v[152:155], v[28:31], a[32:35], v[152:155]
    ds_read_b128 v[20:23], v4 offset:9216
    v_fmac_f32 v68, v136, v129
    v_mfma_f32_16x16x32_bf16 v[156:159], v[28:31], a[36:39], v[156:159]
    buffer_load_dwordx4 v2, s[4:7], s61 offen offset:0 lds
    v_mfma_f32_16x16x32_bf16 v[160:163], v[28:31], a[40:43], v[160:163]
    s_add_u32 m0, s49, 36864
    s_add_u32 s61, s48, 184320
    v_fmac_f32 v69, v137, v129
    v_mfma_f32_16x16x32_bf16 v[164:167], v[28:31], a[44:47], v[164:167]
    s_waitcnt lgkmcnt(3)
    v_fmac_f32 v70, v138, v129
    v_fmac_f32 v71, v139, v129
    v_mfma_f32_16x16x32_bf16 v[192:195], v[8:11], a[48:51], v[192:195]
    ds_read_b128 v[24:27], v4 offset:10240
    v_fmac_f32 v84, v140, v129
    v_mfma_f32_16x16x32_bf16 v[196:199], v[8:11], a[52:55], v[196:199]
    buffer_load_dwordx4 v2, s[4:7], s61 offen offset:0 lds
    v_mfma_f32_16x16x32_bf16 v[200:203], v[8:11], a[56:59], v[200:203]
    v_fmac_f32 v85, v141, v129
    v_fmac_f32 v86, v142, v129
    v_mfma_f32_16x16x32_bf16 v[204:207], v[8:11], a[60:63], v[204:207]
    s_waitcnt lgkmcnt(3)
    v_fmac_f32 v87, v143, v129
    v_mul_f32 v68, v68, v133
    v_mfma_f32_16x16x32_bf16 v[152:155], v[12:15], a[48:51], v[152:155]
    ds_read_b128 v[28:31], v4 offset:11264
    v_mul_f32 v69, v69, v133
    v_mfma_f32_16x16x32_bf16 v[156:159], v[12:15], a[52:55], v[156:159]
    buffer_load_dwordx4 v2, s[4:7], s61 offen offset:1024 lds
    v_mfma_f32_16x16x32_bf16 v[160:163], v[12:15], a[56:59], v[160:163]
    v_mul_f32 v70, v70, v133
    v_mul_f32 v71, v71, v133
    v_mfma_f32_16x16x32_bf16 v[164:167], v[12:15], a[60:63], v[164:167]
    s_waitcnt lgkmcnt(3)
    v_mul_f32 v68, v68, v84
    v_mul_f32 v69, v69, v85
    v_mfma_f32_16x16x32_bf16 v[192:195], v[16:19], a[64:67], v[192:195]
    ds_read_b128 v[8:11], v4 offset:12288
    v_mul_f32 v70, v70, v86
    v_mfma_f32_16x16x32_bf16 v[196:199], v[16:19], a[68:71], v[196:199]
    buffer_load_dwordx4 v2, s[4:7], s61 offen offset:2048 lds
    v_mfma_f32_16x16x32_bf16 v[200:203], v[16:19], a[72:75], v[200:203]
    v_mul_f32 v71, v71, v87
    v_cvt_pk_bf16_f32 v180, v68, v69
    v_mfma_f32_16x16x32_bf16 v[204:207], v[16:19], a[76:79], v[204:207]
    s_waitcnt lgkmcnt(3)
    v_cvt_pk_bf16_f32 v181, v70, v71
    v_fmac_f32 v72, v136, v130
    v_mfma_f32_16x16x32_bf16 v[152:155], v[20:23], a[64:67], v[152:155]
    ds_read_b128 v[12:15], v4 offset:13312
    v_fmac_f32 v73, v137, v130
    v_mfma_f32_16x16x32_bf16 v[156:159], v[20:23], a[68:71], v[156:159]
    buffer_load_dwordx4 v2, s[4:7], s61 offen offset:3072 lds
    v_mfma_f32_16x16x32_bf16 v[160:163], v[20:23], a[72:75], v[160:163]
    s_add_u32 m0, s49, 40960
    s_add_u32 s61, s48, 188416
    v_fmac_f32 v74, v138, v130
    v_mfma_f32_16x16x32_bf16 v[164:167], v[20:23], a[76:79], v[164:167]
    s_waitcnt lgkmcnt(3)
    v_fmac_f32 v75, v139, v130
    v_fmac_f32 v88, v140, v130
    v_mfma_f32_16x16x32_bf16 v[192:195], v[24:27], a[80:83], v[192:195]
    ds_read_b128 v[16:19], v4 offset:14336
    v_fmac_f32 v89, v141, v130
    v_mfma_f32_16x16x32_bf16 v[196:199], v[24:27], a[84:87], v[196:199]
    buffer_load_dwordx4 v2, s[4:7], s61 offen offset:0 lds
    v_mfma_f32_16x16x32_bf16 v[200:203], v[24:27], a[88:91], v[200:203]
    v_fmac_f32 v90, v142, v130
    v_fmac_f32 v91, v143, v130
    v_mfma_f32_16x16x32_bf16 v[204:207], v[24:27], a[92:95], v[204:207]
    s_waitcnt lgkmcnt(3)
    v_mul_f32 v72, v72, v134
    v_mul_f32 v73, v73, v134
    v_mfma_f32_16x16x32_bf16 v[152:155], v[28:31], a[80:83], v[152:155]
    ds_read_b128 v[20:23], v4 offset:15360
    v_mul_f32 v74, v74, v134
    v_mfma_f32_16x16x32_bf16 v[156:159], v[28:31], a[84:87], v[156:159]
    buffer_load_dwordx4 v2, s[4:7], s61 offen offset:1024 lds
    v_mfma_f32_16x16x32_bf16 v[160:163], v[28:31], a[88:91], v[160:163]
    v_mul_f32 v75, v75, v134
    v_mul_f32 v72, v72, v88
    v_mfma_f32_16x16x32_bf16 v[164:167], v[28:31], a[92:95], v[164:167]
    s_waitcnt lgkmcnt(3)
    v_mul_f32 v73, v73, v89
    v_mul_f32 v74, v74, v90
    v_mfma_f32_16x16x32_bf16 v[192:195], v[8:11], a[96:99], v[192:195]
    ds_read_b128 v[24:27], v4 offset:16384
    v_mul_f32 v75, v75, v91
    v_mfma_f32_16x16x32_bf16 v[196:199], v[8:11], a[100:103], v[196:199]
    buffer_load_dwordx4 v2, s[4:7], s61 offen offset:2048 lds
    v_mfma_f32_16x16x32_bf16 v[200:203], v[8:11], a[104:107], v[200:203]
    v_cvt_pk_bf16_f32 v184, v72, v73
    v_cvt_pk_bf16_f32 v185, v74, v75
    v_mfma_f32_16x16x32_bf16 v[204:207], v[8:11], a[108:111], v[204:207]
    s_waitcnt lgkmcnt(3)
    v_fmac_f32 v76, v136, v131
    v_fmac_f32 v77, v137, v131
    v_mfma_f32_16x16x32_bf16 v[152:155], v[12:15], a[96:99], v[152:155]
    ds_read_b128 v[28:31], v4 offset:17408
    v_fmac_f32 v78, v138, v131
    v_mfma_f32_16x16x32_bf16 v[156:159], v[12:15], a[100:103], v[156:159]
    buffer_load_dwordx4 v2, s[4:7], s61 offen offset:3072 lds
    v_mfma_f32_16x16x32_bf16 v[160:163], v[12:15], a[104:107], v[160:163]
    s_add_u32 m0, s49, 45056
    s_add_u32 s61, s48, 192512
    v_fmac_f32 v79, v139, v131
    v_mfma_f32_16x16x32_bf16 v[164:167], v[12:15], a[108:111], v[164:167]
    s_waitcnt lgkmcnt(3)
    v_fmac_f32 v92, v140, v131
    v_fmac_f32 v93, v141, v131
    v_mfma_f32_16x16x32_bf16 v[192:195], v[16:19], a[112:115], v[192:195]
    ds_read_b128 v[8:11], v4 offset:18432
    v_fmac_f32 v94, v142, v131
    v_mfma_f32_16x16x32_bf16 v[196:199], v[16:19], a[116:119], v[196:199]
    buffer_load_dwordx4 v2, s[4:7], s61 offen offset:0 lds
    v_mfma_f32_16x16x32_bf16 v[200:203], v[16:19], a[120:123], v[200:203]
    s_add_u32 m0, s49, 73728
    s_add_u32 s61, s48, 221184
    v_fmac_f32 v95, v143, v131
    v_mfma_f32_16x16x32_bf16 v[204:207], v[16:19], a[124:127], v[204:207]
    s_waitcnt lgkmcnt(3)
    v_mul_f32 v76, v76, v135
    v_mul_f32 v77, v77, v135
    v_mfma_f32_16x16x32_bf16 v[152:155], v[20:23], a[112:115], v[152:155]
    ds_read_b128 v[12:15], v4 offset:19456
    v_mul_f32 v78, v78, v135
    v_mfma_f32_16x16x32_bf16 v[156:159], v[20:23], a[116:119], v[156:159]
    buffer_load_dwordx4 v2, s[4:7], s61 offen offset:0 lds
    v_mfma_f32_16x16x32_bf16 v[160:163], v[20:23], a[120:123], v[160:163]
    v_mul_f32 v79, v79, v135
    v_mul_f32 v76, v76, v92
    v_mfma_f32_16x16x32_bf16 v[164:167], v[20:23], a[124:127], v[164:167]
    s_waitcnt lgkmcnt(3)
    v_mul_f32 v77, v77, v93
    v_mul_f32 v78, v78, v94
    v_mfma_f32_16x16x32_bf16 v[192:195], v[24:27], a[128:131], v[192:195]
    ds_read_b128 v[16:19], v4 offset:20480
    v_mul_f32 v79, v79, v95
    v_mfma_f32_16x16x32_bf16 v[196:199], v[24:27], a[132:135], v[196:199]
    buffer_load_dwordx4 v2, s[4:7], s61 offen offset:1024 lds
    v_mfma_f32_16x16x32_bf16 v[200:203], v[24:27], a[136:139], v[200:203]
    v_cvt_pk_bf16_f32 v188, v76, v77
    v_cvt_pk_bf16_f32 v189, v78, v79
    v_mfma_f32_16x16x32_bf16 v[204:207], v[24:27], a[140:143], v[204:207]
    s_waitcnt lgkmcnt(3)
    ds_read_b128 v[136:139], v5 offset:0
    ds_read_b128 v[140:143], v5 offset:64
    v_mfma_f32_16x16x32_bf16 v[152:155], v[28:31], a[128:131], v[152:155]
    ds_read_b128 v[20:23], v4 offset:21504
    v_fmac_f32 v96, v144, v128
    v_mfma_f32_16x16x32_bf16 v[156:159], v[28:31], a[132:135], v[156:159]
    buffer_load_dwordx4 v2, s[4:7], s61 offen offset:2048 lds
    v_mfma_f32_16x16x32_bf16 v[160:163], v[28:31], a[136:139], v[160:163]
    v_fmac_f32 v97, v145, v128
    v_fmac_f32 v98, v146, v128
    v_mfma_f32_16x16x32_bf16 v[164:167], v[28:31], a[140:143], v[164:167]
    s_waitcnt lgkmcnt(5)
    v_fmac_f32 v99, v147, v128
    v_fmac_f32 v112, v148, v128
    v_mfma_f32_16x16x32_bf16 v[192:195], v[8:11], a[144:147], v[192:195]
    ds_read_b128 v[24:27], v4 offset:22528
    v_fmac_f32 v113, v149, v128
    v_mfma_f32_16x16x32_bf16 v[196:199], v[8:11], a[148:151], v[196:199]
    buffer_load_dwordx4 v2, s[4:7], s61 offen offset:3072 lds
    v_mfma_f32_16x16x32_bf16 v[200:203], v[8:11], a[152:155], v[200:203]
    s_add_u32 m0, s49, 77824
    s_add_u32 s61, s48, 225280
    v_fmac_f32 v114, v150, v128
    v_mfma_f32_16x16x32_bf16 v[204:207], v[8:11], a[156:159], v[204:207]
    s_waitcnt lgkmcnt(5)
    v_fmac_f32 v115, v151, v128
    v_mul_f32 v96, v96, v132
    v_mfma_f32_16x16x32_bf16 v[152:155], v[12:15], a[144:147], v[152:155]
    ds_read_b128 v[28:31], v4 offset:23552
    v_mul_f32 v97, v97, v132
    v_mfma_f32_16x16x32_bf16 v[156:159], v[12:15], a[148:151], v[156:159]
    buffer_load_dwordx4 v2, s[4:7], s61 offen offset:0 lds
    v_mfma_f32_16x16x32_bf16 v[160:163], v[12:15], a[152:155], v[160:163]
    v_mul_f32 v98, v98, v132
    v_mul_f32 v99, v99, v132
    v_mfma_f32_16x16x32_bf16 v[164:167], v[12:15], a[156:159], v[164:167]
    s_waitcnt lgkmcnt(5)
    v_mul_f32 v96, v96, v112
    v_mul_f32 v97, v97, v113
    v_mfma_f32_16x16x32_bf16 v[192:195], v[16:19], a[160:163], v[192:195]
    ds_read_b128 v[8:11], v4 offset:24576
    v_mul_f32 v98, v98, v114
    v_mfma_f32_16x16x32_bf16 v[196:199], v[16:19], a[164:167], v[196:199]
    buffer_load_dwordx4 v2, s[4:7], s61 offen offset:1024 lds
    v_mfma_f32_16x16x32_bf16 v[200:203], v[16:19], a[168:171], v[200:203]
    v_mul_f32 v99, v99, v115
    v_cvt_pk_bf16_f32 v178, v96, v97
    v_mfma_f32_16x16x32_bf16 v[204:207], v[16:19], a[172:175], v[204:207]
    s_waitcnt lgkmcnt(3)
    v_cvt_pk_bf16_f32 v179, v98, v99
    v_mfma_f32_16x16x32_bf16 v[152:155], v[20:23], a[160:163], v[152:155]
    s_add_u32 s66, s51, 0
    ds_read_b128 v[12:15], v4 offset:25600
    v_mfma_f32_16x16x32_bf16 v[156:159], v[20:23], a[164:167], v[156:159]
    buffer_store_dwordx4 v[176:179], v2, s[4:7], s66 offen offset:0 sc1
    v_mfma_f32_16x16x32_bf16 v[160:163], v[20:23], a[168:171], v[160:163]
    v_fmac_f32 v100, v144, v129
    v_fmac_f32 v101, v145, v129
    v_mfma_f32_16x16x32_bf16 v[164:167], v[20:23], a[172:175], v[164:167]
    s_waitcnt lgkmcnt(3)
    v_fmac_f32 v102, v146, v129
    v_fmac_f32 v103, v147, v129
    v_mfma_f32_16x16x32_bf16 v[192:195], v[24:27], a[176:179], v[192:195]
    ds_read_b128 v[16:19], v4 offset:26624
    v_fmac_f32 v116, v148, v129
    v_mfma_f32_16x16x32_bf16 v[196:199], v[24:27], a[180:183], v[196:199]
    buffer_load_dwordx4 v2, s[4:7], s61 offen offset:2048 lds
    v_mfma_f32_16x16x32_bf16 v[200:203], v[24:27], a[184:187], v[200:203]
    v_fmac_f32 v117, v149, v129
    v_fmac_f32 v118, v150, v129
    v_mfma_f32_16x16x32_bf16 v[204:207], v[24:27], a[188:191], v[204:207]
    s_waitcnt lgkmcnt(3)
    v_fmac_f32 v119, v151, v129
    v_mul_f32 v100, v100, v133
    v_mfma_f32_16x16x32_bf16 v[152:155], v[28:31], a[176:179], v[152:155]
    ds_read_b128 v[20:23], v4 offset:27648
    v_mul_f32 v101, v101, v133
    v_mfma_f32_16x16x32_bf16 v[156:159], v[28:31], a[180:183], v[156:159]
    buffer_load_dwordx4 v2, s[4:7], s61 offen offset:3072 lds
    v_mfma_f32_16x16x32_bf16 v[160:163], v[28:31], a[184:187], v[160:163]
    s_add_u32 m0, s49, 81920
    s_add_u32 s61, s48, 229376
    v_mul_f32 v102, v102, v133
    v_mfma_f32_16x16x32_bf16 v[164:167], v[28:31], a[188:191], v[164:167]
    s_waitcnt lgkmcnt(3)
    v_mul_f32 v103, v103, v133
    v_mul_f32 v100, v100, v116
    v_mfma_f32_16x16x32_bf16 v[192:195], v[8:11], a[192:195], v[192:195]
    ds_read_b128 v[24:27], v4 offset:28672
    v_mul_f32 v101, v101, v117
    v_mfma_f32_16x16x32_bf16 v[196:199], v[8:11], a[196:199], v[196:199]
    buffer_load_dwordx4 v2, s[4:7], s61 offen offset:0 lds
    v_mfma_f32_16x16x32_bf16 v[200:203], v[8:11], a[200:203], v[200:203]
    v_mul_f32 v102, v102, v118
    v_mul_f32 v103, v103, v119
    v_mfma_f32_16x16x32_bf16 v[204:207], v[8:11], a[204:207], v[204:207]
    s_waitcnt lgkmcnt(3)
    v_cvt_pk_bf16_f32 v182, v100, v101
    v_cvt_pk_bf16_f32 v183, v102, v103
    v_mfma_f32_16x16x32_bf16 v[152:155], v[12:15], a[192:195], v[152:155]
    ds_read_b128 v[28:31], v4 offset:29696
    v_mfma_f32_16x16x32_bf16 v[156:159], v[12:15], a[196:199], v[156:159]
    buffer_store_dwordx4 v[180:183], v2, s[4:7], s66 offen offset:1024 sc1
    v_mfma_f32_16x16x32_bf16 v[160:163], v[12:15], a[200:203], v[160:163]
    v_fmac_f32 v104, v144, v130
    v_fmac_f32 v105, v145, v130
    v_mfma_f32_16x16x32_bf16 v[164:167], v[12:15], a[204:207], v[164:167]
    s_waitcnt lgkmcnt(3)
    v_fmac_f32 v106, v146, v130
    v_fmac_f32 v107, v147, v130
    v_mfma_f32_16x16x32_bf16 v[192:195], v[16:19], a[208:211], v[192:195]
    ds_read_b128 v[8:11], v4 offset:30720
    v_fmac_f32 v120, v148, v130
    v_mfma_f32_16x16x32_bf16 v[196:199], v[16:19], a[212:215], v[196:199]
    v_fmac_f32 v121, v149, v130
    v_fmac_f32 v122, v150, v130
    v_mfma_f32_16x16x32_bf16 v[200:203], v[16:19], a[216:219], v[200:203]
    v_fmac_f32 v123, v151, v130
    v_mul_f32 v104, v104, v134
    v_mfma_f32_16x16x32_bf16 v[204:207], v[16:19], a[220:223], v[204:207]
    s_waitcnt lgkmcnt(3)
    v_mul_f32 v105, v105, v134
    v_mul_f32 v106, v106, v134
    v_mfma_f32_16x16x32_bf16 v[152:155], v[20:23], a[208:211], v[152:155]
    ds_read_b128 v[12:15], v4 offset:31744
    v_mul_f32 v107, v107, v134
    v_mfma_f32_16x16x32_bf16 v[156:159], v[20:23], a[212:215], v[156:159]
    v_mul_f32 v104, v104, v120
    v_mul_f32 v105, v105, v121
    v_mfma_f32_16x16x32_bf16 v[160:163], v[20:23], a[216:219], v[160:163]
    v_mul_f32 v106, v106, v122
    v_mul_f32 v107, v107, v123
    v_mfma_f32_16x16x32_bf16 v[164:167], v[20:23], a[220:223], v[164:167]
    s_waitcnt lgkmcnt(3)
    v_cvt_pk_bf16_f32 v186, v104, v105
    v_cvt_pk_bf16_f32 v187, v106, v107
    v_mfma_f32_16x16x32_bf16 v[192:195], v[24:27], a[224:227], v[192:195]
    ds_read_b128 v[16:19], v4 offset:32768
    v_mfma_f32_16x16x32_bf16 v[196:199], v[24:27], a[228:231], v[196:199]
    buffer_store_dwordx4 v[184:187], v2, s[4:7], s66 offen offset:2048 sc1
    v_mfma_f32_16x16x32_bf16 v[200:203], v[24:27], a[232:235], v[200:203]
    v_fmac_f32 v108, v144, v131
    v_fmac_f32 v109, v145, v131
    v_mfma_f32_16x16x32_bf16 v[204:207], v[24:27], a[236:239], v[204:207]
    s_waitcnt lgkmcnt(3)
    v_fmac_f32 v110, v146, v131
    v_fmac_f32 v111, v147, v131
    v_mfma_f32_16x16x32_bf16 v[152:155], v[28:31], a[224:227], v[152:155]
    ds_read_b128 v[20:23], v4 offset:33792
    v_fmac_f32 v124, v148, v131
    v_mfma_f32_16x16x32_bf16 v[156:159], v[28:31], a[228:231], v[156:159]
    v_fmac_f32 v125, v149, v131
    v_fmac_f32 v126, v150, v131
    v_mfma_f32_16x16x32_bf16 v[160:163], v[28:31], a[232:235], v[160:163]
    v_fmac_f32 v127, v151, v131
    v_mul_f32 v108, v108, v135
    v_mfma_f32_16x16x32_bf16 v[164:167], v[28:31], a[236:239], v[164:167]
    s_waitcnt lgkmcnt(3)
    v_mul_f32 v109, v109, v135
    v_mul_f32 v110, v110, v135
    v_mfma_f32_16x16x32_bf16 v[192:195], v[8:11], a[240:243], v[192:195]
    ds_read_b128 v[24:27], v4 offset:34816
    v_mul_f32 v111, v111, v135
    v_mfma_f32_16x16x32_bf16 v[196:199], v[8:11], a[244:247], v[196:199]
    v_mul_f32 v108, v108, v124
    v_mul_f32 v109, v109, v125
    v_mfma_f32_16x16x32_bf16 v[200:203], v[8:11], a[248:251], v[200:203]
    v_mul_f32 v110, v110, v126
    v_mul_f32 v111, v111, v127
    v_mfma_f32_16x16x32_bf16 v[204:207], v[8:11], a[252:255], v[204:207]
    s_waitcnt lgkmcnt(3)
    v_cvt_pk_bf16_f32 v190, v108, v109
    v_cvt_pk_bf16_f32 v191, v110, v111
    v_mfma_f32_16x16x32_bf16 v[152:155], v[12:15], a[240:243], v[152:155]
    ds_read_b128 v[28:31], v4 offset:35840
    v_mfma_f32_16x16x32_bf16 v[156:159], v[12:15], a[244:247], v[156:159]
    buffer_store_dwordx4 v[188:191], v2, s[4:7], s66 offen offset:3072 sc1
    v_mfma_f32_16x16x32_bf16 v[160:163], v[12:15], a[248:251], v[160:163]
    ds_read_b128 v[144:147], v5 offset:384
    ds_read_b128 v[148:151], v5 offset:448
    v_mfma_f32_16x16x32_bf16 v[164:167], v[12:15], a[252:255], v[164:167]
    s_waitcnt lgkmcnt(5)
    v_fmac_f32 v208, v136, v128
    v_fmac_f32 v209, v137, v128
    v_mfma_f32_16x16x32_bf16 v[192:195], v[16:19], v[32:35], v[192:195]
    s_waitcnt vmcnt(22)
    s_barrier
    v_add_u32 v4, 0xfffe5000, v4
    v_mfma_f32_16x16x32_bf16 v[196:199], v[16:19], v[36:39], v[196:199]
    ds_read_b128 v[8:11], v4 offset:0
    v_fmac_f32 v210, v138, v128
    v_mfma_f32_16x16x32_bf16 v[200:203], v[16:19], v[40:43], v[200:203]
    v_fmac_f32 v211, v139, v128
    v_fmac_f32 v224, v140, v128
    v_mfma_f32_16x16x32_bf16 v[204:207], v[16:19], v[44:47], v[204:207]
    s_waitcnt lgkmcnt(5)
    v_fmac_f32 v225, v141, v128
    v_fmac_f32 v226, v142, v128
    v_mfma_f32_16x16x32_bf16 v[152:155], v[20:23], v[32:35], v[152:155]
    ds_read_b128 v[12:15], v4 offset:1024
    v_fmac_f32 v227, v143, v128
    v_mfma_f32_16x16x32_bf16 v[156:159], v[20:23], v[36:39], v[156:159]
    v_mul_f32 v208, v208, v132
    v_mul_f32 v209, v209, v132
    v_mfma_f32_16x16x32_bf16 v[160:163], v[20:23], v[40:43], v[160:163]
    v_mul_f32 v210, v210, v132
    v_mul_f32 v211, v211, v132
    v_mfma_f32_16x16x32_bf16 v[164:167], v[20:23], v[44:47], v[164:167]
    s_waitcnt lgkmcnt(5)
    v_mul_f32 v208, v208, v224
    v_mul_f32 v209, v209, v225
    v_mfma_f32_16x16x32_bf16 v[192:195], v[24:27], v[48:51], v[192:195]
    ds_read_b128 v[16:19], v4 offset:2048
    v_mul_f32 v210, v210, v226
    v_mfma_f32_16x16x32_bf16 v[196:199], v[24:27], v[52:55], v[196:199]
    v_mul_f32 v211, v211, v227
    v_cvt_pk_bf16_f32 v240, v208, v209
    v_mfma_f32_16x16x32_bf16 v[200:203], v[24:27], v[56:59], v[200:203]
    v_cvt_pk_bf16_f32 v241, v210, v211
    v_mfma_f32_16x16x32_bf16 v[204:207], v[24:27], v[60:63], v[204:207]
    s_waitcnt lgkmcnt(5)
    s_add_u32 s66, s51, s65
    v_mfma_f32_16x16x32_bf16 v[152:155], v[28:31], v[48:51], v[152:155]
    ds_read_b128 v[20:23], v4 offset:3072
    v_mfma_f32_16x16x32_bf16 v[156:159], v[28:31], v[52:55], v[156:159]
    buffer_store_dwordx2 v[240:241], v3, s[4:7], s66 offen offset:0 sc1
    v_mfma_f32_16x16x32_bf16 v[160:163], v[28:31], v[56:59], v[160:163]
    v_fmac_f32 v212, v136, v129
    v_fmac_f32 v213, v137, v129
    v_mfma_f32_16x16x32_bf16 v[164:167], v[28:31], v[60:63], v[164:167]
    s_waitcnt lgkmcnt(3)
    v_fmac_f32 v214, v138, v129
    v_fmac_f32 v215, v139, v129
    v_mfma_f32_16x16x32_bf16 v[96:99], v[8:11], a[0:3], 0
    ds_read_b128 v[24:27], v4 offset:4096
    v_fmac_f32 v228, v140, v129
    v_mfma_f32_16x16x32_bf16 v[100:103], v[8:11], a[4:7], 0
    v_fmac_f32 v229, v141, v129
    v_fmac_f32 v230, v142, v129
    v_mfma_f32_16x16x32_bf16 v[104:107], v[8:11], a[8:11], 0
    v_fmac_f32 v231, v143, v129
    v_mul_f32 v212, v212, v133
    v_mfma_f32_16x16x32_bf16 v[108:111], v[8:11], a[12:15], 0
    s_waitcnt lgkmcnt(3)
    v_mul_f32 v213, v213, v133
    v_mul_f32 v214, v214, v133
    v_mfma_f32_16x16x32_bf16 v[112:115], v[12:15], a[0:3], 0
    ds_read_b128 v[28:31], v4 offset:5120
    v_mul_f32 v215, v215, v133
    v_mfma_f32_16x16x32_bf16 v[116:119], v[12:15], a[4:7], 0
    v_mul_f32 v212, v212, v228
    v_mul_f32 v213, v213, v229
    v_mfma_f32_16x16x32_bf16 v[120:123], v[12:15], a[8:11], 0
    v_mul_f32 v214, v214, v230
    v_mul_f32 v215, v215, v231
    v_mfma_f32_16x16x32_bf16 v[124:127], v[12:15], a[12:15], 0
    s_waitcnt lgkmcnt(3)
    v_cvt_pk_bf16_f32 v244, v212, v213
    v_cvt_pk_bf16_f32 v245, v214, v215
    v_mfma_f32_16x16x32_bf16 v[96:99], v[16:19], a[16:19], v[96:99]
    ds_read_b128 v[8:11], v4 offset:6144
    v_mfma_f32_16x16x32_bf16 v[100:103], v[16:19], a[20:23], v[100:103]
    buffer_store_dwordx2 v[244:245], v3, s[4:7], s66 offen offset:512 sc1
    v_mfma_f32_16x16x32_bf16 v[104:107], v[16:19], a[24:27], v[104:107]
    v_fmac_f32 v216, v136, v130
    v_fmac_f32 v217, v137, v130
    v_mfma_f32_16x16x32_bf16 v[108:111], v[16:19], a[28:31], v[108:111]
    s_waitcnt lgkmcnt(3)
    v_fmac_f32 v218, v138, v130
    v_fmac_f32 v219, v139, v130
    v_mfma_f32_16x16x32_bf16 v[112:115], v[20:23], a[16:19], v[112:115]
    ds_read_b128 v[12:15], v4 offset:7168
    v_fmac_f32 v232, v140, v130
    v_mfma_f32_16x16x32_bf16 v[116:119], v[20:23], a[20:23], v[116:119]
    v_fmac_f32 v233, v141, v130
    v_fmac_f32 v234, v142, v130
    v_mfma_f32_16x16x32_bf16 v[120:123], v[20:23], a[24:27], v[120:123]
    v_fmac_f32 v235, v143, v130
    v_mul_f32 v216, v216, v134
    v_mfma_f32_16x16x32_bf16 v[124:127], v[20:23], a[28:31], v[124:127]
    s_waitcnt lgkmcnt(3)
    v_mul_f32 v217, v217, v134
    v_mul_f32 v218, v218, v134
    v_mfma_f32_16x16x32_bf16 v[96:99], v[24:27], a[32:35], v[96:99]
    ds_read_b128 v[16:19], v4 offset:8192
    v_mul_f32 v219, v219, v134
    v_mfma_f32_16x16x32_bf16 v[100:103], v[24:27], a[36:39], v[100:103]
    v_mul_f32 v216, v216, v232
    v_mul_f32 v217, v217, v233
    v_mfma_f32_16x16x32_bf16 v[104:107], v[24:27], a[40:43], v[104:107]
    v_mul_f32 v218, v218, v234
    v_mul_f32 v219, v219, v235
    v_mfma_f32_16x16x32_bf16 v[108:111], v[24:27], a[44:47], v[108:111]
    s_waitcnt lgkmcnt(3)
    v_cvt_pk_bf16_f32 v248, v216, v217
    v_cvt_pk_bf16_f32 v249, v218, v219
    v_mfma_f32_16x16x32_bf16 v[112:115], v[28:31], a[32:35], v[112:115]
    ds_read_b128 v[20:23], v4 offset:9216
    v_mfma_f32_16x16x32_bf16 v[116:119], v[28:31], a[36:39], v[116:119]
    buffer_store_dwordx2 v[248:249], v3, s[4:7], s66 offen offset:1024 sc1
    v_mfma_f32_16x16x32_bf16 v[120:123], v[28:31], a[40:43], v[120:123]
    v_fmac_f32 v220, v136, v131
    v_fmac_f32 v221, v137, v131
    v_mfma_f32_16x16x32_bf16 v[124:127], v[28:31], a[44:47], v[124:127]
    s_waitcnt lgkmcnt(3)
    v_fmac_f32 v222, v138, v131
    v_fmac_f32 v223, v139, v131
    v_mfma_f32_16x16x32_bf16 v[96:99], v[8:11], a[48:51], v[96:99]
    ds_read_b128 v[24:27], v4 offset:10240
    v_fmac_f32 v236, v140, v131
    v_mfma_f32_16x16x32_bf16 v[100:103], v[8:11], a[52:55], v[100:103]
    v_fmac_f32 v237, v141, v131
    v_fmac_f32 v238, v142, v131
    v_mfma_f32_16x16x32_bf16 v[104:107], v[8:11], a[56:59], v[104:107]
    v_fmac_f32 v239, v143, v131
    v_mul_f32 v220, v220, v135
    v_mfma_f32_16x16x32_bf16 v[108:111], v[8:11], a[60:63], v[108:111]
    s_waitcnt lgkmcnt(3)
    v_mul_f32 v221, v221, v135
    v_mul_f32 v222, v222, v135
    v_mfma_f32_16x16x32_bf16 v[112:115], v[12:15], a[48:51], v[112:115]
    ds_read_b128 v[28:31], v4 offset:11264
    v_mul_f32 v223, v223, v135
    v_mfma_f32_16x16x32_bf16 v[116:119], v[12:15], a[52:55], v[116:119]
    v_mul_f32 v220, v220, v236
    v_mul_f32 v221, v221, v237
    v_mfma_f32_16x16x32_bf16 v[120:123], v[12:15], a[56:59], v[120:123]
    v_mul_f32 v222, v222, v238
    v_mul_f32 v223, v223, v239
    v_mfma_f32_16x16x32_bf16 v[124:127], v[12:15], a[60:63], v[124:127]
    s_waitcnt lgkmcnt(3)
    v_cvt_pk_bf16_f32 v252, v220, v221
    v_cvt_pk_bf16_f32 v253, v222, v223
    v_mfma_f32_16x16x32_bf16 v[96:99], v[16:19], a[64:67], v[96:99]
    ds_read_b128 v[8:11], v4 offset:12288
    v_mfma_f32_16x16x32_bf16 v[100:103], v[16:19], a[68:71], v[100:103]
    buffer_store_dwordx2 v[252:253], v3, s[4:7], s66 offen offset:1536 sc1
    v_mfma_f32_16x16x32_bf16 v[104:107], v[16:19], a[72:75], v[104:107]
    ds_read_b128 v[136:139], v5 offset:512
    ds_read_b128 v[140:143], v5 offset:576
    v_mfma_f32_16x16x32_bf16 v[108:111], v[16:19], a[76:79], v[108:111]
    s_waitcnt lgkmcnt(5)
    v_fmac_f32 v192, v144, v128
    v_fmac_f32 v193, v145, v128
    v_mfma_f32_16x16x32_bf16 v[112:115], v[20:23], a[64:67], v[112:115]
    ds_read_b128 v[12:15], v4 offset:13312
    v_fmac_f32 v194, v146, v128
    v_mfma_f32_16x16x32_bf16 v[116:119], v[20:23], a[68:71], v[116:119]
    v_fmac_f32 v195, v147, v128
    v_fmac_f32 v152, v148, v128
    v_mfma_f32_16x16x32_bf16 v[120:123], v[20:23], a[72:75], v[120:123]
    v_fmac_f32 v153, v149, v128
    v_fmac_f32 v154, v150, v128
    v_mfma_f32_16x16x32_bf16 v[124:127], v[20:23], a[76:79], v[124:127]
    s_waitcnt lgkmcnt(5)
    v_fmac_f32 v155, v151, v128
    v_mul_f32 v192, v192, v132
    v_mfma_f32_16x16x32_bf16 v[96:99], v[24:27], a[80:83], v[96:99]
    ds_read_b128 v[16:19], v4 offset:14336
    v_mul_f32 v193, v193, v132
    v_mfma_f32_16x16x32_bf16 v[100:103], v[24:27], a[84:87], v[100:103]
    v_mul_f32 v194, v194, v132
    v_mul_f32 v195, v195, v132
    v_mfma_f32_16x16x32_bf16 v[104:107], v[24:27], a[88:91], v[104:107]
    v_mul_f32 v192, v192, v152
    v_mul_f32 v193, v193, v153
    v_mfma_f32_16x16x32_bf16 v[108:111], v[24:27], a[92:95], v[108:111]
    s_waitcnt lgkmcnt(5)
    v_mul_f32 v194, v194, v154
    v_mul_f32 v195, v195, v155
    v_mfma_f32_16x16x32_bf16 v[112:115], v[28:31], a[80:83], v[112:115]
    ds_read_b128 v[20:23], v4 offset:15360
    v_cvt_pk_bf16_f32 v192, v192, v193
    v_mfma_f32_16x16x32_bf16 v[116:119], v[28:31], a[84:87], v[116:119]
    v_cvt_pk_bf16_f32 v193, v194, v195
    v_fmac_f32 v196, v144, v129
    v_mfma_f32_16x16x32_bf16 v[120:123], v[28:31], a[88:91], v[120:123]
    v_fmac_f32 v197, v145, v129
    v_fmac_f32 v198, v146, v129
    v_mfma_f32_16x16x32_bf16 v[124:127], v[28:31], a[92:95], v[124:127]
    s_waitcnt lgkmcnt(5)
    v_fmac_f32 v199, v147, v129
    v_fmac_f32 v156, v148, v129
    v_mfma_f32_16x16x32_bf16 v[96:99], v[8:11], a[96:99], v[96:99]
    ds_read_b128 v[24:27], v4 offset:16384
    v_fmac_f32 v157, v149, v129
    v_mfma_f32_16x16x32_bf16 v[100:103], v[8:11], a[100:103], v[100:103]
    v_fmac_f32 v158, v150, v129
    v_fmac_f32 v159, v151, v129
    v_mfma_f32_16x16x32_bf16 v[104:107], v[8:11], a[104:107], v[104:107]
    v_mul_f32 v196, v196, v133
    v_mul_f32 v197, v197, v133
    v_mfma_f32_16x16x32_bf16 v[108:111], v[8:11], a[108:111], v[108:111]
    s_waitcnt lgkmcnt(3)
    v_mul_f32 v198, v198, v133
    v_mul_f32 v199, v199, v133
    v_mfma_f32_16x16x32_bf16 v[112:115], v[12:15], a[96:99], v[112:115]
    ds_read_b128 v[28:31], v4 offset:17408
    v_mul_f32 v196, v196, v156
    v_mfma_f32_16x16x32_bf16 v[116:119], v[12:15], a[100:103], v[116:119]
    v_mul_f32 v197, v197, v157
    v_mul_f32 v198, v198, v158
    v_mfma_f32_16x16x32_bf16 v[120:123], v[12:15], a[104:107], v[120:123]
    v_mul_f32 v199, v199, v159
    v_cvt_pk_bf16_f32 v196, v196, v197
    v_mfma_f32_16x16x32_bf16 v[124:127], v[12:15], a[108:111], v[124:127]
    s_waitcnt lgkmcnt(3)
    v_cvt_pk_bf16_f32 v197, v198, v199
    v_fmac_f32 v200, v144, v130
    v_mfma_f32_16x16x32_bf16 v[96:99], v[16:19], a[112:115], v[96:99]
    ds_read_b128 v[8:11], v4 offset:18432
    v_fmac_f32 v201, v145, v130
    v_mfma_f32_16x16x32_bf16 v[100:103], v[16:19], a[116:119], v[100:103]
    v_fmac_f32 v202, v146, v130
    v_fmac_f32 v203, v147, v130
    v_mfma_f32_16x16x32_bf16 v[104:107], v[16:19], a[120:123], v[104:107]
    v_fmac_f32 v160, v148, v130
    v_fmac_f32 v161, v149, v130
    v_mfma_f32_16x16x32_bf16 v[108:111], v[16:19], a[124:127], v[108:111]
    s_waitcnt lgkmcnt(3)
    v_fmac_f32 v162, v150, v130
    v_fmac_f32 v163, v151, v130
    v_mfma_f32_16x16x32_bf16 v[112:115], v[20:23], a[112:115], v[112:115]
    ds_read_b128 v[12:15], v4 offset:19456
    v_mul_f32 v200, v200, v134
    v_mfma_f32_16x16x32_bf16 v[116:119], v[20:23], a[116:119], v[116:119]
    v_mul_f32 v201, v201, v134
    v_mul_f32 v202, v202, v134
    v_mfma_f32_16x16x32_bf16 v[120:123], v[20:23], a[120:123], v[120:123]
    v_mul_f32 v203, v203, v134
    v_mul_f32 v200, v200, v160
    v_mfma_f32_16x16x32_bf16 v[124:127], v[20:23], a[124:127], v[124:127]
    s_waitcnt lgkmcnt(3)
    v_mul_f32 v201, v201, v161
    v_mul_f32 v202, v202, v162
    v_mfma_f32_16x16x32_bf16 v[96:99], v[24:27], a[128:131], v[96:99]
    ds_read_b128 v[16:19], v4 offset:20480
    v_mul_f32 v203, v203, v163
    v_mfma_f32_16x16x32_bf16 v[100:103], v[24:27], a[132:135], v[100:103]
    v_min_u32 v0, 17, v1
    v_lshlrev_b32 v0, 3, v0
    v_mfma_f32_16x16x32_bf16 v[104:107], v[24:27], a[136:139], v[104:107]
    s_add_u32 s55, s64, 288
    v_cvt_pk_bf16_f32 v200, v200, v201
    v_cvt_pk_bf16_f32 v201, v202, v203
    v_mfma_f32_16x16x32_bf16 v[108:111], v[24:27], a[140:143], v[108:111]
    s_waitcnt lgkmcnt(3)
    v_fmac_f32 v204, v144, v131
    v_fmac_f32 v205, v145, v131
    v_mfma_f32_16x16x32_bf16 v[112:115], v[28:31], a[128:131], v[112:115]
    ds_read_b128 v[20:23], v4 offset:21504
    v_fmac_f32 v206, v146, v131
    v_mfma_f32_16x16x32_bf16 v[116:119], v[28:31], a[132:135], v[116:119]
    buffer_load_dwordx2 v[6:7], v0, s[4:7], s55 offen sc1
    v_mfma_f32_16x16x32_bf16 v[120:123], v[28:31], a[136:139], v[120:123]
    v_fmac_f32 v207, v147, v131
    v_fmac_f32 v164, v148, v131
    v_mfma_f32_16x16x32_bf16 v[124:127], v[28:31], a[140:143], v[124:127]
    s_waitcnt lgkmcnt(3)
    v_fmac_f32 v165, v149, v131
    v_fmac_f32 v166, v150, v131
    v_mfma_f32_16x16x32_bf16 v[96:99], v[8:11], a[144:147], v[96:99]
    ds_read_b128 v[24:27], v4 offset:22528
    v_fmac_f32 v167, v151, v131
    v_mfma_f32_16x16x32_bf16 v[100:103], v[8:11], a[148:151], v[100:103]
    v_mul_f32 v204, v204, v135
    v_mul_f32 v205, v205, v135
    v_mfma_f32_16x16x32_bf16 v[104:107], v[8:11], a[152:155], v[104:107]
    v_mul_f32 v206, v206, v135
    v_mul_f32 v207, v207, v135
    v_mfma_f32_16x16x32_bf16 v[108:111], v[8:11], a[156:159], v[108:111]
    s_waitcnt lgkmcnt(3)
    v_mul_f32 v204, v204, v164
    v_mul_f32 v205, v205, v165
    v_mfma_f32_16x16x32_bf16 v[112:115], v[12:15], a[144:147], v[112:115]
    ds_read_b128 v[28:31], v4 offset:23552
    v_mul_f32 v206, v206, v166
    v_mfma_f32_16x16x32_bf16 v[116:119], v[12:15], a[148:151], v[116:119]
    v_mul_f32 v207, v207, v167
    v_cvt_pk_bf16_f32 v204, v204, v205
    v_mfma_f32_16x16x32_bf16 v[120:123], v[12:15], a[152:155], v[120:123]
    v_cvt_pk_bf16_f32 v205, v206, v207
    v_mfma_f32_16x16x32_bf16 v[124:127], v[12:15], a[156:159], v[124:127]
    s_waitcnt lgkmcnt(3)
    ds_read_b128 v[144:147], v5 offset:640
    ds_read_b128 v[148:151], v5 offset:704
    v_mfma_f32_16x16x32_bf16 v[96:99], v[16:19], a[160:163], v[96:99]
    ds_read_b128 v[8:11], v4 offset:24576
    v_mfma_f32_16x16x32_bf16 v[100:103], v[16:19], a[164:167], v[100:103]
    v_mfma_f32_16x16x32_bf16 v[104:107], v[16:19], a[168:171], v[104:107]
    v_mfma_f32_16x16x32_bf16 v[108:111], v[16:19], a[172:175], v[108:111]
    s_waitcnt lgkmcnt(5)
    v_mfma_f32_16x16x32_bf16 v[112:115], v[20:23], a[160:163], v[112:115]
    ds_read_b128 v[12:15], v4 offset:25600
    v_mfma_f32_16x16x32_bf16 v[116:119], v[20:23], a[164:167], v[116:119]
    v_mfma_f32_16x16x32_bf16 v[120:123], v[20:23], a[168:171], v[120:123]
    v_mfma_f32_16x16x32_bf16 v[124:127], v[20:23], a[172:175], v[124:127]
    s_waitcnt lgkmcnt(5)
    v_mfma_f32_16x16x32_bf16 v[96:99], v[24:27], a[176:179], v[96:99]
    ds_read_b128 v[16:19], v4 offset:26624
    v_mfma_f32_16x16x32_bf16 v[100:103], v[24:27], a[180:183], v[100:103]
    v_mfma_f32_16x16x32_bf16 v[104:107], v[24:27], a[184:187], v[104:107]
    v_mfma_f32_16x16x32_bf16 v[108:111], v[24:27], a[188:191], v[108:111]
    s_waitcnt lgkmcnt(5)
    v_mfma_f32_16x16x32_bf16 v[112:115], v[28:31], a[176:179], v[112:115]
    ds_read_b128 v[20:23], v4 offset:27648
    v_mfma_f32_16x16x32_bf16 v[116:119], v[28:31], a[180:183], v[116:119]
    v_mfma_f32_16x16x32_bf16 v[120:123], v[28:31], a[184:187], v[120:123]
    v_mfma_f32_16x16x32_bf16 v[124:127], v[28:31], a[188:191], v[124:127]
    s_waitcnt lgkmcnt(3)
    v_mfma_f32_16x16x32_bf16 v[96:99], v[8:11], a[192:195], v[96:99]
    ds_read_b128 v[24:27], v4 offset:28672
    v_mfma_f32_16x16x32_bf16 v[100:103], v[8:11], a[196:199], v[100:103]
    v_mfma_f32_16x16x32_bf16 v[104:107], v[8:11], a[200:203], v[104:107]
    v_mfma_f32_16x16x32_bf16 v[108:111], v[8:11], a[204:207], v[108:111]
    s_waitcnt lgkmcnt(3)
    v_mfma_f32_16x16x32_bf16 v[112:115], v[12:15], a[192:195], v[112:115]
    ds_read_b128 v[28:31], v4 offset:29696
    v_mfma_f32_16x16x32_bf16 v[116:119], v[12:15], a[196:199], v[116:119]
    v_mfma_f32_16x16x32_bf16 v[120:123], v[12:15], a[200:203], v[120:123]
    v_mfma_f32_16x16x32_bf16 v[124:127], v[12:15], a[204:207], v[124:127]
    s_waitcnt lgkmcnt(3)
    v_mfma_f32_16x16x32_bf16 v[96:99], v[16:19], a[208:211], v[96:99]
    ds_read_b128 v[8:11], v4 offset:30720
    v_mfma_f32_16x16x32_bf16 v[100:103], v[16:19], a[212:215], v[100:103]
    v_mfma_f32_16x16x32_bf16 v[104:107], v[16:19], a[216:219], v[104:107]
    v_mfma_f32_16x16x32_bf16 v[108:111], v[16:19], a[220:223], v[108:111]
    s_waitcnt lgkmcnt(3)
    v_mfma_f32_16x16x32_bf16 v[112:115], v[20:23], a[208:211], v[112:115]
    ds_read_b128 v[12:15], v4 offset:31744
    v_mfma_f32_16x16x32_bf16 v[116:119], v[20:23], a[212:215], v[116:119]
    s_waitcnt vmcnt(0)
    v_cmp_eq_u64 vcc, s[98:99], v[6:7]
    s_nop 0
    s_cmp_eq_u64 vcc, exec
    s_cbranch_scc0 L_pd_slow_79
L_pd_back_80:
    v_mfma_f32_16x16x32_bf16 v[120:123], v[20:23], a[216:219], v[120:123]
    v_mfma_f32_16x16x32_bf16 v[124:127], v[20:23], a[220:223], v[124:127]
    s_waitcnt lgkmcnt(3)
    v_mfma_f32_16x16x32_bf16 v[96:99], v[24:27], a[224:227], v[96:99]
    ds_read_b128 v[16:19], v4 offset:32768
    v_mfma_f32_16x16x32_bf16 v[100:103], v[24:27], a[228:231], v[100:103]
    v_mfma_f32_16x16x32_bf16 v[104:107], v[24:27], a[232:235], v[104:107]
    v_mfma_f32_16x16x32_bf16 v[108:111], v[24:27], a[236:239], v[108:111]
    s_waitcnt lgkmcnt(3)
    v_mfma_f32_16x16x32_bf16 v[112:115], v[28:31], a[224:227], v[112:115]
    ds_read_b128 v[20:23], v4 offset:33792
    v_mfma_f32_16x16x32_bf16 v[116:119], v[28:31], a[228:231], v[116:119]
    v_mfma_f32_16x16x32_bf16 v[120:123], v[28:31], a[232:235], v[120:123]
    v_mfma_f32_16x16x32_bf16 v[124:127], v[28:31], a[236:239], v[124:127]
    s_waitcnt lgkmcnt(3)
    v_mfma_f32_16x16x32_bf16 v[96:99], v[8:11], a[240:243], v[96:99]
    ds_read_b128 v[24:27], v4 offset:34816
    v_mfma_f32_16x16x32_bf16 v[100:103], v[8:11], a[244:247], v[100:103]
    v_mfma_f32_16x16x32_bf16 v[104:107], v[8:11], a[248:251], v[104:107]
    v_mfma_f32_16x16x32_bf16 v[108:111], v[8:11], a[252:255], v[108:111]
    s_waitcnt lgkmcnt(3)
    v_mfma_f32_16x16x32_bf16 v[112:115], v[12:15], a[240:243], v[112:115]
    ds_read_b128 v[28:31], v4 offset:35840
    v_mfma_f32_16x16x32_bf16 v[116:119], v[12:15], a[244:247], v[116:119]
    v_mfma_f32_16x16x32_bf16 v[120:123], v[12:15], a[248:251], v[120:123]
    v_mfma_f32_16x16x32_bf16 v[124:127], v[12:15], a[252:255], v[124:127]
    s_waitcnt lgkmcnt(3)
    v_mfma_f32_16x16x32_bf16 v[96:99], v[16:19], v[32:35], v[96:99]
    s_barrier
    v_add_u32 v4, 0x9000, v4
    v_mfma_f32_16x16x32_bf16 v[100:103], v[16:19], v[36:39], v[100:103]
    s_add_u32 m0, s49, 110592
    s_add_u32 s61, s48, 258048
    ds_read_b128 v[8:11], v4 offset:0
    v_mfma_f32_16x16x32_bf16 v[104:107], v[16:19], v[40:43], v[104:107]
    buffer_load_dwordx4 v2, s[4:7], s61 offen offset:0 lds
    v_mfma_f32_16x16x32_bf16 v[108:111], v[16:19], v[44:47], v[108:111]
    s_waitcnt lgkmcnt(3)
    v_mfma_f32_16x16x32_bf16 v[112:115], v[20:23], v[32:35], v[112:115]
    ds_read_b128 v[12:15], v4 offset:1024
    v_mfma_f32_16x16x32_bf16 v[116:119], v[20:23], v[36:39], v[116:119]
    v_mfma_f32_16x16x32_bf16 v[120:123], v[20:23], v[40:43], v[120:123]
    buffer_load_dwordx4 v2, s[4:7], s61 offen offset:1024 lds
    v_mfma_f32_16x16x32_bf16 v[124:127], v[20:23], v[44:47], v[124:127]
    s_waitcnt lgkmcnt(3)
    v_mfma_f32_16x16x32_bf16 v[96:99], v[24:27], v[48:51], v[96:99]
    ds_read_b128 v[16:19], v4 offset:2048
    v_mfma_f32_16x16x32_bf16 v[100:103], v[24:27], v[52:55], v[100:103]
    v_mfma_f32_16x16x32_bf16 v[104:107], v[24:27], v[56:59], v[104:107]
    buffer_load_dwordx4 v2, s[4:7], s61 offen offset:2048 lds
    v_mfma_f32_16x16x32_bf16 v[108:111], v[24:27], v[60:63], v[108:111]
    s_waitcnt lgkmcnt(3)
    v_mfma_f32_16x16x32_bf16 v[112:115], v[28:31], v[48:51], v[112:115]
    ds_read_b128 v[20:23], v4 offset:3072
    v_mfma_f32_16x16x32_bf16 v[116:119], v[28:31], v[52:55], v[116:119]
    v_mfma_f32_16x16x32_bf16 v[120:123], v[28:31], v[56:59], v[120:123]
    buffer_load_dwordx4 v2, s[4:7], s61 offen offset:3072 lds
    v_mfma_f32_16x16x32_bf16 v[124:127], v[28:31], v[60:63], v[124:127]
    s_waitcnt lgkmcnt(3)
    s_add_u32 m0, s49, 114688
    s_add_u32 s61, s48, 262144
    v_mfma_f32_16x16x32_bf16 v[64:67], v[8:11], a[0:3], 0
    ds_read_b128 v[24:27], v4 offset:4096
    v_mfma_f32_16x16x32_bf16 v[68:71], v[8:11], a[4:7], 0
    v_mfma_f32_16x16x32_bf16 v[72:75], v[8:11], a[8:11], 0
    buffer_load_dwordx4 v2, s[4:7], s61 offen offset:0 lds
    v_mfma_f32_16x16x32_bf16 v[76:79], v[8:11], a[12:15], 0
    s_waitcnt lgkmcnt(3)
    v_mfma_f32_16x16x32_bf16 v[80:83], v[12:15], a[0:3], 0
    ds_read_b128 v[28:31], v4 offset:5120
    v_mfma_f32_16x16x32_bf16 v[84:87], v[12:15], a[4:7], 0
    v_fmac_f32 v96, v136, v128
    v_fmac_f32 v97, v137, v128
    v_mfma_f32_16x16x32_bf16 v[88:91], v[12:15], a[8:11], 0
    buffer_load_dwordx4 v2, s[4:7], s61 offen offset:1024 lds
    v_mfma_f32_16x16x32_bf16 v[92:95], v[12:15], a[12:15], 0
    s_waitcnt lgkmcnt(3)
    v_fmac_f32 v98, v138, v128
    v_fmac_f32 v99, v139, v128
    v_mfma_f32_16x16x32_bf16 v[64:67], v[16:19], a[16:19], v[64:67]
    ds_read_b128 v[8:11], v4 offset:6144
    v_fmac_f32 v112, v140, v128
    v_mfma_f32_16x16x32_bf16 v[68:71], v[16:19], a[20:23], v[68:71]
    v_fmac_f32 v113, v141, v128
    v_fmac_f32 v114, v142, v128
    v_mfma_f32_16x16x32_bf16 v[72:75], v[16:19], a[24:27], v[72:75]
    buffer_load_dwordx4 v2, s[4:7], s61 offen offset:2048 lds
    v_mfma_f32_16x16x32_bf16 v[76:79], v[16:19], a[28:31], v[76:79]
    s_waitcnt lgkmcnt(3)
    v_fmac_f32 v115, v143, v128
    v_mul_f32 v96, v96, v132
    v_mfma_f32_16x16x32_bf16 v[80:83], v[20:23], a[16:19], v[80:83]
    ds_read_b128 v[12:15], v4 offset:7168
    v_mul_f32 v97, v97, v132
    v_mfma_f32_16x16x32_bf16 v[84:87], v[20:23], a[20:23], v[84:87]
    v_mul_f32 v98, v98, v132
    v_mul_f32 v99, v99, v132
    v_mfma_f32_16x16x32_bf16 v[88:91], v[20:23], a[24:27], v[88:91]
    buffer_load_dwordx4 v2, s[4:7], s61 offen offset:3072 lds
    v_mfma_f32_16x16x32_bf16 v[92:95], v[20:23], a[28:31], v[92:95]
    s_waitcnt lgkmcnt(3)
    s_add_u32 m0, s49, 118784
    s_add_u32 s61, s48, 266240
    v_mfma_f32_16x16x32_bf16 v[64:67], v[24:27], a[32:35], v[64:67]
    ds_read_b128 v[16:19], v4 offset:8192
    v_mul_f32 v96, v96, v112
    v_mfma_f32_16x16x32_bf16 v[68:71], v[24:27], a[36:39], v[68:71]
    v_mul_f32 v97, v97, v113
    v_mul_f32 v98, v98, v114
    v_mfma_f32_16x16x32_bf16 v[72:75], v[24:27], a[40:43], v[72:75]
    buffer_load_dwordx4 v2, s[4:7], s61 offen offset:0 lds
    v_mfma_f32_16x16x32_bf16 v[76:79], v[24:27], a[44:47], v[76:79]
    s_waitcnt lgkmcnt(3)
    v_mul_f32 v99, v99, v115
    v_cvt_pk_bf16_f32 v194, v96, v97
    v_mfma_f32_16x16x32_bf16 v[80:83], v[28:31], a[32:35], v[80:83]
    ds_read_b128 v[20:23], v4 offset:9216
    v_cvt_pk_bf16_f32 v195, v98, v99
    v_mfma_f32_16x16x32_bf16 v[84:87], v[28:31], a[36:39], v[84:87]
    s_add_u32 s66, s51, 16384
    v_mfma_f32_16x16x32_bf16 v[88:91], v[28:31], a[40:43], v[88:91]
    buffer_store_dwordx4 v[192:195], v2, s[4:7], s66 offen offset:0 sc1
    v_mfma_f32_16x16x32_bf16 v[92:95], v[28:31], a[44:47], v[92:95]
    s_waitcnt lgkmcnt(3)
    v_fmac_f32 v100, v136, v129
    v_fmac_f32 v101, v137, v129
    v_mfma_f32_16x16x32_bf16 v[64:67], v[8:11], a[48:51], v[64:67]
    ds_read_b128 v[24:27], v4 offset:10240
    v_fmac_f32 v102, v138, v129
    v_mfma_f32_16x16x32_bf16 v[68:71], v[8:11], a[52:55], v[68:71]
    v_fmac_f32 v103, v139, v129
    v_fmac_f32 v116, v140, v129
    v_mfma_f32_16x16x32_bf16 v[72:75], v[8:11], a[56:59], v[72:75]
    v_fmac_f32 v117, v141, v129
    v_fmac_f32 v118, v142, v129
    v_mfma_f32_16x16x32_bf16 v[76:79], v[8:11], a[60:63], v[76:79]
    s_waitcnt lgkmcnt(3)
    v_fmac_f32 v119, v143, v129
    v_mul_f32 v100, v100, v133
    v_mfma_f32_16x16x32_bf16 v[80:83], v[12:15], a[48:51], v[80:83]
    ds_read_b128 v[28:31], v4 offset:11264
    v_mul_f32 v101, v101, v133
    v_mfma_f32_16x16x32_bf16 v[84:87], v[12:15], a[52:55], v[84:87]
    v_mul_f32 v102, v102, v133
    v_mul_f32 v103, v103, v133
    v_mfma_f32_16x16x32_bf16 v[88:91], v[12:15], a[56:59], v[88:91]
    v_mul_f32 v100, v100, v116
    v_mul_f32 v101, v101, v117
    v_mfma_f32_16x16x32_bf16 v[92:95], v[12:15], a[60:63], v[92:95]
    s_waitcnt lgkmcnt(3)
    v_mul_f32 v102, v102, v118
    v_mul_f32 v103, v103, v119
    v_mfma_f32_16x16x32_bf16 v[64:67], v[16:19], a[64:67], v[64:67]
    ds_read_b128 v[8:11], v4 offset:12288
    v_cvt_pk_bf16_f32 v198, v100, v101
    v_mfma_f32_16x16x32_bf16 v[68:71], v[16:19], a[68:71], v[68:71]
    v_cvt_pk_bf16_f32 v199, v102, v103
    v_mfma_f32_16x16x32_bf16 v[72:75], v[16:19], a[72:75], v[72:75]
    buffer_store_dwordx4 v[196:199], v2, s[4:7], s66 offen offset:1024 sc1
    v_mfma_f32_16x16x32_bf16 v[76:79], v[16:19], a[76:79], v[76:79]
    s_waitcnt lgkmcnt(3)
    v_fmac_f32 v104, v136, v130
    v_fmac_f32 v105, v137, v130
    v_mfma_f32_16x16x32_bf16 v[80:83], v[20:23], a[64:67], v[80:83]
    ds_read_b128 v[12:15], v4 offset:13312
    v_fmac_f32 v106, v138, v130
    v_mfma_f32_16x16x32_bf16 v[84:87], v[20:23], a[68:71], v[84:87]
    v_fmac_f32 v107, v139, v130
    v_fmac_f32 v120, v140, v130
    v_mfma_f32_16x16x32_bf16 v[88:91], v[20:23], a[72:75], v[88:91]
    v_fmac_f32 v121, v141, v130
    v_fmac_f32 v122, v142, v130
    v_mfma_f32_16x16x32_bf16 v[92:95], v[20:23], a[76:79], v[92:95]
    s_waitcnt lgkmcnt(3)
    v_fmac_f32 v123, v143, v130
    v_mul_f32 v104, v104, v134
    v_mfma_f32_16x16x32_bf16 v[64:67], v[24:27], a[80:83], v[64:67]
    ds_read_b128 v[16:19], v4 offset:14336
    v_mul_f32 v105, v105, v134
    v_mfma_f32_16x16x32_bf16 v[68:71], v[24:27], a[84:87], v[68:71]
    v_mul_f32 v106, v106, v134
    v_mul_f32 v107, v107, v134
    v_mfma_f32_16x16x32_bf16 v[72:75], v[24:27], a[88:91], v[72:75]
    v_mul_f32 v104, v104, v120
    v_mul_f32 v105, v105, v121
    v_mfma_f32_16x16x32_bf16 v[76:79], v[24:27], a[92:95], v[76:79]
    s_waitcnt lgkmcnt(3)
    v_mul_f32 v106, v106, v122
    v_mul_f32 v107, v107, v123
    v_mfma_f32_16x16x32_bf16 v[80:83], v[28:31], a[80:83], v[80:83]
    ds_read_b128 v[20:23], v4 offset:15360
    v_cvt_pk_bf16_f32 v202, v104, v105
    v_mfma_f32_16x16x32_bf16 v[84:87], v[28:31], a[84:87], v[84:87]
    v_cvt_pk_bf16_f32 v203, v106, v107
    v_mfma_f32_16x16x32_bf16 v[88:91], v[28:31], a[88:91], v[88:91]
    buffer_store_dwordx4 v[200:203], v2, s[4:7], s66 offen offset:2048 sc1
    v_mfma_f32_16x16x32_bf16 v[92:95], v[28:31], a[92:95], v[92:95]
    s_waitcnt lgkmcnt(3)
    v_fmac_f32 v108, v136, v131
    v_fmac_f32 v109, v137, v131
    v_mfma_f32_16x16x32_bf16 v[64:67], v[8:11], a[96:99], v[64:67]
    ds_read_b128 v[24:27], v4 offset:16384
    v_fmac_f32 v110, v138, v131
    v_mfma_f32_16x16x32_bf16 v[68:71], v[8:11], a[100:103], v[68:71]
    v_fmac_f32 v111, v139, v131
    v_fmac_f32 v124, v140, v131
    v_mfma_f32_16x16x32_bf16 v[72:75], v[8:11], a[104:107], v[72:75]
    v_fmac_f32 v125, v141, v131
    v_fmac_f32 v126, v142, v131
    v_mfma_f32_16x16x32_bf16 v[76:79], v[8:11], a[108:111], v[76:79]
    s_waitcnt lgkmcnt(3)
    v_fmac_f32 v127, v143, v131
    v_mul_f32 v108, v108, v135
    v_mfma_f32_16x16x32_bf16 v[80:83], v[12:15], a[96:99], v[80:83]
    ds_read_b128 v[28:31], v4 offset:17408
    v_mul_f32 v109, v109, v135
    v_mfma_f32_16x16x32_bf16 v[84:87], v[12:15], a[100:103], v[84:87]
    v_mul_f32 v110, v110, v135
    v_mul_f32 v111, v111, v135
    v_mfma_f32_16x16x32_bf16 v[88:91], v[12:15], a[104:107], v[88:91]
    v_mul_f32 v108, v108, v124
    v_mul_f32 v109, v109, v125
    v_mfma_f32_16x16x32_bf16 v[92:95], v[12:15], a[108:111], v[92:95]
    s_waitcnt lgkmcnt(3)
    v_mul_f32 v110, v110, v126
    v_mul_f32 v111, v111, v127
    v_mfma_f32_16x16x32_bf16 v[64:67], v[16:19], a[112:115], v[64:67]
    ds_read_b128 v[8:11], v4 offset:18432
    v_cvt_pk_bf16_f32 v206, v108, v109
    v_mfma_f32_16x16x32_bf16 v[68:71], v[16:19], a[116:119], v[68:71]
    v_cvt_pk_bf16_f32 v207, v110, v111
    v_mfma_f32_16x16x32_bf16 v[72:75], v[16:19], a[120:123], v[72:75]
    buffer_store_dwordx4 v[204:207], v2, s[4:7], s66 offen offset:3072 sc1
    v_mfma_f32_16x16x32_bf16 v[76:79], v[16:19], a[124:127], v[76:79]
    s_waitcnt lgkmcnt(3)
    ds_read_b128 v[136:139], v5 offset:768
    ds_read_b128 v[140:143], v5 offset:832
    v_mfma_f32_16x16x32_bf16 v[80:83], v[20:23], a[112:115], v[80:83]
    ds_read_b128 v[12:15], v4 offset:19456
    v_mfma_f32_16x16x32_bf16 v[84:87], v[20:23], a[116:119], v[84:87]
    v_mfma_f32_16x16x32_bf16 v[88:91], v[20:23], a[120:123], v[88:91]
    v_mfma_f32_16x16x32_bf16 v[92:95], v[20:23], a[124:127], v[92:95]
    s_waitcnt lgkmcnt(5)
    v_mfma_f32_16x16x32_bf16 v[64:67], v[24:27], a[128:131], v[64:67]
    ds_read_b128 v[16:19], v4 offset:20480
    v_mfma_f32_16x16x32_bf16 v[68:71], v[24:27], a[132:135], v[68:71]
    v_mfma_f32_16x16x32_bf16 v[72:75], v[24:27], a[136:139], v[72:75]
    v_mfma_f32_16x16x32_bf16 v[76:79], v[24:27], a[140:143], v[76:79]
    s_waitcnt lgkmcnt(5)
    v_mfma_f32_16x16x32_bf16 v[80:83], v[28:31], a[128:131], v[80:83]
    ds_read_b128 v[20:23], v4 offset:21504
    v_mfma_f32_16x16x32_bf16 v[84:87], v[28:31], a[132:135], v[84:87]
    v_mfma_f32_16x16x32_bf16 v[88:91], v[28:31], a[136:139], v[88:91]
    v_mfma_f32_16x16x32_bf16 v[92:95], v[28:31], a[140:143], v[92:95]
    s_waitcnt lgkmcnt(5)
    v_mfma_f32_16x16x32_bf16 v[64:67], v[8:11], a[144:147], v[64:67]
    ds_read_b128 v[24:27], v4 offset:22528
    v_mfma_f32_16x16x32_bf16 v[68:71], v[8:11], a[148:151], v[68:71]
    v_mfma_f32_16x16x32_bf16 v[72:75], v[8:11], a[152:155], v[72:75]
    v_mfma_f32_16x16x32_bf16 v[76:79], v[8:11], a[156:159], v[76:79]
    s_waitcnt lgkmcnt(3)
    v_mfma_f32_16x16x32_bf16 v[80:83], v[12:15], a[144:147], v[80:83]
    ds_read_b128 v[28:31], v4 offset:23552
    v_mfma_f32_16x16x32_bf16 v[84:87], v[12:15], a[148:151], v[84:87]
    v_mfma_f32_16x16x32_bf16 v[88:91], v[12:15], a[152:155], v[88:91]
    v_mfma_f32_16x16x32_bf16 v[92:95], v[12:15], a[156:159], v[92:95]
    s_waitcnt lgkmcnt(3)
    v_mfma_f32_16x16x32_bf16 v[64:67], v[16:19], a[160:163], v[64:67]
    ds_read_b128 v[8:11], v4 offset:24576
    v_mfma_f32_16x16x32_bf16 v[68:71], v[16:19], a[164:167], v[68:71]
    v_mfma_f32_16x16x32_bf16 v[72:75], v[16:19], a[168:171], v[72:75]
    v_mfma_f32_16x16x32_bf16 v[76:79], v[16:19], a[172:175], v[76:79]
    s_waitcnt lgkmcnt(3)
    v_mfma_f32_16x16x32_bf16 v[80:83], v[20:23], a[160:163], v[80:83]
    ds_read_b128 v[12:15], v4 offset:25600
    v_mfma_f32_16x16x32_bf16 v[84:87], v[20:23], a[164:167], v[84:87]
    v_mfma_f32_16x16x32_bf16 v[88:91], v[20:23], a[168:171], v[88:91]
    v_mfma_f32_16x16x32_bf16 v[92:95], v[20:23], a[172:175], v[92:95]
    s_waitcnt lgkmcnt(3)
    v_mfma_f32_16x16x32_bf16 v[64:67], v[24:27], a[176:179], v[64:67]
    ds_read_b128 v[16:19], v4 offset:26624
    v_mfma_f32_16x16x32_bf16 v[68:71], v[24:27], a[180:183], v[68:71]
    v_mfma_f32_16x16x32_bf16 v[72:75], v[24:27], a[184:187], v[72:75]
    v_mfma_f32_16x16x32_bf16 v[76:79], v[24:27], a[188:191], v[76:79]
    s_waitcnt lgkmcnt(3)
    v_mfma_f32_16x16x32_bf16 v[80:83], v[28:31], a[176:179], v[80:83]
    ds_read_b128 v[20:23], v4 offset:27648
    v_mfma_f32_16x16x32_bf16 v[84:87], v[28:31], a[180:183], v[84:87]
    v_mfma_f32_16x16x32_bf16 v[88:91], v[28:31], a[184:187], v[88:91]
    v_mfma_f32_16x16x32_bf16 v[92:95], v[28:31], a[188:191], v[92:95]
    s_waitcnt lgkmcnt(3)
    v_mfma_f32_16x16x32_bf16 v[64:67], v[8:11], a[192:195], v[64:67]
    ds_read_b128 v[24:27], v4 offset:28672
    v_mfma_f32_16x16x32_bf16 v[68:71], v[8:11], a[196:199], v[68:71]
    v_mfma_f32_16x16x32_bf16 v[72:75], v[8:11], a[200:203], v[72:75]
    v_mfma_f32_16x16x32_bf16 v[76:79], v[8:11], a[204:207], v[76:79]
    s_waitcnt lgkmcnt(3)
    v_mfma_f32_16x16x32_bf16 v[80:83], v[12:15], a[192:195], v[80:83]
    ds_read_b128 v[28:31], v4 offset:29696
    v_mfma_f32_16x16x32_bf16 v[84:87], v[12:15], a[196:199], v[84:87]
    v_mfma_f32_16x16x32_bf16 v[88:91], v[12:15], a[200:203], v[88:91]
    v_mfma_f32_16x16x32_bf16 v[92:95], v[12:15], a[204:207], v[92:95]
    s_waitcnt lgkmcnt(3)
    v_mfma_f32_16x16x32_bf16 v[64:67], v[16:19], a[208:211], v[64:67]
    ds_read_b128 v[8:11], v4 offset:30720
    v_mfma_f32_16x16x32_bf16 v[68:71], v[16:19], a[212:215], v[68:71]
    v_mfma_f32_16x16x32_bf16 v[72:75], v[16:19], a[216:219], v[72:75]
    v_mfma_f32_16x16x32_bf16 v[76:79], v[16:19], a[220:223], v[76:79]
    s_waitcnt lgkmcnt(3)
    v_mfma_f32_16x16x32_bf16 v[80:83], v[20:23], a[208:211], v[80:83]
    ds_read_b128 v[12:15], v4 offset:31744
    v_mfma_f32_16x16x32_bf16 v[84:87], v[20:23], a[212:215], v[84:87]
    v_mfma_f32_16x16x32_bf16 v[88:91], v[20:23], a[216:219], v[88:91]
    v_mfma_f32_16x16x32_bf16 v[92:95], v[20:23], a[220:223], v[92:95]
    s_waitcnt lgkmcnt(3)
    v_mfma_f32_16x16x32_bf16 v[64:67], v[24:27], a[224:227], v[64:67]
    ds_read_b128 v[16:19], v4 offset:32768
    v_mfma_f32_16x16x32_bf16 v[68:71], v[24:27], a[228:231], v[68:71]
    v_mfma_f32_16x16x32_bf16 v[72:75], v[24:27], a[232:235], v[72:75]
    v_mfma_f32_16x16x32_bf16 v[76:79], v[24:27], a[236:239], v[76:79]
    s_waitcnt lgkmcnt(3)
    v_mfma_f32_16x16x32_bf16 v[80:83], v[28:31], a[224:227], v[80:83]
    ds_read_b128 v[20:23], v4 offset:33792
    v_mfma_f32_16x16x32_bf16 v[84:87], v[28:31], a[228:231], v[84:87]
    v_mfma_f32_16x16x32_bf16 v[88:91], v[28:31], a[232:235], v[88:91]
    v_mfma_f32_16x16x32_bf16 v[92:95], v[28:31], a[236:239], v[92:95]
    s_waitcnt lgkmcnt(3)
    v_mfma_f32_16x16x32_bf16 v[64:67], v[8:11], a[240:243], v[64:67]
    ds_read_b128 v[24:27], v4 offset:34816
    v_mfma_f32_16x16x32_bf16 v[68:71], v[8:11], a[244:247], v[68:71]
    v_mfma_f32_16x16x32_bf16 v[72:75], v[8:11], a[248:251], v[72:75]
    v_mfma_f32_16x16x32_bf16 v[76:79], v[8:11], a[252:255], v[76:79]
    s_waitcnt lgkmcnt(3)
    v_mfma_f32_16x16x32_bf16 v[80:83], v[12:15], a[240:243], v[80:83]
    ds_read_b128 v[28:31], v4 offset:35840
    v_mfma_f32_16x16x32_bf16 v[84:87], v[12:15], a[244:247], v[84:87]
    v_mfma_f32_16x16x32_bf16 v[88:91], v[12:15], a[248:251], v[88:91]
    v_mfma_f32_16x16x32_bf16 v[92:95], v[12:15], a[252:255], v[92:95]
    s_waitcnt lgkmcnt(3)
    v_mfma_f32_16x16x32_bf16 v[64:67], v[16:19], v[32:35], v[64:67]
    s_barrier
    v_add_u32 v4, 0x9000, v4
    v_mfma_f32_16x16x32_bf16 v[68:71], v[16:19], v[36:39], v[68:71]
    s_add_u32 m0, s49, 0
    s_add_u32 s61, s48, 294912
    ds_read_b128 v[8:11], v4 offset:0
    v_mfma_f32_16x16x32_bf16 v[72:75], v[16:19], v[40:43], v[72:75]
    buffer_load_dwordx4 v2, s[4:7], s61 offen offset:0 lds
    v_mfma_f32_16x16x32_bf16 v[76:79], v[16:19], v[44:47], v[76:79]
    s_waitcnt lgkmcnt(3)
    v_mfma_f32_16x16x32_bf16 v[80:83], v[20:23], v[32:35], v[80:83]
    ds_read_b128 v[12:15], v4 offset:1024
    v_mfma_f32_16x16x32_bf16 v[84:87], v[20:23], v[36:39], v[84:87]
    v_mfma_f32_16x16x32_bf16 v[88:91], v[20:23], v[40:43], v[88:91]
    buffer_load_dwordx4 v2, s[4:7], s61 offen offset:1024 lds
    v_mfma_f32_16x16x32_bf16 v[92:95], v[20:23], v[44:47], v[92:95]
    s_waitcnt lgkmcnt(3)
    v_mfma_f32_16x16x32_bf16 v[64:67], v[24:27], v[48:51], v[64:67]
    ds_read_b128 v[16:19], v4 offset:2048
    v_mfma_f32_16x16x32_bf16 v[68:71], v[24:27], v[52:55], v[68:71]
    v_mfma_f32_16x16x32_bf16 v[72:75], v[24:27], v[56:59], v[72:75]
    buffer_load_dwordx4 v2, s[4:7], s61 offen offset:2048 lds
    v_mfma_f32_16x16x32_bf16 v[76:79], v[24:27], v[60:63], v[76:79]
    s_waitcnt lgkmcnt(3)
    v_mfma_f32_16x16x32_bf16 v[80:83], v[28:31], v[48:51], v[80:83]
    ds_read_b128 v[20:23], v4 offset:3072
    v_mfma_f32_16x16x32_bf16 v[84:87], v[28:31], v[52:55], v[84:87]
    v_mfma_f32_16x16x32_bf16 v[88:91], v[28:31], v[56:59], v[88:91]
    buffer_load_dwordx4 v2, s[4:7], s61 offen offset:3072 lds
    v_mfma_f32_16x16x32_bf16 v[92:95], v[28:31], v[60:63], v[92:95]
    s_waitcnt lgkmcnt(3)
    s_add_u32 m0, s49, 4096
    s_add_u32 s61, s48, 299008
    v_mfma_f32_16x16x32_bf16 v[96:99], v[8:11], a[0:3], 0
    ds_read_b128 v[24:27], v4 offset:4096
    v_mfma_f32_16x16x32_bf16 v[100:103], v[8:11], a[4:7], 0
    v_mfma_f32_16x16x32_bf16 v[104:107], v[8:11], a[8:11], 0
    buffer_load_dwordx4 v2, s[4:7], s61 offen offset:0 lds
    v_mfma_f32_16x16x32_bf16 v[108:111], v[8:11], a[12:15], 0
    s_waitcnt lgkmcnt(3)
    v_mfma_f32_16x16x32_bf16 v[112:115], v[12:15], a[0:3], 0
    ds_read_b128 v[28:31], v4 offset:5120
    v_mfma_f32_16x16x32_bf16 v[116:119], v[12:15], a[4:7], 0
    v_fmac_f32 v64, v144, v128
    v_fmac_f32 v65, v145, v128
    v_mfma_f32_16x16x32_bf16 v[120:123], v[12:15], a[8:11], 0
    buffer_load_dwordx4 v2, s[4:7], s61 offen offset:1024 lds
    v_mfma_f32_16x16x32_bf16 v[124:127], v[12:15], a[12:15], 0
    s_waitcnt lgkmcnt(3)
    v_fmac_f32 v66, v146, v128
    v_fmac_f32 v67, v147, v128
    v_mfma_f32_16x16x32_bf16 v[96:99], v[16:19], a[16:19], v[96:99]
    ds_read_b128 v[8:11], v4 offset:6144
    v_fmac_f32 v80, v148, v128
    v_mfma_f32_16x16x32_bf16 v[100:103], v[16:19], a[20:23], v[100:103]
    v_fmac_f32 v81, v149, v128
    v_fmac_f32 v82, v150, v128
    v_mfma_f32_16x16x32_bf16 v[104:107], v[16:19], a[24:27], v[104:107]
    buffer_load_dwordx4 v2, s[4:7], s61 offen offset:2048 lds
    v_mfma_f32_16x16x32_bf16 v[108:111], v[16:19], a[28:31], v[108:111]
    s_waitcnt lgkmcnt(3)
    v_fmac_f32 v83, v151, v128
    v_mul_f32 v64, v64, v132
    v_mfma_f32_16x16x32_bf16 v[112:115], v[20:23], a[16:19], v[112:115]
    ds_read_b128 v[12:15], v4 offset:7168
    v_mul_f32 v65, v65, v132
    v_mfma_f32_16x16x32_bf16 v[116:119], v[20:23], a[20:23], v[116:119]
    v_mul_f32 v66, v66, v132
    v_mul_f32 v67, v67, v132
    v_mfma_f32_16x16x32_bf16 v[120:123], v[20:23], a[24:27], v[120:123]
    buffer_load_dwordx4 v2, s[4:7], s61 offen offset:3072 lds
    v_mfma_f32_16x16x32_bf16 v[124:127], v[20:23], a[28:31], v[124:127]
    s_waitcnt lgkmcnt(3)
    s_add_u32 m0, s49, 8192
    s_add_u32 s61, s48, 303104
    v_mfma_f32_16x16x32_bf16 v[96:99], v[24:27], a[32:35], v[96:99]
    ds_read_b128 v[16:19], v4 offset:8192
    v_mul_f32 v64, v64, v80
    v_mfma_f32_16x16x32_bf16 v[100:103], v[24:27], a[36:39], v[100:103]
    v_mul_f32 v65, v65, v81
    v_mul_f32 v66, v66, v82
    v_mfma_f32_16x16x32_bf16 v[104:107], v[24:27], a[40:43], v[104:107]
    buffer_load_dwordx4 v2, s[4:7], s61 offen offset:0 lds
    v_mfma_f32_16x16x32_bf16 v[108:111], v[24:27], a[44:47], v[108:111]
    s_waitcnt lgkmcnt(3)
    v_mul_f32 v67, v67, v83
    v_cvt_pk_bf16_f32 v208, v64, v65
    v_mfma_f32_16x16x32_bf16 v[112:115], v[28:31], a[32:35], v[112:115]
    ds_read_b128 v[20:23], v4 offset:9216
    v_cvt_pk_bf16_f32 v209, v66, v67
    v_mfma_f32_16x16x32_bf16 v[116:119], v[28:31], a[36:39], v[116:119]
    v_fmac_f32 v68, v144, v129
    v_fmac_f32 v69, v145, v129
    v_mfma_f32_16x16x32_bf16 v[120:123], v[28:31], a[40:43], v[120:123]
    v_fmac_f32 v70, v146, v129
    v_fmac_f32 v71, v147, v129
    v_mfma_f32_16x16x32_bf16 v[124:127], v[28:31], a[44:47], v[124:127]
    s_waitcnt lgkmcnt(3)
    v_fmac_f32 v84, v148, v129
    v_fmac_f32 v85, v149, v129
    v_mfma_f32_16x16x32_bf16 v[96:99], v[8:11], a[48:51], v[96:99]
    ds_read_b128 v[24:27], v4 offset:10240
    v_fmac_f32 v86, v150, v129
    v_mfma_f32_16x16x32_bf16 v[100:103], v[8:11], a[52:55], v[100:103]
    v_fmac_f32 v87, v151, v129
    v_mul_f32 v68, v68, v133
    v_mfma_f32_16x16x32_bf16 v[104:107], v[8:11], a[56:59], v[104:107]
    v_mul_f32 v69, v69, v133
    v_mul_f32 v70, v70, v133
    v_mfma_f32_16x16x32_bf16 v[108:111], v[8:11], a[60:63], v[108:111]
    s_waitcnt lgkmcnt(3)
    v_mul_f32 v71, v71, v133
    v_mul_f32 v68, v68, v84
    v_mfma_f32_16x16x32_bf16 v[112:115], v[12:15], a[48:51], v[112:115]
    ds_read_b128 v[28:31], v4 offset:11264
    v_mul_f32 v69, v69, v85
    v_mfma_f32_16x16x32_bf16 v[116:119], v[12:15], a[52:55], v[116:119]
    v_mul_f32 v70, v70, v86
    v_mul_f32 v71, v71, v87
    v_mfma_f32_16x16x32_bf16 v[120:123], v[12:15], a[56:59], v[120:123]
    v_cvt_pk_bf16_f32 v212, v68, v69
    v_cvt_pk_bf16_f32 v213, v70, v71
    v_mfma_f32_16x16x32_bf16 v[124:127], v[12:15], a[60:63], v[124:127]
    s_waitcnt lgkmcnt(3)
    v_fmac_f32 v72, v144, v130
    v_fmac_f32 v73, v145, v130
    v_mfma_f32_16x16x32_bf16 v[96:99], v[16:19], a[64:67], v[96:99]
    ds_read_b128 v[8:11], v4 offset:12288
    v_fmac_f32 v74, v146, v130
    v_mfma_f32_16x16x32_bf16 v[100:103], v[16:19], a[68:71], v[100:103]
    v_fmac_f32 v75, v147, v130
    v_fmac_f32 v88, v148, v130
    v_mfma_f32_16x16x32_bf16 v[104:107], v[16:19], a[72:75], v[104:107]
    v_fmac_f32 v89, v149, v130
    v_fmac_f32 v90, v150, v130
    v_mfma_f32_16x16x32_bf16 v[108:111], v[16:19], a[76:79], v[108:111]
    s_waitcnt lgkmcnt(3)
    v_fmac_f32 v91, v151, v130
    v_mul_f32 v72, v72, v134
    v_mfma_f32_16x16x32_bf16 v[112:115], v[20:23], a[64:67], v[112:115]
    ds_read_b128 v[12:15], v4 offset:13312
    v_mul_f32 v73, v73, v134
    v_mfma_f32_16x16x32_bf16 v[116:119], v[20:23], a[68:71], v[116:119]
    v_mul_f32 v74, v74, v134
    v_mul_f32 v75, v75, v134
    v_mfma_f32_16x16x32_bf16 v[120:123], v[20:23], a[72:75], v[120:123]
    v_mul_f32 v72, v72, v88
    v_mul_f32 v73, v73, v89
    v_mfma_f32_16x16x32_bf16 v[124:127], v[20:23], a[76:79], v[124:127]
    s_waitcnt lgkmcnt(3)
    v_mul_f32 v74, v74, v90
    v_mul_f32 v75, v75, v91
    v_mfma_f32_16x16x32_bf16 v[96:99], v[24:27], a[80:83], v[96:99]
    ds_read_b128 v[16:19], v4 offset:14336
    v_cvt_pk_bf16_f32 v216, v72, v73
    v_mfma_f32_16x16x32_bf16 v[100:103], v[24:27], a[84:87], v[100:103]
    v_cvt_pk_bf16_f32 v217, v74, v75
    v_fmac_f32 v76, v144, v131
    v_mfma_f32_16x16x32_bf16 v[104:107], v[24:27], a[88:91], v[104:107]
    v_fmac_f32 v77, v145, v131
    v_fmac_f32 v78, v146, v131
    v_mfma_f32_16x16x32_bf16 v[108:111], v[24:27], a[92:95], v[108:111]
    s_waitcnt lgkmcnt(3)
    v_fmac_f32 v79, v147, v131
    v_fmac_f32 v92, v148, v131
    v_mfma_f32_16x16x32_bf16 v[112:115], v[28:31], a[80:83], v[112:115]
    ds_read_b128 v[20:23], v4 offset:15360
    v_fmac_f32 v93, v149, v131
    v_mfma_f32_16x16x32_bf16 v[116:119], v[28:31], a[84:87], v[116:119]
    v_fmac_f32 v94, v150, v131
    v_fmac_f32 v95, v151, v131
    v_mfma_f32_16x16x32_bf16 v[120:123], v[28:31], a[88:91], v[120:123]
    v_mul_f32 v76, v76, v135
    v_mul_f32 v77, v77, v135
    v_mfma_f32_16x16x32_bf16 v[124:127], v[28:31], a[92:95], v[124:127]
    s_waitcnt lgkmcnt(3)
    v_mul_f32 v78, v78, v135
    v_mul_f32 v79, v79, v135
    v_mfma_f32_16x16x32_bf16 v[96:99], v[8:11], a[96:99], v[96:99]
    ds_read_b128 v[24:27], v4 offset:16384
    v_mul_f32 v76, v76, v92
    v_mfma_f32_16x16x32_bf16 v[100:103], v[8:11], a[100:103], v[100:103]
    v_mul_f32 v77, v77, v93
    v_mul_f32 v78, v78, v94
    v_mfma_f32_16x16x32_bf16 v[104:107], v[8:11], a[104:107], v[104:107]
    v_mul_f32 v79, v79, v95
    v_cvt_pk_bf16_f32 v220, v76, v77
    v_mfma_f32_16x16x32_bf16 v[108:111], v[8:11], a[108:111], v[108:111]
    s_waitcnt lgkmcnt(3)
    v_cvt_pk_bf16_f32 v221, v78, v79
    v_mfma_f32_16x16x32_bf16 v[112:115], v[12:15], a[96:99], v[112:115]
    ds_read_b128 v[28:31], v4 offset:17408
    ds_read_b128 v[144:147], v5 offset:896
    v_mfma_f32_16x16x32_bf16 v[116:119], v[12:15], a[100:103], v[116:119]
    ds_read_b128 v[148:151], v5 offset:960
    v_mfma_f32_16x16x32_bf16 v[120:123], v[12:15], a[104:107], v[120:123]
    v_mfma_f32_16x16x32_bf16 v[124:127], v[12:15], a[108:111], v[124:127]
    s_waitcnt lgkmcnt(5)
    v_mfma_f32_16x16x32_bf16 v[96:99], v[16:19], a[112:115], v[96:99]
    ds_read_b128 v[8:11], v4 offset:18432
    v_mfma_f32_16x16x32_bf16 v[100:103], v[16:19], a[116:119], v[100:103]
    s_add_u32 s71, s67, 0
    v_mov_b32 v6, s98
    v_mov_b32 v7, s99
    v_mfma_f32_16x16x32_bf16 v[104:107], v[16:19], a[120:123], v[104:107]
    v_mfma_f32_16x16x32_bf16 v[108:111], v[16:19], a[124:127], v[108:111]
    s_waitcnt lgkmcnt(5)
    s_waitcnt vmcnt(9)
    v_mfma_f32_16x16x32_bf16 v[112:115], v[20:23], a[112:115], v[112:115]
    ds_read_b128 v[12:15], v4 offset:19456
    v_mfma_f32_16x16x32_bf16 v[116:119], v[20:23], a[116:119], v[116:119]
    s_mov_b64 exec, 1
    buffer_store_dwordx2 v[6:7], off, s[4:7], s71 sc1
    s_mov_b64 exec, -1
    v_mfma_f32_16x16x32_bf16 v[120:123], v[20:23], a[120:123], v[120:123]
    v_mfma_f32_16x16x32_bf16 v[124:127], v[20:23], a[124:127], v[124:127]
    s_waitcnt lgkmcnt(5)
    v_mfma_f32_16x16x32_bf16 v[96:99], v[24:27], a[128:131], v[96:99]
    ds_read_b128 v[16:19], v4 offset:20480
    v_mfma_f32_16x16x32_bf16 v[100:103], v[24:27], a[132:135], v[100:103]
    v_mfma_f32_16x16x32_bf16 v[104:107], v[24:27], a[136:139], v[104:107]
    v_mfma_f32_16x16x32_bf16 v[108:111], v[24:27], a[140:143], v[108:111]
    s_waitcnt lgkmcnt(5)
    v_mfma_f32_16x16x32_bf16 v[112:115], v[28:31], a[128:131], v[112:115]
    ds_read_b128 v[20:23], v4 offset:21504
    v_mfma_f32_16x16x32_bf16 v[116:119], v[28:31], a[132:135], v[116:119]
    v_mfma_f32_16x16x32_bf16 v[120:123], v[28:31], a[136:139], v[120:123]
    v_mfma_f32_16x16x32_bf16 v[124:127], v[28:31], a[140:143], v[124:127]
    s_waitcnt lgkmcnt(3)
    v_mfma_f32_16x16x32_bf16 v[96:99], v[8:11], a[144:147], v[96:99]
    ds_read_b128 v[24:27], v4 offset:22528
    v_mfma_f32_16x16x32_bf16 v[100:103], v[8:11], a[148:151], v[100:103]
    v_mfma_f32_16x16x32_bf16 v[104:107], v[8:11], a[152:155], v[104:107]
    v_mfma_f32_16x16x32_bf16 v[108:111], v[8:11], a[156:159], v[108:111]
    s_waitcnt lgkmcnt(3)
    v_mfma_f32_16x16x32_bf16 v[112:115], v[12:15], a[144:147], v[112:115]
    ds_read_b128 v[28:31], v4 offset:23552
    v_mfma_f32_16x16x32_bf16 v[116:119], v[12:15], a[148:151], v[116:119]
    v_mfma_f32_16x16x32_bf16 v[120:123], v[12:15], a[152:155], v[120:123]
    v_mfma_f32_16x16x32_bf16 v[124:127], v[12:15], a[156:159], v[124:127]
    s_waitcnt lgkmcnt(3)
    v_mfma_f32_16x16x32_bf16 v[96:99], v[16:19], a[160:163], v[96:99]
    ds_read_b128 v[8:11], v4 offset:24576
    v_mfma_f32_16x16x32_bf16 v[100:103], v[16:19], a[164:167], v[100:103]
    v_mfma_f32_16x16x32_bf16 v[104:107], v[16:19], a[168:171], v[104:107]
    v_mfma_f32_16x16x32_bf16 v[108:111], v[16:19], a[172:175], v[108:111]
    s_waitcnt lgkmcnt(3)
    v_mfma_f32_16x16x32_bf16 v[112:115], v[20:23], a[160:163], v[112:115]
    ds_read_b128 v[12:15], v4 offset:25600
    v_mfma_f32_16x16x32_bf16 v[116:119], v[20:23], a[164:167], v[116:119]
    v_mfma_f32_16x16x32_bf16 v[120:123], v[20:23], a[168:171], v[120:123]
    v_mfma_f32_16x16x32_bf16 v[124:127], v[20:23], a[172:175], v[124:127]
    s_waitcnt lgkmcnt(3)
    v_mfma_f32_16x16x32_bf16 v[96:99], v[24:27], a[176:179], v[96:99]
    ds_read_b128 v[16:19], v4 offset:26624
    v_mfma_f32_16x16x32_bf16 v[100:103], v[24:27], a[180:183], v[100:103]
    v_mfma_f32_16x16x32_bf16 v[104:107], v[24:27], a[184:187], v[104:107]
    v_mfma_f32_16x16x32_bf16 v[108:111], v[24:27], a[188:191], v[108:111]
    s_waitcnt lgkmcnt(3)
    v_mfma_f32_16x16x32_bf16 v[112:115], v[28:31], a[176:179], v[112:115]
    ds_read_b128 v[20:23], v4 offset:27648
    v_mfma_f32_16x16x32_bf16 v[116:119], v[28:31], a[180:183], v[116:119]
    v_mfma_f32_16x16x32_bf16 v[120:123], v[28:31], a[184:187], v[120:123]
    v_mfma_f32_16x16x32_bf16 v[124:127], v[28:31], a[188:191], v[124:127]
    s_waitcnt lgkmcnt(3)
    v_mfma_f32_16x16x32_bf16 v[96:99], v[8:11], a[192:195], v[96:99]
    ds_read_b128 v[24:27], v4 offset:28672
    v_mfma_f32_16x16x32_bf16 v[100:103], v[8:11], a[196:199], v[100:103]
    v_mfma_f32_16x16x32_bf16 v[104:107], v[8:11], a[200:203], v[104:107]
    v_mfma_f32_16x16x32_bf16 v[108:111], v[8:11], a[204:207], v[108:111]
    s_waitcnt lgkmcnt(3)
    v_mfma_f32_16x16x32_bf16 v[112:115], v[12:15], a[192:195], v[112:115]
    ds_read_b128 v[28:31], v4 offset:29696
    v_mfma_f32_16x16x32_bf16 v[116:119], v[12:15], a[196:199], v[116:119]
    v_mfma_f32_16x16x32_bf16 v[120:123], v[12:15], a[200:203], v[120:123]
    v_mfma_f32_16x16x32_bf16 v[124:127], v[12:15], a[204:207], v[124:127]
    s_waitcnt lgkmcnt(3)
    v_mfma_f32_16x16x32_bf16 v[96:99], v[16:19], a[208:211], v[96:99]
    ds_read_b128 v[8:11], v4 offset:30720
    v_mfma_f32_16x16x32_bf16 v[100:103], v[16:19], a[212:215], v[100:103]
    v_mfma_f32_16x16x32_bf16 v[104:107], v[16:19], a[216:219], v[104:107]
    v_mfma_f32_16x16x32_bf16 v[108:111], v[16:19], a[220:223], v[108:111]
    s_waitcnt lgkmcnt(3)
    v_mfma_f32_16x16x32_bf16 v[112:115], v[20:23], a[208:211], v[112:115]
    ds_read_b128 v[12:15], v4 offset:31744
    v_mfma_f32_16x16x32_bf16 v[116:119], v[20:23], a[212:215], v[116:119]
    v_mfma_f32_16x16x32_bf16 v[120:123], v[20:23], a[216:219], v[120:123]
    v_mfma_f32_16x16x32_bf16 v[124:127], v[20:23], a[220:223], v[124:127]
    s_waitcnt lgkmcnt(3)
    v_mfma_f32_16x16x32_bf16 v[96:99], v[24:27], a[224:227], v[96:99]
    ds_read_b128 v[16:19], v4 offset:32768
    v_mfma_f32_16x16x32_bf16 v[100:103], v[24:27], a[228:231], v[100:103]
    v_mfma_f32_16x16x32_bf16 v[104:107], v[24:27], a[232:235], v[104:107]
    v_mfma_f32_16x16x32_bf16 v[108:111], v[24:27], a[236:239], v[108:111]
    s_waitcnt lgkmcnt(3)
    v_mfma_f32_16x16x32_bf16 v[112:115], v[28:31], a[224:227], v[112:115]
    ds_read_b128 v[20:23], v4 offset:33792
    v_mfma_f32_16x16x32_bf16 v[116:119], v[28:31], a[228:231], v[116:119]
    v_mfma_f32_16x16x32_bf16 v[120:123], v[28:31], a[232:235], v[120:123]
    v_mfma_f32_16x16x32_bf16 v[124:127], v[28:31], a[236:239], v[124:127]
    s_waitcnt lgkmcnt(3)
    v_mfma_f32_16x16x32_bf16 v[96:99], v[8:11], a[240:243], v[96:99]
    ds_read_b128 v[24:27], v4 offset:34816
    v_mfma_f32_16x16x32_bf16 v[100:103], v[8:11], a[244:247], v[100:103]
    v_mfma_f32_16x16x32_bf16 v[104:107], v[8:11], a[248:251], v[104:107]
    v_mfma_f32_16x16x32_bf16 v[108:111], v[8:11], a[252:255], v[108:111]
    s_waitcnt lgkmcnt(3)
    v_mfma_f32_16x16x32_bf16 v[112:115], v[12:15], a[240:243], v[112:115]
    ds_read_b128 v[28:31], v4 offset:35840
    v_mfma_f32_16x16x32_bf16 v[116:119], v[12:15], a[244:247], v[116:119]
    v_mfma_f32_16x16x32_bf16 v[120:123], v[12:15], a[248:251], v[120:123]
    v_mfma_f32_16x16x32_bf16 v[124:127], v[12:15], a[252:255], v[124:127]
    s_waitcnt lgkmcnt(3)
    v_mfma_f32_16x16x32_bf16 v[96:99], v[16:19], v[32:35], v[96:99]
    s_barrier
    v_add_u32 v4, 0x9000, v4
    v_mfma_f32_16x16x32_bf16 v[100:103], v[16:19], v[36:39], v[100:103]
    s_add_u32 m0, s49, 36864
    s_add_u32 s61, s48, 331776
    ds_read_b128 v[8:11], v4 offset:0
    v_mfma_f32_16x16x32_bf16 v[104:107], v[16:19], v[40:43], v[104:107]
    buffer_load_dwordx4 v2, s[4:7], s61 offen offset:0 lds
    v_mfma_f32_16x16x32_bf16 v[108:111], v[16:19], v[44:47], v[108:111]
    s_waitcnt lgkmcnt(3)
    v_mfma_f32_16x16x32_bf16 v[112:115], v[20:23], v[32:35], v[112:115]
    ds_read_b128 v[12:15], v4 offset:1024
    v_mfma_f32_16x16x32_bf16 v[116:119], v[20:23], v[36:39], v[116:119]
    v_mfma_f32_16x16x32_bf16 v[120:123], v[20:23], v[40:43], v[120:123]
    buffer_load_dwordx4 v2, s[4:7], s61 offen offset:1024 lds
    v_mfma_f32_16x16x32_bf16 v[124:127], v[20:23], v[44:47], v[124:127]
    s_waitcnt lgkmcnt(3)
    v_mfma_f32_16x16x32_bf16 v[96:99], v[24:27], v[48:51], v[96:99]
    ds_read_b128 v[16:19], v4 offset:2048
    v_mfma_f32_16x16x32_bf16 v[100:103], v[24:27], v[52:55], v[100:103]
    v_mfma_f32_16x16x32_bf16 v[104:107], v[24:27], v[56:59], v[104:107]
    buffer_load_dwordx4 v2, s[4:7], s61 offen offset:2048 lds
    v_mfma_f32_16x16x32_bf16 v[108:111], v[24:27], v[60:63], v[108:111]
    s_waitcnt lgkmcnt(3)
    v_mfma_f32_16x16x32_bf16 v[112:115], v[28:31], v[48:51], v[112:115]
    ds_read_b128 v[20:23], v4 offset:3072
    v_mfma_f32_16x16x32_bf16 v[116:119], v[28:31], v[52:55], v[116:119]
    v_mfma_f32_16x16x32_bf16 v[120:123], v[28:31], v[56:59], v[120:123]
    buffer_load_dwordx4 v2, s[4:7], s61 offen offset:3072 lds
    v_mfma_f32_16x16x32_bf16 v[124:127], v[28:31], v[60:63], v[124:127]
    s_waitcnt lgkmcnt(3)
    s_add_u32 m0, s49, 40960
    s_add_u32 s61, s48, 335872
    v_mfma_f32_16x16x32_bf16 v[64:67], v[8:11], a[0:3], 0
    ds_read_b128 v[24:27], v4 offset:4096
    v_mfma_f32_16x16x32_bf16 v[68:71], v[8:11], a[4:7], 0
    v_mfma_f32_16x16x32_bf16 v[72:75], v[8:11], a[8:11], 0
    buffer_load_dwordx4 v2, s[4:7], s61 offen offset:0 lds
    v_mfma_f32_16x16x32_bf16 v[76:79], v[8:11], a[12:15], 0
    s_waitcnt lgkmcnt(3)
    v_mfma_f32_16x16x32_bf16 v[80:83], v[12:15], a[0:3], 0
    ds_read_b128 v[28:31], v4 offset:5120
    v_mfma_f32_16x16x32_bf16 v[84:87], v[12:15], a[4:7], 0
    v_fmac_f32 v96, v136, v128
    v_fmac_f32 v97, v137, v128
    v_mfma_f32_16x16x32_bf16 v[88:91], v[12:15], a[8:11], 0
    buffer_load_dwordx4 v2, s[4:7], s61 offen offset:1024 lds
    v_mfma_f32_16x16x32_bf16 v[92:95], v[12:15], a[12:15], 0
    s_waitcnt lgkmcnt(3)
    v_fmac_f32 v98, v138, v128
    v_fmac_f32 v99, v139, v128
    v_mfma_f32_16x16x32_bf16 v[64:67], v[16:19], a[16:19], v[64:67]
    ds_read_b128 v[8:11], v4 offset:6144
    v_fmac_f32 v112, v140, v128
    v_mfma_f32_16x16x32_bf16 v[68:71], v[16:19], a[20:23], v[68:71]
    v_fmac_f32 v113, v141, v128
    v_fmac_f32 v114, v142, v128
    v_mfma_f32_16x16x32_bf16 v[72:75], v[16:19], a[24:27], v[72:75]
    buffer_load_dwordx4 v2, s[4:7], s61 offen offset:2048 lds
    v_mfma_f32_16x16x32_bf16 v[76:79], v[16:19], a[28:31], v[76:79]
    s_waitcnt lgkmcnt(3)
    v_fmac_f32 v115, v143, v128
    v_mul_f32 v96, v96, v132
    v_mfma_f32_16x16x32_bf16 v[80:83], v[20:23], a[16:19], v[80:83]
    ds_read_b128 v[12:15], v4 offset:7168
    v_mul_f32 v97, v97, v132
    v_mfma_f32_16x16x32_bf16 v[84:87], v[20:23], a[20:23], v[84:87]
    v_mul_f32 v98, v98, v132
    v_mul_f32 v99, v99, v132
    v_mfma_f32_16x16x32_bf16 v[88:91], v[20:23], a[24:27], v[88:91]
    buffer_load_dwordx4 v2, s[4:7], s61 offen offset:3072 lds
    v_mfma_f32_16x16x32_bf16 v[92:95], v[20:23], a[28:31], v[92:95]
    s_waitcnt lgkmcnt(3)
    s_add_u32 m0, s49, 45056
    s_add_u32 s61, s48, 339968
    v_mfma_f32_16x16x32_bf16 v[64:67], v[24:27], a[32:35], v[64:67]
    ds_read_b128 v[16:19], v4 offset:8192
    v_mul_f32 v96, v96, v112
    v_mfma_f32_16x16x32_bf16 v[68:71], v[24:27], a[36:39], v[68:71]
    v_mul_f32 v97, v97, v113
    v_mul_f32 v98, v98, v114
    v_mfma_f32_16x16x32_bf16 v[72:75], v[24:27], a[40:43], v[72:75]
    buffer_load_dwordx4 v2, s[4:7], s61 offen offset:0 lds
    v_mfma_f32_16x16x32_bf16 v[76:79], v[24:27], a[44:47], v[76:79]
    s_waitcnt lgkmcnt(3)
    v_mul_f32 v99, v99, v115
    v_cvt_pk_bf16_f32 v210, v96, v97
    v_mfma_f32_16x16x32_bf16 v[80:83], v[28:31], a[32:35], v[80:83]
    ds_read_b128 v[20:23], v4 offset:9216
    v_cvt_pk_bf16_f32 v211, v98, v99
    v_mfma_f32_16x16x32_bf16 v[84:87], v[28:31], a[36:39], v[84:87]
    s_add_u32 s66, s51, 32768
    v_mfma_f32_16x16x32_bf16 v[88:91], v[28:31], a[40:43], v[88:91]
    buffer_store_dwordx4 v[208:211], v2, s[4:7], s66 offen offset:0 sc1
    v_mfma_f32_16x16x32_bf16 v[92:95], v[28:31], a[44:47], v[92:95]
    s_waitcnt lgkmcnt(3)
    v_fmac_f32 v100, v136, v129
    v_fmac_f32 v101, v137, v129
    v_mfma_f32_16x16x32_bf16 v[64:67], v[8:11], a[48:51], v[64:67]
    ds_read_b128 v[24:27], v4 offset:10240
    v_fmac_f32 v102, v138, v129
    v_mfma_f32_16x16x32_bf16 v[68:71], v[8:11], a[52:55], v[68:71]
    v_fmac_f32 v103, v139, v129
    v_fmac_f32 v116, v140, v129
    v_mfma_f32_16x16x32_bf16 v[72:75], v[8:11], a[56:59], v[72:75]
    v_fmac_f32 v117, v141, v129
    v_fmac_f32 v118, v142, v129
    v_mfma_f32_16x16x32_bf16 v[76:79], v[8:11], a[60:63], v[76:79]
    s_waitcnt lgkmcnt(3)
    v_fmac_f32 v119, v143, v129
    v_mul_f32 v100, v100, v133
    v_mfma_f32_16x16x32_bf16 v[80:83], v[12:15], a[48:51], v[80:83]
    ds_read_b128 v[28:31], v4 offset:11264
    v_mul_f32 v101, v101, v133
    v_mfma_f32_16x16x32_bf16 v[84:87], v[12:15], a[52:55], v[84:87]
    v_mul_f32 v102, v102, v133
    v_mul_f32 v103, v103, v133
    v_mfma_f32_16x16x32_bf16 v[88:91], v[12:15], a[56:59], v[88:91]
    v_mul_f32 v100, v100, v116
    v_mul_f32 v101, v101, v117
    v_mfma_f32_16x16x32_bf16 v[92:95], v[12:15], a[60:63], v[92:95]
    s_waitcnt lgkmcnt(3)
    v_mul_f32 v102, v102, v118
    v_mul_f32 v103, v103, v119
    v_mfma_f32_16x16x32_bf16 v[64:67], v[16:19], a[64:67], v[64:67]
    ds_read_b128 v[8:11], v4 offset:12288
    v_cvt_pk_bf16_f32 v214, v100, v101
    v_mfma_f32_16x16x32_bf16 v[68:71], v[16:19], a[68:71], v[68:71]
    v_cvt_pk_bf16_f32 v215, v102, v103
    v_mfma_f32_16x16x32_bf16 v[72:75], v[16:19], a[72:75], v[72:75]
    buffer_store_dwordx4 v[212:215], v2, s[4:7], s66 offen offset:1024 sc1
    v_mfma_f32_16x16x32_bf16 v[76:79], v[16:19], a[76:79], v[76:79]
    s_waitcnt lgkmcnt(3)
    v_fmac_f32 v104, v136, v130
    v_fmac_f32 v105, v137, v130
    v_mfma_f32_16x16x32_bf16 v[80:83], v[20:23], a[64:67], v[80:83]
    ds_read_b128 v[12:15], v4 offset:13312
    v_fmac_f32 v106, v138, v130
    v_mfma_f32_16x16x32_bf16 v[84:87], v[20:23], a[68:71], v[84:87]
    v_fmac_f32 v107, v139, v130
    v_fmac_f32 v120, v140, v130
    v_mfma_f32_16x16x32_bf16 v[88:91], v[20:23], a[72:75], v[88:91]
    v_fmac_f32 v121, v141, v130
    v_fmac_f32 v122, v142, v130
    v_mfma_f32_16x16x32_bf16 v[92:95], v[20:23], a[76:79], v[92:95]
    s_waitcnt lgkmcnt(3)
    v_fmac_f32 v123, v143, v130
    v_mul_f32 v104, v104, v134
    v_mfma_f32_16x16x32_bf16 v[64:67], v[24:27], a[80:83], v[64:67]
    ds_read_b128 v[16:19], v4 offset:14336
    v_mul_f32 v105, v105, v134
    v_mfma_f32_16x16x32_bf16 v[68:71], v[24:27], a[84:87], v[68:71]
    v_mul_f32 v106, v106, v134
    v_mul_f32 v107, v107, v134
    v_mfma_f32_16x16x32_bf16 v[72:75], v[24:27], a[88:91], v[72:75]
    v_mul_f32 v104, v104, v120
    v_mul_f32 v105, v105, v121
    v_mfma_f32_16x16x32_bf16 v[76:79], v[24:27], a[92:95], v[76:79]
    s_waitcnt lgkmcnt(3)
    v_mul_f32 v106, v106, v122
    v_mul_f32 v107, v107, v123
    v_mfma_f32_16x16x32_bf16 v[80:83], v[28:31], a[80:83], v[80:83]
    ds_read_b128 v[20:23], v4 offset:15360
    v_cvt_pk_bf16_f32 v218, v104, v105
    v_mfma_f32_16x16x32_bf16 v[84:87], v[28:31], a[84:87], v[84:87]
    v_cvt_pk_bf16_f32 v219, v106, v107
    v_mfma_f32_16x16x32_bf16 v[88:91], v[28:31], a[88:91], v[88:91]
    buffer_store_dwordx4 v[216:219], v2, s[4:7], s66 offen offset:2048 sc1
    v_mfma_f32_16x16x32_bf16 v[92:95], v[28:31], a[92:95], v[92:95]
    s_waitcnt lgkmcnt(3)
    v_fmac_f32 v108, v136, v131
    v_fmac_f32 v109, v137, v131
    v_mfma_f32_16x16x32_bf16 v[64:67], v[8:11], a[96:99], v[64:67]
    ds_read_b128 v[24:27], v4 offset:16384
    v_fmac_f32 v110, v138, v131
    v_mfma_f32_16x16x32_bf16 v[68:71], v[8:11], a[100:103], v[68:71]
    v_fmac_f32 v111, v139, v131
    v_fmac_f32 v124, v140, v131
    v_mfma_f32_16x16x32_bf16 v[72:75], v[8:11], a[104:107], v[72:75]
    v_fmac_f32 v125, v141, v131
    v_fmac_f32 v126, v142, v131
    v_mfma_f32_16x16x32_bf16 v[76:79], v[8:11], a[108:111], v[76:79]
    s_waitcnt lgkmcnt(3)
    v_fmac_f32 v127, v143, v131
    v_mul_f32 v108, v108, v135
    v_mfma_f32_16x16x32_bf16 v[80:83], v[12:15], a[96:99], v[80:83]
    ds_read_b128 v[28:31], v4 offset:17408
    v_mul_f32 v109, v109, v135
    v_mfma_f32_16x16x32_bf16 v[84:87], v[12:15], a[100:103], v[84:87]
    v_mul_f32 v110, v110, v135
    v_mul_f32 v111, v111, v135
    v_mfma_f32_16x16x32_bf16 v[88:91], v[12:15], a[104:107], v[88:91]
    v_mul_f32 v108, v108, v124
    v_mul_f32 v109, v109, v125
    v_mfma_f32_16x16x32_bf16 v[92:95], v[12:15], a[108:111], v[92:95]
    s_waitcnt lgkmcnt(3)
    v_mul_f32 v110, v110, v126
    v_mul_f32 v111, v111, v127
    v_mfma_f32_16x16x32_bf16 v[64:67], v[16:19], a[112:115], v[64:67]
    ds_read_b128 v[8:11], v4 offset:18432
    v_cvt_pk_bf16_f32 v222, v108, v109
    v_mfma_f32_16x16x32_bf16 v[68:71], v[16:19], a[116:119], v[68:71]
    v_cvt_pk_bf16_f32 v223, v110, v111
    v_mfma_f32_16x16x32_bf16 v[72:75], v[16:19], a[120:123], v[72:75]
    buffer_store_dwordx4 v[220:223], v2, s[4:7], s66 offen offset:3072 sc1
    v_mfma_f32_16x16x32_bf16 v[76:79], v[16:19], a[124:127], v[76:79]
    s_waitcnt lgkmcnt(3)
    ds_read_b128 v[136:139], v5 offset:1024
    ds_read_b128 v[140:143], v5 offset:1088
    v_mfma_f32_16x16x32_bf16 v[80:83], v[20:23], a[112:115], v[80:83]
    ds_read_b128 v[12:15], v4 offset:19456
    v_mfma_f32_16x16x32_bf16 v[84:87], v[20:23], a[116:119], v[84:87]
    v_mfma_f32_16x16x32_bf16 v[88:91], v[20:23], a[120:123], v[88:91]
    v_mfma_f32_16x16x32_bf16 v[92:95], v[20:23], a[124:127], v[92:95]
    s_waitcnt lgkmcnt(5)
    v_and_b32 v0, 3, v1
    v_lshlrev_b32 v0, 3, v0
    v_mfma_f32_16x16x32_bf16 v[64:67], v[24:27], a[128:131], v[64:67]
    s_mov_b32 s55, s52
    ds_read_b128 v[16:19], v4 offset:20480
    v_mfma_f32_16x16x32_bf16 v[68:71], v[24:27], a[132:135], v[68:71]
    v_mfma_f32_16x16x32_bf16 v[72:75], v[24:27], a[136:139], v[72:75]
    v_mfma_f32_16x16x32_bf16 v[76:79], v[24:27], a[140:143], v[76:79]
    s_waitcnt lgkmcnt(5)
    v_mfma_f32_16x16x32_bf16 v[80:83], v[28:31], a[128:131], v[80:83]
    ds_read_b128 v[20:23], v4 offset:21504
    v_mfma_f32_16x16x32_bf16 v[84:87], v[28:31], a[132:135], v[84:87]
    v_mfma_f32_16x16x32_bf16 v[88:91], v[28:31], a[136:139], v[88:91]
    v_mfma_f32_16x16x32_bf16 v[92:95], v[28:31], a[140:143], v[92:95]
    s_waitcnt lgkmcnt(5)
    v_mfma_f32_16x16x32_bf16 v[64:67], v[8:11], a[144:147], v[64:67]
    ds_read_b128 v[24:27], v4 offset:22528
    v_mfma_f32_16x16x32_bf16 v[68:71], v[8:11], a[148:151], v[68:71]
    v_mfma_f32_16x16x32_bf16 v[72:75], v[8:11], a[152:155], v[72:75]
    v_mfma_f32_16x16x32_bf16 v[76:79], v[8:11], a[156:159], v[76:79]
    s_waitcnt lgkmcnt(3)
    v_mfma_f32_16x16x32_bf16 v[80:83], v[12:15], a[144:147], v[80:83]
    ds_read_b128 v[28:31], v4 offset:23552
    v_mfma_f32_16x16x32_bf16 v[84:87], v[12:15], a[148:151], v[84:87]
    v_mfma_f32_16x16x32_bf16 v[88:91], v[12:15], a[152:155], v[88:91]
    v_mfma_f32_16x16x32_bf16 v[92:95], v[12:15], a[156:159], v[92:95]
    s_waitcnt lgkmcnt(3)
    v_mfma_f32_16x16x32_bf16 v[64:67], v[16:19], a[160:163], v[64:67]
    ds_read_b128 v[8:11], v4 offset:24576
    v_mfma_f32_16x16x32_bf16 v[68:71], v[16:19], a[164:167], v[68:71]
    v_mfma_f32_16x16x32_bf16 v[72:75], v[16:19], a[168:171], v[72:75]
    v_mfma_f32_16x16x32_bf16 v[76:79], v[16:19], a[172:175], v[76:79]
    s_waitcnt lgkmcnt(3)
    v_mfma_f32_16x16x32_bf16 v[80:83], v[20:23], a[160:163], v[80:83]
    ds_read_b128 v[12:15], v4 offset:25600
    v_mfma_f32_16x16x32_bf16 v[84:87], v[20:23], a[164:167], v[84:87]
    buffer_load_dwordx2 v[6:7], v0, s[4:7], s55 offen sc1
    v_mfma_f32_16x16x32_bf16 v[88:91], v[20:23], a[168:171], v[88:91]
    v_mfma_f32_16x16x32_bf16 v[92:95], v[20:23], a[172:175], v[92:95]
    s_waitcnt lgkmcnt(3)
    v_mfma_f32_16x16x32_bf16 v[64:67], v[24:27], a[176:179], v[64:67]
    ds_read_b128 v[16:19], v4 offset:26624
    v_mfma_f32_16x16x32_bf16 v[68:71], v[24:27], a[180:183], v[68:71]
    v_mfma_f32_16x16x32_bf16 v[72:75], v[24:27], a[184:187], v[72:75]
    v_mfma_f32_16x16x32_bf16 v[76:79], v[24:27], a[188:191], v[76:79]
    s_waitcnt lgkmcnt(3)
    v_mfma_f32_16x16x32_bf16 v[80:83], v[28:31], a[176:179], v[80:83]
    ds_read_b128 v[20:23], v4 offset:27648
    v_mfma_f32_16x16x32_bf16 v[84:87], v[28:31], a[180:183], v[84:87]
    v_mfma_f32_16x16x32_bf16 v[88:91], v[28:31], a[184:187], v[88:91]
    v_mfma_f32_16x16x32_bf16 v[92:95], v[28:31], a[188:191], v[92:95]
    s_waitcnt lgkmcnt(3)
    v_mfma_f32_16x16x32_bf16 v[64:67], v[8:11], a[192:195], v[64:67]
    ds_read_b128 v[24:27], v4 offset:28672
    v_mfma_f32_16x16x32_bf16 v[68:71], v[8:11], a[196:199], v[68:71]
    v_mfma_f32_16x16x32_bf16 v[72:75], v[8:11], a[200:203], v[72:75]
    v_mfma_f32_16x16x32_bf16 v[76:79], v[8:11], a[204:207], v[76:79]
    s_waitcnt lgkmcnt(3)
    v_mfma_f32_16x16x32_bf16 v[80:83], v[12:15], a[192:195], v[80:83]
    ds_read_b128 v[28:31], v4 offset:29696
    v_mfma_f32_16x16x32_bf16 v[84:87], v[12:15], a[196:199], v[84:87]
    v_mfma_f32_16x16x32_bf16 v[88:91], v[12:15], a[200:203], v[88:91]
    v_mfma_f32_16x16x32_bf16 v[92:95], v[12:15], a[204:207], v[92:95]
    s_waitcnt lgkmcnt(3)
    v_mfma_f32_16x16x32_bf16 v[64:67], v[16:19], a[208:211], v[64:67]
    ds_read_b128 v[8:11], v4 offset:30720
    v_mfma_f32_16x16x32_bf16 v[68:71], v[16:19], a[212:215], v[68:71]
    v_mfma_f32_16x16x32_bf16 v[72:75], v[16:19], a[216:219], v[72:75]
    v_mfma_f32_16x16x32_bf16 v[76:79], v[16:19], a[220:223], v[76:79]
    s_waitcnt lgkmcnt(3)
    v_mfma_f32_16x16x32_bf16 v[80:83], v[20:23], a[208:211], v[80:83]
    ds_read_b128 v[12:15], v4 offset:31744
    v_mfma_f32_16x16x32_bf16 v[84:87], v[20:23], a[212:215], v[84:87]
    v_mfma_f32_16x16x32_bf16 v[88:91], v[20:23], a[216:219], v[88:91]
    v_mfma_f32_16x16x32_bf16 v[92:95], v[20:23], a[220:223], v[92:95]
    s_waitcnt lgkmcnt(3)
    v_mfma_f32_16x16x32_bf16 v[64:67], v[24:27], a[224:227], v[64:67]
    ds_read_b128 v[16:19], v4 offset:32768
    v_mfma_f32_16x16x32_bf16 v[68:71], v[24:27], a[228:231], v[68:71]
    v_mfma_f32_16x16x32_bf16 v[72:75], v[24:27], a[232:235], v[72:75]
    v_mfma_f32_16x16x32_bf16 v[76:79], v[24:27], a[236:239], v[76:79]
    s_waitcnt lgkmcnt(3)
    v_mfma_f32_16x16x32_bf16 v[80:83], v[28:31], a[224:227], v[80:83]
    ds_read_b128 v[20:23], v4 offset:33792
    v_mfma_f32_16x16x32_bf16 v[84:87], v[28:31], a[228:231], v[84:87]
    v_mfma_f32_16x16x32_bf16 v[88:91], v[28:31], a[232:235], v[88:91]
    v_mfma_f32_16x16x32_bf16 v[92:95], v[28:31], a[236:239], v[92:95]
    s_waitcnt lgkmcnt(3)
    v_mfma_f32_16x16x32_bf16 v[64:67], v[8:11], a[240:243], v[64:67]
    ds_read_b128 v[24:27], v4 offset:34816
    v_mfma_f32_16x16x32_bf16 v[68:71], v[8:11], a[244:247], v[68:71]
    v_mfma_f32_16x16x32_bf16 v[72:75], v[8:11], a[248:251], v[72:75]
    v_mfma_f32_16x16x32_bf16 v[76:79], v[8:11], a[252:255], v[76:79]
    s_waitcnt lgkmcnt(3)
    v_mfma_f32_16x16x32_bf16 v[80:83], v[12:15], a[240:243], v[80:83]
    s_waitcnt vmcnt(0)
    v_cmp_eq_u64 vcc, s[98:99], v[6:7]
    s_nop 0
    s_cmp_eq_u64 vcc, exec
    s_cbranch_scc0 L_p0_slow_82
L_p0_back_83:
    v_mfma_f32_16x16x32_bf16 v[84:87], v[12:15], a[244:247], v[84:87]
    s_add_u32 s60, s56, s65
    ds_read_b128 v[28:31], v4 offset:35840
    v_mfma_f32_16x16x32_bf16 v[88:91], v[12:15], a[248:251], v[88:91]
    buffer_load_dwordx2 v[242:243], v3, s[4:7], s60 offen offset:0 sc1
    v_mfma_f32_16x16x32_bf16 v[92:95], v[12:15], a[252:255], v[92:95]
    s_waitcnt lgkmcnt(3)
    v_mfma_f32_16x16x32_bf16 v[64:67], v[16:19], v[32:35], v[64:67]
    s_barrier
    v_add_u32 v4, 0xfffe5000, v4
    v_mfma_f32_16x16x32_bf16 v[68:71], v[16:19], v[36:39], v[68:71]
    s_add_u32 m0, s49, 73728
    s_add_u32 s61, s48, 368640
    ds_read_b128 v[8:11], v4 offset:0
    v_mfma_f32_16x16x32_bf16 v[72:75], v[16:19], v[40:43], v[72:75]
    buffer_load_dwordx4 v2, s[4:7], s61 offen offset:0 lds
    v_mfma_f32_16x16x32_bf16 v[76:79], v[16:19], v[44:47], v[76:79]
    s_waitcnt lgkmcnt(3)
    v_mfma_f32_16x16x32_bf16 v[80:83], v[20:23], v[32:35], v[80:83]
    ds_read_b128 v[12:15], v4 offset:1024
    v_mfma_f32_16x16x32_bf16 v[84:87], v[20:23], v[36:39], v[84:87]
    v_mfma_f32_16x16x32_bf16 v[88:91], v[20:23], v[40:43], v[88:91]
    buffer_load_dwordx4 v2, s[4:7], s61 offen offset:1024 lds
    v_mfma_f32_16x16x32_bf16 v[92:95], v[20:23], v[44:47], v[92:95]
    s_waitcnt lgkmcnt(3)
    v_mfma_f32_16x16x32_bf16 v[64:67], v[24:27], v[48:51], v[64:67]
    ds_read_b128 v[16:19], v4 offset:2048
    v_mfma_f32_16x16x32_bf16 v[68:71], v[24:27], v[52:55], v[68:71]
    s_add_u32 s71, s67, 32
    v_mov_b32 v6, s98
    v_mov_b32 v7, s99
    v_mfma_f32_16x16x32_bf16 v[72:75], v[24:27], v[56:59], v[72:75]
    buffer_load_dwordx4 v2, s[4:7], s61 offen offset:2048 lds
    v_mfma_f32_16x16x32_bf16 v[76:79], v[24:27], v[60:63], v[76:79]
    s_waitcnt lgkmcnt(3)
    v_mfma_f32_16x16x32_bf16 v[80:83], v[28:31], v[48:51], v[80:83]
    ds_read_b128 v[20:23], v4 offset:3072
    v_mfma_f32_16x16x32_bf16 v[84:87], v[28:31], v[52:55], v[84:87]
    v_mfma_f32_16x16x32_bf16 v[88:91], v[28:31], v[56:59], v[88:91]
    s_mov_b64 exec, 1
    buffer_store_dwordx2 v[6:7], off, s[4:7], s71 sc1
    s_mov_b64 exec, -1
    v_mfma_f32_16x16x32_bf16 v[92:95], v[28:31], v[60:63], v[92:95]
    s_waitcnt lgkmcnt(3)
    v_mfma_f32_16x16x32_bf16 v[96:99], v[8:11], a[0:3], 0
    ds_read_b128 v[24:27], v4 offset:4096
    v_mfma_f32_16x16x32_bf16 v[100:103], v[8:11], a[4:7], 0
    v_mfma_f32_16x16x32_bf16 v[104:107], v[8:11], a[8:11], 0
    buffer_load_dwordx4 v2, s[4:7], s61 offen offset:3072 lds
    v_mfma_f32_16x16x32_bf16 v[108:111], v[8:11], a[12:15], 0
    s_waitcnt lgkmcnt(3)
    s_add_u32 m0, s49, 77824
    s_add_u32 s61, s48, 372736
    v_mfma_f32_16x16x32_bf16 v[112:115], v[12:15], a[0:3], 0
    ds_read_b128 v[28:31], v4 offset:5120
    v_mfma_f32_16x16x32_bf16 v[116:119], v[12:15], a[4:7], 0
    v_fmac_f32 v64, v144, v128
    v_fmac_f32 v65, v145, v128
    v_mfma_f32_16x16x32_bf16 v[120:123], v[12:15], a[8:11], 0
    buffer_load_dwordx4 v2, s[4:7], s61 offen offset:0 lds
    v_mfma_f32_16x16x32_bf16 v[124:127], v[12:15], a[12:15], 0
    s_waitcnt lgkmcnt(3)
    v_fmac_f32 v66, v146, v128
    v_fmac_f32 v67, v147, v128
    v_mfma_f32_16x16x32_bf16 v[96:99], v[16:19], a[16:19], v[96:99]
    ds_read_b128 v[8:11], v4 offset:6144
    v_fmac_f32 v80, v148, v128
    v_mfma_f32_16x16x32_bf16 v[100:103], v[16:19], a[20:23], v[100:103]
    v_fmac_f32 v81, v149, v128
    v_fmac_f32 v82, v150, v128
    v_mfma_f32_16x16x32_bf16 v[104:107], v[16:19], a[24:27], v[104:107]
    buffer_load_dwordx4 v2, s[4:7], s61 offen offset:1024 lds
    v_mfma_f32_16x16x32_bf16 v[108:111], v[16:19], a[28:31], v[108:111]
    s_waitcnt lgkmcnt(3)
    v_fmac_f32 v83, v151, v128
    v_mul_f32 v64, v64, v132
    v_mfma_f32_16x16x32_bf16 v[112:115], v[20:23], a[16:19], v[112:115]
    ds_read_b128 v[12:15], v4 offset:7168
    v_mul_f32 v65, v65, v132
    v_mfma_f32_16x16x32_bf16 v[116:119], v[20:23], a[20:23], v[116:119]
    v_mul_f32 v66, v66, v132
    v_mul_f32 v67, v67, v132
    v_mfma_f32_16x16x32_bf16 v[120:123], v[20:23], a[24:27], v[120:123]
    buffer_load_dwordx4 v2, s[4:7], s61 offen offset:2048 lds
    v_mfma_f32_16x16x32_bf16 v[124:127], v[20:23], a[28:31], v[124:127]
    s_waitcnt lgkmcnt(3)
    v_mul_f32 v64, v64, v80
    v_mul_f32 v65, v65, v81
    v_mfma_f32_16x16x32_bf16 v[96:99], v[24:27], a[32:35], v[96:99]
    ds_read_b128 v[16:19], v4 offset:8192
    v_mul_f32 v66, v66, v82
    v_mfma_f32_16x16x32_bf16 v[100:103], v[24:27], a[36:39], v[100:103]
    v_mul_f32 v67, v67, v83
    v_cvt_pk_bf16_f32 v224, v64, v65
    v_mfma_f32_16x16x32_bf16 v[104:107], v[24:27], a[40:43], v[104:107]
    buffer_load_dwordx4 v2, s[4:7], s61 offen offset:3072 lds
    v_mfma_f32_16x16x32_bf16 v[108:111], v[24:27], a[44:47], v[108:111]
    s_waitcnt lgkmcnt(3)
    s_add_u32 m0, s49, 81920
    s_add_u32 s61, s48, 376832
    v_mfma_f32_16x16x32_bf16 v[112:115], v[28:31], a[32:35], v[112:115]
    ds_read_b128 v[20:23], v4 offset:9216
    v_cvt_pk_bf16_f32 v225, v66, v67
    v_mfma_f32_16x16x32_bf16 v[116:119], v[28:31], a[36:39], v[116:119]
    v_fmac_f32 v68, v144, v129
    v_fmac_f32 v69, v145, v129
    v_mfma_f32_16x16x32_bf16 v[120:123], v[28:31], a[40:43], v[120:123]
    buffer_load_dwordx4 v2, s[4:7], s61 offen offset:0 lds
    v_mfma_f32_16x16x32_bf16 v[124:127], v[28:31], a[44:47], v[124:127]
    s_waitcnt lgkmcnt(3)
    v_fmac_f32 v70, v146, v129
    v_fmac_f32 v71, v147, v129
    v_mfma_f32_16x16x32_bf16 v[96:99], v[8:11], a[48:51], v[96:99]
    ds_read_b128 v[24:27], v4 offset:10240
    v_fmac_f32 v84, v148, v129
    v_mfma_f32_16x16x32_bf16 v[100:103], v[8:11], a[52:55], v[100:103]
    v_fmac_f32 v85, v149, v129
    v_fmac_f32 v86, v150, v129
    v_mfma_f32_16x16x32_bf16 v[104:107], v[8:11], a[56:59], v[104:107]
    buffer_load_dwordx2 v[246:247], v3, s[4:7], s60 offen offset:512 sc1
    v_mfma_f32_16x16x32_bf16 v[108:111], v[8:11], a[60:63], v[108:111]
    s_waitcnt lgkmcnt(3)
    v_fmac_f32 v87, v151, v129
    v_mul_f32 v68, v68, v133
    v_mfma_f32_16x16x32_bf16 v[112:115], v[12:15], a[48:51], v[112:115]
    ds_read_b128 v[28:31], v4 offset:11264
    v_mul_f32 v69, v69, v133
    v_mfma_f32_16x16x32_bf16 v[116:119], v[12:15], a[52:55], v[116:119]
    v_mul_f32 v70, v70, v133
    v_mul_f32 v71, v71, v133
    v_mfma_f32_16x16x32_bf16 v[120:123], v[12:15], a[56:59], v[120:123]
    buffer_load_dwordx2 v[250:251], v3, s[4:7], s60 offen offset:1024 sc1
    v_mfma_f32_16x16x32_bf16 v[124:127], v[12:15], a[60:63], v[124:127]
    s_waitcnt lgkmcnt(3)
    v_mul_f32 v68, v68, v84
    v_mul_f32 v69, v69, v85
    v_mfma_f32_16x16x32_bf16 v[96:99], v[16:19], a[64:67], v[96:99]
    ds_read_b128 v[8:11], v4 offset:12288
    v_mul_f32 v70, v70, v86
    v_mfma_f32_16x16x32_bf16 v[100:103], v[16:19], a[68:71], v[100:103]
    v_mul_f32 v71, v71, v87
    v_cvt_pk_bf16_f32 v228, v68, v69
    v_mfma_f32_16x16x32_bf16 v[104:107], v[16:19], a[72:75], v[104:107]
    buffer_load_dwordx2 v[254:255], v3, s[4:7], s60 offen offset:1536 sc1
    v_mfma_f32_16x16x32_bf16 v[108:111], v[16:19], a[76:79], v[108:111]
    s_waitcnt lgkmcnt(3)
    s_add_u32 s60, s57, s65
    v_cvt_pk_bf16_f32 v229, v70, v71
    v_mfma_f32_16x16x32_bf16 v[112:115], v[20:23], a[64:67], v[112:115]
    ds_read_b128 v[12:15], v4 offset:13312
    v_fmac_f32 v72, v144, v130
    v_mfma_f32_16x16x32_bf16 v[116:119], v[20:23], a[68:71], v[116:119]
    v_fmac_f32 v73, v145, v130
    v_fmac_f32 v74, v146, v130
    v_mfma_f32_16x16x32_bf16 v[120:123], v[20:23], a[72:75], v[120:123]
    buffer_load_dwordx2 a[0:1], v3, s[4:7], s60 offen offset:0 sc1
    v_mfma_f32_16x16x32_bf16 v[124:127], v[20:23], a[76:79], v[124:127]
    s_waitcnt lgkmcnt(3)
    v_fmac_f32 v75, v147, v130
    v_fmac_f32 v88, v148, v130
    v_mfma_f32_16x16x32_bf16 v[96:99], v[24:27], a[80:83], v[96:99]
    ds_read_b128 v[16:19], v4 offset:14336
    v_fmac_f32 v89, v149, v130
    v_mfma_f32_16x16x32_bf16 v[100:103], v[24:27], a[84:87], v[100:103]
    v_fmac_f32 v90, v150, v130
    v_fmac_f32 v91, v151, v130
    v_mfma_f32_16x16x32_bf16 v[104:107], v[24:27], a[88:91], v[104:107]
    buffer_load_dwordx2 a[4:5], v3, s[4:7], s60 offen offset:512 sc1
    v_mfma_f32_16x16x32_bf16 v[108:111], v[24:27], a[92:95], v[108:111]
    s_waitcnt lgkmcnt(3)
    v_mul_f32 v72, v72, v134
    v_mul_f32 v73, v73, v134
    v_mfma_f32_16x16x32_bf16 v[112:115], v[28:31], a[80:83], v[112:115]
    ds_read_b128 v[20:23], v4 offset:15360
    v_mul_f32 v74, v74, v134
    v_mfma_f32_16x16x32_bf16 v[116:119], v[28:31], a[84:87], v[116:119]
    v_mul_f32 v75, v75, v134
    v_mul_f32 v72, v72, v88
    v_mfma_f32_16x16x32_bf16 v[120:123], v[28:31], a[88:91], v[120:123]
    buffer_load_dwordx2 a[8:9], v3, s[4:7], s60 offen offset:1024 sc1
    v_mfma_f32_16x16x32_bf16 v[124:127], v[28:31], a[92:95], v[124:127]
    s_waitcnt lgkmcnt(3)
    v_mul_f32 v73, v73, v89
    v_mul_f32 v74, v74, v90
    v_mfma_f32_16x16x32_bf16 v[96:99], v[8:11], a[96:99], v[96:99]
    ds_read_b128 v[24:27], v4 offset:16384
    v_mul_f32 v75, v75, v91
    v_mfma_f32_16x16x32_bf16 v[100:103], v[8:11], a[100:103], v[100:103]
    v_cvt_pk_bf16_f32 v232, v72, v73
    v_cvt_pk_bf16_f32 v233, v74, v75
    v_mfma_f32_16x16x32_bf16 v[104:107], v[8:11], a[104:107], v[104:107]
    buffer_load_dwordx2 a[12:13], v3, s[4:7], s60 offen offset:1536 sc1
    v_mfma_f32_16x16x32_bf16 v[108:111], v[8:11], a[108:111], v[108:111]
    s_waitcnt lgkmcnt(3)
    s_add_u32 s60, s58, s65
    v_fmac_f32 v76, v144, v131
    v_mfma_f32_16x16x32_bf16 v[112:115], v[12:15], a[96:99], v[112:115]
    ds_read_b128 v[28:31], v4 offset:17408
    v_fmac_f32 v77, v145, v131
    v_mfma_f32_16x16x32_bf16 v[116:119], v[12:15], a[100:103], v[116:119]
    v_fmac_f32 v78, v146, v131
    v_fmac_f32 v79, v147, v131
    v_mfma_f32_16x16x32_bf16 v[120:123], v[12:15], a[104:107], v[120:123]
    buffer_load_dwordx2 a[2:3], v3, s[4:7], s60 offen offset:0 sc1
    v_mfma_f32_16x16x32_bf16 v[124:127], v[12:15], a[108:111], v[124:127]
    s_waitcnt lgkmcnt(3)
    v_fmac_f32 v92, v148, v131
    v_fmac_f32 v93, v149, v131
    v_mfma_f32_16x16x32_bf16 v[96:99], v[16:19], a[112:115], v[96:99]
    ds_read_b128 v[8:11], v4 offset:18432
    v_fmac_f32 v94, v150, v131
    v_mfma_f32_16x16x32_bf16 v[100:103], v[16:19], a[116:119], v[100:103]
    v_fmac_f32 v95, v151, v131
    v_mul_f32 v76, v76, v135
    v_mfma_f32_16x16x32_bf16 v[104:107], v[16:19], a[120:123], v[104:107]
    buffer_load_dwordx2 a[6:7], v3, s[4:7], s60 offen offset:512 sc1
    v_mfma_f32_16x16x32_bf16 v[108:111], v[16:19], a[124:127], v[108:111]
    s_waitcnt lgkmcnt(3)
    v_mul_f32 v77, v77, v135
    v_mul_f32 v78, v78, v135
    v_mfma_f32_16x16x32_bf16 v[112:115], v[20:23], a[112:115], v[112:115]
    ds_read_b128 v[12:15], v4 offset:19456
    v_mul_f32 v79, v79, v135
    v_mfma_f32_16x16x32_bf16 v[116:119], v[20:23], a[116:119], v[116:119]
    v_mul_f32 v76, v76, v92
    v_mul_f32 v77, v77, v93
    v_mfma_f32_16x16x32_bf16 v[120:123], v[20:23], a[120:123], v[120:123]
    buffer_load_dwordx2 a[10:11], v3, s[4:7], s60 offen offset:1024 sc1
    v_mfma_f32_16x16x32_bf16 v[124:127], v[20:23], a[124:127], v[124:127]
    s_waitcnt lgkmcnt(3)
    v_mul_f32 v78, v78, v94
    v_mul_f32 v79, v79, v95
    v_mfma_f32_16x16x32_bf16 v[96:99], v[24:27], a[128:131], v[96:99]
    ds_read_b128 v[16:19], v4 offset:20480
    v_cvt_pk_bf16_f32 v236, v76, v77
    v_mfma_f32_16x16x32_bf16 v[100:103], v[24:27], a[132:135], v[100:103]
    v_cvt_pk_bf16_f32 v237, v78, v79
    v_mfma_f32_16x16x32_bf16 v[104:107], v[24:27], a[136:139], v[104:107]
    buffer_load_dwordx2 a[14:15], v3, s[4:7], s60 offen offset:1536 sc1
    v_mfma_f32_16x16x32_bf16 v[108:111], v[24:27], a[140:143], v[108:111]
    s_waitcnt lgkmcnt(3)
    s_add_u32 s60, s56, 0
    v_mfma_f32_16x16x32_bf16 v[112:115], v[28:31], a[128:131], v[112:115]
    ds_read_b128 v[20:23], v4 offset:21504
    v_mfma_f32_16x16x32_bf16 v[116:119], v[28:31], a[132:135], v[116:119]
    v_mfma_f32_16x16x32_bf16 v[120:123], v[28:31], a[136:139], v[120:123]
    buffer_load_dwordx4 a[16:19], v2, s[4:7], s60 offen offset:0 sc1
    v_mfma_f32_16x16x32_bf16 v[124:127], v[28:31], a[140:143], v[124:127]
    s_waitcnt lgkmcnt(3)
    v_mfma_f32_16x16x32_bf16 v[96:99], v[8:11], a[144:147], v[96:99]
    ds_read_b128 v[24:27], v4 offset:22528
    v_mfma_f32_16x16x32_bf16 v[100:103], v[8:11], a[148:151], v[100:103]
    v_mfma_f32_16x16x32_bf16 v[104:107], v[8:11], a[152:155], v[104:107]
    buffer_load_dwordx4 a[20:23], v2, s[4:7], s60 offen offset:1024 sc1
    v_mfma_f32_16x16x32_bf16 v[108:111], v[8:11], a[156:159], v[108:111]
    s_waitcnt lgkmcnt(3)
    v_mfma_f32_16x16x32_bf16 v[112:115], v[12:15], a[144:147], v[112:115]
    ds_read_b128 v[28:31], v4 offset:23552
    v_mfma_f32_16x16x32_bf16 v[116:119], v[12:15], a[148:151], v[116:119]
    v_mfma_f32_16x16x32_bf16 v[120:123], v[12:15], a[152:155], v[120:123]
    buffer_load_dwordx4 a[24:27], v2, s[4:7], s60 offen offset:2048 sc1
    v_mfma_f32_16x16x32_bf16 v[124:127], v[12:15], a[156:159], v[124:127]
    s_waitcnt lgkmcnt(3)
    v_mfma_f32_16x16x32_bf16 v[96:99], v[16:19], a[160:163], v[96:99]
    ds_read_b128 v[8:11], v4 offset:24576
    v_mfma_f32_16x16x32_bf16 v[100:103], v[16:19], a[164:167], v[100:103]
    v_mfma_f32_16x16x32_bf16 v[104:107], v[16:19], a[168:171], v[104:107]
    buffer_load_dwordx4 a[28:31], v2, s[4:7], s60 offen offset:3072 sc1
    v_mfma_f32_16x16x32_bf16 v[108:111], v[16:19], a[172:175], v[108:111]
    s_waitcnt lgkmcnt(3)
    s_add_u32 s60, s57, 0
    v_mfma_f32_16x16x32_bf16 v[112:115], v[20:23], a[160:163], v[112:115]
    ds_read_b128 v[12:15], v4 offset:25600
    v_mfma_f32_16x16x32_bf16 v[116:119], v[20:23], a[164:167], v[116:119]
    v_mfma_f32_16x16x32_bf16 v[120:123], v[20:23], a[168:171], v[120:123]
    buffer_load_dwordx4 a[32:35], v2, s[4:7], s60 offen offset:0 sc1
    v_mfma_f32_16x16x32_bf16 v[124:127], v[20:23], a[172:175], v[124:127]
    s_waitcnt lgkmcnt(3)
    v_mfma_f32_16x16x32_bf16 v[96:99], v[24:27], a[176:179], v[96:99]
    ds_read_b128 v[16:19], v4 offset:26624
    v_mfma_f32_16x16x32_bf16 v[100:103], v[24:27], a[180:183], v[100:103]
    v_mfma_f32_16x16x32_bf16 v[104:107], v[24:27], a[184:187], v[104:107]
    buffer_load_dwordx4 a[36:39], v2, s[4:7], s60 offen offset:1024 sc1
    v_mfma_f32_16x16x32_bf16 v[108:111], v[24:27], a[188:191], v[108:111]
    s_waitcnt lgkmcnt(3)
    v_mfma_f32_16x16x32_bf16 v[112:115], v[28:31], a[176:179], v[112:115]
    ds_read_b128 v[20:23], v4 offset:27648
    v_mfma_f32_16x16x32_bf16 v[116:119], v[28:31], a[180:183], v[116:119]
    v_mfma_f32_16x16x32_bf16 v[120:123], v[28:31], a[184:187], v[120:123]
    buffer_load_dwordx4 a[40:43], v2, s[4:7], s60 offen offset:2048 sc1
    v_mfma_f32_16x16x32_bf16 v[124:127], v[28:31], a[188:191], v[124:127]
    s_waitcnt lgkmcnt(3)
    v_mfma_f32_16x16x32_bf16 v[96:99], v[8:11], a[192:195], v[96:99]
    ds_read_b128 v[24:27], v4 offset:28672
    v_mfma_f32_16x16x32_bf16 v[100:103], v[8:11], a[196:199], v[100:103]
    v_mfma_f32_16x16x32_bf16 v[104:107], v[8:11], a[200:203], v[104:107]
    buffer_load_dwordx4 a[44:47], v2, s[4:7], s60 offen offset:3072 sc1
    v_mfma_f32_16x16x32_bf16 v[108:111], v[8:11], a[204:207], v[108:111]
    s_waitcnt lgkmcnt(3)
    s_add_u32 s60, s58, 0
    v_mfma_f32_16x16x32_bf16 v[112:115], v[12:15], a[192:195], v[112:115]
    ds_read_b128 v[28:31], v4 offset:29696
    v_mfma_f32_16x16x32_bf16 v[116:119], v[12:15], a[196:199], v[116:119]
    v_mfma_f32_16x16x32_bf16 v[120:123], v[12:15], a[200:203], v[120:123]
    buffer_load_dwordx4 a[48:51], v2, s[4:7], s60 offen offset:0 sc1
    v_mfma_f32_16x16x32_bf16 v[124:127], v[12:15], a[204:207], v[124:127]
    s_waitcnt lgkmcnt(3)
    v_mfma_f32_16x16x32_bf16 v[96:99], v[16:19], a[208:211], v[96:99]
    ds_read_b128 v[8:11], v4 offset:30720
    v_mfma_f32_16x16x32_bf16 v[100:103], v[16:19], a[212:215], v[100:103]
    v_mfma_f32_16x16x32_bf16 v[104:107], v[16:19], a[216:219], v[104:107]
    buffer_load_dwordx4 a[52:55], v2, s[4:7], s60 offen offset:1024 sc1
    v_mfma_f32_16x16x32_bf16 v[108:111], v[16:19], a[220:223], v[108:111]
    s_waitcnt lgkmcnt(3)
    v_mfma_f32_16x16x32_bf16 v[112:115], v[20:23], a[208:211], v[112:115]
    ds_read_b128 v[12:15], v4 offset:31744
    v_mfma_f32_16x16x32_bf16 v[116:119], v[20:23], a[212:215], v[116:119]
    v_mfma_f32_16x16x32_bf16 v[120:123], v[20:23], a[216:219], v[120:123]
    buffer_load_dwordx4 a[56:59], v2, s[4:7], s60 offen offset:2048 sc1
    v_mfma_f32_16x16x32_bf16 v[124:127], v[20:23], a[220:223], v[124:127]
    s_waitcnt lgkmcnt(3)
    v_mfma_f32_16x16x32_bf16 v[96:99], v[24:27], a[224:227], v[96:99]
    ds_read_b128 v[16:19], v4 offset:32768
    v_mfma_f32_16x16x32_bf16 v[100:103], v[24:27], a[228:231], v[100:103]
    v_mfma_f32_16x16x32_bf16 v[104:107], v[24:27], a[232:235], v[104:107]
    buffer_load_dwordx4 a[60:63], v2, s[4:7], s60 offen offset:3072 sc1
    v_mfma_f32_16x16x32_bf16 v[108:111], v[24:27], a[236:239], v[108:111]
    s_waitcnt lgkmcnt(3)
    s_add_u32 s60, s56, 16384
    v_mfma_f32_16x16x32_bf16 v[112:115], v[28:31], a[224:227], v[112:115]
    ds_read_b128 v[20:23], v4 offset:33792
    v_mfma_f32_16x16x32_bf16 v[116:119], v[28:31], a[228:231], v[116:119]
    v_mfma_f32_16x16x32_bf16 v[120:123], v[28:31], a[232:235], v[120:123]
    buffer_load_dwordx4 a[64:67], v2, s[4:7], s60 offen offset:0 sc1
    v_mfma_f32_16x16x32_bf16 v[124:127], v[28:31], a[236:239], v[124:127]
    s_waitcnt lgkmcnt(3)
    v_mfma_f32_16x16x32_bf16 v[96:99], v[8:11], a[240:243], v[96:99]
    ds_read_b128 v[24:27], v4 offset:34816
    v_mfma_f32_16x16x32_bf16 v[100:103], v[8:11], a[244:247], v[100:103]
    v_mfma_f32_16x16x32_bf16 v[104:107], v[8:11], a[248:251], v[104:107]
    buffer_load_dwordx4 a[68:71], v2, s[4:7], s60 offen offset:1024 sc1
    v_mfma_f32_16x16x32_bf16 v[108:111], v[8:11], a[252:255], v[108:111]
    s_waitcnt lgkmcnt(3)
    v_mfma_f32_16x16x32_bf16 v[112:115], v[12:15], a[240:243], v[112:115]
    ds_read_b128 v[28:31], v4 offset:35840
    v_mfma_f32_16x16x32_bf16 v[116:119], v[12:15], a[244:247], v[116:119]
    v_mfma_f32_16x16x32_bf16 v[120:123], v[12:15], a[248:251], v[120:123]
    buffer_load_dwordx4 a[72:75], v2, s[4:7], s60 offen offset:2048 sc1
    v_mfma_f32_16x16x32_bf16 v[124:127], v[12:15], a[252:255], v[124:127]
    s_waitcnt lgkmcnt(3)
    v_mfma_f32_16x16x32_bf16 v[96:99], v[16:19], v[32:35], v[96:99]
    s_barrier
    v_add_u32 v4, 0x9000, v4
    v_mfma_f32_16x16x32_bf16 v[100:103], v[16:19], v[36:39], v[100:103]
    s_add_u32 m0, s49, 110592
    s_add_u32 s61, s48, 405504
    ds_read_b128 v[8:11], v4 offset:0
    v_mfma_f32_16x16x32_bf16 v[104:107], v[16:19], v[40:43], v[104:107]
    buffer_load_dwordx4 a[76:79], v2, s[4:7], s60 offen offset:3072 sc1
    v_mfma_f32_16x16x32_bf16 v[108:111], v[16:19], v[44:47], v[108:111]
    s_waitcnt lgkmcnt(3)
    s_add_u32 s60, s57, 16384
    v_mfma_f32_16x16x32_bf16 v[112:115], v[20:23], v[32:35], v[112:115]
    ds_read_b128 v[12:15], v4 offset:1024
    v_mfma_f32_16x16x32_bf16 v[116:119], v[20:23], v[36:39], v[116:119]
    v_mfma_f32_16x16x32_bf16 v[120:123], v[20:23], v[40:43], v[120:123]
    buffer_load_dwordx4 a[80:83], v2, s[4:7], s60 offen offset:0 sc1
    v_mfma_f32_16x16x32_bf16 v[124:127], v[20:23], v[44:47], v[124:127]
    s_waitcnt lgkmcnt(3)
    v_mfma_f32_16x16x32_bf16 v[96:99], v[24:27], v[48:51], v[96:99]
    ds_read_b128 v[16:19], v4 offset:2048
    v_mfma_f32_16x16x32_bf16 v[100:103], v[24:27], v[52:55], v[100:103]
    v_mfma_f32_16x16x32_bf16 v[104:107], v[24:27], v[56:59], v[104:107]
    buffer_load_dwordx4 a[84:87], v2, s[4:7], s60 offen offset:1024 sc1
    v_mfma_f32_16x16x32_bf16 v[108:111], v[24:27], v[60:63], v[108:111]
    s_waitcnt lgkmcnt(3)
    v_mfma_f32_16x16x32_bf16 v[112:115], v[28:31], v[48:51], v[112:115]
    ds_read_b128 v[20:23], v4 offset:3072
    v_mfma_f32_16x16x32_bf16 v[116:119], v[28:31], v[52:55], v[116:119]
    v_mfma_f32_16x16x32_bf16 v[120:123], v[28:31], v[56:59], v[120:123]
    buffer_load_dwordx4 a[88:91], v2, s[4:7], s60 offen offset:2048 sc1
    v_mfma_f32_16x16x32_bf16 v[124:127], v[28:31], v[60:63], v[124:127]
    s_waitcnt lgkmcnt(3)
    v_mfma_f32_16x16x32_bf16 v[32:35], v[8:11], v[176:179], 0
    ds_read_b128 v[24:27], v4 offset:4096
    v_mfma_f32_16x16x32_bf16 v[40:43], v[8:11], v[180:183], 0
    v_mfma_f32_16x16x32_bf16 v[48:51], v[8:11], v[184:187], 0
    buffer_load_dwordx4 a[92:95], v2, s[4:7], s60 offen offset:3072 sc1
    v_mfma_f32_16x16x32_bf16 v[56:59], v[8:11], v[188:191], 0
    s_waitcnt lgkmcnt(3)
    s_add_u32 s60, s58, 16384
    v_mfma_f32_16x16x32_bf16 v[36:39], v[12:15], v[176:179], 0
    ds_read_b128 v[28:31], v4 offset:5120
    v_mfma_f32_16x16x32_bf16 v[44:47], v[12:15], v[180:183], 0
    v_fmac_f32 v96, v136, v128
    v_fmac_f32 v97, v137, v128
    v_mfma_f32_16x16x32_bf16 v[52:55], v[12:15], v[184:187], 0
    v_fmac_f32 v98, v138, v128
    v_fmac_f32 v99, v139, v128
    v_mfma_f32_16x16x32_bf16 v[60:63], v[12:15], v[188:191], 0
    s_waitcnt lgkmcnt(3)
    v_fmac_f32 v112, v140, v128
    v_fmac_f32 v113, v141, v128
    v_mfma_f32_16x16x32_bf16 v[64:67], v[16:19], v[176:179], 0
    ds_read_b128 v[8:11], v4 offset:6144
    v_fmac_f32 v114, v142, v128
    v_mfma_f32_16x16x32_bf16 v[72:75], v[16:19], v[180:183], 0
    v_fmac_f32 v115, v143, v128
    v_mul_f32 v96, v96, v132
    v_mfma_f32_16x16x32_bf16 v[80:83], v[16:19], v[184:187], 0
    v_mul_f32 v97, v97, v132
    v_mul_f32 v98, v98, v132
    v_mfma_f32_16x16x32_bf16 v[88:91], v[16:19], v[188:191], 0
    s_waitcnt lgkmcnt(3)
    v_mul_f32 v99, v99, v132
    v_mul_f32 v96, v96, v112
    v_mfma_f32_16x16x32_bf16 v[68:71], v[20:23], v[176:179], 0
    ds_read_b128 v[12:15], v4 offset:7168
    v_mul_f32 v97, v97, v113
    v_mfma_f32_16x16x32_bf16 v[76:79], v[20:23], v[180:183], 0
    v_mul_f32 v98, v98, v114
    v_mul_f32 v99, v99, v115
    v_mfma_f32_16x16x32_bf16 v[84:87], v[20:23], v[184:187], 0
    v_cvt_pk_bf16_f32 v226, v96, v97
    v_cvt_pk_bf16_f32 v227, v98, v99
    v_mfma_f32_16x16x32_bf16 v[92:95], v[20:23], v[188:191], 0
    s_waitcnt lgkmcnt(3)
    s_add_u32 s66, s51, 49152
    v_mfma_f32_16x16x32_bf16 v[160:163], v[24:27], v[176:179], 0
    ds_read_b128 v[16:19], v4 offset:8192
    v_mfma_f32_16x16x32_bf16 v[164:167], v[24:27], v[180:183], 0
    buffer_store_dwordx4 v[224:227], v2, s[4:7], s66 offen offset:0 sc1
    v_mfma_f32_16x16x32_bf16 v[168:171], v[24:27], v[184:187], 0
    v_fmac_f32 v100, v136, v129
    v_fmac_f32 v101, v137, v129
    v_mfma_f32_16x16x32_bf16 v[172:175], v[24:27], v[188:191], 0
    s_waitcnt lgkmcnt(3)
    v_fmac_f32 v102, v138, v129
    v_fmac_f32 v103, v139, v129
    v_mfma_f32_16x16x32_bf16 v[32:35], v[28:31], v[192:195], v[32:35]
    ds_read_b128 v[20:23], v4 offset:9216
    v_fmac_f32 v116, v140, v129
    v_mfma_f32_16x16x32_bf16 v[40:43], v[28:31], v[196:199], v[40:43]
    v_fmac_f32 v117, v141, v129
    v_fmac_f32 v118, v142, v129
    v_mfma_f32_16x16x32_bf16 v[48:51], v[28:31], v[200:203], v[48:51]
    v_fmac_f32 v119, v143, v129
    v_mul_f32 v100, v100, v133
    v_mfma_f32_16x16x32_bf16 v[56:59], v[28:31], v[204:207], v[56:59]
    s_waitcnt lgkmcnt(3)
    v_mul_f32 v101, v101, v133
    v_mul_f32 v102, v102, v133
    v_mfma_f32_16x16x32_bf16 v[36:39], v[8:11], v[192:195], v[36:39]
    ds_read_b128 v[24:27], v4 offset:10240
    v_mul_f32 v103, v103, v133
    v_mfma_f32_16x16x32_bf16 v[44:47], v[8:11], v[196:199], v[44:47]
    v_mul_f32 v100, v100, v116
    v_mul_f32 v101, v101, v117
    v_mfma_f32_16x16x32_bf16 v[52:55], v[8:11], v[200:203], v[52:55]
    v_mul_f32 v102, v102, v118
    v_mul_f32 v103, v103, v119
    v_mfma_f32_16x16x32_bf16 v[60:63], v[8:11], v[204:207], v[60:63]
    s_waitcnt lgkmcnt(3)
    v_cvt_pk_bf16_f32 v230, v100, v101
    v_cvt_pk_bf16_f32 v231, v102, v103
    v_mfma_f32_16x16x32_bf16 v[64:67], v[12:15], v[192:195], v[64:67]
    ds_read_b128 v[28:31], v4 offset:11264
    v_mfma_f32_16x16x32_bf16 v[72:75], v[12:15], v[196:199], v[72:75]
    buffer_store_dwordx4 v[228:231], v2, s[4:7], s66 offen offset:1024 sc1
    v_mfma_f32_16x16x32_bf16 v[80:83], v[12:15], v[200:203], v[80:83]
    v_fmac_f32 v104, v136, v130
    v_fmac_f32 v105, v137, v130
    v_mfma_f32_16x16x32_bf16 v[88:91], v[12:15], v[204:207], v[88:91]
    s_waitcnt lgkmcnt(3)
    v_fmac_f32 v106, v138, v130
    v_fmac_f32 v107, v139, v130
    v_mfma_f32_16x16x32_bf16 v[68:71], v[16:19], v[192:195], v[68:71]
    ds_read_b128 v[8:11], v4 offset:12288
    v_fmac_f32 v120, v140, v130
    v_mfma_f32_16x16x32_bf16 v[76:79], v[16:19], v[196:199], v[76:79]
    v_fmac_f32 v121, v141, v130
    v_fmac_f32 v122, v142, v130
    v_mfma_f32_16x16x32_bf16 v[84:87], v[16:19], v[200:203], v[84:87]
    v_fmac_f32 v123, v143, v130
    v_mul_f32 v104, v104, v134
    v_mfma_f32_16x16x32_bf16 v[92:95], v[16:19], v[204:207], v[92:95]
    s_waitcnt lgkmcnt(3)
    v_mul_f32 v105, v105, v134
    v_mul_f32 v106, v106, v134
    v_mfma_f32_16x16x32_bf16 v[160:163], v[20:23], v[192:195], v[160:163]
    ds_read_b128 v[12:15], v4 offset:13312
    v_mul_f32 v107, v107, v134
    v_mfma_f32_16x16x32_bf16 v[164:167], v[20:23], v[196:199], v[164:167]
    v_mul_f32 v104, v104, v120
    v_mul_f32 v105, v105, v121
    v_mfma_f32_16x16x32_bf16 v[168:171], v[20:23], v[200:203], v[168:171]
    v_mul_f32 v106, v106, v122
    v_mul_f32 v107, v107, v123
    v_mfma_f32_16x16x32_bf16 v[172:175], v[20:23], v[204:207], v[172:175]
    s_waitcnt lgkmcnt(3)
    v_cvt_pk_bf16_f32 v234, v104, v105
    v_cvt_pk_bf16_f32 v235, v106, v107
    v_mfma_f32_16x16x32_bf16 v[32:35], v[24:27], v[208:211], v[32:35]
    ds_read_b128 v[16:19], v4 offset:14336
    v_mfma_f32_16x16x32_bf16 v[40:43], v[24:27], v[212:215], v[40:43]
    buffer_store_dwordx4 v[232:235], v2, s[4:7], s66 offen offset:2048 sc1
    v_mfma_f32_16x16x32_bf16 v[48:51], v[24:27], v[216:219], v[48:51]
    v_fmac_f32 v108, v136, v131
    v_fmac_f32 v109, v137, v131
    v_mfma_f32_16x16x32_bf16 v[56:59], v[24:27], v[220:223], v[56:59]
    s_waitcnt lgkmcnt(3)
    v_fmac_f32 v110, v138, v131
    v_fmac_f32 v111, v139, v131
    v_mfma_f32_16x16x32_bf16 v[36:39], v[28:31], v[208:211], v[36:39]
    ds_read_b128 v[20:23], v4 offset:15360
    v_fmac_f32 v124, v140, v131
    v_mfma_f32_16x16x32_bf16 v[44:47], v[28:31], v[212:215], v[44:47]
    v_fmac_f32 v125, v141, v131
    v_fmac_f32 v126, v142, v131
    v_mfma_f32_16x16x32_bf16 v[52:55], v[28:31], v[216:219], v[52:55]
    v_fmac_f32 v127, v143, v131
    v_mul_f32 v108, v108, v135
    v_mfma_f32_16x16x32_bf16 v[60:63], v[28:31], v[220:223], v[60:63]
    s_waitcnt lgkmcnt(3)
    v_mul_f32 v109, v109, v135
    v_mul_f32 v110, v110, v135
    v_mfma_f32_16x16x32_bf16 v[64:67], v[8:11], v[208:211], v[64:67]
    ds_read_b128 v[24:27], v4 offset:16384
    v_mul_f32 v111, v111, v135
    v_mfma_f32_16x16x32_bf16 v[72:75], v[8:11], v[212:215], v[72:75]
    v_mul_f32 v108, v108, v124
    v_mul_f32 v109, v109, v125
    v_mfma_f32_16x16x32_bf16 v[80:83], v[8:11], v[216:219], v[80:83]
    v_mul_f32 v110, v110, v126
    v_mul_f32 v111, v111, v127
    v_mfma_f32_16x16x32_bf16 v[88:91], v[8:11], v[220:223], v[88:91]
    s_waitcnt lgkmcnt(3)
    v_cvt_pk_bf16_f32 v238, v108, v109
    v_cvt_pk_bf16_f32 v239, v110, v111
    v_mfma_f32_16x16x32_bf16 v[68:71], v[12:15], v[208:211], v[68:71]
    ds_read_b128 v[28:31], v4 offset:17408
    v_mfma_f32_16x16x32_bf16 v[76:79], v[12:15], v[212:215], v[76:79]
    buffer_store_dwordx4 v[236:239], v2, s[4:7], s66 offen offset:3072 sc1
    v_mfma_f32_16x16x32_bf16 v[84:87], v[12:15], v[216:219], v[84:87]
    v_mfma_f32_16x16x32_bf16 v[92:95], v[12:15], v[220:223], v[92:95]
    s_waitcnt lgkmcnt(3)
    v_mfma_f32_16x16x32_bf16 v[160:163], v[16:19], v[208:211], v[160:163]
    ds_read_b128 v[8:11], v4 offset:18432
    v_mfma_f32_16x16x32_bf16 v[164:167], v[16:19], v[212:215], v[164:167]
    buffer_load_dwordx4 a[96:99], v2, s[4:7], s60 offen offset:0 sc1
    v_mfma_f32_16x16x32_bf16 v[168:171], v[16:19], v[216:219], v[168:171]
    v_mfma_f32_16x16x32_bf16 v[172:175], v[16:19], v[220:223], v[172:175]
    s_waitcnt lgkmcnt(3)
    v_mfma_f32_16x16x32_bf16 v[96:99], v[20:23], v[176:179], 0
    ds_read_b128 v[12:15], v4 offset:19456
    v_mfma_f32_16x16x32_bf16 v[104:107], v[20:23], v[180:183], 0
    buffer_load_dwordx4 a[100:103], v2, s[4:7], s60 offen offset:1024 sc1
    v_mfma_f32_16x16x32_bf16 v[112:115], v[20:23], v[184:187], 0
    buffer_load_dwordx4 a[104:107], v2, s[4:7], s60 offen offset:2048 sc1
    buffer_load_dwordx4 a[108:111], v2, s[4:7], s60 offen offset:3072 sc1
    s_add_u32 s55, s52, 32
    buffer_load_dwordx2 v[6:7], v0, s[4:7], s55 offen sc1
    v_mfma_f32_16x16x32_bf16 v[120:123], v[20:23], v[188:191], 0
    s_waitcnt lgkmcnt(3)
    v_mfma_f32_16x16x32_bf16 v[100:103], v[24:27], v[176:179], 0
    ds_read_b128 v[16:19], v4 offset:20480
    v_mfma_f32_16x16x32_bf16 v[108:111], v[24:27], v[180:183], 0
    v_mfma_f32_16x16x32_bf16 v[116:119], v[24:27], v[184:187], 0
    buffer_load_dwordx4 v2, s[4:7], s61 offen offset:0 lds
    v_mfma_f32_16x16x32_bf16 v[124:127], v[24:27], v[188:191], 0
    s_waitcnt lgkmcnt(3)
    v_mfma_f32_16x16x32_bf16 v[128:131], v[28:31], v[176:179], 0
    ds_read_b128 v[20:23], v4 offset:21504
    v_mfma_f32_16x16x32_bf16 v[136:139], v[28:31], v[180:183], 0
    v_mfma_f32_16x16x32_bf16 v[144:147], v[28:31], v[184:187], 0
    buffer_load_dwordx4 v2, s[4:7], s61 offen offset:1024 lds
    v_mfma_f32_16x16x32_bf16 v[152:155], v[28:31], v[188:191], 0
    s_waitcnt lgkmcnt(3)
    v_mfma_f32_16x16x32_bf16 v[132:135], v[8:11], v[176:179], 0
    ds_read_b128 v[24:27], v4 offset:22528
    v_mfma_f32_16x16x32_bf16 v[140:143], v[8:11], v[180:183], 0
    v_mfma_f32_16x16x32_bf16 v[148:151], v[8:11], v[184:187], 0
    buffer_load_dwordx4 v2, s[4:7], s61 offen offset:2048 lds
    v_mfma_f32_16x16x32_bf16 v[156:159], v[8:11], v[188:191], 0
    s_waitcnt lgkmcnt(3)
    v_mfma_f32_16x16x32_bf16 v[96:99], v[12:15], v[192:195], v[96:99]
    ds_read_b128 v[28:31], v4 offset:23552
    v_mfma_f32_16x16x32_bf16 v[104:107], v[12:15], v[196:199], v[104:107]
    v_mfma_f32_16x16x32_bf16 v[112:115], v[12:15], v[200:203], v[112:115]
    buffer_load_dwordx4 v2, s[4:7], s61 offen offset:3072 lds
    v_mfma_f32_16x16x32_bf16 v[120:123], v[12:15], v[204:207], v[120:123]
    s_waitcnt lgkmcnt(3)
    s_add_u32 m0, s49, 114688
    s_add_u32 s61, s48, 409600
    v_mfma_f32_16x16x32_bf16 v[100:103], v[16:19], v[192:195], v[100:103]
    ds_read_b128 v[8:11], v4 offset:24576
    v_mfma_f32_16x16x32_bf16 v[108:111], v[16:19], v[196:199], v[108:111]
    v_mfma_f32_16x16x32_bf16 v[116:119], v[16:19], v[200:203], v[116:119]
    buffer_load_dwordx4 v2, s[4:7], s61 offen offset:0 lds
    v_mfma_f32_16x16x32_bf16 v[124:127], v[16:19], v[204:207], v[124:127]
    s_waitcnt lgkmcnt(3)
    v_mfma_f32_16x16x32_bf16 v[128:131], v[20:23], v[192:195], v[128:131]
    ds_read_b128 v[12:15], v4 offset:25600
    v_mfma_f32_16x16x32_bf16 v[136:139], v[20:23], v[196:199], v[136:139]
    v_mfma_f32_16x16x32_bf16 v[144:147], v[20:23], v[200:203], v[144:147]
    buffer_load_dwordx4 v2, s[4:7], s61 offen offset:1024 lds
    v_mfma_f32_16x16x32_bf16 v[152:155], v[20:23], v[204:207], v[152:155]
    s_waitcnt lgkmcnt(3)
    v_mfma_f32_16x16x32_bf16 v[132:135], v[24:27], v[192:195], v[132:135]
    ds_read_b128 v[16:19], v4 offset:26624
    v_mfma_f32_16x16x32_bf16 v[140:143], v[24:27], v[196:199], v[140:143]
    v_mfma_f32_16x16x32_bf16 v[148:151], v[24:27], v[200:203], v[148:151]
    buffer_load_dwordx4 v2, s[4:7], s61 offen offset:2048 lds
    v_mfma_f32_16x16x32_bf16 v[156:159], v[24:27], v[204:207], v[156:159]
    s_waitcnt lgkmcnt(3)
    v_mfma_f32_16x16x32_bf16 v[96:99], v[28:31], v[208:211], v[96:99]
    ds_read_b128 v[20:23], v4 offset:27648
    v_mfma_f32_16x16x32_bf16 v[104:107], v[28:31], v[212:215], v[104:107]
    v_mfma_f32_16x16x32_bf16 v[112:115], v[28:31], v[216:219], v[112:115]
    buffer_load_dwordx4 v2, s[4:7], s61 offen offset:3072 lds
    v_mfma_f32_16x16x32_bf16 v[120:123], v[28:31], v[220:223], v[120:123]
    s_waitcnt lgkmcnt(3)
    s_add_u32 m0, s49, 118784
    s_add_u32 s61, s48, 413696
    v_mfma_f32_16x16x32_bf16 v[100:103], v[8:11], v[208:211], v[100:103]
    ds_read_b128 v[24:27], v4 offset:28672
    v_mfma_f32_16x16x32_bf16 v[108:111], v[8:11], v[212:215], v[108:111]
    v_mfma_f32_16x16x32_bf16 v[116:119], v[8:11], v[216:219], v[116:119]
    buffer_load_dwordx4 v2, s[4:7], s61 offen offset:0 lds
    v_mfma_f32_16x16x32_bf16 v[124:127], v[8:11], v[220:223], v[124:127]
    s_waitcnt lgkmcnt(3)
    v_mfma_f32_16x16x32_bf16 v[128:131], v[12:15], v[208:211], v[128:131]
    s_waitcnt vmcnt(9)
    v_cmp_eq_u64 vcc, s[98:99], v[6:7]
    s_nop 0
    s_cmp_eq_u64 vcc, exec
    s_cbranch_scc0 L_p1_slow_85
L_p1_back_86:
    v_mfma_f32_16x16x32_bf16 v[136:139], v[12:15], v[212:215], v[136:139]
    s_add_u32 s60, s56, 32768
    ds_read_b128 v[28:31], v4 offset:29696
    v_mfma_f32_16x16x32_bf16 v[144:147], v[12:15], v[216:219], v[144:147]
    buffer_load_dwordx4 a[112:115], v2, s[4:7], s60 offen offset:0 sc1
    v_mfma_f32_16x16x32_bf16 v[152:155], v[12:15], v[220:223], v[152:155]
    s_waitcnt lgkmcnt(3)
    v_mfma_f32_16x16x32_bf16 v[132:135], v[16:19], v[208:211], v[132:135]
    ds_read_b128 v[8:11], v4 offset:30720
    v_mfma_f32_16x16x32_bf16 v[140:143], v[16:19], v[212:215], v[140:143]
    v_mfma_f32_16x16x32_bf16 v[148:151], v[16:19], v[216:219], v[148:151]
    buffer_load_dwordx4 a[116:119], v2, s[4:7], s60 offen offset:1024 sc1
    v_mfma_f32_16x16x32_bf16 v[156:159], v[16:19], v[220:223], v[156:159]
    s_waitcnt lgkmcnt(3)
    v_mfma_f32_16x16x32_bf16 v[32:35], v[20:23], v[224:227], v[32:35]
    ds_read_b128 v[12:15], v4 offset:31744
    v_mfma_f32_16x16x32_bf16 v[40:43], v[20:23], v[228:231], v[40:43]
    v_mfma_f32_16x16x32_bf16 v[48:51], v[20:23], v[232:235], v[48:51]
    buffer_load_dwordx4 a[120:123], v2, s[4:7], s60 offen offset:2048 sc1
    v_mfma_f32_16x16x32_bf16 v[56:59], v[20:23], v[236:239], v[56:59]
    s_waitcnt lgkmcnt(3)
    v_mfma_f32_16x16x32_bf16 v[36:39], v[24:27], v[224:227], v[36:39]
    ds_read_b128 v[16:19], v4 offset:32768
    v_mfma_f32_16x16x32_bf16 v[44:47], v[24:27], v[228:231], v[44:47]
    s_add_u32 s71, s67, 64
    v_mov_b32 v6, s98
    v_mov_b32 v7, s99
    v_mfma_f32_16x16x32_bf16 v[52:55], v[24:27], v[232:235], v[52:55]
    buffer_load_dwordx4 a[124:127], v2, s[4:7], s60 offen offset:3072 sc1
    v_mfma_f32_16x16x32_bf16 v[60:63], v[24:27], v[236:239], v[60:63]
    s_waitcnt lgkmcnt(3)
    s_add_u32 s60, s57, 32768
    v_mfma_f32_16x16x32_bf16 v[64:67], v[28:31], v[224:227], v[64:67]
    ds_read_b128 v[20:23], v4 offset:33792
    v_mfma_f32_16x16x32_bf16 v[72:75], v[28:31], v[228:231], v[72:75]
    v_mfma_f32_16x16x32_bf16 v[80:83], v[28:31], v[232:235], v[80:83]
    s_mov_b64 exec, 1
    buffer_store_dwordx2 v[6:7], off, s[4:7], s71 sc1
    s_mov_b64 exec, -1
    v_mfma_f32_16x16x32_bf16 v[88:91], v[28:31], v[236:239], v[88:91]
    s_waitcnt lgkmcnt(3)
    v_mfma_f32_16x16x32_bf16 v[68:71], v[8:11], v[224:227], v[68:71]
    ds_read_b128 v[24:27], v4 offset:34816
    v_mfma_f32_16x16x32_bf16 v[76:79], v[8:11], v[228:231], v[76:79]
    v_mfma_f32_16x16x32_bf16 v[84:87], v[8:11], v[232:235], v[84:87]
    buffer_load_dwordx4 a[128:131], v2, s[4:7], s60 offen offset:0 sc1
    v_mfma_f32_16x16x32_bf16 v[92:95], v[8:11], v[236:239], v[92:95]
    s_waitcnt lgkmcnt(3)
    v_mfma_f32_16x16x32_bf16 v[96:99], v[12:15], v[224:227], v[96:99]
    ds_read_b128 v[28:31], v4 offset:35840
    v_mfma_f32_16x16x32_bf16 v[104:107], v[12:15], v[228:231], v[104:107]
    v_mfma_f32_16x16x32_bf16 v[112:115], v[12:15], v[232:235], v[112:115]
    buffer_load_dwordx4 a[132:135], v2, s[4:7], s60 offen offset:1024 sc1
    v_mfma_f32_16x16x32_bf16 v[120:123], v[12:15], v[236:239], v[120:123]
    s_waitcnt lgkmcnt(3)
    v_mfma_f32_16x16x32_bf16 v[100:103], v[16:19], v[224:227], v[100:103]
    s_barrier
    v_add_u32 v4, 0x9000, v4
    v_mfma_f32_16x16x32_bf16 v[108:111], v[16:19], v[228:231], v[108:111]
    s_add_u32 m0, s49, 0
    s_add_u32 s61, s48, 442368
    ds_read_b128 v[8:11], v4 offset:0
    v_mfma_f32_16x16x32_bf16 v[116:119], v[16:19], v[232:235], v[116:119]
    buffer_load_dwordx4 a[136:139], v2, s[4:7], s60 offen offset:2048 sc1
    v_mfma_f32_16x16x32_bf16 v[124:127], v[16:19], v[236:239], v[124:127]
    s_waitcnt lgkmcnt(3)
    v_mfma_f32_16x16x32_bf16 v[128:131], v[20:23], v[224:227], v[128:131]
    ds_read_b128 v[12:15], v4 offset:1024
    v_mfma_f32_16x16x32_bf16 v[136:139], v[20:23], v[228:231], v[136:139]
    v_mfma_f32_16x16x32_bf16 v[144:147], v[20:23], v[232:235], v[144:147]
    buffer_load_dwordx4 a[140:143], v2, s[4:7], s60 offen offset:3072 sc1
    v_mfma_f32_16x16x32_bf16 v[152:155], v[20:23], v[236:239], v[152:155]
    s_waitcnt lgkmcnt(3)
    s_add_u32 s60, s58, 32768
    v_mfma_f32_16x16x32_bf16 v[132:135], v[24:27], v[224:227], v[132:135]
    ds_read_b128 v[16:19], v4 offset:2048
    v_mfma_f32_16x16x32_bf16 v[140:143], v[24:27], v[228:231], v[140:143]
    v_mfma_f32_16x16x32_bf16 v[148:151], v[24:27], v[232:235], v[148:151]
    buffer_load_dwordx4 a[144:147], v2, s[4:7], s60 offen offset:0 sc1
    v_mfma_f32_16x16x32_bf16 v[156:159], v[24:27], v[236:239], v[156:159]
    s_waitcnt lgkmcnt(3)
    v_mfma_f32_16x16x32_bf16 v[160:163], v[28:31], v[224:227], v[160:163]
    ds_read_b128 v[20:23], v4 offset:3072
    v_mfma_f32_16x16x32_bf16 v[164:167], v[28:31], v[228:231], v[164:167]
    v_mfma_f32_16x16x32_bf16 v[168:171], v[28:31], v[232:235], v[168:171]
    buffer_load_dwordx4 a[148:151], v2, s[4:7], s60 offen offset:1024 sc1
    v_mfma_f32_16x16x32_bf16 v[172:175], v[28:31], v[236:239], v[172:175]
    s_waitcnt lgkmcnt(3)
    v_mfma_f32_16x16x32_bf16 v[32:35], v[8:11], v[240:243], v[32:35]
    ds_read_b128 v[24:27], v4 offset:4096
    v_mfma_f32_16x16x32_bf16 v[40:43], v[8:11], v[244:247], v[40:43]
    v_mfma_f32_16x16x32_bf16 v[48:51], v[8:11], v[248:251], v[48:51]
    buffer_load_dwordx4 a[152:155], v2, s[4:7], s60 offen offset:2048 sc1
    v_mfma_f32_16x16x32_bf16 v[56:59], v[8:11], v[252:255], v[56:59]
    s_waitcnt lgkmcnt(3)
    v_mfma_f32_16x16x32_bf16 v[36:39], v[12:15], v[240:243], v[36:39]
    ds_read_b128 v[28:31], v4 offset:5120
    v_mfma_f32_16x16x32_bf16 v[44:47], v[12:15], v[244:247], v[44:47]
    v_mfma_f32_16x16x32_bf16 v[52:55], v[12:15], v[248:251], v[52:55]
    buffer_load_dwordx4 a[156:159], v2, s[4:7], s60 offen offset:3072 sc1
    v_mfma_f32_16x16x32_bf16 v[60:63], v[12:15], v[252:255], v[60:63]
    s_waitcnt lgkmcnt(3)
    v_mfma_f32_16x16x32_bf16 v[64:67], v[16:19], v[240:243], v[64:67]
    ds_read_b128 v[8:11], v4 offset:6144
    v_mfma_f32_16x16x32_bf16 v[72:75], v[16:19], v[244:247], v[72:75]
    v_mfma_f32_16x16x32_bf16 v[80:83], v[16:19], v[248:251], v[80:83]
    buffer_load_dwordx4 v2, s[4:7], s61 offen offset:0 lds
    v_mfma_f32_16x16x32_bf16 v[88:91], v[16:19], v[252:255], v[88:91]
    s_waitcnt lgkmcnt(3)
    v_mfma_f32_16x16x32_bf16 v[68:71], v[20:23], v[240:243], v[68:71]
    ds_read_b128 v[12:15], v4 offset:7168
    v_mfma_f32_16x16x32_bf16 v[76:79], v[20:23], v[244:247], v[76:79]
    v_mfma_f32_16x16x32_bf16 v[84:87], v[20:23], v[248:251], v[84:87]
    buffer_load_dwordx4 v2, s[4:7], s61 offen offset:1024 lds
    v_mfma_f32_16x16x32_bf16 v[92:95], v[20:23], v[252:255], v[92:95]
    s_waitcnt lgkmcnt(3)
    v_mfma_f32_16x16x32_bf16 v[96:99], v[24:27], v[240:243], v[96:99]
    ds_read_b128 v[16:19], v4 offset:8192
    v_mfma_f32_16x16x32_bf16 v[104:107], v[24:27], v[244:247], v[104:107]
    v_mfma_f32_16x16x32_bf16 v[112:115], v[24:27], v[248:251], v[112:115]
    buffer_load_dwordx4 v2, s[4:7], s61 offen offset:2048 lds
    v_mfma_f32_16x16x32_bf16 v[120:123], v[24:27], v[252:255], v[120:123]
    s_waitcnt lgkmcnt(3)
    v_mfma_f32_16x16x32_bf16 v[100:103], v[28:31], v[240:243], v[100:103]
    ds_read_b128 v[20:23], v4 offset:9216
    v_mfma_f32_16x16x32_bf16 v[108:111], v[28:31], v[244:247], v[108:111]
    v_mfma_f32_16x16x32_bf16 v[116:119], v[28:31], v[248:251], v[116:119]
    buffer_load_dwordx4 v2, s[4:7], s61 offen offset:3072 lds
    v_mfma_f32_16x16x32_bf16 v[124:127], v[28:31], v[252:255], v[124:127]
    s_waitcnt lgkmcnt(3)
    s_add_u32 m0, s49, 4096
    s_add_u32 s61, s48, 446464
    v_mfma_f32_16x16x32_bf16 v[128:131], v[8:11], v[240:243], v[128:131]
    ds_read_b128 v[24:27], v4 offset:10240
    v_mfma_f32_16x16x32_bf16 v[136:139], v[8:11], v[244:247], v[136:139]
    v_mfma_f32_16x16x32_bf16 v[144:147], v[8:11], v[248:251], v[144:147]
    buffer_load_dwordx4 v2, s[4:7], s61 offen offset:0 lds
    v_mfma_f32_16x16x32_bf16 v[152:155], v[8:11], v[252:255], v[152:155]
    s_waitcnt lgkmcnt(3)
    v_mfma_f32_16x16x32_bf16 v[132:135], v[12:15], v[240:243], v[132:135]
    ds_read_b128 v[28:31], v4 offset:11264
    v_mfma_f32_16x16x32_bf16 v[140:143], v[12:15], v[244:247], v[140:143]
    v_mfma_f32_16x16x32_bf16 v[148:151], v[12:15], v[248:251], v[148:151]
    buffer_load_dwordx4 v2, s[4:7], s61 offen offset:1024 lds
    v_mfma_f32_16x16x32_bf16 v[156:159], v[12:15], v[252:255], v[156:159]
    s_waitcnt lgkmcnt(3)
    v_mfma_f32_16x16x32_bf16 v[160:163], v[16:19], v[240:243], v[160:163]
    ds_read_b128 v[8:11], v4 offset:12288
    v_mfma_f32_16x16x32_bf16 v[164:167], v[16:19], v[244:247], v[164:167]
    v_mfma_f32_16x16x32_bf16 v[168:171], v[16:19], v[248:251], v[168:171]
    buffer_load_dwordx4 v2, s[4:7], s61 offen offset:2048 lds
    v_mfma_f32_16x16x32_bf16 v[172:175], v[16:19], v[252:255], v[172:175]
    s_waitcnt lgkmcnt(3)
    v_mfma_f32_16x16x32_bf16 v[32:35], v[20:23], a[0:3], v[32:35]
    ds_read_b128 v[12:15], v4 offset:13312
    v_mfma_f32_16x16x32_bf16 v[40:43], v[20:23], a[4:7], v[40:43]
    v_mfma_f32_16x16x32_bf16 v[48:51], v[20:23], a[8:11], v[48:51]
    buffer_load_dwordx4 v2, s[4:7], s61 offen offset:3072 lds
    v_mfma_f32_16x16x32_bf16 v[56:59], v[20:23], a[12:15], v[56:59]
    s_waitcnt lgkmcnt(3)
    s_add_u32 m0, s49, 8192
    s_add_u32 s61, s48, 450560
    v_mfma_f32_16x16x32_bf16 v[36:39], v[24:27], a[0:3], v[36:39]
    ds_read_b128 v[16:19], v4 offset:14336
    v_mfma_f32_16x16x32_bf16 v[44:47], v[24:27], a[4:7], v[44:47]
    v_mfma_f32_16x16x32_bf16 v[52:55], v[24:27], a[8:11], v[52:55]
    buffer_load_dwordx4 v2, s[4:7], s61 offen offset:0 lds
    v_mfma_f32_16x16x32_bf16 v[60:63], v[24:27], a[12:15], v[60:63]
    s_waitcnt lgkmcnt(3)
    v_mfma_f32_16x16x32_bf16 v[64:67], v[28:31], a[0:3], v[64:67]
    ds_read_b128 v[20:23], v4 offset:15360
    v_mfma_f32_16x16x32_bf16 v[72:75], v[28:31], a[4:7], v[72:75]
    v_mfma_f32_16x16x32_bf16 v[80:83], v[28:31], a[8:11], v[80:83]
    v_mfma_f32_16x16x32_bf16 v[88:91], v[28:31], a[12:15], v[88:91]
    s_waitcnt lgkmcnt(3)
    v_mfma_f32_16x16x32_bf16 v[68:71], v[8:11], a[0:3], v[68:71]
    ds_read_b128 v[24:27], v4 offset:16384
    v_mfma_f32_16x16x32_bf16 v[76:79], v[8:11], a[4:7], v[76:79]
    v_mfma_f32_16x16x32_bf16 v[84:87], v[8:11], a[8:11], v[84:87]
    v_mfma_f32_16x16x32_bf16 v[92:95], v[8:11], a[12:15], v[92:95]
    s_waitcnt lgkmcnt(3)
    v_mfma_f32_16x16x32_bf16 v[96:99], v[12:15], a[0:3], v[96:99]
    ds_read_b128 v[28:31], v4 offset:17408
    v_mfma_f32_16x16x32_bf16 v[104:107], v[12:15], a[4:7], v[104:107]
    v_mfma_f32_16x16x32_bf16 v[112:115], v[12:15], a[8:11], v[112:115]
    v_mfma_f32_16x16x32_bf16 v[120:123], v[12:15], a[12:15], v[120:123]
    s_waitcnt lgkmcnt(3)
    v_mfma_f32_16x16x32_bf16 v[100:103], v[16:19], a[0:3], v[100:103]
    ds_read_b128 v[8:11], v4 offset:18432
    v_mfma_f32_16x16x32_bf16 v[108:111], v[16:19], a[4:7], v[108:111]
    s_add_u32 s55, s52, 64
    v_mfma_f32_16x16x32_bf16 v[116:119], v[16:19], a[8:11], v[116:119]
    v_mfma_f32_16x16x32_bf16 v[124:127], v[16:19], a[12:15], v[124:127]
    s_waitcnt lgkmcnt(3)
    v_mfma_f32_16x16x32_bf16 v[128:131], v[20:23], a[0:3], v[128:131]
    ds_read_b128 v[12:15], v4 offset:19456
    v_mfma_f32_16x16x32_bf16 v[136:139], v[20:23], a[4:7], v[136:139]
    v_mfma_f32_16x16x32_bf16 v[144:147], v[20:23], a[8:11], v[144:147]
    v_mfma_f32_16x16x32_bf16 v[152:155], v[20:23], a[12:15], v[152:155]
    s_waitcnt lgkmcnt(3)
    v_mfma_f32_16x16x32_bf16 v[132:135], v[24:27], a[0:3], v[132:135]
    ds_read_b128 v[16:19], v4 offset:20480
    v_mfma_f32_16x16x32_bf16 v[140:143], v[24:27], a[4:7], v[140:143]
    v_mfma_f32_16x16x32_bf16 v[148:151], v[24:27], a[8:11], v[148:151]
    v_mfma_f32_16x16x32_bf16 v[156:159], v[24:27], a[12:15], v[156:159]
    s_waitcnt lgkmcnt(3)
    v_mfma_f32_16x16x32_bf16 v[160:163], v[28:31], a[0:3], v[160:163]
    ds_read_b128 v[20:23], v4 offset:21504
    v_mfma_f32_16x16x32_bf16 v[164:167], v[28:31], a[4:7], v[164:167]
    buffer_load_dwordx2 v[6:7], v0, s[4:7], s55 offen sc1
    v_mfma_f32_16x16x32_bf16 v[168:171], v[28:31], a[8:11], v[168:171]
    v_mfma_f32_16x16x32_bf16 v[172:175], v[28:31], a[12:15], v[172:175]
    s_waitcnt lgkmcnt(3)
    v_mfma_f32_16x16x32_bf16 v[32:35], v[8:11], a[16:19], v[32:35]
    ds_read_b128 v[24:27], v4 offset:22528
    v_mfma_f32_16x16x32_bf16 v[40:43], v[8:11], a[20:23], v[40:43]
    v_mfma_f32_16x16x32_bf16 v[48:51], v[8:11], a[24:27], v[48:51]
    v_mfma_f32_16x16x32_bf16 v[56:59], v[8:11], a[28:31], v[56:59]
    s_waitcnt lgkmcnt(3)
    v_mfma_f32_16x16x32_bf16 v[36:39], v[12:15], a[16:19], v[36:39]
    ds_read_b128 v[28:31], v4 offset:23552
    v_mfma_f32_16x16x32_bf16 v[44:47], v[12:15], a[20:23], v[44:47]
    v_mfma_f32_16x16x32_bf16 v[52:55], v[12:15], a[24:27], v[52:55]
    v_mfma_f32_16x16x32_bf16 v[60:63], v[12:15], a[28:31], v[60:63]
    s_waitcnt lgkmcnt(3)
    v_mfma_f32_16x16x32_bf16 v[64:67], v[16:19], a[16:19], v[64:67]
    ds_read_b128 v[8:11], v4 offset:24576
    v_mfma_f32_16x16x32_bf16 v[72:75], v[16:19], a[20:23], v[72:75]
    v_mfma_f32_16x16x32_bf16 v[80:83], v[16:19], a[24:27], v[80:83]
    v_mfma_f32_16x16x32_bf16 v[88:91], v[16:19], a[28:31], v[88:91]
    s_waitcnt lgkmcnt(3)
    v_mfma_f32_16x16x32_bf16 v[68:71], v[20:23], a[16:19], v[68:71]
    ds_read_b128 v[12:15], v4 offset:25600
    v_mfma_f32_16x16x32_bf16 v[76:79], v[20:23], a[20:23], v[76:79]
    v_mfma_f32_16x16x32_bf16 v[84:87], v[20:23], a[24:27], v[84:87]
    v_mfma_f32_16x16x32_bf16 v[92:95], v[20:23], a[28:31], v[92:95]
    s_waitcnt lgkmcnt(3)
    v_mfma_f32_16x16x32_bf16 v[96:99], v[24:27], a[16:19], v[96:99]
    ds_read_b128 v[16:19], v4 offset:26624
    v_mfma_f32_16x16x32_bf16 v[104:107], v[24:27], a[20:23], v[104:107]
    v_mfma_f32_16x16x32_bf16 v[112:115], v[24:27], a[24:27], v[112:115]
    v_mfma_f32_16x16x32_bf16 v[120:123], v[24:27], a[28:31], v[120:123]
    s_waitcnt lgkmcnt(3)
    v_mfma_f32_16x16x32_bf16 v[100:103], v[28:31], a[16:19], v[100:103]
    ds_read_b128 v[20:23], v4 offset:27648
    v_mfma_f32_16x16x32_bf16 v[108:111], v[28:31], a[20:23], v[108:111]
    v_mfma_f32_16x16x32_bf16 v[116:119], v[28:31], a[24:27], v[116:119]
    v_mfma_f32_16x16x32_bf16 v[124:127], v[28:31], a[28:31], v[124:127]
    s_waitcnt lgkmcnt(3)
    v_mfma_f32_16x16x32_bf16 v[128:131], v[8:11], a[16:19], v[128:131]
    ds_read_b128 v[24:27], v4 offset:28672
    v_mfma_f32_16x16x32_bf16 v[136:139], v[8:11], a[20:23], v[136:139]
    v_mfma_f32_16x16x32_bf16 v[144:147], v[8:11], a[24:27], v[144:147]
    v_mfma_f32_16x16x32_bf16 v[152:155], v[8:11], a[28:31], v[152:155]
    s_waitcnt lgkmcnt(3)
    v_mfma_f32_16x16x32_bf16 v[132:135], v[12:15], a[16:19], v[132:135]
    ds_read_b128 v[28:31], v4 offset:29696
    v_mfma_f32_16x16x32_bf16 v[140:143], v[12:15], a[20:23], v[140:143]
    v_mfma_f32_16x16x32_bf16 v[148:151], v[12:15], a[24:27], v[148:151]
    v_mfma_f32_16x16x32_bf16 v[156:159], v[12:15], a[28:31], v[156:159]
    s_waitcnt lgkmcnt(3)
    v_mfma_f32_16x16x32_bf16 v[160:163], v[16:19], a[16:19], v[160:163]
    ds_read_b128 v[8:11], v4 offset:30720
    v_mfma_f32_16x16x32_bf16 v[164:167], v[16:19], a[20:23], v[164:167]
    v_mfma_f32_16x16x32_bf16 v[168:171], v[16:19], a[24:27], v[168:171]
    v_mfma_f32_16x16x32_bf16 v[172:175], v[16:19], a[28:31], v[172:175]
    s_waitcnt lgkmcnt(3)
    v_mfma_f32_16x16x32_bf16 v[32:35], v[20:23], a[32:35], v[32:35]
    s_waitcnt vmcnt(0)
    v_cmp_eq_u64 vcc, s[98:99], v[6:7]
    s_nop 0
    s_cmp_eq_u64 vcc, exec
    s_cbranch_scc0 L_p2_slow_88
L_p2_back_89:
    v_mfma_f32_16x16x32_bf16 v[40:43], v[20:23], a[36:39], v[40:43]
    s_add_u32 s60, s56, 49152
    ds_read_b128 v[12:15], v4 offset:31744
    v_mfma_f32_16x16x32_bf16 v[48:51], v[20:23], a[40:43], v[48:51]
    buffer_load_dwordx4 a[160:163], v2, s[4:7], s60 offen offset:0 sc1
    v_mfma_f32_16x16x32_bf16 v[56:59], v[20:23], a[44:47], v[56:59]
    s_waitcnt lgkmcnt(3)
    s_and_b32 s68, s46, 1
    s_mul_i32 s69, s68, 5120
    v_mfma_f32_16x16x32_bf16 v[36:39], v[24:27], a[32:35], v[36:39]
    s_add_u32 s69, s69, s53
    s_lshl_b32 s68, s68, 9
    ds_read_b128 v[16:19], v4 offset:32768
    v_mfma_f32_16x16x32_bf16 v[44:47], v[24:27], a[36:39], v[44:47]
    s_add_u32 s68, s68, s53
    v_and_b32 v0, 15, v1
    v_lshlrev_b32 v0, 5, v0
    v_mfma_f32_16x16x32_bf16 v[52:55], v[24:27], a[40:43], v[52:55]
    buffer_load_dwordx4 a[164:167], v2, s[4:7], s60 offen offset:1024 sc1
    v_mfma_f32_16x16x32_bf16 v[60:63], v[24:27], a[44:47], v[60:63]
    s_waitcnt lgkmcnt(3)
    v_lshrrev_b32 v5, 4, v1
    v_lshl_add_u32 v0, v5, 3, v0
    v_mfma_f32_16x16x32_bf16 v[64:67], v[28:31], a[32:35], v[64:67]
    ds_read_b128 v[20:23], v4 offset:33792
    v_mfma_f32_16x16x32_bf16 v[72:75], v[28:31], a[36:39], v[72:75]
    v_mfma_f32_16x16x32_bf16 v[80:83], v[28:31], a[40:43], v[80:83]
    buffer_load_dwordx4 a[168:171], v2, s[4:7], s60 offen offset:2048 sc1
    v_mfma_f32_16x16x32_bf16 v[88:91], v[28:31], a[44:47], v[88:91]
    s_waitcnt lgkmcnt(3)
    v_mfma_f32_16x16x32_bf16 v[68:71], v[8:11], a[32:35], v[68:71]
    ds_read_b128 v[24:27], v4 offset:34816
    v_mfma_f32_16x16x32_bf16 v[76:79], v[8:11], a[36:39], v[76:79]
    v_mfma_f32_16x16x32_bf16 v[84:87], v[8:11], a[40:43], v[84:87]
    buffer_load_dwordx4 a[172:175], v2, s[4:7], s60 offen offset:3072 sc1
    v_mfma_f32_16x16x32_bf16 v[92:95], v[8:11], a[44:47], v[92:95]
    s_waitcnt lgkmcnt(3)
    s_add_u32 s60, s57, 49152
    v_mfma_f32_16x16x32_bf16 v[96:99], v[12:15], a[32:35], v[96:99]
    ds_read_b128 v[28:31], v4 offset:35840
    v_mfma_f32_16x16x32_bf16 v[104:107], v[12:15], a[36:39], v[104:107]
    v_mfma_f32_16x16x32_bf16 v[112:115], v[12:15], a[40:43], v[112:115]
    buffer_load_dwordx4 a[176:179], v2, s[4:7], s60 offen offset:0 sc1
    v_mfma_f32_16x16x32_bf16 v[120:123], v[12:15], a[44:47], v[120:123]
    s_waitcnt lgkmcnt(3)
    v_mfma_f32_16x16x32_bf16 v[100:103], v[16:19], a[32:35], v[100:103]
    s_barrier
    v_add_u32 v4, 0x9000, v4
    v_mfma_f32_16x16x32_bf16 v[108:111], v[16:19], a[36:39], v[108:111]
    s_add_u32 m0, s63, 36864
    s_add_u32 s61, s62, 479232
    ds_read_b128 v[8:11], v4 offset:0
    v_mfma_f32_16x16x32_bf16 v[116:119], v[16:19], a[40:43], v[116:119]
    buffer_load_dwordx4 a[180:183], v2, s[4:7], s60 offen offset:1024 sc1
    v_mfma_f32_16x16x32_bf16 v[124:127], v[16:19], a[44:47], v[124:127]
    s_waitcnt lgkmcnt(3)
    v_mfma_f32_16x16x32_bf16 v[128:131], v[20:23], a[32:35], v[128:131]
    ds_read_b128 v[12:15], v4 offset:1024
    v_mfma_f32_16x16x32_bf16 v[136:139], v[20:23], a[36:39], v[136:139]
    v_mfma_f32_16x16x32_bf16 v[144:147], v[20:23], a[40:43], v[144:147]
    buffer_load_dwordx4 a[184:187], v2, s[4:7], s60 offen offset:2048 sc1
    v_mfma_f32_16x16x32_bf16 v[152:155], v[20:23], a[44:47], v[152:155]
    s_waitcnt lgkmcnt(3)
    v_mfma_f32_16x16x32_bf16 v[132:135], v[24:27], a[32:35], v[132:135]
    ds_read_b128 v[16:19], v4 offset:2048
    v_mfma_f32_16x16x32_bf16 v[140:143], v[24:27], a[36:39], v[140:143]
    v_mfma_f32_16x16x32_bf16 v[148:151], v[24:27], a[40:43], v[148:151]
    buffer_load_dwordx4 a[188:191], v2, s[4:7], s60 offen offset:3072 sc1
    v_mfma_f32_16x16x32_bf16 v[156:159], v[24:27], a[44:47], v[156:159]
    s_waitcnt lgkmcnt(3)
    s_add_u32 s60, s58, 49152
    v_mfma_f32_16x16x32_bf16 v[160:163], v[28:31], a[32:35], v[160:163]
    ds_read_b128 v[20:23], v4 offset:3072
    v_mfma_f32_16x16x32_bf16 v[164:167], v[28:31], a[36:39], v[164:167]
    v_mfma_f32_16x16x32_bf16 v[168:171], v[28:31], a[40:43], v[168:171]
    buffer_load_dwordx4 a[192:195], v2, s[4:7], s60 offen offset:0 sc1
    v_mfma_f32_16x16x32_bf16 v[172:175], v[28:31], a[44:47], v[172:175]
    s_waitcnt lgkmcnt(3)
    v_mfma_f32_16x16x32_bf16 v[32:35], v[8:11], a[48:51], v[32:35]
    ds_read_b128 v[24:27], v4 offset:4096
    v_mfma_f32_16x16x32_bf16 v[40:43], v[8:11], a[52:55], v[40:43]
    v_mfma_f32_16x16x32_bf16 v[48:51], v[8:11], a[56:59], v[48:51]
    buffer_load_dwordx4 a[196:199], v2, s[4:7], s60 offen offset:1024 sc1
    v_mfma_f32_16x16x32_bf16 v[56:59], v[8:11], a[60:63], v[56:59]
    s_waitcnt lgkmcnt(3)
    v_mfma_f32_16x16x32_bf16 v[36:39], v[12:15], a[48:51], v[36:39]
    ds_read_b128 v[28:31], v4 offset:5120
    v_mfma_f32_16x16x32_bf16 v[44:47], v[12:15], a[52:55], v[44:47]
    v_mfma_f32_16x16x32_bf16 v[52:55], v[12:15], a[56:59], v[52:55]
    buffer_load_dwordx4 a[200:203], v2, s[4:7], s60 offen offset:2048 sc1
    v_mfma_f32_16x16x32_bf16 v[60:63], v[12:15], a[60:63], v[60:63]
    s_waitcnt lgkmcnt(3)
    v_mfma_f32_16x16x32_bf16 v[64:67], v[16:19], a[48:51], v[64:67]
    ds_read_b128 v[8:11], v4 offset:6144
    v_mfma_f32_16x16x32_bf16 v[72:75], v[16:19], a[52:55], v[72:75]
    v_mfma_f32_16x16x32_bf16 v[80:83], v[16:19], a[56:59], v[80:83]
    buffer_load_dwordx4 a[204:207], v2, s[4:7], s60 offen offset:3072 sc1
    v_mfma_f32_16x16x32_bf16 v[88:91], v[16:19], a[60:63], v[88:91]
    s_waitcnt lgkmcnt(3)
    v_mfma_f32_16x16x32_bf16 v[68:71], v[20:23], a[48:51], v[68:71]
    ds_read_b128 v[12:15], v4 offset:7168
    v_mfma_f32_16x16x32_bf16 v[76:79], v[20:23], a[52:55], v[76:79]
    v_mfma_f32_16x16x32_bf16 v[84:87], v[20:23], a[56:59], v[84:87]
    buffer_load_dwordx4 v2, s[4:7], s61 offen offset:0 lds
    v_mfma_f32_16x16x32_bf16 v[92:95], v[20:23], a[60:63], v[92:95]
    s_waitcnt lgkmcnt(3)
    v_mfma_f32_16x16x32_bf16 v[96:99], v[24:27], a[48:51], v[96:99]
    ds_read_b128 v[16:19], v4 offset:8192
    v_mfma_f32_16x16x32_bf16 v[104:107], v[24:27], a[52:55], v[104:107]
    v_mfma_f32_16x16x32_bf16 v[112:115], v[24:27], a[56:59], v[112:115]
    buffer_load_dwordx4 v2, s[4:7], s61 offen offset:1024 lds
    v_mfma_f32_16x16x32_bf16 v[120:123], v[24:27], a[60:63], v[120:123]
    s_waitcnt lgkmcnt(3)
    v_mfma_f32_16x16x32_bf16 v[100:103], v[28:31], a[48:51], v[100:103]
    ds_read_b128 v[20:23], v4 offset:9216
    v_mfma_f32_16x16x32_bf16 v[108:111], v[28:31], a[52:55], v[108:111]
    v_mfma_f32_16x16x32_bf16 v[116:119], v[28:31], a[56:59], v[116:119]
    buffer_load_dwordx4 v2, s[4:7], s61 offen offset:2048 lds
    v_mfma_f32_16x16x32_bf16 v[124:127], v[28:31], a[60:63], v[124:127]
    s_waitcnt lgkmcnt(3)
    v_mfma_f32_16x16x32_bf16 v[128:131], v[8:11], a[48:51], v[128:131]
    ds_read_b128 v[24:27], v4 offset:10240
    v_mfma_f32_16x16x32_bf16 v[136:139], v[8:11], a[52:55], v[136:139]
    v_mfma_f32_16x16x32_bf16 v[144:147], v[8:11], a[56:59], v[144:147]
    buffer_load_dwordx4 v2, s[4:7], s61 offen offset:3072 lds
    v_mfma_f32_16x16x32_bf16 v[152:155], v[8:11], a[60:63], v[152:155]
    s_waitcnt lgkmcnt(3)
    s_add_u32 m0, s63, 40960
    s_add_u32 s61, s62, 483328
    v_mfma_f32_16x16x32_bf16 v[132:135], v[12:15], a[48:51], v[132:135]
    ds_read_b128 v[28:31], v4 offset:11264
    v_mfma_f32_16x16x32_bf16 v[140:143], v[12:15], a[52:55], v[140:143]
    v_mfma_f32_16x16x32_bf16 v[148:151], v[12:15], a[56:59], v[148:151]
    buffer_load_dwordx4 v2, s[4:7], s61 offen offset:0 lds
    v_mfma_f32_16x16x32_bf16 v[156:159], v[12:15], a[60:63], v[156:159]
    s_waitcnt lgkmcnt(3)
    v_mfma_f32_16x16x32_bf16 v[160:163], v[16:19], a[48:51], v[160:163]
    ds_read_b128 v[8:11], v4 offset:12288
    v_mfma_f32_16x16x32_bf16 v[164:167], v[16:19], a[52:55], v[164:167]
    v_mfma_f32_16x16x32_bf16 v[168:171], v[16:19], a[56:59], v[168:171]
    v_mfma_f32_16x16x32_bf16 v[172:175], v[16:19], a[60:63], v[172:175]
    s_waitcnt lgkmcnt(3)
    v_mfma_f32_16x16x32_bf16 v[32:35], v[20:23], a[64:67], v[32:35]
    ds_read_b128 v[12:15], v4 offset:13312
    v_mfma_f32_16x16x32_bf16 v[40:43], v[20:23], a[68:71], v[40:43]
    v_mfma_f32_16x16x32_bf16 v[48:51], v[20:23], a[72:75], v[48:51]
    v_mfma_f32_16x16x32_bf16 v[56:59], v[20:23], a[76:79], v[56:59]
    s_waitcnt lgkmcnt(3)
    v_mfma_f32_16x16x32_bf16 v[36:39], v[24:27], a[64:67], v[36:39]
    ds_read_b128 v[16:19], v4 offset:14336
    v_mfma_f32_16x16x32_bf16 v[44:47], v[24:27], a[68:71], v[44:47]
    v_mfma_f32_16x16x32_bf16 v[52:55], v[24:27], a[72:75], v[52:55]
    v_mfma_f32_16x16x32_bf16 v[60:63], v[24:27], a[76:79], v[60:63]
    s_waitcnt lgkmcnt(3)
    v_mfma_f32_16x16x32_bf16 v[32:35], v[28:31], a[80:83], v[32:35]
    s_and_b32 s62, s22, 15
    s_mul_i32 s62, s62, 129024
    ds_read_b128 v[20:23], v4 offset:15360
    v_mfma_f32_16x16x32_bf16 v[40:43], v[28:31], a[84:87], v[40:43]
    s_add_u32 s62, s62, 0
    v_mfma_f32_16x16x32_bf16 v[48:51], v[28:31], a[88:91], v[48:51]
    s_cmp_lg_u32 s101, 0
    s_cselect_b32 s62, 0x10000000, s62
    v_mfma_f32_16x16x32_bf16 v[56:59], v[28:31], a[92:95], v[56:59]
    s_waitcnt lgkmcnt(3)
    s_add_u32 s61, s63, 36864
    s_add_u32 m0, s61, 18432
    v_mfma_f32_16x16x32_bf16 v[36:39], v[8:11], a[80:83], v[36:39]
    s_add_u32 s61, s61, s62
    ds_read_b128 v[24:27], v4 offset:16384
    v_mfma_f32_16x16x32_bf16 v[44:47], v[8:11], a[84:87], v[44:47]
    buffer_load_dwordx4 v2, s[4:7], s61 offen offset:0 lds
    v_mfma_f32_16x16x32_bf16 v[52:55], v[8:11], a[88:91], v[52:55]
    v_mfma_f32_16x16x32_bf16 v[60:63], v[8:11], a[92:95], v[60:63]
    s_waitcnt lgkmcnt(3)
    v_mfma_f32_16x16x32_bf16 v[32:35], v[12:15], a[96:99], v[32:35]
    ds_read_b128 v[28:31], v4 offset:17408
    v_mfma_f32_16x16x32_bf16 v[40:43], v[12:15], a[100:103], v[40:43]
    buffer_load_dwordx4 v2, s[4:7], s61 offen offset:1024 lds
    v_mfma_f32_16x16x32_bf16 v[48:51], v[12:15], a[104:107], v[48:51]
    v_mfma_f32_16x16x32_bf16 v[56:59], v[12:15], a[108:111], v[56:59]
    s_waitcnt lgkmcnt(3)
    v_mfma_f32_16x16x32_bf16 v[36:39], v[16:19], a[96:99], v[36:39]
    ds_read_b128 v[8:11], v4 offset:18432
    v_mfma_f32_16x16x32_bf16 v[44:47], v[16:19], a[100:103], v[44:47]
    buffer_load_dwordx4 v2, s[4:7], s61 offen offset:2048 lds
    v_mfma_f32_16x16x32_bf16 v[52:55], v[16:19], a[104:107], v[52:55]
    v_mfma_f32_16x16x32_bf16 v[60:63], v[16:19], a[108:111], v[60:63]
    s_waitcnt lgkmcnt(3)
    v_mfma_f32_16x16x32_bf16 v[32:35], v[20:23], a[112:115], v[32:35]
    ds_read_b128 v[12:15], v4 offset:19456
    v_mfma_f32_16x16x32_bf16 v[40:43], v[20:23], a[116:119], v[40:43]
    buffer_load_dwordx4 v2, s[4:7], s61 offen offset:3072 lds
    v_mfma_f32_16x16x32_bf16 v[48:51], v[20:23], a[120:123], v[48:51]
    s_add_u32 s61, s63, 40960
    s_add_u32 m0, s61, 18432
    s_add_u32 s61, s61, s62
    v_mfma_f32_16x16x32_bf16 v[56:59], v[20:23], a[124:127], v[56:59]
    s_waitcnt lgkmcnt(3)
    v_mfma_f32_16x16x32_bf16 v[36:39], v[24:27], a[112:115], v[36:39]
    ds_read_b128 v[16:19], v4 offset:20480
    v_mfma_f32_16x16x32_bf16 v[44:47], v[24:27], a[116:119], v[44:47]
    buffer_load_dwordx4 v2, s[4:7], s61 offen offset:0 lds
    v_mfma_f32_16x16x32_bf16 v[52:55], v[24:27], a[120:123], v[52:55]
    v_mfma_f32_16x16x32_bf16 v[60:63], v[24:27], a[124:127], v[60:63]
    s_waitcnt lgkmcnt(3)
    v_mfma_f32_16x16x32_bf16 v[32:35], v[28:31], a[128:131], v[32:35]
    ds_read_b128 v[20:23], v4 offset:21504
    v_mfma_f32_16x16x32_bf16 v[40:43], v[28:31], a[132:135], v[40:43]
    v_mfma_f32_16x16x32_bf16 v[48:51], v[28:31], a[136:139], v[48:51]
    v_mfma_f32_16x16x32_bf16 v[56:59], v[28:31], a[140:143], v[56:59]
    s_waitcnt lgkmcnt(3)
    v_mfma_f32_16x16x32_bf16 v[36:39], v[8:11], a[128:131], v[36:39]
    ds_read_b128 v[24:27], v4 offset:22528
    v_mfma_f32_16x16x32_bf16 v[44:47], v[8:11], a[132:135], v[44:47]
    v_mfma_f32_16x16x32_bf16 v[52:55], v[8:11], a[136:139], v[52:55]
    v_mfma_f32_16x16x32_bf16 v[60:63], v[8:11], a[140:143], v[60:63]
    s_waitcnt lgkmcnt(3)
    v_mfma_f32_16x16x32_bf16 v[32:35], v[12:15], a[144:147], v[32:35]
    ds_read_b128 v[28:31], v4 offset:23552
    v_mfma_f32_16x16x32_bf16 v[40:43], v[12:15], a[148:151], v[40:43]
    v_mfma_f32_16x16x32_bf16 v[48:51], v[12:15], a[152:155], v[48:51]
    v_mfma_f32_16x16x32_bf16 v[56:59], v[12:15], a[156:159], v[56:59]
    s_waitcnt lgkmcnt(3)
    v_mfma_f32_16x16x32_bf16 v[36:39], v[16:19], a[144:147], v[36:39]
    ds_read_b128 v[8:11], v4 offset:24576
    v_mfma_f32_16x16x32_bf16 v[44:47], v[16:19], a[148:151], v[44:47]
    v_mfma_f32_16x16x32_bf16 v[52:55], v[16:19], a[152:155], v[52:55]
    v_mfma_f32_16x16x32_bf16 v[60:63], v[16:19], a[156:159], v[60:63]
    s_waitcnt vmcnt(21) lgkmcnt(3)
    v_mfma_f32_16x16x32_bf16 v[32:35], v[20:23], a[160:163], v[32:35]
    s_waitcnt vmcnt(20)
    ds_read_b128 v[12:15], v4 offset:25600
    v_mfma_f32_16x16x32_bf16 v[40:43], v[20:23], a[164:167], v[40:43]
    s_waitcnt vmcnt(19)
    v_mfma_f32_16x16x32_bf16 v[48:51], v[20:23], a[168:171], v[48:51]
    s_waitcnt vmcnt(18)
    v_mfma_f32_16x16x32_bf16 v[56:59], v[20:23], a[172:175], v[56:59]
    s_waitcnt lgkmcnt(3)
    v_mfma_f32_16x16x32_bf16 v[36:39], v[24:27], a[160:163], v[36:39]
    ds_read_b128 v[16:19], v4 offset:26624
    v_mfma_f32_16x16x32_bf16 v[44:47], v[24:27], a[164:167], v[44:47]
    v_mfma_f32_16x16x32_bf16 v[52:55], v[24:27], a[168:171], v[52:55]
    v_mfma_f32_16x16x32_bf16 v[60:63], v[24:27], a[172:175], v[60:63]
    s_waitcnt vmcnt(17) lgkmcnt(3)
    v_mfma_f32_16x16x32_bf16 v[32:35], v[28:31], a[176:179], v[32:35]
    s_waitcnt vmcnt(16)
    ds_read_b128 v[20:23], v4 offset:27648
    v_mfma_f32_16x16x32_bf16 v[40:43], v[28:31], a[180:183], v[40:43]
    s_waitcnt vmcnt(15)
    v_mfma_f32_16x16x32_bf16 v[48:51], v[28:31], a[184:187], v[48:51]
    s_waitcnt vmcnt(14)
    v_mfma_f32_16x16x32_bf16 v[56:59], v[28:31], a[188:191], v[56:59]
    s_waitcnt lgkmcnt(3)
    v_mfma_f32_16x16x32_bf16 v[36:39], v[8:11], a[176:179], v[36:39]
    ds_read_b128 v[24:27], v4 offset:28672
    v_mfma_f32_16x16x32_bf16 v[44:47], v[8:11], a[180:183], v[44:47]
    v_mfma_f32_16x16x32_bf16 v[52:55], v[8:11], a[184:187], v[52:55]
    v_mfma_f32_16x16x32_bf16 v[60:63], v[8:11], a[188:191], v[60:63]
    s_waitcnt vmcnt(13) lgkmcnt(3)
    v_mfma_f32_16x16x32_bf16 v[32:35], v[12:15], a[192:195], v[32:35]
    s_waitcnt vmcnt(12)
    ds_read_b128 v[28:31], v4 offset:29696
    v_mfma_f32_16x16x32_bf16 v[40:43], v[12:15], a[196:199], v[40:43]
    s_waitcnt vmcnt(11)
    v_mfma_f32_16x16x32_bf16 v[48:51], v[12:15], a[200:203], v[48:51]
    s_waitcnt vmcnt(10)
    v_mfma_f32_16x16x32_bf16 v[56:59], v[12:15], a[204:207], v[56:59]
    s_waitcnt lgkmcnt(3)
    v_mfma_f32_16x16x32_bf16 v[36:39], v[16:19], a[192:195], v[36:39]
    ds_read_b128 v[8:11], v4 offset:30720
    v_mfma_f32_16x16x32_bf16 v[44:47], v[16:19], a[196:199], v[44:47]
    v_mfma_f32_16x16x32_bf16 v[52:55], v[16:19], a[200:203], v[52:55]
    v_mfma_f32_16x16x32_bf16 v[60:63], v[16:19], a[204:207], v[60:63]
    s_waitcnt lgkmcnt(3)
    v_mfma_f32_16x16x32_bf16 v[64:67], v[20:23], a[64:67], v[64:67]
    ds_read_b128 v[12:15], v4 offset:31744
    v_mfma_f32_16x16x32_bf16 v[72:75], v[20:23], a[68:71], v[72:75]
    v_mfma_f32_16x16x32_bf16 v[80:83], v[20:23], a[72:75], v[80:83]
    v_mfma_f32_16x16x32_bf16 v[88:91], v[20:23], a[76:79], v[88:91]
    s_waitcnt lgkmcnt(3)
    v_cvt_pk_bf16_f32 v32, v32, v33
    v_cvt_pk_bf16_f32 v33, v34, v35
    v_mfma_f32_16x16x32_bf16 v[68:71], v[24:27], a[64:67], v[68:71]
    ds_read_b128 v[16:19], v4 offset:32768
    v_cvt_pk_bf16_f32 v34, v36, v37
    v_mfma_f32_16x16x32_bf16 v[76:79], v[24:27], a[68:71], v[76:79]
    v_cvt_pk_bf16_f32 v35, v38, v39
    v_mfma_f32_16x16x32_bf16 v[84:87], v[24:27], a[72:75], v[84:87]
    s_add_u32 s70, s69, 0
    v_mfma_f32_16x16x32_bf16 v[92:95], v[24:27], a[76:79], v[92:95]
    s_waitcnt lgkmcnt(3)
    v_mfma_f32_16x16x32_bf16 v[64:67], v[28:31], a[80:83], v[64:67]
    ds_read_b128 v[20:23], v4 offset:33792
    v_mfma_f32_16x16x32_bf16 v[72:75], v[28:31], a[84:87], v[72:75]
    buffer_store_dwordx4 v[32:35], v2, s[4:7], s70 offen sc1
    v_mfma_f32_16x16x32_bf16 v[80:83], v[28:31], a[88:91], v[80:83]
    v_cvt_pk_bf16_f32 v40, v40, v41
    v_cvt_pk_bf16_f32 v41, v42, v43
    v_mfma_f32_16x16x32_bf16 v[88:91], v[28:31], a[92:95], v[88:91]
    s_waitcnt lgkmcnt(3)
    v_cvt_pk_bf16_f32 v42, v44, v45
    v_cvt_pk_bf16_f32 v43, v46, v47
    v_mfma_f32_16x16x32_bf16 v[68:71], v[8:11], a[80:83], v[68:71]
    s_add_u32 s70, s69, 18432
    ds_read_b128 v[24:27], v4 offset:34816
    v_mfma_f32_16x16x32_bf16 v[76:79], v[8:11], a[84:87], v[76:79]
    buffer_store_dwordx4 v[40:43], v2, s[4:7], s70 offen sc1
    v_mfma_f32_16x16x32_bf16 v[84:87], v[8:11], a[88:91], v[84:87]
    v_cvt_pk_bf16_f32 v48, v48, v49
    v_cvt_pk_bf16_f32 v49, v50, v51
    v_mfma_f32_16x16x32_bf16 v[92:95], v[8:11], a[92:95], v[92:95]
    s_waitcnt lgkmcnt(3)
    v_cvt_pk_bf16_f32 v50, v52, v53
    v_cvt_pk_bf16_f32 v51, v54, v55
    v_mfma_f32_16x16x32_bf16 v[64:67], v[12:15], a[96:99], v[64:67]
    s_add_u32 s70, s69, 36864
    ds_read_b128 v[28:31], v4 offset:35840
    v_mfma_f32_16x16x32_bf16 v[72:75], v[12:15], a[100:103], v[72:75]
    buffer_store_dwordx4 v[48:51], v2, s[4:7], s70 offen sc1
    v_mfma_f32_16x16x32_bf16 v[80:83], v[12:15], a[104:107], v[80:83]
    v_cvt_pk_bf16_f32 v56, v56, v57
    v_cvt_pk_bf16_f32 v57, v58, v59
    v_mfma_f32_16x16x32_bf16 v[88:91], v[12:15], a[108:111], v[88:91]
    s_waitcnt lgkmcnt(3)
    v_cvt_pk_bf16_f32 v58, v60, v61
    v_cvt_pk_bf16_f32 v59, v62, v63
    v_mfma_f32_16x16x32_bf16 v[68:71], v[16:19], a[96:99], v[68:71]
    s_barrier
    v_add_u32 v4, 0xfffe5000, v4
    v_mfma_f32_16x16x32_bf16 v[76:79], v[16:19], a[100:103], v[76:79]
    s_add_u32 s70, s69, 55296
    s_add_u32 s61, s49, 55296
    ds_read_b128 v[8:11], v4 offset:0
    v_mfma_f32_16x16x32_bf16 v[84:87], v[16:19], a[104:107], v[84:87]
    buffer_store_dwordx4 v[56:59], v2, s[4:7], s70 offen sc1
    v_mfma_f32_16x16x32_bf16 v[92:95], v[16:19], a[108:111], v[92:95]
    s_waitcnt lgkmcnt(3)
    s_add_u32 m0, s61, 18432
    s_add_u32 s61, s61, s62
    v_mfma_f32_16x16x32_bf16 v[64:67], v[20:23], a[112:115], v[64:67]
    ds_read_b128 v[12:15], v4 offset:1024
    v_mfma_f32_16x16x32_bf16 v[72:75], v[20:23], a[116:119], v[72:75]
    v_mfma_f32_16x16x32_bf16 v[80:83], v[20:23], a[120:123], v[80:83]
    buffer_load_dwordx4 v2, s[4:7], s61 offen offset:0 lds
    v_mfma_f32_16x16x32_bf16 v[88:91], v[20:23], a[124:127], v[88:91]
    s_waitcnt lgkmcnt(3)
    v_mfma_f32_16x16x32_bf16 v[68:71], v[24:27], a[112:115], v[68:71]
    ds_read_b128 v[16:19], v4 offset:2048
    v_mfma_f32_16x16x32_bf16 v[76:79], v[24:27], a[116:119], v[76:79]
    v_mfma_f32_16x16x32_bf16 v[84:87], v[24:27], a[120:123], v[84:87]
    buffer_load_dwordx4 v2, s[4:7], s61 offen offset:1024 lds
    v_mfma_f32_16x16x32_bf16 v[92:95], v[24:27], a[124:127], v[92:95]
    s_waitcnt lgkmcnt(3)
    v_mfma_f32_16x16x32_bf16 v[64:67], v[28:31], a[128:131], v[64:67]
    ds_read_b128 v[20:23], v4 offset:3072
    v_mfma_f32_16x16x32_bf16 v[72:75], v[28:31], a[132:135], v[72:75]
    v_mfma_f32_16x16x32_bf16 v[80:83], v[28:31], a[136:139], v[80:83]
    buffer_load_dwordx4 v2, s[4:7], s61 offen offset:2048 lds
    v_mfma_f32_16x16x32_bf16 v[88:91], v[28:31], a[140:143], v[88:91]
    s_waitcnt lgkmcnt(3)
    v_mfma_f32_16x16x32_bf16 v[68:71], v[8:11], a[128:131], v[68:71]
    ds_read_b128 v[24:27], v4 offset:4096
    v_mfma_f32_16x16x32_bf16 v[76:79], v[8:11], a[132:135], v[76:79]
    v_mfma_f32_16x16x32_bf16 v[84:87], v[8:11], a[136:139], v[84:87]
    buffer_load_dwordx4 v2, s[4:7], s61 offen offset:3072 lds
    v_mfma_f32_16x16x32_bf16 v[92:95], v[8:11], a[140:143], v[92:95]
    s_waitcnt lgkmcnt(3)
    s_add_u32 s61, s49, 59392
    s_add_u32 m0, s61, 18432
    v_mfma_f32_16x16x32_bf16 v[64:67], v[12:15], a[144:147], v[64:67]
    s_add_u32 s61, s61, s62
    ds_read_b128 v[28:31], v4 offset:5120
    v_mfma_f32_16x16x32_bf16 v[72:75], v[12:15], a[148:151], v[72:75]
    v_mfma_f32_16x16x32_bf16 v[80:83], v[12:15], a[152:155], v[80:83]
    buffer_load_dwordx4 v2, s[4:7], s61 offen offset:0 lds
    v_mfma_f32_16x16x32_bf16 v[88:91], v[12:15], a[156:159], v[88:91]
    s_waitcnt lgkmcnt(3)
    v_mfma_f32_16x16x32_bf16 v[68:71], v[16:19], a[144:147], v[68:71]
    ds_read_b128 v[8:11], v4 offset:6144
    v_mfma_f32_16x16x32_bf16 v[76:79], v[16:19], a[148:151], v[76:79]
    v_mfma_f32_16x16x32_bf16 v[84:87], v[16:19], a[152:155], v[84:87]
    buffer_load_dwordx4 v2, s[4:7], s61 offen offset:1024 lds
    v_mfma_f32_16x16x32_bf16 v[92:95], v[16:19], a[156:159], v[92:95]
    s_waitcnt lgkmcnt(3)
    v_mfma_f32_16x16x32_bf16 v[64:67], v[20:23], a[160:163], v[64:67]
    ds_read_b128 v[12:15], v4 offset:7168
    v_mfma_f32_16x16x32_bf16 v[72:75], v[20:23], a[164:167], v[72:75]
    v_mfma_f32_16x16x32_bf16 v[80:83], v[20:23], a[168:171], v[80:83]
    buffer_load_dwordx4 v2, s[4:7], s61 offen offset:2048 lds
    v_mfma_f32_16x16x32_bf16 v[88:91], v[20:23], a[172:175], v[88:91]
    s_waitcnt lgkmcnt(3)
    v_mfma_f32_16x16x32_bf16 v[68:71], v[24:27], a[160:163], v[68:71]
    ds_read_b128 v[16:19], v4 offset:8192
    v_mfma_f32_16x16x32_bf16 v[76:79], v[24:27], a[164:167], v[76:79]
    v_mfma_f32_16x16x32_bf16 v[84:87], v[24:27], a[168:171], v[84:87]
    buffer_load_dwordx4 v2, s[4:7], s61 offen offset:3072 lds
    v_mfma_f32_16x16x32_bf16 v[92:95], v[24:27], a[172:175], v[92:95]
    s_waitcnt lgkmcnt(3)
    s_add_u32 s61, s49, 63488
    s_add_u32 m0, s61, 18432
    v_mfma_f32_16x16x32_bf16 v[64:67], v[28:31], a[176:179], v[64:67]
    s_add_u32 s61, s61, s62
    ds_read_b128 v[20:23], v4 offset:9216
    v_mfma_f32_16x16x32_bf16 v[72:75], v[28:31], a[180:183], v[72:75]
    v_mfma_f32_16x16x32_bf16 v[80:83], v[28:31], a[184:187], v[80:83]
    buffer_load_dwordx4 v2, s[4:7], s61 offen offset:0 lds
    v_mfma_f32_16x16x32_bf16 v[88:91], v[28:31], a[188:191], v[88:91]
    s_waitcnt lgkmcnt(3)
    v_mfma_f32_16x16x32_bf16 v[68:71], v[8:11], a[176:179], v[68:71]
    ds_read_b128 v[24:27], v4 offset:10240
    v_mfma_f32_16x16x32_bf16 v[76:79], v[8:11], a[180:183], v[76:79]
    v_mfma_f32_16x16x32_bf16 v[84:87], v[8:11], a[184:187], v[84:87]
    v_mfma_f32_16x16x32_bf16 v[92:95], v[8:11], a[188:191], v[92:95]
    s_waitcnt lgkmcnt(3)
    v_mfma_f32_16x16x32_bf16 v[64:67], v[12:15], a[192:195], v[64:67]
    ds_read_b128 v[28:31], v4 offset:11264
    v_mfma_f32_16x16x32_bf16 v[72:75], v[12:15], a[196:199], v[72:75]
    v_mfma_f32_16x16x32_bf16 v[80:83], v[12:15], a[200:203], v[80:83]
    v_mfma_f32_16x16x32_bf16 v[88:91], v[12:15], a[204:207], v[88:91]
    s_waitcnt lgkmcnt(3)
    v_mfma_f32_16x16x32_bf16 v[68:71], v[16:19], a[192:195], v[68:71]
    ds_read_b128 v[8:11], v4 offset:12288
    v_mfma_f32_16x16x32_bf16 v[76:79], v[16:19], a[196:199], v[76:79]
    v_mfma_f32_16x16x32_bf16 v[84:87], v[16:19], a[200:203], v[84:87]
    v_mfma_f32_16x16x32_bf16 v[92:95], v[16:19], a[204:207], v[92:95]
    s_waitcnt lgkmcnt(3)
    v_mfma_f32_16x16x32_bf16 v[96:99], v[20:23], a[64:67], v[96:99]
    ds_read_b128 v[12:15], v4 offset:13312
    v_mfma_f32_16x16x32_bf16 v[104:107], v[20:23], a[68:71], v[104:107]
    v_mfma_f32_16x16x32_bf16 v[112:115], v[20:23], a[72:75], v[112:115]
    v_mfma_f32_16x16x32_bf16 v[120:123], v[20:23], a[76:79], v[120:123]
    s_waitcnt lgkmcnt(3)
    v_cvt_pk_bf16_f32 v64, v64, v65
    v_cvt_pk_bf16_f32 v65, v66, v67
    v_mfma_f32_16x16x32_bf16 v[100:103], v[24:27], a[64:67], v[100:103]
    ds_read_b128 v[16:19], v4 offset:14336
    v_cvt_pk_bf16_f32 v66, v68, v69
    v_mfma_f32_16x16x32_bf16 v[108:111], v[24:27], a[68:71], v[108:111]
    v_cvt_pk_bf16_f32 v67, v70, v71
    v_mfma_f32_16x16x32_bf16 v[116:119], v[24:27], a[72:75], v[116:119]
    s_add_u32 s70, s69, 1024
    v_mfma_f32_16x16x32_bf16 v[124:127], v[24:27], a[76:79], v[124:127]
    s_waitcnt lgkmcnt(3)
    v_mfma_f32_16x16x32_bf16 v[96:99], v[28:31], a[80:83], v[96:99]
    ds_read_b128 v[20:23], v4 offset:15360
    v_mfma_f32_16x16x32_bf16 v[104:107], v[28:31], a[84:87], v[104:107]
    buffer_store_dwordx4 v[64:67], v2, s[4:7], s70 offen sc1
    v_mfma_f32_16x16x32_bf16 v[112:115], v[28:31], a[88:91], v[112:115]
    v_cvt_pk_bf16_f32 v72, v72, v73
    v_cvt_pk_bf16_f32 v73, v74, v75
    v_mfma_f32_16x16x32_bf16 v[120:123], v[28:31], a[92:95], v[120:123]
    s_waitcnt lgkmcnt(3)
    v_cvt_pk_bf16_f32 v74, v76, v77
    v_cvt_pk_bf16_f32 v75, v78, v79
    v_mfma_f32_16x16x32_bf16 v[100:103], v[8:11], a[80:83], v[100:103]
    s_add_u32 s70, s69, 19456
    ds_read_b128 v[24:27], v4 offset:16384
    v_mfma_f32_16x16x32_bf16 v[108:111], v[8:11], a[84:87], v[108:111]
    buffer_store_dwordx4 v[72:75], v2, s[4:7], s70 offen sc1
    v_mfma_f32_16x16x32_bf16 v[116:119], v[8:11], a[88:91], v[116:119]
    v_cvt_pk_bf16_f32 v80, v80, v81
    v_cvt_pk_bf16_f32 v81, v82, v83
    v_mfma_f32_16x16x32_bf16 v[124:127], v[8:11], a[92:95], v[124:127]
    s_waitcnt lgkmcnt(3)
    v_cvt_pk_bf16_f32 v82, v84, v85
    v_cvt_pk_bf16_f32 v83, v86, v87
    v_mfma_f32_16x16x32_bf16 v[96:99], v[12:15], a[96:99], v[96:99]
    s_add_u32 s70, s69, 37888
    ds_read_b128 v[28:31], v4 offset:17408
    v_mfma_f32_16x16x32_bf16 v[104:107], v[12:15], a[100:103], v[104:107]
    buffer_store_dwordx4 v[80:83], v2, s[4:7], s70 offen sc1
    v_mfma_f32_16x16x32_bf16 v[112:115], v[12:15], a[104:107], v[112:115]
    v_cvt_pk_bf16_f32 v88, v88, v89
    v_cvt_pk_bf16_f32 v89, v90, v91
    v_mfma_f32_16x16x32_bf16 v[120:123], v[12:15], a[108:111], v[120:123]
    s_waitcnt lgkmcnt(3)
    v_cvt_pk_bf16_f32 v90, v92, v93
    v_cvt_pk_bf16_f32 v91, v94, v95
    v_mfma_f32_16x16x32_bf16 v[100:103], v[16:19], a[96:99], v[100:103]
    s_add_u32 s70, s69, 56320
    ds_read_b128 v[8:11], v4 offset:18432
    v_mfma_f32_16x16x32_bf16 v[108:111], v[16:19], a[100:103], v[108:111]
    buffer_store_dwordx4 v[88:91], v2, s[4:7], s70 offen sc1
    v_mfma_f32_16x16x32_bf16 v[116:119], v[16:19], a[104:107], v[116:119]
    v_mfma_f32_16x16x32_bf16 v[124:127], v[16:19], a[108:111], v[124:127]
    s_waitcnt lgkmcnt(3)
    v_mfma_f32_16x16x32_bf16 v[96:99], v[20:23], a[112:115], v[96:99]
    ds_read_b128 v[12:15], v4 offset:19456
    v_mfma_f32_16x16x32_bf16 v[104:107], v[20:23], a[116:119], v[104:107]
    v_mfma_f32_16x16x32_bf16 v[112:115], v[20:23], a[120:123], v[112:115]
    v_mfma_f32_16x16x32_bf16 v[120:123], v[20:23], a[124:127], v[120:123]
    s_waitcnt lgkmcnt(3)
    v_mfma_f32_16x16x32_bf16 v[100:103], v[24:27], a[112:115], v[100:103]
    ds_read_b128 v[16:19], v4 offset:20480
    v_mfma_f32_16x16x32_bf16 v[108:111], v[24:27], a[116:119], v[108:111]
    v_mfma_f32_16x16x32_bf16 v[116:119], v[24:27], a[120:123], v[116:119]
    v_mfma_f32_16x16x32_bf16 v[124:127], v[24:27], a[124:127], v[124:127]
    s_waitcnt lgkmcnt(3)
    v_mfma_f32_16x16x32_bf16 v[96:99], v[28:31], a[128:131], v[96:99]
    ds_read_b128 v[20:23], v4 offset:21504
    v_mfma_f32_16x16x32_bf16 v[104:107], v[28:31], a[132:135], v[104:107]
    v_mfma_f32_16x16x32_bf16 v[112:115], v[28:31], a[136:139], v[112:115]
    v_mfma_f32_16x16x32_bf16 v[120:123], v[28:31], a[140:143], v[120:123]
    s_waitcnt lgkmcnt(3)
    v_mfma_f32_16x16x32_bf16 v[100:103], v[8:11], a[128:131], v[100:103]
    ds_read_b128 v[24:27], v4 offset:22528
    v_mfma_f32_16x16x32_bf16 v[108:111], v[8:11], a[132:135], v[108:111]
    v_mfma_f32_16x16x32_bf16 v[116:119], v[8:11], a[136:139], v[116:119]
    v_mfma_f32_16x16x32_bf16 v[124:127], v[8:11], a[140:143], v[124:127]
    s_waitcnt lgkmcnt(3)
    v_mfma_f32_16x16x32_bf16 v[96:99], v[12:15], a[144:147], v[96:99]
    ds_read_b128 v[28:31], v4 offset:23552
    v_mfma_f32_16x16x32_bf16 v[104:107], v[12:15], a[148:151], v[104:107]
    v_mfma_f32_16x16x32_bf16 v[112:115], v[12:15], a[152:155], v[112:115]
    v_mfma_f32_16x16x32_bf16 v[120:123], v[12:15], a[156:159], v[120:123]
    s_waitcnt lgkmcnt(3)
    v_mfma_f32_16x16x32_bf16 v[100:103], v[16:19], a[144:147], v[100:103]
    ds_read_b128 v[8:11], v4 offset:24576
    v_mfma_f32_16x16x32_bf16 v[108:111], v[16:19], a[148:151], v[108:111]
    v_mfma_f32_16x16x32_bf16 v[116:119], v[16:19], a[152:155], v[116:119]
    v_mfma_f32_16x16x32_bf16 v[124:127], v[16:19], a[156:159], v[124:127]
    s_waitcnt lgkmcnt(3)
    v_mfma_f32_16x16x32_bf16 v[96:99], v[20:23], a[160:163], v[96:99]
    ds_read_b128 v[12:15], v4 offset:25600
    v_mfma_f32_16x16x32_bf16 v[104:107], v[20:23], a[164:167], v[104:107]
    v_mfma_f32_16x16x32_bf16 v[112:115], v[20:23], a[168:171], v[112:115]
    v_mfma_f32_16x16x32_bf16 v[120:123], v[20:23], a[172:175], v[120:123]
    s_waitcnt lgkmcnt(3)
    v_mfma_f32_16x16x32_bf16 v[100:103], v[24:27], a[160:163], v[100:103]
    ds_read_b128 v[16:19], v4 offset:26624
    v_mfma_f32_16x16x32_bf16 v[108:111], v[24:27], a[164:167], v[108:111]
    v_mfma_f32_16x16x32_bf16 v[116:119], v[24:27], a[168:171], v[116:119]
    v_mfma_f32_16x16x32_bf16 v[124:127], v[24:27], a[172:175], v[124:127]
    s_waitcnt lgkmcnt(3)
    v_mfma_f32_16x16x32_bf16 v[96:99], v[28:31], a[176:179], v[96:99]
    ds_read_b128 v[20:23], v4 offset:27648
    v_mfma_f32_16x16x32_bf16 v[104:107], v[28:31], a[180:183], v[104:107]
    v_mfma_f32_16x16x32_bf16 v[112:115], v[28:31], a[184:187], v[112:115]
    v_mfma_f32_16x16x32_bf16 v[120:123], v[28:31], a[188:191], v[120:123]
    s_waitcnt lgkmcnt(3)
    v_mfma_f32_16x16x32_bf16 v[100:103], v[8:11], a[176:179], v[100:103]
    ds_read_b128 v[24:27], v4 offset:28672
    v_mfma_f32_16x16x32_bf16 v[108:111], v[8:11], a[180:183], v[108:111]
    v_mfma_f32_16x16x32_bf16 v[116:119], v[8:11], a[184:187], v[116:119]
    v_mfma_f32_16x16x32_bf16 v[124:127], v[8:11], a[188:191], v[124:127]
    s_waitcnt lgkmcnt(3)
    v_mfma_f32_16x16x32_bf16 v[96:99], v[12:15], a[192:195], v[96:99]
    ds_read_b128 v[28:31], v4 offset:29696
    v_mfma_f32_16x16x32_bf16 v[104:107], v[12:15], a[196:199], v[104:107]
    v_mfma_f32_16x16x32_bf16 v[112:115], v[12:15], a[200:203], v[112:115]
    v_mfma_f32_16x16x32_bf16 v[120:123], v[12:15], a[204:207], v[120:123]
    s_waitcnt lgkmcnt(3)
    v_mfma_f32_16x16x32_bf16 v[100:103], v[16:19], a[192:195], v[100:103]
    ds_read_b128 v[8:11], v4 offset:30720
    v_mfma_f32_16x16x32_bf16 v[108:111], v[16:19], a[196:199], v[108:111]
    v_mfma_f32_16x16x32_bf16 v[116:119], v[16:19], a[200:203], v[116:119]
    v_mfma_f32_16x16x32_bf16 v[124:127], v[16:19], a[204:207], v[124:127]
    s_waitcnt lgkmcnt(3)
    v_mfma_f32_16x16x32_bf16 v[128:131], v[20:23], a[64:67], v[128:131]
    ds_read_b128 v[12:15], v4 offset:31744
    v_mfma_f32_16x16x32_bf16 v[136:139], v[20:23], a[68:71], v[136:139]
    v_mfma_f32_16x16x32_bf16 v[144:147], v[20:23], a[72:75], v[144:147]
    v_mfma_f32_16x16x32_bf16 v[152:155], v[20:23], a[76:79], v[152:155]
    s_waitcnt lgkmcnt(3)
    v_cvt_pk_bf16_f32 v96, v96, v97
    v_cvt_pk_bf16_f32 v97, v98, v99
    v_mfma_f32_16x16x32_bf16 v[132:135], v[24:27], a[64:67], v[132:135]
    ds_read_b128 v[16:19], v4 offset:32768
    v_cvt_pk_bf16_f32 v98, v100, v101
    v_mfma_f32_16x16x32_bf16 v[140:143], v[24:27], a[68:71], v[140:143]
    v_cvt_pk_bf16_f32 v99, v102, v103
    v_mfma_f32_16x16x32_bf16 v[148:151], v[24:27], a[72:75], v[148:151]
    s_add_u32 s70, s69, 2048
    v_mfma_f32_16x16x32_bf16 v[156:159], v[24:27], a[76:79], v[156:159]
    s_waitcnt lgkmcnt(3)
    v_mfma_f32_16x16x32_bf16 v[128:131], v[28:31], a[80:83], v[128:131]
    ds_read_b128 v[20:23], v4 offset:33792
    v_mfma_f32_16x16x32_bf16 v[136:139], v[28:31], a[84:87], v[136:139]
    buffer_store_dwordx4 v[96:99], v2, s[4:7], s70 offen sc1
    v_mfma_f32_16x16x32_bf16 v[144:147], v[28:31], a[88:91], v[144:147]
    v_cvt_pk_bf16_f32 v104, v104, v105
    v_cvt_pk_bf16_f32 v105, v106, v107
    v_mfma_f32_16x16x32_bf16 v[152:155], v[28:31], a[92:95], v[152:155]
    s_waitcnt lgkmcnt(3)
    v_cvt_pk_bf16_f32 v106, v108, v109
    v_cvt_pk_bf16_f32 v107, v110, v111
    v_mfma_f32_16x16x32_bf16 v[132:135], v[8:11], a[80:83], v[132:135]
    s_add_u32 s70, s69, 20480
    ds_read_b128 v[24:27], v4 offset:34816
    v_mfma_f32_16x16x32_bf16 v[140:143], v[8:11], a[84:87], v[140:143]
    buffer_store_dwordx4 v[104:107], v2, s[4:7], s70 offen sc1
    v_mfma_f32_16x16x32_bf16 v[148:151], v[8:11], a[88:91], v[148:151]
    v_cvt_pk_bf16_f32 v112, v112, v113
    v_cvt_pk_bf16_f32 v113, v114, v115
    v_mfma_f32_16x16x32_bf16 v[156:159], v[8:11], a[92:95], v[156:159]
    s_waitcnt lgkmcnt(3)
    v_cvt_pk_bf16_f32 v114, v116, v117
    v_cvt_pk_bf16_f32 v115, v118, v119
    v_mfma_f32_16x16x32_bf16 v[128:131], v[12:15], a[96:99], v[128:131]
    s_add_u32 s70, s69, 38912
    ds_read_b128 v[28:31], v4 offset:35840
    v_mfma_f32_16x16x32_bf16 v[136:139], v[12:15], a[100:103], v[136:139]
    buffer_store_dwordx4 v[112:115], v2, s[4:7], s70 offen sc1
    v_mfma_f32_16x16x32_bf16 v[144:147], v[12:15], a[104:107], v[144:147]
    v_cvt_pk_bf16_f32 v120, v120, v121
    v_cvt_pk_bf16_f32 v121, v122, v123
    v_mfma_f32_16x16x32_bf16 v[152:155], v[12:15], a[108:111], v[152:155]
    s_waitcnt lgkmcnt(3)
    v_cvt_pk_bf16_f32 v122, v124, v125
    v_cvt_pk_bf16_f32 v123, v126, v127
    v_mfma_f32_16x16x32_bf16 v[132:135], v[16:19], a[96:99], v[132:135]
    s_waitcnt vmcnt(25)
    s_barrier
    v_add_u32 v4, 0x9000, v4
    v_mfma_f32_16x16x32_bf16 v[140:143], v[16:19], a[100:103], v[140:143]
    s_add_u32 s70, s69, 57344
    s_add_u32 s61, s49, 92160
    ds_read_b128 v[8:11], v4 offset:0
    v_mfma_f32_16x16x32_bf16 v[148:151], v[16:19], a[104:107], v[148:151]
    buffer_store_dwordx4 v[120:123], v2, s[4:7], s70 offen sc1
    v_mfma_f32_16x16x32_bf16 v[156:159], v[16:19], a[108:111], v[156:159]
    s_waitcnt lgkmcnt(3)
    s_add_u32 m0, s61, 18432
    s_add_u32 s61, s61, s62
    v_mfma_f32_16x16x32_bf16 v[128:131], v[20:23], a[112:115], v[128:131]
    ds_read_b128 v[12:15], v4 offset:1024
    v_mfma_f32_16x16x32_bf16 v[136:139], v[20:23], a[116:119], v[136:139]
    v_mfma_f32_16x16x32_bf16 v[144:147], v[20:23], a[120:123], v[144:147]
    buffer_load_dwordx4 v2, s[4:7], s61 offen offset:0 lds
    v_mfma_f32_16x16x32_bf16 v[152:155], v[20:23], a[124:127], v[152:155]
    s_waitcnt lgkmcnt(3)
    v_mfma_f32_16x16x32_bf16 v[132:135], v[24:27], a[112:115], v[132:135]
    ds_read_b128 v[16:19], v4 offset:2048
    v_mfma_f32_16x16x32_bf16 v[140:143], v[24:27], a[116:119], v[140:143]
    v_mfma_f32_16x16x32_bf16 v[148:151], v[24:27], a[120:123], v[148:151]
    buffer_load_dwordx4 v2, s[4:7], s61 offen offset:1024 lds
    v_mfma_f32_16x16x32_bf16 v[156:159], v[24:27], a[124:127], v[156:159]
    s_waitcnt lgkmcnt(3)
    v_mfma_f32_16x16x32_bf16 v[128:131], v[28:31], a[128:131], v[128:131]
    ds_read_b128 v[20:23], v4 offset:3072
    v_mfma_f32_16x16x32_bf16 v[136:139], v[28:31], a[132:135], v[136:139]
    v_mfma_f32_16x16x32_bf16 v[144:147], v[28:31], a[136:139], v[144:147]
    buffer_load_dwordx4 v2, s[4:7], s61 offen offset:2048 lds
    v_mfma_f32_16x16x32_bf16 v[152:155], v[28:31], a[140:143], v[152:155]
    s_waitcnt lgkmcnt(3)
    v_mfma_f32_16x16x32_bf16 v[132:135], v[8:11], a[128:131], v[132:135]
    ds_read_b128 v[24:27], v4 offset:4096
    v_mfma_f32_16x16x32_bf16 v[140:143], v[8:11], a[132:135], v[140:143]
    v_mfma_f32_16x16x32_bf16 v[148:151], v[8:11], a[136:139], v[148:151]
    buffer_load_dwordx4 v2, s[4:7], s61 offen offset:3072 lds
    v_mfma_f32_16x16x32_bf16 v[156:159], v[8:11], a[140:143], v[156:159]
    s_waitcnt lgkmcnt(3)
    s_add_u32 s61, s49, 96256
    s_add_u32 m0, s61, 18432
    v_mfma_f32_16x16x32_bf16 v[128:131], v[12:15], a[144:147], v[128:131]
    s_add_u32 s61, s61, s62
    ds_read_b128 v[28:31], v4 offset:5120
    v_mfma_f32_16x16x32_bf16 v[136:139], v[12:15], a[148:151], v[136:139]
    v_mfma_f32_16x16x32_bf16 v[144:147], v[12:15], a[152:155], v[144:147]
    buffer_load_dwordx4 v2, s[4:7], s61 offen offset:0 lds
    v_mfma_f32_16x16x32_bf16 v[152:155], v[12:15], a[156:159], v[152:155]
    s_waitcnt lgkmcnt(3)
    v_mfma_f32_16x16x32_bf16 v[132:135], v[16:19], a[144:147], v[132:135]
    ds_read_b128 v[8:11], v4 offset:6144
    v_mfma_f32_16x16x32_bf16 v[140:143], v[16:19], a[148:151], v[140:143]
    v_mfma_f32_16x16x32_bf16 v[148:151], v[16:19], a[152:155], v[148:151]
    buffer_load_dwordx4 v2, s[4:7], s61 offen offset:1024 lds
    v_mfma_f32_16x16x32_bf16 v[156:159], v[16:19], a[156:159], v[156:159]
    s_waitcnt lgkmcnt(3)
    v_mfma_f32_16x16x32_bf16 v[128:131], v[20:23], a[160:163], v[128:131]
    ds_read_b128 v[12:15], v4 offset:7168
    v_mfma_f32_16x16x32_bf16 v[136:139], v[20:23], a[164:167], v[136:139]
    v_mfma_f32_16x16x32_bf16 v[144:147], v[20:23], a[168:171], v[144:147]
    buffer_load_dwordx4 v2, s[4:7], s61 offen offset:2048 lds
    v_mfma_f32_16x16x32_bf16 v[152:155], v[20:23], a[172:175], v[152:155]
    s_waitcnt lgkmcnt(3)
    v_mfma_f32_16x16x32_bf16 v[132:135], v[24:27], a[160:163], v[132:135]
    ds_read_b128 v[16:19], v4 offset:8192
    v_mfma_f32_16x16x32_bf16 v[140:143], v[24:27], a[164:167], v[140:143]
    v_mfma_f32_16x16x32_bf16 v[148:151], v[24:27], a[168:171], v[148:151]
    buffer_load_dwordx4 v2, s[4:7], s61 offen offset:3072 lds
    v_mfma_f32_16x16x32_bf16 v[156:159], v[24:27], a[172:175], v[156:159]
    s_waitcnt lgkmcnt(3)
    s_add_u32 s61, s49, 100352
    s_add_u32 m0, s61, 18432
    v_mfma_f32_16x16x32_bf16 v[128:131], v[28:31], a[176:179], v[128:131]
    s_add_u32 s61, s61, s62
    ds_read_b128 v[20:23], v4 offset:9216
    v_mfma_f32_16x16x32_bf16 v[136:139], v[28:31], a[180:183], v[136:139]
    v_mfma_f32_16x16x32_bf16 v[144:147], v[28:31], a[184:187], v[144:147]
    buffer_load_dwordx4 v2, s[4:7], s61 offen offset:0 lds
    v_mfma_f32_16x16x32_bf16 v[152:155], v[28:31], a[188:191], v[152:155]
    s_waitcnt lgkmcnt(3)
    v_mfma_f32_16x16x32_bf16 v[132:135], v[8:11], a[176:179], v[132:135]
    ds_read_b128 v[24:27], v4 offset:10240
    v_mfma_f32_16x16x32_bf16 v[140:143], v[8:11], a[180:183], v[140:143]
    v_mfma_f32_16x16x32_bf16 v[148:151], v[8:11], a[184:187], v[148:151]
    v_mfma_f32_16x16x32_bf16 v[156:159], v[8:11], a[188:191], v[156:159]
    s_waitcnt lgkmcnt(3)
    v_mfma_f32_16x16x32_bf16 v[128:131], v[12:15], a[192:195], v[128:131]
    ds_read_b128 v[28:31], v4 offset:11264
    v_mfma_f32_16x16x32_bf16 v[136:139], v[12:15], a[196:199], v[136:139]
    v_mfma_f32_16x16x32_bf16 v[144:147], v[12:15], a[200:203], v[144:147]
    v_mfma_f32_16x16x32_bf16 v[152:155], v[12:15], a[204:207], v[152:155]
    s_waitcnt lgkmcnt(3)
    v_mfma_f32_16x16x32_bf16 v[132:135], v[16:19], a[192:195], v[132:135]
    ds_read_b128 v[8:11], v4 offset:12288
    v_mfma_f32_16x16x32_bf16 v[140:143], v[16:19], a[196:199], v[140:143]
    v_mfma_f32_16x16x32_bf16 v[148:151], v[16:19], a[200:203], v[148:151]
    v_mfma_f32_16x16x32_bf16 v[156:159], v[16:19], a[204:207], v[156:159]
    s_waitcnt lgkmcnt(3)
    v_mfma_f32_16x16x32_bf16 v[160:163], v[20:23], a[64:67], v[160:163]
    ds_read_b128 v[12:15], v4 offset:13312
    v_mfma_f32_16x16x32_bf16 v[164:167], v[20:23], a[68:71], v[164:167]
    v_mfma_f32_16x16x32_bf16 v[168:171], v[20:23], a[72:75], v[168:171]
    v_mfma_f32_16x16x32_bf16 v[172:175], v[20:23], a[76:79], v[172:175]
    s_waitcnt lgkmcnt(3)
    v_cvt_pk_bf16_f32 v128, v128, v129
    v_cvt_pk_bf16_f32 v129, v130, v131
    v_mfma_f32_16x16x32_bf16 v[160:163], v[24:27], a[80:83], v[160:163]
    ds_read_b128 v[16:19], v4 offset:14336
    v_cvt_pk_bf16_f32 v130, v132, v133
    v_mfma_f32_16x16x32_bf16 v[164:167], v[24:27], a[84:87], v[164:167]
    v_cvt_pk_bf16_f32 v131, v134, v135
    v_mfma_f32_16x16x32_bf16 v[168:171], v[24:27], a[88:91], v[168:171]
    s_add_u32 s70, s69, 3072
    v_mfma_f32_16x16x32_bf16 v[172:175], v[24:27], a[92:95], v[172:175]
    s_waitcnt lgkmcnt(3)
    v_mfma_f32_16x16x32_bf16 v[160:163], v[28:31], a[96:99], v[160:163]
    ds_read_b128 v[20:23], v4 offset:15360
    v_mfma_f32_16x16x32_bf16 v[164:167], v[28:31], a[100:103], v[164:167]
    buffer_store_dwordx4 v[128:131], v2, s[4:7], s70 offen sc1
    v_mfma_f32_16x16x32_bf16 v[168:171], v[28:31], a[104:107], v[168:171]
    v_cvt_pk_bf16_f32 v136, v136, v137
    v_cvt_pk_bf16_f32 v137, v138, v139
    v_mfma_f32_16x16x32_bf16 v[172:175], v[28:31], a[108:111], v[172:175]
    s_waitcnt lgkmcnt(3)
    v_cvt_pk_bf16_f32 v138, v140, v141
    v_cvt_pk_bf16_f32 v139, v142, v143
    v_mfma_f32_16x16x32_bf16 v[160:163], v[8:11], a[112:115], v[160:163]
    s_add_u32 s70, s69, 21504
    ds_read_b128 v[24:27], v4 offset:16384
    v_mfma_f32_16x16x32_bf16 v[164:167], v[8:11], a[116:119], v[164:167]
    buffer_store_dwordx4 v[136:139], v2, s[4:7], s70 offen sc1
    v_mfma_f32_16x16x32_bf16 v[168:171], v[8:11], a[120:123], v[168:171]
    v_cvt_pk_bf16_f32 v144, v144, v145
    v_cvt_pk_bf16_f32 v145, v146, v147
    v_mfma_f32_16x16x32_bf16 v[172:175], v[8:11], a[124:127], v[172:175]
    s_waitcnt lgkmcnt(3)
    v_cvt_pk_bf16_f32 v146, v148, v149
    v_cvt_pk_bf16_f32 v147, v150, v151
    v_mfma_f32_16x16x32_bf16 v[160:163], v[12:15], a[128:131], v[160:163]
    s_add_u32 s70, s69, 39936
    ds_read_b128 v[28:31], v4 offset:17408
    v_mfma_f32_16x16x32_bf16 v[164:167], v[12:15], a[132:135], v[164:167]
    buffer_store_dwordx4 v[144:147], v2, s[4:7], s70 offen sc1
    v_mfma_f32_16x16x32_bf16 v[168:171], v[12:15], a[136:139], v[168:171]
    v_cvt_pk_bf16_f32 v152, v152, v153
    v_cvt_pk_bf16_f32 v153, v154, v155
    v_mfma_f32_16x16x32_bf16 v[172:175], v[12:15], a[140:143], v[172:175]
    s_waitcnt lgkmcnt(3)
    v_cvt_pk_bf16_f32 v154, v156, v157
    v_cvt_pk_bf16_f32 v155, v158, v159
    v_mfma_f32_16x16x32_bf16 v[160:163], v[16:19], a[144:147], v[160:163]
    s_add_u32 s70, s69, 58368
    v_mfma_f32_16x16x32_bf16 v[164:167], v[16:19], a[148:151], v[164:167]
    buffer_store_dwordx4 v[152:155], v2, s[4:7], s70 offen sc1
    v_mfma_f32_16x16x32_bf16 v[168:171], v[16:19], a[152:155], v[168:171]
    v_mfma_f32_16x16x32_bf16 v[172:175], v[16:19], a[156:159], v[172:175]
    s_waitcnt lgkmcnt(2)
    v_mfma_f32_16x16x32_bf16 v[160:163], v[20:23], a[160:163], v[160:163]
    v_mfma_f32_16x16x32_bf16 v[164:167], v[20:23], a[164:167], v[164:167]
    v_mfma_f32_16x16x32_bf16 v[168:171], v[20:23], a[168:171], v[168:171]
    v_mfma_f32_16x16x32_bf16 v[172:175], v[20:23], a[172:175], v[172:175]
    s_waitcnt lgkmcnt(1)
    v_mfma_f32_16x16x32_bf16 v[160:163], v[24:27], a[176:179], v[160:163]
    v_mfma_f32_16x16x32_bf16 v[164:167], v[24:27], a[180:183], v[164:167]
    v_mfma_f32_16x16x32_bf16 v[168:171], v[24:27], a[184:187], v[168:171]
    v_mfma_f32_16x16x32_bf16 v[172:175], v[24:27], a[188:191], v[172:175]
    s_waitcnt lgkmcnt(0)
    v_mfma_f32_16x16x32_bf16 v[160:163], v[28:31], a[192:195], v[160:163]
    v_mfma_f32_16x16x32_bf16 v[164:167], v[28:31], a[196:199], v[164:167]
    v_mfma_f32_16x16x32_bf16 v[168:171], v[28:31], a[200:203], v[168:171]
    v_mfma_f32_16x16x32_bf16 v[172:175], v[28:31], a[204:207], v[172:175]
    s_nop 4
    v_cvt_pk_bf16_f32 v160, v160, v161
    v_cvt_pk_bf16_f32 v161, v162, v163
    s_add_u32 s70, s68, 4096
    buffer_store_dwordx2 v[160:161], v0, s[4:7], s70 offen sc1
    v_cvt_pk_bf16_f32 v164, v164, v165
    v_cvt_pk_bf16_f32 v165, v166, v167
    s_add_u32 s70, s68, 22528
    buffer_store_dwordx2 v[164:165], v0, s[4:7], s70 offen sc1
    v_cvt_pk_bf16_f32 v168, v168, v169
    v_cvt_pk_bf16_f32 v169, v170, v171
    s_add_u32 s70, s68, 40960
    buffer_store_dwordx2 v[168:169], v0, s[4:7], s70 offen sc1
    v_cvt_pk_bf16_f32 v172, v172, v173
    v_cvt_pk_bf16_f32 v173, v174, v175
    s_add_u32 s70, s68, 59392
    buffer_store_dwordx2 v[172:173], v0, s[4:7], s70 offen sc1
    s_lshl_b32 s60, s44, 2
    s_add_u32 s60, s60, s20
    s_lshl_b32 s60, s60, 5
    s_add_u32 s60, s60, s47
    s_lshl_b32 s60, s60, 3
    s_add_u32 s60, s60, s101
    s_add_u32 s60, s60, 4046848
    v_mov_b32 v6, s98
    v_mov_b32 v7, s99
    s_waitcnt vmcnt(0)
    s_mov_b64 exec, 1
    buffer_store_dwordx2 v[6:7], off, s[4:7], s60 sc1
    s_mov_b64 exec, -1
    s_cmp_lg_u32 s101, 0
    s_cbranch_scc1 L_red1_50
    s_barrier
    s_lshl_b32 s47, s21, 5
    s_add_u32 s47, s47, s22
    v_and_b32 v8, 7, v1
    v_lshrrev_b32 v9, 3, v1
    s_lshl_b32 s48, s47, 3
    v_add_u32 v3, s48, v8
    v_mul_u32_u24 v3, 1152, v3
    s_mul_i32 s48, s20, 384
    v_lshl_add_u32 v3, v9, 4, v3
    v_add_u32 v3, s48, v3
    s_lshr_b32 s48, s47, 1
    s_mul_i32 s48, s48, 18432
    s_and_b32 s49, s47, 1
    s_lshl_b32 s49, s49, 7
    s_add_u32 s48, s48, s49
    s_mul_i32 s49, s20, 6144
    s_add_u32 s48, s48, s49
    v_lshlrev_b32 v8, 4, v8
    v_lshl_add_u32 v8, v9, 8, v8
    v_add_u32 v4, s48, v8
    v_lshrrev_b32 v8, 3, v1
    v_and_b32 v9, 7, v1
    s_and_b32 s48, s47, 1
    s_lshl_b32 s48, s48, 3
    v_add_u32 v9, s48, v9
    v_lshlrev_b32 v9, 4, v9
    v_bfe_u32 v10, v8, 1, 1
    v_and_b32 v11, 1, v8
    v_lshl_add_u32 v9, v11, 4, v9
    v_lshl_add_u32 v9, v10, 9, v9
    v_and_b32 v10, 3, v8
    v_lshlrev_b32 v10, 8, v10
    v_sub_u32 v9, v9, v10
    s_mul_i32 s48, s20, 6
    v_lshrrev_b32 v8, 2, v8
    v_add_u32 v8, s48, v8
    v_add_u32 v10, 0, v8
    v_cmp_eq_u32 vcc, 4, v10
    v_cmp_eq_u32 s[56:57], 13, v10
    s_nop 0
    s_or_b64 vcc, vcc, s[56:57]
    v_cndmask_b32 v10, 0, v9, vcc
    v_add3_u32 v5, v4, v10, 0
    v_add_u32 v5, 0, v5
    v_add_u32 v10, 2, v8
    v_cmp_eq_u32 vcc, 4, v10
    v_cmp_eq_u32 s[56:57], 13, v10
    s_nop 0
    s_or_b64 vcc, vcc, s[56:57]
    v_cndmask_b32 v10, 0, v9, vcc
    v_add3_u32 v6, v4, v10, 0
    v_add_u32 v6, 2048, v6
    v_add_u32 v10, 4, v8
    v_cmp_eq_u32 vcc, 4, v10
    v_cmp_eq_u32 s[56:57], 13, v10
    s_nop 0
    s_or_b64 vcc, vcc, s[56:57]
    v_cndmask_b32 v10, 0, v9, vcc
    v_add3_u32 v7, v4, v10, 0
    v_add_u32 v7, 4096, v7
    s_cmp_eq_u32 s20, 3
    s_cbranch_scc1 L_w3a_91
    s_mov_b32 s48, 25690112
    buffer_load_dwordx4 v[16:19], v4, s[4:7], s48 offen offset:0 sc1
    buffer_load_dwordx4 v[52:55], v4, s[4:7], s48 offen offset:2048 sc1
    s_add_u32 s48, s48, 4096
    buffer_load_dwordx4 v[88:91], v4, s[4:7], s48 offen offset:0 sc1
    s_lshr_b32 s49, s47, 3
    s_lshl_b32 s49, s49, 8
    s_add_u32 s49, s49, 4046848
    v_and_b32 v10, 31, v1
    v_lshlrev_b32 v10, 3, v10
    buffer_load_dwordx2 v[8:9], v10, s[4:7], s49 offen sc1
    s_waitcnt vmcnt(0)
    v_cmp_eq_u64 vcc, s[98:99], v[8:9]
    s_nop 0
    s_cmp_eq_u64 vcc, exec
    s_cbranch_scc0 L_pp_slow_92
L_pp_back_93:
    s_mov_b32 s48, 50331648
    buffer_load_dwordx4 v[20:23], v5, s[4:7], s48 offen sc1
    buffer_load_dwordx4 v[56:59], v6, s[4:7], s48 offen sc1
    buffer_load_dwordx4 v[92:95], v7, s[4:7], s48 offen sc1
    s_mov_b32 s48, 52690944
    buffer_load_dwordx4 v[24:27], v5, s[4:7], s48 offen sc1
    buffer_load_dwordx4 v[60:63], v6, s[4:7], s48 offen sc1
    buffer_load_dwordx4 v[96:99], v7, s[4:7], s48 offen sc1
    s_mov_b32 s48, 55050240
    buffer_load_dwordx4 v[28:31], v5, s[4:7], s48 offen sc1
    buffer_load_dwordx4 v[64:67], v6, s[4:7], s48 offen sc1
    buffer_load_dwordx4 v[100:103], v7, s[4:7], s48 offen sc1
    s_mov_b32 s48, 57409536
    buffer_load_dwordx4 v[32:35], v5, s[4:7], s48 offen sc1
    buffer_load_dwordx4 v[68:71], v6, s[4:7], s48 offen sc1
    buffer_load_dwordx4 v[104:107], v7, s[4:7], s48 offen sc1
    s_mov_b32 s48, 59768832
    buffer_load_dwordx4 v[36:39], v5, s[4:7], s48 offen sc1
    buffer_load_dwordx4 v[72:75], v6, s[4:7], s48 offen sc1
    buffer_load_dwordx4 v[108:111], v7, s[4:7], s48 offen sc1
    s_mov_b32 s48, 62128128
    buffer_load_dwordx4 v[40:43], v5, s[4:7], s48 offen sc1
    buffer_load_dwordx4 v[76:79], v6, s[4:7], s48 offen sc1
    buffer_load_dwordx4 v[112:115], v7, s[4:7], s48 offen sc1
    s_mov_b32 s48, 64487424
    buffer_load_dwordx4 v[44:47], v5, s[4:7], s48 offen sc1
    buffer_load_dwordx4 v[80:83], v6, s[4:7], s48 offen sc1
    buffer_load_dwordx4 v[116:119], v7, s[4:7], s48 offen sc1
    s_mov_b32 s48, 66846720
    buffer_load_dwordx4 v[48:51], v5, s[4:7], s48 offen sc1
    buffer_load_dwordx4 v[84:87], v6, s[4:7], s48 offen sc1
    buffer_load_dwordx4 v[120:123], v7, s[4:7], s48 offen sc1
    v_lshlrev_b32 v128, 16, v16
    v_and_b32 v129, 0xffff0000, v16
    v_lshlrev_b32 v130, 16, v17
    v_and_b32 v131, 0xffff0000, v17
    v_lshlrev_b32 v132, 16, v18
    v_and_b32 v133, 0xffff0000, v18
    v_lshlrev_b32 v134, 16, v19
    v_and_b32 v135, 0xffff0000, v19
    v_lshlrev_b32 v136, 16, v52
    v_and_b32 v137, 0xffff0000, v52
    v_lshlrev_b32 v138, 16, v53
    v_and_b32 v139, 0xffff0000, v53
    v_lshlrev_b32 v140, 16, v54
    v_and_b32 v141, 0xffff0000, v54
    v_lshlrev_b32 v142, 16, v55
    v_and_b32 v143, 0xffff0000, v55
    v_lshlrev_b32 v144, 16, v88
    v_and_b32 v145, 0xffff0000, v88
    v_lshlrev_b32 v146, 16, v89
    v_and_b32 v147, 0xffff0000, v89
    v_lshlrev_b32 v148, 16, v90
    v_and_b32 v149, 0xffff0000, v90
    v_lshlrev_b32 v150, 16, v91
    v_and_b32 v151, 0xffff0000, v91
    v_mov_b32 v12, 0x3f80
    v_mov_b32 v13, 0x3f800000
    s_waitcnt vmcnt(23)
    v_dot2c_f32_bf16 v128, v20, v12
    v_dot2c_f32_bf16 v129, v20, v13
    v_dot2c_f32_bf16 v130, v21, v12
    v_dot2c_f32_bf16 v131, v21, v13
    v_dot2c_f32_bf16 v132, v22, v12
    v_dot2c_f32_bf16 v133, v22, v13
    v_dot2c_f32_bf16 v134, v23, v12
    v_dot2c_f32_bf16 v135, v23, v13
    s_waitcnt vmcnt(22)
    v_dot2c_f32_bf16 v136, v56, v12
    v_dot2c_f32_bf16 v137, v56, v13
    v_dot2c_f32_bf16 v138, v57, v12
    v_dot2c_f32_bf16 v139, v57, v13
    v_dot2c_f32_bf16 v140, v58, v12
    v_dot2c_f32_bf16 v141, v58, v13
    v_dot2c_f32_bf16 v142, v59, v12
    v_dot2c_f32_bf16 v143, v59, v13
    s_waitcnt vmcnt(21)
    v_dot2c_f32_bf16 v144, v92, v12
    v_dot2c_f32_bf16 v145, v92, v13
    v_dot2c_f32_bf16 v146, v93, v12
    v_dot2c_f32_bf16 v147, v93, v13
    v_dot2c_f32_bf16 v148, v94, v12
    v_dot2c_f32_bf16 v149, v94, v13
    v_dot2c_f32_bf16 v150, v95, v12
    v_dot2c_f32_bf16 v151, v95, v13
    s_waitcnt vmcnt(20)
    v_dot2c_f32_bf16 v128, v24, v12
    v_dot2c_f32_bf16 v129, v24, v13
    v_dot2c_f32_bf16 v130, v25, v12
    v_dot2c_f32_bf16 v131, v25, v13
    v_dot2c_f32_bf16 v132, v26, v12
    v_dot2c_f32_bf16 v133, v26, v13
    v_dot2c_f32_bf16 v134, v27, v12
    v_dot2c_f32_bf16 v135, v27, v13
    s_waitcnt vmcnt(19)
    v_dot2c_f32_bf16 v136, v60, v12
    v_dot2c_f32_bf16 v137, v60, v13
    v_dot2c_f32_bf16 v138, v61, v12
    v_dot2c_f32_bf16 v139, v61, v13
    v_dot2c_f32_bf16 v140, v62, v12
    v_dot2c_f32_bf16 v141, v62, v13
    v_dot2c_f32_bf16 v142, v63, v12
    v_dot2c_f32_bf16 v143, v63, v13
    s_waitcnt vmcnt(18)
    v_dot2c_f32_bf16 v144, v96, v12
    v_dot2c_f32_bf16 v145, v96, v13
    v_dot2c_f32_bf16 v146, v97, v12
    v_dot2c_f32_bf16 v147, v97, v13
    v_dot2c_f32_bf16 v148, v98, v12
    v_dot2c_f32_bf16 v149, v98, v13
    v_dot2c_f32_bf16 v150, v99, v12
    v_dot2c_f32_bf16 v151, v99, v13
    s_waitcnt vmcnt(17)
    v_dot2c_f32_bf16 v128, v28, v12
    v_dot2c_f32_bf16 v129, v28, v13
    v_dot2c_f32_bf16 v130, v29, v12
    v_dot2c_f32_bf16 v131, v29, v13
    v_dot2c_f32_bf16 v132, v30, v12
    v_dot2c_f32_bf16 v133, v30, v13
    v_dot2c_f32_bf16 v134, v31, v12
    v_dot2c_f32_bf16 v135, v31, v13
    s_waitcnt vmcnt(16)
    v_dot2c_f32_bf16 v136, v64, v12
    v_dot2c_f32_bf16 v137, v64, v13
    v_dot2c_f32_bf16 v138, v65, v12
    v_dot2c_f32_bf16 v139, v65, v13
    v_dot2c_f32_bf16 v140, v66, v12
    v_dot2c_f32_bf16 v141, v66, v13
    v_dot2c_f32_bf16 v142, v67, v12
    v_dot2c_f32_bf16 v143, v67, v13
    s_waitcnt vmcnt(15)
    v_dot2c_f32_bf16 v144, v100, v12
    v_dot2c_f32_bf16 v145, v100, v13
    v_dot2c_f32_bf16 v146, v101, v12
    v_dot2c_f32_bf16 v147, v101, v13
    v_dot2c_f32_bf16 v148, v102, v12
    v_dot2c_f32_bf16 v149, v102, v13
    v_dot2c_f32_bf16 v150, v103, v12
    v_dot2c_f32_bf16 v151, v103, v13
    s_waitcnt vmcnt(14)
    v_dot2c_f32_bf16 v128, v32, v12
    v_dot2c_f32_bf16 v129, v32, v13
    v_dot2c_f32_bf16 v130, v33, v12
    v_dot2c_f32_bf16 v131, v33, v13
    v_dot2c_f32_bf16 v132, v34, v12
    v_dot2c_f32_bf16 v133, v34, v13
    v_dot2c_f32_bf16 v134, v35, v12
    v_dot2c_f32_bf16 v135, v35, v13
    s_waitcnt vmcnt(13)
    v_dot2c_f32_bf16 v136, v68, v12
    v_dot2c_f32_bf16 v137, v68, v13
    v_dot2c_f32_bf16 v138, v69, v12
    v_dot2c_f32_bf16 v139, v69, v13
    v_dot2c_f32_bf16 v140, v70, v12
    v_dot2c_f32_bf16 v141, v70, v13
    v_dot2c_f32_bf16 v142, v71, v12
    v_dot2c_f32_bf16 v143, v71, v13
    s_waitcnt vmcnt(12)
    v_dot2c_f32_bf16 v144, v104, v12
    v_dot2c_f32_bf16 v145, v104, v13
    v_dot2c_f32_bf16 v146, v105, v12
    v_dot2c_f32_bf16 v147, v105, v13
    v_dot2c_f32_bf16 v148, v106, v12
    v_dot2c_f32_bf16 v149, v106, v13
    v_dot2c_f32_bf16 v150, v107, v12
    v_dot2c_f32_bf16 v151, v107, v13
    s_waitcnt vmcnt(11)
    v_dot2c_f32_bf16 v128, v36, v12
    v_dot2c_f32_bf16 v129, v36, v13
    v_dot2c_f32_bf16 v130, v37, v12
    v_dot2c_f32_bf16 v131, v37, v13
    v_dot2c_f32_bf16 v132, v38, v12
    v_dot2c_f32_bf16 v133, v38, v13
    v_dot2c_f32_bf16 v134, v39, v12
    v_dot2c_f32_bf16 v135, v39, v13
    s_waitcnt vmcnt(10)
    v_dot2c_f32_bf16 v136, v72, v12
    v_dot2c_f32_bf16 v137, v72, v13
    v_dot2c_f32_bf16 v138, v73, v12
    v_dot2c_f32_bf16 v139, v73, v13
    v_dot2c_f32_bf16 v140, v74, v12
    v_dot2c_f32_bf16 v141, v74, v13
    v_dot2c_f32_bf16 v142, v75, v12
    v_dot2c_f32_bf16 v143, v75, v13
    s_waitcnt vmcnt(9)
    v_dot2c_f32_bf16 v144, v108, v12
    v_dot2c_f32_bf16 v145, v108, v13
    v_dot2c_f32_bf16 v146, v109, v12
    v_dot2c_f32_bf16 v147, v109, v13
    v_dot2c_f32_bf16 v148, v110, v12
    v_dot2c_f32_bf16 v149, v110, v13
    v_dot2c_f32_bf16 v150, v111, v12
    v_dot2c_f32_bf16 v151, v111, v13
    s_waitcnt vmcnt(8)
    v_dot2c_f32_bf16 v128, v40, v12
    v_dot2c_f32_bf16 v129, v40, v13
    v_dot2c_f32_bf16 v130, v41, v12
    v_dot2c_f32_bf16 v131, v41, v13
    v_dot2c_f32_bf16 v132, v42, v12
    v_dot2c_f32_bf16 v133, v42, v13
    v_dot2c_f32_bf16 v134, v43, v12
    v_dot2c_f32_bf16 v135, v43, v13
    s_waitcnt vmcnt(7)
    v_dot2c_f32_bf16 v136, v76, v12
    v_dot2c_f32_bf16 v137, v76, v13
    v_dot2c_f32_bf16 v138, v77, v12
    v_dot2c_f32_bf16 v139, v77, v13
    v_dot2c_f32_bf16 v140, v78, v12
    v_dot2c_f32_bf16 v141, v78, v13
    v_dot2c_f32_bf16 v142, v79, v12
    v_dot2c_f32_bf16 v143, v79, v13
    s_waitcnt vmcnt(6)
    v_dot2c_f32_bf16 v144, v112, v12
    v_dot2c_f32_bf16 v145, v112, v13
    v_dot2c_f32_bf16 v146, v113, v12
    v_dot2c_f32_bf16 v147, v113, v13
    v_dot2c_f32_bf16 v148, v114, v12
    v_dot2c_f32_bf16 v149, v114, v13
    v_dot2c_f32_bf16 v150, v115, v12
    v_dot2c_f32_bf16 v151, v115, v13
    s_waitcnt vmcnt(5)
    v_dot2c_f32_bf16 v128, v44, v12
    v_dot2c_f32_bf16 v129, v44, v13
    v_dot2c_f32_bf16 v130, v45, v12
    v_dot2c_f32_bf16 v131, v45, v13
    v_dot2c_f32_bf16 v132, v46, v12
    v_dot2c_f32_bf16 v133, v46, v13
    v_dot2c_f32_bf16 v134, v47, v12
    v_dot2c_f32_bf16 v135, v47, v13
    s_waitcnt vmcnt(4)
    v_dot2c_f32_bf16 v136, v80, v12
    v_dot2c_f32_bf16 v137, v80, v13
    v_dot2c_f32_bf16 v138, v81, v12
    v_dot2c_f32_bf16 v139, v81, v13
    v_dot2c_f32_bf16 v140, v82, v12
    v_dot2c_f32_bf16 v141, v82, v13
    v_dot2c_f32_bf16 v142, v83, v12
    v_dot2c_f32_bf16 v143, v83, v13
    s_waitcnt vmcnt(3)
    v_dot2c_f32_bf16 v144, v116, v12
    v_dot2c_f32_bf16 v145, v116, v13
    v_dot2c_f32_bf16 v146, v117, v12
    v_dot2c_f32_bf16 v147, v117, v13
    v_dot2c_f32_bf16 v148, v118, v12
    v_dot2c_f32_bf16 v149, v118, v13
    v_dot2c_f32_bf16 v150, v119, v12
    v_dot2c_f32_bf16 v151, v119, v13
    s_waitcnt vmcnt(2)
    v_dot2c_f32_bf16 v128, v48, v12
    v_dot2c_f32_bf16 v129, v48, v13
    v_dot2c_f32_bf16 v130, v49, v12
    v_dot2c_f32_bf16 v131, v49, v13
    v_dot2c_f32_bf16 v132, v50, v12
    v_dot2c_f32_bf16 v133, v50, v13
    v_dot2c_f32_bf16 v134, v51, v12
    v_dot2c_f32_bf16 v135, v51, v13
    s_waitcnt vmcnt(1)
    v_dot2c_f32_bf16 v136, v84, v12
    v_dot2c_f32_bf16 v137, v84, v13
    v_dot2c_f32_bf16 v138, v85, v12
    v_dot2c_f32_bf16 v139, v85, v13
    v_dot2c_f32_bf16 v140, v86, v12
    v_dot2c_f32_bf16 v141, v86, v13
    v_dot2c_f32_bf16 v142, v87, v12
    v_dot2c_f32_bf16 v143, v87, v13
    s_waitcnt vmcnt(0)
    v_dot2c_f32_bf16 v144, v120, v12
    v_dot2c_f32_bf16 v145, v120, v13
    v_dot2c_f32_bf16 v146, v121, v12
    v_dot2c_f32_bf16 v147, v121, v13
    v_dot2c_f32_bf16 v148, v122, v12
    v_dot2c_f32_bf16 v149, v122, v13
    v_dot2c_f32_bf16 v150, v123, v12
    v_dot2c_f32_bf16 v151, v123, v13
    s_add_u32 s16, s42, 28311552
    s_addc_u32 s17, s43, 0
    s_mov_b32 s18, 0x240000
    s_mov_b32 s19, 0x20000
    v_cvt_pk_bf16_f32 v160, v128, v129
    v_cvt_pk_bf16_f32 v161, v130, v131
    v_cvt_pk_bf16_f32 v162, v132, v133
    v_cvt_pk_bf16_f32 v163, v134, v135
    buffer_store_dwordx4 v[160:163], v3, s[16:19], 0 offen offset:0 sc1
    v_cvt_pk_bf16_f32 v164, v136, v137
    v_cvt_pk_bf16_f32 v165, v138, v139
    v_cvt_pk_bf16_f32 v166, v140, v141
    v_cvt_pk_bf16_f32 v167, v142, v143
    buffer_store_dwordx4 v[164:167], v3, s[16:19], 0 offen offset:128 sc1
    v_cvt_pk_bf16_f32 v168, v144, v145
    v_cvt_pk_bf16_f32 v169, v146, v147
    v_cvt_pk_bf16_f32 v170, v148, v149
    v_cvt_pk_bf16_f32 v171, v150, v151
    buffer_store_dwordx4 v[168:171], v3, s[16:19], 0 offen offset:256 sc1
    v_lshlrev_b32 v128, 16, v160
    v_and_b32 v129, 0xffff0000, v160
    v_lshlrev_b32 v130, 16, v161
    v_and_b32 v131, 0xffff0000, v161
    v_lshlrev_b32 v132, 16, v162
    v_and_b32 v133, 0xffff0000, v162
    v_lshlrev_b32 v134, 16, v163
    v_and_b32 v135, 0xffff0000, v163
    v_lshlrev_b32 v136, 16, v164
    v_and_b32 v137, 0xffff0000, v164
    v_lshlrev_b32 v138, 16, v165
    v_and_b32 v139, 0xffff0000, v165
    v_lshlrev_b32 v140, 16, v166
    v_and_b32 v141, 0xffff0000, v166
    v_lshlrev_b32 v142, 16, v167
    v_and_b32 v143, 0xffff0000, v167
    v_lshlrev_b32 v144, 16, v168
    v_and_b32 v145, 0xffff0000, v168
    v_lshlrev_b32 v146, 16, v169
    v_and_b32 v147, 0xffff0000, v169
    v_lshlrev_b32 v148, 16, v170
    v_and_b32 v149, 0xffff0000, v170
    v_lshlrev_b32 v150, 16, v171
    v_and_b32 v151, 0xffff0000, v171
    v_add_f32 v152, v128, v129
    v_add_f32 v8, v130, v131
    v_add_f32 v152, v152, v132
    v_add_f32 v8, v8, v133
    v_add_f32 v152, v152, v134
    v_add_f32 v8, v8, v135
    v_add_f32 v152, v152, v136
    v_add_f32 v8, v8, v137
    v_add_f32 v152, v152, v138
    v_add_f32 v8, v8, v139
    v_add_f32 v152, v152, v140
    v_add_f32 v8, v8, v141
    v_add_f32 v152, v152, v142
    v_add_f32 v8, v8, v143
    v_add_f32 v152, v152, v144
    v_add_f32 v8, v8, v145
    v_add_f32 v152, v152, v146
    v_add_f32 v8, v8, v147
    v_add_f32 v152, v152, v148
    v_add_f32 v8, v8, v149
    v_add_f32 v152, v152, v150
    v_add_f32 v8, v8, v151
    v_add_f32 v152, v152, v8
    s_nop 1
    v_add_f32_dpp v152, v152, v152 row_ror:8 row_mask:0xf bank_mask:0xf
    v_mov_b32 v8, v152
    s_nop 1
    v_permlane16_swap_b32 v152, v8
    v_add_f32 v152, v152, v8
    v_mov_b32 v8, v152
    s_nop 1
    v_permlane32_swap_b32 v152, v8
    v_add_f32 v152, v152, v8
    v_mul_f32 v9, 0x3baaaaab, v152
    v_sub_f32 v8, v128, v9
    v_mul_f32 v153, v8, v8
    v_sub_f32 v11, v129, v9
    v_fmac_f32 v153, v11, v11
    v_sub_f32 v10, v130, v9
    v_fmac_f32 v153, v10, v10
    v_sub_f32 v11, v131, v9
    v_fmac_f32 v153, v11, v11
    v_sub_f32 v10, v132, v9
    v_fmac_f32 v153, v10, v10
    v_sub_f32 v11, v133, v9
    v_fmac_f32 v153, v11, v11
    v_sub_f32 v10, v134, v9
    v_fmac_f32 v153, v10, v10
    v_sub_f32 v11, v135, v9
    v_fmac_f32 v153, v11, v11
    v_sub_f32 v10, v136, v9
    v_fmac_f32 v153, v10, v10
    v_sub_f32 v11, v137, v9
    v_fmac_f32 v153, v11, v11
    v_sub_f32 v10, v138, v9
    v_fmac_f32 v153, v10, v10
    v_sub_f32 v11, v139, v9
    v_fmac_f32 v153, v11, v11
    v_sub_f32 v10, v140, v9
    v_fmac_f32 v153, v10, v10
    v_sub_f32 v11, v141, v9
    v_fmac_f32 v153, v11, v11
    v_sub_f32 v10, v142, v9
    v_fmac_f32 v153, v10, v10
    v_sub_f32 v11, v143, v9
    v_fmac_f32 v153, v11, v11
    v_sub_f32 v10, v144, v9
    v_fmac_f32 v153, v10, v10
    v_sub_f32 v11, v145, v9
    v_fmac_f32 v153, v11, v11
    v_sub_f32 v10, v146, v9
    v_fmac_f32 v153, v10, v10
    v_sub_f32 v11, v147, v9
    v_fmac_f32 v153, v11, v11
    v_sub_f32 v10, v148, v9
    v_fmac_f32 v153, v10, v10
    v_sub_f32 v11, v149, v9
    v_fmac_f32 v153, v11, v11
    v_sub_f32 v10, v150, v9
    v_fmac_f32 v153, v10, v10
    v_sub_f32 v11, v151, v9
    v_fmac_f32 v153, v11, v11
    s_nop 1
    v_add_f32_dpp v153, v153, v153 row_ror:8 row_mask:0xf bank_mask:0xf
    v_mov_b32 v8, v153
    s_nop 1
    v_permlane16_swap_b32 v153, v8
    v_add_f32 v153, v153, v8
    v_mov_b32 v8, v153
    s_nop 1
    v_permlane32_swap_b32 v153, v8
    v_add_f32 v153, v153, v8
    v_and_b32 v8, 7, v1
    s_mul_i32 s46, s20, 64
    s_add_u32 s46, s46, 160896
    v_lshl_add_u32 v8, v8, 3, s46
    ds_write_b64 v8, v[152:153]
    s_waitcnt lgkmcnt(0)
    s_branch L_join_95
L_w3a_91:
    s_and_b32 s44, s22, 15
    s_mul_i32 s44, s44, 129024
    s_add_u32 s44, s44, 0
    s_mov_b32 m0, 18432
    s_add_u32 s45, s44, 0
    buffer_load_dwordx4 v2, s[4:7], s45 offen offset:0 lds
    buffer_load_dwordx4 v2, s[4:7], s45 offen offset:1024 lds
    buffer_load_dwordx4 v2, s[4:7], s45 offen offset:2048 lds
    buffer_load_dwordx4 v2, s[4:7], s45 offen offset:3072 lds
    s_mov_b32 m0, 22528
    s_add_u32 s45, s44, 4096
    buffer_load_dwordx4 v2, s[4:7], s45 offen offset:0 lds
    buffer_load_dwordx4 v2, s[4:7], s45 offen offset:1024 lds
    buffer_load_dwordx4 v2, s[4:7], s45 offen offset:2048 lds
    buffer_load_dwordx4 v2, s[4:7], s45 offen offset:3072 lds
    s_mov_b32 m0, 26624
    s_add_u32 s45, s44, 8192
    buffer_load_dwordx4 v2, s[4:7], s45 offen offset:0 lds
    buffer_load_dwordx4 v2, s[4:7], s45 offen offset:1024 lds
    buffer_load_dwordx4 v2, s[4:7], s45 offen offset:2048 lds
    buffer_load_dwordx4 v2, s[4:7], s45 offen offset:3072 lds
    s_mov_b32 m0, 30720
    s_add_u32 s45, s44, 12288
    buffer_load_dwordx4 v2, s[4:7], s45 offen offset:0 lds
    buffer_load_dwordx4 v2, s[4:7], s45 offen offset:1024 lds
    buffer_load_dwordx4 v2, s[4:7], s45 offen offset:2048 lds
    buffer_load_dwordx4 v2, s[4:7], s45 offen offset:3072 lds
    s_mov_b32 m0, 34816
    s_add_u32 s45, s44, 16384
    buffer_load_dwordx4 v2, s[4:7], s45 offen offset:0 lds
    buffer_load_dwordx4 v2, s[4:7], s45 offen offset:1024 lds
    buffer_load_dwordx4 v2, s[4:7], s45 offen offset:2048 lds
    buffer_load_dwordx4 v2, s[4:7], s45 offen offset:3072 lds
    s_mov_b32 m0, 38912
    s_add_u32 s45, s44, 20480
    buffer_load_dwordx4 v2, s[4:7], s45 offen offset:0 lds
    buffer_load_dwordx4 v2, s[4:7], s45 offen offset:1024 lds
    buffer_load_dwordx4 v2, s[4:7], s45 offen offset:2048 lds
    buffer_load_dwordx4 v2, s[4:7], s45 offen offset:3072 lds
    s_mov_b32 m0, 43008
    s_add_u32 s45, s44, 24576
    buffer_load_dwordx4 v2, s[4:7], s45 offen offset:0 lds
    buffer_load_dwordx4 v2, s[4:7], s45 offen offset:1024 lds
    buffer_load_dwordx4 v2, s[4:7], s45 offen offset:2048 lds
    buffer_load_dwordx4 v2, s[4:7], s45 offen offset:3072 lds
    s_mov_b32 m0, 47104
    s_add_u32 s45, s44, 28672
    buffer_load_dwordx4 v2, s[4:7], s45 offen offset:0 lds
    buffer_load_dwordx4 v2, s[4:7], s45 offen offset:1024 lds
    buffer_load_dwordx4 v2, s[4:7], s45 offen offset:2048 lds
    buffer_load_dwordx4 v2, s[4:7], s45 offen offset:3072 lds
    s_mov_b32 m0, 51200
    s_add_u32 s45, s44, 32768
    buffer_load_dwordx4 v2, s[4:7], s45 offen offset:0 lds
    buffer_load_dwordx4 v2, s[4:7], s45 offen offset:1024 lds
    buffer_load_dwordx4 v2, s[4:7], s45 offen offset:2048 lds
    buffer_load_dwordx4 v2, s[4:7], s45 offen offset:3072 lds
L_join_95:
    s_barrier
    s_cmp_eq_u32 s20, 3
    s_cbranch_scc1 L_w3b_96
    v_and_b32 v8, 7, v1
    v_lshlrev_b32 v8, 3, v8
    v_add_u32 v8, 160896, v8
    ds_read_b64 v[152:153], v8 offset:0
    ds_read_b64 v[154:155], v8 offset:64
    ds_read_b64 v[156:157], v8 offset:128
    s_waitcnt lgkmcnt(1)
    v_add_f32 v8, v152, v154
    s_waitcnt lgkmcnt(0)
    v_add_f32 v8, v8, v156
    v_mul_f32 v8, 0x3ae38e39, v8
    v_add_f32 v9, v153, v155
    v_add_f32 v9, v9, v157
    v_mul_f32 v10, 0x3baaaaab, v152
    v_sub_f32 v10, v10, v8
    v_mul_f32 v10, v10, v10
    v_fmac_f32 v9, 0x43400000, v10
    v_mul_f32 v10, 0x3baaaaab, v154
    v_sub_f32 v10, v10, v8
    v_mul_f32 v10, v10, v10
    v_fmac_f32 v9, 0x43400000, v10
    v_mul_f32 v10, 0x3baaaaab, v156
    v_sub_f32 v10, v10, v8
    v_mul_f32 v10, v10, v10
    v_fmac_f32 v9, 0x43400000, v10
    v_mul_f32 v9, 0x3ae38e39, v9
    v_cvt_pk_bf16_f32 v9, v9, v9
    v_lshlrev_b32 v9, 16, v9
    v_add_f32 v9, 0x3727c5ac, v9
    v_cvt_pk_bf16_f32 v9, v9, v9
    v_lshlrev_b32 v9, 16, v9
    v_sqrt_f32 v9, v9
    s_nop 0
    v_cvt_pk_bf16_f32 v9, v9, v9
    v_lshlrev_b32 v9, 16, v9
    v_rcp_f32 v9, v9
    v_cvt_pk_bf16_f32 v8, v8, v8
    v_lshlrev_b32 v8, 16, v8
    v_sub_f32 v128, v128, v8
    v_sub_f32 v129, v129, v8
    v_cvt_pk_bf16_f32 v10, v128, v129
    v_lshlrev_b32 v128, 16, v10
    v_and_b32 v129, 0xffff0000, v10
    v_mul_f32 v128, v128, v9
    v_mul_f32 v129, v129, v9
    v_cvt_pk_bf16_f32 v16, v128, v129
    v_sub_f32 v130, v130, v8
    v_sub_f32 v131, v131, v8
    v_cvt_pk_bf16_f32 v10, v130, v131
    v_lshlrev_b32 v130, 16, v10
    v_and_b32 v131, 0xffff0000, v10
    v_mul_f32 v130, v130, v9
    v_mul_f32 v131, v131, v9
    v_cvt_pk_bf16_f32 v17, v130, v131
    v_sub_f32 v132, v132, v8
    v_sub_f32 v133, v133, v8
    v_cvt_pk_bf16_f32 v10, v132, v133
    v_lshlrev_b32 v132, 16, v10
    v_and_b32 v133, 0xffff0000, v10
    v_mul_f32 v132, v132, v9
    v_mul_f32 v133, v133, v9
    v_cvt_pk_bf16_f32 v18, v132, v133
    v_sub_f32 v134, v134, v8
    v_sub_f32 v135, v135, v8
    v_cvt_pk_bf16_f32 v10, v134, v135
    v_lshlrev_b32 v134, 16, v10
    v_and_b32 v135, 0xffff0000, v10
    v_mul_f32 v134, v134, v9
    v_mul_f32 v135, v135, v9
    v_cvt_pk_bf16_f32 v19, v134, v135
    v_sub_f32 v136, v136, v8
    v_sub_f32 v137, v137, v8
    v_cvt_pk_bf16_f32 v10, v136, v137
    v_lshlrev_b32 v136, 16, v10
    v_and_b32 v137, 0xffff0000, v10
    v_mul_f32 v136, v136, v9
    v_mul_f32 v137, v137, v9
    v_cvt_pk_bf16_f32 v20, v136, v137
    v_sub_f32 v138, v138, v8
    v_sub_f32 v139, v139, v8
    v_cvt_pk_bf16_f32 v10, v138, v139
    v_lshlrev_b32 v138, 16, v10
    v_and_b32 v139, 0xffff0000, v10
    v_mul_f32 v138, v138, v9
    v_mul_f32 v139, v139, v9
    v_cvt_pk_bf16_f32 v21, v138, v139
    v_sub_f32 v140, v140, v8
    v_sub_f32 v141, v141, v8
    v_cvt_pk_bf16_f32 v10, v140, v141
    v_lshlrev_b32 v140, 16, v10
    v_and_b32 v141, 0xffff0000, v10
    v_mul_f32 v140, v140, v9
    v_mul_f32 v141, v141, v9
    v_cvt_pk_bf16_f32 v22, v140, v141
    v_sub_f32 v142, v142, v8
    v_sub_f32 v143, v143, v8
    v_cvt_pk_bf16_f32 v10, v142, v143
    v_lshlrev_b32 v142, 16, v10
    v_and_b32 v143, 0xffff0000, v10
    v_mul_f32 v142, v142, v9
    v_mul_f32 v143, v143, v9
    v_cvt_pk_bf16_f32 v23, v142, v143
    v_sub_f32 v144, v144, v8
    v_sub_f32 v145, v145, v8
    v_cvt_pk_bf16_f32 v10, v144, v145
    v_lshlrev_b32 v144, 16, v10
    v_and_b32 v145, 0xffff0000, v10
    v_mul_f32 v144, v144, v9
    v_mul_f32 v145, v145, v9
    v_cvt_pk_bf16_f32 v24, v144, v145
    v_sub_f32 v146, v146, v8
    v_sub_f32 v147, v147, v8
    v_cvt_pk_bf16_f32 v10, v146, v147
    v_lshlrev_b32 v146, 16, v10
    v_and_b32 v147, 0xffff0000, v10
    v_mul_f32 v146, v146, v9
    v_mul_f32 v147, v147, v9
    v_cvt_pk_bf16_f32 v25, v146, v147
    v_sub_f32 v148, v148, v8
    v_sub_f32 v149, v149, v8
    v_cvt_pk_bf16_f32 v10, v148, v149
    v_lshlrev_b32 v148, 16, v10
    v_and_b32 v149, 0xffff0000, v10
    v_mul_f32 v148, v148, v9
    v_mul_f32 v149, v149, v9
    v_cvt_pk_bf16_f32 v26, v148, v149
    v_sub_f32 v150, v150, v8
    v_sub_f32 v151, v151, v8
    v_cvt_pk_bf16_f32 v10, v150, v151
    v_lshlrev_b32 v150, 16, v10
    v_and_b32 v151, 0xffff0000, v10
    v_mul_f32 v150, v150, v9
    v_mul_f32 v151, v151, v9
    v_cvt_pk_bf16_f32 v27, v150, v151
    s_mov_b32 s46, 71303168
    buffer_store_dwordx4 v[16:19], v4, s[4:7], s46 offen offset:0 sc1
    buffer_store_dwordx4 v[20:23], v4, s[4:7], s46 offen offset:2048 sc1
    s_add_u32 s46, s46, 4096
    buffer_store_dwordx4 v[24:27], v4, s[4:7], s46 offen offset:0 sc1
    s_lshl_b32 s46, s47, 2
    s_add_u32 s46, s46, s20
    s_lshl_b32 s46, s46, 3
    s_add_u32 s46, s46, 3940352
    v_mov_b32 v8, s98
    v_mov_b32 v9, s99
    s_waitcnt vmcnt(0)
    s_mov_b64 exec, 1
    buffer_store_dwordx2 v[8:9], off, s[4:7], s46 sc1
    s_mov_b64 exec, -1
L_w3b_96:
    s_lshr_b32 s44, s22, 4
    s_lshl_b32 s52, s21, 1
    s_add_u32 s44, s44, s52
    s_and_b32 s45, s22, 15
    s_mul_i32 s48, s20, 21
    s_lshr_b32 s48, s48, 1
    s_lshl_b32 s48, s48, 10
    s_mul_i32 s47, s45, 129024
    s_add_u32 s47, s47, s48
    s_add_u32 s47, s47, 0
    s_lshl_b32 s46, s44, 3
    s_max_u32 s52, s46, 1
    s_sub_u32 s52, s52, 1
    s_mul_i32 s49, s52, 18432
    s_mul_i32 s50, s20, 9
    s_lshr_b32 s50, s50, 1
    s_lshl_b32 s50, s50, 10
    s_add_u32 s49, s49, s50
    s_add_u32 s49, s49, 71303168
    s_add_u32 s50, s50, 0
    s_lshl_b32 s54, s52, 6
    s_lshl_b32 s52, s20, 1
    s_add_u32 s46, s46, s52
    s_mul_i32 s51, s46, 18432
    s_add_u32 s51, s51, 71303168
    s_lshl_b32 s55, s46, 6
    v_and_b32 v6, 3, v1
    v_min_u32 v6, 2, v6
    v_and_b32 v7, 12, v1
    v_add_lshl_u32 v8, v6, v7, 3
    v_add_u32 v8, s55, v8
    v_and_b32 v7, 4, v1
    v_add_lshl_u32 v9, v6, v7, 3
    v_add_u32 v9, s54, v9
    v_and_b32 v7, 16, v1
    v_cmp_eq_u32 vcc, 0, v7
    s_nop 1
    v_cndmask_b32 v8, v9, v8, vcc
    s_min_u32 s52, s22, 23
    s_mul_i32 s52, s52, 10923
    s_lshr_b32 s52, s52, 16
    s_lshl_b32 s53, s21, 2
    s_add_u32 s52, s52, s53
    s_lshl_b32 s52, s52, 2
    s_add_u32 s52, s52, s20
    s_lshl_b32 s52, s52, 6
    v_and_b32 v7, 4, v1
    v_add_lshl_u32 v7, v6, v7, 3
    v_add_u32 v7, s52, v7
    v_cmp_gt_u32 vcc, 32, v1
    s_nop 1
    v_cndmask_b32 v8, v7, v8, vcc
    s_mov_b32 s52, 3940352
    s_min_u32 s56, s20, 2
    s_add_u32 s57, s56, 2
    s_add_u32 s56, s56, 4
    s_cmp_ge_u32 s20, 2
    s_cselect_b32 s57, 6, s57
    s_lshl_b32 s57, s57, 10
    s_lshl_b32 s56, s56, 10
    v_add_u32 v3, 18432, v2
    v_add_u32 v4, s57, v3
    v_add_u32 v5, s56, v3
    v_add_u32 v10, 0, v2
    s_waitcnt vmcnt(0)
    s_waitcnt vmcnt(0)
    s_barrier
    ds_read_b128 v[88:91], v3 offset:0
    ds_read_b128 v[92:95], v3 offset:1024
    ds_read_b128 v[96:99], v3 offset:2048
    ds_read_b128 v[100:103], v3 offset:3072
    ds_read_b128 v[112:115], v3 offset:6144
    ds_read_b128 v[104:107], v3 offset:4096
    ds_read_b128 v[108:111], v3 offset:5120
    v_mov_b32 v11, v8
    s_mov_b32 s23, s52
    buffer_load_dwordx2 v[12:13], v11, s[4:7], s23 offen sc1
    v_and_b32 v6, 15, v1
    v_lshrrev_b32 v7, 4, v1
    v_lshlrev_b32 v7, 2, v7
    v_sub_u32 v6, v6, v7
    v_mov_b32 v8, 0xf149f2ca
    s_or_b32 s52, s44, s20
    s_cmp_eq_u32 s52, 0
    s_cselect_b64 s[56:57], -1, 0
    v_subrev_u32 v7, 0, v6
    v_and_b32 v9, 0xfffffff1, v7
    v_cmp_eq_u32 vcc, 0, v9
    v_add_u32 v7, 16, v7
    v_and_b32 v9, 0xfffffff1, v7
    v_cndmask_b32_e64 v168, v8, 0, vcc
    v_cmp_eq_u32 vcc, 0, v9
    s_nop 1
    v_cndmask_b32_e64 v172, v8, 0, vcc
    v_cndmask_b32_e64 v176, v172, v8, s[56:57]
    v_subrev_u32 v7, 1, v6
    v_and_b32 v9, 0xfffffff1, v7
    v_cmp_eq_u32 vcc, 0, v9
    v_add_u32 v7, 16, v7
    v_and_b32 v9, 0xfffffff1, v7
    v_cndmask_b32_e64 v169, v8, 0, vcc
    v_cmp_eq_u32 vcc, 0, v9
    s_nop 1
    v_cndmask_b32_e64 v173, v8, 0, vcc
    v_cndmask_b32_e64 v177, v173, v8, s[56:57]
    v_subrev_u32 v7, 2, v6
    v_and_b32 v9, 0xfffffff1, v7
    v_cmp_eq_u32 vcc, 0, v9
    v_add_u32 v7, 16, v7
    v_and_b32 v9, 0xfffffff1, v7
    v_cndmask_b32_e64 v170, v8, 0, vcc
    v_cmp_eq_u32 vcc, 0, v9
    s_nop 1
    v_cndmask_b32_e64 v174, v8, 0, vcc
    v_cndmask_b32_e64 v178, v174, v8, s[56:57]
    v_subrev_u32 v7, 3, v6
    v_and_b32 v9, 0xfffffff1, v7
    v_cmp_eq_u32 vcc, 0, v9
    v_add_u32 v7, 16, v7
    v_and_b32 v9, 0xfffffff1, v7
    v_cndmask_b32_e64 v171, v8, 0, vcc
    v_cmp_eq_u32 vcc, 0, v9
    s_nop 1
    v_cndmask_b32_e64 v175, v8, 0, vcc
    v_cndmask_b32_e64 v179, v175, v8, s[56:57]
    s_mul_i32 s53, s45, 2304
    s_add_u32 s53, s53, s51
    s_waitcnt vmcnt(0)
    v_cmp_eq_u64 vcc, s[98:99], v[12:13]
    s_nop 0
    s_cmp_eq_u64 vcc, exec
    s_cbranch_scc0 L_px_slow_97
L_px_back_98:
    s_add_u32 s54, s51, 0
    buffer_load_dwordx4 a[0:3], v2, s[4:7], s54 offen offset:0 sc1
    s_add_u32 s55, s51, 18432
    buffer_load_dwordx4 a[72:75], v2, s[4:7], s55 offen offset:0 sc1
    buffer_load_dwordx4 a[4:7], v2, s[4:7], s54 offen offset:1024 sc1
    buffer_load_dwordx4 a[76:79], v2, s[4:7], s55 offen offset:1024 sc1
    buffer_load_dwordx4 a[8:11], v2, s[4:7], s54 offen offset:2048 sc1
    buffer_load_dwordx4 a[80:83], v2, s[4:7], s55 offen offset:2048 sc1
    s_waitcnt vmcnt(5) lgkmcnt(6)
    s_add_u32 m0, s50, 0
    s_add_u32 s53, s49, 0
    v_mfma_f32_16x16x32_bf16 v[16:19], v[88:91], a[0:3], 0
    buffer_load_dwordx4 v2, s[4:7], s53 offen offset:0 sc1 lds
    s_waitcnt vmcnt(5)
    v_mfma_f32_16x16x32_bf16 v[48:51], v[88:91], a[72:75], 0
    s_waitcnt lgkmcnt(5)
    ds_read_b128 v[116:119], v3 offset:7168
    ds_read_b128 v[120:123], v3 offset:8192
    v_mfma_f32_16x16x32_bf16 v[20:23], v[92:95], a[0:3], 0
    v_mfma_f32_16x16x32_bf16 v[52:55], v[92:95], a[72:75], 0
    s_waitcnt lgkmcnt(6)
    ds_read_b128 v[124:127], v3 offset:9216
    v_mfma_f32_16x16x32_bf16 v[24:27], v[96:99], a[0:3], 0
    buffer_load_dwordx4 v2, s[4:7], s53 offen offset:1024 sc1 lds
    v_mfma_f32_16x16x32_bf16 v[56:59], v[96:99], a[72:75], 0
    s_waitcnt lgkmcnt(6)
    ds_read_b128 v[128:131], v3 offset:10240
    v_mfma_f32_16x16x32_bf16 v[28:31], v[100:103], a[0:3], 0
    v_mfma_f32_16x16x32_bf16 v[60:63], v[100:103], a[72:75], 0
    buffer_load_dwordx4 v2, s[4:7], s53 offen offset:2048 sc1 lds
    buffer_load_dwordx4 v2, s[4:7], s53 offen offset:3072 sc1 lds
    s_add_u32 m0, s50, 4096
    s_add_u32 s53, s49, 4096
    buffer_load_dwordx4 v2, s[4:7], s53 offen offset:0 sc1 lds
    buffer_load_dwordx4 a[12:15], v2, s[4:7], s54 offen offset:3072 sc1
    buffer_load_dwordx4 a[84:87], v2, s[4:7], s55 offen offset:3072 sc1
    s_waitcnt lgkmcnt(6)
    v_mfma_f32_16x16x32_bf16 v[32:35], v[112:115], a[0:3], 0
    s_add_u32 s54, s51, 4096
    ds_read_b128 v[140:143], v3 offset:13312
    v_mfma_f32_16x16x32_bf16 v[64:67], v[112:115], a[72:75], 0
    ds_read_b128 v[132:135], v3 offset:11264
    v_mfma_f32_16x16x32_bf16 v[44:47], a[0:3], v[112:115], 0
    v_mfma_f32_16x16x32_bf16 v[76:79], a[72:75], v[112:115], 0
    s_waitcnt lgkmcnt(7)
    ds_read_b128 v[136:139], v3 offset:12288
    v_mfma_f32_16x16x32_bf16 v[36:39], a[0:3], v[104:107], 0
    buffer_load_dwordx4 a[16:19], v2, s[4:7], s54 offen offset:0 sc1
    v_mfma_f32_16x16x32_bf16 v[68:71], a[72:75], v[104:107], 0
    s_waitcnt lgkmcnt(7)
    s_add_u32 s55, s51, 22528
    v_mfma_f32_16x16x32_bf16 v[40:43], a[0:3], v[108:111], 0
    v_mfma_f32_16x16x32_bf16 v[72:75], a[72:75], v[108:111], 0
    s_waitcnt vmcnt(11) lgkmcnt(6)
    v_mfma_f32_16x16x32_bf16 v[16:19], v[116:119], a[4:7], v[16:19]
    buffer_load_dwordx4 a[88:91], v2, s[4:7], s55 offen offset:0 sc1
    s_waitcnt vmcnt(11)
    v_mfma_f32_16x16x32_bf16 v[48:51], v[116:119], a[76:79], v[48:51]
    s_waitcnt lgkmcnt(5)
    ds_read_b128 v[88:91], v3 offset:14336
    ds_read_b128 v[92:95], v3 offset:15360
    v_mfma_f32_16x16x32_bf16 v[20:23], v[120:123], a[4:7], v[20:23]
    v_mfma_f32_16x16x32_bf16 v[52:55], v[120:123], a[76:79], v[52:55]
    s_waitcnt lgkmcnt(6)
    ds_read_b128 v[96:99], v3 offset:16384
    v_mfma_f32_16x16x32_bf16 v[24:27], v[124:127], a[4:7], v[24:27]
    buffer_load_dwordx4 a[20:23], v2, s[4:7], s54 offen offset:1024 sc1
    v_mfma_f32_16x16x32_bf16 v[56:59], v[124:127], a[76:79], v[56:59]
    s_waitcnt lgkmcnt(6)
    ds_read_b128 v[100:103], v3 offset:17408
    v_mfma_f32_16x16x32_bf16 v[28:31], v[128:131], a[4:7], v[28:31]
    v_mfma_f32_16x16x32_bf16 v[60:63], v[128:131], a[76:79], v[60:63]
    s_waitcnt lgkmcnt(6)
    ds_read_b128 v[112:115], v3 offset:20480
    v_mfma_f32_16x16x32_bf16 v[32:35], v[140:143], a[4:7], v[32:35]
    buffer_load_dwordx4 a[92:95], v2, s[4:7], s55 offen offset:1024 sc1
    v_mfma_f32_16x16x32_bf16 v[64:67], v[140:143], a[76:79], v[64:67]
    ds_read_b128 v[104:107], v3 offset:18432
    v_mfma_f32_16x16x32_bf16 v[44:47], a[4:7], v[140:143], v[44:47]
    v_mfma_f32_16x16x32_bf16 v[76:79], a[76:79], v[140:143], v[76:79]
    s_waitcnt lgkmcnt(7)
    ds_read_b128 v[108:111], v3 offset:19456
    v_mfma_f32_16x16x32_bf16 v[36:39], a[4:7], v[132:135], v[36:39]
    buffer_load_dwordx4 a[24:27], v2, s[4:7], s54 offen offset:2048 sc1
    v_mfma_f32_16x16x32_bf16 v[68:71], a[76:79], v[132:135], v[68:71]
    s_waitcnt lgkmcnt(7)
    v_mfma_f32_16x16x32_bf16 v[40:43], a[4:7], v[136:139], v[40:43]
    v_mfma_f32_16x16x32_bf16 v[72:75], a[76:79], v[136:139], v[72:75]
    s_waitcnt vmcnt(13) lgkmcnt(6)
    v_mfma_f32_16x16x32_bf16 v[16:19], v[88:91], a[8:11], v[16:19]
    buffer_load_dwordx4 a[96:99], v2, s[4:7], s55 offen offset:2048 sc1
    s_waitcnt vmcnt(13)
    v_mfma_f32_16x16x32_bf16 v[48:51], v[88:91], a[80:83], v[48:51]
    s_waitcnt lgkmcnt(5)
    ds_read_b128 v[116:119], v3 offset:21504
    ds_read_b128 v[120:123], v3 offset:22528
    v_mfma_f32_16x16x32_bf16 v[20:23], v[92:95], a[8:11], v[20:23]
    v_mfma_f32_16x16x32_bf16 v[52:55], v[92:95], a[80:83], v[52:55]
    s_waitcnt lgkmcnt(6)
    ds_read_b128 v[124:127], v3 offset:23552
    v_mfma_f32_16x16x32_bf16 v[24:27], v[96:99], a[8:11], v[24:27]
    buffer_load_dwordx4 a[28:31], v2, s[4:7], s54 offen offset:3072 sc1
    v_mfma_f32_16x16x32_bf16 v[56:59], v[96:99], a[80:83], v[56:59]
    s_waitcnt lgkmcnt(6)
    ds_read_b128 v[128:131], v3 offset:24576
    v_mfma_f32_16x16x32_bf16 v[28:31], v[100:103], a[8:11], v[28:31]
    v_mfma_f32_16x16x32_bf16 v[60:63], v[100:103], a[80:83], v[60:63]
    s_waitcnt lgkmcnt(6)
    ds_read_b128 v[140:143], v3 offset:27648
    v_mfma_f32_16x16x32_bf16 v[32:35], v[112:115], a[8:11], v[32:35]
    buffer_load_dwordx4 a[100:103], v2, s[4:7], s55 offen offset:3072 sc1
    v_mfma_f32_16x16x32_bf16 v[64:67], v[112:115], a[80:83], v[64:67]
    s_add_u32 s54, s51, 8192
    ds_read_b128 v[132:135], v3 offset:25600
    v_mfma_f32_16x16x32_bf16 v[44:47], a[8:11], v[112:115], v[44:47]
    v_mfma_f32_16x16x32_bf16 v[76:79], a[80:83], v[112:115], v[76:79]
    s_waitcnt lgkmcnt(7)
    ds_read_b128 v[136:139], v3 offset:26624
    v_mfma_f32_16x16x32_bf16 v[36:39], a[8:11], v[104:107], v[36:39]
    buffer_load_dwordx4 a[32:35], v2, s[4:7], s54 offen offset:0 sc1
    v_mfma_f32_16x16x32_bf16 v[68:71], a[80:83], v[104:107], v[68:71]
    s_waitcnt lgkmcnt(7)
    s_add_u32 s55, s51, 26624
    v_mfma_f32_16x16x32_bf16 v[40:43], a[8:11], v[108:111], v[40:43]
    v_mfma_f32_16x16x32_bf16 v[72:75], a[80:83], v[108:111], v[72:75]
    s_waitcnt vmcnt(10) lgkmcnt(6)
    v_mfma_f32_16x16x32_bf16 v[16:19], v[116:119], a[12:15], v[16:19]
    buffer_load_dwordx4 a[104:107], v2, s[4:7], s55 offen offset:0 sc1
    s_waitcnt vmcnt(10)
    v_mfma_f32_16x16x32_bf16 v[48:51], v[116:119], a[84:87], v[48:51]
    s_waitcnt lgkmcnt(5)
    ds_read_b128 v[88:91], v3 offset:28672
    ds_read_b128 v[92:95], v3 offset:29696
    v_mfma_f32_16x16x32_bf16 v[20:23], v[120:123], a[12:15], v[20:23]
    v_mfma_f32_16x16x32_bf16 v[52:55], v[120:123], a[84:87], v[52:55]
    s_waitcnt lgkmcnt(6)
    ds_read_b128 v[96:99], v3 offset:30720
    v_mfma_f32_16x16x32_bf16 v[24:27], v[124:127], a[12:15], v[24:27]
    buffer_load_dwordx4 a[36:39], v2, s[4:7], s54 offen offset:1024 sc1
    v_mfma_f32_16x16x32_bf16 v[56:59], v[124:127], a[84:87], v[56:59]
    s_waitcnt lgkmcnt(6)
    ds_read_b128 v[100:103], v3 offset:31744
    v_mfma_f32_16x16x32_bf16 v[28:31], v[128:131], a[12:15], v[28:31]
    v_mfma_f32_16x16x32_bf16 v[60:63], v[128:131], a[84:87], v[60:63]
    s_waitcnt lgkmcnt(6)
    ds_read_b128 v[112:115], v3 offset:34816
    v_mfma_f32_16x16x32_bf16 v[32:35], v[140:143], a[12:15], v[32:35]
    buffer_load_dwordx4 a[108:111], v2, s[4:7], s55 offen offset:1024 sc1
    v_mfma_f32_16x16x32_bf16 v[64:67], v[140:143], a[84:87], v[64:67]
    ds_read_b128 v[104:107], v3 offset:32768
    v_mfma_f32_16x16x32_bf16 v[44:47], a[12:15], v[140:143], v[44:47]
    v_mfma_f32_16x16x32_bf16 v[76:79], a[84:87], v[140:143], v[76:79]
    s_waitcnt lgkmcnt(7)
    ds_read_b128 v[108:111], v3 offset:33792
    v_mfma_f32_16x16x32_bf16 v[36:39], a[12:15], v[132:135], v[36:39]
    buffer_load_dwordx4 a[40:43], v2, s[4:7], s54 offen offset:2048 sc1
    v_mfma_f32_16x16x32_bf16 v[68:71], a[84:87], v[132:135], v[68:71]
    s_waitcnt lgkmcnt(7)
    v_mfma_f32_16x16x32_bf16 v[40:43], a[12:15], v[136:139], v[40:43]
    v_mfma_f32_16x16x32_bf16 v[72:75], a[84:87], v[136:139], v[72:75]
    s_waitcnt vmcnt(12) lgkmcnt(6)
    v_mfma_f32_16x16x32_bf16 v[16:19], v[88:91], a[16:19], v[16:19]
    buffer_load_dwordx4 a[112:115], v2, s[4:7], s55 offen offset:2048 sc1
    s_waitcnt vmcnt(12)
    v_mfma_f32_16x16x32_bf16 v[48:51], v[88:91], a[88:91], v[48:51]
    s_waitcnt lgkmcnt(5)
    ds_read_b128 v[116:119], v3 offset:35840
    ds_read_b128 v[120:123], v3 offset:36864
    v_mfma_f32_16x16x32_bf16 v[20:23], v[92:95], a[16:19], v[20:23]
    v_mfma_f32_16x16x32_bf16 v[52:55], v[92:95], a[88:91], v[52:55]
    s_waitcnt lgkmcnt(6)
    ds_read_b128 v[124:127], v3 offset:37888
    v_mfma_f32_16x16x32_bf16 v[24:27], v[96:99], a[16:19], v[24:27]
    buffer_load_dwordx4 a[44:47], v2, s[4:7], s54 offen offset:3072 sc1
    v_mfma_f32_16x16x32_bf16 v[56:59], v[96:99], a[88:91], v[56:59]
    s_waitcnt lgkmcnt(6)
    ds_read_b128 v[128:131], v3 offset:38912
    v_mfma_f32_16x16x32_bf16 v[28:31], v[100:103], a[16:19], v[28:31]
    v_mfma_f32_16x16x32_bf16 v[60:63], v[100:103], a[88:91], v[60:63]
    s_waitcnt lgkmcnt(6)
    ds_read_b128 v[140:143], v3 offset:41984
    v_mfma_f32_16x16x32_bf16 v[32:35], v[112:115], a[16:19], v[32:35]
    buffer_load_dwordx4 a[116:119], v2, s[4:7], s55 offen offset:3072 sc1
    v_mfma_f32_16x16x32_bf16 v[64:67], v[112:115], a[88:91], v[64:67]
    s_add_u32 s54, s51, 12288
    ds_read_b128 v[132:135], v3 offset:39936
    v_mfma_f32_16x16x32_bf16 v[44:47], a[16:19], v[112:115], v[44:47]
    v_mfma_f32_16x16x32_bf16 v[76:79], a[88:91], v[112:115], v[76:79]
    s_waitcnt lgkmcnt(7)
    ds_read_b128 v[136:139], v3 offset:40960
    v_mfma_f32_16x16x32_bf16 v[36:39], a[16:19], v[104:107], v[36:39]
    buffer_load_dwordx4 a[48:51], v2, s[4:7], s54 offen offset:0 sc1
    v_mfma_f32_16x16x32_bf16 v[68:71], a[88:91], v[104:107], v[68:71]
    s_waitcnt lgkmcnt(7)
    s_add_u32 s55, s51, 30720
    v_mfma_f32_16x16x32_bf16 v[40:43], a[16:19], v[108:111], v[40:43]
    v_mfma_f32_16x16x32_bf16 v[72:75], a[88:91], v[108:111], v[72:75]
    s_waitcnt vmcnt(14) lgkmcnt(6)
    v_mfma_f32_16x16x32_bf16 v[16:19], v[116:119], a[20:23], v[16:19]
    s_waitcnt vmcnt(13)
    s_barrier
    ds_read_b128 v[88:91], v3 offset:43008
    v_mfma_f32_16x16x32_bf16 v[48:51], v[116:119], a[92:95], v[48:51]
    s_waitcnt lgkmcnt(6)
    ds_read_b128 v[92:95], v3 offset:44032
    ds_read_b128 v[144:147], v10 offset:0
    v_mfma_f32_16x16x32_bf16 v[20:23], v[120:123], a[20:23], v[20:23]
    buffer_load_dwordx4 a[120:123], v2, s[4:7], s55 offen offset:0 sc1
    v_mfma_f32_16x16x32_bf16 v[52:55], v[120:123], a[92:95], v[52:55]
    s_waitcnt lgkmcnt(7)
    ds_read_b128 v[96:99], v3 offset:45056
    ds_read_b128 v[148:151], v4 offset:0
    v_mfma_f32_16x16x32_bf16 v[24:27], v[124:127], a[20:23], v[24:27]
    ds_read_b128 v[152:155], v5 offset:0
    ds_read_b128 v[156:159], v10 offset:1024
    v_mfma_f32_16x16x32_bf16 v[56:59], v[124:127], a[92:95], v[56:59]
    s_waitcnt lgkmcnt(10)
    ds_read_b128 v[100:103], v3 offset:46080
    ds_read_b128 v[160:163], v4 offset:7168
    v_mfma_f32_16x16x32_bf16 v[28:31], v[128:131], a[20:23], v[28:31]
    buffer_load_dwordx4 a[52:55], v2, s[4:7], s54 offen offset:1024 sc1
    v_mfma_f32_16x16x32_bf16 v[60:63], v[128:131], a[92:95], v[60:63]
    s_waitcnt lgkmcnt(11)
    ds_read_b128 v[112:115], v3 offset:49152
    ds_read_b128 v[164:167], v5 offset:7168
    v_mfma_f32_16x16x32_bf16 v[32:35], v[140:143], a[20:23], v[32:35]
    v_mfma_f32_16x16x32_bf16 v[64:67], v[140:143], a[92:95], v[64:67]
    ds_read_b128 v[104:107], v3 offset:47104
    v_mfma_f32_16x16x32_bf16 v[44:47], a[20:23], v[140:143], v[44:47]
    buffer_load_dwordx4 a[124:127], v2, s[4:7], s55 offen offset:1024 sc1
    v_mfma_f32_16x16x32_bf16 v[76:79], a[92:95], v[140:143], v[76:79]
    s_waitcnt lgkmcnt(13)
    ds_read_b128 v[108:111], v3 offset:48128
    v_mfma_f32_16x16x32_bf16 v[36:39], a[20:23], v[132:135], v[36:39]
    v_mfma_f32_16x16x32_bf16 v[68:71], a[92:95], v[132:135], v[68:71]
    s_waitcnt lgkmcnt(13)
    v_mfma_f32_16x16x32_bf16 v[40:43], a[20:23], v[136:139], v[40:43]
    buffer_load_dwordx4 a[56:59], v2, s[4:7], s54 offen offset:2048 sc1
    v_mfma_f32_16x16x32_bf16 v[72:75], a[92:95], v[136:139], v[72:75]
    s_waitcnt vmcnt(16) lgkmcnt(12)
    v_mfma_f32_16x16x32_bf16 v[16:19], v[88:91], a[24:27], v[16:19]
    s_waitcnt vmcnt(15)
    ds_read_b128 v[116:119], v3 offset:50176
    v_mfma_f32_16x16x32_bf16 v[48:51], v[88:91], a[96:99], v[48:51]
    s_waitcnt lgkmcnt(12)
    ds_read_b128 v[120:123], v3 offset:51200
    v_mfma_f32_16x16x32_bf16 v[20:23], v[92:95], a[24:27], v[20:23]
    buffer_load_dwordx4 a[128:131], v2, s[4:7], s55 offen offset:2048 sc1
    v_mfma_f32_16x16x32_bf16 v[52:55], v[92:95], a[96:99], v[52:55]
    s_waitcnt lgkmcnt(11)
    ds_read_b128 v[124:127], v3 offset:52224
    v_mfma_f32_16x16x32_bf16 v[24:27], v[96:99], a[24:27], v[24:27]
    v_mfma_f32_16x16x32_bf16 v[56:59], v[96:99], a[96:99], v[56:59]
    s_waitcnt lgkmcnt(8)
    ds_read_b128 v[128:131], v3 offset:53248
    v_mfma_f32_16x16x32_bf16 v[28:31], v[100:103], a[24:27], v[28:31]
    buffer_load_dwordx4 a[60:63], v2, s[4:7], s54 offen offset:3072 sc1
    v_mfma_f32_16x16x32_bf16 v[60:63], v[100:103], a[96:99], v[60:63]
    s_waitcnt lgkmcnt(7)
    ds_read_b128 v[140:143], v3 offset:56320
    v_mfma_f32_16x16x32_bf16 v[32:35], v[112:115], a[24:27], v[32:35]
    v_mfma_f32_16x16x32_bf16 v[64:67], v[112:115], a[96:99], v[64:67]
    ds_read_b128 v[132:135], v3 offset:54272
    v_mfma_f32_16x16x32_bf16 v[44:47], a[24:27], v[112:115], v[44:47]
    buffer_load_dwordx4 a[132:135], v2, s[4:7], s55 offen offset:3072 sc1
    v_mfma_f32_16x16x32_bf16 v[76:79], a[96:99], v[112:115], v[76:79]
    s_waitcnt lgkmcnt(7)
    s_add_u32 s54, s51, 16384
    ds_read_b128 v[136:139], v3 offset:55296
    v_mfma_f32_16x16x32_bf16 v[36:39], a[24:27], v[104:107], v[36:39]
    v_mfma_f32_16x16x32_bf16 v[68:71], a[96:99], v[104:107], v[68:71]
    s_waitcnt lgkmcnt(7)
    v_mfma_f32_16x16x32_bf16 v[40:43], a[24:27], v[108:111], v[40:43]
    buffer_load_dwordx4 a[64:67], v2, s[4:7], s54 offen offset:0 sc1
    v_mfma_f32_16x16x32_bf16 v[72:75], a[96:99], v[108:111], v[72:75]
    s_add_u32 s55, s51, 34816
    v_mfma_f32_16x16x32_bf16 v[80:83], v[148:151], v[144:147], 0
    v_mfma_f32_16x16x32_bf16 v[84:87], v[144:147], v[152:155], 0
    s_waitcnt vmcnt(18) lgkmcnt(6)
    ds_read_b128 v[144:147], v10 offset:2048
    ds_read_b128 v[148:151], v4 offset:14336
    v_mfma_f32_16x16x32_bf16 v[16:19], v[116:119], a[28:31], v[16:19]
    buffer_load_dwordx4 a[136:139], v2, s[4:7], s55 offen offset:0 sc1
    s_waitcnt vmcnt(18)
    v_mfma_f32_16x16x32_bf16 v[48:51], v[116:119], a[100:103], v[48:51]
    s_waitcnt lgkmcnt(7)
    ds_read_b128 v[88:91], v3 offset:57344
    ds_read_b128 v[92:95], v3 offset:58368
    v_mfma_f32_16x16x32_bf16 v[20:23], v[120:123], a[28:31], v[20:23]
    ds_read_b128 v[152:155], v5 offset:14336
    v_mfma_f32_16x16x32_bf16 v[52:55], v[120:123], a[100:103], v[52:55]
    s_waitcnt lgkmcnt(9)
    ds_read_b128 v[96:99], v3 offset:59392
    v_mfma_f32_16x16x32_bf16 v[24:27], v[124:127], a[28:31], v[24:27]
    buffer_load_dwordx4 a[68:71], v2, s[4:7], s54 offen offset:1024 sc1
    v_mfma_f32_16x16x32_bf16 v[56:59], v[124:127], a[100:103], v[56:59]
    s_waitcnt lgkmcnt(9)
    ds_read_b128 v[100:103], v3 offset:60416
    v_mfma_f32_16x16x32_bf16 v[28:31], v[128:131], a[28:31], v[28:31]
    v_mfma_f32_16x16x32_bf16 v[60:63], v[128:131], a[100:103], v[60:63]
    s_waitcnt lgkmcnt(9)
    ds_read_b128 v[112:115], v3 offset:63488
    v_mfma_f32_16x16x32_bf16 v[32:35], v[140:143], a[28:31], v[32:35]
    buffer_load_dwordx4 a[140:143], v2, s[4:7], s55 offen offset:1024 sc1
    v_mfma_f32_16x16x32_bf16 v[64:67], v[140:143], a[100:103], v[64:67]
    s_lshl_b32 s53, s22, 2
    s_add_u32 s53, s53, s20
    s_mul_i32 s53, s53, 5248
    v_mfma_f32_16x16x32_bf16 v[44:47], a[28:31], v[140:143], v[44:47]
    s_add_u32 s53, s53, 2097152
    ds_read_b128 v[104:107], v3 offset:61440
    v_min_u32 v11, 40, v1
    v_mfma_f32_16x16x32_bf16 v[76:79], a[100:103], v[140:143], v[76:79]
    s_waitcnt lgkmcnt(10)
    ds_read_b128 v[108:111], v3 offset:62464
    v_lshlrev_b32 v11, 7, v11
    v_mfma_f32_16x16x32_bf16 v[36:39], a[28:31], v[132:135], v[36:39]
    buffer_load_dword v13, v11, s[4:7], s53 offen
    v_mfma_f32_16x16x32_bf16 v[68:71], a[100:103], v[132:135], v[68:71]
    s_waitcnt lgkmcnt(10)
    s_and_b32 s53, s21, 3
    s_lshl_b32 s53, s53, 3
    v_mfma_f32_16x16x32_bf16 v[40:43], a[28:31], v[136:139], v[40:43]
    s_and_b32 s54, s22, 7
    s_add_u32 s53, s53, s54
    s_mul_i32 s53, s53, 497664
    v_mfma_f32_16x16x32_bf16 v[72:75], a[100:103], v[136:139], v[72:75]
    s_lshr_b32 s54, s22, 3
    s_lshl_b32 s54, s54, 2
    v_mfma_f32_16x16x32_bf16 v[80:83], v[160:163], v[156:159], v[80:83]
    s_add_u32 s54, s54, s20
    s_mul_i32 s54, s54, 9216
    v_mfma_f32_16x16x32_bf16 v[84:87], v[156:159], v[164:167], v[84:87]
    s_waitcnt vmcnt(20) lgkmcnt(7)
    s_add_u32 s53, s53, s54
    s_add_u32 s53, s53, 4194304
    v_mfma_f32_16x16x32_bf16 v[16:19], v[88:91], a[32:35], v[16:19]
    s_waitcnt vmcnt(19)
    ds_read_b128 v[156:159], v10 offset:3072
    v_add_u32 v3, 64512, v3
    v_mfma_f32_16x16x32_bf16 v[48:51], v[88:91], a[104:107], v[48:51]
    s_waitcnt lgkmcnt(7)
    ds_read_b128 v[116:119], v3 offset:0
    ds_read_b128 v[160:163], v4 offset:21504
    v_mfma_f32_16x16x32_bf16 v[20:23], v[92:95], a[32:35], v[20:23]
    ds_read_b128 v[164:167], v5 offset:21504
    v_min_u32 v11, 63, v1
    v_mfma_f32_16x16x32_bf16 v[52:55], v[92:95], a[104:107], v[52:55]
    s_waitcnt lgkmcnt(8)
    ds_read_b128 v[120:123], v3 offset:1024
    v_lshlrev_b32 v11, 7, v11
    v_mfma_f32_16x16x32_bf16 v[24:27], v[96:99], a[32:35], v[24:27]
    buffer_load_dword v14, v11, s[4:7], s53 offen
    v_mfma_f32_16x16x32_bf16 v[56:59], v[96:99], a[104:107], v[56:59]
    s_waitcnt lgkmcnt(8)
    ds_read_b128 v[124:127], v3 offset:2048
    v_add_u32 v11, 1024, v11
    v_mfma_f32_16x16x32_bf16 v[28:31], v[100:103], a[32:35], v[28:31]
    v_mfma_f32_16x16x32_bf16 v[60:63], v[100:103], a[104:107], v[60:63]
    s_waitcnt lgkmcnt(8)
    ds_read_b128 v[128:131], v3 offset:3072
    v_mfma_f32_16x16x32_bf16 v[32:35], v[112:115], a[32:35], v[32:35]
    buffer_load_dword v15, v11, s[4:7], s53 offen
    v_mfma_f32_16x16x32_bf16 v[64:67], v[112:115], a[104:107], v[64:67]
    ds_read_b128 v[140:143], v3 offset:6144
    v_mfma_f32_16x16x32_bf16 v[44:47], a[32:35], v[112:115], v[44:47]
    v_mfma_f32_16x16x32_bf16 v[76:79], a[104:107], v[112:115], v[76:79]
    s_waitcnt lgkmcnt(9)
    ds_read_b128 v[132:135], v3 offset:4096
    v_mfma_f32_16x16x32_bf16 v[36:39], a[32:35], v[104:107], v[36:39]
    v_mfma_f32_16x16x32_bf16 v[68:71], a[104:107], v[104:107], v[68:71]
    s_waitcnt lgkmcnt(9)
    ds_read_b128 v[136:139], v3 offset:5120
    v_mfma_f32_16x16x32_bf16 v[40:43], a[32:35], v[108:111], v[40:43]
    v_mfma_f32_16x16x32_bf16 v[72:75], a[104:107], v[108:111], v[72:75]
    v_mfma_f32_16x16x32_bf16 v[80:83], v[148:151], v[144:147], v[80:83]
    v_mfma_f32_16x16x32_bf16 v[84:87], v[144:147], v[152:155], v[84:87]
    s_waitcnt vmcnt(20) lgkmcnt(8)
    ds_read_b128 v[144:147], v10 offset:4096
    ds_read_b128 v[148:151], v4 offset:28672
    v_mfma_f32_16x16x32_bf16 v[16:19], v[116:119], a[36:39], v[16:19]
    s_waitcnt vmcnt(19)
    ds_read_b128 v[88:91], v3 offset:7168
    ds_read_b128 v[152:155], v5 offset:28672
    v_mfma_f32_16x16x32_bf16 v[48:51], v[116:119], a[108:111], v[48:51]
    s_waitcnt lgkmcnt(9)
    ds_read_b128 v[92:95], v3 offset:8192
    v_mfma_f32_16x16x32_bf16 v[20:23], v[120:123], a[36:39], v[20:23]
    v_mfma_f32_16x16x32_bf16 v[52:55], v[120:123], a[108:111], v[52:55]
    s_waitcnt lgkmcnt(9)
    ds_read_b128 v[96:99], v3 offset:9216
    v_mfma_f32_16x16x32_bf16 v[24:27], v[124:127], a[36:39], v[24:27]
    v_mfma_f32_16x16x32_bf16 v[56:59], v[124:127], a[108:111], v[56:59]
    s_waitcnt lgkmcnt(9)
    ds_read_b128 v[100:103], v3 offset:10240
    v_mfma_f32_16x16x32_bf16 v[28:31], v[128:131], a[36:39], v[28:31]
    v_mfma_f32_16x16x32_bf16 v[60:63], v[128:131], a[108:111], v[60:63]
    s_waitcnt lgkmcnt(9)
    ds_read_b128 v[112:115], v3 offset:13312
    v_mfma_f32_16x16x32_bf16 v[32:35], v[140:143], a[36:39], v[32:35]
    v_mfma_f32_16x16x32_bf16 v[64:67], v[140:143], a[108:111], v[64:67]
    ds_read_b128 v[104:107], v3 offset:11264
    v_mfma_f32_16x16x32_bf16 v[44:47], a[36:39], v[140:143], v[44:47]
    v_mfma_f32_16x16x32_bf16 v[76:79], a[108:111], v[140:143], v[76:79]
    s_waitcnt lgkmcnt(10)
    ds_read_b128 v[108:111], v3 offset:12288
    v_mfma_f32_16x16x32_bf16 v[36:39], a[36:39], v[132:135], v[36:39]
    v_mfma_f32_16x16x32_bf16 v[68:71], a[108:111], v[132:135], v[68:71]
    s_waitcnt lgkmcnt(10)
    v_mfma_f32_16x16x32_bf16 v[40:43], a[36:39], v[136:139], v[40:43]
    v_mfma_f32_16x16x32_bf16 v[72:75], a[108:111], v[136:139], v[72:75]
    v_mfma_f32_16x16x32_bf16 v[80:83], v[160:163], v[156:159], v[80:83]
    v_mfma_f32_16x16x32_bf16 v[84:87], v[156:159], v[164:167], v[84:87]
    s_waitcnt vmcnt(18) lgkmcnt(7)
    ds_read_b128 v[156:159], v10 offset:5120
    ds_read_b128 v[160:163], v4 offset:35840
    v_mfma_f32_16x16x32_bf16 v[16:19], v[88:91], a[40:43], v[16:19]
    s_waitcnt vmcnt(17)
    ds_read_b128 v[116:119], v3 offset:14336
    ds_read_b128 v[164:167], v5 offset:35840
    v_mfma_f32_16x16x32_bf16 v[48:51], v[88:91], a[112:115], v[48:51]
    s_waitcnt lgkmcnt(9)
    ds_read_b128 v[120:123], v3 offset:15360
    v_mfma_f32_16x16x32_bf16 v[20:23], v[92:95], a[40:43], v[20:23]
    v_mfma_f32_16x16x32_bf16 v[52:55], v[92:95], a[112:115], v[52:55]
    s_waitcnt lgkmcnt(9)
    ds_read_b128 v[124:127], v3 offset:16384
    v_mfma_f32_16x16x32_bf16 v[24:27], v[96:99], a[40:43], v[24:27]
    v_mfma_f32_16x16x32_bf16 v[56:59], v[96:99], a[112:115], v[56:59]
    s_waitcnt lgkmcnt(9)
    ds_read_b128 v[128:131], v3 offset:17408
    v_mfma_f32_16x16x32_bf16 v[28:31], v[100:103], a[40:43], v[28:31]
    v_mfma_f32_16x16x32_bf16 v[60:63], v[100:103], a[112:115], v[60:63]
    s_waitcnt lgkmcnt(9)
    ds_read_b128 v[140:143], v3 offset:20480
    v_mfma_f32_16x16x32_bf16 v[32:35], v[112:115], a[40:43], v[32:35]
    v_mfma_f32_16x16x32_bf16 v[64:67], v[112:115], a[112:115], v[64:67]
    ds_read_b128 v[132:135], v3 offset:18432
    v_mfma_f32_16x16x32_bf16 v[44:47], a[40:43], v[112:115], v[44:47]
    v_mfma_f32_16x16x32_bf16 v[76:79], a[112:115], v[112:115], v[76:79]
    s_waitcnt lgkmcnt(10)
    ds_read_b128 v[136:139], v3 offset:19456
    v_mfma_f32_16x16x32_bf16 v[36:39], a[40:43], v[104:107], v[36:39]
    v_mfma_f32_16x16x32_bf16 v[68:71], a[112:115], v[104:107], v[68:71]
    s_waitcnt lgkmcnt(10)
    v_mfma_f32_16x16x32_bf16 v[40:43], a[40:43], v[108:111], v[40:43]
    v_mfma_f32_16x16x32_bf16 v[72:75], a[112:115], v[108:111], v[72:75]
    v_mfma_f32_16x16x32_bf16 v[80:83], v[148:151], v[144:147], v[80:83]
    v_mfma_f32_16x16x32_bf16 v[84:87], v[144:147], v[152:155], v[84:87]
    s_waitcnt vmcnt(16) lgkmcnt(7)
    ds_read_b128 v[144:147], v10 offset:6144
    ds_read_b128 v[148:151], v4 offset:43008
    v_mfma_f32_16x16x32_bf16 v[16:19], v[116:119], a[44:47], v[16:19]
    s_waitcnt vmcnt(15)
    ds_read_b128 v[88:91], v3 offset:21504
    ds_read_b128 v[152:155], v5 offset:43008
    v_mfma_f32_16x16x32_bf16 v[48:51], v[116:119], a[116:119], v[48:51]
    s_waitcnt lgkmcnt(9)
    ds_read_b128 v[92:95], v3 offset:22528
    v_mfma_f32_16x16x32_bf16 v[20:23], v[120:123], a[44:47], v[20:23]
    v_mfma_f32_16x16x32_bf16 v[52:55], v[120:123], a[116:119], v[52:55]
    s_waitcnt lgkmcnt(9)
    ds_read_b128 v[96:99], v3 offset:23552
    v_mfma_f32_16x16x32_bf16 v[24:27], v[124:127], a[44:47], v[24:27]
    v_mfma_f32_16x16x32_bf16 v[56:59], v[124:127], a[116:119], v[56:59]
    s_waitcnt lgkmcnt(9)
    ds_read_b128 v[100:103], v3 offset:24576
    v_mfma_f32_16x16x32_bf16 v[28:31], v[128:131], a[44:47], v[28:31]
    v_mfma_f32_16x16x32_bf16 v[60:63], v[128:131], a[116:119], v[60:63]
    s_waitcnt lgkmcnt(9)
    ds_read_b128 v[112:115], v3 offset:27648
    v_mfma_f32_16x16x32_bf16 v[32:35], v[140:143], a[44:47], v[32:35]
    v_mfma_f32_16x16x32_bf16 v[64:67], v[140:143], a[116:119], v[64:67]
    ds_read_b128 v[104:107], v3 offset:25600
    v_mfma_f32_16x16x32_bf16 v[44:47], a[44:47], v[140:143], v[44:47]
    v_mfma_f32_16x16x32_bf16 v[76:79], a[116:119], v[140:143], v[76:79]
    s_waitcnt lgkmcnt(10)
    ds_read_b128 v[108:111], v3 offset:26624
    v_mfma_f32_16x16x32_bf16 v[36:39], a[44:47], v[132:135], v[36:39]
    v_mfma_f32_16x16x32_bf16 v[68:71], a[116:119], v[132:135], v[68:71]
    s_waitcnt lgkmcnt(10)
    v_mfma_f32_16x16x32_bf16 v[40:43], a[44:47], v[136:139], v[40:43]
    v_mfma_f32_16x16x32_bf16 v[72:75], a[116:119], v[136:139], v[72:75]
    v_mfma_f32_16x16x32_bf16 v[80:83], v[160:163], v[156:159], v[80:83]
    v_mfma_f32_16x16x32_bf16 v[84:87], v[156:159], v[164:167], v[84:87]
    s_waitcnt vmcnt(14) lgkmcnt(7)
    ds_read_b128 v[156:159], v10 offset:7168
    ds_read_b128 v[160:163], v4 offset:50176
    v_mfma_f32_16x16x32_bf16 v[16:19], v[88:91], a[48:51], v[16:19]
    s_waitcnt vmcnt(13)
    ds_read_b128 v[164:167], v5 offset:50176
    ds_read_b128 v[116:119], v3 offset:28672
    v_mfma_f32_16x16x32_bf16 v[48:51], v[88:91], a[120:123], v[48:51]
    s_waitcnt lgkmcnt(9)
    ds_read_b128 v[120:123], v3 offset:29696
    v_mfma_f32_16x16x32_bf16 v[20:23], v[92:95], a[48:51], v[20:23]
    v_mfma_f32_16x16x32_bf16 v[52:55], v[92:95], a[120:123], v[52:55]
    s_waitcnt lgkmcnt(9)
    ds_read_b128 v[124:127], v3 offset:30720
    v_mfma_f32_16x16x32_bf16 v[24:27], v[96:99], a[48:51], v[24:27]
    v_mfma_f32_16x16x32_bf16 v[56:59], v[96:99], a[120:123], v[56:59]
    s_waitcnt lgkmcnt(9)
    ds_read_b128 v[128:131], v3 offset:31744
    v_mfma_f32_16x16x32_bf16 v[28:31], v[100:103], a[48:51], v[28:31]
    v_mfma_f32_16x16x32_bf16 v[60:63], v[100:103], a[120:123], v[60:63]
    ds_read_b128 v[140:143], v3 offset:34816
    v_mfma_f32_16x16x32_bf16 v[80:83], v[148:151], v[144:147], v[80:83]
    v_mfma_f32_16x16x32_bf16 v[84:87], v[144:147], v[152:155], v[84:87]
    s_waitcnt lgkmcnt(10)
    ds_read_b128 v[132:135], v3 offset:32768
    ds_read_b128 v[144:147], v10 offset:8192
    v_mfma_f32_16x16x32_bf16 v[32:35], v[112:115], a[48:51], v[32:35]
    ds_read_b128 v[148:151], v4 offset:57344
    ds_read_b128 v[152:155], v5 offset:57344
    v_mfma_f32_16x16x32_bf16 v[64:67], v[112:115], a[120:123], v[64:67]
    ds_read_b128 v[136:139], v3 offset:33792
    v_mfma_f32_16x16x32_bf16 v[44:47], a[48:51], v[112:115], v[44:47]
    v_mfma_f32_16x16x32_bf16 v[76:79], a[120:123], v[112:115], v[76:79]
    s_waitcnt lgkmcnt(14)
    v_mfma_f32_16x16x32_bf16 v[36:39], a[48:51], v[104:107], v[36:39]
    v_mfma_f32_16x16x32_bf16 v[68:71], a[120:123], v[104:107], v[68:71]
    s_waitcnt lgkmcnt(13)
    v_mfma_f32_16x16x32_bf16 v[40:43], a[48:51], v[108:111], v[40:43]
    v_mfma_f32_16x16x32_bf16 v[72:75], a[120:123], v[108:111], v[72:75]
    s_waitcnt lgkmcnt(11)
    v_mfma_f32_16x16x32_bf16 v[80:83], v[160:163], v[156:159], v[80:83]
    s_waitcnt lgkmcnt(10)
    v_mfma_f32_16x16x32_bf16 v[84:87], v[156:159], v[164:167], v[84:87]
    s_waitcnt vmcnt(12) lgkmcnt(9)
    v_add_u32 v4, 64512, v4
    v_add_u32 v5, 64512, v5
    v_mfma_f32_16x16x32_bf16 v[16:19], v[116:119], a[52:55], v[16:19]
    s_waitcnt vmcnt(11)
    ds_read_b128 v[156:159], v10 offset:9216
    ds_read_b128 v[160:163], v4 offset:0
    v_mfma_f32_16x16x32_bf16 v[48:51], v[116:119], a[124:127], v[48:51]
    s_waitcnt lgkmcnt(10)
    ds_read_b128 v[164:167], v5 offset:0
    ds_read_b128 v[88:91], v3 offset:35840
    v_mfma_f32_16x16x32_bf16 v[20:23], v[120:123], a[52:55], v[20:23]
    ds_read_b128 v[92:95], v3 offset:36864
    v_mfma_f32_16x16x32_bf16 v[52:55], v[120:123], a[124:127], v[52:55]
    s_waitcnt lgkmcnt(12)
    ds_read_b128 v[96:99], v3 offset:37888
    v_mfma_f32_16x16x32_bf16 v[24:27], v[124:127], a[52:55], v[24:27]
    v_mfma_f32_16x16x32_bf16 v[56:59], v[124:127], a[124:127], v[56:59]
    s_waitcnt lgkmcnt(12)
    ds_read_b128 v[100:103], v3 offset:38912
    v_mfma_f32_16x16x32_bf16 v[28:31], v[128:131], a[52:55], v[28:31]
    v_mfma_f32_16x16x32_bf16 v[60:63], v[128:131], a[124:127], v[60:63]
    s_waitcnt lgkmcnt(9)
    ds_read_b128 v[112:115], v3 offset:41984
    v_mfma_f32_16x16x32_bf16 v[80:83], v[148:151], v[144:147], v[80:83]
    s_waitcnt lgkmcnt(9)
    v_mfma_f32_16x16x32_bf16 v[84:87], v[144:147], v[152:155], v[84:87]
    ds_read_b128 v[104:107], v3 offset:39936
    ds_read_b128 v[144:147], v10 offset:10240
    v_mfma_f32_16x16x32_bf16 v[32:35], v[140:143], a[52:55], v[32:35]
    ds_read_b128 v[148:151], v4 offset:7168
    ds_read_b128 v[152:155], v5 offset:7168
    v_mfma_f32_16x16x32_bf16 v[64:67], v[140:143], a[124:127], v[64:67]
    ds_read_b128 v[108:111], v3 offset:40960
    v_mfma_f32_16x16x32_bf16 v[44:47], a[52:55], v[140:143], v[44:47]
    v_mfma_f32_16x16x32_bf16 v[76:79], a[124:127], v[140:143], v[76:79]
    v_mfma_f32_16x16x32_bf16 v[36:39], a[52:55], v[132:135], v[36:39]
    v_mfma_f32_16x16x32_bf16 v[68:71], a[124:127], v[132:135], v[68:71]
    s_waitcnt lgkmcnt(13)
    v_mfma_f32_16x16x32_bf16 v[40:43], a[52:55], v[136:139], v[40:43]
    v_mfma_f32_16x16x32_bf16 v[72:75], a[124:127], v[136:139], v[72:75]
    s_waitcnt lgkmcnt(11)
    v_mfma_f32_16x16x32_bf16 v[80:83], v[160:163], v[156:159], v[80:83]
    s_waitcnt lgkmcnt(10)
    v_mfma_f32_16x16x32_bf16 v[84:87], v[156:159], v[164:167], v[84:87]
    s_waitcnt vmcnt(10) lgkmcnt(9)
    ds_read_b128 v[156:159], v10 offset:11264
    ds_read_b128 v[160:163], v4 offset:14336
    v_mfma_f32_16x16x32_bf16 v[16:19], v[88:91], a[56:59], v[16:19]
    s_waitcnt vmcnt(9)
    ds_read_b128 v[164:167], v5 offset:14336
    ds_read_b128 v[116:119], v3 offset:43008
    v_mfma_f32_16x16x32_bf16 v[48:51], v[88:91], a[128:131], v[48:51]
    s_waitcnt lgkmcnt(12)
    ds_read_b128 v[120:123], v3 offset:44032
    v_mfma_f32_16x16x32_bf16 v[20:23], v[92:95], a[56:59], v[20:23]
    v_mfma_f32_16x16x32_bf16 v[52:55], v[92:95], a[128:131], v[52:55]
    s_waitcnt lgkmcnt(12)
    ds_read_b128 v[124:127], v3 offset:45056
    v_mfma_f32_16x16x32_bf16 v[24:27], v[96:99], a[56:59], v[24:27]
    v_mfma_f32_16x16x32_bf16 v[56:59], v[96:99], a[128:131], v[56:59]
    s_waitcnt lgkmcnt(12)
    ds_read_b128 v[128:131], v3 offset:46080
    v_mfma_f32_16x16x32_bf16 v[28:31], v[100:103], a[56:59], v[28:31]
    v_mfma_f32_16x16x32_bf16 v[60:63], v[100:103], a[128:131], v[60:63]
    s_waitcnt lgkmcnt(9)
    ds_read_b128 v[140:143], v3 offset:49152
    v_mfma_f32_16x16x32_bf16 v[80:83], v[148:151], v[144:147], v[80:83]
    s_waitcnt lgkmcnt(9)
    v_mfma_f32_16x16x32_bf16 v[84:87], v[144:147], v[152:155], v[84:87]
    ds_read_b128 v[132:135], v3 offset:47104
    ds_read_b128 v[144:147], v10 offset:12288
    v_mfma_f32_16x16x32_bf16 v[32:35], v[112:115], a[56:59], v[32:35]
    ds_read_b128 v[148:151], v4 offset:21504
    ds_read_b128 v[152:155], v5 offset:21504
    v_mfma_f32_16x16x32_bf16 v[64:67], v[112:115], a[128:131], v[64:67]
    ds_read_b128 v[136:139], v3 offset:48128
    v_mfma_f32_16x16x32_bf16 v[44:47], a[56:59], v[112:115], v[44:47]
    v_mfma_f32_16x16x32_bf16 v[76:79], a[128:131], v[112:115], v[76:79]
    v_mfma_f32_16x16x32_bf16 v[36:39], a[56:59], v[104:107], v[36:39]
    v_mfma_f32_16x16x32_bf16 v[68:71], a[128:131], v[104:107], v[68:71]
    s_waitcnt lgkmcnt(13)
    v_mfma_f32_16x16x32_bf16 v[40:43], a[56:59], v[108:111], v[40:43]
    v_mfma_f32_16x16x32_bf16 v[72:75], a[128:131], v[108:111], v[72:75]
    s_waitcnt lgkmcnt(11)
    v_mfma_f32_16x16x32_bf16 v[80:83], v[160:163], v[156:159], v[80:83]
    s_waitcnt lgkmcnt(10)
    v_mfma_f32_16x16x32_bf16 v[84:87], v[156:159], v[164:167], v[84:87]
    s_waitcnt vmcnt(8) lgkmcnt(9)
    ds_read_b128 v[156:159], v10 offset:13312
    ds_read_b128 v[160:163], v4 offset:28672
    v_mfma_f32_16x16x32_bf16 v[16:19], v[116:119], a[60:63], v[16:19]
    s_waitcnt vmcnt(7)
    ds_read_b128 v[164:167], v5 offset:28672
    ds_read_b128 v[88:91], v3 offset:50176
    v_mfma_f32_16x16x32_bf16 v[48:51], v[116:119], a[132:135], v[48:51]
    s_waitcnt lgkmcnt(12)
    ds_read_b128 v[92:95], v3 offset:51200
    v_mfma_f32_16x16x32_bf16 v[20:23], v[120:123], a[60:63], v[20:23]
    v_mfma_f32_16x16x32_bf16 v[52:55], v[120:123], a[132:135], v[52:55]
    s_waitcnt lgkmcnt(12)
    ds_read_b128 v[96:99], v3 offset:52224
    v_mfma_f32_16x16x32_bf16 v[24:27], v[124:127], a[60:63], v[24:27]
    v_mfma_f32_16x16x32_bf16 v[56:59], v[124:127], a[132:135], v[56:59]
    s_waitcnt lgkmcnt(12)
    ds_read_b128 v[100:103], v3 offset:53248
    v_mfma_f32_16x16x32_bf16 v[28:31], v[128:131], a[60:63], v[28:31]
    v_mfma_f32_16x16x32_bf16 v[60:63], v[128:131], a[132:135], v[60:63]
    s_waitcnt lgkmcnt(9)
    ds_read_b128 v[112:115], v3 offset:56320
    v_mfma_f32_16x16x32_bf16 v[80:83], v[148:151], v[144:147], v[80:83]
    s_waitcnt lgkmcnt(9)
    v_mfma_f32_16x16x32_bf16 v[84:87], v[144:147], v[152:155], v[84:87]
    ds_read_b128 v[104:107], v3 offset:54272
    ds_read_b128 v[144:147], v10 offset:14336
    v_mfma_f32_16x16x32_bf16 v[32:35], v[140:143], a[60:63], v[32:35]
    ds_read_b128 v[148:151], v4 offset:35840
    ds_read_b128 v[152:155], v5 offset:35840
    v_mfma_f32_16x16x32_bf16 v[64:67], v[140:143], a[132:135], v[64:67]
    ds_read_b128 v[108:111], v3 offset:55296
    v_mfma_f32_16x16x32_bf16 v[44:47], a[60:63], v[140:143], v[44:47]
    v_mfma_f32_16x16x32_bf16 v[76:79], a[132:135], v[140:143], v[76:79]
    v_mfma_f32_16x16x32_bf16 v[36:39], a[60:63], v[132:135], v[36:39]
    v_mfma_f32_16x16x32_bf16 v[68:71], a[132:135], v[132:135], v[68:71]
    s_waitcnt lgkmcnt(13)
    v_mfma_f32_16x16x32_bf16 v[40:43], a[60:63], v[136:139], v[40:43]
    v_mfma_f32_16x16x32_bf16 v[72:75], a[132:135], v[136:139], v[72:75]
    s_waitcnt lgkmcnt(11)
    v_mfma_f32_16x16x32_bf16 v[80:83], v[160:163], v[156:159], v[80:83]
    s_waitcnt lgkmcnt(10)
    v_mfma_f32_16x16x32_bf16 v[84:87], v[156:159], v[164:167], v[84:87]
    s_waitcnt vmcnt(6) lgkmcnt(9)
    ds_read_b128 v[156:159], v10 offset:15360
    ds_read_b128 v[160:163], v4 offset:43008
    v_mfma_f32_16x16x32_bf16 v[16:19], v[88:91], a[64:67], v[16:19]
    s_waitcnt vmcnt(5)
    ds_read_b128 v[164:167], v5 offset:43008
    ds_read_b128 v[116:119], v3 offset:57344
    v_mfma_f32_16x16x32_bf16 v[48:51], v[88:91], a[136:139], v[48:51]
    s_waitcnt lgkmcnt(12)
    ds_read_b128 v[120:123], v3 offset:58368
    v_mfma_f32_16x16x32_bf16 v[20:23], v[92:95], a[64:67], v[20:23]
    v_mfma_f32_16x16x32_bf16 v[52:55], v[92:95], a[136:139], v[52:55]
    s_waitcnt lgkmcnt(12)
    ds_read_b128 v[124:127], v3 offset:59392
    v_mfma_f32_16x16x32_bf16 v[24:27], v[96:99], a[64:67], v[24:27]
    v_mfma_f32_16x16x32_bf16 v[56:59], v[96:99], a[136:139], v[56:59]
    s_waitcnt lgkmcnt(12)
    ds_read_b128 v[128:131], v3 offset:60416
    v_mfma_f32_16x16x32_bf16 v[28:31], v[100:103], a[64:67], v[28:31]
    v_mfma_f32_16x16x32_bf16 v[60:63], v[100:103], a[136:139], v[60:63]
    s_waitcnt lgkmcnt(9)
    ds_read_b128 v[140:143], v3 offset:63488
    v_mfma_f32_16x16x32_bf16 v[80:83], v[148:151], v[144:147], v[80:83]
    s_waitcnt lgkmcnt(9)
    v_mfma_f32_16x16x32_bf16 v[84:87], v[144:147], v[152:155], v[84:87]
    ds_read_b128 v[132:135], v3 offset:61440
    ds_read_b128 v[144:147], v10 offset:16384
    v_mfma_f32_16x16x32_bf16 v[32:35], v[112:115], a[64:67], v[32:35]
    ds_read_b128 v[148:151], v4 offset:50176
    ds_read_b128 v[152:155], v5 offset:50176
    v_mfma_f32_16x16x32_bf16 v[64:67], v[112:115], a[136:139], v[64:67]
    ds_read_b128 v[136:139], v3 offset:62464
    v_mfma_f32_16x16x32_bf16 v[44:47], a[64:67], v[112:115], v[44:47]
    v_mfma_f32_16x16x32_bf16 v[76:79], a[136:139], v[112:115], v[76:79]
    v_mfma_f32_16x16x32_bf16 v[36:39], a[64:67], v[104:107], v[36:39]
    v_mfma_f32_16x16x32_bf16 v[68:71], a[136:139], v[104:107], v[68:71]
    s_waitcnt lgkmcnt(13)
    v_mfma_f32_16x16x32_bf16 v[40:43], a[64:67], v[108:111], v[40:43]
    v_mfma_f32_16x16x32_bf16 v[72:75], a[136:139], v[108:111], v[72:75]
    s_waitcnt lgkmcnt(11)
    v_mfma_f32_16x16x32_bf16 v[80:83], v[160:163], v[156:159], v[80:83]
    s_waitcnt lgkmcnt(10)
    v_mfma_f32_16x16x32_bf16 v[84:87], v[156:159], v[164:167], v[84:87]
    s_waitcnt vmcnt(4) lgkmcnt(9)
    ds_read_b128 v[156:159], v10 offset:17408
    ds_read_b128 v[160:163], v4 offset:57344
    v_mfma_f32_16x16x32_bf16 v[16:19], v[116:119], a[68:71], v[16:19]
    s_waitcnt vmcnt(3)
    ds_read_b128 v[164:167], v5 offset:57344
    v_mfma_f32_16x16x32_bf16 v[48:51], v[116:119], a[140:143], v[48:51]
    s_waitcnt lgkmcnt(11)
    v_mfma_f32_16x16x32_bf16 v[20:23], v[120:123], a[68:71], v[20:23]
    v_mfma_f32_16x16x32_bf16 v[52:55], v[120:123], a[140:143], v[52:55]
    s_waitcnt lgkmcnt(10)
    v_mfma_f32_16x16x32_bf16 v[24:27], v[124:127], a[68:71], v[24:27]
    v_mfma_f32_16x16x32_bf16 v[56:59], v[124:127], a[140:143], v[56:59]
    s_waitcnt lgkmcnt(9)
    v_mfma_f32_16x16x32_bf16 v[28:31], v[128:131], a[68:71], v[28:31]
    v_mfma_f32_16x16x32_bf16 v[60:63], v[128:131], a[140:143], v[60:63]
    s_waitcnt lgkmcnt(5)
    v_mfma_f32_16x16x32_bf16 v[80:83], v[148:151], v[144:147], v[80:83]
    s_waitcnt lgkmcnt(4)
    v_mfma_f32_16x16x32_bf16 v[84:87], v[144:147], v[152:155], v[84:87]
    v_mfma_f32_16x16x32_bf16 v[32:35], v[140:143], a[68:71], v[32:35]
    v_mfma_f32_16x16x32_bf16 v[64:67], v[140:143], a[140:143], v[64:67]
    v_mfma_f32_16x16x32_bf16 v[44:47], a[68:71], v[140:143], v[44:47]
    v_mfma_f32_16x16x32_bf16 v[76:79], a[140:143], v[140:143], v[76:79]
    v_mfma_f32_16x16x32_bf16 v[36:39], a[68:71], v[132:135], v[36:39]
    v_mfma_f32_16x16x32_bf16 v[68:71], a[140:143], v[132:135], v[68:71]
    s_waitcnt lgkmcnt(3)
    v_mfma_f32_16x16x32_bf16 v[40:43], a[68:71], v[136:139], v[40:43]
    v_mfma_f32_16x16x32_bf16 v[72:75], a[140:143], v[136:139], v[72:75]
    s_waitcnt lgkmcnt(1)
    v_mfma_f32_16x16x32_bf16 v[80:83], v[160:163], v[156:159], v[80:83]
    s_waitcnt lgkmcnt(0)
    v_mfma_f32_16x16x32_bf16 v[84:87], v[156:159], v[164:167], v[84:87]
    v_lshlrev_b32 v6, 3, v1
    v_add_u32 v6, 148608, v6
    s_mul_i32 s52, s20, 3072
    v_add_u32 v7, s52, v6
    v_cvt_pk_bf16_f32 v100, v56, v57
    v_cvt_pk_bf16_f32 v101, v58, v59
    v_cvt_pk_bf16_f32 v104, v60, v61
    v_cvt_pk_bf16_f32 v105, v62, v63
    v_cvt_pk_bf16_f32 v134, v64, v65
    v_cvt_pk_bf16_f32 v137, v66, v67
    v_mov_b32 v102, 0
    v_mov_b32 v103, 0
    v_cvt_pk_bf16_f32 v110, v68, v69
    v_cvt_pk_bf16_f32 v111, v70, v71
    v_cvt_pk_bf16_f32 v116, v72, v73
    v_cvt_pk_bf16_f32 v117, v74, v75
    v_cvt_pk_bf16_f32 v122, v76, v77
    v_cvt_pk_bf16_f32 v123, v78, v79
    v_permlane32_swap_b32 v134, v102
    v_permlane32_swap_b32 v137, v103
    s_cmp_eq_u32 s20, 3
    s_cbranch_scc1 L_w3_100
    ds_write_b64 v7, v[100:101] offset:3072
    ds_write_b64 v7, v[102:103] offset:3584
    ds_write_b64 v7, v[104:105] offset:4096
    ds_write_b64 v7, v[110:111] offset:4608
    ds_write_b64 v7, v[116:117] offset:5120
    ds_write_b64 v7, v[122:123] offset:5632
L_w3_100:
    v_cvt_pk_bf16_f32 v140, v80, v81
    v_cvt_pk_bf16_f32 v141, v82, v83
    v_cvt_pk_bf16_f32 v142, v84, v85
    v_cvt_pk_bf16_f32 v143, v86, v87
    s_min_u32 s52, s20, 2
    s_lshl_b32 s53, s52, 1
    s_cmp_ge_u32 s20, 2
    s_cselect_b32 s53, 1, s53
    s_lshl_b32 s53, s53, 9
    s_add_u32 s52, s52, 3
    s_lshl_b32 s52, s52, 9
    v_add_u32 v8, s53, v6
    v_add_u32 v9, s52, v6
    s_cmp_lt_u32 s20, 2
    s_cbranch_scc1 L_noswap_101
    v_mov_b32 v10, 0
    v_mov_b32 v11, 0
    s_nop 1
    v_permlane32_swap_b32 v140, v10
    v_permlane32_swap_b32 v141, v11
    v_mov_b32 v140, v10
    v_mov_b32 v141, v11
L_noswap_101:
    ds_write_b64 v8, v[140:141]
    ds_write_b64 v9, v[142:143]
    v_cvt_pk_bf16_f32 v132, v48, v49
    v_cvt_pk_bf16_f32 v133, v50, v51
    v_cvt_pk_bf16_f32 v138, v52, v53
    v_cvt_pk_bf16_f32 v139, v54, v55
    v_mov_b32 v135, 0
    v_mov_b32 v136, 0
    v_cvt_pk_bf16_f32 v94, v24, v25
    v_cvt_pk_bf16_f32 v95, v26, v27
    v_cvt_pk_bf16_f32 v98, v28, v29
    v_cvt_pk_bf16_f32 v99, v30, v31
    v_cvt_pk_bf16_f32 v126, v32, v33
    v_cvt_pk_bf16_f32 v129, v34, v35
    v_mov_b32 v96, 0
    v_mov_b32 v97, 0
    v_cvt_pk_bf16_f32 v108, v36, v37
    v_cvt_pk_bf16_f32 v109, v38, v39
    v_cvt_pk_bf16_f32 v114, v40, v41
    v_cvt_pk_bf16_f32 v115, v42, v43
    v_cvt_pk_bf16_f32 v120, v44, v45
    v_cvt_pk_bf16_f32 v121, v46, v47
    v_permlane32_swap_b32 v126, v96
    v_permlane32_swap_b32 v129, v97
    v_cvt_pk_bf16_f32 v124, v16, v17
    v_cvt_pk_bf16_f32 v125, v18, v19
    v_cvt_pk_bf16_f32 v130, v20, v21
    v_cvt_pk_bf16_f32 v131, v22, v23
    v_mov_b32 v127, 0
    v_mov_b32 v128, 0
    v_mov_b32 v12, 0x3f803f80
    s_waitcnt vmcnt(2)
    v_mov_b32 v13, 0x3f803f80
    s_waitcnt vmcnt(1)
    v_mov_b32 v14, 0x3f803f80
    s_waitcnt vmcnt(0)
    v_mov_b32 v15, 0x3f803f80
    v_mfma_f32_16x16x32_bf16 v[32:35], v[94:97], v[132:135], v[172:175]
    v_mfma_f32_16x16x32_bf16 v[36:39], v[100:103], v[132:135], v[168:171]
    v_mfma_f32_16x16x32_bf16 v[20:23], v[94:97], v[124:127], v[168:171]
    v_mfma_f32_16x16x32_bf16 v[40:43], v[96:99], v[136:139], v[172:175]
    v_mfma_f32_16x16x32_bf16 v[44:47], v[102:105], v[136:139], v[168:171]
    v_mfma_f32_16x16x32_bf16 v[28:31], v[96:99], v[128:131], v[168:171]
    s_waitcnt lgkmcnt(0)
    s_barrier
    ds_read_b64 v[88:89], v7 offset:0
    ds_read_b64 v[90:91], v7 offset:512
    ds_read_b64 v[92:93], v7 offset:1024
    ds_read_b64 v[106:107], v7 offset:1536
    ds_read_b64 v[112:113], v7 offset:2048
    ds_read_b64 v[118:119], v7 offset:2560
    s_mov_b32 s52, 0x3eae1a93
    s_waitcnt lgkmcnt(4)
    v_mfma_f32_16x16x32_bf16 v[16:19], v[88:91], v[124:127], v[176:179]
    s_waitcnt lgkmcnt(3)
    v_mfma_f32_16x16x32_bf16 v[24:27], v[90:93], v[128:131], v[176:179]
    v_max3_f32 v48, v32, v33, v34
    v_max3_f32 v49, v40, v41, v42
    s_nop 3
    v_max3_f32 v50, v16, v17, v18
    s_nop 0
    v_max3_f32 v51, v24, v25, v26
    v_max3_f32 v48, v48, v35, v36
    v_max3_f32 v49, v49, v43, v44
    v_max3_f32 v50, v50, v19, v20
    v_max3_f32 v51, v51, v27, v28
    v_max3_f32 v48, v48, v37, v38
    v_max3_f32 v49, v49, v45, v46
    v_max3_f32 v50, v50, v21, v22
    v_max3_f32 v51, v51, v29, v30
    v_max_f32 v48, v48, v39
    v_max_f32 v49, v49, v47
    v_max_f32 v50, v50, v23
    v_max_f32 v51, v51, v31
    v_mov_b32 v52, v48
    v_mov_b32 v53, v49
    v_mov_b32 v54, v50
    v_mov_b32 v55, v51
    v_permlane16_swap_b32 v48, v52
    v_permlane16_swap_b32 v49, v53
    v_permlane16_swap_b32 v50, v54
    v_permlane16_swap_b32 v51, v55
    v_max_f32 v48, v48, v52
    v_max_f32 v49, v49, v53
    v_max_f32 v50, v50, v54
    v_max_f32 v51, v51, v55
    v_mov_b32 v52, v48
    v_mov_b32 v53, v49
    v_mov_b32 v54, v50
    v_mov_b32 v55, v51
    v_permlane32_swap_b32 v48, v52
    v_permlane32_swap_b32 v49, v53
    v_permlane32_swap_b32 v50, v54
    v_permlane32_swap_b32 v51, v55
    v_max_f32 v48, v48, v52
    v_max_f32 v49, v49, v53
    v_max_f32 v50, v50, v54
    v_max_f32 v51, v51, v55
    v_mul_f32 v48, s52, v48
    v_mul_f32 v49, s52, v49
    v_mul_f32 v50, s52, v50
    v_mul_f32 v51, s52, v51
    v_fma_f32 v32, v32, s52, -v48
    v_fma_f32 v40, v40, s52, -v49
    v_fma_f32 v16, v16, s52, -v50
    v_fma_f32 v24, v24, s52, -v51
    v_fma_f32 v33, v33, s52, -v48
    v_fma_f32 v41, v41, s52, -v49
    v_fma_f32 v17, v17, s52, -v50
    v_fma_f32 v25, v25, s52, -v51
    v_fma_f32 v34, v34, s52, -v48
    v_fma_f32 v42, v42, s52, -v49
    v_fma_f32 v18, v18, s52, -v50
    v_fma_f32 v26, v26, s52, -v51
    v_fma_f32 v35, v35, s52, -v48
    v_fma_f32 v43, v43, s52, -v49
    v_fma_f32 v19, v19, s52, -v50
    v_fma_f32 v27, v27, s52, -v51
    v_fma_f32 v36, v36, s52, -v48
    v_fma_f32 v44, v44, s52, -v49
    v_fma_f32 v20, v20, s52, -v50
    v_fma_f32 v28, v28, s52, -v51
    v_fma_f32 v37, v37, s52, -v48
    v_fma_f32 v45, v45, s52, -v49
    v_fma_f32 v21, v21, s52, -v50
    v_fma_f32 v29, v29, s52, -v51
    v_fma_f32 v38, v38, s52, -v48
    v_fma_f32 v46, v46, s52, -v49
    v_fma_f32 v22, v22, s52, -v50
    v_fma_f32 v30, v30, s52, -v51
    v_fma_f32 v39, v39, s52, -v48
    v_fma_f32 v47, v47, s52, -v49
    v_fma_f32 v23, v23, s52, -v50
    v_fma_f32 v31, v31, s52, -v51
    v_exp_f32 v32, v32
    v_exp_f32 v40, v40
    v_exp_f32 v16, v16
    v_exp_f32 v24, v24
    v_exp_f32 v33, v33
    v_exp_f32 v41, v41
    v_exp_f32 v17, v17
    v_exp_f32 v25, v25
    v_exp_f32 v34, v34
    v_exp_f32 v42, v42
    v_exp_f32 v18, v18
    v_exp_f32 v26, v26
    v_exp_f32 v35, v35
    v_exp_f32 v43, v43
    v_exp_f32 v19, v19
    v_exp_f32 v27, v27
    v_exp_f32 v36, v36
    v_exp_f32 v44, v44
    v_exp_f32 v20, v20
    v_exp_f32 v28, v28
    v_exp_f32 v37, v37
    v_exp_f32 v45, v45
    v_exp_f32 v21, v21
    v_exp_f32 v29, v29
    v_exp_f32 v38, v38
    v_exp_f32 v46, v46
    v_exp_f32 v22, v22
    v_exp_f32 v30, v30
    v_exp_f32 v39, v39
    v_exp_f32 v47, v47
    v_exp_f32 v23, v23
    v_exp_f32 v31, v31
    v_cvt_pk_bf16_f32 v56, v32, v33
    v_cvt_pk_bf16_f32 v60, v40, v41
    v_cvt_pk_bf16_f32 v64, v16, v17
    v_cvt_pk_bf16_f32 v68, v24, v25
    v_cvt_pk_bf16_f32 v57, v34, v35
    v_cvt_pk_bf16_f32 v61, v42, v43
    v_cvt_pk_bf16_f32 v65, v18, v19
    v_cvt_pk_bf16_f32 v69, v26, v27
    v_cvt_pk_bf16_f32 v58, v36, v37
    v_cvt_pk_bf16_f32 v62, v44, v45
    v_cvt_pk_bf16_f32 v66, v20, v21
    v_cvt_pk_bf16_f32 v70, v28, v29
    v_cvt_pk_bf16_f32 v59, v38, v39
    v_cvt_pk_bf16_f32 v63, v46, v47
    v_cvt_pk_bf16_f32 v67, v22, v23
    v_cvt_pk_bf16_f32 v71, v30, v31
    v_mfma_f32_16x16x32_bf16 v[188:191], v[12:15], v[56:59], 0
    v_mfma_f32_16x16x32_bf16 v[180:183], v[108:111], v[56:59], 0
    v_mfma_f32_16x16x32_bf16 v[184:187], v[120:123], v[56:59], 0
    v_mfma_f32_16x16x32_bf16 v[200:203], v[12:15], v[60:63], 0
    v_mfma_f32_16x16x32_bf16 v[192:195], v[114:117], v[60:63], 0
    v_mfma_f32_16x16x32_bf16 v[196:199], v[120:123], v[60:63], 0
    v_mfma_f32_16x16x32_bf16 v[212:215], v[12:15], v[64:67], 0
    s_waitcnt lgkmcnt(2)
    v_mfma_f32_16x16x32_bf16 v[204:207], v[106:109], v[64:67], 0
    s_waitcnt lgkmcnt(0)
    v_mfma_f32_16x16x32_bf16 v[208:211], v[118:121], v[64:67], 0
    v_mfma_f32_16x16x32_bf16 v[224:227], v[12:15], v[68:71], 0
    v_mfma_f32_16x16x32_bf16 v[216:219], v[112:115], v[68:71], 0
    v_mfma_f32_16x16x32_bf16 v[220:223], v[118:121], v[68:71], 0
    s_lshl_b32 s53, s46, 4
    s_add_u32 s53, s53, s45
    s_lshl_b32 s54, s53, 10
    s_add_u32 s54, s54, 73662464
    s_lshl_b32 s55, s53, 7
    s_add_u32 s55, s55, 75759488
    v_lshlrev_b32 v6, 3, v1
    v_rcp_f32 v188, v188
    v_rcp_f32 v200, v200
    v_rcp_f32 v212, v212
    v_rcp_f32 v224, v224
    v_mul_f32 v180, v180, v188
    v_mul_f32 v181, v181, v188
    v_mul_f32 v182, v182, v188
    v_mul_f32 v183, v183, v188
    v_mul_f32 v184, v184, v188
    v_mul_f32 v185, v185, v188
    v_cvt_pk_bf16_f32 v76, v180, v181
    v_cvt_pk_bf16_f32 v77, v182, v183
    v_cvt_pk_bf16_f32 v82, v184, v185
    v_mul_f32 v192, v192, v200
    v_mul_f32 v193, v193, v200
    v_mul_f32 v194, v194, v200
    v_mul_f32 v195, v195, v200
    v_mul_f32 v198, v198, v200
    v_mul_f32 v199, v199, v200
    v_cvt_pk_bf16_f32 v78, v192, v193
    v_cvt_pk_bf16_f32 v79, v194, v195
    v_cvt_pk_bf16_f32 v83, v198, v199
    s_add_u32 s53, s54, 16384
    buffer_store_dwordx4 v[76:79], v2, s[4:7], s53 offen sc1
    v_mul_f32 v204, v204, v212
    v_mul_f32 v205, v205, v212
    v_mul_f32 v206, v206, v212
    v_mul_f32 v207, v207, v212
    v_mul_f32 v208, v208, v212
    v_mul_f32 v209, v209, v212
    v_cvt_pk_bf16_f32 v72, v204, v205
    v_cvt_pk_bf16_f32 v73, v206, v207
    v_cvt_pk_bf16_f32 v80, v208, v209
    v_mul_f32 v216, v216, v224
    v_mul_f32 v217, v217, v224
    v_mul_f32 v218, v218, v224
    v_mul_f32 v219, v219, v224
    v_mul_f32 v222, v222, v224
    v_mul_f32 v223, v223, v224
    v_cvt_pk_bf16_f32 v74, v216, v217
    v_cvt_pk_bf16_f32 v75, v218, v219
    v_cvt_pk_bf16_f32 v81, v222, v223
    s_add_u32 s53, s54, 0
    buffer_store_dwordx4 v[72:75], v2, s[4:7], s53 offen sc1
    s_mov_b32 exec_lo, 0xffff0000
    s_mov_b32 exec_hi, 0
    buffer_store_dwordx2 v[80:81], v6, s[4:7], s55 offen offset:0 sc1
    buffer_store_dwordx2 v[82:83], v6, s[4:7], s55 offen offset:2048 sc1
    s_mov_b64 exec, -1
    s_lshl_b32 s52, s44, 2
    s_add_u32 s52, s52, s20
    s_lshl_b32 s52, s52, 4
    s_add_u32 s52, s52, s45
    s_lshl_b32 s52, s52, 3
    s_add_u32 s52, s52, 3956736
    v_mov_b32 v8, s98
    v_mov_b32 v9, s99
    s_waitcnt vmcnt(0)
    s_mov_b64 exec, 1
    buffer_store_dwordx2 v[8:9], off, s[4:7], s52 sc1
    s_mov_b64 exec, -1
    s_cmp_ge_u32 s22, 24
    s_cbranch_scc1 L_next_51
    s_mul_i32 s44, s22, 10923
    s_lshr_b32 s44, s44, 16
    s_mul_i32 s52, s44, 6
    s_sub_u32 s45, s22, s52
    s_lshl_b32 s52, s21, 2
    s_add_u32 s44, s44, s52
    s_lshl_b32 s46, s44, 2
    s_add_u32 s46, s46, s20
    s_mul_i32 s47, s45, 110592
    s_mul_i32 s48, s20, 3072
    s_add_u32 s47, s47, s48
    s_add_u32 s47, s47, 2097152
    s_lshl_b32 s49, s46, 14
    s_add_u32 s49, s49, 73662464
    s_lshl_b32 s50, s46, 11
    s_add_u32 s50, s50, 75759616
    v_and_b32 v3, 15, v1
    v_lshrrev_b32 v4, 4, v1
    v_lshlrev_b32 v5, 3, v3
    v_lshl_add_u32 v5, v4, 8, v5
    s_lshl_b32 s52, s46, 4
    v_add_u32 v6, s52, v3
    v_lshlrev_b32 v7, 3, v6
    v_mul_u32_u24 v6, 1152, v6
    v_lshl_add_u32 v6, v4, 4, v6
    s_mul_i32 s51, s45, 192
    s_add_u32 s8, s42, 28311552
    s_addc_u32 s9, s43, 0
    s_mov_b32 s10, 0x240000
    s_mov_b32 s11, 0x20000
    s_mov_b32 m0, s48
    s_nop 0
    buffer_load_dwordx4 v2, s[4:7], s47 offen offset:0 lds
    buffer_load_dwordx4 v2, s[4:7], s47 offen offset:1024 lds
    buffer_load_dwordx4 v2, s[4:7], s47 offen offset:2048 lds
    s_add_u32 s48, s48, 12288
    s_add_u32 s47, s47, 12288
    s_mov_b32 m0, s48
    s_nop 0
    buffer_load_dwordx4 v2, s[4:7], s47 offen offset:0 lds
    buffer_load_dwordx4 v2, s[4:7], s47 offen offset:1024 lds
    buffer_load_dwordx4 v2, s[4:7], s47 offen offset:2048 lds
    s_add_u32 s48, s48, 12288
    s_add_u32 s47, s47, 12288
    s_mov_b32 m0, s48
    s_nop 0
    buffer_load_dwordx4 v2, s[4:7], s47 offen offset:0 lds
    buffer_load_dwordx4 v2, s[4:7], s47 offen offset:1024 lds
    buffer_load_dwordx4 v2, s[4:7], s47 offen offset:2048 lds
    s_add_u32 s48, s48, 12288
    s_add_u32 s47, s47, 12288
    s_mov_b32 m0, s48
    s_nop 0
    buffer_load_dwordx4 v2, s[4:7], s47 offen offset:0 lds
    buffer_load_dwordx4 v2, s[4:7], s47 offen offset:1024 lds
    buffer_load_dwordx4 v2, s[4:7], s47 offen offset:2048 lds
    s_add_u32 s48, s48, 12288
    s_add_u32 s47, s47, 12288
    s_mov_b32 m0, s48
    s_nop 0
    buffer_load_dwordx4 v2, s[4:7], s47 offen offset:0 lds
    buffer_load_dwordx4 v2, s[4:7], s47 offen offset:1024 lds
    buffer_load_dwordx4 v2, s[4:7], s47 offen offset:2048 lds
    s_add_u32 s48, s48, 12288
    s_add_u32 s47, s47, 12288
    s_mov_b32 m0, s48
    s_nop 0
    buffer_load_dwordx4 v2, s[4:7], s47 offen offset:0 lds
    buffer_load_dwordx4 v2, s[4:7], s47 offen offset:1024 lds
    buffer_load_dwordx4 v2, s[4:7], s47 offen offset:2048 lds
    s_add_u32 s48, s48, 12288
    s_add_u32 s47, s47, 12288
    s_mov_b32 m0, s48
    s_nop 0
    buffer_load_dwordx4 v2, s[4:7], s47 offen offset:0 lds
    buffer_load_dwordx4 v2, s[4:7], s47 offen offset:1024 lds
    buffer_load_dwordx4 v2, s[4:7], s47 offen offset:2048 lds
    s_add_u32 s48, s48, 12288
    s_add_u32 s47, s47, 12288
    s_mov_b32 m0, s48
    s_nop 0
    buffer_load_dwordx4 v2, s[4:7], s47 offen offset:0 lds
    buffer_load_dwordx4 v2, s[4:7], s47 offen offset:1024 lds
    buffer_load_dwordx4 v2, s[4:7], s47 offen offset:2048 lds
    s_add_u32 s48, s48, 12288
    s_add_u32 s47, s47, 12288
    s_mov_b32 m0, s48
    s_nop 0
    buffer_load_dwordx4 v2, s[4:7], s47 offen offset:0 lds
    buffer_load_dwordx4 v2, s[4:7], s47 offen offset:1024 lds
    buffer_load_dwordx4 v2, s[4:7], s47 offen offset:2048 lds
    s_add_u32 s48, s48, 12288
    s_add_u32 s47, s47, 12288
    s_lshr_b32 s52, s46, 1
    s_lshl_b32 s52, s52, 7
    s_add_u32 s52, s52, 3956736
    v_and_b32 v10, 15, v1
    v_lshlrev_b32 v10, 3, v10
    s_mul_i32 s53, s45, 2816
    s_min_u32 s53, s53, 13568
    s_add_u32 s53, s53, s49
    buffer_load_dwordx4 v[160:163], v6, s[8:11], s51 offen offset:0 sc1
    buffer_load_dwordx4 v[164:167], v6, s[8:11], s51 offen offset:64 sc1
    buffer_load_dwordx4 v[168:171], v6, s[8:11], s51 offen offset:128 sc1
    v_mov_b32 v8, v2
    s_waitcnt vmcnt(3)
    s_barrier
    buffer_load_dwordx2 v[12:13], v10, s[4:7], s52 offen sc1
    ds_read_b128 a[0:3], v8 offset:0
    ds_read_b128 a[4:7], v8 offset:1024
    ds_read_b128 a[8:11], v8 offset:2048
    ds_read_b128 a[12:15], v8 offset:3072
    ds_read_b128 a[16:19], v8 offset:4096
    ds_read_b128 a[20:23], v8 offset:5120
    ds_read_b128 a[24:27], v8 offset:6144
    ds_read_b128 a[28:31], v8 offset:7168
    ds_read_b128 a[32:35], v8 offset:8192
    ds_read_b128 a[36:39], v8 offset:9216
    ds_read_b128 a[40:43], v8 offset:10240
    ds_read_b128 a[44:47], v8 offset:11264
    ds_read_b128 a[48:51], v8 offset:12288
    ds_read_b128 a[52:55], v8 offset:13312
    ds_read_b128 a[56:59], v8 offset:14336
    ds_read_b128 a[60:63], v8 offset:15360
    ds_read_b128 a[64:67], v8 offset:16384
    ds_read_b128 a[68:71], v8 offset:17408
    ds_read_b128 a[72:75], v8 offset:18432
    ds_read_b128 a[76:79], v8 offset:19456
    ds_read_b128 a[80:83], v8 offset:20480
    ds_read_b128 a[84:87], v8 offset:21504
    ds_read_b128 a[88:91], v8 offset:22528
    ds_read_b128 a[92:95], v8 offset:23552
    ds_read_b128 v[112:115], v8 offset:24576
    ds_read_b128 v[116:119], v8 offset:25600
    ds_read_b128 v[120:123], v8 offset:26624
    ds_read_b128 v[124:127], v8 offset:27648
    ds_read_b128 v[128:131], v8 offset:28672
    ds_read_b128 v[132:135], v8 offset:29696
    ds_read_b128 v[136:139], v8 offset:30720
    ds_read_b128 v[140:143], v8 offset:31744
    ds_read_b128 v[144:147], v8 offset:32768
    ds_read_b128 v[148:151], v8 offset:33792
    s_waitcnt vmcnt(0)
    v_cmp_eq_u64 vcc, s[98:99], v[12:13]
    s_nop 0
    s_cmp_eq_u64 vcc, exec
    s_cbranch_scc0 L_po_slow_102
L_po_back_103:
    buffer_load_dwordx4 v[16:19], v2, s[4:7], s49 offen offset:0 sc1
    buffer_load_dwordx4 v[20:23], v2, s[4:7], s49 offen offset:1024 sc1
    buffer_load_dwordx4 v[24:27], v2, s[4:7], s49 offen offset:2048 sc1
    buffer_load_dwordx4 v[28:31], v2, s[4:7], s49 offen offset:3072 sc1
    s_add_u32 s49, s49, 4096
    buffer_load_dwordx4 v[32:35], v2, s[4:7], s49 offen offset:0 sc1
    buffer_load_dwordx4 v[36:39], v2, s[4:7], s49 offen offset:1024 sc1
    buffer_load_dwordx4 v[40:43], v2, s[4:7], s49 offen offset:2048 sc1
    buffer_load_dwordx4 v[44:47], v2, s[4:7], s49 offen offset:3072 sc1
    s_waitcnt vmcnt(7) lgkmcnt(15)
    s_add_u32 s49, s49, 4096
    v_mfma_f32_16x16x32_bf16 v[88:91], a[0:3], v[16:19], 0
    buffer_load_dwordx4 v[48:51], v2, s[4:7], s49 offen offset:0 sc1
    s_waitcnt lgkmcnt(15)
    v_mfma_f32_16x16x32_bf16 v[92:95], a[4:7], v[16:19], 0
    s_waitcnt lgkmcnt(15)
    v_mfma_f32_16x16x32_bf16 v[96:99], a[8:11], v[16:19], 0
    s_waitcnt lgkmcnt(15)
    v_mfma_f32_16x16x32_bf16 v[100:103], a[12:15], v[16:19], 0
    buffer_load_dwordx4 v[52:55], v2, s[4:7], s49 offen offset:1024 sc1
    s_waitcnt lgkmcnt(15)
    v_mfma_f32_16x16x32_bf16 v[104:107], a[16:19], v[16:19], 0
    s_waitcnt lgkmcnt(15)
    v_mfma_f32_16x16x32_bf16 v[108:111], a[20:23], v[16:19], 0
    s_waitcnt vmcnt(8) lgkmcnt(15)
    v_mfma_f32_16x16x32_bf16 v[88:91], a[24:27], v[20:23], v[88:91]
    buffer_load_dwordx4 v[56:59], v2, s[4:7], s49 offen offset:2048 sc1
    s_waitcnt lgkmcnt(15)
    v_mfma_f32_16x16x32_bf16 v[92:95], a[28:31], v[20:23], v[92:95]
    s_waitcnt lgkmcnt(15)
    v_mfma_f32_16x16x32_bf16 v[96:99], a[32:35], v[20:23], v[96:99]
    s_waitcnt lgkmcnt(15)
    v_mfma_f32_16x16x32_bf16 v[100:103], a[36:39], v[20:23], v[100:103]
    buffer_load_dwordx4 v[60:63], v2, s[4:7], s49 offen offset:3072 sc1
    s_waitcnt lgkmcnt(15)
    v_mfma_f32_16x16x32_bf16 v[104:107], a[40:43], v[20:23], v[104:107]
    s_waitcnt lgkmcnt(15)
    s_add_u32 s49, s49, 4096
    v_mfma_f32_16x16x32_bf16 v[108:111], a[44:47], v[20:23], v[108:111]
    s_waitcnt vmcnt(9) lgkmcnt(15)
    v_mfma_f32_16x16x32_bf16 v[88:91], a[48:51], v[24:27], v[88:91]
    buffer_load_dwordx4 v[64:67], v2, s[4:7], s49 offen offset:0 sc1
    s_waitcnt lgkmcnt(15)
    v_mfma_f32_16x16x32_bf16 v[92:95], a[52:55], v[24:27], v[92:95]
    s_waitcnt lgkmcnt(15)
    v_mfma_f32_16x16x32_bf16 v[96:99], a[56:59], v[24:27], v[96:99]
    s_waitcnt lgkmcnt(15)
    v_mfma_f32_16x16x32_bf16 v[100:103], a[60:63], v[24:27], v[100:103]
    buffer_load_dwordx4 v[68:71], v2, s[4:7], s49 offen offset:1024 sc1
    s_waitcnt lgkmcnt(15)
    v_mfma_f32_16x16x32_bf16 v[104:107], a[64:67], v[24:27], v[104:107]
    s_waitcnt lgkmcnt(15)
    v_mfma_f32_16x16x32_bf16 v[108:111], a[68:71], v[24:27], v[108:111]
    s_waitcnt vmcnt(10) lgkmcnt(15)
    v_mfma_f32_16x16x32_bf16 v[88:91], a[72:75], v[28:31], v[88:91]
    buffer_load_dwordx4 v[72:75], v2, s[4:7], s49 offen offset:2048 sc1
    s_waitcnt lgkmcnt(14)
    v_mfma_f32_16x16x32_bf16 v[92:95], a[76:79], v[28:31], v[92:95]
    s_waitcnt lgkmcnt(13)
    v_mfma_f32_16x16x32_bf16 v[96:99], a[80:83], v[28:31], v[96:99]
    s_waitcnt lgkmcnt(12)
    v_mfma_f32_16x16x32_bf16 v[100:103], a[84:87], v[28:31], v[100:103]
    buffer_load_dwordx4 v[76:79], v2, s[4:7], s49 offen offset:3072 sc1
    s_waitcnt lgkmcnt(11)
    v_mfma_f32_16x16x32_bf16 v[104:107], a[88:91], v[28:31], v[104:107]
    s_waitcnt lgkmcnt(10)
    v_mfma_f32_16x16x32_bf16 v[108:111], a[92:95], v[28:31], v[108:111]
    s_waitcnt vmcnt(11) lgkmcnt(9)
    v_mfma_f32_16x16x32_bf16 v[88:91], v[112:115], v[32:35], v[88:91]
    s_waitcnt lgkmcnt(8)
    ds_read_b128 v[152:155], v8 offset:34816
    v_mfma_f32_16x16x32_bf16 v[92:95], v[116:119], v[32:35], v[92:95]
    s_waitcnt lgkmcnt(8)
    ds_read_b128 v[156:159], v8 offset:35840
    v_mfma_f32_16x16x32_bf16 v[96:99], v[120:123], v[32:35], v[96:99]
    s_waitcnt lgkmcnt(8)
    ds_read_b128 v[112:115], v8 offset:36864
    v_mfma_f32_16x16x32_bf16 v[100:103], v[124:127], v[32:35], v[100:103]
    s_waitcnt lgkmcnt(8)
    ds_read_b128 v[116:119], v8 offset:37888
    v_mfma_f32_16x16x32_bf16 v[104:107], v[128:131], v[32:35], v[104:107]
    s_waitcnt lgkmcnt(8)
    ds_read_b128 v[120:123], v8 offset:38912
    v_mfma_f32_16x16x32_bf16 v[108:111], v[132:135], v[32:35], v[108:111]
    s_waitcnt vmcnt(10) lgkmcnt(8)
    ds_read_b128 v[124:127], v8 offset:39936
    v_mfma_f32_16x16x32_bf16 v[88:91], v[136:139], v[36:39], v[88:91]
    s_waitcnt lgkmcnt(8)
    ds_read_b128 v[128:131], v8 offset:40960
    v_mfma_f32_16x16x32_bf16 v[92:95], v[140:143], v[36:39], v[92:95]
    s_waitcnt lgkmcnt(8)
    ds_read_b128 v[132:135], v8 offset:41984
    v_mfma_f32_16x16x32_bf16 v[96:99], v[144:147], v[36:39], v[96:99]
    s_waitcnt lgkmcnt(8)
    ds_read_b128 v[136:139], v8 offset:43008
    v_mfma_f32_16x16x32_bf16 v[100:103], v[148:151], v[36:39], v[100:103]
    s_waitcnt lgkmcnt(8)
    ds_read_b128 v[140:143], v8 offset:44032
    v_mfma_f32_16x16x32_bf16 v[104:107], v[152:155], v[36:39], v[104:107]
    s_waitcnt lgkmcnt(8)
    ds_read_b128 v[144:147], v8 offset:45056
    v_mfma_f32_16x16x32_bf16 v[108:111], v[156:159], v[36:39], v[108:111]
    s_waitcnt vmcnt(9) lgkmcnt(8)
    ds_read_b128 v[148:151], v8 offset:46080
    v_mfma_f32_16x16x32_bf16 v[88:91], v[112:115], v[40:43], v[88:91]
    s_waitcnt lgkmcnt(8)
    ds_read_b128 v[152:155], v8 offset:47104
    v_mfma_f32_16x16x32_bf16 v[92:95], v[116:119], v[40:43], v[92:95]
    s_waitcnt lgkmcnt(8)
    ds_read_b128 v[156:159], v8 offset:48128
    v_mfma_f32_16x16x32_bf16 v[96:99], v[120:123], v[40:43], v[96:99]
    s_waitcnt lgkmcnt(8)
    ds_read_b128 v[112:115], v8 offset:49152
    v_mfma_f32_16x16x32_bf16 v[100:103], v[124:127], v[40:43], v[100:103]
    s_waitcnt lgkmcnt(8)
    ds_read_b128 v[116:119], v8 offset:50176
    v_mfma_f32_16x16x32_bf16 v[104:107], v[128:131], v[40:43], v[104:107]
    s_waitcnt lgkmcnt(8)
    ds_read_b128 v[120:123], v8 offset:51200
    v_mfma_f32_16x16x32_bf16 v[108:111], v[132:135], v[40:43], v[108:111]
    s_waitcnt vmcnt(8) lgkmcnt(8)
    ds_read_b128 v[124:127], v8 offset:52224
    v_mfma_f32_16x16x32_bf16 v[88:91], v[136:139], v[44:47], v[88:91]
    s_waitcnt lgkmcnt(8)
    ds_read_b128 v[128:131], v8 offset:53248
    v_mfma_f32_16x16x32_bf16 v[92:95], v[140:143], v[44:47], v[92:95]
    s_waitcnt lgkmcnt(8)
    ds_read_b128 v[132:135], v8 offset:54272
    v_mfma_f32_16x16x32_bf16 v[96:99], v[144:147], v[44:47], v[96:99]
    s_waitcnt lgkmcnt(8)
    ds_read_b128 v[136:139], v8 offset:55296
    v_mfma_f32_16x16x32_bf16 v[100:103], v[148:151], v[44:47], v[100:103]
    s_waitcnt lgkmcnt(8)
    ds_read_b128 v[140:143], v8 offset:56320
    v_mfma_f32_16x16x32_bf16 v[104:107], v[152:155], v[44:47], v[104:107]
    s_waitcnt lgkmcnt(8)
    ds_read_b128 v[144:147], v8 offset:57344
    v_mfma_f32_16x16x32_bf16 v[108:111], v[156:159], v[44:47], v[108:111]
    s_waitcnt vmcnt(7) lgkmcnt(8)
    ds_read_b128 v[148:151], v8 offset:58368
    v_mfma_f32_16x16x32_bf16 v[88:91], v[112:115], v[48:51], v[88:91]
    s_waitcnt lgkmcnt(8)
    ds_read_b128 v[152:155], v8 offset:59392
    v_mfma_f32_16x16x32_bf16 v[92:95], v[116:119], v[48:51], v[92:95]
    s_waitcnt lgkmcnt(8)
    ds_read_b128 v[156:159], v8 offset:60416
    v_mfma_f32_16x16x32_bf16 v[96:99], v[120:123], v[48:51], v[96:99]
    s_waitcnt lgkmcnt(8)
    v_add_u32 v8, 61440, v8
    ds_read_b128 v[112:115], v8 offset:0
    v_mfma_f32_16x16x32_bf16 v[100:103], v[124:127], v[48:51], v[100:103]
    s_waitcnt lgkmcnt(8)
    ds_read_b128 v[116:119], v8 offset:1024
    v_mfma_f32_16x16x32_bf16 v[104:107], v[128:131], v[48:51], v[104:107]
    s_waitcnt lgkmcnt(8)
    ds_read_b128 v[120:123], v8 offset:2048
    v_mfma_f32_16x16x32_bf16 v[108:111], v[132:135], v[48:51], v[108:111]
    s_waitcnt vmcnt(6) lgkmcnt(8)
    ds_read_b128 v[124:127], v8 offset:3072
    v_mfma_f32_16x16x32_bf16 v[88:91], v[136:139], v[52:55], v[88:91]
    s_waitcnt lgkmcnt(8)
    ds_read_b128 v[128:131], v8 offset:4096
    v_mfma_f32_16x16x32_bf16 v[92:95], v[140:143], v[52:55], v[92:95]
    s_waitcnt lgkmcnt(8)
    ds_read_b128 v[132:135], v8 offset:5120
    v_mfma_f32_16x16x32_bf16 v[96:99], v[144:147], v[52:55], v[96:99]
    s_waitcnt lgkmcnt(8)
    ds_read_b128 v[136:139], v8 offset:6144
    v_mfma_f32_16x16x32_bf16 v[100:103], v[148:151], v[52:55], v[100:103]
    s_waitcnt lgkmcnt(8)
    ds_read_b128 v[140:143], v8 offset:7168
    v_mfma_f32_16x16x32_bf16 v[104:107], v[152:155], v[52:55], v[104:107]
    s_waitcnt lgkmcnt(8)
    ds_read_b128 v[144:147], v8 offset:8192
    v_mfma_f32_16x16x32_bf16 v[108:111], v[156:159], v[52:55], v[108:111]
    s_waitcnt vmcnt(5) lgkmcnt(8)
    ds_read_b128 v[148:151], v8 offset:9216
    v_mfma_f32_16x16x32_bf16 v[88:91], v[112:115], v[56:59], v[88:91]
    s_waitcnt lgkmcnt(8)
    ds_read_b128 v[152:155], v8 offset:10240
    v_mfma_f32_16x16x32_bf16 v[92:95], v[116:119], v[56:59], v[92:95]
    s_waitcnt lgkmcnt(8)
    ds_read_b128 v[156:159], v8 offset:11264
    v_mfma_f32_16x16x32_bf16 v[96:99], v[120:123], v[56:59], v[96:99]
    s_waitcnt lgkmcnt(8)
    ds_read_b128 v[112:115], v8 offset:12288
    v_mfma_f32_16x16x32_bf16 v[100:103], v[124:127], v[56:59], v[100:103]
    s_waitcnt lgkmcnt(8)
    ds_read_b128 v[116:119], v8 offset:13312
    v_mfma_f32_16x16x32_bf16 v[104:107], v[128:131], v[56:59], v[104:107]
    s_waitcnt lgkmcnt(8)
    ds_read_b128 v[120:123], v8 offset:14336
    v_mfma_f32_16x16x32_bf16 v[108:111], v[132:135], v[56:59], v[108:111]
    ds_read_b128 v[124:127], v8 offset:15360
    buffer_load_dwordx2 v[80:81], v5, s[4:7], s50 offen offset:0 sc1
    buffer_load_dwordx2 v[82:83], v5, s[4:7], s50 offen offset:128 sc1
    s_waitcnt vmcnt(6) lgkmcnt(9)
    v_mfma_f32_16x16x32_bf16 v[88:91], v[136:139], v[60:63], v[88:91]
    s_waitcnt lgkmcnt(8)
    ds_read_b128 v[128:131], v8 offset:16384
    v_mfma_f32_16x16x32_bf16 v[92:95], v[140:143], v[60:63], v[92:95]
    s_waitcnt lgkmcnt(8)
    ds_read_b128 v[132:135], v8 offset:17408
    v_mfma_f32_16x16x32_bf16 v[96:99], v[144:147], v[60:63], v[96:99]
    s_waitcnt lgkmcnt(8)
    ds_read_b128 v[136:139], v8 offset:18432
    v_mfma_f32_16x16x32_bf16 v[100:103], v[148:151], v[60:63], v[100:103]
    s_waitcnt lgkmcnt(8)
    ds_read_b128 v[140:143], v8 offset:19456
    v_mfma_f32_16x16x32_bf16 v[104:107], v[152:155], v[60:63], v[104:107]
    s_waitcnt lgkmcnt(8)
    ds_read_b128 v[144:147], v8 offset:20480
    v_mfma_f32_16x16x32_bf16 v[108:111], v[156:159], v[60:63], v[108:111]
    ds_read_b128 v[148:151], v8 offset:21504
    buffer_load_dwordx2 v[84:85], v5, s[4:7], s50 offen offset:1024 sc1
    buffer_load_dwordx2 v[86:87], v5, s[4:7], s50 offen offset:1152 sc1
    s_waitcnt vmcnt(7) lgkmcnt(9)
    v_mfma_f32_16x16x32_bf16 v[88:91], v[112:115], v[64:67], v[88:91]
    s_waitcnt lgkmcnt(8)
    ds_read_b128 v[152:155], v8 offset:22528
    v_mfma_f32_16x16x32_bf16 v[92:95], v[116:119], v[64:67], v[92:95]
    s_waitcnt lgkmcnt(8)
    ds_read_b128 v[156:159], v8 offset:23552
    v_mfma_f32_16x16x32_bf16 v[96:99], v[120:123], v[64:67], v[96:99]
    s_waitcnt lgkmcnt(8)
    ds_read_b128 v[112:115], v8 offset:24576
    v_mfma_f32_16x16x32_bf16 v[100:103], v[124:127], v[64:67], v[100:103]
    s_waitcnt lgkmcnt(8)
    ds_read_b128 v[116:119], v8 offset:25600
    v_mfma_f32_16x16x32_bf16 v[104:107], v[128:131], v[64:67], v[104:107]
    s_waitcnt lgkmcnt(8)
    ds_read_b128 v[120:123], v8 offset:26624
    v_mfma_f32_16x16x32_bf16 v[108:111], v[132:135], v[64:67], v[108:111]
    s_waitcnt vmcnt(6) lgkmcnt(8)
    ds_read_b128 v[124:127], v8 offset:27648
    v_mfma_f32_16x16x32_bf16 v[88:91], v[136:139], v[68:71], v[88:91]
    s_waitcnt lgkmcnt(8)
    ds_read_b128 v[128:131], v8 offset:28672
    v_mfma_f32_16x16x32_bf16 v[92:95], v[140:143], v[68:71], v[92:95]
    s_waitcnt lgkmcnt(8)
    ds_read_b128 v[132:135], v8 offset:29696
    v_mfma_f32_16x16x32_bf16 v[96:99], v[144:147], v[68:71], v[96:99]
    s_waitcnt lgkmcnt(8)
    ds_read_b128 v[136:139], v8 offset:30720
    v_mfma_f32_16x16x32_bf16 v[100:103], v[148:151], v[68:71], v[100:103]
    s_waitcnt lgkmcnt(8)
    ds_read_b128 v[140:143], v8 offset:31744
    v_mfma_f32_16x16x32_bf16 v[104:107], v[152:155], v[68:71], v[104:107]
    s_waitcnt lgkmcnt(8)
    ds_read_b128 v[144:147], v8 offset:32768
    v_mfma_f32_16x16x32_bf16 v[108:111], v[156:159], v[68:71], v[108:111]
    s_waitcnt vmcnt(5) lgkmcnt(8)
    ds_read_b128 v[148:151], v8 offset:33792
    v_mfma_f32_16x16x32_bf16 v[88:91], v[112:115], v[72:75], v[88:91]
    s_waitcnt lgkmcnt(8)
    ds_read_b128 v[152:155], v8 offset:34816
    v_mfma_f32_16x16x32_bf16 v[92:95], v[116:119], v[72:75], v[92:95]
    s_waitcnt lgkmcnt(8)
    ds_read_b128 v[156:159], v8 offset:35840
    v_mfma_f32_16x16x32_bf16 v[96:99], v[120:123], v[72:75], v[96:99]
    s_waitcnt lgkmcnt(8)
    ds_read_b128 v[112:115], v8 offset:36864
    v_mfma_f32_16x16x32_bf16 v[100:103], v[124:127], v[72:75], v[100:103]
    s_waitcnt lgkmcnt(8)
    ds_read_b128 v[116:119], v8 offset:37888
    v_mfma_f32_16x16x32_bf16 v[104:107], v[128:131], v[72:75], v[104:107]
    s_waitcnt lgkmcnt(8)
    ds_read_b128 v[120:123], v8 offset:38912
    v_mfma_f32_16x16x32_bf16 v[108:111], v[132:135], v[72:75], v[108:111]
    s_waitcnt vmcnt(4) lgkmcnt(8)
    ds_read_b128 v[124:127], v8 offset:39936
    v_mfma_f32_16x16x32_bf16 v[88:91], v[136:139], v[76:79], v[88:91]
    s_waitcnt lgkmcnt(8)
    ds_read_b128 v[128:131], v8 offset:40960
    v_mfma_f32_16x16x32_bf16 v[92:95], v[140:143], v[76:79], v[92:95]
    s_waitcnt lgkmcnt(8)
    ds_read_b128 v[132:135], v8 offset:41984
    v_mfma_f32_16x16x32_bf16 v[96:99], v[144:147], v[76:79], v[96:99]
    s_waitcnt lgkmcnt(8)
    ds_read_b128 v[136:139], v8 offset:43008
    v_mfma_f32_16x16x32_bf16 v[100:103], v[148:151], v[76:79], v[100:103]
    s_waitcnt lgkmcnt(8)
    ds_read_b128 v[140:143], v8 offset:44032
    v_mfma_f32_16x16x32_bf16 v[104:107], v[152:155], v[76:79], v[104:107]
    s_waitcnt lgkmcnt(8)
    ds_read_b128 v[144:147], v8 offset:45056
    v_mfma_f32_16x16x32_bf16 v[108:111], v[156:159], v[76:79], v[108:111]
    s_waitcnt vmcnt(2) lgkmcnt(8)
    ds_read_b128 v[148:151], v8 offset:46080
    v_mfma_f32_16x16x32_bf16 v[88:91], v[112:115], v[80:83], v[88:91]
    s_waitcnt lgkmcnt(8)
    ds_read_b128 v[152:155], v8 offset:47104
    v_mfma_f32_16x16x32_bf16 v[92:95], v[116:119], v[80:83], v[92:95]
    s_waitcnt lgkmcnt(8)
    ds_read_b128 v[156:159], v8 offset:48128
    v_mfma_f32_16x16x32_bf16 v[96:99], v[120:123], v[80:83], v[96:99]
    s_waitcnt lgkmcnt(8)
    v_mfma_f32_16x16x32_bf16 v[100:103], v[124:127], v[80:83], v[100:103]
    s_waitcnt lgkmcnt(7)
    v_mfma_f32_16x16x32_bf16 v[104:107], v[128:131], v[80:83], v[104:107]
    s_waitcnt lgkmcnt(6)
    v_mfma_f32_16x16x32_bf16 v[108:111], v[132:135], v[80:83], v[108:111]
    s_waitcnt vmcnt(0) lgkmcnt(5)
    v_mfma_f32_16x16x32_bf16 v[88:91], v[136:139], v[84:87], v[88:91]
    s_waitcnt lgkmcnt(4)
    v_mfma_f32_16x16x32_bf16 v[92:95], v[140:143], v[84:87], v[92:95]
    s_waitcnt lgkmcnt(3)
    v_mfma_f32_16x16x32_bf16 v[96:99], v[144:147], v[84:87], v[96:99]
    s_waitcnt lgkmcnt(2)
    v_mfma_f32_16x16x32_bf16 v[100:103], v[148:151], v[84:87], v[100:103]
    s_waitcnt lgkmcnt(1)
    v_mfma_f32_16x16x32_bf16 v[104:107], v[152:155], v[84:87], v[104:107]
    s_waitcnt lgkmcnt(0)
    v_mfma_f32_16x16x32_bf16 v[108:111], v[156:159], v[84:87], v[108:111]
    v_lshlrev_b32 v16, 16, v160
    v_and_b32 v17, 0xffff0000, v160
    v_lshlrev_b32 v18, 16, v161
    v_and_b32 v19, 0xffff0000, v161
    v_lshlrev_b32 v20, 16, v162
    v_and_b32 v21, 0xffff0000, v162
    v_lshlrev_b32 v22, 16, v163
    v_and_b32 v23, 0xffff0000, v163
    v_lshlrev_b32 v24, 16, v164
    v_and_b32 v25, 0xffff0000, v164
    v_lshlrev_b32 v26, 16, v165
    v_and_b32 v27, 0xffff0000, v165
    v_lshlrev_b32 v28, 16, v166
    v_and_b32 v29, 0xffff0000, v166
    v_lshlrev_b32 v30, 16, v167
    v_and_b32 v31, 0xffff0000, v167
    v_lshlrev_b32 v32, 16, v168
    v_and_b32 v33, 0xffff0000, v168
    v_lshlrev_b32 v34, 16, v169
    v_and_b32 v35, 0xffff0000, v169
    v_lshlrev_b32 v36, 16, v170
    v_and_b32 v37, 0xffff0000, v170
    v_lshlrev_b32 v38, 16, v171
    v_and_b32 v39, 0xffff0000, v171
    v_add_f32 v16, v16, v88
    v_add_f32 v17, v17, v89
    v_add_f32 v18, v18, v90
    v_add_f32 v19, v19, v91
    v_add_f32 v20, v20, v92
    v_add_f32 v21, v21, v93
    v_add_f32 v22, v22, v94
    v_add_f32 v23, v23, v95
    v_add_f32 v24, v24, v96
    v_add_f32 v25, v25, v97
    v_add_f32 v26, v26, v98
    v_add_f32 v27, v27, v99
    v_add_f32 v28, v28, v100
    v_add_f32 v29, v29, v101
    v_add_f32 v30, v30, v102
    v_add_f32 v31, v31, v103
    v_add_f32 v32, v32, v104
    v_add_f32 v33, v33, v105
    v_add_f32 v34, v34, v106
    v_add_f32 v35, v35, v107
    v_add_f32 v36, v36, v108
    v_add_f32 v37, v37, v109
    v_add_f32 v38, v38, v110
    v_add_f32 v39, v39, v111
    s_mul_i32 s52, s46, 18
    s_mul_i32 s53, s45, 3
    s_add_u32 s52, s52, s53
    s_lshl_b32 s52, s52, 10
    s_add_u32 s52, s52, 76021760
    v_cvt_pk_bf16_f32 v40, v16, v17
    v_cvt_pk_bf16_f32 v41, v18, v19
    v_cvt_pk_bf16_f32 v42, v20, v21
    v_cvt_pk_bf16_f32 v43, v22, v23
    buffer_store_dwordx4 v[40:43], v2, s[4:7], s52 offen offset:0 sc1
    v_cvt_pk_bf16_f32 v44, v24, v25
    v_cvt_pk_bf16_f32 v45, v26, v27
    v_cvt_pk_bf16_f32 v46, v28, v29
    v_cvt_pk_bf16_f32 v47, v30, v31
    buffer_store_dwordx4 v[44:47], v2, s[4:7], s52 offen offset:1024 sc1
    v_cvt_pk_bf16_f32 v48, v32, v33
    v_cvt_pk_bf16_f32 v49, v34, v35
    v_cvt_pk_bf16_f32 v50, v36, v37
    v_cvt_pk_bf16_f32 v51, v38, v39
    buffer_store_dwordx4 v[48:51], v2, s[4:7], s52 offen offset:2048 sc1
    v_lshlrev_b32 v16, 16, v40
    v_and_b32 v17, 0xffff0000, v40
    v_lshlrev_b32 v18, 16, v41
    v_and_b32 v19, 0xffff0000, v41
    v_lshlrev_b32 v20, 16, v42
    v_and_b32 v21, 0xffff0000, v42
    v_lshlrev_b32 v22, 16, v43
    v_and_b32 v23, 0xffff0000, v43
    v_lshlrev_b32 v24, 16, v44
    v_and_b32 v25, 0xffff0000, v44
    v_lshlrev_b32 v26, 16, v45
    v_and_b32 v27, 0xffff0000, v45
    v_lshlrev_b32 v28, 16, v46
    v_and_b32 v29, 0xffff0000, v46
    v_lshlrev_b32 v30, 16, v47
    v_and_b32 v31, 0xffff0000, v47
    v_lshlrev_b32 v32, 16, v48
    v_and_b32 v33, 0xffff0000, v48
    v_lshlrev_b32 v34, 16, v49
    v_and_b32 v35, 0xffff0000, v49
    v_lshlrev_b32 v36, 16, v50
    v_and_b32 v37, 0xffff0000, v50
    v_lshlrev_b32 v38, 16, v51
    v_and_b32 v39, 0xffff0000, v51
    v_add_f32 v56, v16, v17
    v_add_f32 v58, v18, v19
    v_add_f32 v56, v56, v20
    v_add_f32 v58, v58, v21
    v_add_f32 v56, v56, v22
    v_add_f32 v58, v58, v23
    v_add_f32 v56, v56, v24
    v_add_f32 v58, v58, v25
    v_add_f32 v56, v56, v26
    v_add_f32 v58, v58, v27
    v_add_f32 v56, v56, v28
    v_add_f32 v58, v58, v29
    v_add_f32 v56, v56, v30
    v_add_f32 v58, v58, v31
    v_add_f32 v56, v56, v32
    v_add_f32 v58, v58, v33
    v_add_f32 v56, v56, v34
    v_add_f32 v58, v58, v35
    v_add_f32 v56, v56, v36
    v_add_f32 v58, v58, v37
    v_add_f32 v56, v56, v38
    v_add_f32 v58, v58, v39
    v_add_f32 v56, v56, v58
    v_mov_b32 v58, v56
    s_nop 1
    v_permlane16_swap_b32 v56, v58
    v_add_f32 v56, v56, v58
    v_mov_b32 v58, v56
    s_nop 1
    v_permlane32_swap_b32 v56, v58
    v_add_f32 v56, v56, v58
    v_mul_f32 v59, 0x3c2aaaab, v56
    v_sub_f32 v58, v16, v59
    v_mul_f32 v57, v58, v58
    v_sub_f32 v61, v17, v59
    v_fmac_f32 v57, v61, v61
    v_sub_f32 v60, v18, v59
    v_fmac_f32 v57, v60, v60
    v_sub_f32 v61, v19, v59
    v_fmac_f32 v57, v61, v61
    v_sub_f32 v60, v20, v59
    v_fmac_f32 v57, v60, v60
    v_sub_f32 v61, v21, v59
    v_fmac_f32 v57, v61, v61
    v_sub_f32 v60, v22, v59
    v_fmac_f32 v57, v60, v60
    v_sub_f32 v61, v23, v59
    v_fmac_f32 v57, v61, v61
    v_sub_f32 v60, v24, v59
    v_fmac_f32 v57, v60, v60
    v_sub_f32 v61, v25, v59
    v_fmac_f32 v57, v61, v61
    v_sub_f32 v60, v26, v59
    v_fmac_f32 v57, v60, v60
    v_sub_f32 v61, v27, v59
    v_fmac_f32 v57, v61, v61
    v_sub_f32 v60, v28, v59
    v_fmac_f32 v57, v60, v60
    v_sub_f32 v61, v29, v59
    v_fmac_f32 v57, v61, v61
    v_sub_f32 v60, v30, v59
    v_fmac_f32 v57, v60, v60
    v_sub_f32 v61, v31, v59
    v_fmac_f32 v57, v61, v61
    v_sub_f32 v60, v32, v59
    v_fmac_f32 v57, v60, v60
    v_sub_f32 v61, v33, v59
    v_fmac_f32 v57, v61, v61
    v_sub_f32 v60, v34, v59
    v_fmac_f32 v57, v60, v60
    v_sub_f32 v61, v35, v59
    v_fmac_f32 v57, v61, v61
    v_sub_f32 v60, v36, v59
    v_fmac_f32 v57, v60, v60
    v_sub_f32 v61, v37, v59
    v_fmac_f32 v57, v61, v61
    v_sub_f32 v60, v38, v59
    v_fmac_f32 v57, v60, v60
    v_sub_f32 v61, v39, v59
    v_fmac_f32 v57, v61, v61
    v_mov_b32 v58, v57
    s_nop 1
    v_permlane16_swap_b32 v57, v58
    v_add_f32 v57, v57, v58
    v_mov_b32 v58, v57
    s_nop 1
    v_permlane32_swap_b32 v57, v58
    v_add_f32 v57, v57, v58
    s_lshl_b32 s52, s45, 14
    s_add_u32 s52, s52, 78381056
    s_mov_b32 exec_lo, 0xffff
    s_mov_b32 exec_hi, 0
    buffer_store_dwordx2 v[56:57], v7, s[4:7], s52 offen sc1
    s_mov_b64 exec, -1
    s_lshl_b32 s52, s46, 3
    s_add_u32 s52, s52, s45
    s_lshl_b32 s52, s52, 3
    s_add_u32 s52, s52, 3973120
    v_mov_b32 v8, s98
    v_mov_b32 v9, s99
    s_waitcnt vmcnt(0)
    s_mov_b64 exec, 1
    buffer_store_dwordx2 v[8:9], off, s[4:7], s52 sc1
    s_mov_b64 exec, -1
L_next_51:
    s_mov_b32 s100, 71303168
    s_mov_b32 s101, 0x2000
    s_branch L_ffn_49
L_red1_50:
    s_lshl_b32 s47, s21, 5
    s_add_u32 s47, s47, s22
    v_and_b32 v8, 7, v1
    v_lshrrev_b32 v9, 3, v1
    s_lshl_b32 s48, s47, 3
    v_add_u32 v3, s48, v8
    v_mul_u32_u24 v3, 1152, v3
    s_mul_i32 s48, s20, 384
    v_lshl_add_u32 v3, v9, 4, v3
    v_add_u32 v3, s48, v3
    s_lshr_b32 s48, s47, 1
    s_mul_i32 s48, s48, 18432
    s_and_b32 s49, s47, 1
    s_lshl_b32 s49, s49, 7
    s_add_u32 s48, s48, s49
    s_mul_i32 s49, s20, 6144
    s_add_u32 s48, s48, s49
    v_lshlrev_b32 v8, 4, v8
    v_lshl_add_u32 v8, v9, 8, v8
    v_add_u32 v4, s48, v8
    v_lshrrev_b32 v8, 3, v1
    v_and_b32 v9, 7, v1
    s_and_b32 s48, s47, 1
    s_lshl_b32 s48, s48, 3
    v_add_u32 v9, s48, v9
    v_lshlrev_b32 v9, 4, v9
    v_bfe_u32 v10, v8, 1, 1
    v_and_b32 v11, 1, v8
    v_lshl_add_u32 v9, v11, 4, v9
    v_lshl_add_u32 v9, v10, 9, v9
    v_and_b32 v10, 3, v8
    v_lshlrev_b32 v10, 8, v10
    v_sub_u32 v9, v9, v10
    s_mul_i32 s48, s20, 6
    v_lshrrev_b32 v8, 2, v8
    v_add_u32 v8, s48, v8
    v_add_u32 v10, 0, v8
    v_cmp_eq_u32 vcc, 4, v10
    v_cmp_eq_u32 s[56:57], 13, v10
    s_nop 0
    s_or_b64 vcc, vcc, s[56:57]
    v_cndmask_b32 v10, 0, v9, vcc
    v_add3_u32 v5, v4, v10, 0
    v_add_u32 v5, 0, v5
    v_add_u32 v10, 2, v8
    v_cmp_eq_u32 vcc, 4, v10
    v_cmp_eq_u32 s[56:57], 13, v10
    s_nop 0
    s_or_b64 vcc, vcc, s[56:57]
    v_cndmask_b32 v10, 0, v9, vcc
    v_add3_u32 v6, v4, v10, 0
    v_add_u32 v6, 2048, v6
    v_add_u32 v10, 4, v8
    v_cmp_eq_u32 vcc, 4, v10
    v_cmp_eq_u32 s[56:57], 13, v10
    s_nop 0
    s_or_b64 vcc, vcc, s[56:57]
    v_cndmask_b32 v10, 0, v9, vcc
    v_add3_u32 v7, v4, v10, 0
    v_add_u32 v7, 4096, v7
    s_cmp_eq_u32 s20, 3
    s_cbranch_scc1 L_w3a_105
    s_mov_b32 s48, 76021760
    buffer_load_dwordx4 v[16:19], v4, s[4:7], s48 offen offset:0 sc1
    buffer_load_dwordx4 v[52:55], v4, s[4:7], s48 offen offset:2048 sc1
    s_add_u32 s48, s48, 4096
    buffer_load_dwordx4 v[88:91], v4, s[4:7], s48 offen offset:0 sc1
    s_lshr_b32 s49, s47, 3
    s_lshl_b32 s49, s49, 8
    s_add_u32 s49, s49, 4055040
    v_and_b32 v10, 31, v1
    v_lshlrev_b32 v10, 3, v10
    buffer_load_dwordx2 v[8:9], v10, s[4:7], s49 offen sc1
    s_waitcnt vmcnt(0)
    v_cmp_eq_u64 vcc, s[98:99], v[8:9]
    s_nop 0
    s_cmp_eq_u64 vcc, exec
    s_cbranch_scc0 L_pp_slow_106
L_pp_back_107:
    s_mov_b32 s48, 100663296
    buffer_load_dwordx4 v[20:23], v5, s[4:7], s48 offen sc1
    buffer_load_dwordx4 v[56:59], v6, s[4:7], s48 offen sc1
    buffer_load_dwordx4 v[92:95], v7, s[4:7], s48 offen sc1
    s_mov_b32 s48, 103022592
    buffer_load_dwordx4 v[24:27], v5, s[4:7], s48 offen sc1
    buffer_load_dwordx4 v[60:63], v6, s[4:7], s48 offen sc1
    buffer_load_dwordx4 v[96:99], v7, s[4:7], s48 offen sc1
    s_mov_b32 s48, 105381888
    buffer_load_dwordx4 v[28:31], v5, s[4:7], s48 offen sc1
    buffer_load_dwordx4 v[64:67], v6, s[4:7], s48 offen sc1
    buffer_load_dwordx4 v[100:103], v7, s[4:7], s48 offen sc1
    s_mov_b32 s48, 107741184
    buffer_load_dwordx4 v[32:35], v5, s[4:7], s48 offen sc1
    buffer_load_dwordx4 v[68:71], v6, s[4:7], s48 offen sc1
    buffer_load_dwordx4 v[104:107], v7, s[4:7], s48 offen sc1
    s_mov_b32 s48, 110100480
    buffer_load_dwordx4 v[36:39], v5, s[4:7], s48 offen sc1
    buffer_load_dwordx4 v[72:75], v6, s[4:7], s48 offen sc1
    buffer_load_dwordx4 v[108:111], v7, s[4:7], s48 offen sc1
    s_mov_b32 s48, 112459776
    buffer_load_dwordx4 v[40:43], v5, s[4:7], s48 offen sc1
    buffer_load_dwordx4 v[76:79], v6, s[4:7], s48 offen sc1
    buffer_load_dwordx4 v[112:115], v7, s[4:7], s48 offen sc1
    s_mov_b32 s48, 114819072
    buffer_load_dwordx4 v[44:47], v5, s[4:7], s48 offen sc1
    buffer_load_dwordx4 v[80:83], v6, s[4:7], s48 offen sc1
    buffer_load_dwordx4 v[116:119], v7, s[4:7], s48 offen sc1
    s_mov_b32 s48, 117178368
    buffer_load_dwordx4 v[48:51], v5, s[4:7], s48 offen sc1
    buffer_load_dwordx4 v[84:87], v6, s[4:7], s48 offen sc1
    buffer_load_dwordx4 v[120:123], v7, s[4:7], s48 offen sc1
    v_lshlrev_b32 v128, 16, v16
    v_and_b32 v129, 0xffff0000, v16
    v_lshlrev_b32 v130, 16, v17
    v_and_b32 v131, 0xffff0000, v17
    v_lshlrev_b32 v132, 16, v18
    v_and_b32 v133, 0xffff0000, v18
    v_lshlrev_b32 v134, 16, v19
    v_and_b32 v135, 0xffff0000, v19
    v_lshlrev_b32 v136, 16, v52
    v_and_b32 v137, 0xffff0000, v52
    v_lshlrev_b32 v138, 16, v53
    v_and_b32 v139, 0xffff0000, v53
    v_lshlrev_b32 v140, 16, v54
    v_and_b32 v141, 0xffff0000, v54
    v_lshlrev_b32 v142, 16, v55
    v_and_b32 v143, 0xffff0000, v55
    v_lshlrev_b32 v144, 16, v88
    v_and_b32 v145, 0xffff0000, v88
    v_lshlrev_b32 v146, 16, v89
    v_and_b32 v147, 0xffff0000, v89
    v_lshlrev_b32 v148, 16, v90
    v_and_b32 v149, 0xffff0000, v90
    v_lshlrev_b32 v150, 16, v91
    v_and_b32 v151, 0xffff0000, v91
    v_mov_b32 v12, 0x3f80
    v_mov_b32 v13, 0x3f800000
    s_waitcnt vmcnt(23)
    v_dot2c_f32_bf16 v128, v20, v12
    v_dot2c_f32_bf16 v129, v20, v13
    v_dot2c_f32_bf16 v130, v21, v12
    v_dot2c_f32_bf16 v131, v21, v13
    v_dot2c_f32_bf16 v132, v22, v12
    v_dot2c_f32_bf16 v133, v22, v13
    v_dot2c_f32_bf16 v134, v23, v12
    v_dot2c_f32_bf16 v135, v23, v13
    s_waitcnt vmcnt(22)
    v_dot2c_f32_bf16 v136, v56, v12
    v_dot2c_f32_bf16 v137, v56, v13
    v_dot2c_f32_bf16 v138, v57, v12
    v_dot2c_f32_bf16 v139, v57, v13
    v_dot2c_f32_bf16 v140, v58, v12
    v_dot2c_f32_bf16 v141, v58, v13
    v_dot2c_f32_bf16 v142, v59, v12
    v_dot2c_f32_bf16 v143, v59, v13
    s_waitcnt vmcnt(21)
    v_dot2c_f32_bf16 v144, v92, v12
    v_dot2c_f32_bf16 v145, v92, v13
    v_dot2c_f32_bf16 v146, v93, v12
    v_dot2c_f32_bf16 v147, v93, v13
    v_dot2c_f32_bf16 v148, v94, v12
    v_dot2c_f32_bf16 v149, v94, v13
    v_dot2c_f32_bf16 v150, v95, v12
    v_dot2c_f32_bf16 v151, v95, v13
    s_waitcnt vmcnt(20)
    v_dot2c_f32_bf16 v128, v24, v12
    v_dot2c_f32_bf16 v129, v24, v13
    v_dot2c_f32_bf16 v130, v25, v12
    v_dot2c_f32_bf16 v131, v25, v13
    v_dot2c_f32_bf16 v132, v26, v12
    v_dot2c_f32_bf16 v133, v26, v13
    v_dot2c_f32_bf16 v134, v27, v12
    v_dot2c_f32_bf16 v135, v27, v13
    s_waitcnt vmcnt(19)
    v_dot2c_f32_bf16 v136, v60, v12
    v_dot2c_f32_bf16 v137, v60, v13
    v_dot2c_f32_bf16 v138, v61, v12
    v_dot2c_f32_bf16 v139, v61, v13
    v_dot2c_f32_bf16 v140, v62, v12
    v_dot2c_f32_bf16 v141, v62, v13
    v_dot2c_f32_bf16 v142, v63, v12
    v_dot2c_f32_bf16 v143, v63, v13
    s_waitcnt vmcnt(18)
    v_dot2c_f32_bf16 v144, v96, v12
    v_dot2c_f32_bf16 v145, v96, v13
    v_dot2c_f32_bf16 v146, v97, v12
    v_dot2c_f32_bf16 v147, v97, v13
    v_dot2c_f32_bf16 v148, v98, v12
    v_dot2c_f32_bf16 v149, v98, v13
    v_dot2c_f32_bf16 v150, v99, v12
    v_dot2c_f32_bf16 v151, v99, v13
    s_waitcnt vmcnt(17)
    v_dot2c_f32_bf16 v128, v28, v12
    v_dot2c_f32_bf16 v129, v28, v13
    v_dot2c_f32_bf16 v130, v29, v12
    v_dot2c_f32_bf16 v131, v29, v13
    v_dot2c_f32_bf16 v132, v30, v12
    v_dot2c_f32_bf16 v133, v30, v13
    v_dot2c_f32_bf16 v134, v31, v12
    v_dot2c_f32_bf16 v135, v31, v13
    s_waitcnt vmcnt(16)
    v_dot2c_f32_bf16 v136, v64, v12
    v_dot2c_f32_bf16 v137, v64, v13
    v_dot2c_f32_bf16 v138, v65, v12
    v_dot2c_f32_bf16 v139, v65, v13
    v_dot2c_f32_bf16 v140, v66, v12
    v_dot2c_f32_bf16 v141, v66, v13
    v_dot2c_f32_bf16 v142, v67, v12
    v_dot2c_f32_bf16 v143, v67, v13
    s_waitcnt vmcnt(15)
    v_dot2c_f32_bf16 v144, v100, v12
    v_dot2c_f32_bf16 v145, v100, v13
    v_dot2c_f32_bf16 v146, v101, v12
    v_dot2c_f32_bf16 v147, v101, v13
    v_dot2c_f32_bf16 v148, v102, v12
    v_dot2c_f32_bf16 v149, v102, v13
    v_dot2c_f32_bf16 v150, v103, v12
    v_dot2c_f32_bf16 v151, v103, v13
    s_waitcnt vmcnt(14)
    v_dot2c_f32_bf16 v128, v32, v12
    v_dot2c_f32_bf16 v129, v32, v13
    v_dot2c_f32_bf16 v130, v33, v12
    v_dot2c_f32_bf16 v131, v33, v13
    v_dot2c_f32_bf16 v132, v34, v12
    v_dot2c_f32_bf16 v133, v34, v13
    v_dot2c_f32_bf16 v134, v35, v12
    v_dot2c_f32_bf16 v135, v35, v13
    s_waitcnt vmcnt(13)
    v_dot2c_f32_bf16 v136, v68, v12
    v_dot2c_f32_bf16 v137, v68, v13
    v_dot2c_f32_bf16 v138, v69, v12
    v_dot2c_f32_bf16 v139, v69, v13
    v_dot2c_f32_bf16 v140, v70, v12
    v_dot2c_f32_bf16 v141, v70, v13
    v_dot2c_f32_bf16 v142, v71, v12
    v_dot2c_f32_bf16 v143, v71, v13
    s_waitcnt vmcnt(12)
    v_dot2c_f32_bf16 v144, v104, v12
    v_dot2c_f32_bf16 v145, v104, v13
    v_dot2c_f32_bf16 v146, v105, v12
    v_dot2c_f32_bf16 v147, v105, v13
    v_dot2c_f32_bf16 v148, v106, v12
    v_dot2c_f32_bf16 v149, v106, v13
    v_dot2c_f32_bf16 v150, v107, v12
    v_dot2c_f32_bf16 v151, v107, v13
    s_waitcnt vmcnt(11)
    v_dot2c_f32_bf16 v128, v36, v12
    v_dot2c_f32_bf16 v129, v36, v13
    v_dot2c_f32_bf16 v130, v37, v12
    v_dot2c_f32_bf16 v131, v37, v13
    v_dot2c_f32_bf16 v132, v38, v12
    v_dot2c_f32_bf16 v133, v38, v13
    v_dot2c_f32_bf16 v134, v39, v12
    v_dot2c_f32_bf16 v135, v39, v13
    s_waitcnt vmcnt(10)
    v_dot2c_f32_bf16 v136, v72, v12
    v_dot2c_f32_bf16 v137, v72, v13
    v_dot2c_f32_bf16 v138, v73, v12
    v_dot2c_f32_bf16 v139, v73, v13
    v_dot2c_f32_bf16 v140, v74, v12
    v_dot2c_f32_bf16 v141, v74, v13
    v_dot2c_f32_bf16 v142, v75, v12
    v_dot2c_f32_bf16 v143, v75, v13
    s_waitcnt vmcnt(9)
    v_dot2c_f32_bf16 v144, v108, v12
    v_dot2c_f32_bf16 v145, v108, v13
    v_dot2c_f32_bf16 v146, v109, v12
    v_dot2c_f32_bf16 v147, v109, v13
    v_dot2c_f32_bf16 v148, v110, v12
    v_dot2c_f32_bf16 v149, v110, v13
    v_dot2c_f32_bf16 v150, v111, v12
    v_dot2c_f32_bf16 v151, v111, v13
    s_waitcnt vmcnt(8)
    v_dot2c_f32_bf16 v128, v40, v12
    v_dot2c_f32_bf16 v129, v40, v13
    v_dot2c_f32_bf16 v130, v41, v12
    v_dot2c_f32_bf16 v131, v41, v13
    v_dot2c_f32_bf16 v132, v42, v12
    v_dot2c_f32_bf16 v133, v42, v13
    v_dot2c_f32_bf16 v134, v43, v12
    v_dot2c_f32_bf16 v135, v43, v13
    s_waitcnt vmcnt(7)
    v_dot2c_f32_bf16 v136, v76, v12
    v_dot2c_f32_bf16 v137, v76, v13
    v_dot2c_f32_bf16 v138, v77, v12
    v_dot2c_f32_bf16 v139, v77, v13
    v_dot2c_f32_bf16 v140, v78, v12
    v_dot2c_f32_bf16 v141, v78, v13
    v_dot2c_f32_bf16 v142, v79, v12
    v_dot2c_f32_bf16 v143, v79, v13
    s_waitcnt vmcnt(6)
    v_dot2c_f32_bf16 v144, v112, v12
    v_dot2c_f32_bf16 v145, v112, v13
    v_dot2c_f32_bf16 v146, v113, v12
    v_dot2c_f32_bf16 v147, v113, v13
    v_dot2c_f32_bf16 v148, v114, v12
    v_dot2c_f32_bf16 v149, v114, v13
    v_dot2c_f32_bf16 v150, v115, v12
    v_dot2c_f32_bf16 v151, v115, v13
    s_waitcnt vmcnt(5)
    v_dot2c_f32_bf16 v128, v44, v12
    v_dot2c_f32_bf16 v129, v44, v13
    v_dot2c_f32_bf16 v130, v45, v12
    v_dot2c_f32_bf16 v131, v45, v13
    v_dot2c_f32_bf16 v132, v46, v12
    v_dot2c_f32_bf16 v133, v46, v13
    v_dot2c_f32_bf16 v134, v47, v12
    v_dot2c_f32_bf16 v135, v47, v13
    s_waitcnt vmcnt(4)
    v_dot2c_f32_bf16 v136, v80, v12
    v_dot2c_f32_bf16 v137, v80, v13
    v_dot2c_f32_bf16 v138, v81, v12
    v_dot2c_f32_bf16 v139, v81, v13
    v_dot2c_f32_bf16 v140, v82, v12
    v_dot2c_f32_bf16 v141, v82, v13
    v_dot2c_f32_bf16 v142, v83, v12
    v_dot2c_f32_bf16 v143, v83, v13
    s_waitcnt vmcnt(3)
    v_dot2c_f32_bf16 v144, v116, v12
    v_dot2c_f32_bf16 v145, v116, v13
    v_dot2c_f32_bf16 v146, v117, v12
    v_dot2c_f32_bf16 v147, v117, v13
    v_dot2c_f32_bf16 v148, v118, v12
    v_dot2c_f32_bf16 v149, v118, v13
    v_dot2c_f32_bf16 v150, v119, v12
    v_dot2c_f32_bf16 v151, v119, v13
    s_waitcnt vmcnt(2)
    v_dot2c_f32_bf16 v128, v48, v12
    v_dot2c_f32_bf16 v129, v48, v13
    v_dot2c_f32_bf16 v130, v49, v12
    v_dot2c_f32_bf16 v131, v49, v13
    v_dot2c_f32_bf16 v132, v50, v12
    v_dot2c_f32_bf16 v133, v50, v13
    v_dot2c_f32_bf16 v134, v51, v12
    v_dot2c_f32_bf16 v135, v51, v13
    s_waitcnt vmcnt(1)
    v_dot2c_f32_bf16 v136, v84, v12
    v_dot2c_f32_bf16 v137, v84, v13
    v_dot2c_f32_bf16 v138, v85, v12
    v_dot2c_f32_bf16 v139, v85, v13
    v_dot2c_f32_bf16 v140, v86, v12
    v_dot2c_f32_bf16 v141, v86, v13
    v_dot2c_f32_bf16 v142, v87, v12
    v_dot2c_f32_bf16 v143, v87, v13
    s_waitcnt vmcnt(0)
    v_dot2c_f32_bf16 v144, v120, v12
    v_dot2c_f32_bf16 v145, v120, v13
    v_dot2c_f32_bf16 v146, v121, v12
    v_dot2c_f32_bf16 v147, v121, v13
    v_dot2c_f32_bf16 v148, v122, v12
    v_dot2c_f32_bf16 v149, v122, v13
    v_dot2c_f32_bf16 v150, v123, v12
    v_dot2c_f32_bf16 v151, v123, v13
    s_mov_b32 s16, s38
    s_mov_b32 s17, s39
    s_mov_b32 s18, 0x240000
    s_mov_b32 s19, 0x20000
    v_cvt_pk_bf16_f32 v160, v128, v129
    v_cvt_pk_bf16_f32 v161, v130, v131
    v_cvt_pk_bf16_f32 v162, v132, v133
    v_cvt_pk_bf16_f32 v163, v134, v135
    buffer_store_dwordx4 v[160:163], v3, s[16:19], 0 offen offset:0
    v_cvt_pk_bf16_f32 v164, v136, v137
    v_cvt_pk_bf16_f32 v165, v138, v139
    v_cvt_pk_bf16_f32 v166, v140, v141
    v_cvt_pk_bf16_f32 v167, v142, v143
    buffer_store_dwordx4 v[164:167], v3, s[16:19], 0 offen offset:128
    v_cvt_pk_bf16_f32 v168, v144, v145
    v_cvt_pk_bf16_f32 v169, v146, v147
    v_cvt_pk_bf16_f32 v170, v148, v149
    v_cvt_pk_bf16_f32 v171, v150, v151
    buffer_store_dwordx4 v[168:171], v3, s[16:19], 0 offen offset:256
L_w3a_105:
    s_waitcnt vmcnt(0) lgkmcnt(0)
interleave_layers__sliding_local_dilated__glu_gated_bilinear__prompt_kernel_end:
    s_endpgm
L_pn_slow_27:
    s_mov_b32 s97, 0x40000
L_pn_spin_29:
    global_load_dwordx2 v[6:7], v5, s[40:41] sc1
    s_waitcnt vmcnt(0)
    v_cmp_ne_u64 vcc, 0, v[6:7]
    s_sub_u32 s97, s97, 1
    s_cbranch_scc1 L_pn_back_28
    s_cmp_eq_u64 vcc, exec
    s_cbranch_scc1 L_pn_back_28
    s_branch L_pn_spin_29
L_pwo_slow_40:
    s_mov_b32 s97, 0x40000
L_pwo_spin_42:
    buffer_load_dwordx2 v[14:15], v13, s[4:7], s23 offen sc1
    s_waitcnt vmcnt(0)
    v_cmp_eq_u64 vcc, s[98:99], v[14:15]
    s_sub_u32 s97, s97, 1
    s_cbranch_scc1 L_pwo_back_41
    s_cmp_eq_u64 vcc, exec
    s_cbranch_scc1 L_pwo_back_41
    s_branch L_pwo_spin_42
L_px_slow_43:
    s_mov_b32 s97, 0x40000
L_px_spin_45:
    buffer_load_dwordx2 v[12:13], v11, s[4:7], s23 offen sc1
    s_waitcnt vmcnt(0)
    v_cmp_eq_u64 vcc, s[98:99], v[12:13]
    s_sub_u32 s97, s97, 1
    s_cbranch_scc1 L_px_back_44
    s_cmp_eq_u64 vcc, exec
    s_cbranch_scc1 L_px_back_44
    s_branch L_px_spin_45
L_pw_slow_52:
    s_mov_b32 s97, 0x40000
L_pw_spin_54:
    buffer_load_dwordx2 v[12:13], v14, s[4:7], s1 offen sc1
    s_waitcnt vmcnt(0)
    v_cmp_eq_u64 vcc, s[98:99], v[12:13]
    s_sub_u32 s97, s97, 1
    s_cbranch_scc1 L_pw_back_53
    s_cmp_eq_u64 vcc, exec
    s_cbranch_scc1 L_pw_back_53
    s_branch L_pw_spin_54
L_po_slow_55:
    s_mov_b32 s97, 0x40000
L_po_spin_57:
    buffer_load_dwordx2 v[12:13], v10, s[4:7], s52 offen sc1
    s_waitcnt vmcnt(0)
    v_cmp_eq_u64 vcc, s[98:99], v[12:13]
    s_sub_u32 s97, s97, 1
    s_cbranch_scc1 L_po_back_56
    s_cmp_eq_u64 vcc, exec
    s_cbranch_scc1 L_po_back_56
    s_branch L_po_spin_57
L_p1_slow_75:
    s_mov_b32 s97, 0x40000
L_p1_spin_77:
    buffer_load_dwordx2 v[6:7], v0, s[4:7], s55 offen sc1
    s_waitcnt vmcnt(0)
    v_cmp_eq_u64 vcc, s[98:99], v[6:7]
    s_sub_u32 s97, s97, 1
    s_cbranch_scc1 L_p1_back_76
    s_cmp_eq_u64 vcc, exec
    s_cbranch_scc1 L_p1_back_76
    s_branch L_p1_spin_77
L_pd_slow_79:
    s_mov_b32 s97, 0x40000
L_pd_spin_81:
    buffer_load_dwordx2 v[6:7], v0, s[4:7], s55 offen sc1
    s_waitcnt vmcnt(0)
    v_cmp_eq_u64 vcc, s[98:99], v[6:7]
    s_sub_u32 s97, s97, 1
    s_cbranch_scc1 L_pd_back_80
    s_cmp_eq_u64 vcc, exec
    s_cbranch_scc1 L_pd_back_80
    s_branch L_pd_spin_81
L_p0_slow_82:
    s_mov_b32 s97, 0x40000
L_p0_spin_84:
    buffer_load_dwordx2 v[6:7], v0, s[4:7], s55 offen sc1
    s_waitcnt vmcnt(0)
    v_cmp_eq_u64 vcc, s[98:99], v[6:7]
    s_sub_u32 s97, s97, 1
    s_cbranch_scc1 L_p0_back_83
    s_cmp_eq_u64 vcc, exec
    s_cbranch_scc1 L_p0_back_83
    s_branch L_p0_spin_84
L_p1_slow_85:
    s_mov_b32 s97, 0x40000
L_p1_spin_87:
    buffer_load_dwordx2 v[6:7], v0, s[4:7], s55 offen sc1
    s_waitcnt vmcnt(0)
    v_cmp_eq_u64 vcc, s[98:99], v[6:7]
    s_sub_u32 s97, s97, 1
    s_cbranch_scc1 L_p1_back_86
    s_cmp_eq_u64 vcc, exec
    s_cbranch_scc1 L_p1_back_86
    s_branch L_p1_spin_87
L_p2_slow_88:
    s_mov_b32 s97, 0x40000
L_p2_spin_90:
    buffer_load_dwordx2 v[6:7], v0, s[4:7], s55 offen sc1
    s_waitcnt vmcnt(0)
    v_cmp_eq_u64 vcc, s[98:99], v[6:7]
    s_sub_u32 s97, s97, 1
    s_cbranch_scc1 L_p2_back_89
    s_cmp_eq_u64 vcc, exec
    s_cbranch_scc1 L_p2_back_89
    s_branch L_p2_spin_90
L_pp_slow_92:
    s_mov_b32 s97, 0x40000
L_pp_spin_94:
    buffer_load_dwordx2 v[8:9], v10, s[4:7], s49 offen sc1
    s_waitcnt vmcnt(0)
    v_cmp_eq_u64 vcc, s[98:99], v[8:9]
    s_sub_u32 s97, s97, 1
    s_cbranch_scc1 L_pp_back_93
    s_cmp_eq_u64 vcc, exec
    s_cbranch_scc1 L_pp_back_93
    s_branch L_pp_spin_94
L_px_slow_97:
    s_mov_b32 s97, 0x40000
L_px_spin_99:
    buffer_load_dwordx2 v[12:13], v11, s[4:7], s23 offen sc1
    s_waitcnt vmcnt(0)
    v_cmp_eq_u64 vcc, s[98:99], v[12:13]
    s_sub_u32 s97, s97, 1
    s_cbranch_scc1 L_px_back_98
    s_cmp_eq_u64 vcc, exec
    s_cbranch_scc1 L_px_back_98
    s_branch L_px_spin_99
L_po_slow_102:
    s_mov_b32 s97, 0x40000
L_po_spin_104:
    buffer_load_dwordx2 v[12:13], v10, s[4:7], s52 offen sc1
    s_waitcnt vmcnt(0)
    v_cmp_eq_u64 vcc, s[98:99], v[12:13]
    s_sub_u32 s97, s97, 1
    s_cbranch_scc1 L_po_back_103
    s_cmp_eq_u64 vcc, exec
    s_cbranch_scc1 L_po_back_103
    s_branch L_po_spin_104
L_pp_slow_106:
    s_mov_b32 s97, 0x40000
L_pp_spin_108:
    buffer_load_dwordx2 v[8:9], v10, s[4:7], s49 offen sc1
    s_waitcnt vmcnt(0)
    v_cmp_eq_u64 vcc, s[98:99], v[8:9]
    s_sub_u32 s97, s97, 1
    s_cbranch_scc1 L_pp_back_107
    s_cmp_eq_u64 vcc, exec
    s_cbranch_scc1 L_pp_back_107
    s_branch L_pp_spin_108
interleave_layers__sliding_local_dilated__glu_gated_bilinear__prompt_kernel_last:
    s_endpgm
.section .rodata,"a"
.p2align 6
.amdhsa_kernel interleave_layers__sliding_local_dilated__glu_gated_bilinear__prompt_kernel
  .amdhsa_next_free_vgpr 512
  .amdhsa_next_free_sgpr 102
  .amdhsa_accum_offset 256
  .amdhsa_group_segment_fixed_size 0
  .amdhsa_kernarg_size 80
  .amdhsa_user_sgpr_count 2
  .amdhsa_user_sgpr_kernarg_segment_ptr 1
  .amdhsa_system_sgpr_workgroup_id_x 1
  .amdhsa_float_denorm_mode_32 3
.end_amdhsa_kernel
```

```asm
; @launch grid=(256,1,1) block=(256,1,1) lds=163840
.amdgcn_target "amdgcn-amd-amdhsa--gfx950"
.text
.globl interleave_layers__sliding_local_dilated__glu_gated_bilinear__prompt_kernel
.p2align 8
.type interleave_layers__sliding_local_dilated__glu_gated_bilinear__prompt_kernel,@function
interleave_layers__sliding_local_dilated__glu_gated_bilinear__prompt_kernel:
    s_cmp_ge_u32 s2, 256
    s_cbranch_scc1 interleave_layers__sliding_local_dilated__glu_gated_bilinear__prompt_kernel_end
    s_load_dwordx16 s[24:39], s[0:1], 0
    s_load_dwordx4 s[40:43], s[0:1], 64
    v_lshrrev_b32 v1, 6, v0
    s_and_b32 s21, s2, 7
    v_readfirstlane_b32 s20, v1
    s_lshr_b32 s22, s2, 3
    v_and_b32 v1, 63, v0
    v_lshlrev_b32 v2, 4, v1
    s_lshl_b32 s23, s22, 2
    s_add_u32 s23, s23, s20
    s_mul_i32 s23, s23, 5
    v_add_lshl_u32 v219, v1, s23, 7
    s_getpc_b64 s[16:17]
L_pc_1:
    v_min_u32 v219, interleave_layers__sliding_local_dilated__glu_gated_bilinear__prompt_kernel_last-L_pc_1, v219
    s_mov_b64 exec, 31
    global_load_dword v219, v219, s[16:17]
    s_mov_b64 exec, -1
    s_waitcnt lgkmcnt(0)
    s_mov_b32 s4, s42
    s_mov_b32 s5, s43
    s_mov_b32 s6, 0x10000000
    s_mov_b32 s7, 0x20000
    s_mov_b32 s100, 20971520
    s_mov_b32 s101, 0
    s_mov_b32 s8, s24
    s_mov_b32 s9, s25
    s_mov_b32 s10, 0x240000
    s_mov_b32 s11, 0x20000
    s_mov_b32 s12, s26
    s_mov_b32 s13, s27
    s_mov_b32 s14, 0x1e6000
    s_mov_b32 s15, 0x20000
    v_mov_b32 v3, 0
    v_mov_b32 v4, 0
    v_mov_b32 v5, 0
    s_or_b32 s44, s2, s20
    s_cmp_lg_u32 s44, 0
    s_cbranch_scc1 L_nonce_2
    s_memrealtime s[44:45]
    s_waitcnt lgkmcnt(0)
    v_mov_b32 v6, s44
    v_mov_b32 v7, s45
    s_mov_b64 exec, 1
    global_store_dwordx2 v5, v[6:7], s[40:41] sc1
    s_mov_b64 exec, -1
L_nonce_2:
    s_cmp_eq_u32 s20, 3
    s_cbranch_scc1 L_w3_3
    s_lshl_b32 s47, s21, 5
    s_add_u32 s47, s47, s22
    v_and_b32 v6, 7, v1
    v_lshrrev_b32 v7, 3, v1
    s_lshl_b32 s48, s47, 3
    v_add_u32 v3, s48, v6
    v_mul_u32_u24 v3, 1152, v3
    s_mul_i32 s48, s20, 384
    v_lshl_add_u32 v3, v7, 4, v3
    v_add_u32 v3, s48, v3
    s_lshr_b32 s48, s47, 1
    s_mul_i32 s48, s48, 18432
    s_and_b32 s49, s47, 1
    s_lshl_b32 s49, s49, 7
    s_add_u32 s48, s48, s49
    s_mul_i32 s49, s20, 6144
    s_add_u32 s48, s48, s49
    v_lshlrev_b32 v6, 4, v6
    v_lshl_add_u32 v6, v7, 8, v6
    v_add_u32 v4, s48, v6
    buffer_load_dwordx4 v[8:11], v3, s[8:11], 0 offen offset:0 nt
    buffer_load_dwordx4 v[12:15], v3, s[8:11], 0 offen offset:128 nt
    buffer_load_dwordx4 v[16:19], v3, s[8:11], 0 offen offset:256 nt
    s_branch L_uend_4
L_w3_3:
    s_mov_b32 s55, 0
    s_mov_b32 s56, 0
    s_mov_b32 s57, 8192
    s_mul_i32 s67, s21, 36
    s_add_u32 s67, s67, s22
    s_lshr_b32 s0, s67, 4
    s_and_b32 s67, s67, 15
    s_mul_i32 s67, s67, 18
    s_add_u32 s67, s67, s0
    s_mul_i32 s44, s67, 3641
    s_lshr_b32 s44, s44, 16
    s_mul_i32 s45, s44, 18
    s_sub_u32 s45, s67, s45
    s_mul_i32 s46, s44, 72
    s_and_b32 s47, s46, 8
    s_and_b32 s46, s46, -16
    s_mul_i32 s48, s45, 110592
    s_add_u32 s46, s46, s48
    s_mov_b32 s48, 3216
    s_mul_i32 s51, s67, 7168
    s_mov_b32 s12, s26
    s_mov_b32 s13, s27
    s_mov_b32 s14, 0x1e6000
    s_mov_b32 s15, 0x20000
    v_add_u32 v64, 0, v1
    v_mul_u32_u24 v65, 4370, v64
    v_lshrrev_b32 v65, 16, v65
    v_mad_i32_i24 v66, v65, -15, v64
    v_mul_u32_u24 v66, 13108, v66
    v_lshrrev_b32 v66, 16, v66
    v_mul_u32_u24 v66, 1072, v66
    v_mad_u32_u24 v65, v65, s48, v66
    v_lshl_add_u32 v64, v64, 4, v65
    s_add_u32 m0, s56, 0
    s_nop 0
    buffer_load_dwordx4 v64, s[12:15], s46 offen nt lds
    v_add_u32 v64, 64, v1
    v_mul_u32_u24 v65, 4370, v64
    v_lshrrev_b32 v65, 16, v65
    v_mad_i32_i24 v66, v65, -15, v64
    v_mul_u32_u24 v66, 13108, v66
    v_lshrrev_b32 v66, 16, v66
    v_mul_u32_u24 v66, 1072, v66
    v_mad_u32_u24 v65, v65, s48, v66
    v_lshl_add_u32 v64, v64, 4, v65
    s_add_u32 m0, s56, 1024
    s_nop 0
    buffer_load_dwordx4 v64, s[12:15], s46 offen nt lds
    v_add_u32 v64, 128, v1
    v_mul_u32_u24 v65, 4370, v64
    v_lshrrev_b32 v65, 16, v65
    v_mad_i32_i24 v66, v65, -15, v64
    v_mul_u32_u24 v66, 13108, v66
    v_lshrrev_b32 v66, 16, v66
    v_mul_u32_u24 v66, 1072, v66
    v_mad_u32_u24 v65, v65, s48, v66
    v_lshl_add_u32 v64, v64, 4, v65
    s_add_u32 m0, s56, 2048
    s_nop 0
    buffer_load_dwordx4 v64, s[12:15], s46 offen nt lds
    v_add_u32 v64, 192, v1
    v_mul_u32_u24 v65, 4370, v64
    v_lshrrev_b32 v65, 16, v65
    v_mad_i32_i24 v66, v65, -15, v64
    v_mul_u32_u24 v66, 13108, v66
    v_lshrrev_b32 v66, 16, v66
    v_mul_u32_u24 v66, 1072, v66
    v_mad_u32_u24 v65, v65, s48, v66
    v_lshl_add_u32 v64, v64, 4, v65
    s_add_u32 m0, s56, 3072
    s_nop 0
    buffer_load_dwordx4 v64, s[12:15], s46 offen nt lds
    v_add_u32 v64, 256, v1
    v_mul_u32_u24 v65, 4370, v64
    v_lshrrev_b32 v65, 16, v65
    v_mad_i32_i24 v66, v65, -15, v64
    v_mul_u32_u24 v66, 13108, v66
    v_lshrrev_b32 v66, 16, v66
    v_mul_u32_u24 v66, 1072, v66
    v_mad_u32_u24 v65, v65, s48, v66
    v_lshl_add_u32 v64, v64, 4, v65
    s_add_u32 m0, s56, 4096
    s_nop 0
    buffer_load_dwordx4 v64, s[12:15], s46 offen nt lds
    v_add_u32 v64, 320, v1
    v_mul_u32_u24 v65, 4370, v64
    v_lshrrev_b32 v65, 16, v65
    v_mad_i32_i24 v66, v65, -15, v64
    v_mul_u32_u24 v66, 13108, v66
    v_lshrrev_b32 v66, 16, v66
    v_mul_u32_u24 v66, 1072, v66
    v_mad_u32_u24 v65, v65, s48, v66
    v_lshl_add_u32 v64, v64, 4, v65
    s_add_u32 m0, s56, 5120
    s_nop 0
    buffer_load_dwordx4 v64, s[12:15], s46 offen nt lds
    v_add_u32 v64, 384, v1
    v_mul_u32_u24 v65, 4370, v64
    v_lshrrev_b32 v65, 16, v65
    v_mad_i32_i24 v66, v65, -15, v64
    v_mul_u32_u24 v66, 13108, v66
    v_lshrrev_b32 v66, 16, v66
    v_mul_u32_u24 v66, 1072, v66
    v_mad_u32_u24 v65, v65, s48, v66
    v_lshl_add_u32 v64, v64, 4, v65
    s_add_u32 m0, s56, 6144
    s_nop 0
    buffer_load_dwordx4 v64, s[12:15], s46 offen nt lds
    v_add_u32 v64, 448, v1
    v_mul_u32_u24 v65, 4370, v64
    v_lshrrev_b32 v65, 16, v65
    v_mad_i32_i24 v66, v65, -15, v64
    v_mul_u32_u24 v66, 13108, v66
    v_lshrrev_b32 v66, 16, v66
    v_mul_u32_u24 v66, 1072, v66
    v_mad_u32_u24 v65, v65, s48, v66
    v_lshl_add_u32 v64, v64, 4, v65
    s_add_u32 m0, s56, 7168
    s_nop 0
    buffer_load_dwordx4 v64, s[12:15], s46 offen nt lds
    s_lshl_b32 s0, s44, 5
    s_add_u32 s0, s0, s45
    s_lshl_b32 s0, s0, 3
    s_add_u32 s0, s0, 4063232
    s_cmp_ge_u32 s22, 4
    s_cbranch_scc1 L_uw_5
    s_mov_b32 s55, 1
    s_mul_i32 s67, s21, 36
    s_add_u32 s67, s67, s22
    s_add_u32 s67, s67, 32
    s_lshr_b32 s1, s67, 4
    s_and_b32 s67, s67, 15
    s_mul_i32 s67, s67, 18
    s_add_u32 s67, s67, s1
    s_mul_i32 s84, s67, 3641
    s_lshr_b32 s84, s84, 16
    s_mul_i32 s85, s84, 18
    s_sub_u32 s85, s67, s85
    s_mul_i32 s86, s84, 72
    s_and_b32 s87, s86, 8
    s_and_b32 s86, s86, -16
    s_mul_i32 s88, s85, 110592
    s_add_u32 s86, s86, s88
    s_mov_b32 s88, 3216
    s_mul_i32 s91, s67, 7168
    s_mov_b32 s12, s26
    s_mov_b32 s13, s27
    s_mov_b32 s14, 0x1e6000
    s_mov_b32 s15, 0x20000
    v_add_u32 v64, 0, v1
    v_mul_u32_u24 v65, 4370, v64
    v_lshrrev_b32 v65, 16, v65
    v_mad_i32_i24 v66, v65, -15, v64
    v_mul_u32_u24 v66, 13108, v66
    v_lshrrev_b32 v66, 16, v66
    v_mul_u32_u24 v66, 1072, v66
    v_mad_u32_u24 v65, v65, s88, v66
    v_lshl_add_u32 v64, v64, 4, v65
    s_add_u32 m0, s57, 0
    s_nop 0
    buffer_load_dwordx4 v64, s[12:15], s86 offen nt lds
    v_add_u32 v64, 64, v1
    v_mul_u32_u24 v65, 4370, v64
    v_lshrrev_b32 v65, 16, v65
    v_mad_i32_i24 v66, v65, -15, v64
    v_mul_u32_u24 v66, 13108, v66
    v_lshrrev_b32 v66, 16, v66
    v_mul_u32_u24 v66, 1072, v66
    v_mad_u32_u24 v65, v65, s88, v66
    v_lshl_add_u32 v64, v64, 4, v65
    s_add_u32 m0, s57, 1024
    s_nop 0
    buffer_load_dwordx4 v64, s[12:15], s86 offen nt lds
    v_add_u32 v64, 128, v1
    v_mul_u32_u24 v65, 4370, v64
    v_lshrrev_b32 v65, 16, v65
    v_mad_i32_i24 v66, v65, -15, v64
    v_mul_u32_u24 v66, 13108, v66
    v_lshrrev_b32 v66, 16, v66
    v_mul_u32_u24 v66, 1072, v66
    v_mad_u32_u24 v65, v65, s88, v66
    v_lshl_add_u32 v64, v64, 4, v65
    s_add_u32 m0, s57, 2048
    s_nop 0
    buffer_load_dwordx4 v64, s[12:15], s86 offen nt lds
    v_add_u32 v64, 192, v1
    v_mul_u32_u24 v65, 4370, v64
    v_lshrrev_b32 v65, 16, v65
    v_mad_i32_i24 v66, v65, -15, v64
    v_mul_u32_u24 v66, 13108, v66
    v_lshrrev_b32 v66, 16, v66
    v_mul_u32_u24 v66, 1072, v66
    v_mad_u32_u24 v65, v65, s88, v66
    v_lshl_add_u32 v64, v64, 4, v65
    s_add_u32 m0, s57, 3072
    s_nop 0
    buffer_load_dwordx4 v64, s[12:15], s86 offen nt lds
    v_add_u32 v64, 256, v1
    v_mul_u32_u24 v65, 4370, v64
    v_lshrrev_b32 v65, 16, v65
    v_mad_i32_i24 v66, v65, -15, v64
    v_mul_u32_u24 v66, 13108, v66
    v_lshrrev_b32 v66, 16, v66
    v_mul_u32_u24 v66, 1072, v66
    v_mad_u32_u24 v65, v65, s88, v66
    v_lshl_add_u32 v64, v64, 4, v65
    s_add_u32 m0, s57, 4096
    s_nop 0
    buffer_load_dwordx4 v64, s[12:15], s86 offen nt lds
    v_add_u32 v64, 320, v1
    v_mul_u32_u24 v65, 4370, v64
    v_lshrrev_b32 v65, 16, v65
    v_mad_i32_i24 v66, v65, -15, v64
    v_mul_u32_u24 v66, 13108, v66
    v_lshrrev_b32 v66, 16, v66
    v_mul_u32_u24 v66, 1072, v66
    v_mad_u32_u24 v65, v65, s88, v66
    v_lshl_add_u32 v64, v64, 4, v65
    s_add_u32 m0, s57, 5120
    s_nop 0
    buffer_load_dwordx4 v64, s[12:15], s86 offen nt lds
    v_add_u32 v64, 384, v1
    v_mul_u32_u24 v65, 4370, v64
    v_lshrrev_b32 v65, 16, v65
    v_mad_i32_i24 v66, v65, -15, v64
    v_mul_u32_u24 v66, 13108, v66
    v_lshrrev_b32 v66, 16, v66
    v_mul_u32_u24 v66, 1072, v66
    v_mad_u32_u24 v65, v65, s88, v66
    v_lshl_add_u32 v64, v64, 4, v65
    s_add_u32 m0, s57, 6144
    s_nop 0
    buffer_load_dwordx4 v64, s[12:15], s86 offen nt lds
    v_add_u32 v64, 448, v1
    v_mul_u32_u24 v65, 4370, v64
    v_lshrrev_b32 v65, 16, v65
    v_mad_i32_i24 v66, v65, -15, v64
    v_mul_u32_u24 v66, 13108, v66
    v_lshrrev_b32 v66, 16, v66
    v_mul_u32_u24 v66, 1072, v66
    v_mad_u32_u24 v65, v65, s88, v66
    v_lshl_add_u32 v64, v64, 4, v65
    s_add_u32 m0, s57, 7168
    s_nop 0
    buffer_load_dwordx4 v64, s[12:15], s86 offen nt lds
    s_lshl_b32 s1, s84, 5
    s_add_u32 s1, s1, s85
    s_lshl_b32 s1, s1, 3
    s_add_u32 s1, s1, 4063232
    s_branch L_uend_4
L_uw_5:
    s_cmp_ge_u32 s22, 18
    s_cbranch_scc1 L_uend_4
    s_mul_i32 s67, s21, 14
    s_add_u32 s67, s67, s22
    s_sub_u32 s67, s67, 4
    s_cmp_ge_u32 s67, 108
    s_cbranch_scc1 L_uend_4
    s_mov_b32 s55, 2
    s_mul_i32 s84, s67, 3641
    s_lshr_b32 s84, s84, 16
    s_mul_i32 s85, s84, 18
    s_sub_u32 s85, s67, s85
    s_mul_i32 s86, s85, 41472
    s_sub_u32 s87, s85, 16
    s_mul_i32 s87, s87, 331776
    s_add_u32 s87, s87, 18432
    s_cmp_lt_u32 s85, 16
    s_cselect_b32 s86, s86, s87
    s_mov_b32 s88, 82944
    s_mov_b32 s89, 41472
    s_cselect_b32 s88, 4608, s88
    s_cselect_b32 s89, 23040, s89
    s_mul_i32 s87, s84, 192
    s_add_u32 s86, s86, s87
    s_mov_b32 s90, 1152
    s_mul_i32 s91, s67, 6144
    s_mov_b32 s12, s28
    s_mov_b32 s13, s29
    s_mov_b32 s14, 0xa2000
    s_mov_b32 s15, 0x20000
    v_add_u32 v64, 0, v1
    v_mul_u32_u24 v65, 5462, v64
    v_lshrrev_b32 v65, 16, v65
    v_mul_u32_u24 v66, 12, v65
    v_sub_u32 v64, v64, v66
    v_lshlrev_b32 v64, 4, v64
    v_lshrrev_b32 v66, 3, v65
    v_mul_lo_u32 v66, v66, s88
    v_bfe_u32 v67, v65, 2, 1
    v_mul_lo_u32 v67, v67, s89
    v_and_b32 v65, 3, v65
    v_mul_lo_u32 v65, v65, s90
    v_add3_u32 v64, v64, v66, v67
    v_add3_u32 v64, v64, v65, s86
    s_add_u32 m0, s57, 0
    s_nop 0
    buffer_load_dwordx4 v64, s[12:15], 0 offen nt lds
    v_add_u32 v64, 64, v1
    v_mul_u32_u24 v65, 5462, v64
    v_lshrrev_b32 v65, 16, v65
    v_mul_u32_u24 v66, 12, v65
    v_sub_u32 v64, v64, v66
    v_lshlrev_b32 v64, 4, v64
    v_lshrrev_b32 v66, 3, v65
    v_mul_lo_u32 v66, v66, s88
    v_bfe_u32 v67, v65, 2, 1
    v_mul_lo_u32 v67, v67, s89
    v_and_b32 v65, 3, v65
    v_mul_lo_u32 v65, v65, s90
    v_add3_u32 v64, v64, v66, v67
    v_add3_u32 v64, v64, v65, s86
    s_add_u32 m0, s57, 1024
    s_nop 0
    buffer_load_dwordx4 v64, s[12:15], 0 offen nt lds
    v_add_u32 v64, 128, v1
    v_mul_u32_u24 v65, 5462, v64
    v_lshrrev_b32 v65, 16, v65
    v_mul_u32_u24 v66, 12, v65
    v_sub_u32 v64, v64, v66
    v_lshlrev_b32 v64, 4, v64
    v_lshrrev_b32 v66, 3, v65
    v_mul_lo_u32 v66, v66, s88
    v_bfe_u32 v67, v65, 2, 1
    v_mul_lo_u32 v67, v67, s89
    v_and_b32 v65, 3, v65
    v_mul_lo_u32 v65, v65, s90
    v_add3_u32 v64, v64, v66, v67
    v_add3_u32 v64, v64, v65, s86
    s_add_u32 m0, s57, 2048
    s_nop 0
    buffer_load_dwordx4 v64, s[12:15], 0 offen nt lds
    v_add_u32 v64, 192, v1
    v_mul_u32_u24 v65, 5462, v64
    v_lshrrev_b32 v65, 16, v65
    v_mul_u32_u24 v66, 12, v65
    v_sub_u32 v64, v64, v66
    v_lshlrev_b32 v64, 4, v64
    v_lshrrev_b32 v66, 3, v65
    v_mul_lo_u32 v66, v66, s88
    v_bfe_u32 v67, v65, 2, 1
    v_mul_lo_u32 v67, v67, s89
    v_and_b32 v65, 3, v65
    v_mul_lo_u32 v65, v65, s90
    v_add3_u32 v64, v64, v66, v67
    v_add3_u32 v64, v64, v65, s86
    s_add_u32 m0, s57, 3072
    s_nop 0
    buffer_load_dwordx4 v64, s[12:15], 0 offen nt lds
    v_add_u32 v64, 256, v1
    v_mul_u32_u24 v65, 5462, v64
    v_lshrrev_b32 v65, 16, v65
    v_mul_u32_u24 v66, 12, v65
    v_sub_u32 v64, v64, v66
    v_lshlrev_b32 v64, 4, v64
    v_lshrrev_b32 v66, 3, v65
    v_mul_lo_u32 v66, v66, s88
    v_bfe_u32 v67, v65, 2, 1
    v_mul_lo_u32 v67, v67, s89
    v_and_b32 v65, 3, v65
    v_mul_lo_u32 v65, v65, s90
    v_add3_u32 v64, v64, v66, v67
    v_add3_u32 v64, v64, v65, s86
    s_add_u32 m0, s57, 4096
    s_nop 0
    buffer_load_dwordx4 v64, s[12:15], 0 offen nt lds
    v_add_u32 v64, 320, v1
    v_mul_u32_u24 v65, 5462, v64
    v_lshrrev_b32 v65, 16, v65
    v_mul_u32_u24 v66, 12, v65
    v_sub_u32 v64, v64, v66
    v_lshlrev_b32 v64, 4, v64
    v_lshrrev_b32 v66, 3, v65
    v_mul_lo_u32 v66, v66, s88
    v_bfe_u32 v67, v65, 2, 1
    v_mul_lo_u32 v67, v67, s89
    v_and_b32 v65, 3, v65
    v_mul_lo_u32 v65, v65, s90
    v_add3_u32 v64, v64, v66, v67
    v_add3_u32 v64, v64, v65, s86
    s_add_u32 m0, s57, 5120
    s_nop 0
    buffer_load_dwordx4 v64, s[12:15], 0 offen nt lds
    s_lshl_b32 s1, s84, 5
    s_add_u32 s1, s1, s85
    s_lshl_b32 s1, s1, 3
    s_add_u32 s1, s1, 4067328
L_uend_4:
    v_add_u32 v64, 0, v1
    v_mul_u32_u24 v65, 3641, v64
    v_lshrrev_b32 v65, 16, v65
    v_mul_u32_u24 v66, 18, v65
    v_sub_u32 v64, v64, v66
    v_lshl_or_b32 v220, v64, 8, v65
    v_add_u32 v64, 64, v1
    v_mul_u32_u24 v65, 3641, v64
    v_lshrrev_b32 v65, 16, v65
    v_mul_u32_u24 v66, 18, v65
    v_sub_u32 v64, v64, v66
    v_lshl_or_b32 v221, v64, 8, v65
    v_add_u32 v64, 128, v1
    v_mul_u32_u24 v65, 3641, v64
    v_lshrrev_b32 v65, 16, v65
    v_mul_u32_u24 v66, 18, v65
    v_sub_u32 v64, v64, v66
    v_lshl_or_b32 v222, v64, 8, v65
    v_add_u32 v64, 192, v1
    v_mul_u32_u24 v65, 3641, v64
    v_lshrrev_b32 v65, 16, v65
    v_mul_u32_u24 v66, 18, v65
    v_sub_u32 v64, v64, v66
    v_lshl_or_b32 v223, v64, 8, v65
    v_add_u32 v64, 256, v1
    v_mul_u32_u24 v65, 3641, v64
    v_lshrrev_b32 v65, 16, v65
    v_mul_u32_u24 v66, 18, v65
    v_sub_u32 v64, v64, v66
    v_lshl_or_b32 v224, v64, 8, v65
    v_add_u32 v64, 320, v1
    v_mul_u32_u24 v65, 3641, v64
    v_lshrrev_b32 v65, 16, v65
    v_mul_u32_u24 v66, 18, v65
    v_sub_u32 v64, v64, v66
    v_lshl_or_b32 v225, v64, 8, v65
    v_add_u32 v64, 384, v1
    v_mul_u32_u24 v65, 3641, v64
    v_lshrrev_b32 v65, 16, v65
    v_mul_u32_u24 v66, 18, v65
    v_sub_u32 v64, v64, v66
    v_lshl_or_b32 v226, v64, 8, v65
    v_add_u32 v64, 448, v1
    v_mul_u32_u24 v65, 3641, v64
    v_lshrrev_b32 v65, 16, v65
    v_mul_u32_u24 v66, 18, v65
    v_sub_u32 v64, v64, v66
    v_lshl_or_b32 v227, v64, 8, v65
    v_add_u32 v64, 512, v1
    v_mul_u32_u24 v65, 3641, v64
    v_lshrrev_b32 v65, 16, v65
    v_mul_u32_u24 v66, 18, v65
    v_sub_u32 v64, v64, v66
    v_lshl_or_b32 v228, v64, 8, v65
    s_lshl_b32 s3, s21, 7
    s_lshl_b32 s52, s22, 2
    s_add_u32 s53, s52, s20
    s_add_u32 s3, s3, s53
    s_lshr_b32 s52, s3, 5
    s_and_b32 s3, s3, 31
    s_mul_i32 s3, s3, 36
    s_add_u32 s3, s3, s52
    s_cmp_ge_u32 s3, 1152
    s_cbranch_scc1 L_ud_6
    s_mul_i32 s64, s3, 1821
    s_lshr_b32 s64, s64, 16
    s_mul_i32 s92, s64, 36
    s_sub_u32 s92, s3, s92
    s_and_b32 s93, s92, 1
    s_lshr_b32 s94, s92, 1
    s_cmp_eq_u32 s93, 0
    s_cselect_b32 s16, s32, s34
    s_cselect_b32 s17, s33, s35
    s_mul_i32 s58, s94, 294912
    s_mul_i32 s95, s64, 288
    s_add_u32 s58, s58, s95
    s_mov_b32 s59, 73728
    s_mov_b32 s60, 36864
    s_mov_b32 s61, 9216
    s_branch L_udone_7
L_ud_6:
    s_sub_u32 s92, s3, 1152
    s_mul_i32 s64, s92, 3641
    s_lshr_b32 s64, s64, 16
    s_mul_i32 s93, s64, 18
    s_sub_u32 s92, s92, s93
    s_and_b32 s93, s64, 3
    s_and_b32 s94, s93, 1
    s_mov_b32 s16, s36
    s_mov_b32 s17, s37
    s_mov_b32 s61, 1152
    s_cmp_eq_u32 s94, 0
    s_mov_b32 s97, -165888
    s_cselect_b32 s97, 165888, s97
    s_mov_b32 s59, 9216
    s_mov_b32 s60, 4608
    s_cmp_ge_u32 s92, 4
    s_cbranch_scc1 L_ush_8
    s_mov_b32 s95, s93
    s_lshl_b32 s96, s92, 5
    s_branch L_urows_10
L_ush_8:
    s_cmp_ge_u32 s92, 6
    s_cbranch_scc1 L_urm_9
    s_sub_u32 s95, s92, 4
    s_lshl_b32 s95, s95, 1
    s_xor_b32 s95, s95, s93
    s_mov_b32 s96, 128
    s_mov_b32 s59, 4608
    s_mov_b32 s60, s97
    s_branch L_urows_10
L_urm_9:
    s_sub_u32 s95, s92, 6
    s_mul_i32 s96, s95, 21846
    s_lshr_b32 s96, s96, 16
    s_mul_i32 s97, s96, 3
    s_sub_u32 s95, s95, s97
    s_add_u32 s95, s95, 1
    s_xor_b32 s95, s95, s93
    s_lshl_b32 s96, s96, 5
L_urows_10:
    s_mul_i32 s95, s95, 144
    s_add_u32 s95, s95, s96
    s_lshr_b32 s96, s64, 2
    s_mul_i32 s96, s96, 576
    s_add_u32 s95, s95, s96
    s_mul_i32 s95, s95, 1152
    s_mul_i32 s96, s93, 288
    s_add_u32 s58, s95, s96
L_udone_7:
    s_mov_b32 s18, 0x510000
    s_mov_b32 s19, 0x20000
    v_bfe_u32 v64, v220, 3, 2
    v_mul_u32_u24 v64, s59, v64
    v_bfe_u32 v65, v220, 2, 1
    v_mul_lo_u32 v65, v65, s60
    v_and_b32 v66, 3, v220
    v_mul_u32_u24 v66, s61, v66
    v_add3_u32 v64, v64, v65, v66
    v_lshrrev_b32 v65, 8, v220
    v_lshl_add_u32 v64, v65, 4, v64
    v_add_u32 v229, s58, v64
    v_bfe_u32 v64, v221, 3, 2
    v_mul_u32_u24 v64, s59, v64
    v_bfe_u32 v65, v221, 2, 1
    v_mul_lo_u32 v65, v65, s60
    v_and_b32 v66, 3, v221
    v_mul_u32_u24 v66, s61, v66
    v_add3_u32 v64, v64, v65, v66
    v_lshrrev_b32 v65, 8, v221
    v_lshl_add_u32 v64, v65, 4, v64
    v_add_u32 v230, s58, v64
    v_bfe_u32 v64, v222, 3, 2
    v_mul_u32_u24 v64, s59, v64
    v_bfe_u32 v65, v222, 2, 1
    v_mul_lo_u32 v65, v65, s60
    v_and_b32 v66, 3, v222
    v_mul_u32_u24 v66, s61, v66
    v_add3_u32 v64, v64, v65, v66
    v_lshrrev_b32 v65, 8, v222
    v_lshl_add_u32 v64, v65, 4, v64
    v_add_u32 v231, s58, v64
    v_bfe_u32 v64, v223, 3, 2
    v_mul_u32_u24 v64, s59, v64
    v_bfe_u32 v65, v223, 2, 1
    v_mul_lo_u32 v65, v65, s60
    v_and_b32 v66, 3, v223
    v_mul_u32_u24 v66, s61, v66
    v_add3_u32 v64, v64, v65, v66
    v_lshrrev_b32 v65, 8, v223
    v_lshl_add_u32 v64, v65, 4, v64
    v_add_u32 v232, s58, v64
    v_bfe_u32 v64, v224, 3, 2
    v_mul_u32_u24 v64, s59, v64
    v_bfe_u32 v65, v224, 2, 1
    v_mul_lo_u32 v65, v65, s60
    v_and_b32 v66, 3, v224
    v_mul_u32_u24 v66, s61, v66
    v_add3_u32 v64, v64, v65, v66
    v_lshrrev_b32 v65, 8, v224
    v_lshl_add_u32 v64, v65, 4, v64
    v_add_u32 v233, s58, v64
    v_bfe_u32 v64, v225, 3, 2
    v_mul_u32_u24 v64, s59, v64
    v_bfe_u32 v65, v225, 2, 1
    v_mul_lo_u32 v65, v65, s60
    v_and_b32 v66, 3, v225
    v_mul_u32_u24 v66, s61, v66
    v_add3_u32 v64, v64, v65, v66
    v_lshrrev_b32 v65, 8, v225
    v_lshl_add_u32 v64, v65, 4, v64
    v_add_u32 v234, s58, v64
    v_bfe_u32 v64, v226, 3, 2
    v_mul_u32_u24 v64, s59, v64
    v_bfe_u32 v65, v226, 2, 1
    v_mul_lo_u32 v65, v65, s60
    v_and_b32 v66, 3, v226
    v_mul_u32_u24 v66, s61, v66
    v_add3_u32 v64, v64, v65, v66
    v_lshrrev_b32 v65, 8, v226
    v_lshl_add_u32 v64, v65, 4, v64
    v_add_u32 v235, s58, v64
    v_bfe_u32 v64, v227, 3, 2
    v_mul_u32_u24 v64, s59, v64
    v_bfe_u32 v65, v227, 2, 1
    v_mul_lo_u32 v65, v65, s60
    v_and_b32 v66, 3, v227
    v_mul_u32_u24 v66, s61, v66
    v_add3_u32 v64, v64, v65, v66
    v_lshrrev_b32 v65, 8, v227
    v_lshl_add_u32 v64, v65, 4, v64
    v_add_u32 v236, s58, v64
    v_bfe_u32 v64, v228, 3, 2
    v_mul_u32_u24 v64, s59, v64
    v_bfe_u32 v65, v228, 2, 1
    v_mul_lo_u32 v65, v65, s60
    v_and_b32 v66, 3, v228
    v_mul_u32_u24 v66, s61, v66
    v_add3_u32 v64, v64, v65, v66
    v_lshrrev_b32 v65, 8, v228
    v_lshl_add_u32 v64, v65, 4, v64
    v_add_u32 v237, s58, v64
    s_mov_b32 s30, -1
    s_mov_b32 s31, -1
    s_mul_i32 s54, s21, 72
    s_add_u32 s54, s54, 1152
    s_cmp_ge_u32 s22, 24
    s_cbranch_scc1 L_ui_11
    s_cmp_lg_u32 s20, 3
    s_cbranch_scc1 L_ue_14
    s_add_u32 s30, s54, s22
    s_add_u32 s30, s30, 48
    s_branch L_ub_13
L_ui_11:
    s_sub_u32 s53, s53, 96
    s_add_u32 s31, s54, s53
    s_add_u32 s30, s31, -16
    s_add_u32 s31, s31, 16
    s_cmp_ge_u32 s53, 16
    s_cbranch_scc1 L_ud_12
    s_lshl_b32 s30, s21, 4
    s_add_u32 s30, s30, s53
    s_add_u32 s30, s30, 1024
    s_lshr_b32 s52, s30, 5
    s_and_b32 s30, s30, 31
    s_mul_i32 s30, s30, 36
    s_add_u32 s30, s30, s52
L_ud_12:
L_ub_13:
L_ue_14:
    v_mov_b32 v238, 0
    v_mov_b32 v239, 0
    v_mov_b32 v240, 0
    v_mov_b32 v241, 0
    v_mov_b32 v242, 0
    v_mov_b32 v243, 0
    v_mov_b32 v244, 0
    v_mov_b32 v245, 0
    v_mov_b32 v246, 0
    s_mov_b32 s14, 0
    s_cmp_eq_u32 s30, -1
    s_cbranch_scc1 L_absent_15
    s_cmp_ge_u32 s30, 1152
    s_cbranch_scc1 L_ud_16
    s_mul_i32 s64, s30, 1821
    s_lshr_b32 s64, s64, 16
    s_mul_i32 s92, s64, 36
    s_sub_u32 s92, s30, s92
    s_and_b32 s93, s92, 1
    s_lshr_b32 s94, s92, 1
    s_cmp_eq_u32 s93, 0
    s_cselect_b32 s12, s32, s34
    s_cselect_b32 s13, s33, s35
    s_mul_i32 s58, s94, 294912
    s_mul_i32 s95, s64, 288
    s_add_u32 s58, s58, s95
    s_mov_b32 s59, 73728
    s_mov_b32 s60, 36864
    s_mov_b32 s61, 9216
    s_branch L_udone_17
L_ud_16:
    s_sub_u32 s92, s30, 1152
    s_mul_i32 s64, s92, 3641
    s_lshr_b32 s64, s64, 16
    s_mul_i32 s93, s64, 18
    s_sub_u32 s92, s92, s93
    s_and_b32 s93, s64, 3
    s_and_b32 s94, s93, 1
    s_mov_b32 s12, s36
    s_mov_b32 s13, s37
    s_mov_b32 s61, 1152
    s_cmp_eq_u32 s94, 0
    s_mov_b32 s97, -165888
    s_cselect_b32 s97, 165888, s97
    s_mov_b32 s59, 9216
    s_mov_b32 s60, 4608
    s_cmp_ge_u32 s92, 4
    s_cbranch_scc1 L_ush_18
    s_mov_b32 s95, s93
    s_lshl_b32 s96, s92, 5
    s_branch L_urows_20
L_ush_18:
    s_cmp_ge_u32 s92, 6
    s_cbranch_scc1 L_urm_19
    s_sub_u32 s95, s92, 4
    s_lshl_b32 s95, s95, 1
    s_xor_b32 s95, s95, s93
    s_mov_b32 s96, 128
    s_mov_b32 s59, 4608
    s_mov_b32 s60, s97
    s_branch L_urows_20
L_urm_19:
    s_sub_u32 s95, s92, 6
    s_mul_i32 s96, s95, 21846
    s_lshr_b32 s96, s96, 16
    s_mul_i32 s97, s96, 3
    s_sub_u32 s95, s95, s97
    s_add_u32 s95, s95, 1
    s_xor_b32 s95, s95, s93
    s_lshl_b32 s96, s96, 5
L_urows_20:
    s_mul_i32 s95, s95, 144
    s_add_u32 s95, s95, s96
    s_lshr_b32 s96, s64, 2
    s_mul_i32 s96, s96, 576
    s_add_u32 s95, s95, s96
    s_mul_i32 s95, s95, 1152
    s_mul_i32 s96, s93, 288
    s_add_u32 s58, s95, s96
L_udone_17:
    s_mov_b32 s14, 0x510000
    s_mov_b32 s15, 0x20000
    v_bfe_u32 v64, v220, 3, 2
    v_mul_u32_u24 v64, s59, v64
    v_bfe_u32 v65, v220, 2, 1
    v_mul_lo_u32 v65, v65, s60
    v_and_b32 v66, 3, v220
    v_mul_u32_u24 v66, s61, v66
    v_add3_u32 v64, v64, v65, v66
    v_lshrrev_b32 v65, 8, v220
    v_lshl_add_u32 v64, v65, 4, v64
    v_add_u32 v238, s58, v64
    v_bfe_u32 v64, v221, 3, 2
    v_mul_u32_u24 v64, s59, v64
    v_bfe_u32 v65, v221, 2, 1
    v_mul_lo_u32 v65, v65, s60
    v_and_b32 v66, 3, v221
    v_mul_u32_u24 v66, s61, v66
    v_add3_u32 v64, v64, v65, v66
    v_lshrrev_b32 v65, 8, v221
    v_lshl_add_u32 v64, v65, 4, v64
    v_add_u32 v239, s58, v64
    v_bfe_u32 v64, v222, 3, 2
    v_mul_u32_u24 v64, s59, v64
    v_bfe_u32 v65, v222, 2, 1
    v_mul_lo_u32 v65, v65, s60
    v_and_b32 v66, 3, v222
    v_mul_u32_u24 v66, s61, v66
    v_add3_u32 v64, v64, v65, v66
    v_lshrrev_b32 v65, 8, v222
    v_lshl_add_u32 v64, v65, 4, v64
    v_add_u32 v240, s58, v64
    v_bfe_u32 v64, v223, 3, 2
    v_mul_u32_u24 v64, s59, v64
    v_bfe_u32 v65, v223, 2, 1
    v_mul_lo_u32 v65, v65, s60
    v_and_b32 v66, 3, v223
    v_mul_u32_u24 v66, s61, v66
    v_add3_u32 v64, v64, v65, v66
    v_lshrrev_b32 v65, 8, v223
    v_lshl_add_u32 v64, v65, 4, v64
    v_add_u32 v241, s58, v64
    v_bfe_u32 v64, v224, 3, 2
    v_mul_u32_u24 v64, s59, v64
    v_bfe_u32 v65, v224, 2, 1
    v_mul_lo_u32 v65, v65, s60
    v_and_b32 v66, 3, v224
    v_mul_u32_u24 v66, s61, v66
    v_add3_u32 v64, v64, v65, v66
    v_lshrrev_b32 v65, 8, v224
    v_lshl_add_u32 v64, v65, 4, v64
    v_add_u32 v242, s58, v64
    v_bfe_u32 v64, v225, 3, 2
    v_mul_u32_u24 v64, s59, v64
    v_bfe_u32 v65, v225, 2, 1
    v_mul_lo_u32 v65, v65, s60
    v_and_b32 v66, 3, v225
    v_mul_u32_u24 v66, s61, v66
    v_add3_u32 v64, v64, v65, v66
    v_lshrrev_b32 v65, 8, v225
    v_lshl_add_u32 v64, v65, 4, v64
    v_add_u32 v243, s58, v64
    v_bfe_u32 v64, v226, 3, 2
    v_mul_u32_u24 v64, s59, v64
    v_bfe_u32 v65, v226, 2, 1
    v_mul_lo_u32 v65, v65, s60
    v_and_b32 v66, 3, v226
    v_mul_u32_u24 v66, s61, v66
    v_add3_u32 v64, v64, v65, v66
    v_lshrrev_b32 v65, 8, v226
    v_lshl_add_u32 v64, v65, 4, v64
    v_add_u32 v244, s58, v64
    v_bfe_u32 v64, v227, 3, 2
    v_mul_u32_u24 v64, s59, v64
    v_bfe_u32 v65, v227, 2, 1
    v_mul_lo_u32 v65, v65, s60
    v_and_b32 v66, 3, v227
    v_mul_u32_u24 v66, s61, v66
    v_add3_u32 v64, v64, v65, v66
    v_lshrrev_b32 v65, 8, v227
    v_lshl_add_u32 v64, v65, 4, v64
    v_add_u32 v245, s58, v64
    v_bfe_u32 v64, v228, 3, 2
    v_mul_u32_u24 v64, s59, v64
    v_bfe_u32 v65, v228, 2, 1
    v_mul_lo_u32 v65, v65, s60
    v_and_b32 v66, 3, v228
    v_mul_u32_u24 v66, s61, v66
    v_add3_u32 v64, v64, v65, v66
    v_lshrrev_b32 v65, 8, v228
    v_lshl_add_u32 v64, v65, 4, v64
    v_add_u32 v246, s58, v64
L_absent_15:
    v_mov_b32 v247, 0
    v_mov_b32 v248, 0
    v_mov_b32 v249, 0
    v_mov_b32 v250, 0
    v_mov_b32 v251, 0
    v_mov_b32 v252, 0
    v_mov_b32 v253, 0
    v_mov_b32 v254, 0
    v_mov_b32 v255, 0
    s_mov_b32 s10, 0
    s_cmp_eq_u32 s31, -1
    s_cbranch_scc1 L_absent_21
    s_cmp_ge_u32 s31, 1152
    s_cbranch_scc1 L_ud_22
    s_mul_i32 s64, s31, 1821
    s_lshr_b32 s64, s64, 16
    s_mul_i32 s92, s64, 36
    s_sub_u32 s92, s31, s92
    s_and_b32 s93, s92, 1
    s_lshr_b32 s94, s92, 1
    s_cmp_eq_u32 s93, 0
    s_cselect_b32 s8, s32, s34
    s_cselect_b32 s9, s33, s35
    s_mul_i32 s58, s94, 294912
    s_mul_i32 s95, s64, 288
    s_add_u32 s58, s58, s95
    s_mov_b32 s59, 73728
    s_mov_b32 s60, 36864
    s_mov_b32 s61, 9216
    s_branch L_udone_23
L_ud_22:
    s_sub_u32 s92, s31, 1152
    s_mul_i32 s64, s92, 3641
    s_lshr_b32 s64, s64, 16
    s_mul_i32 s93, s64, 18
    s_sub_u32 s92, s92, s93
    s_and_b32 s93, s64, 3
    s_and_b32 s94, s93, 1
    s_mov_b32 s8, s36
    s_mov_b32 s9, s37
    s_mov_b32 s61, 1152
    s_cmp_eq_u32 s94, 0
    s_mov_b32 s97, -165888
    s_cselect_b32 s97, 165888, s97
    s_mov_b32 s59, 9216
    s_mov_b32 s60, 4608
    s_cmp_ge_u32 s92, 4
    s_cbranch_scc1 L_ush_24
    s_mov_b32 s95, s93
    s_lshl_b32 s96, s92, 5
    s_branch L_urows_26
L_ush_24:
    s_cmp_ge_u32 s92, 6
    s_cbranch_scc1 L_urm_25
    s_sub_u32 s95, s92, 4
    s_lshl_b32 s95, s95, 1
    s_xor_b32 s95, s95, s93
    s_mov_b32 s96, 128
    s_mov_b32 s59, 4608
    s_mov_b32 s60, s97
    s_branch L_urows_26
L_urm_25:
    s_sub_u32 s95, s92, 6
    s_mul_i32 s96, s95, 21846
    s_lshr_b32 s96, s96, 16
    s_mul_i32 s97, s96, 3
    s_sub_u32 s95, s95, s97
    s_add_u32 s95, s95, 1
    s_xor_b32 s95, s95, s93
    s_lshl_b32 s96, s96, 5
L_urows_26:
    s_mul_i32 s95, s95, 144
    s_add_u32 s95, s95, s96
    s_lshr_b32 s96, s64, 2
    s_mul_i32 s96, s96, 576
    s_add_u32 s95, s95, s96
    s_mul_i32 s95, s95, 1152
    s_mul_i32 s96, s93, 288
    s_add_u32 s58, s95, s96
L_udone_23:
    s_mov_b32 s10, 0x510000
    s_mov_b32 s11, 0x20000
    v_bfe_u32 v64, v220, 3, 2
    v_mul_u32_u24 v64, s59, v64
    v_bfe_u32 v65, v220, 2, 1
    v_mul_lo_u32 v65, v65, s60
    v_and_b32 v66, 3, v220
    v_mul_u32_u24 v66, s61, v66
    v_add3_u32 v64, v64, v65, v66
    v_lshrrev_b32 v65, 8, v220
    v_lshl_add_u32 v64, v65, 4, v64
    v_add_u32 v247, s58, v64
    v_bfe_u32 v64, v221, 3, 2
    v_mul_u32_u24 v64, s59, v64
    v_bfe_u32 v65, v221, 2, 1
    v_mul_lo_u32 v65, v65, s60
    v_and_b32 v66, 3, v221
    v_mul_u32_u24 v66, s61, v66
    v_add3_u32 v64, v64, v65, v66
    v_lshrrev_b32 v65, 8, v221
    v_lshl_add_u32 v64, v65, 4, v64
    v_add_u32 v248, s58, v64
    v_bfe_u32 v64, v222, 3, 2
    v_mul_u32_u24 v64, s59, v64
    v_bfe_u32 v65, v222, 2, 1
    v_mul_lo_u32 v65, v65, s60
    v_and_b32 v66, 3, v222
    v_mul_u32_u24 v66, s61, v66
    v_add3_u32 v64, v64, v65, v66
    v_lshrrev_b32 v65, 8, v222
    v_lshl_add_u32 v64, v65, 4, v64
    v_add_u32 v249, s58, v64
    v_bfe_u32 v64, v223, 3, 2
    v_mul_u32_u24 v64, s59, v64
    v_bfe_u32 v65, v223, 2, 1
    v_mul_lo_u32 v65, v65, s60
    v_and_b32 v66, 3, v223
    v_mul_u32_u24 v66, s61, v66
    v_add3_u32 v64, v64, v65, v66
    v_lshrrev_b32 v65, 8, v223
    v_lshl_add_u32 v64, v65, 4, v64
    v_add_u32 v250, s58, v64
    v_bfe_u32 v64, v224, 3, 2
    v_mul_u32_u24 v64, s59, v64
    v_bfe_u32 v65, v224, 2, 1
    v_mul_lo_u32 v65, v65, s60
    v_and_b32 v66, 3, v224
    v_mul_u32_u24 v66, s61, v66
    v_add3_u32 v64, v64, v65, v66
    v_lshrrev_b32 v65, 8, v224
    v_lshl_add_u32 v64, v65, 4, v64
    v_add_u32 v251, s58, v64
    v_bfe_u32 v64, v225, 3, 2
    v_mul_u32_u24 v64, s59, v64
    v_bfe_u32 v65, v225, 2, 1
    v_mul_lo_u32 v65, v65, s60
    v_and_b32 v66, 3, v225
    v_mul_u32_u24 v66, s61, v66
    v_add3_u32 v64, v64, v65, v66
    v_lshrrev_b32 v65, 8, v225
    v_lshl_add_u32 v64, v65, 4, v64
    v_add_u32 v252, s58, v64
    v_bfe_u32 v64, v226, 3, 2
    v_mul_u32_u24 v64, s59, v64
    v_bfe_u32 v65, v226, 2, 1
    v_mul_lo_u32 v65, v65, s60
    v_and_b32 v66, 3, v226
    v_mul_u32_u24 v66, s61, v66
    v_add3_u32 v64, v64, v65, v66
    v_lshrrev_b32 v65, 8, v226
    v_lshl_add_u32 v64, v65, 4, v64
    v_add_u32 v253, s58, v64
    v_bfe_u32 v64, v227, 3, 2
    v_mul_u32_u24 v64, s59, v64
    v_bfe_u32 v65, v227, 2, 1
    v_mul_lo_u32 v65, v65, s60
    v_and_b32 v66, 3, v227
    v_mul_u32_u24 v66, s61, v66
    v_add3_u32 v64, v64, v65, v66
    v_lshrrev_b32 v65, 8, v227
    v_lshl_add_u32 v64, v65, 4, v64
    v_add_u32 v254, s58, v64
    v_bfe_u32 v64, v228, 3, 2
    v_mul_u32_u24 v64, s59, v64
    v_bfe_u32 v65, v228, 2, 1
    v_mul_lo_u32 v65, v65, s60
    v_and_b32 v66, 3, v228
    v_mul_u32_u24 v66, s61, v66
    v_add3_u32 v64, v64, v65, v66
    v_lshrrev_b32 v65, 8, v228
    v_lshl_add_u32 v64, v65, 4, v64
    v_add_u32 v255, s58, v64
L_absent_21:
    s_cmp_eq_u32 s20, 3
    s_cbranch_scc1 L_w3_30
    s_waitcnt vmcnt(0)
    v_lshlrev_b32 v20, 16, v8
    v_and_b32 v21, 0xffff0000, v8
    v_lshlrev_b32 v22, 16, v9
    v_and_b32 v23, 0xffff0000, v9
    v_lshlrev_b32 v24, 16, v10
    v_and_b32 v25, 0xffff0000, v10
    v_lshlrev_b32 v26, 16, v11
    v_and_b32 v27, 0xffff0000, v11
    v_lshlrev_b32 v28, 16, v12
    v_and_b32 v29, 0xffff0000, v12
    v_lshlrev_b32 v30, 16, v13
    v_and_b32 v31, 0xffff0000, v13
    v_lshlrev_b32 v32, 16, v14
    v_and_b32 v33, 0xffff0000, v14
    v_lshlrev_b32 v34, 16, v15
    v_and_b32 v35, 0xffff0000, v15
    v_lshlrev_b32 v36, 16, v16
    v_and_b32 v37, 0xffff0000, v16
    v_lshlrev_b32 v38, 16, v17
    v_and_b32 v39, 0xffff0000, v17
    v_lshlrev_b32 v40, 16, v18
    v_and_b32 v41, 0xffff0000, v18
    v_lshlrev_b32 v42, 16, v19
    v_and_b32 v43, 0xffff0000, v19
    v_add_f32 v44, v20, v21
    v_add_f32 v64, v22, v23
    v_add_f32 v44, v44, v24
    v_add_f32 v64, v64, v25
    v_add_f32 v44, v44, v26
    v_add_f32 v64, v64, v27
    v_add_f32 v44, v44, v28
    v_add_f32 v64, v64, v29
    v_add_f32 v44, v44, v30
    v_add_f32 v64, v64, v31
    v_add_f32 v44, v44, v32
    v_add_f32 v64, v64, v33
    v_add_f32 v44, v44, v34
    v_add_f32 v64, v64, v35
    v_add_f32 v44, v44, v36
    v_add_f32 v64, v64, v37
    v_add_f32 v44, v44, v38
    v_add_f32 v64, v64, v39
    v_add_f32 v44, v44, v40
    v_add_f32 v64, v64, v41
    v_add_f32 v44, v44, v42
    v_add_f32 v64, v64, v43
    v_add_f32 v44, v44, v64
    s_nop 1
    v_add_f32_dpp v44, v44, v44 row_ror:8 row_mask:0xf bank_mask:0xf
    v_mov_b32 v64, v44
    s_nop 1
    v_permlane16_swap_b32 v44, v64
    v_add_f32 v44, v44, v64
    v_mov_b32 v64, v44
    s_nop 1
    v_permlane32_swap_b32 v44, v64
    v_add_f32 v44, v44, v64
    v_mul_f32 v65, 0x3baaaaab, v44
    v_sub_f32 v64, v20, v65
    v_mul_f32 v45, v64, v64
    v_sub_f32 v67, v21, v65
    v_fmac_f32 v45, v67, v67
    v_sub_f32 v66, v22, v65
    v_fmac_f32 v45, v66, v66
    v_sub_f32 v67, v23, v65
    v_fmac_f32 v45, v67, v67
    v_sub_f32 v66, v24, v65
    v_fmac_f32 v45, v66, v66
    v_sub_f32 v67, v25, v65
    v_fmac_f32 v45, v67, v67
    v_sub_f32 v66, v26, v65
    v_fmac_f32 v45, v66, v66
    v_sub_f32 v67, v27, v65
    v_fmac_f32 v45, v67, v67
    v_sub_f32 v66, v28, v65
    v_fmac_f32 v45, v66, v66
    v_sub_f32 v67, v29, v65
    v_fmac_f32 v45, v67, v67
    v_sub_f32 v66, v30, v65
    v_fmac_f32 v45, v66, v66
    v_sub_f32 v67, v31, v65
    v_fmac_f32 v45, v67, v67
    v_sub_f32 v66, v32, v65
    v_fmac_f32 v45, v66, v66
    v_sub_f32 v67, v33, v65
    v_fmac_f32 v45, v67, v67
    v_sub_f32 v66, v34, v65
    v_fmac_f32 v45, v66, v66
    v_sub_f32 v67, v35, v65
    v_fmac_f32 v45, v67, v67
    v_sub_f32 v66, v36, v65
    v_fmac_f32 v45, v66, v66
    v_sub_f32 v67, v37, v65
    v_fmac_f32 v45, v67, v67
    v_sub_f32 v66, v38, v65
    v_fmac_f32 v45, v66, v66
    v_sub_f32 v67, v39, v65
    v_fmac_f32 v45, v67, v67
    v_sub_f32 v66, v40, v65
    v_fmac_f32 v45, v66, v66
    v_sub_f32 v67, v41, v65
    v_fmac_f32 v45, v67, v67
    v_sub_f32 v66, v42, v65
    v_fmac_f32 v45, v66, v66
    v_sub_f32 v67, v43, v65
    v_fmac_f32 v45, v67, v67
    s_nop 1
    v_add_f32_dpp v45, v45, v45 row_ror:8 row_mask:0xf bank_mask:0xf
    v_mov_b32 v64, v45
    s_nop 1
    v_permlane16_swap_b32 v45, v64
    v_add_f32 v45, v45, v64
    v_mov_b32 v64, v45
    s_nop 1
    v_permlane32_swap_b32 v45, v64
    v_add_f32 v45, v45, v64
    v_and_b32 v64, 7, v1
    s_mul_i32 s46, s20, 64
    s_add_u32 s46, s46, 160896
    v_lshl_add_u32 v64, v64, 3, s46
    ds_write_b64 v64, v[44:45]
    s_waitcnt lgkmcnt(0)
L_w3_30:
    s_barrier
    global_load_dwordx2 v[6:7], v5, s[40:41] sc1
    s_cmp_eq_u32 s20, 3
    s_cbranch_scc1 L_w3_31
    v_and_b32 v64, 7, v1
    v_lshlrev_b32 v64, 3, v64
    v_add_u32 v64, 160896, v64
    ds_read_b64 v[44:45], v64 offset:0
    ds_read_b64 v[46:47], v64 offset:64
    ds_read_b64 v[48:49], v64 offset:128
    s_waitcnt lgkmcnt(1)
    v_add_f32 v64, v44, v46
    s_waitcnt lgkmcnt(0)
    v_add_f32 v64, v64, v48
    v_mul_f32 v64, 0x3ae38e39, v64
    v_add_f32 v65, v45, v47
    v_add_f32 v65, v65, v49
    v_mul_f32 v66, 0x3baaaaab, v44
    v_sub_f32 v66, v66, v64
    v_mul_f32 v66, v66, v66
    v_fmac_f32 v65, 0x43400000, v66
    v_mul_f32 v66, 0x3baaaaab, v46
    v_sub_f32 v66, v66, v64
    v_mul_f32 v66, v66, v66
    v_fmac_f32 v65, 0x43400000, v66
    v_mul_f32 v66, 0x3baaaaab, v48
    v_sub_f32 v66, v66, v64
    v_mul_f32 v66, v66, v66
    v_fmac_f32 v65, 0x43400000, v66
    v_mul_f32 v65, 0x3ae38e39, v65
    v_cvt_pk_bf16_f32 v65, v65, v65
    v_lshlrev_b32 v65, 16, v65
    v_add_f32 v65, 0x3727c5ac, v65
    v_cvt_pk_bf16_f32 v65, v65, v65
    v_lshlrev_b32 v65, 16, v65
    v_sqrt_f32 v65, v65
    s_nop 0
    v_cvt_pk_bf16_f32 v65, v65, v65
    v_lshlrev_b32 v65, 16, v65
    v_rcp_f32 v65, v65
    v_cvt_pk_bf16_f32 v64, v64, v64
    v_lshlrev_b32 v64, 16, v64
    v_sub_f32 v20, v20, v64
    v_sub_f32 v21, v21, v64
    v_cvt_pk_bf16_f32 v66, v20, v21
    v_lshlrev_b32 v20, 16, v66
    v_and_b32 v21, 0xffff0000, v66
    v_mul_f32 v20, v20, v65
    v_mul_f32 v21, v21, v65
    v_cvt_pk_bf16_f32 v52, v20, v21
    v_sub_f32 v22, v22, v64
    v_sub_f32 v23, v23, v64
    v_cvt_pk_bf16_f32 v66, v22, v23
    v_lshlrev_b32 v22, 16, v66
    v_and_b32 v23, 0xffff0000, v66
    v_mul_f32 v22, v22, v65
    v_mul_f32 v23, v23, v65
    v_cvt_pk_bf16_f32 v53, v22, v23
    v_sub_f32 v24, v24, v64
    v_sub_f32 v25, v25, v64
    v_cvt_pk_bf16_f32 v66, v24, v25
    v_lshlrev_b32 v24, 16, v66
    v_and_b32 v25, 0xffff0000, v66
    v_mul_f32 v24, v24, v65
    v_mul_f32 v25, v25, v65
    v_cvt_pk_bf16_f32 v54, v24, v25
    v_sub_f32 v26, v26, v64
    v_sub_f32 v27, v27, v64
    v_cvt_pk_bf16_f32 v66, v26, v27
    v_lshlrev_b32 v26, 16, v66
    v_and_b32 v27, 0xffff0000, v66
    v_mul_f32 v26, v26, v65
    v_mul_f32 v27, v27, v65
    v_cvt_pk_bf16_f32 v55, v26, v27
    v_sub_f32 v28, v28, v64
    v_sub_f32 v29, v29, v64
    v_cvt_pk_bf16_f32 v66, v28, v29
    v_lshlrev_b32 v28, 16, v66
    v_and_b32 v29, 0xffff0000, v66
    v_mul_f32 v28, v28, v65
    v_mul_f32 v29, v29, v65
    v_cvt_pk_bf16_f32 v56, v28, v29
    v_sub_f32 v30, v30, v64
    v_sub_f32 v31, v31, v64
    v_cvt_pk_bf16_f32 v66, v30, v31
    v_lshlrev_b32 v30, 16, v66
    v_and_b32 v31, 0xffff0000, v66
    v_mul_f32 v30, v30, v65
    v_mul_f32 v31, v31, v65
    v_cvt_pk_bf16_f32 v57, v30, v31
    v_sub_f32 v32, v32, v64
    v_sub_f32 v33, v33, v64
    v_cvt_pk_bf16_f32 v66, v32, v33
    v_lshlrev_b32 v32, 16, v66
    v_and_b32 v33, 0xffff0000, v66
    v_mul_f32 v32, v32, v65
    v_mul_f32 v33, v33, v65
    v_cvt_pk_bf16_f32 v58, v32, v33
    v_sub_f32 v34, v34, v64
    v_sub_f32 v35, v35, v64
    v_cvt_pk_bf16_f32 v66, v34, v35
    v_lshlrev_b32 v34, 16, v66
    v_and_b32 v35, 0xffff0000, v66
    v_mul_f32 v34, v34, v65
    v_mul_f32 v35, v35, v65
    v_cvt_pk_bf16_f32 v59, v34, v35
    v_sub_f32 v36, v36, v64
    v_sub_f32 v37, v37, v64
    v_cvt_pk_bf16_f32 v66, v36, v37
    v_lshlrev_b32 v36, 16, v66
    v_and_b32 v37, 0xffff0000, v66
    v_mul_f32 v36, v36, v65
    v_mul_f32 v37, v37, v65
    v_cvt_pk_bf16_f32 v60, v36, v37
    v_sub_f32 v38, v38, v64
    v_sub_f32 v39, v39, v64
    v_cvt_pk_bf16_f32 v66, v38, v39
    v_lshlrev_b32 v38, 16, v66
    v_and_b32 v39, 0xffff0000, v66
    v_mul_f32 v38, v38, v65
    v_mul_f32 v39, v39, v65
    v_cvt_pk_bf16_f32 v61, v38, v39
    v_sub_f32 v40, v40, v64
    v_sub_f32 v41, v41, v64
    v_cvt_pk_bf16_f32 v66, v40, v41
    v_lshlrev_b32 v40, 16, v66
    v_and_b32 v41, 0xffff0000, v66
    v_mul_f32 v40, v40, v65
    v_mul_f32 v41, v41, v65
    v_cvt_pk_bf16_f32 v62, v40, v41
    v_sub_f32 v42, v42, v64
    v_sub_f32 v43, v43, v64
    v_cvt_pk_bf16_f32 v66, v42, v43
    v_lshlrev_b32 v42, 16, v66
    v_and_b32 v43, 0xffff0000, v66
    v_mul_f32 v42, v42, v65
    v_mul_f32 v43, v43, v65
    v_cvt_pk_bf16_f32 v63, v42, v43
    s_mov_b32 s46, 20971520
    buffer_store_dwordx4 v[52:55], v4, s[4:7], s46 offen offset:0 sc1
    buffer_store_dwordx4 v[56:59], v4, s[4:7], s46 offen offset:2048 sc1
    s_add_u32 s46, s46, 4096
    buffer_store_dwordx4 v[60:63], v4, s[4:7], s46 offen offset:0 sc1
    s_lshl_b32 s0, s47, 2
    s_add_u32 s0, s0, s20
    s_lshl_b32 s0, s0, 3
    s_add_u32 s0, s0, 3932160
    s_mov_b32 s55, 0
    s_branch L_ln_32
L_w3_31:
    v_lshrrev_b32 v64, 4, v1
    v_bfe_u32 v66, v1, 2, 2
    v_lshl_add_u32 v64, v64, 3, v66
    v_mul_u32_u24 v64, 240, v64
    v_add_u32 v64, s56, v64
    v_and_b32 v66, 3, v1
    v_add_u32 v64, s47, v64
    v_and_b32 v67, 1, v66
    v_mul_u32_u24 v67, 160, v67
    v_lshrrev_b32 v65, 1, v66
    v_mul_u32_u24 v65, 80, v65
    v_add3_u32 v65, v65, v67, v64
    v_cmp_eq_u32 vcc, 3, v66
    s_nop 1
    v_cndmask_b32 v65, v65, v64, vcc
    v_lshl_add_u32 v64, v66, 3, v64
    s_waitcnt vmcnt(1)
    ds_read_b64_tr_b16 v[72:73], v64 offset:0
    ds_read_b64_tr_b16 v[74:75], v64 offset:960
    ds_read_b64_tr_b16 v[76:77], v64 offset:40
    ds_read_b64_tr_b16 v[78:79], v64 offset:1000
    ds_read_b64_tr_b16 v[80:81], v64 offset:80
    ds_read_b64_tr_b16 v[82:83], v64 offset:1040
    ds_read_b64_tr_b16 v[84:85], v64 offset:120
    ds_read_b64_tr_b16 v[86:87], v64 offset:1080
    ds_read_b64_tr_b16 v[88:89], v64 offset:160
    ds_read_b64_tr_b16 v[90:91], v64 offset:1120
    ds_read_b64_tr_b16 v[92:93], v64 offset:200
    ds_read_b64_tr_b16 v[94:95], v64 offset:1160
    ds_read_b64_tr_b16 v[96:97], v65 offset:32
    ds_read_b64_tr_b16 v[98:99], v65 offset:992
    v_and_b32 v66, 15, v1
    v_cmp_gt_u32 vcc, 12, v66
    s_waitcnt lgkmcnt(1)
    s_nop 0
    v_cndmask_b32 v96, 0, v96, vcc
    v_cndmask_b32 v97, 0, v97, vcc
    s_waitcnt lgkmcnt(0)
    v_cndmask_b32 v98, 0, v98, vcc
    v_cndmask_b32 v99, 0, v99, vcc
    s_add_u32 s51, s51, 0
    buffer_store_dwordx4 v[72:75], v2, s[4:7], s51 offen offset:0 sc1
    buffer_store_dwordx4 v[76:79], v2, s[4:7], s51 offen offset:1024 sc1
    buffer_store_dwordx4 v[80:83], v2, s[4:7], s51 offen offset:2048 sc1
    buffer_store_dwordx4 v[84:87], v2, s[4:7], s51 offen offset:3072 sc1
    s_add_u32 s51, s51, 4096
    buffer_store_dwordx4 v[88:91], v2, s[4:7], s51 offen offset:0 sc1
    buffer_store_dwordx4 v[92:95], v2, s[4:7], s51 offen offset:1024 sc1
    buffer_store_dwordx4 v[96:99], v2, s[4:7], s51 offen offset:2048 sc1
    s_cmp_eq_u32 s55, 0
    s_cbranch_scc1 L_ln_32
    s_cmp_eq_u32 s55, 2
    s_cbranch_scc1 L_fw_33
    v_lshrrev_b32 v64, 4, v1
    v_bfe_u32 v66, v1, 2, 2
    v_lshl_add_u32 v64, v64, 3, v66
    v_mul_u32_u24 v64, 240, v64
    v_add_u32 v64, s57, v64
    v_and_b32 v66, 3, v1
    v_add_u32 v64, s87, v64
    v_and_b32 v67, 1, v66
    v_mul_u32_u24 v67, 160, v67
    v_lshrrev_b32 v65, 1, v66
    v_mul_u32_u24 v65, 80, v65
    v_add3_u32 v65, v65, v67, v64
    v_cmp_eq_u32 vcc, 3, v66
    s_nop 1
    v_cndmask_b32 v65, v65, v64, vcc
    v_lshl_add_u32 v64, v66, 3, v64
    s_waitcnt vmcnt(8)
    ds_read_b64_tr_b16 v[100:101], v64 offset:0
    ds_read_b64_tr_b16 v[102:103], v64 offset:960
    ds_read_b64_tr_b16 v[104:105], v64 offset:40
    ds_read_b64_tr_b16 v[106:107], v64 offset:1000
    ds_read_b64_tr_b16 v[108:109], v64 offset:80
    ds_read_b64_tr_b16 v[110:111], v64 offset:1040
    ds_read_b64_tr_b16 v[112:113], v64 offset:120
    ds_read_b64_tr_b16 v[114:115], v64 offset:1080
    ds_read_b64_tr_b16 v[116:117], v64 offset:160
    ds_read_b64_tr_b16 v[118:119], v64 offset:1120
    ds_read_b64_tr_b16 v[120:121], v64 offset:200
    ds_read_b64_tr_b16 v[122:123], v64 offset:1160
    ds_read_b64_tr_b16 v[124:125], v65 offset:32
    ds_read_b64_tr_b16 v[126:127], v65 offset:992
    v_and_b32 v66, 15, v1
    v_cmp_gt_u32 vcc, 12, v66
    s_waitcnt lgkmcnt(1)
    s_nop 0
    v_cndmask_b32 v124, 0, v124, vcc
    v_cndmask_b32 v125, 0, v125, vcc
    s_waitcnt lgkmcnt(0)
    v_cndmask_b32 v126, 0, v126, vcc
    v_cndmask_b32 v127, 0, v127, vcc
    s_add_u32 s91, s91, 0
    buffer_store_dwordx4 v[100:103], v2, s[4:7], s91 offen offset:0 sc1
    buffer_store_dwordx4 v[104:107], v2, s[4:7], s91 offen offset:1024 sc1
    buffer_store_dwordx4 v[108:111], v2, s[4:7], s91 offen offset:2048 sc1
    buffer_store_dwordx4 v[112:115], v2, s[4:7], s91 offen offset:3072 sc1
    s_add_u32 s91, s91, 4096
    buffer_store_dwordx4 v[116:119], v2, s[4:7], s91 offen offset:0 sc1
    buffer_store_dwordx4 v[120:123], v2, s[4:7], s91 offen offset:1024 sc1
    buffer_store_dwordx4 v[124:127], v2, s[4:7], s91 offen offset:2048 sc1
    s_branch L_ln_32
L_fw_33:
    v_lshrrev_b32 v64, 4, v1
    v_bfe_u32 v66, v1, 2, 2
    v_lshl_add_u32 v64, v64, 3, v66
    v_mul_u32_u24 v64, 192, v64
    v_add_u32 v64, s57, v64
    v_and_b32 v66, 3, v1
    v_lshl_add_u32 v64, v66, 4, v64
    s_waitcnt vmcnt(8)
    ds_read_b64_tr_b16 v[100:101], v64 offset:0
    ds_read_b64_tr_b16 v[102:103], v64 offset:768
    ds_read_b64_tr_b16 v[104:105], v64 offset:8
    ds_read_b64_tr_b16 v[106:107], v64 offset:776
    ds_read_b64_tr_b16 v[108:109], v64 offset:64
    ds_read_b64_tr_b16 v[110:111], v64 offset:832
    ds_read_b64_tr_b16 v[112:113], v64 offset:72
    ds_read_b64_tr_b16 v[114:115], v64 offset:840
    ds_read_b64_tr_b16 v[116:117], v64 offset:128
    ds_read_b64_tr_b16 v[118:119], v64 offset:896
    ds_read_b64_tr_b16 v[120:121], v64 offset:136
    ds_read_b64_tr_b16 v[122:123], v64 offset:904
    s_add_u32 s91, s91, 2097152
    s_waitcnt lgkmcnt(10)
    buffer_store_dwordx4 v[100:103], v2, s[4:7], s91 offen offset:0 sc1
    s_waitcnt lgkmcnt(8)
    buffer_store_dwordx4 v[104:107], v2, s[4:7], s91 offen offset:1024 sc1
    s_waitcnt lgkmcnt(6)
    buffer_store_dwordx4 v[108:111], v2, s[4:7], s91 offen offset:2048 sc1
    s_waitcnt lgkmcnt(4)
    buffer_store_dwordx4 v[112:115], v2, s[4:7], s91 offen offset:3072 sc1
    s_add_u32 s91, s91, 4096
    s_waitcnt lgkmcnt(2)
    buffer_store_dwordx4 v[116:119], v2, s[4:7], s91 offen offset:0 sc1
    s_waitcnt lgkmcnt(0)
    buffer_store_dwordx4 v[120:123], v2, s[4:7], s91 offen offset:1024 sc1
L_ln_32:
    s_waitcnt vmcnt(0)
    v_cmp_ne_u64 vcc, 0, v[6:7]
    s_nop 0
    s_cmp_eq_u64 vcc, exec
    s_cbranch_scc0 L_pn_slow_27
L_pn_back_28:
    v_readfirstlane_b32 s98, v6
    v_readfirstlane_b32 s99, v7
    s_nop 0
    v_mov_b32 v6, s98
    v_mov_b32 v7, s99
    s_waitcnt vmcnt(0)
    s_mov_b64 exec, 1
    buffer_store_dwordx2 v[6:7], off, s[4:7], s0 sc1
    s_mov_b64 exec, -1
    s_cmp_eq_u32 s55, 0
    s_cbranch_scc1 L_norole_34
    s_mov_b64 exec, 1
    buffer_store_dwordx2 v[6:7], off, s[4:7], s1 sc1
    s_mov_b64 exec, -1
L_norole_34:
    s_lshr_b32 s44, s22, 4
    s_lshl_b32 s52, s21, 1
    s_add_u32 s44, s44, s52
    s_and_b32 s45, s22, 15
    s_mul_i32 s48, s20, 21
    s_lshr_b32 s48, s48, 1
    s_lshl_b32 s48, s48, 10
    s_mul_i32 s47, s45, 129024
    s_add_u32 s47, s47, s48
    s_add_u32 s47, s47, 0
    buffer_load_dwordx4 a[144:147], v229, s[16:19], 0 offen nt
    buffer_load_dwordx4 a[148:151], v230, s[16:19], 0 offen nt
    buffer_load_dwordx4 a[152:155], v231, s[16:19], 0 offen nt
    buffer_load_dwordx4 a[156:159], v232, s[16:19], 0 offen nt
    buffer_load_dwordx4 a[160:163], v233, s[16:19], 0 offen nt
    buffer_load_dwordx4 a[164:167], v234, s[16:19], 0 offen nt
    buffer_load_dwordx4 a[168:171], v235, s[16:19], 0 offen nt
    buffer_load_dwordx4 a[172:175], v236, s[16:19], 0 offen nt
    buffer_load_dwordx4 a[176:179], v237, s[16:19], 0 offen nt
    s_mul_i32 s55, s20, 9216
    s_add_u32 s55, s55, 110592
    v_add_u32 v64, s55, v2
    s_waitcnt vmcnt(8)
    ds_write_b128 v64, a[144:147] offset:0
    s_waitcnt vmcnt(7)
    ds_write_b128 v64, a[148:151] offset:1024
    s_waitcnt vmcnt(6)
    ds_write_b128 v64, a[152:155] offset:2048
    s_waitcnt vmcnt(5)
    ds_write_b128 v64, a[156:159] offset:3072
    s_waitcnt vmcnt(4)
    ds_write_b128 v64, a[160:163] offset:4096
    s_waitcnt vmcnt(3)
    ds_write_b128 v64, a[164:167] offset:5120
    s_waitcnt vmcnt(2)
    ds_write_b128 v64, a[168:171] offset:6144
    s_waitcnt vmcnt(1)
    ds_write_b128 v64, a[172:175] offset:7168
    s_waitcnt vmcnt(0)
    ds_write_b128 v64, a[176:179] offset:8192
    s_cmp_ge_u32 s3, 1152
    s_cbranch_scc1 L_ud_35
    s_mul_i32 s64, s3, 1821
    s_lshr_b32 s64, s64, 16
    s_mul_i32 s92, s64, 36
    s_sub_u32 s92, s3, s92
    s_and_b32 s93, s92, 1
    s_lshr_b32 s94, s92, 1
    s_mov_b32 s62, 0
    s_mov_b32 s63, 256
    s_mul_i32 s95, s64, 486
    s_add_u32 s95, s95, s92
    s_lshl_b32 s95, s95, 10
    s_add_u32 s69, s95, 4194304
    s_add_u32 s67, s69, 36864
    s_add_u32 s68, s69, 184320
    s_mov_b32 s70, 36864
    s_mov_b32 s71, 73728
    s_lshl_b32 s95, s64, 1
    s_add_u32 s95, s95, s93
    s_mul_i32 s95, s95, 18
    s_add_u32 s95, s95, s94
    s_mul_i32 s95, s95, 576
    s_add_u32 s65, s95, 2883584
    s_mov_b32 s66, s92
    s_branch L_udone_36
L_ud_35:
    s_sub_u32 s92, s3, 1152
    s_mul_i32 s64, s92, 3641
    s_lshr_b32 s64, s64, 16
    s_mul_i32 s93, s64, 18
    s_sub_u32 s92, s92, s93
    s_and_b32 s93, s64, 3
    s_and_b32 s94, s93, 1
    s_mov_b32 s65, 0
    s_lshl_b32 s62, s94, 5
    s_cmp_eq_u32 s94, 0
    s_cselect_b32 s63, 256, 0
    s_add_u32 s66, s92, 36
    s_mul_i32 s95, s64, 486
    s_add_u32 s95, s95, 324
    s_lshl_b32 s95, s95, 10
    s_add_u32 s95, s95, 4194304
    s_cmp_ge_u32 s92, 3
    s_cbranch_scc1 L_ub_37
    s_sub_u32 s96, s92, 0
    s_mov_b32 s70, 1024
    s_mov_b32 s71, 2048
    s_mul_i32 s97, s96, 5120
    s_add_u32 s97, s97, 0
    s_add_u32 s67, s97, s95
    s_mul_i32 s97, s96, 4096
    s_add_u32 s97, s97, 15360
    s_add_u32 s68, s97, s95
    s_mul_i32 s97, s96, 5120
    s_add_u32 s97, s97, 4096
    s_add_u32 s69, s97, s95
    s_branch L_udone_36
L_ub_37:
    s_cmp_ge_u32 s92, 9
    s_cbranch_scc1 L_uc_38
    s_sub_u32 s96, s92, 3
    s_mov_b32 s70, 1024
    s_mov_b32 s71, 2048
    s_mul_i32 s97, s96, 9216
    s_add_u32 s97, s97, 27648
    s_add_u32 s67, s97, s95
    s_mul_i32 s97, s96, 9216
    s_add_u32 s97, s97, 31744
    s_add_u32 s68, s97, s95
    s_mul_i32 s97, s96, 9216
    s_add_u32 s97, s97, 35840
    s_add_u32 s69, s97, s95
    s_branch L_udone_36
L_uc_38:
    s_sub_u32 s96, s92, 9
    s_mov_b32 s70, 1024
    s_mov_b32 s71, 18432
    s_mul_i32 s97, s96, 2048
    s_add_u32 s97, s97, 82944
    s_add_u32 s67, s97, s95
    s_mul_i32 s97, s96, 2048
    s_add_u32 s97, s97, 119808
    s_add_u32 s68, s97, s95
    s_mul_i32 s97, s96, 1024
    s_add_u32 s97, s97, 156672
    s_add_u32 s69, s97, s95
L_udone_36:
    s_lshl_b32 s95, s64, 6
    s_add_u32 s95, s95, s66
    s_lshl_b32 s95, s95, 3
    s_add_u32 s66, s95, 4071424
    v_lshrrev_b32 v64, 4, v1
    v_bfe_u32 v66, v1, 2, 2
    v_lshl_add_u32 v64, v64, 3, v66
    v_mul_u32_u24 v64, 288, v64
    v_add_u32 v64, s55, v64
    v_and_b32 v66, 3, v1
    v_lshl_add_u32 v65, v66, 3, v64
    v_add_u32 v65, s63, v65
    v_lshl_add_u32 v64, v66, 4, v64
    v_add_u32 v64, s62, v64
    ds_read_b64_tr_b16 v[180:181], v64 offset:0
    ds_read_b64_tr_b16 v[182:183], v64 offset:1152
    ds_read_b64_tr_b16 v[184:185], v64 offset:8
    ds_read_b64_tr_b16 v[186:187], v64 offset:1160
    ds_read_b64_tr_b16 v[188:189], v64 offset:64
    ds_read_b64_tr_b16 v[190:191], v64 offset:1216
    ds_read_b64_tr_b16 v[192:193], v64 offset:72
    ds_read_b64_tr_b16 v[194:195], v64 offset:1224
    ds_read_b64_tr_b16 v[196:197], v64 offset:128
    ds_read_b64_tr_b16 v[198:199], v64 offset:1280
    ds_read_b64_tr_b16 v[200:201], v64 offset:136
    ds_read_b64_tr_b16 v[202:203], v64 offset:1288
    ds_read_b64_tr_b16 v[204:205], v64 offset:192
    ds_read_b64_tr_b16 v[206:207], v64 offset:1344
    ds_read_b64_tr_b16 v[208:209], v64 offset:200
    ds_read_b64_tr_b16 v[210:211], v64 offset:1352
    ds_read_b64_tr_b16 v[212:213], v65 offset:0
    ds_read_b64_tr_b16 v[214:215], v65 offset:1152
    s_cmp_eq_u32 s65, 0
    s_cbranch_scc1 L_nocs_39
    v_mov_b32 v68, 0x3f803f80
    v_mov_b32 v69, 0x3f803f80
    v_mov_b32 v70, 0x3f803f80
    v_mov_b32 v71, 0x3f803f80
    s_waitcnt lgkmcnt(15)
    s_nop 0
    v_mfma_f32_16x16x32_bf16 v[72:75], v[180:183], v[68:71], 0
    s_waitcnt lgkmcnt(14)
    v_mfma_f32_16x16x32_bf16 v[76:79], v[184:187], v[68:71], 0
    s_waitcnt lgkmcnt(12)
    v_mfma_f32_16x16x32_bf16 v[80:83], v[188:191], v[68:71], 0
    s_waitcnt lgkmcnt(10)
    v_mfma_f32_16x16x32_bf16 v[84:87], v[192:195], v[68:71], 0
    s_waitcnt lgkmcnt(8)
    v_mfma_f32_16x16x32_bf16 v[88:91], v[196:199], v[68:71], 0
    s_waitcnt lgkmcnt(6)
    v_mfma_f32_16x16x32_bf16 v[92:95], v[200:203], v[68:71], 0
    s_waitcnt lgkmcnt(4)
    v_mfma_f32_16x16x32_bf16 v[96:99], v[204:207], v[68:71], 0
    s_waitcnt lgkmcnt(2)
    v_mfma_f32_16x16x32_bf16 v[100:103], v[208:211], v[68:71], 0
    s_waitcnt lgkmcnt(0)
    v_mfma_f32_16x16x32_bf16 v[104:107], v[212:215], v[68:71], 0
    v_and_b32 v66, 15, v1
    v_add_u32 v67, 1, v66
    v_cmp_gt_u32 vcc, 8, v66
    v_and_b32 v64, 48, v1
    s_nop 0
    v_cndmask_b32 v67, 0, v67, vcc
    v_lshlrev_b32 v67, 6, v67
    v_add_u32 v67, v67, v64
    v_cmp_eq_u32 vcc, 1, v66
    s_nop 1
    v_cndmask_b32 v72, v72, v76, vcc
    v_cndmask_b32 v73, v73, v77, vcc
    v_cndmask_b32 v74, v74, v78, vcc
    v_cndmask_b32 v75, v75, v79, vcc
    v_cmp_eq_u32 vcc, 2, v66
    s_nop 1
    v_cndmask_b32 v72, v72, v80, vcc
    v_cndmask_b32 v73, v73, v81, vcc
    v_cndmask_b32 v74, v74, v82, vcc
    v_cndmask_b32 v75, v75, v83, vcc
    v_cmp_eq_u32 vcc, 3, v66
    s_nop 1
    v_cndmask_b32 v72, v72, v84, vcc
    v_cndmask_b32 v73, v73, v85, vcc
    v_cndmask_b32 v74, v74, v86, vcc
    v_cndmask_b32 v75, v75, v87, vcc
    v_cmp_eq_u32 vcc, 4, v66
    s_nop 1
    v_cndmask_b32 v72, v72, v88, vcc
    v_cndmask_b32 v73, v73, v89, vcc
    v_cndmask_b32 v74, v74, v90, vcc
    v_cndmask_b32 v75, v75, v91, vcc
    v_cmp_eq_u32 vcc, 5, v66
    s_nop 1
    v_cndmask_b32 v72, v72, v92, vcc
    v_cndmask_b32 v73, v73, v93, vcc
    v_cndmask_b32 v74, v74, v94, vcc
    v_cndmask_b32 v75, v75, v95, vcc
    v_cmp_eq_u32 vcc, 6, v66
    s_nop 1
    v_cndmask_b32 v72, v72, v96, vcc
    v_cndmask_b32 v73, v73, v97, vcc
    v_cndmask_b32 v74, v74, v98, vcc
    v_cndmask_b32 v75, v75, v99, vcc
    v_cmp_eq_u32 vcc, 7, v66
    s_nop 1
    v_cndmask_b32 v72, v72, v100, vcc
    v_cndmask_b32 v73, v73, v101, vcc
    v_cndmask_b32 v74, v74, v102, vcc
    v_cndmask_b32 v75, v75, v103, vcc
    v_cmp_eq_u32 vcc, 8, v66
    s_nop 1
    v_cndmask_b32 v72, v72, v104, vcc
    v_cndmask_b32 v73, v73, v105, vcc
    v_cndmask_b32 v74, v74, v106, vcc
    v_cndmask_b32 v75, v75, v107, vcc
    s_mov_b32 exec_lo, 0x01ff01ff
    s_mov_b32 exec_hi, 0x01ff01ff
    buffer_store_dwordx4 v[72:75], v67, s[4:7], s65 offen sc1
    s_mov_b64 exec, -1
L_nocs_39:
    s_mov_b32 s0, s66
    s_lshl_b32 s46, s44, 3
    s_max_u32 s52, s46, 1
    s_sub_u32 s52, s52, 1
    s_mul_i32 s49, s52, 18432
    s_mul_i32 s50, s20, 9
    s_lshr_b32 s50, s50, 1
    s_lshl_b32 s50, s50, 10
    s_add_u32 s49, s49, s50
    s_add_u32 s49, s49, 20971520
    s_add_u32 s50, s50, 0
    s_lshl_b32 s54, s52, 6
    s_lshl_b32 s52, s20, 1
    s_add_u32 s46, s46, s52
    s_mul_i32 s51, s46, 18432
    s_add_u32 s51, s51, 20971520
    s_lshl_b32 s55, s46, 6
    v_and_b32 v6, 3, v1
    v_min_u32 v6, 2, v6
    v_and_b32 v7, 12, v1
    v_add_lshl_u32 v8, v6, v7, 3
    v_add_u32 v8, s55, v8
    v_and_b32 v7, 4, v1
    v_add_lshl_u32 v9, v6, v7, 3
    v_add_u32 v9, s54, v9
    v_and_b32 v7, 16, v1
    v_cmp_eq_u32 vcc, 0, v7
    s_nop 1
    v_cndmask_b32 v8, v9, v8, vcc
    v_subrev_u32 v7, 32, v1
    v_min_u32 v7, 17, v7
    s_lshl_b32 s52, s45, 8
    s_add_u32 s52, s52, 131072
    v_lshl_add_u32 v7, v7, 3, s52
    v_cmp_gt_u32 vcc, 32, v1
    s_nop 1
    v_cndmask_b32 v8, v7, v8, vcc
    s_mov_b32 s52, 3932160
    s_min_u32 s56, s20, 2
    s_add_u32 s57, s56, 2
    s_and_b32 s56, s20, 1
    s_add_u32 s56, s56, 4
    s_cmp_ge_u32 s20, 2
    s_cselect_b32 s57, 6, s57
    s_lshl_b32 s57, s57, 10
    s_lshl_b32 s56, s56, 10
    v_add_u32 v3, 18432, v2
    v_add_u32 v4, s57, v3
    v_add_u32 v5, s56, v3
    v_add_u32 v10, 0, v2
    v_mov_b32 v11, v8
    s_mov_b32 s23, s52
    buffer_load_dwordx2 v[12:13], v11, s[4:7], s23 offen sc1
    v_and_b32 v6, 15, v1
    v_lshrrev_b32 v7, 4, v1
    v_lshlrev_b32 v7, 2, v7
    v_sub_u32 v6, v6, v7
    v_mov_b32 v8, 0xf149f2ca
    s_or_b32 s52, s44, s20
    s_cmp_eq_u32 s52, 0
    s_cselect_b64 s[56:57], -1, 0
    v_subrev_u32 v7, 0, v6
    v_and_b32 v9, 0xfffffff1, v7
    v_cmp_eq_u32 vcc, 0, v9
    v_add_u32 v7, 16, v7
    v_and_b32 v9, 0xfffffff1, v7
    v_cndmask_b32_e64 v168, v8, 0, vcc
    v_cmp_eq_u32 vcc, 0, v9
    s_nop 1
    v_cndmask_b32_e64 v172, v8, 0, vcc
    v_cndmask_b32_e64 v176, v172, v8, s[56:57]
    v_subrev_u32 v7, 1, v6
    v_and_b32 v9, 0xfffffff1, v7
    v_cmp_eq_u32 vcc, 0, v9
    v_add_u32 v7, 16, v7
    v_and_b32 v9, 0xfffffff1, v7
    v_cndmask_b32_e64 v169, v8, 0, vcc
    v_cmp_eq_u32 vcc, 0, v9
    s_nop 1
    v_cndmask_b32_e64 v173, v8, 0, vcc
    v_cndmask_b32_e64 v177, v173, v8, s[56:57]
    v_subrev_u32 v7, 2, v6
    v_and_b32 v9, 0xfffffff1, v7
    v_cmp_eq_u32 vcc, 0, v9
    v_add_u32 v7, 16, v7
    v_and_b32 v9, 0xfffffff1, v7
    v_cndmask_b32_e64 v170, v8, 0, vcc
    v_cmp_eq_u32 vcc, 0, v9
    s_nop 1
    v_cndmask_b32_e64 v174, v8, 0, vcc
    v_cndmask_b32_e64 v178, v174, v8, s[56:57]
    v_subrev_u32 v7, 3, v6
    v_and_b32 v9, 0xfffffff1, v7
    v_cmp_eq_u32 vcc, 0, v9
    v_add_u32 v7, 16, v7
    v_and_b32 v9, 0xfffffff1, v7
    v_cndmask_b32_e64 v171, v8, 0, vcc
    v_cmp_eq_u32 vcc, 0, v9
    s_nop 1
    v_cndmask_b32_e64 v175, v8, 0, vcc
    v_cndmask_b32_e64 v179, v175, v8, s[56:57]
    s_mul_i32 s53, s45, 2304
    s_add_u32 s53, s53, s51
    s_waitcnt vmcnt(0)
    v_cmp_eq_u64 vcc, s[98:99], v[12:13]
    s_nop 0
    s_cmp_eq_u64 vcc, exec
    s_cbranch_scc0 L_px_slow_43
L_px_back_44:
    s_barrier
    s_add_u32 m0, s48, 18432
    s_add_u32 s53, s47, 0
    buffer_load_dwordx4 v2, s[4:7], s53 offen offset:0 lds
    buffer_load_dwordx4 v2, s[4:7], s53 offen offset:1024 lds
    buffer_load_dwordx4 v2, s[4:7], s53 offen offset:2048 lds
    buffer_load_dwordx4 v2, s[4:7], s53 offen offset:3072 lds
    s_add_u32 m0, s48, 22528
    s_add_u32 s53, s47, 4096
    buffer_load_dwordx4 v2, s[4:7], s53 offen offset:0 lds
    buffer_load_dwordx4 v2, s[4:7], s53 offen offset:1024 lds
    buffer_load_dwordx4 v2, s[4:7], s53 offen offset:2048 lds
    buffer_load_dwordx4 v2, s[4:7], s53 offen offset:3072 lds
    s_add_u32 m0, s48, 26624
    s_add_u32 s53, s47, 8192
    buffer_load_dwordx4 v2, s[4:7], s53 offen offset:0 lds
    buffer_load_dwordx4 v2, s[4:7], s53 offen offset:1024 lds
    buffer_load_dwordx4 v2, s[4:7], s53 offen offset:2048 lds
    s_add_u32 s54, s51, 0
    buffer_load_dwordx4 a[0:3], v2, s[4:7], s54 offen offset:0 sc1
    s_add_u32 s55, s51, 18432
    buffer_load_dwordx4 a[72:75], v2, s[4:7], s55 offen offset:0 sc1
    buffer_load_dwordx4 a[4:7], v2, s[4:7], s54 offen offset:1024 sc1
    buffer_load_dwordx4 a[76:79], v2, s[4:7], s55 offen offset:1024 sc1
    buffer_load_dwordx4 a[8:11], v2, s[4:7], s54 offen offset:2048 sc1
    buffer_load_dwordx4 a[80:83], v2, s[4:7], s55 offen offset:2048 sc1
    buffer_load_dwordx4 a[12:15], v2, s[4:7], s54 offen offset:3072 sc1
    buffer_load_dwordx4 a[84:87], v2, s[4:7], s55 offen offset:3072 sc1
    s_add_u32 s54, s51, 4096
    buffer_load_dwordx4 a[16:19], v2, s[4:7], s54 offen offset:0 sc1
    s_add_u32 s55, s51, 22528
    buffer_load_dwordx4 a[88:91], v2, s[4:7], s55 offen offset:0 sc1
    buffer_load_dwordx4 a[20:23], v2, s[4:7], s54 offen offset:1024 sc1
    buffer_load_dwordx4 a[92:95], v2, s[4:7], s55 offen offset:1024 sc1
    s_add_u32 m0, s48, 61440
    s_add_u32 s53, s47, 43008
    buffer_load_dwordx4 v2, s[4:7], s53 offen offset:0 lds
    buffer_load_dwordx4 v2, s[4:7], s53 offen offset:1024 lds
    buffer_load_dwordx4 v2, s[4:7], s53 offen offset:2048 lds
    buffer_load_dwordx4 v2, s[4:7], s53 offen offset:3072 lds
    s_add_u32 m0, s48, 65536
    s_add_u32 s53, s47, 47104
    buffer_load_dwordx4 v2, s[4:7], s53 offen offset:0 lds
    buffer_load_dwordx4 v2, s[4:7], s53 offen offset:1024 lds
    buffer_load_dwordx4 v2, s[4:7], s53 offen offset:2048 lds
    buffer_load_dwordx4 v2, s[4:7], s53 offen offset:3072 lds
    s_add_u32 m0, s48, 69632
    s_add_u32 s53, s47, 51200
    buffer_load_dwordx4 v2, s[4:7], s53 offen offset:0 lds
    buffer_load_dwordx4 v2, s[4:7], s53 offen offset:1024 lds
    buffer_load_dwordx4 v2, s[4:7], s53 offen offset:2048 lds
    s_waitcnt vmcnt(23)
    s_barrier
    ds_read_b128 v[88:91], v3 offset:0
    ds_read_b128 v[92:95], v3 offset:1024
    ds_read_b128 v[96:99], v3 offset:2048
    ds_read_b128 v[100:103], v3 offset:3072
    ds_read_b128 v[112:115], v3 offset:6144
    ds_read_b128 v[104:107], v3 offset:4096
    ds_read_b128 v[108:111], v3 offset:5120
    s_waitcnt vmcnt(22) lgkmcnt(6)
    s_add_u32 m0, s50, 0
    s_add_u32 s53, s49, 0
    v_mfma_f32_16x16x32_bf16 v[16:19], v[88:91], a[0:3], 0
    buffer_load_dwordx4 v2, s[4:7], s53 offen offset:0 sc1 lds
    s_waitcnt vmcnt(22)
    v_mfma_f32_16x16x32_bf16 v[48:51], v[88:91], a[72:75], 0
    s_waitcnt lgkmcnt(5)
    ds_read_b128 v[116:119], v3 offset:7168
    ds_read_b128 v[120:123], v3 offset:8192
    v_mfma_f32_16x16x32_bf16 v[20:23], v[92:95], a[0:3], 0
    v_mfma_f32_16x16x32_bf16 v[52:55], v[92:95], a[72:75], 0
    s_waitcnt lgkmcnt(6)
    ds_read_b128 v[124:127], v3 offset:9216
    v_mfma_f32_16x16x32_bf16 v[24:27], v[96:99], a[0:3], 0
    buffer_load_dwordx4 v2, s[4:7], s53 offen offset:1024 sc1 lds
    v_mfma_f32_16x16x32_bf16 v[56:59], v[96:99], a[72:75], 0
    s_waitcnt lgkmcnt(6)
    ds_read_b128 v[128:131], v3 offset:10240
    v_mfma_f32_16x16x32_bf16 v[28:31], v[100:103], a[0:3], 0
    v_mfma_f32_16x16x32_bf16 v[60:63], v[100:103], a[72:75], 0
    s_waitcnt lgkmcnt(6)
    ds_read_b128 v[140:143], v3 offset:13312
    v_mfma_f32_16x16x32_bf16 v[32:35], v[112:115], a[0:3], 0
    buffer_load_dwordx4 v2, s[4:7], s53 offen offset:2048 sc1 lds
    v_mfma_f32_16x16x32_bf16 v[64:67], v[112:115], a[72:75], 0
    s_waitcnt lgkmcnt(6)
    ds_read_b128 v[132:135], v3 offset:11264
    v_mfma_f32_16x16x32_bf16 v[36:39], a[0:3], v[104:107], 0
    ds_read_b128 v[136:139], v3 offset:12288
    v_mfma_f32_16x16x32_bf16 v[68:71], a[72:75], v[104:107], 0
    s_waitcnt lgkmcnt(7)
    v_mfma_f32_16x16x32_bf16 v[40:43], a[0:3], v[108:111], 0
    buffer_load_dwordx4 v2, s[4:7], s53 offen offset:3072 sc1 lds
    v_mfma_f32_16x16x32_bf16 v[72:75], a[72:75], v[108:111], 0
    s_waitcnt vmcnt(24) lgkmcnt(6)
    s_add_u32 m0, s50, 4096
    s_add_u32 s53, s49, 4096
    v_mfma_f32_16x16x32_bf16 v[16:19], v[116:119], a[4:7], v[16:19]
    s_waitcnt vmcnt(23)
    ds_read_b128 v[88:91], v3 offset:14336
    v_mfma_f32_16x16x32_bf16 v[48:51], v[116:119], a[76:79], v[48:51]
    s_waitcnt lgkmcnt(6)
    ds_read_b128 v[92:95], v3 offset:15360
    v_mfma_f32_16x16x32_bf16 v[20:23], v[120:123], a[4:7], v[20:23]
    buffer_load_dwordx4 v2, s[4:7], s53 offen offset:0 sc1 lds
    v_mfma_f32_16x16x32_bf16 v[52:55], v[120:123], a[76:79], v[52:55]
    s_waitcnt lgkmcnt(6)
    ds_read_b128 v[96:99], v3 offset:16384
    v_mfma_f32_16x16x32_bf16 v[24:27], v[124:127], a[4:7], v[24:27]
    v_mfma_f32_16x16x32_bf16 v[56:59], v[124:127], a[76:79], v[56:59]
    s_waitcnt lgkmcnt(6)
    ds_read_b128 v[100:103], v3 offset:17408
    v_mfma_f32_16x16x32_bf16 v[28:31], v[128:131], a[4:7], v[28:31]
    buffer_load_dwordx4 a[24:27], v2, s[4:7], s54 offen offset:2048 sc1
    v_mfma_f32_16x16x32_bf16 v[60:63], v[128:131], a[76:79], v[60:63]
    s_waitcnt lgkmcnt(6)
    ds_read_b128 v[112:115], v3 offset:20480
    v_mfma_f32_16x16x32_bf16 v[32:35], v[140:143], a[4:7], v[32:35]
    ds_read_b128 v[104:107], v3 offset:18432
    v_mfma_f32_16x16x32_bf16 v[64:67], v[140:143], a[76:79], v[64:67]
    s_waitcnt lgkmcnt(7)
    v_mfma_f32_16x16x32_bf16 v[36:39], a[4:7], v[132:135], v[36:39]
    ds_read_b128 v[108:111], v3 offset:19456
    v_mfma_f32_16x16x32_bf16 v[68:71], a[76:79], v[132:135], v[68:71]
    s_waitcnt lgkmcnt(7)
    v_mfma_f32_16x16x32_bf16 v[40:43], a[4:7], v[136:139], v[40:43]
    buffer_load_dwordx4 a[96:99], v2, s[4:7], s55 offen offset:2048 sc1
    v_mfma_f32_16x16x32_bf16 v[72:75], a[76:79], v[136:139], v[72:75]
    s_waitcnt vmcnt(25) lgkmcnt(6)
    v_mfma_f32_16x16x32_bf16 v[16:19], v[88:91], a[8:11], v[16:19]
    s_waitcnt vmcnt(24)
    ds_read_b128 v[116:119], v3 offset:21504
    v_mfma_f32_16x16x32_bf16 v[48:51], v[88:91], a[80:83], v[48:51]
    s_waitcnt lgkmcnt(6)
    ds_read_b128 v[120:123], v3 offset:22528
    v_mfma_f32_16x16x32_bf16 v[20:23], v[92:95], a[8:11], v[20:23]
    buffer_load_dwordx4 a[28:31], v2, s[4:7], s54 offen offset:3072 sc1
    v_mfma_f32_16x16x32_bf16 v[52:55], v[92:95], a[80:83], v[52:55]
    s_waitcnt lgkmcnt(6)
    ds_read_b128 v[124:127], v3 offset:23552
    v_mfma_f32_16x16x32_bf16 v[24:27], v[96:99], a[8:11], v[24:27]
    v_mfma_f32_16x16x32_bf16 v[56:59], v[96:99], a[80:83], v[56:59]
    s_waitcnt lgkmcnt(6)
    ds_read_b128 v[128:131], v3 offset:24576
    v_mfma_f32_16x16x32_bf16 v[28:31], v[100:103], a[8:11], v[28:31]
    buffer_load_dwordx4 a[100:103], v2, s[4:7], s55 offen offset:3072 sc1
    v_mfma_f32_16x16x32_bf16 v[60:63], v[100:103], a[80:83], v[60:63]
    s_waitcnt lgkmcnt(6)
    s_add_u32 s54, s51, 8192
    ds_read_b128 v[140:143], v3 offset:27648
    v_mfma_f32_16x16x32_bf16 v[32:35], v[112:115], a[8:11], v[32:35]
    ds_read_b128 v[132:135], v3 offset:25600
    v_mfma_f32_16x16x32_bf16 v[64:67], v[112:115], a[80:83], v[64:67]
    s_waitcnt lgkmcnt(7)
    v_mfma_f32_16x16x32_bf16 v[36:39], a[8:11], v[104:107], v[36:39]
    ds_read_b128 v[136:139], v3 offset:26624
    v_mfma_f32_16x16x32_bf16 v[68:71], a[80:83], v[104:107], v[68:71]
    s_waitcnt lgkmcnt(7)
    v_mfma_f32_16x16x32_bf16 v[40:43], a[8:11], v[108:111], v[40:43]
    buffer_store_dwordx4 v[180:183], v2, s[4:7], s67 offen sc1
    v_mfma_f32_16x16x32_bf16 v[72:75], a[80:83], v[108:111], v[72:75]
    s_waitcnt vmcnt(26) lgkmcnt(6)
    v_mfma_f32_16x16x32_bf16 v[16:19], v[116:119], a[12:15], v[16:19]
    s_waitcnt vmcnt(25)
    ds_read_b128 v[88:91], v3 offset:28672
    v_mfma_f32_16x16x32_bf16 v[48:51], v[116:119], a[84:87], v[48:51]
    s_waitcnt lgkmcnt(6)
    ds_read_b128 v[92:95], v3 offset:29696
    v_mfma_f32_16x16x32_bf16 v[20:23], v[120:123], a[12:15], v[20:23]
    buffer_load_dwordx4 a[32:35], v2, s[4:7], s54 offen offset:0 sc1
    v_mfma_f32_16x16x32_bf16 v[52:55], v[120:123], a[84:87], v[52:55]
    s_waitcnt lgkmcnt(6)
    s_add_u32 s55, s51, 26624
    ds_read_b128 v[96:99], v3 offset:30720
    v_mfma_f32_16x16x32_bf16 v[24:27], v[124:127], a[12:15], v[24:27]
    v_mfma_f32_16x16x32_bf16 v[56:59], v[124:127], a[84:87], v[56:59]
    s_waitcnt lgkmcnt(6)
    ds_read_b128 v[100:103], v3 offset:31744
    v_mfma_f32_16x16x32_bf16 v[28:31], v[128:131], a[12:15], v[28:31]
    buffer_load_dwordx4 a[104:107], v2, s[4:7], s55 offen offset:0 sc1
    v_mfma_f32_16x16x32_bf16 v[60:63], v[128:131], a[84:87], v[60:63]
    s_waitcnt lgkmcnt(6)
    ds_read_b128 v[112:115], v3 offset:34816
    v_mfma_f32_16x16x32_bf16 v[32:35], v[140:143], a[12:15], v[32:35]
    ds_read_b128 v[104:107], v3 offset:32768
    v_mfma_f32_16x16x32_bf16 v[64:67], v[140:143], a[84:87], v[64:67]
    s_waitcnt lgkmcnt(7)
    v_mfma_f32_16x16x32_bf16 v[36:39], a[12:15], v[132:135], v[36:39]
    ds_read_b128 v[108:111], v3 offset:33792
    v_mfma_f32_16x16x32_bf16 v[68:71], a[84:87], v[132:135], v[68:71]
    s_waitcnt lgkmcnt(7)
    v_mfma_f32_16x16x32_bf16 v[40:43], a[12:15], v[136:139], v[40:43]
    buffer_load_dwordx4 a[36:39], v2, s[4:7], s54 offen offset:1024 sc1
    v_mfma_f32_16x16x32_bf16 v[72:75], a[84:87], v[136:139], v[72:75]
    s_waitcnt vmcnt(27) lgkmcnt(6)
    v_mfma_f32_16x16x32_bf16 v[16:19], v[88:91], a[16:19], v[16:19]
    s_waitcnt vmcnt(26)
    ds_read_b128 v[116:119], v3 offset:35840
    v_mfma_f32_16x16x32_bf16 v[48:51], v[88:91], a[88:91], v[48:51]
    s_waitcnt lgkmcnt(6)
    ds_read_b128 v[120:123], v3 offset:36864
    v_mfma_f32_16x16x32_bf16 v[20:23], v[92:95], a[16:19], v[20:23]
    buffer_load_dwordx4 a[108:111], v2, s[4:7], s55 offen offset:1024 sc1
    v_mfma_f32_16x16x32_bf16 v[52:55], v[92:95], a[88:91], v[52:55]
    s_waitcnt lgkmcnt(6)
    ds_read_b128 v[124:127], v3 offset:37888
    v_mfma_f32_16x16x32_bf16 v[24:27], v[96:99], a[16:19], v[24:27]
    v_mfma_f32_16x16x32_bf16 v[56:59], v[96:99], a[88:91], v[56:59]
    s_waitcnt lgkmcnt(6)
    ds_read_b128 v[128:131], v3 offset:38912
    v_mfma_f32_16x16x32_bf16 v[28:31], v[100:103], a[16:19], v[28:31]
    buffer_load_dwordx4 a[40:43], v2, s[4:7], s54 offen offset:2048 sc1
    v_mfma_f32_16x16x32_bf16 v[60:63], v[100:103], a[88:91], v[60:63]
    s_waitcnt lgkmcnt(6)
    s_add_u32 s92, s67, s70
    ds_read_b128 v[140:143], v3 offset:41984
    v_mfma_f32_16x16x32_bf16 v[32:35], v[112:115], a[16:19], v[32:35]
    ds_read_b128 v[132:135], v3 offset:39936
    v_mfma_f32_16x16x32_bf16 v[64:67], v[112:115], a[88:91], v[64:67]
    s_waitcnt lgkmcnt(7)
    v_mfma_f32_16x16x32_bf16 v[36:39], a[16:19], v[104:107], v[36:39]
    ds_read_b128 v[136:139], v3 offset:40960
    v_mfma_f32_16x16x32_bf16 v[68:71], a[88:91], v[104:107], v[68:71]
    buffer_store_dwordx4 v[184:187], v2, s[4:7], s92 offen sc1
    s_waitcnt lgkmcnt(7)
    v_mfma_f32_16x16x32_bf16 v[40:43], a[16:19], v[108:111], v[40:43]
    v_mfma_f32_16x16x32_bf16 v[72:75], a[88:91], v[108:111], v[72:75]
    s_waitcnt vmcnt(28) lgkmcnt(6)
    v_mfma_f32_16x16x32_bf16 v[16:19], v[116:119], a[20:23], v[16:19]
    s_waitcnt vmcnt(27)
    s_waitcnt vmcnt(16)
    s_waitcnt vmcnt(11)
    s_barrier
    v_mfma_f32_16x16x32_bf16 v[48:51], v[116:119], a[92:95], v[48:51]
    s_waitcnt lgkmcnt(5)
    ds_read_b128 v[88:91], v3 offset:43008
    ds_read_b128 v[92:95], v3 offset:44032
    v_mfma_f32_16x16x32_bf16 v[20:23], v[120:123], a[20:23], v[20:23]
    buffer_load_dwordx4 a[112:115], v2, s[4:7], s55 offen offset:2048 sc1
    v_mfma_f32_16x16x32_bf16 v[52:55], v[120:123], a[92:95], v[52:55]
    s_waitcnt lgkmcnt(6)
    ds_read_b128 v[96:99], v3 offset:45056
    ds_read_b128 v[144:147], v10 offset:0
    v_mfma_f32_16x16x32_bf16 v[24:27], v[124:127], a[20:23], v[24:27]
    ds_read_b128 v[148:151], v4 offset:0
    ds_read_b128 v[152:155], v5 offset:0
    v_mfma_f32_16x16x32_bf16 v[56:59], v[124:127], a[92:95], v[56:59]
    s_waitcnt lgkmcnt(9)
    ds_read_b128 v[100:103], v3 offset:46080
    ds_read_b128 v[156:159], v10 offset:1024
    v_mfma_f32_16x16x32_bf16 v[28:31], v[128:131], a[20:23], v[28:31]
    buffer_load_dwordx4 a[44:47], v2, s[4:7], s54 offen offset:3072 sc1
    v_mfma_f32_16x16x32_bf16 v[60:63], v[128:131], a[92:95], v[60:63]
    s_waitcnt lgkmcnt(10)
    ds_read_b128 v[112:115], v3 offset:49152
    ds_read_b128 v[160:163], v4 offset:7168
    v_mfma_f32_16x16x32_bf16 v[32:35], v[140:143], a[20:23], v[32:35]
    ds_read_b128 v[104:107], v3 offset:47104
    ds_read_b128 v[164:167], v5 offset:7168
    v_mfma_f32_16x16x32_bf16 v[64:67], v[140:143], a[92:95], v[64:67]
    s_waitcnt lgkmcnt(13)
    v_mfma_f32_16x16x32_bf16 v[36:39], a[20:23], v[132:135], v[36:39]
    ds_read_b128 v[108:111], v3 offset:48128
    v_mfma_f32_16x16x32_bf16 v[68:71], a[92:95], v[132:135], v[68:71]
    s_waitcnt lgkmcnt(13)
    v_mfma_f32_16x16x32_bf16 v[40:43], a[20:23], v[136:139], v[40:43]
    buffer_load_dwordx4 a[116:119], v2, s[4:7], s55 offen offset:3072 sc1
    v_mfma_f32_16x16x32_bf16 v[72:75], a[92:95], v[136:139], v[72:75]
    s_waitcnt vmcnt(13) lgkmcnt(12)
    s_add_u32 m0, s48, 104448
    s_add_u32 s53, s47, 86016
    v_mfma_f32_16x16x32_bf16 v[16:19], v[88:91], a[24:27], v[16:19]
    s_waitcnt vmcnt(12)
    ds_read_b128 v[116:119], v3 offset:50176
    v_mfma_f32_16x16x32_bf16 v[48:51], v[88:91], a[96:99], v[48:51]
    s_waitcnt lgkmcnt(12)
    ds_read_b128 v[120:123], v3 offset:51200
    v_mfma_f32_16x16x32_bf16 v[20:23], v[92:95], a[24:27], v[20:23]
    buffer_load_dwordx4 v2, s[4:7], s53 offen offset:0 lds
    v_mfma_f32_16x16x32_bf16 v[52:55], v[92:95], a[96:99], v[52:55]
    s_waitcnt lgkmcnt(12)
    s_add_u32 s92, s67, s71
    ds_read_b128 v[124:127], v3 offset:52224
    v_mfma_f32_16x16x32_bf16 v[24:27], v[96:99], a[24:27], v[24:27]
    v_mfma_f32_16x16x32_bf16 v[56:59], v[96:99], a[96:99], v[56:59]
    s_waitcnt lgkmcnt(9)
    ds_read_b128 v[128:131], v3 offset:53248
    v_mfma_f32_16x16x32_bf16 v[28:31], v[100:103], a[24:27], v[28:31]
    buffer_store_dwordx4 v[188:191], v2, s[4:7], s92 offen sc1
    v_mfma_f32_16x16x32_bf16 v[60:63], v[100:103], a[96:99], v[60:63]
    s_waitcnt lgkmcnt(8)
    ds_read_b128 v[140:143], v3 offset:56320
    v_mfma_f32_16x16x32_bf16 v[32:35], v[112:115], a[24:27], v[32:35]
    ds_read_b128 v[132:135], v3 offset:54272
    v_mfma_f32_16x16x32_bf16 v[64:67], v[112:115], a[96:99], v[64:67]
    s_waitcnt lgkmcnt(8)
    v_mfma_f32_16x16x32_bf16 v[36:39], a[24:27], v[104:107], v[36:39]
    ds_read_b128 v[136:139], v3 offset:55296
    v_mfma_f32_16x16x32_bf16 v[68:71], a[96:99], v[104:107], v[68:71]
    s_waitcnt lgkmcnt(7)
    v_mfma_f32_16x16x32_bf16 v[40:43], a[24:27], v[108:111], v[40:43]
    buffer_load_dwordx4 v2, s[4:7], s53 offen offset:1024 lds
    v_mfma_f32_16x16x32_bf16 v[72:75], a[96:99], v[108:111], v[72:75]
    v_mfma_f32_16x16x32_bf16 v[80:83], v[148:151], v[144:147], 0
    v_mfma_f32_16x16x32_bf16 v[84:87], v[144:147], v[152:155], 0
    s_waitcnt vmcnt(14) lgkmcnt(6)
    ds_read_b128 v[144:147], v10 offset:2048
    ds_read_b128 v[148:151], v4 offset:14336
    v_mfma_f32_16x16x32_bf16 v[16:19], v[116:119], a[28:31], v[16:19]
    buffer_load_dwordx4 v2, s[4:7], s53 offen offset:2048 lds
    s_waitcnt vmcnt(14)
    v_mfma_f32_16x16x32_bf16 v[48:51], v[116:119], a[100:103], v[48:51]
    s_waitcnt lgkmcnt(7)
    ds_read_b128 v[88:91], v3 offset:57344
    ds_read_b128 v[92:95], v3 offset:58368
    v_mfma_f32_16x16x32_bf16 v[20:23], v[120:123], a[28:31], v[20:23]
    ds_read_b128 v[152:155], v5 offset:14336
    v_mfma_f32_16x16x32_bf16 v[52:55], v[120:123], a[100:103], v[52:55]
    s_waitcnt lgkmcnt(9)
    ds_read_b128 v[96:99], v3 offset:59392
    v_mfma_f32_16x16x32_bf16 v[24:27], v[124:127], a[28:31], v[24:27]
    buffer_load_dwordx4 v2, s[4:7], s53 offen offset:3072 lds
    v_mfma_f32_16x16x32_bf16 v[56:59], v[124:127], a[100:103], v[56:59]
    s_waitcnt lgkmcnt(9)
    s_add_u32 m0, s48, 108544
    s_add_u32 s53, s47, 90112
    v_mfma_f32_16x16x32_bf16 v[28:31], v[128:131], a[28:31], v[28:31]
    ds_read_b128 v[100:103], v3 offset:60416
    v_mfma_f32_16x16x32_bf16 v[60:63], v[128:131], a[100:103], v[60:63]
    s_waitcnt lgkmcnt(9)
    ds_read_b128 v[112:115], v3 offset:63488
    v_mfma_f32_16x16x32_bf16 v[32:35], v[140:143], a[28:31], v[32:35]
    buffer_load_dwordx4 v2, s[4:7], s53 offen offset:0 lds
    v_mfma_f32_16x16x32_bf16 v[64:67], v[140:143], a[100:103], v[64:67]
    s_waitcnt lgkmcnt(9)
    ds_read_b128 v[104:107], v3 offset:61440
    v_mfma_f32_16x16x32_bf16 v[36:39], a[28:31], v[132:135], v[36:39]
    ds_read_b128 v[108:111], v3 offset:62464
    v_mfma_f32_16x16x32_bf16 v[68:71], a[100:103], v[132:135], v[68:71]
    s_waitcnt lgkmcnt(10)
    s_add_u32 s92, s92, s70
    v_mfma_f32_16x16x32_bf16 v[40:43], a[28:31], v[136:139], v[40:43]
    buffer_store_dwordx4 v[192:195], v2, s[4:7], s92 offen sc1
    v_mfma_f32_16x16x32_bf16 v[72:75], a[100:103], v[136:139], v[72:75]
    v_mfma_f32_16x16x32_bf16 v[80:83], v[160:163], v[156:159], v[80:83]
    v_mfma_f32_16x16x32_bf16 v[84:87], v[156:159], v[164:167], v[84:87]
    s_waitcnt vmcnt(15) lgkmcnt(7)
    ds_read_b128 v[156:159], v10 offset:3072
    ds_read_b128 v[160:163], v4 offset:21504
    v_mfma_f32_16x16x32_bf16 v[16:19], v[88:91], a[32:35], v[16:19]
    buffer_load_dwordx4 v2, s[4:7], s53 offen offset:1024 lds
    s_waitcnt vmcnt(15)
    v_mfma_f32_16x16x32_bf16 v[48:51], v[88:91], a[104:107], v[48:51]
    s_waitcnt lgkmcnt(8)
    ds_read_b128 v[164:167], v5 offset:21504
    v_add_u32 v3, 64512, v3
    v_mfma_f32_16x16x32_bf16 v[20:23], v[92:95], a[32:35], v[20:23]
    ds_read_b128 v[116:119], v3 offset:0
    v_mfma_f32_16x16x32_bf16 v[52:55], v[92:95], a[104:107], v[52:55]
    s_waitcnt lgkmcnt(8)
    ds_read_b128 v[120:123], v3 offset:1024
    v_mfma_f32_16x16x32_bf16 v[24:27], v[96:99], a[32:35], v[24:27]
    buffer_load_dwordx4 v2, s[4:7], s53 offen offset:2048 lds
    v_mfma_f32_16x16x32_bf16 v[56:59], v[96:99], a[104:107], v[56:59]
    s_waitcnt lgkmcnt(8)
    ds_read_b128 v[124:127], v3 offset:2048
    v_mfma_f32_16x16x32_bf16 v[28:31], v[100:103], a[32:35], v[28:31]
    v_mfma_f32_16x16x32_bf16 v[60:63], v[100:103], a[104:107], v[60:63]
    buffer_load_dwordx4 v2, s[4:7], s53 offen offset:3072 lds
    s_add_u32 m0, s48, 112640
    s_add_u32 s53, s47, 94208
    buffer_load_dwordx4 v2, s[4:7], s53 offen offset:0 lds
    buffer_load_dwordx4 v2, s[4:7], s53 offen offset:1024 lds
    buffer_load_dwordx4 v2, s[4:7], s53 offen offset:2048 lds
    s_waitcnt lgkmcnt(8)
    v_mfma_f32_16x16x32_bf16 v[32:35], v[112:115], a[32:35], v[32:35]
    s_add_u32 s54, s51, 12288
    ds_read_b128 v[128:131], v3 offset:3072
    ds_read_b128 v[140:143], v3 offset:6144
    v_mfma_f32_16x16x32_bf16 v[64:67], v[112:115], a[104:107], v[64:67]
    s_waitcnt lgkmcnt(9)
    v_mfma_f32_16x16x32_bf16 v[36:39], a[32:35], v[104:107], v[36:39]
    ds_read_b128 v[132:135], v3 offset:4096
    v_mfma_f32_16x16x32_bf16 v[68:71], a[104:107], v[104:107], v[68:71]
    s_waitcnt lgkmcnt(9)
    v_mfma_f32_16x16x32_bf16 v[40:43], a[32:35], v[108:111], v[40:43]
    ds_read_b128 v[136:139], v3 offset:5120
    v_mfma_f32_16x16x32_bf16 v[72:75], a[104:107], v[108:111], v[72:75]
    v_mfma_f32_16x16x32_bf16 v[80:83], v[148:151], v[144:147], v[80:83]
    v_mfma_f32_16x16x32_bf16 v[84:87], v[144:147], v[152:155], v[84:87]
    s_waitcnt vmcnt(19) lgkmcnt(6)
    ds_read_b128 v[144:147], v10 offset:4096
    ds_read_b128 v[148:151], v4 offset:28672
    v_mfma_f32_16x16x32_bf16 v[16:19], v[116:119], a[36:39], v[16:19]
    buffer_load_dwordx4 a[48:51], v2, s[4:7], s54 offen offset:0 sc1
    s_waitcnt vmcnt(19)
    v_mfma_f32_16x16x32_bf16 v[48:51], v[116:119], a[108:111], v[48:51]
    s_waitcnt lgkmcnt(7)
    s_add_u32 s55, s51, 30720
    ds_read_b128 v[88:91], v3 offset:7168
    v_mfma_f32_16x16x32_bf16 v[20:23], v[120:123], a[36:39], v[20:23]
    ds_read_b128 v[92:95], v3 offset:8192
    ds_read_b128 v[152:155], v5 offset:28672
    v_mfma_f32_16x16x32_bf16 v[52:55], v[120:123], a[108:111], v[52:55]
    s_waitcnt lgkmcnt(9)
    ds_read_b128 v[96:99], v3 offset:9216
    v_mfma_f32_16x16x32_bf16 v[24:27], v[124:127], a[36:39], v[24:27]
    buffer_load_dwordx4 a[120:123], v2, s[4:7], s55 offen offset:0 sc1
    v_mfma_f32_16x16x32_bf16 v[56:59], v[124:127], a[108:111], v[56:59]
    s_waitcnt lgkmcnt(9)
    ds_read_b128 v[100:103], v3 offset:10240
    v_mfma_f32_16x16x32_bf16 v[28:31], v[128:131], a[36:39], v[28:31]
    v_mfma_f32_16x16x32_bf16 v[60:63], v[128:131], a[108:111], v[60:63]
    buffer_store_dwordx4 v[196:199], v2, s[4:7], s68 offen sc1
    s_waitcnt lgkmcnt(9)
    v_mfma_f32_16x16x32_bf16 v[32:35], v[140:143], a[36:39], v[32:35]
    ds_read_b128 v[112:115], v3 offset:13312
    ds_read_b128 v[104:107], v3 offset:11264
    v_mfma_f32_16x16x32_bf16 v[64:67], v[140:143], a[108:111], v[64:67]
    s_waitcnt lgkmcnt(10)
    v_mfma_f32_16x16x32_bf16 v[36:39], a[36:39], v[132:135], v[36:39]
    ds_read_b128 v[108:111], v3 offset:12288
    v_mfma_f32_16x16x32_bf16 v[68:71], a[108:111], v[132:135], v[68:71]
    s_waitcnt lgkmcnt(10)
    v_mfma_f32_16x16x32_bf16 v[40:43], a[36:39], v[136:139], v[40:43]
    buffer_load_dwordx4 a[52:55], v2, s[4:7], s54 offen offset:1024 sc1
    v_mfma_f32_16x16x32_bf16 v[72:75], a[108:111], v[136:139], v[72:75]
    v_mfma_f32_16x16x32_bf16 v[80:83], v[160:163], v[156:159], v[80:83]
    v_mfma_f32_16x16x32_bf16 v[84:87], v[156:159], v[164:167], v[84:87]
    s_waitcnt vmcnt(21) lgkmcnt(7)
    ds_read_b128 v[156:159], v10 offset:5120
    ds_read_b128 v[160:163], v4 offset:35840
    v_mfma_f32_16x16x32_bf16 v[16:19], v[88:91], a[40:43], v[16:19]
    buffer_load_dwordx4 a[124:127], v2, s[4:7], s55 offen offset:1024 sc1
    s_waitcnt vmcnt(20)
    v_mfma_f32_16x16x32_bf16 v[48:51], v[88:91], a[112:115], v[48:51]
    s_waitcnt lgkmcnt(8)
    ds_read_b128 v[116:119], v3 offset:14336
    ds_read_b128 v[120:123], v3 offset:15360
    v_mfma_f32_16x16x32_bf16 v[20:23], v[92:95], a[40:43], v[20:23]
    ds_read_b128 v[164:167], v5 offset:35840
    v_mfma_f32_16x16x32_bf16 v[52:55], v[92:95], a[112:115], v[52:55]
    s_waitcnt lgkmcnt(9)
    ds_read_b128 v[124:127], v3 offset:16384
    v_mfma_f32_16x16x32_bf16 v[24:27], v[96:99], a[40:43], v[24:27]
    buffer_load_dwordx4 a[56:59], v2, s[4:7], s54 offen offset:2048 sc1
    v_mfma_f32_16x16x32_bf16 v[56:59], v[96:99], a[112:115], v[56:59]
    s_waitcnt lgkmcnt(9)
    ds_read_b128 v[128:131], v3 offset:17408
    v_mfma_f32_16x16x32_bf16 v[28:31], v[100:103], a[40:43], v[28:31]
    v_mfma_f32_16x16x32_bf16 v[60:63], v[100:103], a[112:115], v[60:63]
    s_waitcnt lgkmcnt(9)
    ds_read_b128 v[140:143], v3 offset:20480
    v_mfma_f32_16x16x32_bf16 v[32:35], v[112:115], a[40:43], v[32:35]
    buffer_load_dwordx4 a[128:131], v2, s[4:7], s55 offen offset:2048 sc1
    v_mfma_f32_16x16x32_bf16 v[64:67], v[112:115], a[112:115], v[64:67]
    s_waitcnt lgkmcnt(9)
    ds_read_b128 v[132:135], v3 offset:18432
    v_mfma_f32_16x16x32_bf16 v[36:39], a[40:43], v[104:107], v[36:39]
    ds_read_b128 v[136:139], v3 offset:19456
    v_mfma_f32_16x16x32_bf16 v[68:71], a[112:115], v[104:107], v[68:71]
    s_waitcnt lgkmcnt(10)
    s_add_u32 s92, s68, s70
    v_mfma_f32_16x16x32_bf16 v[40:43], a[40:43], v[108:111], v[40:43]
    buffer_store_dwordx4 v[200:203], v2, s[4:7], s92 offen sc1
    v_mfma_f32_16x16x32_bf16 v[72:75], a[112:115], v[108:111], v[72:75]
    v_mfma_f32_16x16x32_bf16 v[80:83], v[148:151], v[144:147], v[80:83]
    v_mfma_f32_16x16x32_bf16 v[84:87], v[144:147], v[152:155], v[84:87]
    s_waitcnt vmcnt(22) lgkmcnt(7)
    ds_read_b128 v[144:147], v10 offset:6144
    ds_read_b128 v[148:151], v4 offset:43008
    v_mfma_f32_16x16x32_bf16 v[16:19], v[116:119], a[44:47], v[16:19]
    s_waitcnt vmcnt(21)
    s_waitcnt vmcnt(8)
    s_barrier
    ds_read_b128 v[88:91], v3 offset:21504
    v_mfma_f32_16x16x32_bf16 v[48:51], v[116:119], a[116:119], v[48:51]
    s_waitcnt lgkmcnt(9)
    ds_read_b128 v[92:95], v3 offset:22528
    ds_read_b128 v[152:155], v5 offset:43008
    v_mfma_f32_16x16x32_bf16 v[20:23], v[120:123], a[44:47], v[20:23]
    buffer_load_dwordx4 a[60:63], v2, s[4:7], s54 offen offset:3072 sc1
    v_mfma_f32_16x16x32_bf16 v[52:55], v[120:123], a[116:119], v[52:55]
    s_waitcnt lgkmcnt(9)
    ds_read_b128 v[96:99], v3 offset:23552
    v_mfma_f32_16x16x32_bf16 v[24:27], v[124:127], a[44:47], v[24:27]
    v_mfma_f32_16x16x32_bf16 v[56:59], v[124:127], a[116:119], v[56:59]
    s_waitcnt lgkmcnt(9)
    ds_read_b128 v[100:103], v3 offset:24576
    v_mfma_f32_16x16x32_bf16 v[28:31], v[128:131], a[44:47], v[28:31]
    buffer_load_dwordx4 a[132:135], v2, s[4:7], s55 offen offset:3072 sc1
    v_mfma_f32_16x16x32_bf16 v[60:63], v[128:131], a[116:119], v[60:63]
    s_waitcnt lgkmcnt(9)
    s_add_u32 s54, s51, 16384
    ds_read_b128 v[112:115], v3 offset:27648
    v_mfma_f32_16x16x32_bf16 v[32:35], v[140:143], a[44:47], v[32:35]
    ds_read_b128 v[104:107], v3 offset:25600
    v_mfma_f32_16x16x32_bf16 v[64:67], v[140:143], a[116:119], v[64:67]
    s_waitcnt lgkmcnt(10)
    v_mfma_f32_16x16x32_bf16 v[36:39], a[44:47], v[132:135], v[36:39]
    ds_read_b128 v[108:111], v3 offset:26624
    v_mfma_f32_16x16x32_bf16 v[68:71], a[116:119], v[132:135], v[68:71]
    s_waitcnt lgkmcnt(10)
    v_mfma_f32_16x16x32_bf16 v[40:43], a[44:47], v[136:139], v[40:43]
    buffer_load_dwordx4 a[64:67], v2, s[4:7], s54 offen offset:0 sc1
    v_mfma_f32_16x16x32_bf16 v[72:75], a[116:119], v[136:139], v[72:75]
    s_add_u32 s55, s51, 34816
    v_mfma_f32_16x16x32_bf16 v[80:83], v[160:163], v[156:159], v[80:83]
    v_mfma_f32_16x16x32_bf16 v[84:87], v[156:159], v[164:167], v[84:87]
    s_waitcnt vmcnt(10) lgkmcnt(7)
    ds_read_b128 v[156:159], v10 offset:7168
    ds_read_b128 v[160:163], v4 offset:50176
    v_mfma_f32_16x16x32_bf16 v[16:19], v[88:91], a[48:51], v[16:19]
    buffer_load_dwordx4 a[136:139], v2, s[4:7], s55 offen offset:0 sc1
    s_waitcnt vmcnt(10)
    v_mfma_f32_16x16x32_bf16 v[48:51], v[88:91], a[120:123], v[48:51]
    s_waitcnt lgkmcnt(8)
    ds_read_b128 v[164:167], v5 offset:50176
    ds_read_b128 v[116:119], v3 offset:28672
    v_mfma_f32_16x16x32_bf16 v[20:23], v[92:95], a[48:51], v[20:23]
    ds_read_b128 v[120:123], v3 offset:29696
    v_mfma_f32_16x16x32_bf16 v[52:55], v[92:95], a[120:123], v[52:55]
    s_waitcnt lgkmcnt(9)
    s_add_u32 s92, s68, s71
    ds_read_b128 v[124:127], v3 offset:30720
    v_mfma_f32_16x16x32_bf16 v[24:27], v[96:99], a[48:51], v[24:27]
    buffer_store_dwordx4 v[204:207], v2, s[4:7], s92 offen sc1
    v_mfma_f32_16x16x32_bf16 v[56:59], v[96:99], a[120:123], v[56:59]
    ds_read_b128 v[128:131], v3 offset:31744
    v_mfma_f32_16x16x32_bf16 v[80:83], v[148:151], v[144:147], v[80:83]
    v_mfma_f32_16x16x32_bf16 v[84:87], v[144:147], v[152:155], v[84:87]
    s_waitcnt lgkmcnt(10)
    ds_read_b128 v[140:143], v3 offset:34816
    ds_read_b128 v[144:147], v10 offset:8192
    v_mfma_f32_16x16x32_bf16 v[28:31], v[100:103], a[48:51], v[28:31]
    buffer_load_dwordx4 a[68:71], v2, s[4:7], s54 offen offset:1024 sc1
    v_mfma_f32_16x16x32_bf16 v[60:63], v[100:103], a[120:123], v[60:63]
    s_waitcnt lgkmcnt(11)
    ds_read_b128 v[132:135], v3 offset:32768
    ds_read_b128 v[148:151], v4 offset:57344
    v_mfma_f32_16x16x32_bf16 v[32:35], v[112:115], a[48:51], v[32:35]
    ds_read_b128 v[136:139], v3 offset:33792
    ds_read_b128 v[152:155], v5 offset:57344
    v_mfma_f32_16x16x32_bf16 v[64:67], v[112:115], a[120:123], v[64:67]
    s_waitcnt lgkmcnt(14)
    v_mfma_f32_16x16x32_bf16 v[36:39], a[48:51], v[104:107], v[36:39]
    buffer_load_dwordx4 a[140:143], v2, s[4:7], s55 offen offset:1024 sc1
    v_mfma_f32_16x16x32_bf16 v[68:71], a[120:123], v[104:107], v[68:71]
    s_waitcnt lgkmcnt(13)
    v_mfma_f32_16x16x32_bf16 v[40:43], a[48:51], v[108:111], v[40:43]
    v_mfma_f32_16x16x32_bf16 v[72:75], a[120:123], v[108:111], v[72:75]
    s_waitcnt lgkmcnt(11)
    v_mfma_f32_16x16x32_bf16 v[80:83], v[160:163], v[156:159], v[80:83]
    s_waitcnt lgkmcnt(10)
    v_mfma_f32_16x16x32_bf16 v[84:87], v[156:159], v[164:167], v[84:87]
    s_waitcnt vmcnt(11) lgkmcnt(9)
    v_add_u32 v4, 64512, v4
    v_add_u32 v5, 64512, v5
    v_mfma_f32_16x16x32_bf16 v[16:19], v[116:119], a[52:55], v[16:19]
    buffer_load_dwordx4 a[180:183], v238, s[12:15], 0 offen nt
    s_waitcnt vmcnt(11)
    v_mfma_f32_16x16x32_bf16 v[48:51], v[116:119], a[124:127], v[48:51]
    s_waitcnt lgkmcnt(8)
    ds_read_b128 v[156:159], v10 offset:9216
    ds_read_b128 v[160:163], v4 offset:0
    v_mfma_f32_16x16x32_bf16 v[20:23], v[120:123], a[52:55], v[20:23]
    ds_read_b128 v[164:167], v5 offset:0
    ds_read_b128 v[88:91], v3 offset:35840
    v_mfma_f32_16x16x32_bf16 v[52:55], v[120:123], a[124:127], v[52:55]
    s_waitcnt lgkmcnt(11)
    ds_read_b128 v[92:95], v3 offset:36864
    ds_read_b128 v[96:99], v3 offset:37888
    v_mfma_f32_16x16x32_bf16 v[24:27], v[124:127], a[52:55], v[24:27]
    buffer_load_dwordx4 a[184:187], v239, s[12:15], 0 offen nt
    v_mfma_f32_16x16x32_bf16 v[56:59], v[124:127], a[124:127], v[56:59]
    s_waitcnt lgkmcnt(8)
    ds_read_b128 v[100:103], v3 offset:38912
    v_mfma_f32_16x16x32_bf16 v[80:83], v[148:151], v[144:147], v[80:83]
    s_waitcnt lgkmcnt(7)
    v_mfma_f32_16x16x32_bf16 v[84:87], v[144:147], v[152:155], v[84:87]
    ds_read_b128 v[112:115], v3 offset:41984
    ds_read_b128 v[144:147], v10 offset:10240
    v_mfma_f32_16x16x32_bf16 v[28:31], v[128:131], a[52:55], v[28:31]
    buffer_load_dwordx4 a[188:191], v240, s[12:15], 0 offen nt
    v_mfma_f32_16x16x32_bf16 v[60:63], v[128:131], a[124:127], v[60:63]
    s_add_u32 s92, s92, s70
    ds_read_b128 v[104:107], v3 offset:39936
    v_mfma_f32_16x16x32_bf16 v[32:35], v[140:143], a[52:55], v[32:35]
    ds_read_b128 v[108:111], v3 offset:40960
    ds_read_b128 v[148:151], v4 offset:7168
    v_mfma_f32_16x16x32_bf16 v[64:67], v[140:143], a[124:127], v[64:67]
    ds_read_b128 v[152:155], v5 offset:7168
    v_mfma_f32_16x16x32_bf16 v[36:39], a[52:55], v[132:135], v[36:39]
    buffer_store_dwordx4 v[208:211], v2, s[4:7], s92 offen sc1
    v_mfma_f32_16x16x32_bf16 v[68:71], a[124:127], v[132:135], v[68:71]
    v_mfma_f32_16x16x32_bf16 v[40:43], a[52:55], v[136:139], v[40:43]
    v_mfma_f32_16x16x32_bf16 v[72:75], a[124:127], v[136:139], v[72:75]
    s_waitcnt lgkmcnt(11)
    v_mfma_f32_16x16x32_bf16 v[80:83], v[160:163], v[156:159], v[80:83]
    s_waitcnt lgkmcnt(10)
    v_mfma_f32_16x16x32_bf16 v[84:87], v[156:159], v[164:167], v[84:87]
    s_waitcnt vmcnt(13) lgkmcnt(9)
    ds_read_b128 v[156:159], v10 offset:11264
    ds_read_b128 v[160:163], v4 offset:14336
    v_mfma_f32_16x16x32_bf16 v[16:19], v[88:91], a[56:59], v[16:19]
    buffer_load_dwordx4 a[192:195], v241, s[12:15], 0 offen nt
    s_waitcnt vmcnt(13)
    v_mfma_f32_16x16x32_bf16 v[48:51], v[88:91], a[128:131], v[48:51]
    s_waitcnt lgkmcnt(10)
    ds_read_b128 v[164:167], v5 offset:14336
    ds_read_b128 v[116:119], v3 offset:43008
    v_mfma_f32_16x16x32_bf16 v[20:23], v[92:95], a[56:59], v[20:23]
    ds_read_b128 v[120:123], v3 offset:44032
    v_mfma_f32_16x16x32_bf16 v[52:55], v[92:95], a[128:131], v[52:55]
    s_waitcnt lgkmcnt(12)
    ds_read_b128 v[124:127], v3 offset:45056
    v_mfma_f32_16x16x32_bf16 v[24:27], v[96:99], a[56:59], v[24:27]
    buffer_load_dwordx4 a[196:199], v242, s[12:15], 0 offen nt
    v_mfma_f32_16x16x32_bf16 v[56:59], v[96:99], a[128:131], v[56:59]
    s_waitcnt lgkmcnt(7)
    ds_read_b128 v[128:131], v3 offset:46080
    v_mfma_f32_16x16x32_bf16 v[80:83], v[148:151], v[144:147], v[80:83]
    s_waitcnt lgkmcnt(7)
    v_mfma_f32_16x16x32_bf16 v[84:87], v[144:147], v[152:155], v[84:87]
    ds_read_b128 v[140:143], v3 offset:49152
    ds_read_b128 v[144:147], v10 offset:12288
    v_mfma_f32_16x16x32_bf16 v[28:31], v[100:103], a[56:59], v[28:31]
    buffer_load_dwordx4 a[200:203], v243, s[12:15], 0 offen nt
    v_mfma_f32_16x16x32_bf16 v[60:63], v[100:103], a[128:131], v[60:63]
    ds_read_b128 v[132:135], v3 offset:47104
    ds_read_b128 v[148:151], v4 offset:21504
    v_mfma_f32_16x16x32_bf16 v[32:35], v[112:115], a[56:59], v[32:35]
    ds_read_b128 v[136:139], v3 offset:48128
    ds_read_b128 v[152:155], v5 offset:21504
    v_mfma_f32_16x16x32_bf16 v[64:67], v[112:115], a[128:131], v[64:67]
    v_mfma_f32_16x16x32_bf16 v[36:39], a[56:59], v[104:107], v[36:39]
    buffer_load_dwordx4 a[204:207], v244, s[12:15], 0 offen nt
    v_mfma_f32_16x16x32_bf16 v[68:71], a[128:131], v[104:107], v[68:71]
    v_mfma_f32_16x16x32_bf16 v[40:43], a[56:59], v[108:111], v[40:43]
    v_mfma_f32_16x16x32_bf16 v[72:75], a[128:131], v[108:111], v[72:75]
    s_waitcnt lgkmcnt(11)
    v_mfma_f32_16x16x32_bf16 v[80:83], v[160:163], v[156:159], v[80:83]
    s_waitcnt lgkmcnt(10)
    v_mfma_f32_16x16x32_bf16 v[84:87], v[156:159], v[164:167], v[84:87]
    s_waitcnt vmcnt(14) lgkmcnt(9)
    ds_read_b128 v[156:159], v10 offset:13312
    ds_read_b128 v[160:163], v4 offset:28672
    v_mfma_f32_16x16x32_bf16 v[16:19], v[116:119], a[60:63], v[16:19]
    buffer_store_dwordx4 v[212:215], v2, s[4:7], s69 offen sc1
    s_waitcnt vmcnt(14)
    v_mfma_f32_16x16x32_bf16 v[48:51], v[116:119], a[132:135], v[48:51]
    s_waitcnt lgkmcnt(10)
    ds_read_b128 v[164:167], v5 offset:28672
    ds_read_b128 v[88:91], v3 offset:50176
    v_mfma_f32_16x16x32_bf16 v[20:23], v[120:123], a[60:63], v[20:23]
    ds_read_b128 v[92:95], v3 offset:51200
    v_mfma_f32_16x16x32_bf16 v[52:55], v[120:123], a[132:135], v[52:55]
    s_waitcnt lgkmcnt(12)
    ds_read_b128 v[96:99], v3 offset:52224
    v_mfma_f32_16x16x32_bf16 v[24:27], v[124:127], a[60:63], v[24:27]
    buffer_load_dwordx4 a[208:211], v245, s[12:15], 0 offen nt
    v_mfma_f32_16x16x32_bf16 v[56:59], v[124:127], a[132:135], v[56:59]
    s_waitcnt lgkmcnt(8)
    ds_read_b128 v[100:103], v3 offset:53248
    v_mfma_f32_16x16x32_bf16 v[80:83], v[148:151], v[144:147], v[80:83]
    s_waitcnt lgkmcnt(7)
    v_mfma_f32_16x16x32_bf16 v[84:87], v[144:147], v[152:155], v[84:87]
    ds_read_b128 v[112:115], v3 offset:56320
    ds_read_b128 v[144:147], v10 offset:14336
    v_mfma_f32_16x16x32_bf16 v[28:31], v[128:131], a[60:63], v[28:31]
    buffer_load_dwordx4 a[212:215], v246, s[12:15], 0 offen nt
    v_mfma_f32_16x16x32_bf16 v[60:63], v[128:131], a[132:135], v[60:63]
    ds_read_b128 v[104:107], v3 offset:54272
    ds_read_b128 v[148:151], v4 offset:35840
    v_mfma_f32_16x16x32_bf16 v[32:35], v[140:143], a[60:63], v[32:35]
    ds_read_b128 v[108:111], v3 offset:55296
    ds_read_b128 v[152:155], v5 offset:35840
    v_mfma_f32_16x16x32_bf16 v[64:67], v[140:143], a[132:135], v[64:67]
    v_mfma_f32_16x16x32_bf16 v[36:39], a[60:63], v[132:135], v[36:39]
    buffer_load_dwordx4 a[216:219], v247, s[8:11], 0 offen nt
    v_mfma_f32_16x16x32_bf16 v[68:71], a[132:135], v[132:135], v[68:71]
    v_mfma_f32_16x16x32_bf16 v[40:43], a[60:63], v[136:139], v[40:43]
    v_mfma_f32_16x16x32_bf16 v[72:75], a[132:135], v[136:139], v[72:75]
    s_waitcnt lgkmcnt(11)
    v_mfma_f32_16x16x32_bf16 v[80:83], v[160:163], v[156:159], v[80:83]
    s_waitcnt lgkmcnt(10)
    v_mfma_f32_16x16x32_bf16 v[84:87], v[156:159], v[164:167], v[84:87]
    s_waitcnt vmcnt(16) lgkmcnt(9)
    ds_read_b128 v[156:159], v10 offset:15360
    ds_read_b128 v[160:163], v4 offset:43008
    v_mfma_f32_16x16x32_bf16 v[16:19], v[88:91], a[64:67], v[16:19]
    buffer_load_dwordx4 a[220:223], v248, s[8:11], 0 offen nt
    s_waitcnt vmcnt(16)
    v_mfma_f32_16x16x32_bf16 v[48:51], v[88:91], a[136:139], v[48:51]
    s_waitcnt lgkmcnt(10)
    ds_read_b128 v[164:167], v5 offset:43008
    ds_read_b128 v[116:119], v3 offset:57344
    v_mfma_f32_16x16x32_bf16 v[20:23], v[92:95], a[64:67], v[20:23]
    ds_read_b128 v[120:123], v3 offset:58368
    v_mfma_f32_16x16x32_bf16 v[52:55], v[92:95], a[136:139], v[52:55]
    s_waitcnt lgkmcnt(12)
    ds_read_b128 v[124:127], v3 offset:59392
    v_mfma_f32_16x16x32_bf16 v[24:27], v[96:99], a[64:67], v[24:27]
    buffer_load_dwordx4 a[224:227], v249, s[8:11], 0 offen nt
    v_mfma_f32_16x16x32_bf16 v[56:59], v[96:99], a[136:139], v[56:59]
    s_waitcnt lgkmcnt(8)
    ds_read_b128 v[128:131], v3 offset:60416
    v_mfma_f32_16x16x32_bf16 v[80:83], v[148:151], v[144:147], v[80:83]
    s_waitcnt lgkmcnt(7)
    v_mfma_f32_16x16x32_bf16 v[84:87], v[144:147], v[152:155], v[84:87]
    ds_read_b128 v[140:143], v3 offset:63488
    ds_read_b128 v[144:147], v10 offset:16384
    v_mfma_f32_16x16x32_bf16 v[28:31], v[100:103], a[64:67], v[28:31]
    buffer_load_dwordx4 a[228:231], v250, s[8:11], 0 offen nt
    v_mfma_f32_16x16x32_bf16 v[60:63], v[100:103], a[136:139], v[60:63]
    ds_read_b128 v[132:135], v3 offset:61440
    ds_read_b128 v[148:151], v4 offset:50176
    v_mfma_f32_16x16x32_bf16 v[32:35], v[112:115], a[64:67], v[32:35]
    ds_read_b128 v[136:139], v3 offset:62464
    ds_read_b128 v[152:155], v5 offset:50176
    v_mfma_f32_16x16x32_bf16 v[64:67], v[112:115], a[136:139], v[64:67]
    v_mfma_f32_16x16x32_bf16 v[36:39], a[64:67], v[104:107], v[36:39]
    buffer_load_dwordx4 a[232:235], v251, s[8:11], 0 offen nt
    v_mfma_f32_16x16x32_bf16 v[68:71], a[136:139], v[104:107], v[68:71]
    v_mfma_f32_16x16x32_bf16 v[40:43], a[64:67], v[108:111], v[40:43]
    v_mfma_f32_16x16x32_bf16 v[72:75], a[136:139], v[108:111], v[72:75]
    s_waitcnt lgkmcnt(11)
    v_mfma_f32_16x16x32_bf16 v[80:83], v[160:163], v[156:159], v[80:83]
    s_waitcnt lgkmcnt(10)
    v_mfma_f32_16x16x32_bf16 v[84:87], v[156:159], v[164:167], v[84:87]
    s_waitcnt vmcnt(17) lgkmcnt(9)
    ds_read_b128 v[156:159], v10 offset:17408
    ds_read_b128 v[160:163], v4 offset:57344
    v_mfma_f32_16x16x32_bf16 v[16:19], v[116:119], a[68:71], v[16:19]
    buffer_load_dwordx4 a[236:239], v252, s[8:11], 0 offen nt
    s_waitcnt vmcnt(17)
    v_mfma_f32_16x16x32_bf16 v[48:51], v[116:119], a[140:143], v[48:51]
    s_waitcnt lgkmcnt(10)
    ds_read_b128 v[164:167], v5 offset:57344
    v_mfma_f32_16x16x32_bf16 v[20:23], v[120:123], a[68:71], v[20:23]
    v_mfma_f32_16x16x32_bf16 v[52:55], v[120:123], a[140:143], v[52:55]
    s_waitcnt lgkmcnt(10)
    v_mfma_f32_16x16x32_bf16 v[24:27], v[124:127], a[68:71], v[24:27]
    buffer_load_dwordx4 a[240:243], v253, s[8:11], 0 offen nt
    v_mfma_f32_16x16x32_bf16 v[56:59], v[124:127], a[140:143], v[56:59]
    s_waitcnt lgkmcnt(5)
    v_mfma_f32_16x16x32_bf16 v[80:83], v[148:151], v[144:147], v[80:83]
    s_waitcnt lgkmcnt(3)
    v_mfma_f32_16x16x32_bf16 v[84:87], v[144:147], v[152:155], v[84:87]
    v_mfma_f32_16x16x32_bf16 v[28:31], v[128:131], a[68:71], v[28:31]
    buffer_load_dwordx4 a[244:247], v254, s[8:11], 0 offen nt
    v_mfma_f32_16x16x32_bf16 v[60:63], v[128:131], a[140:143], v[60:63]
    v_mfma_f32_16x16x32_bf16 v[32:35], v[140:143], a[68:71], v[32:35]
    v_mfma_f32_16x16x32_bf16 v[64:67], v[140:143], a[140:143], v[64:67]
    v_mfma_f32_16x16x32_bf16 v[36:39], a[68:71], v[132:135], v[36:39]
    buffer_load_dwordx4 a[248:251], v255, s[8:11], 0 offen nt
    v_mfma_f32_16x16x32_bf16 v[68:71], a[140:143], v[132:135], v[68:71]
    v_mfma_f32_16x16x32_bf16 v[40:43], a[68:71], v[136:139], v[40:43]
    v_mfma_f32_16x16x32_bf16 v[72:75], a[140:143], v[136:139], v[72:75]
    s_waitcnt lgkmcnt(1)
    v_mfma_f32_16x16x32_bf16 v[80:83], v[160:163], v[156:159], v[80:83]
    s_waitcnt lgkmcnt(0)
    v_mfma_f32_16x16x32_bf16 v[84:87], v[156:159], v[164:167], v[84:87]
    v_lshlrev_b32 v6, 3, v1
    v_add_u32 v6, 148608, v6
    s_mul_i32 s52, s20, 3072
    v_add_u32 v7, s52, v6
    s_lshl_b32 s52, s20, 8
    s_add_u32 s52, s52, 161024
    v_lshl_add_u32 v13, v1, 3, s52
    v_lshrrev_b32 v14, 2, v1
    v_lshl_add_u32 v14, v14, 3, s52
    v_cvt_pk_bf16_f32 v100, v56, v57
    v_cvt_pk_bf16_f32 v101, v58, v59
    v_cvt_pk_bf16_f32 v104, v60, v61
    v_cvt_pk_bf16_f32 v105, v62, v63
    v_cvt_pk_bf16_f32 v134, v64, v65
    v_cvt_pk_bf16_f32 v137, v66, v67
    v_mov_b32 v102, 0
    v_mov_b32 v103, 0
    v_cvt_pk_bf16_f32 v110, v68, v69
    v_cvt_pk_bf16_f32 v111, v70, v71
    v_cvt_pk_bf16_f32 v116, v72, v73
    v_cvt_pk_bf16_f32 v117, v74, v75
    s_mov_b32 exec_lo, 0xffff0000
    s_mov_b32 exec_hi, 0
    ds_write2_b32 v13, v134, v137 offset0:64 offset1:65
    s_mov_b64 exec, -1
    v_permlane32_swap_b32 v134, v102
    v_permlane32_swap_b32 v137, v103
    s_cmp_eq_u32 s20, 3
    s_cbranch_scc1 L_w3_46
    ds_write_b64 v7, v[100:101] offset:3072
    ds_write_b64 v7, v[102:103] offset:3584
    ds_write_b64 v7, v[104:105] offset:4096
    ds_write_b64 v7, v[110:111] offset:4608
    ds_write_b64 v7, v[116:117] offset:5120
L_w3_46:
    v_cvt_pk_bf16_f32 v140, v80, v81
    v_cvt_pk_bf16_f32 v141, v82, v83
    v_cvt_pk_bf16_f32 v142, v84, v85
    v_cvt_pk_bf16_f32 v143, v86, v87
    s_min_u32 s52, s20, 2
    s_lshl_b32 s53, s52, 1
    s_cmp_ge_u32 s20, 2
    s_cselect_b32 s53, 1, s53
    s_lshl_b32 s53, s53, 9
    s_and_b32 s52, s20, 1
    s_add_u32 s52, s52, 3
    s_lshl_b32 s52, s52, 9
    v_add_u32 v8, s53, v6
    v_add_u32 v9, s52, v6
    s_cmp_lt_u32 s20, 2
    s_cbranch_scc1 L_noswap_47
    v_lshlrev_b32 v10, 3, v1
    v_add_u32 v10, 161024, v10
    s_mov_b32 exec_lo, 0xffff0000
    s_mov_b32 exec_hi, 0
    ds_write_b64 v10, v[140:141]
    s_mov_b64 exec, -1
    v_mov_b32 v10, 0
    v_mov_b32 v11, 0
    s_nop 1
    v_permlane32_swap_b32 v140, v10
    v_permlane32_swap_b32 v141, v11
    v_mov_b32 v140, v10
    v_mov_b32 v141, v11
L_noswap_47:
    ds_write_b64 v8, v[140:141]
    ds_write_b64 v9, v[142:143]
    v_cvt_pk_bf16_f32 v132, v48, v49
    v_cvt_pk_bf16_f32 v133, v50, v51
    v_cvt_pk_bf16_f32 v138, v52, v53
    v_cvt_pk_bf16_f32 v139, v54, v55
    v_mov_b32 v135, 0
    v_mov_b32 v136, 0
    v_cvt_pk_bf16_f32 v94, v24, v25
    v_cvt_pk_bf16_f32 v95, v26, v27
    v_cvt_pk_bf16_f32 v98, v28, v29
    v_cvt_pk_bf16_f32 v99, v30, v31
    v_cvt_pk_bf16_f32 v126, v32, v33
    v_cvt_pk_bf16_f32 v129, v34, v35
    v_mov_b32 v96, 0
    v_mov_b32 v97, 0
    v_cvt_pk_bf16_f32 v108, v36, v37
    v_cvt_pk_bf16_f32 v109, v38, v39
    v_cvt_pk_bf16_f32 v114, v40, v41
    v_cvt_pk_bf16_f32 v115, v42, v43
    s_mov_b32 exec_lo, 0xffff0000
    s_mov_b32 exec_hi, 0
    ds_write2_b32 v13, v126, v129 offset0:32 offset1:33
    s_mov_b64 exec, -1
    v_permlane32_swap_b32 v126, v96
    v_permlane32_swap_b32 v129, v97
    v_cvt_pk_bf16_f32 v124, v16, v17
    v_cvt_pk_bf16_f32 v125, v18, v19
    v_cvt_pk_bf16_f32 v130, v20, v21
    v_cvt_pk_bf16_f32 v131, v22, v23
    v_mov_b32 v127, 0
    v_mov_b32 v128, 0
    v_mov_b32 v144, 0x3f803f80
    v_mov_b32 v145, 0x3f803f80
    v_mov_b32 v146, 0x3f803f80
    v_mov_b32 v147, 0x3f803f80
    v_mfma_f32_16x16x32_bf16 v[32:35], v[94:97], v[132:135], v[172:175]
    v_mfma_f32_16x16x32_bf16 v[36:39], v[100:103], v[132:135], v[168:171]
    v_mfma_f32_16x16x32_bf16 v[20:23], v[94:97], v[124:127], v[168:171]
    v_mfma_f32_16x16x32_bf16 v[40:43], v[96:99], v[136:139], v[172:175]
    v_mfma_f32_16x16x32_bf16 v[44:47], v[102:105], v[136:139], v[168:171]
    v_mfma_f32_16x16x32_bf16 v[28:31], v[96:99], v[128:131], v[168:171]
    s_waitcnt lgkmcnt(0)
    s_barrier
    ds_read_b64 v[88:89], v7 offset:0
    ds_read_b64 v[90:91], v7 offset:512
    ds_read_b64 v[92:93], v7 offset:1024
    ds_read_b64 v[106:107], v7 offset:1536
    ds_read_b64 v[112:113], v7 offset:2048
    ds_read_b64_tr_b16 v[118:119], v14 offset:128
    ds_read_b64_tr_b16 v[120:121], v14 offset:256
    ds_read_b64_tr_b16 v[122:123], v14 offset:384
    s_mov_b32 s52, 0x3eae1a93
    s_waitcnt lgkmcnt(6)
    v_mfma_f32_16x16x32_bf16 v[16:19], v[88:91], v[124:127], v[176:179]
    s_waitcnt lgkmcnt(5)
    v_mfma_f32_16x16x32_bf16 v[24:27], v[90:93], v[128:131], v[176:179]
    v_max3_f32 v48, v32, v33, v34
    v_max3_f32 v49, v40, v41, v42
    s_nop 3
    v_max3_f32 v50, v16, v17, v18
    s_nop 0
    v_max3_f32 v51, v24, v25, v26
    v_max3_f32 v48, v48, v35, v36
    v_max3_f32 v49, v49, v43, v44
    v_max3_f32 v50, v50, v19, v20
    v_max3_f32 v51, v51, v27, v28
    v_max3_f32 v48, v48, v37, v38
    v_max3_f32 v49, v49, v45, v46
    v_max3_f32 v50, v50, v21, v22
    v_max3_f32 v51, v51, v29, v30
    v_max_f32 v48, v48, v39
    v_max_f32 v49, v49, v47
    v_max_f32 v50, v50, v23
    v_max_f32 v51, v51, v31
    v_mov_b32 v52, v48
    v_mov_b32 v53, v49
    v_mov_b32 v54, v50
    v_mov_b32 v55, v51
    v_permlane16_swap_b32 v48, v52
    v_permlane16_swap_b32 v49, v53
    v_permlane16_swap_b32 v50, v54
    v_permlane16_swap_b32 v51, v55
    v_max_f32 v48, v48, v52
    v_max_f32 v49, v49, v53
    v_max_f32 v50, v50, v54
    v_max_f32 v51, v51, v55
    v_mov_b32 v52, v48
    v_mov_b32 v53, v49
    v_mov_b32 v54, v50
    v_mov_b32 v55, v51
    v_permlane32_swap_b32 v48, v52
    v_permlane32_swap_b32 v49, v53
    v_permlane32_swap_b32 v50, v54
    v_permlane32_swap_b32 v51, v55
    v_max_f32 v48, v48, v52
    v_max_f32 v49, v49, v53
    v_max_f32 v50, v50, v54
    v_max_f32 v51, v51, v55
    v_mul_f32 v48, s52, v48
    v_mul_f32 v49, s52, v49
    v_mul_f32 v50, s52, v50
    v_mul_f32 v51, s52, v51
    v_fma_f32 v32, v32, s52, -v48
    v_fma_f32 v40, v40, s52, -v49
    v_fma_f32 v16, v16, s52, -v50
    v_fma_f32 v24, v24, s52, -v51
    v_fma_f32 v33, v33, s52, -v48
    v_fma_f32 v41, v41, s52, -v49
    v_fma_f32 v17, v17, s52, -v50
    v_fma_f32 v25, v25, s52, -v51
    v_fma_f32 v34, v34, s52, -v48
    v_fma_f32 v42, v42, s52, -v49
    v_fma_f32 v18, v18, s52, -v50
    v_fma_f32 v26, v26, s52, -v51
    v_fma_f32 v35, v35, s52, -v48
    v_fma_f32 v43, v43, s52, -v49
    v_fma_f32 v19, v19, s52, -v50
    v_fma_f32 v27, v27, s52, -v51
    v_fma_f32 v36, v36, s52, -v48
    v_fma_f32 v44, v44, s52, -v49
    v_fma_f32 v20, v20, s52, -v50
    v_fma_f32 v28, v28, s52, -v51
    v_fma_f32 v37, v37, s52, -v48
    v_fma_f32 v45, v45, s52, -v49
    v_fma_f32 v21, v21, s52, -v50
    v_fma_f32 v29, v29, s52, -v51
    v_fma_f32 v38, v38, s52, -v48
    v_fma_f32 v46, v46, s52, -v49
    v_fma_f32 v22, v22, s52, -v50
    v_fma_f32 v30, v30, s52, -v51
    v_fma_f32 v39, v39, s52, -v48
    v_fma_f32 v47, v47, s52, -v49
    v_fma_f32 v23, v23, s52, -v50
    v_fma_f32 v31, v31, s52, -v51
    v_exp_f32 v32, v32
    v_exp_f32 v40, v40
    v_exp_f32 v16, v16
    v_exp_f32 v24, v24
    v_exp_f32 v33, v33
    v_exp_f32 v41, v41
    v_exp_f32 v17, v17
    v_exp_f32 v25, v25
    v_exp_f32 v34, v34
    v_exp_f32 v42, v42
    v_exp_f32 v18, v18
    v_exp_f32 v26, v26
    v_exp_f32 v35, v35
    v_exp_f32 v43, v43
    v_exp_f32 v19, v19
    v_exp_f32 v27, v27
    v_exp_f32 v36, v36
    v_exp_f32 v44, v44
    v_exp_f32 v20, v20
    v_exp_f32 v28, v28
    v_exp_f32 v37, v37
    v_exp_f32 v45, v45
    v_exp_f32 v21, v21
    v_exp_f32 v29, v29
    v_exp_f32 v38, v38
    v_exp_f32 v46, v46
    v_exp_f32 v22, v22
    v_exp_f32 v30, v30
    v_exp_f32 v39, v39
    v_exp_f32 v47, v47
    v_exp_f32 v23, v23
    v_exp_f32 v31, v31
    v_cvt_pk_bf16_f32 v56, v32, v33
    v_cvt_pk_bf16_f32 v60, v40, v41
    v_cvt_pk_bf16_f32 v64, v16, v17
    v_cvt_pk_bf16_f32 v68, v24, v25
    v_cvt_pk_bf16_f32 v57, v34, v35
    v_cvt_pk_bf16_f32 v61, v42, v43
    v_cvt_pk_bf16_f32 v65, v18, v19
    v_cvt_pk_bf16_f32 v69, v26, v27
    v_cvt_pk_bf16_f32 v58, v36, v37
    v_cvt_pk_bf16_f32 v62, v44, v45
    v_cvt_pk_bf16_f32 v66, v20, v21
    v_cvt_pk_bf16_f32 v70, v28, v29
    v_cvt_pk_bf16_f32 v59, v38, v39
    v_cvt_pk_bf16_f32 v63, v46, v47
    v_cvt_pk_bf16_f32 v67, v22, v23
    v_cvt_pk_bf16_f32 v71, v30, v31
    v_mfma_f32_16x16x32_bf16 v[188:191], v[144:147], v[56:59], 0
    v_mfma_f32_16x16x32_bf16 v[180:183], v[108:111], v[56:59], 0
    s_waitcnt lgkmcnt(0)
    v_mfma_f32_16x16x32_bf16 v[184:187], v[120:123], v[56:59], 0
    v_mfma_f32_16x16x32_bf16 v[200:203], v[144:147], v[60:63], 0
    v_mfma_f32_16x16x32_bf16 v[192:195], v[114:117], v[60:63], 0
    v_mfma_f32_16x16x32_bf16 v[196:199], v[120:123], v[60:63], 0
    v_mfma_f32_16x16x32_bf16 v[212:215], v[144:147], v[64:67], 0
    v_mfma_f32_16x16x32_bf16 v[204:207], v[106:109], v[64:67], 0
    v_mfma_f32_16x16x32_bf16 v[208:211], v[118:121], v[64:67], 0
    v_mfma_f32_16x16x32_bf16 v[224:227], v[144:147], v[68:71], 0
    v_mfma_f32_16x16x32_bf16 v[216:219], v[112:115], v[68:71], 0
    v_mfma_f32_16x16x32_bf16 v[220:223], v[118:121], v[68:71], 0
    s_lshl_b32 s53, s46, 4
    s_add_u32 s53, s53, s45
    s_lshl_b32 s54, s53, 10
    s_add_u32 s54, s54, 23330816
    s_lshl_b32 s55, s53, 7
    s_add_u32 s55, s55, 25427840
    v_lshlrev_b32 v6, 3, v1
    v_rcp_f32 v188, v188
    v_rcp_f32 v200, v200
    v_rcp_f32 v212, v212
    v_rcp_f32 v224, v224
    v_mul_f32 v180, v180, v188
    v_mul_f32 v181, v181, v188
    v_mul_f32 v182, v182, v188
    v_mul_f32 v183, v183, v188
    v_mul_f32 v184, v184, v188
    v_mul_f32 v185, v185, v188
    v_cvt_pk_bf16_f32 v76, v180, v181
    v_cvt_pk_bf16_f32 v77, v182, v183
    v_cvt_pk_bf16_f32 v82, v184, v185
    v_mul_f32 v192, v192, v200
    v_mul_f32 v193, v193, v200
    v_mul_f32 v194, v194, v200
    v_mul_f32 v195, v195, v200
    v_mul_f32 v198, v198, v200
    v_mul_f32 v199, v199, v200
    v_cvt_pk_bf16_f32 v78, v192, v193
    v_cvt_pk_bf16_f32 v79, v194, v195
    v_cvt_pk_bf16_f32 v83, v198, v199
    s_add_u32 s53, s54, 16384
    buffer_store_dwordx4 v[76:79], v2, s[4:7], s53 offen sc1
    v_mul_f32 v204, v204, v212
    v_mul_f32 v205, v205, v212
    v_mul_f32 v206, v206, v212
    v_mul_f32 v207, v207, v212
    v_mul_f32 v208, v208, v212
    v_mul_f32 v209, v209, v212
    v_cvt_pk_bf16_f32 v72, v204, v205
    v_cvt_pk_bf16_f32 v73, v206, v207
    v_cvt_pk_bf16_f32 v80, v208, v209
    v_mul_f32 v216, v216, v224
    v_mul_f32 v217, v217, v224
    v_mul_f32 v218, v218, v224
    v_mul_f32 v219, v219, v224
    v_mul_f32 v222, v222, v224
    v_mul_f32 v223, v223, v224
    v_cvt_pk_bf16_f32 v74, v216, v217
    v_cvt_pk_bf16_f32 v75, v218, v219
    v_cvt_pk_bf16_f32 v81, v222, v223
    s_add_u32 s53, s54, 0
    buffer_store_dwordx4 v[72:75], v2, s[4:7], s53 offen sc1
    s_mov_b32 exec_lo, 0xffff0000
    s_mov_b32 exec_hi, 0
    buffer_store_dwordx2 v[80:81], v6, s[4:7], s55 offen offset:0 sc1
    buffer_store_dwordx2 v[82:83], v6, s[4:7], s55 offen offset:2048 sc1
    s_mov_b64 exec, -1
    s_lshl_b32 s52, s44, 2
    s_add_u32 s52, s52, s20
    s_lshl_b32 s52, s52, 4
    s_add_u32 s52, s52, s45
    s_lshl_b32 s52, s52, 3
    s_add_u32 s52, s52, 3948544
    s_mul_i32 s53, s22, 10923
    s_lshr_b32 s53, s53, 16
    s_mul_i32 s53, s53, 6
    s_sub_u32 s53, s22, s53
    s_lshl_b32 s53, s53, 8
    s_add_u32 s23, s53, 4067328
    v_min_u32 v13, 17, v1
    v_lshlrev_b32 v13, 3, v13
    buffer_load_dwordx2 v[14:15], v13, s[4:7], s23 offen sc1
    v_mov_b32 v8, s98
    v_mov_b32 v9, s99
    s_waitcnt vmcnt(1)
    s_mov_b64 exec, 1
    buffer_store_dwordx2 v[8:9], off, s[4:7], s52 sc1
    s_mov_b64 exec, -1
    s_mov_b64 exec, 1
    buffer_store_dwordx2 v[8:9], off, s[4:7], s0 sc1
    s_mov_b64 exec, -1
    s_cmp_ge_u32 s22, 24
    s_cbranch_scc1 L_idle0_48
    s_mul_i32 s44, s22, 10923
    s_lshr_b32 s44, s44, 16
    s_mul_i32 s52, s44, 6
    s_sub_u32 s45, s22, s52
    s_lshl_b32 s52, s21, 2
    s_add_u32 s44, s44, s52
    s_lshl_b32 s46, s44, 2
    s_add_u32 s46, s46, s20
    s_mul_i32 s47, s45, 110592
    s_mul_i32 s48, s20, 3072
    s_add_u32 s47, s47, s48
    s_add_u32 s47, s47, 2097152
    s_lshl_b32 s49, s46, 14
    s_add_u32 s49, s49, 23330816
    s_lshl_b32 s50, s46, 11
    s_add_u32 s50, s50, 25427968
    v_and_b32 v3, 15, v1
    v_lshrrev_b32 v4, 4, v1
    v_lshlrev_b32 v5, 3, v3
    v_lshl_add_u32 v5, v4, 8, v5
    s_lshl_b32 s52, s46, 4
    v_add_u32 v6, s52, v3
    v_lshlrev_b32 v7, 3, v6
    v_mul_u32_u24 v6, 1152, v6
    v_lshl_add_u32 v6, v4, 4, v6
    s_mul_i32 s51, s45, 192
    s_mov_b32 s8, s24
    s_mov_b32 s9, s25
    s_mov_b32 s10, 0x240000
    s_mov_b32 s11, 0x20000
    s_waitcnt vmcnt(2)
    v_cmp_eq_u64 vcc, s[98:99], v[14:15]
    s_nop 0
    s_cmp_eq_u64 vcc, exec
    s_cbranch_scc0 L_pwo_slow_40
L_pwo_back_41:
    s_mov_b32 m0, s48
    s_nop 0
    buffer_load_dwordx4 v2, s[4:7], s47 offen offset:0 lds
    buffer_load_dwordx4 v2, s[4:7], s47 offen offset:1024 lds
    buffer_load_dwordx4 v2, s[4:7], s47 offen offset:2048 lds
    s_add_u32 s48, s48, 12288
    s_add_u32 s47, s47, 12288
    s_mov_b32 m0, s48
    s_nop 0
    buffer_load_dwordx4 v2, s[4:7], s47 offen offset:0 lds
    buffer_load_dwordx4 v2, s[4:7], s47 offen offset:1024 lds
    buffer_load_dwordx4 v2, s[4:7], s47 offen offset:2048 lds
    s_add_u32 s48, s48, 12288
    s_add_u32 s47, s47, 12288
    s_mov_b32 m0, s48
    s_nop 0
    buffer_load_dwordx4 v2, s[4:7], s47 offen offset:0 lds
    buffer_load_dwordx4 v2, s[4:7], s47 offen offset:1024 lds
    buffer_load_dwordx4 v2, s[4:7], s47 offen offset:2048 lds
    s_add_u32 s48, s48, 12288
    s_add_u32 s47, s47, 12288
    s_mov_b32 m0, s48
    s_nop 0
    buffer_load_dwordx4 v2, s[4:7], s47 offen offset:0 lds
    buffer_load_dwordx4 v2, s[4:7], s47 offen offset:1024 lds
    buffer_load_dwordx4 v2, s[4:7], s47 offen offset:2048 lds
    s_add_u32 s48, s48, 12288
    s_add_u32 s47, s47, 12288
    s_mov_b32 m0, s48
    s_nop 0
    buffer_load_dwordx4 v2, s[4:7], s47 offen offset:0 lds
    buffer_load_dwordx4 v2, s[4:7], s47 offen offset:1024 lds
    buffer_load_dwordx4 v2, s[4:7], s47 offen offset:2048 lds
    s_add_u32 s48, s48, 12288
    s_add_u32 s47, s47, 12288
    s_mov_b32 m0, s48
    s_nop 0
    buffer_load_dwordx4 v2, s[4:7], s47 offen offset:0 lds
    buffer_load_dwordx4 v2, s[4:7], s47 offen offset:1024 lds
    buffer_load_dwordx4 v2, s[4:7], s47 offen offset:2048 lds
    s_add_u32 s48, s48, 12288
    s_add_u32 s47, s47, 12288
    s_mov_b32 m0, s48
    s_nop 0
    buffer_load_dwordx4 v2, s[4:7], s47 offen offset:0 lds
    buffer_load_dwordx4 v2, s[4:7], s47 offen offset:1024 lds
    buffer_load_dwordx4 v2, s[4:7], s47 offen offset:2048 lds
    s_add_u32 s48, s48, 12288
    s_add_u32 s47, s47, 12288
    s_mov_b32 m0, s48
    s_nop 0
    buffer_load_dwordx4 v2, s[4:7], s47 offen offset:0 lds
    buffer_load_dwordx4 v2, s[4:7], s47 offen offset:1024 lds
    buffer_load_dwordx4 v2, s[4:7], s47 offen offset:2048 lds
    s_add_u32 s48, s48, 12288
    s_add_u32 s47, s47, 12288
    s_mov_b32 m0, s48
    s_nop 0
    buffer_load_dwordx4 v2, s[4:7], s47 offen offset:0 lds
    buffer_load_dwordx4 v2, s[4:7], s47 offen offset:1024 lds
    buffer_load_dwordx4 v2, s[4:7], s47 offen offset:2048 lds
    s_add_u32 s48, s48, 12288
    s_add_u32 s47, s47, 12288
    s_lshr_b32 s52, s46, 1
    s_lshl_b32 s52, s52, 7
    s_add_u32 s52, s52, 3948544
    v_and_b32 v10, 15, v1
    v_lshlrev_b32 v10, 3, v10
    s_mul_i32 s53, s45, 2816
    s_min_u32 s53, s53, 13568
    s_add_u32 s53, s53, s49
    buffer_load_dwordx4 v[160:163], v6, s[8:11], s51 offen offset:0
    buffer_load_dwordx4 v[164:167], v6, s[8:11], s51 offen offset:64
    buffer_load_dwordx4 v[168:171], v6, s[8:11], s51 offen offset:128
    v_mov_b32 v8, v2
    s_waitcnt vmcnt(3)
    s_barrier
    buffer_load_dwordx2 v[12:13], v10, s[4:7], s52 offen sc1
    ds_read_b128 a[0:3], v8 offset:0
    ds_read_b128 a[4:7], v8 offset:1024
    ds_read_b128 a[8:11], v8 offset:2048
    ds_read_b128 a[12:15], v8 offset:3072
    ds_read_b128 a[16:19], v8 offset:4096
    ds_read_b128 a[20:23], v8 offset:5120
    ds_read_b128 a[24:27], v8 offset:6144
    ds_read_b128 a[28:31], v8 offset:7168
    ds_read_b128 a[32:35], v8 offset:8192
    ds_read_b128 a[36:39], v8 offset:9216
    ds_read_b128 a[40:43], v8 offset:10240
    ds_read_b128 a[44:47], v8 offset:11264
    ds_read_b128 a[48:51], v8 offset:12288
    ds_read_b128 a[52:55], v8 offset:13312
    ds_read_b128 a[56:59], v8 offset:14336
    ds_read_b128 a[60:63], v8 offset:15360
    ds_read_b128 a[64:67], v8 offset:16384
    ds_read_b128 a[68:71], v8 offset:17408
    ds_read_b128 a[72:75], v8 offset:18432
    ds_read_b128 a[76:79], v8 offset:19456
    ds_read_b128 a[80:83], v8 offset:20480
    ds_read_b128 a[84:87], v8 offset:21504
    ds_read_b128 a[88:91], v8 offset:22528
    ds_read_b128 a[92:95], v8 offset:23552
    ds_read_b128 v[112:115], v8 offset:24576
    ds_read_b128 v[116:119], v8 offset:25600
    ds_read_b128 v[120:123], v8 offset:26624
    ds_read_b128 v[124:127], v8 offset:27648
    ds_read_b128 v[128:131], v8 offset:28672
    ds_read_b128 v[132:135], v8 offset:29696
    ds_read_b128 v[136:139], v8 offset:30720
    ds_read_b128 v[140:143], v8 offset:31744
    ds_read_b128 v[144:147], v8 offset:32768
    ds_read_b128 v[148:151], v8 offset:33792
    s_waitcnt vmcnt(0)
    v_cmp_eq_u64 vcc, s[98:99], v[12:13]
    s_nop 0
    s_cmp_eq_u64 vcc, exec
    s_cbranch_scc0 L_po_slow_55
L_po_back_56:
    buffer_load_dwordx4 v[16:19], v2, s[4:7], s49 offen offset:0 sc1
    buffer_load_dwordx4 v[20:23], v2, s[4:7], s49 offen offset:1024 sc1
    buffer_load_dwordx4 v[24:27], v2, s[4:7], s49 offen offset:2048 sc1
    buffer_load_dwordx4 v[28:31], v2, s[4:7], s49 offen offset:3072 sc1
    s_add_u32 s49, s49, 4096
    buffer_load_dwordx4 v[32:35], v2, s[4:7], s49 offen offset:0 sc1
    buffer_load_dwordx4 v[36:39], v2, s[4:7], s49 offen offset:1024 sc1
    buffer_load_dwordx4 v[40:43], v2, s[4:7], s49 offen offset:2048 sc1
    buffer_load_dwordx4 v[44:47], v2, s[4:7], s49 offen offset:3072 sc1
    s_waitcnt vmcnt(7) lgkmcnt(15)
    s_add_u32 s49, s49, 4096
    v_mfma_f32_16x16x32_bf16 v[88:91], a[0:3], v[16:19], 0
    buffer_load_dwordx4 v[48:51], v2, s[4:7], s49 offen offset:0 sc1
    s_waitcnt lgkmcnt(15)
    v_mfma_f32_16x16x32_bf16 v[92:95], a[4:7], v[16:19], 0
    s_waitcnt lgkmcnt(15)
    v_mfma_f32_16x16x32_bf16 v[96:99], a[8:11], v[16:19], 0
    s_waitcnt lgkmcnt(15)
    v_mfma_f32_16x16x32_bf16 v[100:103], a[12:15], v[16:19], 0
    buffer_load_dwordx4 v[52:55], v2, s[4:7], s49 offen offset:1024 sc1
    s_waitcnt lgkmcnt(15)
    v_mfma_f32_16x16x32_bf16 v[104:107], a[16:19], v[16:19], 0
    s_waitcnt lgkmcnt(15)
    v_mfma_f32_16x16x32_bf16 v[108:111], a[20:23], v[16:19], 0
    s_waitcnt vmcnt(8) lgkmcnt(15)
    v_mfma_f32_16x16x32_bf16 v[88:91], a[24:27], v[20:23], v[88:91]
    buffer_load_dwordx4 v[56:59], v2, s[4:7], s49 offen offset:2048 sc1
    s_waitcnt lgkmcnt(15)
    v_mfma_f32_16x16x32_bf16 v[92:95], a[28:31], v[20:23], v[92:95]
    s_waitcnt lgkmcnt(15)
    v_mfma_f32_16x16x32_bf16 v[96:99], a[32:35], v[20:23], v[96:99]
    s_waitcnt lgkmcnt(15)
    v_mfma_f32_16x16x32_bf16 v[100:103], a[36:39], v[20:23], v[100:103]
    buffer_load_dwordx4 v[60:63], v2, s[4:7], s49 offen offset:3072 sc1
    s_waitcnt lgkmcnt(15)
    v_mfma_f32_16x16x32_bf16 v[104:107], a[40:43], v[20:23], v[104:107]
    s_waitcnt lgkmcnt(15)
    s_add_u32 s49, s49, 4096
    v_mfma_f32_16x16x32_bf16 v[108:111], a[44:47], v[20:23], v[108:111]
    s_waitcnt vmcnt(9) lgkmcnt(15)
    v_mfma_f32_16x16x32_bf16 v[88:91], a[48:51], v[24:27], v[88:91]
    buffer_load_dwordx4 v[64:67], v2, s[4:7], s49 offen offset:0 sc1
    s_waitcnt lgkmcnt(15)
    v_mfma_f32_16x16x32_bf16 v[92:95], a[52:55], v[24:27], v[92:95]
    s_waitcnt lgkmcnt(15)
    v_mfma_f32_16x16x32_bf16 v[96:99], a[56:59], v[24:27], v[96:99]
    s_waitcnt lgkmcnt(15)
    v_mfma_f32_16x16x32_bf16 v[100:103], a[60:63], v[24:27], v[100:103]
    buffer_load_dwordx4 v[68:71], v2, s[4:7], s49 offen offset:1024 sc1
    s_waitcnt lgkmcnt(15)
    v_mfma_f32_16x16x32_bf16 v[104:107], a[64:67], v[24:27], v[104:107]
    s_waitcnt lgkmcnt(15)
    v_mfma_f32_16x16x32_bf16 v[108:111], a[68:71], v[24:27], v[108:111]
    s_waitcnt vmcnt(10) lgkmcnt(15)
    v_mfma_f32_16x16x32_bf16 v[88:91], a[72:75], v[28:31], v[88:91]
    buffer_load_dwordx4 v[72:75], v2, s[4:7], s49 offen offset:2048 sc1
    s_waitcnt lgkmcnt(14)
    v_mfma_f32_16x16x32_bf16 v[92:95], a[76:79], v[28:31], v[92:95]
    s_waitcnt lgkmcnt(13)
    v_mfma_f32_16x16x32_bf16 v[96:99], a[80:83], v[28:31], v[96:99]
    s_waitcnt lgkmcnt(12)
    v_mfma_f32_16x16x32_bf16 v[100:103], a[84:87], v[28:31], v[100:103]
    buffer_load_dwordx4 v[76:79], v2, s[4:7], s49 offen offset:3072 sc1
    s_waitcnt lgkmcnt(11)
    v_mfma_f32_16x16x32_bf16 v[104:107], a[88:91], v[28:31], v[104:107]
    s_waitcnt lgkmcnt(10)
    v_mfma_f32_16x16x32_bf16 v[108:111], a[92:95], v[28:31], v[108:111]
    s_waitcnt vmcnt(11) lgkmcnt(9)
    v_mfma_f32_16x16x32_bf16 v[88:91], v[112:115], v[32:35], v[88:91]
    s_waitcnt lgkmcnt(8)
    ds_read_b128 v[152:155], v8 offset:34816
    v_mfma_f32_16x16x32_bf16 v[92:95], v[116:119], v[32:35], v[92:95]
    s_waitcnt lgkmcnt(8)
    ds_read_b128 v[156:159], v8 offset:35840
    v_mfma_f32_16x16x32_bf16 v[96:99], v[120:123], v[32:35], v[96:99]
    s_waitcnt lgkmcnt(8)
    ds_read_b128 v[112:115], v8 offset:36864
    v_mfma_f32_16x16x32_bf16 v[100:103], v[124:127], v[32:35], v[100:103]
    s_waitcnt lgkmcnt(8)
    ds_read_b128 v[116:119], v8 offset:37888
    v_mfma_f32_16x16x32_bf16 v[104:107], v[128:131], v[32:35], v[104:107]
    s_waitcnt lgkmcnt(8)
    ds_read_b128 v[120:123], v8 offset:38912
    v_mfma_f32_16x16x32_bf16 v[108:111], v[132:135], v[32:35], v[108:111]
    s_waitcnt vmcnt(10) lgkmcnt(8)
    ds_read_b128 v[124:127], v8 offset:39936
    v_mfma_f32_16x16x32_bf16 v[88:91], v[136:139], v[36:39], v[88:91]
    s_waitcnt lgkmcnt(8)
    ds_read_b128 v[128:131], v8 offset:40960
    v_mfma_f32_16x16x32_bf16 v[92:95], v[140:143], v[36:39], v[92:95]
    s_waitcnt lgkmcnt(8)
    ds_read_b128 v[132:135], v8 offset:41984
    v_mfma_f32_16x16x32_bf16 v[96:99], v[144:147], v[36:39], v[96:99]
    s_waitcnt lgkmcnt(8)
    ds_read_b128 v[136:139], v8 offset:43008
    v_mfma_f32_16x16x32_bf16 v[100:103], v[148:151], v[36:39], v[100:103]
    s_waitcnt lgkmcnt(8)
    ds_read_b128 v[140:143], v8 offset:44032
    v_mfma_f32_16x16x32_bf16 v[104:107], v[152:155], v[36:39], v[104:107]
    s_waitcnt lgkmcnt(8)
    ds_read_b128 v[144:147], v8 offset:45056
    v_mfma_f32_16x16x32_bf16 v[108:111], v[156:159], v[36:39], v[108:111]
    s_waitcnt vmcnt(9) lgkmcnt(8)
    ds_read_b128 v[148:151], v8 offset:46080
    v_mfma_f32_16x16x32_bf16 v[88:91], v[112:115], v[40:43], v[88:91]
    s_waitcnt lgkmcnt(8)
    ds_read_b128 v[152:155], v8 offset:47104
    v_mfma_f32_16x16x32_bf16 v[92:95], v[116:119], v[40:43], v[92:95]
    s_waitcnt lgkmcnt(8)
    ds_read_b128 v[156:159], v8 offset:48128
    v_mfma_f32_16x16x32_bf16 v[96:99], v[120:123], v[40:43], v[96:99]
    s_waitcnt lgkmcnt(8)
    ds_read_b128 v[112:115], v8 offset:49152
    v_mfma_f32_16x16x32_bf16 v[100:103], v[124:127], v[40:43], v[100:103]
    s_waitcnt lgkmcnt(8)
    ds_read_b128 v[116:119], v8 offset:50176
    v_mfma_f32_16x16x32_bf16 v[104:107], v[128:131], v[40:43], v[104:107]
    s_waitcnt lgkmcnt(8)
    ds_read_b128 v[120:123], v8 offset:51200
    v_mfma_f32_16x16x32_bf16 v[108:111], v[132:135], v[40:43], v[108:111]
    s_waitcnt vmcnt(8) lgkmcnt(8)
    ds_read_b128 v[124:127], v8 offset:52224
    v_mfma_f32_16x16x32_bf16 v[88:91], v[136:139], v[44:47], v[88:91]
    s_waitcnt lgkmcnt(8)
    ds_read_b128 v[128:131], v8 offset:53248
    v_mfma_f32_16x16x32_bf16 v[92:95], v[140:143], v[44:47], v[92:95]
    s_waitcnt lgkmcnt(8)
    ds_read_b128 v[132:135], v8 offset:54272
    v_mfma_f32_16x16x32_bf16 v[96:99], v[144:147], v[44:47], v[96:99]
    s_waitcnt lgkmcnt(8)
    ds_read_b128 v[136:139], v8 offset:55296
    v_mfma_f32_16x16x32_bf16 v[100:103], v[148:151], v[44:47], v[100:103]
    s_waitcnt lgkmcnt(8)
    ds_read_b128 v[140:143], v8 offset:56320
    v_mfma_f32_16x16x32_bf16 v[104:107], v[152:155], v[44:47], v[104:107]
    s_waitcnt lgkmcnt(8)
    ds_read_b128 v[144:147], v8 offset:57344
    v_mfma_f32_16x16x32_bf16 v[108:111], v[156:159], v[44:47], v[108:111]
    s_waitcnt vmcnt(7) lgkmcnt(8)
    ds_read_b128 v[148:151], v8 offset:58368
    v_mfma_f32_16x16x32_bf16 v[88:91], v[112:115], v[48:51], v[88:91]
    s_waitcnt lgkmcnt(8)
    ds_read_b128 v[152:155], v8 offset:59392
    v_mfma_f32_16x16x32_bf16 v[92:95], v[116:119], v[48:51], v[92:95]
    s_waitcnt lgkmcnt(8)
    ds_read_b128 v[156:159], v8 offset:60416
    v_mfma_f32_16x16x32_bf16 v[96:99], v[120:123], v[48:51], v[96:99]
    s_waitcnt lgkmcnt(8)
    v_add_u32 v8, 61440, v8
    ds_read_b128 v[112:115], v8 offset:0
    v_mfma_f32_16x16x32_bf16 v[100:103], v[124:127], v[48:51], v[100:103]
    s_waitcnt lgkmcnt(8)
    ds_read_b128 v[116:119], v8 offset:1024
    v_mfma_f32_16x16x32_bf16 v[104:107], v[128:131], v[48:51], v[104:107]
    s_waitcnt lgkmcnt(8)
    ds_read_b128 v[120:123], v8 offset:2048
    v_mfma_f32_16x16x32_bf16 v[108:111], v[132:135], v[48:51], v[108:111]
    s_waitcnt vmcnt(6) lgkmcnt(8)
    ds_read_b128 v[124:127], v8 offset:3072
    v_mfma_f32_16x16x32_bf16 v[88:91], v[136:139], v[52:55], v[88:91]
    s_waitcnt lgkmcnt(8)
    ds_read_b128 v[128:131], v8 offset:4096
    v_mfma_f32_16x16x32_bf16 v[92:95], v[140:143], v[52:55], v[92:95]
    s_waitcnt lgkmcnt(8)
    ds_read_b128 v[132:135], v8 offset:5120
    v_mfma_f32_16x16x32_bf16 v[96:99], v[144:147], v[52:55], v[96:99]
    s_waitcnt lgkmcnt(8)
    ds_read_b128 v[136:139], v8 offset:6144
    v_mfma_f32_16x16x32_bf16 v[100:103], v[148:151], v[52:55], v[100:103]
    s_waitcnt lgkmcnt(8)
    ds_read_b128 v[140:143], v8 offset:7168
    v_mfma_f32_16x16x32_bf16 v[104:107], v[152:155], v[52:55], v[104:107]
    s_waitcnt lgkmcnt(8)
    ds_read_b128 v[144:147], v8 offset:8192
    v_mfma_f32_16x16x32_bf16 v[108:111], v[156:159], v[52:55], v[108:111]
    s_waitcnt vmcnt(5) lgkmcnt(8)
    ds_read_b128 v[148:151], v8 offset:9216
    v_mfma_f32_16x16x32_bf16 v[88:91], v[112:115], v[56:59], v[88:91]
    s_waitcnt lgkmcnt(8)
    ds_read_b128 v[152:155], v8 offset:10240
    v_mfma_f32_16x16x32_bf16 v[92:95], v[116:119], v[56:59], v[92:95]
    s_waitcnt lgkmcnt(8)
    ds_read_b128 v[156:159], v8 offset:11264
    v_mfma_f32_16x16x32_bf16 v[96:99], v[120:123], v[56:59], v[96:99]
    s_waitcnt lgkmcnt(8)
    ds_read_b128 v[112:115], v8 offset:12288
    v_mfma_f32_16x16x32_bf16 v[100:103], v[124:127], v[56:59], v[100:103]
    s_waitcnt lgkmcnt(8)
    ds_read_b128 v[116:119], v8 offset:13312
    v_mfma_f32_16x16x32_bf16 v[104:107], v[128:131], v[56:59], v[104:107]
    s_waitcnt lgkmcnt(8)
    ds_read_b128 v[120:123], v8 offset:14336
    v_mfma_f32_16x16x32_bf16 v[108:111], v[132:135], v[56:59], v[108:111]
    ds_read_b128 v[124:127], v8 offset:15360
    buffer_load_dwordx2 v[80:81], v5, s[4:7], s50 offen offset:0 sc1
    buffer_load_dwordx2 v[82:83], v5, s[4:7], s50 offen offset:128 sc1
    s_waitcnt vmcnt(6) lgkmcnt(9)
    v_mfma_f32_16x16x32_bf16 v[88:91], v[136:139], v[60:63], v[88:91]
    s_waitcnt lgkmcnt(8)
    ds_read_b128 v[128:131], v8 offset:16384
    v_mfma_f32_16x16x32_bf16 v[92:95], v[140:143], v[60:63], v[92:95]
    s_waitcnt lgkmcnt(8)
    ds_read_b128 v[132:135], v8 offset:17408
    v_mfma_f32_16x16x32_bf16 v[96:99], v[144:147], v[60:63], v[96:99]
    s_waitcnt lgkmcnt(8)
    ds_read_b128 v[136:139], v8 offset:18432
    v_mfma_f32_16x16x32_bf16 v[100:103], v[148:151], v[60:63], v[100:103]
    s_waitcnt lgkmcnt(8)
    ds_read_b128 v[140:143], v8 offset:19456
    v_mfma_f32_16x16x32_bf16 v[104:107], v[152:155], v[60:63], v[104:107]
    s_waitcnt lgkmcnt(8)
    ds_read_b128 v[144:147], v8 offset:20480
    v_mfma_f32_16x16x32_bf16 v[108:111], v[156:159], v[60:63], v[108:111]
    ds_read_b128 v[148:151], v8 offset:21504
    buffer_load_dwordx2 v[84:85], v5, s[4:7], s50 offen offset:1024 sc1
    buffer_load_dwordx2 v[86:87], v5, s[4:7], s50 offen offset:1152 sc1
    s_waitcnt vmcnt(7) lgkmcnt(9)
    v_mfma_f32_16x16x32_bf16 v[88:91], v[112:115], v[64:67], v[88:91]
    s_waitcnt lgkmcnt(8)
    ds_read_b128 v[152:155], v8 offset:22528
    v_mfma_f32_16x16x32_bf16 v[92:95], v[116:119], v[64:67], v[92:95]
    s_waitcnt lgkmcnt(8)
    ds_read_b128 v[156:159], v8 offset:23552
    v_mfma_f32_16x16x32_bf16 v[96:99], v[120:123], v[64:67], v[96:99]
    s_waitcnt lgkmcnt(8)
    ds_read_b128 v[112:115], v8 offset:24576
    v_mfma_f32_16x16x32_bf16 v[100:103], v[124:127], v[64:67], v[100:103]
    s_waitcnt lgkmcnt(8)
    ds_read_b128 v[116:119], v8 offset:25600
    v_mfma_f32_16x16x32_bf16 v[104:107], v[128:131], v[64:67], v[104:107]
    s_waitcnt lgkmcnt(8)
    ds_read_b128 v[120:123], v8 offset:26624
    v_mfma_f32_16x16x32_bf16 v[108:111], v[132:135], v[64:67], v[108:111]
    s_waitcnt vmcnt(6) lgkmcnt(8)
    ds_read_b128 v[124:127], v8 offset:27648
    v_mfma_f32_16x16x32_bf16 v[88:91], v[136:139], v[68:71], v[88:91]
    s_waitcnt lgkmcnt(8)
    ds_read_b128 v[128:131], v8 offset:28672
    v_mfma_f32_16x16x32_bf16 v[92:95], v[140:143], v[68:71], v[92:95]
    s_waitcnt lgkmcnt(8)
    ds_read_b128 v[132:135], v8 offset:29696
    v_mfma_f32_16x16x32_bf16 v[96:99], v[144:147], v[68:71], v[96:99]
    s_waitcnt lgkmcnt(8)
    ds_read_b128 v[136:139], v8 offset:30720
    v_mfma_f32_16x16x32_bf16 v[100:103], v[148:151], v[68:71], v[100:103]
    s_waitcnt lgkmcnt(8)
    ds_read_b128 v[140:143], v8 offset:31744
    v_mfma_f32_16x16x32_bf16 v[104:107], v[152:155], v[68:71], v[104:107]
    s_waitcnt lgkmcnt(8)
    ds_read_b128 v[144:147], v8 offset:32768
    v_mfma_f32_16x16x32_bf16 v[108:111], v[156:159], v[68:71], v[108:111]
    s_waitcnt vmcnt(5) lgkmcnt(8)
    ds_read_b128 v[148:151], v8 offset:33792
    v_mfma_f32_16x16x32_bf16 v[88:91], v[112:115], v[72:75], v[88:91]
    s_waitcnt lgkmcnt(8)
    ds_read_b128 v[152:155], v8 offset:34816
    v_mfma_f32_16x16x32_bf16 v[92:95], v[116:119], v[72:75], v[92:95]
    s_waitcnt lgkmcnt(8)
    ds_read_b128 v[156:159], v8 offset:35840
    v_mfma_f32_16x16x32_bf16 v[96:99], v[120:123], v[72:75], v[96:99]
    s_waitcnt lgkmcnt(8)
    ds_read_b128 v[112:115], v8 offset:36864
    v_mfma_f32_16x16x32_bf16 v[100:103], v[124:127], v[72:75], v[100:103]
    s_waitcnt lgkmcnt(8)
    ds_read_b128 v[116:119], v8 offset:37888
    v_mfma_f32_16x16x32_bf16 v[104:107], v[128:131], v[72:75], v[104:107]
    s_waitcnt lgkmcnt(8)
    ds_read_b128 v[120:123], v8 offset:38912
    v_mfma_f32_16x16x32_bf16 v[108:111], v[132:135], v[72:75], v[108:111]
    s_waitcnt vmcnt(4) lgkmcnt(8)
    ds_read_b128 v[124:127], v8 offset:39936
    v_mfma_f32_16x16x32_bf16 v[88:91], v[136:139], v[76:79], v[88:91]
    s_waitcnt lgkmcnt(8)
    ds_read_b128 v[128:131], v8 offset:40960
    v_mfma_f32_16x16x32_bf16 v[92:95], v[140:143], v[76:79], v[92:95]
    s_waitcnt lgkmcnt(8)
    ds_read_b128 v[132:135], v8 offset:41984
    v_mfma_f32_16x16x32_bf16 v[96:99], v[144:147], v[76:79], v[96:99]
    s_waitcnt lgkmcnt(8)
    ds_read_b128 v[136:139], v8 offset:43008
    v_mfma_f32_16x16x32_bf16 v[100:103], v[148:151], v[76:79], v[100:103]
    s_waitcnt lgkmcnt(8)
    ds_read_b128 v[140:143], v8 offset:44032
    v_mfma_f32_16x16x32_bf16 v[104:107], v[152:155], v[76:79], v[104:107]
    s_waitcnt lgkmcnt(8)
    ds_read_b128 v[144:147], v8 offset:45056
    v_mfma_f32_16x16x32_bf16 v[108:111], v[156:159], v[76:79], v[108:111]
    s_waitcnt vmcnt(2) lgkmcnt(8)
    ds_read_b128 v[148:151], v8 offset:46080
    v_mfma_f32_16x16x32_bf16 v[88:91], v[112:115], v[80:83], v[88:91]
    s_waitcnt lgkmcnt(8)
    ds_read_b128 v[152:155], v8 offset:47104
    v_mfma_f32_16x16x32_bf16 v[92:95], v[116:119], v[80:83], v[92:95]
    s_waitcnt lgkmcnt(8)
    ds_read_b128 v[156:159], v8 offset:48128
    v_mfma_f32_16x16x32_bf16 v[96:99], v[120:123], v[80:83], v[96:99]
    s_waitcnt lgkmcnt(8)
    v_mfma_f32_16x16x32_bf16 v[100:103], v[124:127], v[80:83], v[100:103]
    s_waitcnt lgkmcnt(7)
    v_mfma_f32_16x16x32_bf16 v[104:107], v[128:131], v[80:83], v[104:107]
    s_waitcnt lgkmcnt(6)
    v_mfma_f32_16x16x32_bf16 v[108:111], v[132:135], v[80:83], v[108:111]
    s_waitcnt vmcnt(0) lgkmcnt(5)
    v_mfma_f32_16x16x32_bf16 v[88:91], v[136:139], v[84:87], v[88:91]
    s_waitcnt lgkmcnt(4)
    v_mfma_f32_16x16x32_bf16 v[92:95], v[140:143], v[84:87], v[92:95]
    s_waitcnt lgkmcnt(3)
    v_mfma_f32_16x16x32_bf16 v[96:99], v[144:147], v[84:87], v[96:99]
    s_waitcnt lgkmcnt(2)
    v_mfma_f32_16x16x32_bf16 v[100:103], v[148:151], v[84:87], v[100:103]
    s_waitcnt lgkmcnt(1)
    v_mfma_f32_16x16x32_bf16 v[104:107], v[152:155], v[84:87], v[104:107]
    s_waitcnt lgkmcnt(0)
    v_mfma_f32_16x16x32_bf16 v[108:111], v[156:159], v[84:87], v[108:111]
    v_lshlrev_b32 v16, 16, v160
    v_and_b32 v17, 0xffff0000, v160
    v_lshlrev_b32 v18, 16, v161
    v_and_b32 v19, 0xffff0000, v161
    v_lshlrev_b32 v20, 16, v162
    v_and_b32 v21, 0xffff0000, v162
    v_lshlrev_b32 v22, 16, v163
    v_and_b32 v23, 0xffff0000, v163
    v_lshlrev_b32 v24, 16, v164
    v_and_b32 v25, 0xffff0000, v164
    v_lshlrev_b32 v26, 16, v165
    v_and_b32 v27, 0xffff0000, v165
    v_lshlrev_b32 v28, 16, v166
    v_and_b32 v29, 0xffff0000, v166
    v_lshlrev_b32 v30, 16, v167
    v_and_b32 v31, 0xffff0000, v167
    v_lshlrev_b32 v32, 16, v168
    v_and_b32 v33, 0xffff0000, v168
    v_lshlrev_b32 v34, 16, v169
    v_and_b32 v35, 0xffff0000, v169
    v_lshlrev_b32 v36, 16, v170
    v_and_b32 v37, 0xffff0000, v170
    v_lshlrev_b32 v38, 16, v171
    v_and_b32 v39, 0xffff0000, v171
    v_add_f32 v16, v16, v88
    v_add_f32 v17, v17, v89
    v_add_f32 v18, v18, v90
    v_add_f32 v19, v19, v91
    v_add_f32 v20, v20, v92
    v_add_f32 v21, v21, v93
    v_add_f32 v22, v22, v94
    v_add_f32 v23, v23, v95
    v_add_f32 v24, v24, v96
    v_add_f32 v25, v25, v97
    v_add_f32 v26, v26, v98
    v_add_f32 v27, v27, v99
    v_add_f32 v28, v28, v100
    v_add_f32 v29, v29, v101
    v_add_f32 v30, v30, v102
    v_add_f32 v31, v31, v103
    v_add_f32 v32, v32, v104
    v_add_f32 v33, v33, v105
    v_add_f32 v34, v34, v106
    v_add_f32 v35, v35, v107
    v_add_f32 v36, v36, v108
    v_add_f32 v37, v37, v109
    v_add_f32 v38, v38, v110
    v_add_f32 v39, v39, v111
    s_mul_i32 s52, s46, 18
    s_mul_i32 s53, s45, 3
    s_add_u32 s52, s52, s53
    s_lshl_b32 s52, s52, 10
    s_add_u32 s52, s52, 25690112
    v_cvt_pk_bf16_f32 v40, v16, v17
    v_cvt_pk_bf16_f32 v41, v18, v19
    v_cvt_pk_bf16_f32 v42, v20, v21
    v_cvt_pk_bf16_f32 v43, v22, v23
    buffer_store_dwordx4 v[40:43], v2, s[4:7], s52 offen offset:0 sc1
    v_cvt_pk_bf16_f32 v44, v24, v25
    v_cvt_pk_bf16_f32 v45, v26, v27
    v_cvt_pk_bf16_f32 v46, v28, v29
    v_cvt_pk_bf16_f32 v47, v30, v31
    buffer_store_dwordx4 v[44:47], v2, s[4:7], s52 offen offset:1024 sc1
    v_cvt_pk_bf16_f32 v48, v32, v33
    v_cvt_pk_bf16_f32 v49, v34, v35
    v_cvt_pk_bf16_f32 v50, v36, v37
    v_cvt_pk_bf16_f32 v51, v38, v39
    buffer_store_dwordx4 v[48:51], v2, s[4:7], s52 offen offset:2048 sc1
    v_lshlrev_b32 v16, 16, v40
    v_and_b32 v17, 0xffff0000, v40
    v_lshlrev_b32 v18, 16, v41
    v_and_b32 v19, 0xffff0000, v41
    v_lshlrev_b32 v20, 16, v42
    v_and_b32 v21, 0xffff0000, v42
    v_lshlrev_b32 v22, 16, v43
    v_and_b32 v23, 0xffff0000, v43
    v_lshlrev_b32 v24, 16, v44
    v_and_b32 v25, 0xffff0000, v44
    v_lshlrev_b32 v26, 16, v45
    v_and_b32 v27, 0xffff0000, v45
    v_lshlrev_b32 v28, 16, v46
    v_and_b32 v29, 0xffff0000, v46
    v_lshlrev_b32 v30, 16, v47
    v_and_b32 v31, 0xffff0000, v47
    v_lshlrev_b32 v32, 16, v48
    v_and_b32 v33, 0xffff0000, v48
    v_lshlrev_b32 v34, 16, v49
    v_and_b32 v35, 0xffff0000, v49
    v_lshlrev_b32 v36, 16, v50
    v_and_b32 v37, 0xffff0000, v50
    v_lshlrev_b32 v38, 16, v51
    v_and_b32 v39, 0xffff0000, v51
    v_add_f32 v56, v16, v17
    v_add_f32 v58, v18, v19
    v_add_f32 v56, v56, v20
    v_add_f32 v58, v58, v21
    v_add_f32 v56, v56, v22
    v_add_f32 v58, v58, v23
    v_add_f32 v56, v56, v24
    v_add_f32 v58, v58, v25
    v_add_f32 v56, v56, v26
    v_add_f32 v58, v58, v27
    v_add_f32 v56, v56, v28
    v_add_f32 v58, v58, v29
    v_add_f32 v56, v56, v30
    v_add_f32 v58, v58, v31
    v_add_f32 v56, v56, v32
    v_add_f32 v58, v58, v33
    v_add_f32 v56, v56, v34
    v_add_f32 v58, v58, v35
    v_add_f32 v56, v56, v36
    v_add_f32 v58, v58, v37
    v_add_f32 v56, v56, v38
    v_add_f32 v58, v58, v39
    v_add_f32 v56, v56, v58
    v_mov_b32 v58, v56
    s_nop 1
    v_permlane16_swap_b32 v56, v58
    v_add_f32 v56, v56, v58
    v_mov_b32 v58, v56
    s_nop 1
    v_permlane32_swap_b32 v56, v58
    v_add_f32 v56, v56, v58
    v_mul_f32 v59, 0x3c2aaaab, v56
    v_sub_f32 v58, v16, v59
    v_mul_f32 v57, v58, v58
    v_sub_f32 v61, v17, v59
    v_fmac_f32 v57, v61, v61
    v_sub_f32 v60, v18, v59
    v_fmac_f32 v57, v60, v60
    v_sub_f32 v61, v19, v59
    v_fmac_f32 v57, v61, v61
    v_sub_f32 v60, v20, v59
    v_fmac_f32 v57, v60, v60
    v_sub_f32 v61, v21, v59
    v_fmac_f32 v57, v61, v61
    v_sub_f32 v60, v22, v59
    v_fmac_f32 v57, v60, v60
    v_sub_f32 v61, v23, v59
    v_fmac_f32 v57, v61, v61
    v_sub_f32 v60, v24, v59
    v_fmac_f32 v57, v60, v60
    v_sub_f32 v61, v25, v59
    v_fmac_f32 v57, v61, v61
    v_sub_f32 v60, v26, v59
    v_fmac_f32 v57, v60, v60
    v_sub_f32 v61, v27, v59
    v_fmac_f32 v57, v61, v61
    v_sub_f32 v60, v28, v59
    v_fmac_f32 v57, v60, v60
    v_sub_f32 v61, v29, v59
    v_fmac_f32 v57, v61, v61
    v_sub_f32 v60, v30, v59
    v_fmac_f32 v57, v60, v60
    v_sub_f32 v61, v31, v59
    v_fmac_f32 v57, v61, v61
    v_sub_f32 v60, v32, v59
    v_fmac_f32 v57, v60, v60
    v_sub_f32 v61, v33, v59
    v_fmac_f32 v57, v61, v61
    v_sub_f32 v60, v34, v59
    v_fmac_f32 v57, v60, v60
    v_sub_f32 v61, v35, v59
    v_fmac_f32 v57, v61, v61
    v_sub_f32 v60, v36, v59
    v_fmac_f32 v57, v60, v60
    v_sub_f32 v61, v37, v59
    v_fmac_f32 v57, v61, v61
    v_sub_f32 v60, v38, v59
    v_fmac_f32 v57, v60, v60
    v_sub_f32 v61, v39, v59
    v_fmac_f32 v57, v61, v61
    v_mov_b32 v58, v57
    s_nop 1
    v_permlane16_swap_b32 v57, v58
    v_add_f32 v57, v57, v58
    v_mov_b32 v58, v57
    s_nop 1
    v_permlane32_swap_b32 v57, v58
    v_add_f32 v57, v57, v58
    s_lshl_b32 s52, s45, 14
    s_add_u32 s52, s52, 28049408
    s_mov_b32 exec_lo, 0xffff
    s_mov_b32 exec_hi, 0
    buffer_store_dwordx2 v[56:57], v7, s[4:7], s52 offen sc1
    s_mov_b64 exec, -1
    s_lshl_b32 s52, s46, 3
    s_add_u32 s52, s52, s45
    s_lshl_b32 s52, s52, 3
    s_add_u32 s52, s52, 3964928
    s_and_b32 s23, s21, 7
    s_lshl_b32 s23, s23, 2
    s_and_b32 s1, s22, 3
    s_add_u32 s1, s1, s23
    s_lshl_b32 s1, s1, 9
    s_add_u32 s1, s1, 4071424
    v_min_u32 v14, 35, v1
    v_lshlrev_b32 v14, 3, v14
    buffer_load_dwordx2 v[12:13], v14, s[4:7], s1 offen sc1
    v_mov_b32 v8, s98
    v_mov_b32 v9, s99
    s_waitcnt vmcnt(1)
    s_mov_b64 exec, 1
    buffer_store_dwordx2 v[8:9], off, s[4:7], s52 sc1
    s_mov_b64 exec, -1
    s_mov_b32 s0, 0
    s_cmp_lg_u32 s20, 3
    s_cbranch_scc1 L_ffn_49
    s_mul_i32 s55, s20, 9216
    s_add_u32 s55, s55, 110592
    v_add_u32 v64, s55, v2
    ds_write_b128 v64, a[180:183] offset:0
    ds_write_b128 v64, a[184:187] offset:1024
    ds_write_b128 v64, a[188:191] offset:2048
    ds_write_b128 v64, a[192:195] offset:3072
    ds_write_b128 v64, a[196:199] offset:4096
    ds_write_b128 v64, a[200:203] offset:5120
    ds_write_b128 v64, a[204:207] offset:6144
    ds_write_b128 v64, a[208:211] offset:7168
    ds_write_b128 v64, a[212:215] offset:8192
    s_cmp_ge_u32 s30, 1152
    s_cbranch_scc1 L_ud_58
    s_mul_i32 s64, s30, 1821
    s_lshr_b32 s64, s64, 16
    s_mul_i32 s92, s64, 36
    s_sub_u32 s92, s30, s92
    s_and_b32 s93, s92, 1
    s_lshr_b32 s94, s92, 1
    s_mov_b32 s62, 0
    s_mov_b32 s63, 256
    s_mul_i32 s95, s64, 486
    s_add_u32 s95, s95, s92
    s_lshl_b32 s95, s95, 10
    s_add_u32 s69, s95, 4194304
    s_add_u32 s67, s69, 36864
    s_add_u32 s68, s69, 184320
    s_mov_b32 s70, 36864
    s_mov_b32 s71, 73728
    s_lshl_b32 s95, s64, 1
    s_add_u32 s95, s95, s93
    s_mul_i32 s95, s95, 18
    s_add_u32 s95, s95, s94
    s_mul_i32 s95, s95, 576
    s_add_u32 s65, s95, 2883584
    s_mov_b32 s66, s92
    s_branch L_udone_59
L_ud_58:
    s_sub_u32 s92, s30, 1152
    s_mul_i32 s64, s92, 3641
    s_lshr_b32 s64, s64, 16
    s_mul_i32 s93, s64, 18
    s_sub_u32 s92, s92, s93
    s_and_b32 s93, s64, 3
    s_and_b32 s94, s93, 1
    s_mov_b32 s65, 0
    s_lshl_b32 s62, s94, 5
    s_cmp_eq_u32 s94, 0
    s_cselect_b32 s63, 256, 0
    s_add_u32 s66, s92, 36
    s_mul_i32 s95, s64, 486
    s_add_u32 s95, s95, 324
    s_lshl_b32 s95, s95, 10
    s_add_u32 s95, s95, 4194304
    s_cmp_ge_u32 s92, 3
    s_cbranch_scc1 L_ub_60
    s_sub_u32 s96, s92, 0
    s_mov_b32 s70, 1024
    s_mov_b32 s71, 2048
    s_mul_i32 s97, s96, 5120
    s_add_u32 s97, s97, 0
    s_add_u32 s67, s97, s95
    s_mul_i32 s97, s96, 4096
    s_add_u32 s97, s97, 15360
    s_add_u32 s68, s97, s95
    s_mul_i32 s97, s96, 5120
    s_add_u32 s97, s97, 4096
    s_add_u32 s69, s97, s95
    s_branch L_udone_59
L_ub_60:
    s_cmp_ge_u32 s92, 9
    s_cbranch_scc1 L_uc_61
    s_sub_u32 s96, s92, 3
    s_mov_b32 s70, 1024
    s_mov_b32 s71, 2048
    s_mul_i32 s97, s96, 9216
    s_add_u32 s97, s97, 27648
    s_add_u32 s67, s97, s95
    s_mul_i32 s97, s96, 9216
    s_add_u32 s97, s97, 31744
    s_add_u32 s68, s97, s95
    s_mul_i32 s97, s96, 9216
    s_add_u32 s97, s97, 35840
    s_add_u32 s69, s97, s95
    s_branch L_udone_59
L_uc_61:
    s_sub_u32 s96, s92, 9
    s_mov_b32 s70, 1024
    s_mov_b32 s71, 18432
    s_mul_i32 s97, s96, 2048
    s_add_u32 s97, s97, 82944
    s_add_u32 s67, s97, s95
    s_mul_i32 s97, s96, 2048
    s_add_u32 s97, s97, 119808
    s_add_u32 s68, s97, s95
    s_mul_i32 s97, s96, 1024
    s_add_u32 s97, s97, 156672
    s_add_u32 s69, s97, s95
L_udone_59:
    s_lshl_b32 s95, s64, 6
    s_add_u32 s95, s95, s66
    s_lshl_b32 s95, s95, 3
    s_add_u32 s66, s95, 4071424
    v_lshrrev_b32 v64, 4, v1
    v_bfe_u32 v66, v1, 2, 2
    v_lshl_add_u32 v64, v64, 3, v66
    v_mul_u32_u24 v64, 288, v64
    v_add_u32 v64, s55, v64
    v_and_b32 v66, 3, v1
    v_lshl_add_u32 v65, v66, 3, v64
    v_add_u32 v65, s63, v65
    v_lshl_add_u32 v64, v66, 4, v64
    v_add_u32 v64, s62, v64
    ds_read_b64_tr_b16 v[72:73], v64 offset:0
    ds_read_b64_tr_b16 v[74:75], v64 offset:1152
    ds_read_b64_tr_b16 v[76:77], v64 offset:8
    ds_read_b64_tr_b16 v[78:79], v64 offset:1160
    ds_read_b64_tr_b16 v[80:81], v64 offset:64
    ds_read_b64_tr_b16 v[82:83], v64 offset:1216
    ds_read_b64_tr_b16 v[84:85], v64 offset:72
    ds_read_b64_tr_b16 v[86:87], v64 offset:1224
    ds_read_b64_tr_b16 v[88:89], v64 offset:128
    ds_read_b64_tr_b16 v[90:91], v64 offset:1280
    ds_read_b64_tr_b16 v[92:93], v64 offset:136
    ds_read_b64_tr_b16 v[94:95], v64 offset:1288
    ds_read_b64_tr_b16 v[96:97], v64 offset:192
    ds_read_b64_tr_b16 v[98:99], v64 offset:1344
    ds_read_b64_tr_b16 v[100:101], v64 offset:200
    ds_read_b64_tr_b16 v[102:103], v64 offset:1352
    ds_read_b64_tr_b16 v[104:105], v65 offset:0
    ds_read_b64_tr_b16 v[106:107], v65 offset:1152
    s_waitcnt lgkmcnt(15)
    buffer_store_dwordx4 v[72:75], v2, s[4:7], s67 offen sc1
    s_add_u32 s92, s67, s70
    s_waitcnt lgkmcnt(14)
    buffer_store_dwordx4 v[76:79], v2, s[4:7], s92 offen sc1
    s_add_u32 s92, s67, s71
    s_waitcnt lgkmcnt(12)
    buffer_store_dwordx4 v[80:83], v2, s[4:7], s92 offen sc1
    s_add_u32 s92, s92, s70
    s_waitcnt lgkmcnt(10)
    buffer_store_dwordx4 v[84:87], v2, s[4:7], s92 offen sc1
    s_waitcnt lgkmcnt(8)
    buffer_store_dwordx4 v[88:91], v2, s[4:7], s68 offen sc1
    s_add_u32 s92, s68, s70
    s_waitcnt lgkmcnt(6)
    buffer_store_dwordx4 v[92:95], v2, s[4:7], s92 offen sc1
    s_add_u32 s92, s68, s71
    s_waitcnt lgkmcnt(4)
    buffer_store_dwordx4 v[96:99], v2, s[4:7], s92 offen sc1
    s_add_u32 s92, s92, s70
    s_waitcnt lgkmcnt(2)
    buffer_store_dwordx4 v[100:103], v2, s[4:7], s92 offen sc1
    s_waitcnt lgkmcnt(0)
    buffer_store_dwordx4 v[104:107], v2, s[4:7], s69 offen sc1
    s_cmp_eq_u32 s65, 0
    s_cbranch_scc1 L_nocs_62
    v_mov_b32 v68, 0x3f803f80
    v_mov_b32 v69, 0x3f803f80
    v_mov_b32 v70, 0x3f803f80
    v_mov_b32 v71, 0x3f803f80
    s_nop 1
    v_mfma_f32_16x16x32_bf16 v[108:111], v[72:75], v[68:71], 0
    v_mfma_f32_16x16x32_bf16 v[112:115], v[76:79], v[68:71], 0
    v_mfma_f32_16x16x32_bf16 v[116:119], v[80:83], v[68:71], 0
    v_mfma_f32_16x16x32_bf16 v[120:123], v[84:87], v[68:71], 0
    v_mfma_f32_16x16x32_bf16 v[124:127], v[88:91], v[68:71], 0
    v_mfma_f32_16x16x32_bf16 v[128:131], v[92:95], v[68:71], 0
    v_mfma_f32_16x16x32_bf16 v[132:135], v[96:99], v[68:71], 0
    v_mfma_f32_16x16x32_bf16 v[136:139], v[100:103], v[68:71], 0
    v_mfma_f32_16x16x32_bf16 v[140:143], v[104:107], v[68:71], 0
    v_and_b32 v66, 15, v1
    v_add_u32 v67, 1, v66
    v_cmp_gt_u32 vcc, 8, v66
    v_and_b32 v64, 48, v1
    s_nop 0
    v_cndmask_b32 v67, 0, v67, vcc
    v_lshlrev_b32 v67, 6, v67
    v_add_u32 v67, v67, v64
    v_cmp_eq_u32 vcc, 1, v66
    s_nop 1
    v_cndmask_b32 v108, v108, v112, vcc
    v_cndmask_b32 v109, v109, v113, vcc
    v_cndmask_b32 v110, v110, v114, vcc
    v_cndmask_b32 v111, v111, v115, vcc
    v_cmp_eq_u32 vcc, 2, v66
    s_nop 1
    v_cndmask_b32 v108, v108, v116, vcc
    v_cndmask_b32 v109, v109, v117, vcc
    v_cndmask_b32 v110, v110, v118, vcc
    v_cndmask_b32 v111, v111, v119, vcc
    v_cmp_eq_u32 vcc, 3, v66
    s_nop 1
    v_cndmask_b32 v108, v108, v120, vcc
    v_cndmask_b32 v109, v109, v121, vcc
    v_cndmask_b32 v110, v110, v122, vcc
    v_cndmask_b32 v111, v111, v123, vcc
    v_cmp_eq_u32 vcc, 4, v66
    s_nop 1
    v_cndmask_b32 v108, v108, v124, vcc
    v_cndmask_b32 v109, v109, v125, vcc
    v_cndmask_b32 v110, v110, v126, vcc
    v_cndmask_b32 v111, v111, v127, vcc
    v_cmp_eq_u32 vcc, 5, v66
    s_nop 1
    v_cndmask_b32 v108, v108, v128, vcc
    v_cndmask_b32 v109, v109, v129, vcc
    v_cndmask_b32 v110, v110, v130, vcc
    v_cndmask_b32 v111, v111, v131, vcc
    v_cmp_eq_u32 vcc, 6, v66
    s_nop 1
    v_cndmask_b32 v108, v108, v132, vcc
    v_cndmask_b32 v109, v109, v133, vcc
    v_cndmask_b32 v110, v110, v134, vcc
    v_cndmask_b32 v111, v111, v135, vcc
    v_cmp_eq_u32 vcc, 7, v66
    s_nop 1
    v_cndmask_b32 v108, v108, v136, vcc
    v_cndmask_b32 v109, v109, v137, vcc
    v_cndmask_b32 v110, v110, v138, vcc
    v_cndmask_b32 v111, v111, v139, vcc
    v_cmp_eq_u32 vcc, 8, v66
    s_nop 1
    v_cndmask_b32 v108, v108, v140, vcc
    v_cndmask_b32 v109, v109, v141, vcc
    v_cndmask_b32 v110, v110, v142, vcc
    v_cndmask_b32 v111, v111, v143, vcc
    s_mov_b32 exec_lo, 0x01ff01ff
    s_mov_b32 exec_hi, 0x01ff01ff
    buffer_store_dwordx4 v[108:111], v67, s[4:7], s65 offen sc1
    s_mov_b64 exec, -1
L_nocs_62:
    s_mov_b32 s0, s66
    s_branch L_ffn_49
L_idle0_48:
    s_mul_i32 s55, s20, 9216
    s_add_u32 s55, s55, 110592
    v_add_u32 v64, s55, v2
    ds_write_b128 v64, a[180:183] offset:0
    ds_write_b128 v64, a[184:187] offset:1024
    ds_write_b128 v64, a[188:191] offset:2048
    ds_write_b128 v64, a[192:195] offset:3072
    ds_write_b128 v64, a[196:199] offset:4096
    ds_write_b128 v64, a[200:203] offset:5120
    ds_write_b128 v64, a[204:207] offset:6144
    ds_write_b128 v64, a[208:211] offset:7168
    ds_write_b128 v64, a[212:215] offset:8192
    s_cmp_ge_u32 s30, 1152
    s_cbranch_scc1 L_ud_63
    s_mul_i32 s64, s30, 1821
    s_lshr_b32 s64, s64, 16
    s_mul_i32 s92, s64, 36
    s_sub_u32 s92, s30, s92
    s_and_b32 s93, s92, 1
    s_lshr_b32 s94, s92, 1
    s_mov_b32 s62, 0
    s_mov_b32 s63, 256
    s_mul_i32 s95, s64, 486
    s_add_u32 s95, s95, s92
    s_lshl_b32 s95, s95, 10
    s_add_u32 s69, s95, 4194304
    s_add_u32 s67, s69, 36864
    s_add_u32 s68, s69, 184320
    s_mov_b32 s70, 36864
    s_mov_b32 s71, 73728
    s_lshl_b32 s95, s64, 1
    s_add_u32 s95, s95, s93
    s_mul_i32 s95, s95, 18
    s_add_u32 s95, s95, s94
    s_mul_i32 s95, s95, 576
    s_add_u32 s65, s95, 2883584
    s_mov_b32 s66, s92
    s_branch L_udone_64
L_ud_63:
    s_sub_u32 s92, s30, 1152
    s_mul_i32 s64, s92, 3641
    s_lshr_b32 s64, s64, 16
    s_mul_i32 s93, s64, 18
    s_sub_u32 s92, s92, s93
    s_and_b32 s93, s64, 3
    s_and_b32 s94, s93, 1
    s_mov_b32 s65, 0
    s_lshl_b32 s62, s94, 5
    s_cmp_eq_u32 s94, 0
    s_cselect_b32 s63, 256, 0
    s_add_u32 s66, s92, 36
    s_mul_i32 s95, s64, 486
    s_add_u32 s95, s95, 324
    s_lshl_b32 s95, s95, 10
    s_add_u32 s95, s95, 4194304
    s_cmp_ge_u32 s92, 3
    s_cbranch_scc1 L_ub_65
    s_sub_u32 s96, s92, 0
    s_mov_b32 s70, 1024
    s_mov_b32 s71, 2048
    s_mul_i32 s97, s96, 5120
    s_add_u32 s97, s97, 0
    s_add_u32 s67, s97, s95
    s_mul_i32 s97, s96, 4096
    s_add_u32 s97, s97, 15360
    s_add_u32 s68, s97, s95
    s_mul_i32 s97, s96, 5120
    s_add_u32 s97, s97, 4096
    s_add_u32 s69, s97, s95
    s_branch L_udone_64
L_ub_65:
    s_cmp_ge_u32 s92, 9
    s_cbranch_scc1 L_uc_66
    s_sub_u32 s96, s92, 3
    s_mov_b32 s70, 1024
    s_mov_b32 s71, 2048
    s_mul_i32 s97, s96, 9216
    s_add_u32 s97, s97, 27648
    s_add_u32 s67, s97, s95
    s_mul_i32 s97, s96, 9216
    s_add_u32 s97, s97, 31744
    s_add_u32 s68, s97, s95
    s_mul_i32 s97, s96, 9216
    s_add_u32 s97, s97, 35840
    s_add_u32 s69, s97, s95
    s_branch L_udone_64
L_uc_66:
    s_sub_u32 s96, s92, 9
    s_mov_b32 s70, 1024
    s_mov_b32 s71, 18432
    s_mul_i32 s97, s96, 2048
    s_add_u32 s97, s97, 82944
    s_add_u32 s67, s97, s95
    s_mul_i32 s97, s96, 2048
    s_add_u32 s97, s97, 119808
    s_add_u32 s68, s97, s95
    s_mul_i32 s97, s96, 1024
    s_add_u32 s97, s97, 156672
    s_add_u32 s69, s97, s95
L_udone_64:
    s_lshl_b32 s95, s64, 6
    s_add_u32 s95, s95, s66
    s_lshl_b32 s95, s95, 3
    s_add_u32 s66, s95, 4071424
    v_lshrrev_b32 v64, 4, v1
    v_bfe_u32 v66, v1, 2, 2
    v_lshl_add_u32 v64, v64, 3, v66
    v_mul_u32_u24 v64, 288, v64
    v_add_u32 v64, s55, v64
    v_and_b32 v66, 3, v1
    v_lshl_add_u32 v65, v66, 3, v64
    v_add_u32 v65, s63, v65
    v_lshl_add_u32 v64, v66, 4, v64
    v_add_u32 v64, s62, v64
    ds_read_b64_tr_b16 v[72:73], v64 offset:0
    ds_read_b64_tr_b16 v[74:75], v64 offset:1152
    ds_read_b64_tr_b16 v[76:77], v64 offset:8
    ds_read_b64_tr_b16 v[78:79], v64 offset:1160
    ds_read_b64_tr_b16 v[80:81], v64 offset:64
    ds_read_b64_tr_b16 v[82:83], v64 offset:1216
    ds_read_b64_tr_b16 v[84:85], v64 offset:72
    ds_read_b64_tr_b16 v[86:87], v64 offset:1224
    ds_read_b64_tr_b16 v[88:89], v64 offset:128
    ds_read_b64_tr_b16 v[90:91], v64 offset:1280
    ds_read_b64_tr_b16 v[92:93], v64 offset:136
    ds_read_b64_tr_b16 v[94:95], v64 offset:1288
    ds_read_b64_tr_b16 v[96:97], v64 offset:192
    ds_read_b64_tr_b16 v[98:99], v64 offset:1344
    ds_read_b64_tr_b16 v[100:101], v64 offset:200
    ds_read_b64_tr_b16 v[102:103], v64 offset:1352
    ds_read_b64_tr_b16 v[104:105], v65 offset:0
    ds_read_b64_tr_b16 v[106:107], v65 offset:1152
    s_waitcnt lgkmcnt(15)
    buffer_store_dwordx4 v[72:75], v2, s[4:7], s67 offen sc1
    s_add_u32 s92, s67, s70
    s_waitcnt lgkmcnt(14)
    buffer_store_dwordx4 v[76:79], v2, s[4:7], s92 offen sc1
    s_add_u32 s92, s67, s71
    s_waitcnt lgkmcnt(12)
    buffer_store_dwordx4 v[80:83], v2, s[4:7], s92 offen sc1
    s_add_u32 s92, s92, s70
    s_waitcnt lgkmcnt(10)
    buffer_store_dwordx4 v[84:87], v2, s[4:7], s92 offen sc1
    s_waitcnt lgkmcnt(8)
    buffer_store_dwordx4 v[88:91], v2, s[4:7], s68 offen sc1
    s_add_u32 s92, s68, s70
    s_waitcnt lgkmcnt(6)
    buffer_store_dwordx4 v[92:95], v2, s[4:7], s92 offen sc1
    s_add_u32 s92, s68, s71
    s_waitcnt lgkmcnt(4)
    buffer_store_dwordx4 v[96:99], v2, s[4:7], s92 offen sc1
    s_add_u32 s92, s92, s70
    s_waitcnt lgkmcnt(2)
    buffer_store_dwordx4 v[100:103], v2, s[4:7], s92 offen sc1
    s_waitcnt lgkmcnt(0)
    buffer_store_dwordx4 v[104:107], v2, s[4:7], s69 offen sc1
    s_cmp_eq_u32 s65, 0
    s_cbranch_scc1 L_nocs_67
    v_mov_b32 v68, 0x3f803f80
    v_mov_b32 v69, 0x3f803f80
    v_mov_b32 v70, 0x3f803f80
    v_mov_b32 v71, 0x3f803f80
    s_nop 1
    v_mfma_f32_16x16x32_bf16 v[108:111], v[72:75], v[68:71], 0
    v_mfma_f32_16x16x32_bf16 v[112:115], v[76:79], v[68:71], 0
    v_mfma_f32_16x16x32_bf16 v[116:119], v[80:83], v[68:71], 0
    v_mfma_f32_16x16x32_bf16 v[120:123], v[84:87], v[68:71], 0
    v_mfma_f32_16x16x32_bf16 v[124:127], v[88:91], v[68:71], 0
    v_mfma_f32_16x16x32_bf16 v[128:131], v[92:95], v[68:71], 0
    v_mfma_f32_16x16x32_bf16 v[132:135], v[96:99], v[68:71], 0
    v_mfma_f32_16x16x32_bf16 v[136:139], v[100:103], v[68:71], 0
    v_mfma_f32_16x16x32_bf16 v[140:143], v[104:107], v[68:71], 0
    v_and_b32 v66, 15, v1
    v_add_u32 v67, 1, v66
    v_cmp_gt_u32 vcc, 8, v66
    v_and_b32 v64, 48, v1
    s_nop 0
    v_cndmask_b32 v67, 0, v67, vcc
    v_lshlrev_b32 v67, 6, v67
    v_add_u32 v67, v67, v64
    v_cmp_eq_u32 vcc, 1, v66
    s_nop 1
    v_cndmask_b32 v108, v108, v112, vcc
    v_cndmask_b32 v109, v109, v113, vcc
    v_cndmask_b32 v110, v110, v114, vcc
    v_cndmask_b32 v111, v111, v115, vcc
    v_cmp_eq_u32 vcc, 2, v66
    s_nop 1
    v_cndmask_b32 v108, v108, v116, vcc
    v_cndmask_b32 v109, v109, v117, vcc
    v_cndmask_b32 v110, v110, v118, vcc
    v_cndmask_b32 v111, v111, v119, vcc
    v_cmp_eq_u32 vcc, 3, v66
    s_nop 1
    v_cndmask_b32 v108, v108, v120, vcc
    v_cndmask_b32 v109, v109, v121, vcc
    v_cndmask_b32 v110, v110, v122, vcc
    v_cndmask_b32 v111, v111, v123, vcc
    v_cmp_eq_u32 vcc, 4, v66
    s_nop 1
    v_cndmask_b32 v108, v108, v124, vcc
    v_cndmask_b32 v109, v109, v125, vcc
    v_cndmask_b32 v110, v110, v126, vcc
    v_cndmask_b32 v111, v111, v127, vcc
    v_cmp_eq_u32 vcc, 5, v66
    s_nop 1
    v_cndmask_b32 v108, v108, v128, vcc
    v_cndmask_b32 v109, v109, v129, vcc
    v_cndmask_b32 v110, v110, v130, vcc
    v_cndmask_b32 v111, v111, v131, vcc
    v_cmp_eq_u32 vcc, 6, v66
    s_nop 1
    v_cndmask_b32 v108, v108, v132, vcc
    v_cndmask_b32 v109, v109, v133, vcc
    v_cndmask_b32 v110, v110, v134, vcc
    v_cndmask_b32 v111, v111, v135, vcc
    v_cmp_eq_u32 vcc, 7, v66
    s_nop 1
    v_cndmask_b32 v108, v108, v136, vcc
    v_cndmask_b32 v109, v109, v137, vcc
    v_cndmask_b32 v110, v110, v138, vcc
    v_cndmask_b32 v111, v111, v139, vcc
    v_cmp_eq_u32 vcc, 8, v66
    s_nop 1
    v_cndmask_b32 v108, v108, v140, vcc
    v_cndmask_b32 v109, v109, v141, vcc
    v_cndmask_b32 v110, v110, v142, vcc
    v_cndmask_b32 v111, v111, v143, vcc
    s_mov_b32 exec_lo, 0x01ff01ff
    s_mov_b32 exec_hi, 0x01ff01ff
    buffer_store_dwordx4 v[108:111], v67, s[4:7], s65 offen sc1
    s_mov_b64 exec, -1
L_nocs_67:
    s_mov_b32 s44, s66
    s_mul_i32 s55, s20, 9216
    s_add_u32 s55, s55, 110592
    v_add_u32 v64, s55, v2
    ds_write_b128 v64, a[216:219] offset:0
    ds_write_b128 v64, a[220:223] offset:1024
    ds_write_b128 v64, a[224:227] offset:2048
    ds_write_b128 v64, a[228:231] offset:3072
    ds_write_b128 v64, a[232:235] offset:4096
    ds_write_b128 v64, a[236:239] offset:5120
    ds_write_b128 v64, a[240:243] offset:6144
    ds_write_b128 v64, a[244:247] offset:7168
    ds_write_b128 v64, a[248:251] offset:8192
    s_cmp_ge_u32 s31, 1152
    s_cbranch_scc1 L_ud_68
    s_mul_i32 s64, s31, 1821
    s_lshr_b32 s64, s64, 16
    s_mul_i32 s92, s64, 36
    s_sub_u32 s92, s31, s92
    s_and_b32 s93, s92, 1
    s_lshr_b32 s94, s92, 1
    s_mov_b32 s62, 0
    s_mov_b32 s63, 256
    s_mul_i32 s95, s64, 486
    s_add_u32 s95, s95, s92
    s_lshl_b32 s95, s95, 10
    s_add_u32 s69, s95, 4194304
    s_add_u32 s67, s69, 36864
    s_add_u32 s68, s69, 184320
    s_mov_b32 s70, 36864
    s_mov_b32 s71, 73728
    s_lshl_b32 s95, s64, 1
    s_add_u32 s95, s95, s93
    s_mul_i32 s95, s95, 18
    s_add_u32 s95, s95, s94
    s_mul_i32 s95, s95, 576
    s_add_u32 s65, s95, 2883584
    s_mov_b32 s66, s92
    s_branch L_udone_69
L_ud_68:
    s_sub_u32 s92, s31, 1152
    s_mul_i32 s64, s92, 3641
    s_lshr_b32 s64, s64, 16
    s_mul_i32 s93, s64, 18
    s_sub_u32 s92, s92, s93
    s_and_b32 s93, s64, 3
    s_and_b32 s94, s93, 1
    s_mov_b32 s65, 0
    s_lshl_b32 s62, s94, 5
    s_cmp_eq_u32 s94, 0
    s_cselect_b32 s63, 256, 0
    s_add_u32 s66, s92, 36
    s_mul_i32 s95, s64, 486
    s_add_u32 s95, s95, 324
    s_lshl_b32 s95, s95, 10
    s_add_u32 s95, s95, 4194304
    s_cmp_ge_u32 s92, 3
    s_cbranch_scc1 L_ub_70
    s_sub_u32 s96, s92, 0
    s_mov_b32 s70, 1024
    s_mov_b32 s71, 2048
    s_mul_i32 s97, s96, 5120
    s_add_u32 s97, s97, 0
    s_add_u32 s67, s97, s95
    s_mul_i32 s97, s96, 4096
    s_add_u32 s97, s97, 15360
    s_add_u32 s68, s97, s95
    s_mul_i32 s97, s96, 5120
    s_add_u32 s97, s97, 4096
    s_add_u32 s69, s97, s95
    s_branch L_udone_69
L_ub_70:
    s_cmp_ge_u32 s92, 9
    s_cbranch_scc1 L_uc_71
    s_sub_u32 s96, s92, 3
    s_mov_b32 s70, 1024
    s_mov_b32 s71, 2048
    s_mul_i32 s97, s96, 9216
    s_add_u32 s97, s97, 27648
    s_add_u32 s67, s97, s95
    s_mul_i32 s97, s96, 9216
    s_add_u32 s97, s97, 31744
    s_add_u32 s68, s97, s95
    s_mul_i32 s97, s96, 9216
    s_add_u32 s97, s97, 35840
    s_add_u32 s69, s97, s95
    s_branch L_udone_69
L_uc_71:
    s_sub_u32 s96, s92, 9
    s_mov_b32 s70, 1024
    s_mov_b32 s71, 18432
    s_mul_i32 s97, s96, 2048
    s_add_u32 s97, s97, 82944
    s_add_u32 s67, s97, s95
    s_mul_i32 s97, s96, 2048
    s_add_u32 s97, s97, 119808
    s_add_u32 s68, s97, s95
    s_mul_i32 s97, s96, 1024
    s_add_u32 s97, s97, 156672
    s_add_u32 s69, s97, s95
L_udone_69:
    s_lshl_b32 s95, s64, 6
    s_add_u32 s95, s95, s66
    s_lshl_b32 s95, s95, 3
    s_add_u32 s66, s95, 4071424
    v_lshrrev_b32 v64, 4, v1
    v_bfe_u32 v66, v1, 2, 2
    v_lshl_add_u32 v64, v64, 3, v66
    v_mul_u32_u24 v64, 288, v64
    v_add_u32 v64, s55, v64
    v_and_b32 v66, 3, v1
    v_lshl_add_u32 v65, v66, 3, v64
    v_add_u32 v65, s63, v65
    v_lshl_add_u32 v64, v66, 4, v64
    v_add_u32 v64, s62, v64
    ds_read_b64_tr_b16 v[180:181], v64 offset:0
    ds_read_b64_tr_b16 v[182:183], v64 offset:1152
    ds_read_b64_tr_b16 v[184:185], v64 offset:8
    ds_read_b64_tr_b16 v[186:187], v64 offset:1160
    ds_read_b64_tr_b16 v[188:189], v64 offset:64
    ds_read_b64_tr_b16 v[190:191], v64 offset:1216
    ds_read_b64_tr_b16 v[192:193], v64 offset:72
    ds_read_b64_tr_b16 v[194:195], v64 offset:1224
    ds_read_b64_tr_b16 v[196:197], v64 offset:128
    ds_read_b64_tr_b16 v[198:199], v64 offset:1280
    ds_read_b64_tr_b16 v[200:201], v64 offset:136
    ds_read_b64_tr_b16 v[202:203], v64 offset:1288
    ds_read_b64_tr_b16 v[204:205], v64 offset:192
    ds_read_b64_tr_b16 v[206:207], v64 offset:1344
    ds_read_b64_tr_b16 v[208:209], v64 offset:200
    ds_read_b64_tr_b16 v[210:211], v64 offset:1352
    ds_read_b64_tr_b16 v[212:213], v65 offset:0
    ds_read_b64_tr_b16 v[214:215], v65 offset:1152
    s_cmp_eq_u32 s65, 0
    s_cbranch_scc1 L_nocs_72
    v_mov_b32 v68, 0x3f803f80
    v_mov_b32 v69, 0x3f803f80
    v_mov_b32 v70, 0x3f803f80
    v_mov_b32 v71, 0x3f803f80
    s_waitcnt lgkmcnt(15)
    s_nop 0
    v_mfma_f32_16x16x32_bf16 v[72:75], v[180:183], v[68:71], 0
    s_waitcnt lgkmcnt(14)
    v_mfma_f32_16x16x32_bf16 v[76:79], v[184:187], v[68:71], 0
    s_waitcnt lgkmcnt(12)
    v_mfma_f32_16x16x32_bf16 v[80:83], v[188:191], v[68:71], 0
    s_waitcnt lgkmcnt(10)
    v_mfma_f32_16x16x32_bf16 v[84:87], v[192:195], v[68:71], 0
    s_waitcnt lgkmcnt(8)
    v_mfma_f32_16x16x32_bf16 v[88:91], v[196:199], v[68:71], 0
    s_waitcnt lgkmcnt(6)
    v_mfma_f32_16x16x32_bf16 v[92:95], v[200:203], v[68:71], 0
    s_waitcnt lgkmcnt(4)
    v_mfma_f32_16x16x32_bf16 v[96:99], v[204:207], v[68:71], 0
    s_waitcnt lgkmcnt(2)
    v_mfma_f32_16x16x32_bf16 v[100:103], v[208:211], v[68:71], 0
    s_waitcnt lgkmcnt(0)
    v_mfma_f32_16x16x32_bf16 v[104:107], v[212:215], v[68:71], 0
    v_and_b32 v66, 15, v1
    v_add_u32 v67, 1, v66
    v_cmp_gt_u32 vcc, 8, v66
    v_and_b32 v64, 48, v1
    s_nop 0
    v_cndmask_b32 v67, 0, v67, vcc
    v_lshlrev_b32 v67, 6, v67
    v_add_u32 v67, v67, v64
    v_cmp_eq_u32 vcc, 1, v66
    s_nop 1
    v_cndmask_b32 v72, v72, v76, vcc
    v_cndmask_b32 v73, v73, v77, vcc
    v_cndmask_b32 v74, v74, v78, vcc
    v_cndmask_b32 v75, v75, v79, vcc
    v_cmp_eq_u32 vcc, 2, v66
    s_nop 1
    v_cndmask_b32 v72, v72, v80, vcc
    v_cndmask_b32 v73, v73, v81, vcc
    v_cndmask_b32 v74, v74, v82, vcc
    v_cndmask_b32 v75, v75, v83, vcc
    v_cmp_eq_u32 vcc, 3, v66
    s_nop 1
    v_cndmask_b32 v72, v72, v84, vcc
    v_cndmask_b32 v73, v73, v85, vcc
    v_cndmask_b32 v74, v74, v86, vcc
    v_cndmask_b32 v75, v75, v87, vcc
    v_cmp_eq_u32 vcc, 4, v66
    s_nop 1
    v_cndmask_b32 v72, v72, v88, vcc
    v_cndmask_b32 v73, v73, v89, vcc
    v_cndmask_b32 v74, v74, v90, vcc
    v_cndmask_b32 v75, v75, v91, vcc
    v_cmp_eq_u32 vcc, 5, v66
    s_nop 1
    v_cndmask_b32 v72, v72, v92, vcc
    v_cndmask_b32 v73, v73, v93, vcc
    v_cndmask_b32 v74, v74, v94, vcc
    v_cndmask_b32 v75, v75, v95, vcc
    v_cmp_eq_u32 vcc, 6, v66
    s_nop 1
    v_cndmask_b32 v72, v72, v96, vcc
    v_cndmask_b32 v73, v73, v97, vcc
    v_cndmask_b32 v74, v74, v98, vcc
    v_cndmask_b32 v75, v75, v99, vcc
    v_cmp_eq_u32 vcc, 7, v66
    s_nop 1
    v_cndmask_b32 v72, v72, v100, vcc
    v_cndmask_b32 v73, v73, v101, vcc
    v_cndmask_b32 v74, v74, v102, vcc
    v_cndmask_b32 v75, v75, v103, vcc
    v_cmp_eq_u32 vcc, 8, v66
    s_nop 1
    v_cndmask_b32 v72, v72, v104, vcc
    v_cndmask_b32 v73, v73, v105, vcc
    v_cndmask_b32 v74, v74, v106, vcc
    v_cndmask_b32 v75, v75, v107, vcc
    s_mov_b32 exec_lo, 0x01ff01ff
    s_mov_b32 exec_hi, 0x01ff01ff
    buffer_store_dwordx4 v[72:75], v67, s[4:7], s65 offen sc1
    s_mov_b64 exec, -1
L_nocs_72:
    v_mov_b32 v8, s98
    v_mov_b32 v9, s99
    s_waitcnt vmcnt(0)
    s_mov_b64 exec, 1
    buffer_store_dwordx2 v[8:9], off, s[4:7], s44 sc1
    s_mov_b64 exec, -1
    s_waitcnt lgkmcnt(15)
    buffer_store_dwordx4 v[180:183], v2, s[4:7], s67 offen sc1
    s_add_u32 s92, s67, s70
    s_waitcnt lgkmcnt(14)
    buffer_store_dwordx4 v[184:187], v2, s[4:7], s92 offen sc1
    s_add_u32 s92, s67, s71
    s_waitcnt lgkmcnt(12)
    buffer_store_dwordx4 v[188:191], v2, s[4:7], s92 offen sc1
    s_add_u32 s92, s92, s70
    s_waitcnt lgkmcnt(10)
    buffer_store_dwordx4 v[192:195], v2, s[4:7], s92 offen sc1
    s_waitcnt lgkmcnt(8)
    buffer_store_dwordx4 v[196:199], v2, s[4:7], s68 offen sc1
    s_add_u32 s92, s68, s70
    s_waitcnt lgkmcnt(6)
    buffer_store_dwordx4 v[200:203], v2, s[4:7], s92 offen sc1
    s_add_u32 s92, s68, s71
    s_waitcnt lgkmcnt(4)
    buffer_store_dwordx4 v[204:207], v2, s[4:7], s92 offen sc1
    s_add_u32 s92, s92, s70
    s_waitcnt lgkmcnt(2)
    buffer_store_dwordx4 v[208:211], v2, s[4:7], s92 offen sc1
    s_waitcnt lgkmcnt(0)
    buffer_store_dwordx4 v[212:215], v2, s[4:7], s69 offen sc1
    s_mov_b32 s0, s66
    s_and_b32 s23, s21, 7
    s_lshl_b32 s23, s23, 2
    s_and_b32 s1, s22, 3
    s_add_u32 s1, s1, s23
    s_lshl_b32 s1, s1, 9
    s_add_u32 s1, s1, 4071424
    v_min_u32 v14, 35, v1
    v_lshlrev_b32 v14, 3, v14
    buffer_load_dwordx2 v[12:13], v14, s[4:7], s1 offen sc1
L_ffn_49:
    s_barrier
    s_lshr_b32 s44, s22, 2
    s_and_b32 s60, s21, 0
    s_add_u32 s44, s44, s60
    s_and_b32 s60, s21, 7
    s_lshl_b32 s60, s60, 2
    s_and_b32 s47, s22, 3
    s_add_u32 s47, s47, s60
    s_lshl_b32 s64, s47, 9
    s_add_u32 s64, s64, 4071424
    s_lshr_b32 s45, s47, 2
    s_and_b32 s46, s47, 3
    s_mul_i32 s48, s47, 497664
    s_add_u32 s48, s48, 4194304
    s_mul_i32 s63, s20, 9
    s_lshr_b32 s63, s63, 1
    s_lshl_b32 s63, s63, 10
    s_add_u32 s62, s48, s63
    s_mul_i32 s49, s20, 9216
    s_add_u32 s48, s48, s49
    s_lshl_b32 s54, s44, 4
    s_lshl_b32 s60, s20, 2
    s_add_u32 s54, s54, s60
    s_mul_i32 s50, s54, 18432
    s_mul_i32 s53, s45, 2359296
    s_add_u32 s53, s53, s50
    s_add_u32 s50, s50, 4718592
    s_add_u32 s50, s50, s100
    s_lshr_b32 s60, s46, 1
    s_mul_i32 s60, s60, 9216
    s_add_u32 s53, s53, s60
    s_add_u32 s53, s53, 29360128
    s_add_u32 s53, s53, s100
    v_lshlrev_b32 v3, 3, v1
    v_mov_b32 v4, v2
    s_cmp_lg_u32 s101, 0
    s_cbranch_scc1 L_nopw_73
    s_waitcnt vmcnt(0)
    v_cmp_eq_u64 vcc, s[98:99], v[12:13]
    s_nop 0
    s_cmp_eq_u64 vcc, exec
    s_cbranch_scc0 L_pw_slow_52
L_pw_back_53:
L_nopw_73:
    s_add_u32 m0, s49, 0
    s_add_u32 s61, s48, 0
    buffer_load_dwordx4 v2, s[4:7], s61 offen offset:0 lds
    buffer_load_dwordx4 v2, s[4:7], s61 offen offset:1024 lds
    buffer_load_dwordx4 v2, s[4:7], s61 offen offset:2048 lds
    buffer_load_dwordx4 v2, s[4:7], s61 offen offset:3072 lds
    s_add_u32 m0, s49, 4096
    s_add_u32 s61, s48, 4096
    buffer_load_dwordx4 v2, s[4:7], s61 offen offset:0 lds
    buffer_load_dwordx4 v2, s[4:7], s61 offen offset:1024 lds
    buffer_load_dwordx4 v2, s[4:7], s61 offen offset:2048 lds
    buffer_load_dwordx4 v2, s[4:7], s61 offen offset:3072 lds
    s_add_u32 m0, s49, 8192
    s_add_u32 s61, s48, 8192
    buffer_load_dwordx4 v2, s[4:7], s61 offen offset:0 lds
    s_add_u32 m0, s49, 36864
    s_add_u32 s61, s48, 36864
    buffer_load_dwordx4 v2, s[4:7], s61 offen offset:0 lds
    buffer_load_dwordx4 v2, s[4:7], s61 offen offset:1024 lds
    buffer_load_dwordx4 v2, s[4:7], s61 offen offset:2048 lds
    buffer_load_dwordx4 v2, s[4:7], s61 offen offset:3072 lds
    s_add_u32 m0, s49, 40960
    s_add_u32 s61, s48, 40960
    buffer_load_dwordx4 v2, s[4:7], s61 offen offset:0 lds
    buffer_load_dwordx4 v2, s[4:7], s61 offen offset:1024 lds
    buffer_load_dwordx4 v2, s[4:7], s61 offen offset:2048 lds
    buffer_load_dwordx4 v2, s[4:7], s61 offen offset:3072 lds
    s_add_u32 m0, s49, 45056
    s_add_u32 s61, s48, 45056
    buffer_load_dwordx4 v2, s[4:7], s61 offen offset:0 lds
    s_add_u32 m0, s49, 73728
    s_add_u32 s61, s48, 73728
    buffer_load_dwordx4 v2, s[4:7], s61 offen offset:0 lds
    buffer_load_dwordx4 v2, s[4:7], s61 offen offset:1024 lds
    buffer_load_dwordx4 v2, s[4:7], s61 offen offset:2048 lds
    buffer_load_dwordx4 v2, s[4:7], s61 offen offset:3072 lds
    s_add_u32 m0, s49, 77824
    s_add_u32 s61, s48, 77824
    buffer_load_dwordx4 v2, s[4:7], s61 offen offset:0 lds
    buffer_load_dwordx4 v2, s[4:7], s61 offen offset:1024 lds
    buffer_load_dwordx4 v2, s[4:7], s61 offen offset:2048 lds
    buffer_load_dwordx4 v2, s[4:7], s61 offen offset:3072 lds
    s_add_u32 m0, s49, 81920
    s_add_u32 s61, s48, 81920
    buffer_load_dwordx4 v2, s[4:7], s61 offen offset:0 lds
    s_cmp_lg_u32 s101, 0
    s_cbranch_scc1 L_nocs_74
    s_cmp_ge_u32 s20, 2
    s_cbranch_scc1 L_nocs_74
    s_lshl_b32 s60, s47, 1
    s_add_u32 s60, s60, s20
    s_mul_i32 s60, s60, 10368
    s_add_u32 s60, s60, 2883584
    v_lshrrev_b32 v6, 2, v1
    v_lshlrev_b32 v6, 7, v6
    v_and_b32 v7, 3, v1
    v_lshl_add_u32 v6, v7, 4, v6
    s_lshl_b32 s61, s20, 6
    s_add_u32 s61, s61, 147456
    v_add_u32 v6, s61, v6
    s_mov_b32 exec_hi, 15
    buffer_load_dwordx4 v[64:67], v2, s[4:7], s60 offen offset:0 sc1
    buffer_load_dwordx4 v[68:71], v2, s[4:7], s60 offen offset:576 sc1
    buffer_load_dwordx4 v[72:75], v2, s[4:7], s60 offen offset:1152 sc1
    buffer_load_dwordx4 v[76:79], v2, s[4:7], s60 offen offset:1728 sc1
    buffer_load_dwordx4 v[80:83], v2, s[4:7], s60 offen offset:2304 sc1
    buffer_load_dwordx4 v[84:87], v2, s[4:7], s60 offen offset:2880 sc1
    s_add_u32 s60, s60, 3456
    buffer_load_dwordx4 v[88:91], v2, s[4:7], s60 offen offset:0 sc1
    buffer_load_dwordx4 v[92:95], v2, s[4:7], s60 offen offset:576 sc1
    buffer_load_dwordx4 v[96:99], v2, s[4:7], s60 offen offset:1152 sc1
    buffer_load_dwordx4 v[100:103], v2, s[4:7], s60 offen offset:1728 sc1
    buffer_load_dwordx4 v[104:107], v2, s[4:7], s60 offen offset:2304 sc1
    buffer_load_dwordx4 v[108:111], v2, s[4:7], s60 offen offset:2880 sc1
    s_add_u32 s60, s60, 3456
    buffer_load_dwordx4 v[112:115], v2, s[4:7], s60 offen offset:0 sc1
    buffer_load_dwordx4 v[116:119], v2, s[4:7], s60 offen offset:576 sc1
    buffer_load_dwordx4 v[120:123], v2, s[4:7], s60 offen offset:1152 sc1
    buffer_load_dwordx4 v[124:127], v2, s[4:7], s60 offen offset:1728 sc1
    buffer_load_dwordx4 v[128:131], v2, s[4:7], s60 offen offset:2304 sc1
    buffer_load_dwordx4 v[132:135], v2, s[4:7], s60 offen offset:2880 sc1
    s_waitcnt vmcnt(16)
    v_add_f32 v64, v64, v68
    v_add_f32 v65, v65, v69
    v_add_f32 v66, v66, v70
    v_add_f32 v67, v67, v71
    s_waitcnt vmcnt(15)
    v_add_f32 v64, v64, v72
    v_add_f32 v65, v65, v73
    v_add_f32 v66, v66, v74
    v_add_f32 v67, v67, v75
    s_waitcnt vmcnt(14)
    v_add_f32 v64, v64, v76
    v_add_f32 v65, v65, v77
    v_add_f32 v66, v66, v78
    v_add_f32 v67, v67, v79
    s_waitcnt vmcnt(13)
    v_add_f32 v64, v64, v80
    v_add_f32 v65, v65, v81
    v_add_f32 v66, v66, v82
    v_add_f32 v67, v67, v83
    s_waitcnt vmcnt(12)
    v_add_f32 v64, v64, v84
    v_add_f32 v65, v65, v85
    v_add_f32 v66, v66, v86
    v_add_f32 v67, v67, v87
    s_waitcnt vmcnt(11)
    v_add_f32 v64, v64, v88
    v_add_f32 v65, v65, v89
    v_add_f32 v66, v66, v90
    v_add_f32 v67, v67, v91
    s_waitcnt vmcnt(10)
    v_add_f32 v64, v64, v92
    v_add_f32 v65, v65, v93
    v_add_f32 v66, v66, v94
    v_add_f32 v67, v67, v95
    s_waitcnt vmcnt(9)
    v_add_f32 v64, v64, v96
    v_add_f32 v65, v65, v97
    v_add_f32 v66, v66, v98
    v_add_f32 v67, v67, v99
    s_waitcnt vmcnt(8)
    v_add_f32 v64, v64, v100
    v_add_f32 v65, v65, v101
    v_add_f32 v66, v66, v102
    v_add_f32 v67, v67, v103
    s_waitcnt vmcnt(7)
    v_add_f32 v64, v64, v104
    v_add_f32 v65, v65, v105
    v_add_f32 v66, v66, v106
    v_add_f32 v67, v67, v107
    s_waitcnt vmcnt(6)
    v_add_f32 v64, v64, v108
    v_add_f32 v65, v65, v109
    v_add_f32 v66, v66, v110
    v_add_f32 v67, v67, v111
    s_waitcnt vmcnt(5)
    v_add_f32 v64, v64, v112
    v_add_f32 v65, v65, v113
    v_add_f32 v66, v66, v114
    v_add_f32 v67, v67, v115
    s_waitcnt vmcnt(4)
    v_add_f32 v64, v64, v116
    v_add_f32 v65, v65, v117
    v_add_f32 v66, v66, v118
    v_add_f32 v67, v67, v119
    s_waitcnt vmcnt(3)
    v_add_f32 v64, v64, v120
    v_add_f32 v65, v65, v121
    v_add_f32 v66, v66, v122
    v_add_f32 v67, v67, v123
    s_waitcnt vmcnt(2)
    v_add_f32 v64, v64, v124
    v_add_f32 v65, v65, v125
    v_add_f32 v66, v66, v126
    v_add_f32 v67, v67, v127
    s_waitcnt vmcnt(1)
    v_add_f32 v64, v64, v128
    v_add_f32 v65, v65, v129
    v_add_f32 v66, v66, v130
    v_add_f32 v67, v67, v131
    s_waitcnt vmcnt(0)
    v_add_f32 v64, v64, v132
    v_add_f32 v65, v65, v133
    v_add_f32 v66, v66, v134
    v_add_f32 v67, v67, v135
    ds_write_b128 v6, v[64:67]
    s_mov_b64 exec, -1
    s_waitcnt lgkmcnt(0)
L_nocs_74:
    s_lshr_b32 s60, s54, 2
    s_lshl_b32 s60, s60, 8
    s_add_u32 s55, s101, 3964928
    v_and_b32 v7, 7, v1
    v_min_u32 v7, 5, v7
    v_and_b32 v6, 24, v1
    v_add_lshl_u32 v0, v7, v6, 3
    v_add_u32 v0, s60, v0
    s_lshl_b32 s60, s21, 4
    s_lshr_b32 s61, s22, 1
    s_add_u32 s60, s60, s61
    s_lshl_b32 s60, s60, 6
    v_lshl_add_u32 v7, v7, 3, s60
    v_cmp_gt_u32 vcc, 32, v1
    s_nop 1
    v_cndmask_b32 v0, v7, v0, vcc
    buffer_load_dwordx2 v[168:169], v0, s[4:7], s55 offen sc1
    s_lshl_b32 s60, s44, 5
    s_add_u32 s60, s60, s47
    s_mul_i32 s51, s60, 73728
    s_add_u32 s51, s51, 9699328
    s_add_u32 s51, s51, s100
    s_xor_b32 s61, s60, 1
    s_mul_i32 s56, s61, 73728
    s_add_u32 s56, s56, 9699328
    s_add_u32 s56, s56, s100
    s_xor_b32 s61, s60, 2
    s_mul_i32 s57, s61, 73728
    s_add_u32 s57, s57, 9699328
    s_add_u32 s57, s57, s100
    s_xor_b32 s61, s60, 3
    s_mul_i32 s58, s61, 73728
    s_add_u32 s58, s58, 9699328
    s_add_u32 s58, s58, s100
    s_lshr_b32 s52, s60, 2
    s_lshl_b32 s52, s52, 2
    s_add_u32 s52, s52, s20
    s_lshl_b32 s52, s52, 7
    s_lshl_b32 s61, s101, 2
    s_add_u32 s52, s52, s61
    s_add_u32 s52, s52, 3981312
    v_lshrrev_b32 v5, 4, v1
    v_lshlrev_b32 v5, 4, v5
    v_add_u32 v5, 147456, v5
    s_lshl_b32 s60, s20, 12
    s_add_u32 s51, s51, s60
    s_add_u32 s56, s56, s60
    s_add_u32 s57, s57, s60
    s_add_u32 s58, s58, s60
    s_lshl_b32 s65, s20, 11
    s_sub_u32 s65, 65536, s65
    s_lshl_b32 s67, s46, 3
    s_add_u32 s67, s67, s52
    s_waitcnt vmcnt(1)
    s_barrier
    ds_read_b128 v[8:11], v4 offset:0
    ds_read_b128 v[12:15], v4 offset:1024
    ds_read_b128 v[16:19], v4 offset:36864
    ds_read_b128 v[20:23], v4 offset:37888
    s_and_b32 s61, s22, 3
    s_mul_i32 s61, s61, 18432
    s_add_u32 s61, s61, s50
    s_waitcnt vmcnt(0)
    v_cmp_eq_u64 vcc, s[98:99], v[168:169]
    s_nop 0
    s_cmp_eq_u64 vcc, exec
    s_cbranch_scc0 L_p1_slow_75
L_p1_back_76:
    s_cmp_eq_u32 s0, 0
    s_cbranch_scc1 L_nopend_78
    v_mov_b32 v6, s98
    v_mov_b32 v7, s99
    s_mov_b64 exec, 1
    buffer_store_dwordx2 v[6:7], off, s[4:7], s0 sc1
    s_mov_b64 exec, -1
    s_mov_b32 s0, 0
L_nopend_78:
    s_add_u32 s59, s50, 0
    buffer_load_dwordx4 a[0:3], v2, s[4:7], s59 offen offset:0 sc1
    s_add_u32 s66, s50, 18432
    buffer_load_dwordx4 a[4:7], v2, s[4:7], s66 offen offset:0 sc1
    s_add_u32 s68, s50, 36864
    buffer_load_dwordx4 a[8:11], v2, s[4:7], s68 offen offset:0 sc1
    s_add_u32 s69, s50, 55296
    buffer_load_dwordx4 a[12:15], v2, s[4:7], s69 offen offset:0 sc1
    buffer_load_dwordx4 a[16:19], v2, s[4:7], s59 offen offset:1024 sc1
    buffer_load_dwordx4 a[20:23], v2, s[4:7], s66 offen offset:1024 sc1
    buffer_load_dwordx4 a[24:27], v2, s[4:7], s68 offen offset:1024 sc1
    buffer_load_dwordx4 a[28:31], v2, s[4:7], s69 offen offset:1024 sc1
    s_lshl_b32 s60, s54, 4
    v_add_u32 v6, s60, v1
    v_lshlrev_b32 v6, 3, v6
    s_add_u32 s55, s100, 7077888
    s_add_u32 s60, s55, 0
    buffer_load_dwordx2 v[152:153], v6, s[4:7], s60 offen sc1
    s_add_u32 s60, s55, 16384
    buffer_load_dwordx2 v[154:155], v6, s[4:7], s60 offen sc1
    s_add_u32 s60, s55, 32768
    buffer_load_dwordx2 v[156:157], v6, s[4:7], s60 offen sc1
    s_add_u32 s60, s55, 49152
    buffer_load_dwordx2 v[158:159], v6, s[4:7], s60 offen sc1
    s_add_u32 s60, s55, 65536
    buffer_load_dwordx2 v[160:161], v6, s[4:7], s60 offen sc1
    s_add_u32 s60, s55, 81920
    buffer_load_dwordx2 v[162:163], v6, s[4:7], s60 offen sc1
    v_add_u32 v7, 0x10000, v2
    buffer_load_dwordx4 a[32:35], v2, s[4:7], s59 offen offset:2048 sc1
    buffer_load_dwordx4 a[36:39], v2, s[4:7], s66 offen offset:2048 sc1
    buffer_load_dwordx4 a[40:43], v2, s[4:7], s68 offen offset:2048 sc1
    buffer_load_dwordx4 a[44:47], v2, s[4:7], s69 offen offset:2048 sc1
    s_waitcnt vmcnt(17) lgkmcnt(3)
    v_mfma_f32_16x16x32_bf16 v[208:211], v[8:11], a[0:3], 0
    s_waitcnt vmcnt(16)
    ds_read_b128 v[24:27], v7 offset:8192
    v_mfma_f32_16x16x32_bf16 v[212:215], v[8:11], a[4:7], 0
    s_waitcnt vmcnt(15)
    v_mfma_f32_16x16x32_bf16 v[216:219], v[8:11], a[8:11], 0
    s_waitcnt vmcnt(14)
    v_mfma_f32_16x16x32_bf16 v[220:223], v[8:11], a[12:15], 0
    s_waitcnt lgkmcnt(3)
    v_mfma_f32_16x16x32_bf16 v[224:227], v[12:15], a[0:3], 0
    ds_read_b128 v[28:31], v7 offset:9216
    v_mfma_f32_16x16x32_bf16 v[228:231], v[12:15], a[4:7], 0
    buffer_load_dwordx4 a[48:51], v2, s[4:7], s59 offen offset:3072 sc1
    v_mfma_f32_16x16x32_bf16 v[232:235], v[12:15], a[8:11], 0
    v_mfma_f32_16x16x32_bf16 v[236:239], v[12:15], a[12:15], 0
    s_waitcnt lgkmcnt(3)
    v_mfma_f32_16x16x32_bf16 v[64:67], v[16:19], a[0:3], 0
    ds_read_b128 v[8:11], v4 offset:2048
    v_mfma_f32_16x16x32_bf16 v[68:71], v[16:19], a[4:7], 0
    buffer_load_dwordx4 a[52:55], v2, s[4:7], s66 offen offset:3072 sc1
    v_mfma_f32_16x16x32_bf16 v[72:75], v[16:19], a[8:11], 0
    v_mfma_f32_16x16x32_bf16 v[76:79], v[16:19], a[12:15], 0
    buffer_load_dwordx4 a[56:59], v2, s[4:7], s68 offen offset:3072 sc1
    buffer_load_dwordx4 a[60:63], v2, s[4:7], s69 offen offset:3072 sc1
    s_waitcnt lgkmcnt(3)
    v_mfma_f32_16x16x32_bf16 v[80:83], v[20:23], a[0:3], 0
    s_add_u32 s59, s50, 4096
    ds_read_b128 v[12:15], v4 offset:3072
    v_mfma_f32_16x16x32_bf16 v[84:87], v[20:23], a[4:7], 0
    v_mfma_f32_16x16x32_bf16 v[88:91], v[20:23], a[8:11], 0
    v_mfma_f32_16x16x32_bf16 v[92:95], v[20:23], a[12:15], 0
    s_waitcnt lgkmcnt(3)
    v_mfma_f32_16x16x32_bf16 v[96:99], v[24:27], a[0:3], 0
    ds_read_b128 v[16:19], v4 offset:38912
    v_mfma_f32_16x16x32_bf16 v[100:103], v[24:27], a[4:7], 0
    buffer_load_dwordx4 a[64:67], v2, s[4:7], s59 offen offset:0 sc1
    v_mfma_f32_16x16x32_bf16 v[104:107], v[24:27], a[8:11], 0
    s_add_u32 s66, s50, 22528
    v_mfma_f32_16x16x32_bf16 v[108:111], v[24:27], a[12:15], 0
    s_waitcnt lgkmcnt(3)
    v_mfma_f32_16x16x32_bf16 v[112:115], v[28:31], a[0:3], 0
    ds_read_b128 v[20:23], v4 offset:39936
    v_mfma_f32_16x16x32_bf16 v[116:119], v[28:31], a[4:7], 0
    buffer_load_dwordx4 a[68:71], v2, s[4:7], s66 offen offset:0 sc1
    v_mfma_f32_16x16x32_bf16 v[120:123], v[28:31], a[8:11], 0
    s_add_u32 s68, s50, 40960
    v_mfma_f32_16x16x32_bf16 v[124:127], v[28:31], a[12:15], 0
    s_waitcnt vmcnt(19) lgkmcnt(3)
    v_mfma_f32_16x16x32_bf16 v[208:211], v[8:11], a[16:19], v[208:211]
    s_waitcnt vmcnt(18)
    ds_read_b128 v[24:27], v7 offset:10240
    v_mfma_f32_16x16x32_bf16 v[212:215], v[8:11], a[20:23], v[212:215]
    buffer_load_dwordx4 a[72:75], v2, s[4:7], s68 offen offset:0 sc1
    s_waitcnt vmcnt(18)
    v_mfma_f32_16x16x32_bf16 v[216:219], v[8:11], a[24:27], v[216:219]
    s_waitcnt vmcnt(17)
    s_add_u32 s69, s50, 59392
    v_mfma_f32_16x16x32_bf16 v[220:223], v[8:11], a[28:31], v[220:223]
    s_waitcnt lgkmcnt(3)
    v_mfma_f32_16x16x32_bf16 v[224:227], v[12:15], a[16:19], v[224:227]
    ds_read_b128 v[28:31], v7 offset:11264
    v_mfma_f32_16x16x32_bf16 v[228:231], v[12:15], a[20:23], v[228:231]
    buffer_load_dwordx4 a[76:79], v2, s[4:7], s69 offen offset:0 sc1
    v_mfma_f32_16x16x32_bf16 v[232:235], v[12:15], a[24:27], v[232:235]
    v_mfma_f32_16x16x32_bf16 v[236:239], v[12:15], a[28:31], v[236:239]
    s_waitcnt lgkmcnt(3)
    v_mfma_f32_16x16x32_bf16 v[64:67], v[16:19], a[16:19], v[64:67]
    ds_read_b128 v[8:11], v4 offset:4096
    v_mfma_f32_16x16x32_bf16 v[68:71], v[16:19], a[20:23], v[68:71]
    buffer_load_dwordx4 a[80:83], v2, s[4:7], s59 offen offset:1024 sc1
    v_mfma_f32_16x16x32_bf16 v[72:75], v[16:19], a[24:27], v[72:75]
    v_mfma_f32_16x16x32_bf16 v[76:79], v[16:19], a[28:31], v[76:79]
    s_waitcnt lgkmcnt(3)
    v_mfma_f32_16x16x32_bf16 v[80:83], v[20:23], a[16:19], v[80:83]
    ds_read_b128 v[12:15], v4 offset:5120
    v_mfma_f32_16x16x32_bf16 v[84:87], v[20:23], a[20:23], v[84:87]
    buffer_load_dwordx4 a[84:87], v2, s[4:7], s66 offen offset:1024 sc1
    v_mfma_f32_16x16x32_bf16 v[88:91], v[20:23], a[24:27], v[88:91]
    v_mfma_f32_16x16x32_bf16 v[92:95], v[20:23], a[28:31], v[92:95]
    s_waitcnt lgkmcnt(3)
    v_mfma_f32_16x16x32_bf16 v[96:99], v[24:27], a[16:19], v[96:99]
    ds_read_b128 v[16:19], v4 offset:40960
    v_mfma_f32_16x16x32_bf16 v[100:103], v[24:27], a[20:23], v[100:103]
    buffer_load_dwordx4 a[88:91], v2, s[4:7], s68 offen offset:1024 sc1
    v_mfma_f32_16x16x32_bf16 v[104:107], v[24:27], a[24:27], v[104:107]
    v_mfma_f32_16x16x32_bf16 v[108:111], v[24:27], a[28:31], v[108:111]
    s_waitcnt lgkmcnt(3)
    v_mfma_f32_16x16x32_bf16 v[112:115], v[28:31], a[16:19], v[112:115]
    ds_read_b128 v[20:23], v4 offset:41984
    v_mfma_f32_16x16x32_bf16 v[116:119], v[28:31], a[20:23], v[116:119]
    buffer_load_dwordx4 a[92:95], v2, s[4:7], s69 offen offset:1024 sc1
    v_mfma_f32_16x16x32_bf16 v[120:123], v[28:31], a[24:27], v[120:123]
    v_mfma_f32_16x16x32_bf16 v[124:127], v[28:31], a[28:31], v[124:127]
    s_waitcnt vmcnt(15) lgkmcnt(3)
    v_mfma_f32_16x16x32_bf16 v[208:211], v[8:11], a[32:35], v[208:211]
    s_waitcnt vmcnt(14)
    ds_read_b128 v[24:27], v7 offset:12288
    v_mfma_f32_16x16x32_bf16 v[212:215], v[8:11], a[36:39], v[212:215]
    buffer_load_dwordx4 a[96:99], v2, s[4:7], s59 offen offset:2048 sc1
    s_waitcnt vmcnt(14)
    v_mfma_f32_16x16x32_bf16 v[216:219], v[8:11], a[40:43], v[216:219]
    s_waitcnt vmcnt(13)
    v_mfma_f32_16x16x32_bf16 v[220:223], v[8:11], a[44:47], v[220:223]
    s_waitcnt lgkmcnt(3)
    v_mfma_f32_16x16x32_bf16 v[224:227], v[12:15], a[32:35], v[224:227]
    ds_read_b128 v[28:31], v7 offset:13312
    v_mfma_f32_16x16x32_bf16 v[228:231], v[12:15], a[36:39], v[228:231]
    buffer_load_dwordx4 a[100:103], v2, s[4:7], s66 offen offset:2048 sc1
    v_mfma_f32_16x16x32_bf16 v[232:235], v[12:15], a[40:43], v[232:235]
    v_mfma_f32_16x16x32_bf16 v[236:239], v[12:15], a[44:47], v[236:239]
    s_waitcnt lgkmcnt(3)
    v_mfma_f32_16x16x32_bf16 v[64:67], v[16:19], a[32:35], v[64:67]
    ds_read_b128 v[8:11], v4 offset:6144
    v_mfma_f32_16x16x32_bf16 v[68:71], v[16:19], a[36:39], v[68:71]
    buffer_load_dwordx4 a[104:107], v2, s[4:7], s68 offen offset:2048 sc1
    v_mfma_f32_16x16x32_bf16 v[72:75], v[16:19], a[40:43], v[72:75]
    v_mfma_f32_16x16x32_bf16 v[76:79], v[16:19], a[44:47], v[76:79]
    s_waitcnt lgkmcnt(3)
    v_mfma_f32_16x16x32_bf16 v[80:83], v[20:23], a[32:35], v[80:83]
    ds_read_b128 v[12:15], v4 offset:7168
    v_mfma_f32_16x16x32_bf16 v[84:87], v[20:23], a[36:39], v[84:87]
    buffer_load_dwordx4 a[108:111], v2, s[4:7], s69 offen offset:2048 sc1
    v_mfma_f32_16x16x32_bf16 v[88:91], v[20:23], a[40:43], v[88:91]
    v_mfma_f32_16x16x32_bf16 v[92:95], v[20:23], a[44:47], v[92:95]
    s_waitcnt lgkmcnt(3)
    v_mfma_f32_16x16x32_bf16 v[96:99], v[24:27], a[32:35], v[96:99]
    ds_read_b128 v[16:19], v4 offset:43008
    v_mfma_f32_16x16x32_bf16 v[100:103], v[24:27], a[36:39], v[100:103]
    buffer_load_dwordx4 a[112:115], v2, s[4:7], s59 offen offset:3072 sc1
    v_mfma_f32_16x16x32_bf16 v[104:107], v[24:27], a[40:43], v[104:107]
    v_mfma_f32_16x16x32_bf16 v[108:111], v[24:27], a[44:47], v[108:111]
    s_waitcnt lgkmcnt(3)
    v_mfma_f32_16x16x32_bf16 v[112:115], v[28:31], a[32:35], v[112:115]
    ds_read_b128 v[20:23], v4 offset:44032
    v_mfma_f32_16x16x32_bf16 v[116:119], v[28:31], a[36:39], v[116:119]
    buffer_load_dwordx4 a[116:119], v2, s[4:7], s66 offen offset:3072 sc1
    v_mfma_f32_16x16x32_bf16 v[120:123], v[28:31], a[40:43], v[120:123]
    v_mfma_f32_16x16x32_bf16 v[124:127], v[28:31], a[44:47], v[124:127]
    s_waitcnt vmcnt(17) lgkmcnt(3)
    v_mfma_f32_16x16x32_bf16 v[208:211], v[8:11], a[48:51], v[208:211]
    s_waitcnt vmcnt(16)
    ds_read_b128 v[24:27], v7 offset:14336
    v_mfma_f32_16x16x32_bf16 v[212:215], v[8:11], a[52:55], v[212:215]
    buffer_load_dwordx4 a[120:123], v2, s[4:7], s68 offen offset:3072 sc1
    s_waitcnt vmcnt(16)
    v_mfma_f32_16x16x32_bf16 v[216:219], v[8:11], a[56:59], v[216:219]
    s_waitcnt vmcnt(15)
    v_mfma_f32_16x16x32_bf16 v[220:223], v[8:11], a[60:63], v[220:223]
    s_waitcnt lgkmcnt(3)
    v_mfma_f32_16x16x32_bf16 v[224:227], v[12:15], a[48:51], v[224:227]
    ds_read_b128 v[28:31], v7 offset:15360
    v_mfma_f32_16x16x32_bf16 v[228:231], v[12:15], a[52:55], v[228:231]
    buffer_load_dwordx4 a[124:127], v2, s[4:7], s69 offen offset:3072 sc1
    v_mfma_f32_16x16x32_bf16 v[232:235], v[12:15], a[56:59], v[232:235]
    s_add_u32 s59, s50, 8192
    v_mfma_f32_16x16x32_bf16 v[236:239], v[12:15], a[60:63], v[236:239]
    s_waitcnt lgkmcnt(3)
    v_mfma_f32_16x16x32_bf16 v[64:67], v[16:19], a[48:51], v[64:67]
    ds_read_b128 v[8:11], v4 offset:8192
    v_mfma_f32_16x16x32_bf16 v[68:71], v[16:19], a[52:55], v[68:71]
    buffer_load_dwordx4 a[128:131], v2, s[4:7], s59 offen offset:0 sc1
    v_mfma_f32_16x16x32_bf16 v[72:75], v[16:19], a[56:59], v[72:75]
    s_add_u32 s66, s50, 26624
    v_mfma_f32_16x16x32_bf16 v[76:79], v[16:19], a[60:63], v[76:79]
    s_waitcnt lgkmcnt(3)
    v_mfma_f32_16x16x32_bf16 v[80:83], v[20:23], a[48:51], v[80:83]
    ds_read_b128 v[12:15], v4 offset:9216
    v_mfma_f32_16x16x32_bf16 v[84:87], v[20:23], a[52:55], v[84:87]
    buffer_load_dwordx4 a[132:135], v2, s[4:7], s66 offen offset:0 sc1
    v_mfma_f32_16x16x32_bf16 v[88:91], v[20:23], a[56:59], v[88:91]
    s_add_u32 s68, s50, 45056
    v_mfma_f32_16x16x32_bf16 v[92:95], v[20:23], a[60:63], v[92:95]
    s_waitcnt lgkmcnt(3)
    v_mfma_f32_16x16x32_bf16 v[96:99], v[24:27], a[48:51], v[96:99]
    ds_read_b128 v[16:19], v4 offset:45056
    v_mfma_f32_16x16x32_bf16 v[100:103], v[24:27], a[52:55], v[100:103]
    buffer_load_dwordx4 a[136:139], v2, s[4:7], s68 offen offset:0 sc1
    v_mfma_f32_16x16x32_bf16 v[104:107], v[24:27], a[56:59], v[104:107]
    s_add_u32 s69, s50, 63488
    v_mfma_f32_16x16x32_bf16 v[108:111], v[24:27], a[60:63], v[108:111]
    s_waitcnt lgkmcnt(3)
    v_mfma_f32_16x16x32_bf16 v[112:115], v[28:31], a[48:51], v[112:115]
    ds_read_b128 v[20:23], v4 offset:46080
    v_mfma_f32_16x16x32_bf16 v[116:119], v[28:31], a[52:55], v[116:119]
    buffer_load_dwordx4 a[140:143], v2, s[4:7], s69 offen offset:0 sc1
    v_mfma_f32_16x16x32_bf16 v[120:123], v[28:31], a[56:59], v[120:123]
    v_mfma_f32_16x16x32_bf16 v[124:127], v[28:31], a[60:63], v[124:127]
    s_waitcnt vmcnt(19) lgkmcnt(3)
    v_mfma_f32_16x16x32_bf16 v[208:211], v[8:11], a[64:67], v[208:211]
    s_waitcnt vmcnt(18)
    ds_read_b128 v[24:27], v7 offset:16384
    v_mfma_f32_16x16x32_bf16 v[212:215], v[8:11], a[68:71], v[212:215]
    buffer_load_dwordx4 a[144:147], v2, s[4:7], s59 offen offset:1024 sc1
    s_waitcnt vmcnt(18)
    v_mfma_f32_16x16x32_bf16 v[216:219], v[8:11], a[72:75], v[216:219]
    s_waitcnt vmcnt(17)
    v_mfma_f32_16x16x32_bf16 v[220:223], v[8:11], a[76:79], v[220:223]
    s_waitcnt lgkmcnt(3)
    v_mfma_f32_16x16x32_bf16 v[224:227], v[12:15], a[64:67], v[224:227]
    ds_read_b128 v[28:31], v7 offset:17408
    v_mfma_f32_16x16x32_bf16 v[228:231], v[12:15], a[68:71], v[228:231]
    buffer_load_dwordx4 a[148:151], v2, s[4:7], s66 offen offset:1024 sc1
    v_mfma_f32_16x16x32_bf16 v[232:235], v[12:15], a[72:75], v[232:235]
    v_mfma_f32_16x16x32_bf16 v[236:239], v[12:15], a[76:79], v[236:239]
    s_waitcnt lgkmcnt(3)
    v_mfma_f32_16x16x32_bf16 v[64:67], v[16:19], a[64:67], v[64:67]
    ds_read_b128 v[8:11], v4 offset:10240
    v_mfma_f32_16x16x32_bf16 v[68:71], v[16:19], a[68:71], v[68:71]
    buffer_load_dwordx4 a[152:155], v2, s[4:7], s68 offen offset:1024 sc1
    v_mfma_f32_16x16x32_bf16 v[72:75], v[16:19], a[72:75], v[72:75]
    v_mfma_f32_16x16x32_bf16 v[76:79], v[16:19], a[76:79], v[76:79]
    s_waitcnt lgkmcnt(3)
    v_mfma_f32_16x16x32_bf16 v[80:83], v[20:23], a[64:67], v[80:83]
    ds_read_b128 v[12:15], v4 offset:11264
    v_mfma_f32_16x16x32_bf16 v[84:87], v[20:23], a[68:71], v[84:87]
    buffer_load_dwordx4 a[156:159], v2, s[4:7], s69 offen offset:1024 sc1
    v_mfma_f32_16x16x32_bf16 v[88:91], v[20:23], a[72:75], v[88:91]
    v_mfma_f32_16x16x32_bf16 v[92:95], v[20:23], a[76:79], v[92:95]
    s_waitcnt lgkmcnt(3)
    v_mfma_f32_16x16x32_bf16 v[96:99], v[24:27], a[64:67], v[96:99]
    ds_read_b128 v[16:19], v4 offset:47104
    v_mfma_f32_16x16x32_bf16 v[100:103], v[24:27], a[68:71], v[100:103]
    buffer_load_dwordx4 a[160:163], v2, s[4:7], s59 offen offset:2048 sc1
    v_mfma_f32_16x16x32_bf16 v[104:107], v[24:27], a[72:75], v[104:107]
    v_mfma_f32_16x16x32_bf16 v[108:111], v[24:27], a[76:79], v[108:111]
    s_waitcnt lgkmcnt(3)
    v_mfma_f32_16x16x32_bf16 v[112:115], v[28:31], a[64:67], v[112:115]
    ds_read_b128 v[20:23], v4 offset:48128
    v_mfma_f32_16x16x32_bf16 v[116:119], v[28:31], a[68:71], v[116:119]
    buffer_load_dwordx4 a[164:167], v2, s[4:7], s66 offen offset:2048 sc1
    v_mfma_f32_16x16x32_bf16 v[120:123], v[28:31], a[72:75], v[120:123]
    v_mfma_f32_16x16x32_bf16 v[124:127], v[28:31], a[76:79], v[124:127]
    s_waitcnt vmcnt(21) lgkmcnt(3)
    v_mfma_f32_16x16x32_bf16 v[208:211], v[8:11], a[80:83], v[208:211]
    s_waitcnt vmcnt(20)
    ds_read_b128 v[24:27], v7 offset:18432
    v_mfma_f32_16x16x32_bf16 v[212:215], v[8:11], a[84:87], v[212:215]
    buffer_load_dwordx4 a[168:171], v2, s[4:7], s68 offen offset:2048 sc1
    s_waitcnt vmcnt(20)
    v_mfma_f32_16x16x32_bf16 v[216:219], v[8:11], a[88:91], v[216:219]
    s_waitcnt vmcnt(19)
    v_mfma_f32_16x16x32_bf16 v[220:223], v[8:11], a[92:95], v[220:223]
    s_waitcnt lgkmcnt(3)
    v_mfma_f32_16x16x32_bf16 v[224:227], v[12:15], a[80:83], v[224:227]
    ds_read_b128 v[28:31], v7 offset:19456
    v_mfma_f32_16x16x32_bf16 v[228:231], v[12:15], a[84:87], v[228:231]
    buffer_load_dwordx4 a[172:175], v2, s[4:7], s69 offen offset:2048 sc1
    v_mfma_f32_16x16x32_bf16 v[232:235], v[12:15], a[88:91], v[232:235]
    v_mfma_f32_16x16x32_bf16 v[236:239], v[12:15], a[92:95], v[236:239]
    s_waitcnt lgkmcnt(3)
    v_mfma_f32_16x16x32_bf16 v[64:67], v[16:19], a[80:83], v[64:67]
    ds_read_b128 v[8:11], v4 offset:12288
    v_mfma_f32_16x16x32_bf16 v[68:71], v[16:19], a[84:87], v[68:71]
    buffer_load_dwordx4 a[176:179], v2, s[4:7], s59 offen offset:3072 sc1
    v_mfma_f32_16x16x32_bf16 v[72:75], v[16:19], a[88:91], v[72:75]
    v_mfma_f32_16x16x32_bf16 v[76:79], v[16:19], a[92:95], v[76:79]
    s_waitcnt lgkmcnt(3)
    v_mfma_f32_16x16x32_bf16 v[80:83], v[20:23], a[80:83], v[80:83]
    ds_read_b128 v[12:15], v4 offset:13312
    v_mfma_f32_16x16x32_bf16 v[84:87], v[20:23], a[84:87], v[84:87]
    buffer_load_dwordx4 a[180:183], v2, s[4:7], s66 offen offset:3072 sc1
    v_mfma_f32_16x16x32_bf16 v[88:91], v[20:23], a[88:91], v[88:91]
    v_mfma_f32_16x16x32_bf16 v[92:95], v[20:23], a[92:95], v[92:95]
    s_waitcnt lgkmcnt(3)
    v_mfma_f32_16x16x32_bf16 v[96:99], v[24:27], a[80:83], v[96:99]
    ds_read_b128 v[16:19], v4 offset:49152
    v_mfma_f32_16x16x32_bf16 v[100:103], v[24:27], a[84:87], v[100:103]
    buffer_load_dwordx4 a[184:187], v2, s[4:7], s68 offen offset:3072 sc1
    v_mfma_f32_16x16x32_bf16 v[104:107], v[24:27], a[88:91], v[104:107]
    v_mfma_f32_16x16x32_bf16 v[108:111], v[24:27], a[92:95], v[108:111]
    s_waitcnt lgkmcnt(3)
    v_mfma_f32_16x16x32_bf16 v[112:115], v[28:31], a[80:83], v[112:115]
    ds_read_b128 v[20:23], v4 offset:50176
    v_mfma_f32_16x16x32_bf16 v[116:119], v[28:31], a[84:87], v[116:119]
    buffer_load_dwordx4 a[188:191], v2, s[4:7], s69 offen offset:3072 sc1
    v_mfma_f32_16x16x32_bf16 v[120:123], v[28:31], a[88:91], v[120:123]
    s_add_u32 s59, s50, 12288
    v_mfma_f32_16x16x32_bf16 v[124:127], v[28:31], a[92:95], v[124:127]
    s_waitcnt vmcnt(23) lgkmcnt(3)
    v_mfma_f32_16x16x32_bf16 v[208:211], v[8:11], a[96:99], v[208:211]
    s_waitcnt vmcnt(22)
    ds_read_b128 v[24:27], v7 offset:20480
    v_mfma_f32_16x16x32_bf16 v[212:215], v[8:11], a[100:103], v[212:215]
    buffer_load_dwordx4 a[192:195], v2, s[4:7], s59 offen offset:0 sc1
    s_waitcnt vmcnt(22)
    v_mfma_f32_16x16x32_bf16 v[216:219], v[8:11], a[104:107], v[216:219]
    s_waitcnt vmcnt(21)
    s_add_u32 s66, s50, 30720
    v_mfma_f32_16x16x32_bf16 v[220:223], v[8:11], a[108:111], v[220:223]
    s_waitcnt lgkmcnt(3)
    v_mfma_f32_16x16x32_bf16 v[224:227], v[12:15], a[96:99], v[224:227]
    ds_read_b128 v[28:31], v7 offset:21504
    v_mfma_f32_16x16x32_bf16 v[228:231], v[12:15], a[100:103], v[228:231]
    buffer_load_dwordx4 a[196:199], v2, s[4:7], s66 offen offset:0 sc1
    v_mfma_f32_16x16x32_bf16 v[232:235], v[12:15], a[104:107], v[232:235]
    s_add_u32 s68, s50, 49152
    v_mfma_f32_16x16x32_bf16 v[236:239], v[12:15], a[108:111], v[236:239]
    s_waitcnt lgkmcnt(3)
    v_mfma_f32_16x16x32_bf16 v[64:67], v[16:19], a[96:99], v[64:67]
    ds_read_b128 v[8:11], v4 offset:14336
    v_mfma_f32_16x16x32_bf16 v[68:71], v[16:19], a[100:103], v[68:71]
    buffer_load_dwordx4 a[200:203], v2, s[4:7], s68 offen offset:0 sc1
    v_mfma_f32_16x16x32_bf16 v[72:75], v[16:19], a[104:107], v[72:75]
    s_add_u32 s69, s50, 67584
    v_mfma_f32_16x16x32_bf16 v[76:79], v[16:19], a[108:111], v[76:79]
    s_waitcnt lgkmcnt(3)
    v_mfma_f32_16x16x32_bf16 v[80:83], v[20:23], a[96:99], v[80:83]
    ds_read_b128 v[12:15], v4 offset:15360
    v_mfma_f32_16x16x32_bf16 v[84:87], v[20:23], a[100:103], v[84:87]
    buffer_load_dwordx4 a[204:207], v2, s[4:7], s69 offen offset:0 sc1
    v_mfma_f32_16x16x32_bf16 v[88:91], v[20:23], a[104:107], v[88:91]
    v_mfma_f32_16x16x32_bf16 v[92:95], v[20:23], a[108:111], v[92:95]
    s_waitcnt lgkmcnt(3)
    v_mfma_f32_16x16x32_bf16 v[96:99], v[24:27], a[96:99], v[96:99]
    ds_read_b128 v[16:19], v4 offset:51200
    v_mfma_f32_16x16x32_bf16 v[100:103], v[24:27], a[100:103], v[100:103]
    buffer_load_dwordx4 a[208:211], v2, s[4:7], s59 offen offset:1024 sc1
    v_mfma_f32_16x16x32_bf16 v[104:107], v[24:27], a[104:107], v[104:107]
    v_mfma_f32_16x16x32_bf16 v[108:111], v[24:27], a[108:111], v[108:111]
    s_waitcnt lgkmcnt(3)
    v_mfma_f32_16x16x32_bf16 v[112:115], v[28:31], a[96:99], v[112:115]
    ds_read_b128 v[20:23], v4 offset:52224
    v_mfma_f32_16x16x32_bf16 v[116:119], v[28:31], a[100:103], v[116:119]
    buffer_load_dwordx4 a[212:215], v2, s[4:7], s66 offen offset:1024 sc1
    v_mfma_f32_16x16x32_bf16 v[120:123], v[28:31], a[104:107], v[120:123]
    v_mfma_f32_16x16x32_bf16 v[124:127], v[28:31], a[108:111], v[124:127]
    s_waitcnt vmcnt(25) lgkmcnt(3)
    v_mfma_f32_16x16x32_bf16 v[208:211], v[8:11], a[112:115], v[208:211]
    s_waitcnt vmcnt(24)
    ds_read_b128 v[24:27], v7 offset:22528
    v_mfma_f32_16x16x32_bf16 v[212:215], v[8:11], a[116:119], v[212:215]
    buffer_load_dwordx4 a[216:219], v2, s[4:7], s68 offen offset:1024 sc1
    s_waitcnt vmcnt(24)
    v_mfma_f32_16x16x32_bf16 v[216:219], v[8:11], a[120:123], v[216:219]
    s_waitcnt vmcnt(23)
    v_mfma_f32_16x16x32_bf16 v[220:223], v[8:11], a[124:127], v[220:223]
    s_waitcnt lgkmcnt(3)
    v_mfma_f32_16x16x32_bf16 v[224:227], v[12:15], a[112:115], v[224:227]
    ds_read_b128 v[28:31], v7 offset:23552
    v_mfma_f32_16x16x32_bf16 v[228:231], v[12:15], a[116:119], v[228:231]
    buffer_load_dwordx4 a[220:223], v2, s[4:7], s69 offen offset:1024 sc1
    v_mfma_f32_16x16x32_bf16 v[232:235], v[12:15], a[120:123], v[232:235]
    v_mfma_f32_16x16x32_bf16 v[236:239], v[12:15], a[124:127], v[236:239]
    s_waitcnt lgkmcnt(3)
    v_mfma_f32_16x16x32_bf16 v[64:67], v[16:19], a[112:115], v[64:67]
    ds_read_b128 v[8:11], v4 offset:16384
    v_mfma_f32_16x16x32_bf16 v[68:71], v[16:19], a[116:119], v[68:71]
    buffer_load_dwordx4 a[224:227], v2, s[4:7], s59 offen offset:2048 sc1
    v_mfma_f32_16x16x32_bf16 v[72:75], v[16:19], a[120:123], v[72:75]
    v_mfma_f32_16x16x32_bf16 v[76:79], v[16:19], a[124:127], v[76:79]
    s_waitcnt lgkmcnt(3)
    v_mfma_f32_16x16x32_bf16 v[80:83], v[20:23], a[112:115], v[80:83]
    ds_read_b128 v[12:15], v4 offset:17408
    v_mfma_f32_16x16x32_bf16 v[84:87], v[20:23], a[116:119], v[84:87]
    buffer_load_dwordx4 a[228:231], v2, s[4:7], s66 offen offset:2048 sc1
    v_mfma_f32_16x16x32_bf16 v[88:91], v[20:23], a[120:123], v[88:91]
    v_mfma_f32_16x16x32_bf16 v[92:95], v[20:23], a[124:127], v[92:95]
    s_waitcnt lgkmcnt(3)
    v_mfma_f32_16x16x32_bf16 v[96:99], v[24:27], a[112:115], v[96:99]
    ds_read_b128 v[16:19], v4 offset:53248
    v_mfma_f32_16x16x32_bf16 v[100:103], v[24:27], a[116:119], v[100:103]
    buffer_load_dwordx4 a[232:235], v2, s[4:7], s68 offen offset:2048 sc1
    v_mfma_f32_16x16x32_bf16 v[104:107], v[24:27], a[120:123], v[104:107]
    v_mfma_f32_16x16x32_bf16 v[108:111], v[24:27], a[124:127], v[108:111]
    s_waitcnt lgkmcnt(3)
    v_mfma_f32_16x16x32_bf16 v[112:115], v[28:31], a[112:115], v[112:115]
    ds_read_b128 v[20:23], v4 offset:54272
    v_mfma_f32_16x16x32_bf16 v[116:119], v[28:31], a[116:119], v[116:119]
    buffer_load_dwordx4 a[236:239], v2, s[4:7], s69 offen offset:2048 sc1
    v_mfma_f32_16x16x32_bf16 v[120:123], v[28:31], a[120:123], v[120:123]
    v_mfma_f32_16x16x32_bf16 v[124:127], v[28:31], a[124:127], v[124:127]
    s_waitcnt vmcnt(27) lgkmcnt(3)
    v_mfma_f32_16x16x32_bf16 v[208:211], v[8:11], a[128:131], v[208:211]
    s_waitcnt vmcnt(26)
    ds_read_b128 v[24:27], v7 offset:24576
    v_mfma_f32_16x16x32_bf16 v[212:215], v[8:11], a[132:135], v[212:215]
    buffer_load_dwordx4 a[240:243], v2, s[4:7], s59 offen offset:3072 sc1
    s_waitcnt vmcnt(26)
    v_mfma_f32_16x16x32_bf16 v[216:219], v[8:11], a[136:139], v[216:219]
    s_waitcnt vmcnt(25)
    v_mfma_f32_16x16x32_bf16 v[220:223], v[8:11], a[140:143], v[220:223]
    s_waitcnt lgkmcnt(3)
    v_mfma_f32_16x16x32_bf16 v[224:227], v[12:15], a[128:131], v[224:227]
    ds_read_b128 v[28:31], v7 offset:25600
    v_mfma_f32_16x16x32_bf16 v[228:231], v[12:15], a[132:135], v[228:231]
    buffer_load_dwordx4 a[244:247], v2, s[4:7], s66 offen offset:3072 sc1
    v_mfma_f32_16x16x32_bf16 v[232:235], v[12:15], a[136:139], v[232:235]
    v_mfma_f32_16x16x32_bf16 v[236:239], v[12:15], a[140:143], v[236:239]
    s_waitcnt lgkmcnt(3)
    s_add_u32 m0, s49, 110592
    s_add_u32 s61, s48, 110592
    v_mfma_f32_16x16x32_bf16 v[64:67], v[16:19], a[128:131], v[64:67]
    ds_read_b128 v[8:11], v4 offset:18432
    v_mfma_f32_16x16x32_bf16 v[68:71], v[16:19], a[132:135], v[68:71]
    buffer_load_dwordx4 a[248:251], v2, s[4:7], s68 offen offset:3072 sc1
    v_mfma_f32_16x16x32_bf16 v[72:75], v[16:19], a[136:139], v[72:75]
    v_mfma_f32_16x16x32_bf16 v[76:79], v[16:19], a[140:143], v[76:79]
    s_waitcnt lgkmcnt(3)
    v_mfma_f32_16x16x32_bf16 v[80:83], v[20:23], a[128:131], v[80:83]
    ds_read_b128 v[12:15], v4 offset:19456
    v_mfma_f32_16x16x32_bf16 v[84:87], v[20:23], a[132:135], v[84:87]
    buffer_load_dwordx4 a[252:255], v2, s[4:7], s69 offen offset:3072 sc1
    v_mfma_f32_16x16x32_bf16 v[88:91], v[20:23], a[136:139], v[88:91]
    s_add_u32 s59, s50, 16384
    v_mfma_f32_16x16x32_bf16 v[92:95], v[20:23], a[140:143], v[92:95]
    s_waitcnt lgkmcnt(3)
    v_mfma_f32_16x16x32_bf16 v[96:99], v[24:27], a[128:131], v[96:99]
    ds_read_b128 v[16:19], v4 offset:55296
    v_mfma_f32_16x16x32_bf16 v[100:103], v[24:27], a[132:135], v[100:103]
    buffer_load_dwordx4 v[32:35], v2, s[4:7], s59 offen offset:0 sc1
    v_mfma_f32_16x16x32_bf16 v[104:107], v[24:27], a[136:139], v[104:107]
    s_add_u32 s66, s50, 34816
    v_mfma_f32_16x16x32_bf16 v[108:111], v[24:27], a[140:143], v[108:111]
    s_waitcnt lgkmcnt(3)
    v_mfma_f32_16x16x32_bf16 v[112:115], v[28:31], a[128:131], v[112:115]
    ds_read_b128 v[20:23], v4 offset:56320
    v_mfma_f32_16x16x32_bf16 v[116:119], v[28:31], a[132:135], v[116:119]
    buffer_load_dwordx4 v[36:39], v2, s[4:7], s66 offen offset:0 sc1
    v_mfma_f32_16x16x32_bf16 v[120:123], v[28:31], a[136:139], v[120:123]
    s_add_u32 s68, s50, 53248
    v_mfma_f32_16x16x32_bf16 v[124:127], v[28:31], a[140:143], v[124:127]
    s_waitcnt vmcnt(29) lgkmcnt(3)
    v_mfma_f32_16x16x32_bf16 v[208:211], v[8:11], a[144:147], v[208:211]
    s_waitcnt vmcnt(28)
    ds_read_b128 v[24:27], v7 offset:26624
    v_mfma_f32_16x16x32_bf16 v[212:215], v[8:11], a[148:151], v[212:215]
    buffer_load_dwordx4 v[40:43], v2, s[4:7], s68 offen offset:0 sc1
    s_waitcnt vmcnt(28)
    v_mfma_f32_16x16x32_bf16 v[216:219], v[8:11], a[152:155], v[216:219]
    s_waitcnt vmcnt(27)
    s_add_u32 s69, s50, 71680
    v_mfma_f32_16x16x32_bf16 v[220:223], v[8:11], a[156:159], v[220:223]
    s_waitcnt lgkmcnt(3)
    v_mfma_f32_16x16x32_bf16 v[224:227], v[12:15], a[144:147], v[224:227]
    ds_read_b128 v[28:31], v7 offset:27648
    v_mfma_f32_16x16x32_bf16 v[228:231], v[12:15], a[148:151], v[228:231]
    buffer_load_dwordx4 v[44:47], v2, s[4:7], s69 offen offset:0 sc1
    v_mfma_f32_16x16x32_bf16 v[232:235], v[12:15], a[152:155], v[232:235]
    v_mfma_f32_16x16x32_bf16 v[236:239], v[12:15], a[156:159], v[236:239]
    s_waitcnt lgkmcnt(3)
    v_mfma_f32_16x16x32_bf16 v[64:67], v[16:19], a[144:147], v[64:67]
    ds_read_b128 v[8:11], v4 offset:20480
    v_mfma_f32_16x16x32_bf16 v[68:71], v[16:19], a[148:151], v[68:71]
    buffer_load_dwordx4 v2, s[4:7], s61 offen offset:0 lds
    v_mfma_f32_16x16x32_bf16 v[72:75], v[16:19], a[152:155], v[72:75]
    v_mfma_f32_16x16x32_bf16 v[76:79], v[16:19], a[156:159], v[76:79]
    s_waitcnt lgkmcnt(3)
    v_mfma_f32_16x16x32_bf16 v[80:83], v[20:23], a[144:147], v[80:83]
    ds_read_b128 v[12:15], v4 offset:21504
    v_mfma_f32_16x16x32_bf16 v[84:87], v[20:23], a[148:151], v[84:87]
    buffer_load_dwordx4 v2, s[4:7], s61 offen offset:1024 lds
    v_mfma_f32_16x16x32_bf16 v[88:91], v[20:23], a[152:155], v[88:91]
    v_mfma_f32_16x16x32_bf16 v[92:95], v[20:23], a[156:159], v[92:95]
    s_waitcnt lgkmcnt(3)
    v_mfma_f32_16x16x32_bf16 v[96:99], v[24:27], a[144:147], v[96:99]
    ds_read_b128 v[16:19], v4 offset:57344
    v_mfma_f32_16x16x32_bf16 v[100:103], v[24:27], a[148:151], v[100:103]
    buffer_load_dwordx4 v2, s[4:7], s61 offen offset:2048 lds
    v_mfma_f32_16x16x32_bf16 v[104:107], v[24:27], a[152:155], v[104:107]
    v_mfma_f32_16x16x32_bf16 v[108:111], v[24:27], a[156:159], v[108:111]
    s_waitcnt lgkmcnt(3)
    v_mfma_f32_16x16x32_bf16 v[112:115], v[28:31], a[144:147], v[112:115]
    ds_read_b128 v[20:23], v4 offset:58368
    v_mfma_f32_16x16x32_bf16 v[116:119], v[28:31], a[148:151], v[116:119]
    buffer_load_dwordx4 v2, s[4:7], s61 offen offset:3072 lds
    v_mfma_f32_16x16x32_bf16 v[120:123], v[28:31], a[152:155], v[120:123]
    s_add_u32 m0, s49, 114688
    s_add_u32 s61, s48, 114688
    v_mfma_f32_16x16x32_bf16 v[124:127], v[28:31], a[156:159], v[124:127]
    s_waitcnt vmcnt(31) lgkmcnt(3)
    v_mfma_f32_16x16x32_bf16 v[208:211], v[8:11], a[160:163], v[208:211]
    s_waitcnt vmcnt(30)
    ds_read_b128 v[24:27], v7 offset:28672
    v_mfma_f32_16x16x32_bf16 v[212:215], v[8:11], a[164:167], v[212:215]
    buffer_load_dwordx4 v2, s[4:7], s61 offen offset:0 lds
    s_waitcnt vmcnt(30)
    v_mfma_f32_16x16x32_bf16 v[216:219], v[8:11], a[168:171], v[216:219]
    s_waitcnt vmcnt(29)
    v_mfma_f32_16x16x32_bf16 v[220:223], v[8:11], a[172:175], v[220:223]
    s_waitcnt lgkmcnt(3)
    v_mfma_f32_16x16x32_bf16 v[224:227], v[12:15], a[160:163], v[224:227]
    ds_read_b128 v[28:31], v7 offset:29696
    v_mfma_f32_16x16x32_bf16 v[228:231], v[12:15], a[164:167], v[228:231]
    buffer_load_dwordx4 v2, s[4:7], s61 offen offset:1024 lds
    v_mfma_f32_16x16x32_bf16 v[232:235], v[12:15], a[168:171], v[232:235]
    v_mfma_f32_16x16x32_bf16 v[236:239], v[12:15], a[172:175], v[236:239]
    s_waitcnt lgkmcnt(3)
    v_mfma_f32_16x16x32_bf16 v[64:67], v[16:19], a[160:163], v[64:67]
    ds_read_b128 v[8:11], v4 offset:22528
    v_mfma_f32_16x16x32_bf16 v[68:71], v[16:19], a[164:167], v[68:71]
    buffer_load_dwordx4 v2, s[4:7], s61 offen offset:2048 lds
    v_mfma_f32_16x16x32_bf16 v[72:75], v[16:19], a[168:171], v[72:75]
    v_mfma_f32_16x16x32_bf16 v[76:79], v[16:19], a[172:175], v[76:79]
    s_waitcnt lgkmcnt(3)
    v_mfma_f32_16x16x32_bf16 v[80:83], v[20:23], a[160:163], v[80:83]
    ds_read_b128 v[12:15], v4 offset:23552
    v_mfma_f32_16x16x32_bf16 v[84:87], v[20:23], a[164:167], v[84:87]
    buffer_load_dwordx4 v2, s[4:7], s61 offen offset:3072 lds
    v_mfma_f32_16x16x32_bf16 v[88:91], v[20:23], a[168:171], v[88:91]
    s_add_u32 m0, s49, 118784
    s_add_u32 s61, s48, 118784
    v_mfma_f32_16x16x32_bf16 v[92:95], v[20:23], a[172:175], v[92:95]
    s_waitcnt lgkmcnt(3)
    v_mfma_f32_16x16x32_bf16 v[96:99], v[24:27], a[160:163], v[96:99]
    ds_read_b128 v[16:19], v4 offset:59392
    v_mfma_f32_16x16x32_bf16 v[100:103], v[24:27], a[164:167], v[100:103]
    buffer_load_dwordx4 v2, s[4:7], s61 offen offset:0 lds
    v_mfma_f32_16x16x32_bf16 v[104:107], v[24:27], a[168:171], v[104:107]
    v_mfma_f32_16x16x32_bf16 v[108:111], v[24:27], a[172:175], v[108:111]
    s_waitcnt lgkmcnt(3)
    v_mfma_f32_16x16x32_bf16 v[112:115], v[28:31], a[160:163], v[112:115]
    ds_read_b128 v[20:23], v4 offset:60416
    v_mfma_f32_16x16x32_bf16 v[116:119], v[28:31], a[164:167], v[116:119]
    buffer_load_dwordx4 v[48:51], v2, s[4:7], s59 offen offset:1024 sc1
    v_mfma_f32_16x16x32_bf16 v[120:123], v[28:31], a[168:171], v[120:123]
    v_mfma_f32_16x16x32_bf16 v[124:127], v[28:31], a[172:175], v[124:127]
    s_waitcnt vmcnt(33) lgkmcnt(3)
    v_mfma_f32_16x16x32_bf16 v[208:211], v[8:11], a[176:179], v[208:211]
    s_waitcnt vmcnt(32)
    ds_read_b128 v[24:27], v7 offset:30720
    v_mfma_f32_16x16x32_bf16 v[212:215], v[8:11], a[180:183], v[212:215]
    buffer_load_dwordx4 v[52:55], v2, s[4:7], s66 offen offset:1024 sc1
    s_waitcnt vmcnt(32)
    v_mfma_f32_16x16x32_bf16 v[216:219], v[8:11], a[184:187], v[216:219]
    s_waitcnt vmcnt(31)
    v_mfma_f32_16x16x32_bf16 v[220:223], v[8:11], a[188:191], v[220:223]
    s_waitcnt lgkmcnt(3)
    v_mfma_f32_16x16x32_bf16 v[224:227], v[12:15], a[176:179], v[224:227]
    ds_read_b128 v[28:31], v7 offset:31744
    v_mfma_f32_16x16x32_bf16 v[228:231], v[12:15], a[180:183], v[228:231]
    buffer_load_dwordx4 v[56:59], v2, s[4:7], s68 offen offset:1024 sc1
    v_mfma_f32_16x16x32_bf16 v[232:235], v[12:15], a[184:187], v[232:235]
    v_mfma_f32_16x16x32_bf16 v[236:239], v[12:15], a[188:191], v[236:239]
    s_waitcnt lgkmcnt(3)
    v_mfma_f32_16x16x32_bf16 v[64:67], v[16:19], a[176:179], v[64:67]
    ds_read_b128 v[8:11], v4 offset:24576
    v_mfma_f32_16x16x32_bf16 v[68:71], v[16:19], a[180:183], v[68:71]
    buffer_load_dwordx4 v[60:63], v2, s[4:7], s69 offen offset:1024 sc1
    v_mfma_f32_16x16x32_bf16 v[72:75], v[16:19], a[184:187], v[72:75]
    v_mfma_f32_16x16x32_bf16 v[76:79], v[16:19], a[188:191], v[76:79]
    s_waitcnt lgkmcnt(3)
    v_mfma_f32_16x16x32_bf16 v[80:83], v[20:23], a[176:179], v[80:83]
    ds_read_b128 v[12:15], v4 offset:25600
    v_mfma_f32_16x16x32_bf16 v[84:87], v[20:23], a[180:183], v[84:87]
    v_mfma_f32_16x16x32_bf16 v[88:91], v[20:23], a[184:187], v[88:91]
    v_mfma_f32_16x16x32_bf16 v[92:95], v[20:23], a[188:191], v[92:95]
    s_waitcnt lgkmcnt(3)
    v_mfma_f32_16x16x32_bf16 v[96:99], v[24:27], a[176:179], v[96:99]
    ds_read_b128 v[16:19], v4 offset:61440
    v_mfma_f32_16x16x32_bf16 v[100:103], v[24:27], a[180:183], v[100:103]
    v_mfma_f32_16x16x32_bf16 v[104:107], v[24:27], a[184:187], v[104:107]
    v_mfma_f32_16x16x32_bf16 v[108:111], v[24:27], a[188:191], v[108:111]
    s_waitcnt lgkmcnt(3)
    v_mfma_f32_16x16x32_bf16 v[112:115], v[28:31], a[176:179], v[112:115]
    ds_read_b128 v[20:23], v4 offset:62464
    v_mfma_f32_16x16x32_bf16 v[116:119], v[28:31], a[180:183], v[116:119]
    v_mfma_f32_16x16x32_bf16 v[120:123], v[28:31], a[184:187], v[120:123]
    v_mfma_f32_16x16x32_bf16 v[124:127], v[28:31], a[188:191], v[124:127]
    s_waitcnt vmcnt(32) lgkmcnt(3)
    v_mfma_f32_16x16x32_bf16 v[208:211], v[8:11], a[192:195], v[208:211]
    s_waitcnt vmcnt(31)
    ds_read_b128 v[24:27], v7 offset:32768
    v_mfma_f32_16x16x32_bf16 v[212:215], v[8:11], a[196:199], v[212:215]
    s_waitcnt vmcnt(30)
    v_mfma_f32_16x16x32_bf16 v[216:219], v[8:11], a[200:203], v[216:219]
    s_waitcnt vmcnt(29)
    v_mfma_f32_16x16x32_bf16 v[220:223], v[8:11], a[204:207], v[220:223]
    s_waitcnt lgkmcnt(3)
    v_mfma_f32_16x16x32_bf16 v[224:227], v[12:15], a[192:195], v[224:227]
    ds_read_b128 v[28:31], v7 offset:33792
    v_mfma_f32_16x16x32_bf16 v[228:231], v[12:15], a[196:199], v[228:231]
    v_mfma_f32_16x16x32_bf16 v[232:235], v[12:15], a[200:203], v[232:235]
    v_mfma_f32_16x16x32_bf16 v[236:239], v[12:15], a[204:207], v[236:239]
    s_waitcnt lgkmcnt(3)
    v_mfma_f32_16x16x32_bf16 v[64:67], v[16:19], a[192:195], v[64:67]
    ds_read_b128 v[8:11], v4 offset:26624
    v_mfma_f32_16x16x32_bf16 v[68:71], v[16:19], a[196:199], v[68:71]
    v_mfma_f32_16x16x32_bf16 v[72:75], v[16:19], a[200:203], v[72:75]
    v_mfma_f32_16x16x32_bf16 v[76:79], v[16:19], a[204:207], v[76:79]
    s_waitcnt lgkmcnt(3)
    v_mfma_f32_16x16x32_bf16 v[80:83], v[20:23], a[192:195], v[80:83]
    ds_read_b128 v[12:15], v4 offset:27648
    v_mfma_f32_16x16x32_bf16 v[84:87], v[20:23], a[196:199], v[84:87]
    v_mfma_f32_16x16x32_bf16 v[88:91], v[20:23], a[200:203], v[88:91]
    v_mfma_f32_16x16x32_bf16 v[92:95], v[20:23], a[204:207], v[92:95]
    s_waitcnt lgkmcnt(3)
    v_mfma_f32_16x16x32_bf16 v[96:99], v[24:27], a[192:195], v[96:99]
    ds_read_b128 v[16:19], v4 offset:63488
    v_mfma_f32_16x16x32_bf16 v[100:103], v[24:27], a[196:199], v[100:103]
    v_mfma_f32_16x16x32_bf16 v[104:107], v[24:27], a[200:203], v[104:107]
    v_mfma_f32_16x16x32_bf16 v[108:111], v[24:27], a[204:207], v[108:111]
    s_waitcnt lgkmcnt(3)
    v_mfma_f32_16x16x32_bf16 v[112:115], v[28:31], a[192:195], v[112:115]
    ds_read_b128 v[20:23], v4 offset:64512
    v_mfma_f32_16x16x32_bf16 v[116:119], v[28:31], a[196:199], v[116:119]
    v_mfma_f32_16x16x32_bf16 v[120:123], v[28:31], a[200:203], v[120:123]
    v_mfma_f32_16x16x32_bf16 v[124:127], v[28:31], a[204:207], v[124:127]
    s_waitcnt vmcnt(28) lgkmcnt(3)
    v_mfma_f32_16x16x32_bf16 v[208:211], v[8:11], a[208:211], v[208:211]
    s_waitcnt vmcnt(27)
    ds_read_b128 v[24:27], v7 offset:34816
    v_mfma_f32_16x16x32_bf16 v[212:215], v[8:11], a[212:215], v[212:215]
    s_waitcnt vmcnt(26)
    v_mfma_f32_16x16x32_bf16 v[216:219], v[8:11], a[216:219], v[216:219]
    s_waitcnt vmcnt(25)
    v_mfma_f32_16x16x32_bf16 v[220:223], v[8:11], a[220:223], v[220:223]
    s_waitcnt lgkmcnt(3)
    v_mfma_f32_16x16x32_bf16 v[224:227], v[12:15], a[208:211], v[224:227]
    ds_read_b128 v[28:31], v7 offset:35840
    v_mfma_f32_16x16x32_bf16 v[228:231], v[12:15], a[212:215], v[228:231]
    v_mfma_f32_16x16x32_bf16 v[232:235], v[12:15], a[216:219], v[232:235]
    v_mfma_f32_16x16x32_bf16 v[236:239], v[12:15], a[220:223], v[236:239]
    s_waitcnt lgkmcnt(3)
    v_mfma_f32_16x16x32_bf16 v[64:67], v[16:19], a[208:211], v[64:67]
    ds_read_b128 v[8:11], v4 offset:28672
    v_mfma_f32_16x16x32_bf16 v[68:71], v[16:19], a[212:215], v[68:71]
    v_mfma_f32_16x16x32_bf16 v[72:75], v[16:19], a[216:219], v[72:75]
    v_mfma_f32_16x16x32_bf16 v[76:79], v[16:19], a[220:223], v[76:79]
    s_waitcnt lgkmcnt(3)
    v_mfma_f32_16x16x32_bf16 v[80:83], v[20:23], a[208:211], v[80:83]
    ds_read_b128 v[12:15], v4 offset:29696
    v_mfma_f32_16x16x32_bf16 v[84:87], v[20:23], a[212:215], v[84:87]
    v_mfma_f32_16x16x32_bf16 v[88:91], v[20:23], a[216:219], v[88:91]
    v_mfma_f32_16x16x32_bf16 v[92:95], v[20:23], a[220:223], v[92:95]
    s_waitcnt lgkmcnt(3)
    v_mfma_f32_16x16x32_bf16 v[96:99], v[24:27], a[208:211], v[96:99]
    ds_read_b128 v[16:19], v7 offset:0
    v_mfma_f32_16x16x32_bf16 v[100:103], v[24:27], a[212:215], v[100:103]
    v_mfma_f32_16x16x32_bf16 v[104:107], v[24:27], a[216:219], v[104:107]
    v_mfma_f32_16x16x32_bf16 v[108:111], v[24:27], a[220:223], v[108:111]
    s_waitcnt lgkmcnt(3)
    v_mfma_f32_16x16x32_bf16 v[112:115], v[28:31], a[208:211], v[112:115]
    ds_read_b128 v[20:23], v7 offset:1024
    v_mfma_f32_16x16x32_bf16 v[116:119], v[28:31], a[212:215], v[116:119]
    v_mfma_f32_16x16x32_bf16 v[120:123], v[28:31], a[216:219], v[120:123]
    v_mfma_f32_16x16x32_bf16 v[124:127], v[28:31], a[220:223], v[124:127]
    s_waitcnt vmcnt(24) lgkmcnt(3)
    v_mfma_f32_16x16x32_bf16 v[208:211], v[8:11], a[224:227], v[208:211]
    s_waitcnt vmcnt(23)
    ds_read_b128 v[24:27], v7 offset:36864
    v_mfma_f32_16x16x32_bf16 v[212:215], v[8:11], a[228:231], v[212:215]
    s_waitcnt vmcnt(22)
    v_mfma_f32_16x16x32_bf16 v[216:219], v[8:11], a[232:235], v[216:219]
    s_waitcnt vmcnt(21)
    v_mfma_f32_16x16x32_bf16 v[220:223], v[8:11], a[236:239], v[220:223]
    s_waitcnt lgkmcnt(3)
    v_mfma_f32_16x16x32_bf16 v[224:227], v[12:15], a[224:227], v[224:227]
    ds_read_b128 v[28:31], v7 offset:37888
    v_mfma_f32_16x16x32_bf16 v[228:231], v[12:15], a[228:231], v[228:231]
    v_mfma_f32_16x16x32_bf16 v[232:235], v[12:15], a[232:235], v[232:235]
    v_mfma_f32_16x16x32_bf16 v[236:239], v[12:15], a[236:239], v[236:239]
    s_waitcnt lgkmcnt(3)
    v_mfma_f32_16x16x32_bf16 v[64:67], v[16:19], a[224:227], v[64:67]
    ds_read_b128 v[8:11], v4 offset:30720
    v_mfma_f32_16x16x32_bf16 v[68:71], v[16:19], a[228:231], v[68:71]
    v_mfma_f32_16x16x32_bf16 v[72:75], v[16:19], a[232:235], v[72:75]
    v_mfma_f32_16x16x32_bf16 v[76:79], v[16:19], a[236:239], v[76:79]
    s_waitcnt lgkmcnt(3)
    v_mfma_f32_16x16x32_bf16 v[80:83], v[20:23], a[224:227], v[80:83]
    ds_read_b128 v[12:15], v4 offset:31744
    v_mfma_f32_16x16x32_bf16 v[84:87], v[20:23], a[228:231], v[84:87]
    v_mfma_f32_16x16x32_bf16 v[88:91], v[20:23], a[232:235], v[88:91]
    v_mfma_f32_16x16x32_bf16 v[92:95], v[20:23], a[236:239], v[92:95]
    s_waitcnt lgkmcnt(3)
    v_mfma_f32_16x16x32_bf16 v[96:99], v[24:27], a[224:227], v[96:99]
    ds_read_b128 v[16:19], v7 offset:2048
    v_mfma_f32_16x16x32_bf16 v[100:103], v[24:27], a[228:231], v[100:103]
    v_mfma_f32_16x16x32_bf16 v[104:107], v[24:27], a[232:235], v[104:107]
    v_mfma_f32_16x16x32_bf16 v[108:111], v[24:27], a[236:239], v[108:111]
    s_waitcnt lgkmcnt(3)
    v_mfma_f32_16x16x32_bf16 v[112:115], v[28:31], a[224:227], v[112:115]
    ds_read_b128 v[20:23], v7 offset:3072
    v_mfma_f32_16x16x32_bf16 v[116:119], v[28:31], a[228:231], v[116:119]
    v_mfma_f32_16x16x32_bf16 v[120:123], v[28:31], a[232:235], v[120:123]
    v_mfma_f32_16x16x32_bf16 v[124:127], v[28:31], a[236:239], v[124:127]
    s_waitcnt vmcnt(20) lgkmcnt(3)
    v_mfma_f32_16x16x32_bf16 v[208:211], v[8:11], a[240:243], v[208:211]
    s_waitcnt vmcnt(19)
    ds_read_b128 v[24:27], v7 offset:38912
    v_mfma_f32_16x16x32_bf16 v[212:215], v[8:11], a[244:247], v[212:215]
    s_waitcnt vmcnt(18)
    v_mfma_f32_16x16x32_bf16 v[216:219], v[8:11], a[248:251], v[216:219]
    s_waitcnt vmcnt(17)
    v_mfma_f32_16x16x32_bf16 v[220:223], v[8:11], a[252:255], v[220:223]
    s_waitcnt lgkmcnt(3)
    v_mfma_f32_16x16x32_bf16 v[224:227], v[12:15], a[240:243], v[224:227]
    ds_read_b128 v[28:31], v7 offset:39936
    v_mfma_f32_16x16x32_bf16 v[228:231], v[12:15], a[244:247], v[228:231]
    v_mfma_f32_16x16x32_bf16 v[232:235], v[12:15], a[248:251], v[232:235]
    v_mfma_f32_16x16x32_bf16 v[236:239], v[12:15], a[252:255], v[236:239]
    s_waitcnt lgkmcnt(3)
    v_mfma_f32_16x16x32_bf16 v[64:67], v[16:19], a[240:243], v[64:67]
    ds_read_b128 v[8:11], v4 offset:32768
    v_mfma_f32_16x16x32_bf16 v[68:71], v[16:19], a[244:247], v[68:71]
    v_mfma_f32_16x16x32_bf16 v[72:75], v[16:19], a[248:251], v[72:75]
    v_mfma_f32_16x16x32_bf16 v[76:79], v[16:19], a[252:255], v[76:79]
    s_waitcnt lgkmcnt(3)
    v_mfma_f32_16x16x32_bf16 v[80:83], v[20:23], a[240:243], v[80:83]
    ds_read_b128 v[12:15], v4 offset:33792
    v_mfma_f32_16x16x32_bf16 v[84:87], v[20:23], a[244:247], v[84:87]
    v_mfma_f32_16x16x32_bf16 v[88:91], v[20:23], a[248:251], v[88:91]
    v_mfma_f32_16x16x32_bf16 v[92:95], v[20:23], a[252:255], v[92:95]
    s_waitcnt lgkmcnt(3)
    v_mfma_f32_16x16x32_bf16 v[96:99], v[24:27], a[240:243], v[96:99]
    ds_read_b128 v[16:19], v7 offset:4096
    v_mfma_f32_16x16x32_bf16 v[100:103], v[24:27], a[244:247], v[100:103]
    v_mfma_f32_16x16x32_bf16 v[104:107], v[24:27], a[248:251], v[104:107]
    v_mfma_f32_16x16x32_bf16 v[108:111], v[24:27], a[252:255], v[108:111]
    s_waitcnt lgkmcnt(3)
    v_mfma_f32_16x16x32_bf16 v[112:115], v[28:31], a[240:243], v[112:115]
    ds_read_b128 v[20:23], v7 offset:5120
    v_mfma_f32_16x16x32_bf16 v[116:119], v[28:31], a[244:247], v[116:119]
    v_add_f32 v166, v152, v154
    v_add_f32 v167, v153, v155
    v_mfma_f32_16x16x32_bf16 v[120:123], v[28:31], a[248:251], v[120:123]
    v_add_f32 v166, v166, v156
    v_add_f32 v167, v167, v157
    v_mfma_f32_16x16x32_bf16 v[124:127], v[28:31], a[252:255], v[124:127]
    s_waitcnt vmcnt(16) lgkmcnt(3)
    v_add_f32 v166, v166, v158
    v_add_f32 v167, v167, v159
    v_mfma_f32_16x16x32_bf16 v[208:211], v[8:11], v[32:35], v[208:211]
    s_waitcnt vmcnt(15)
    ds_read_b128 v[24:27], v7 offset:40960
    v_add_f32 v166, v166, v160
    v_mfma_f32_16x16x32_bf16 v[212:215], v[8:11], v[36:39], v[212:215]
    s_waitcnt vmcnt(14)
    v_add_f32 v167, v167, v161
    v_add_f32 v166, v166, v162
    v_mfma_f32_16x16x32_bf16 v[216:219], v[8:11], v[40:43], v[216:219]
    s_waitcnt vmcnt(13)
    v_add_f32 v167, v167, v163
    v_mul_f32 v166, 0xbae38e39, v166
    v_mfma_f32_16x16x32_bf16 v[220:223], v[8:11], v[44:47], v[220:223]
    s_waitcnt lgkmcnt(3)
    v_fmamk_f32 v165, v152, 0x3c2aaaab, v166
    v_mul_f32 v164, v165, v165
    v_mfma_f32_16x16x32_bf16 v[224:227], v[12:15], v[32:35], v[224:227]
    ds_read_b128 v[28:31], v7 offset:41984
    v_fmamk_f32 v165, v154, 0x3c2aaaab, v166
    v_mfma_f32_16x16x32_bf16 v[228:231], v[12:15], v[36:39], v[228:231]
    v_fmac_f32 v164, v165, v165
    v_fmamk_f32 v165, v156, 0x3c2aaaab, v166
    v_mfma_f32_16x16x32_bf16 v[232:235], v[12:15], v[40:43], v[232:235]
    v_fmac_f32 v164, v165, v165
    v_fmamk_f32 v165, v158, 0x3c2aaaab, v166
    v_mfma_f32_16x16x32_bf16 v[236:239], v[12:15], v[44:47], v[236:239]
    s_waitcnt lgkmcnt(3)
    v_fmac_f32 v164, v165, v165
    v_fmamk_f32 v165, v160, 0x3c2aaaab, v166
    v_mfma_f32_16x16x32_bf16 v[64:67], v[16:19], v[32:35], v[64:67]
    ds_read_b128 v[8:11], v4 offset:34816
    v_fmac_f32 v164, v165, v165
    v_mfma_f32_16x16x32_bf16 v[68:71], v[16:19], v[36:39], v[68:71]
    v_fmamk_f32 v165, v162, 0x3c2aaaab, v166
    v_fmac_f32 v164, v165, v165
    v_mfma_f32_16x16x32_bf16 v[72:75], v[16:19], v[40:43], v[72:75]
    v_fmac_f32 v167, 0x42c00000, v164
    v_mov_b32 v165, 0x3727c5ac
    v_mfma_f32_16x16x32_bf16 v[76:79], v[16:19], v[44:47], v[76:79]
    s_waitcnt lgkmcnt(3)
    v_fmac_f32 v165, 0x3ae38e39, v167
    v_rcp_f32 v167, v165
    v_mfma_f32_16x16x32_bf16 v[80:83], v[20:23], v[32:35], v[80:83]
    ds_read_b128 v[12:15], v4 offset:35840
    v_and_b32 v164, 15, v1
    v_mfma_f32_16x16x32_bf16 v[84:87], v[20:23], v[36:39], v[84:87]
    v_lshlrev_b32 v164, 2, v164
    v_mfma_f32_16x16x32_bf16 v[88:91], v[20:23], v[40:43], v[88:91]
    ds_bpermute_b32 v128, v164, v166 offset:0
    ds_bpermute_b32 v132, v164, v167 offset:0
    v_mfma_f32_16x16x32_bf16 v[92:95], v[20:23], v[44:47], v[92:95]
    s_waitcnt lgkmcnt(5)
    ds_bpermute_b32 v129, v164, v166 offset:64
    ds_bpermute_b32 v133, v164, v167 offset:64
    v_mfma_f32_16x16x32_bf16 v[96:99], v[24:27], v[32:35], v[96:99]
    ds_read_b128 v[16:19], v7 offset:6144
    ds_bpermute_b32 v130, v164, v166 offset:128
    v_mfma_f32_16x16x32_bf16 v[100:103], v[24:27], v[36:39], v[100:103]
    ds_bpermute_b32 v134, v164, v167 offset:128
    ds_bpermute_b32 v131, v164, v166 offset:192
    v_mfma_f32_16x16x32_bf16 v[104:107], v[24:27], v[40:43], v[104:107]
    ds_bpermute_b32 v135, v164, v167 offset:192
    v_mfma_f32_16x16x32_bf16 v[108:111], v[24:27], v[44:47], v[108:111]
    s_waitcnt lgkmcnt(11)
    v_mfma_f32_16x16x32_bf16 v[112:115], v[28:31], v[32:35], v[112:115]
    ds_read_b128 v[20:23], v7 offset:7168
    v_mfma_f32_16x16x32_bf16 v[116:119], v[28:31], v[36:39], v[116:119]
    v_mfma_f32_16x16x32_bf16 v[120:123], v[28:31], v[40:43], v[120:123]
    v_mfma_f32_16x16x32_bf16 v[124:127], v[28:31], v[44:47], v[124:127]
    s_waitcnt vmcnt(3) lgkmcnt(11)
    v_mfma_f32_16x16x32_bf16 v[208:211], v[8:11], v[48:51], v[208:211]
    s_waitcnt vmcnt(2)
    ds_read_b128 v[24:27], v7 offset:43008
    v_mfma_f32_16x16x32_bf16 v[212:215], v[8:11], v[52:55], v[212:215]
    s_waitcnt vmcnt(1)
    v_mfma_f32_16x16x32_bf16 v[216:219], v[8:11], v[56:59], v[216:219]
    s_waitcnt vmcnt(0)
    v_mfma_f32_16x16x32_bf16 v[220:223], v[8:11], v[60:63], v[220:223]
    s_waitcnt lgkmcnt(11)
    ds_read_b128 v[136:139], v5 offset:128
    ds_read_b128 v[140:143], v5 offset:192
    v_mfma_f32_16x16x32_bf16 v[224:227], v[12:15], v[48:51], v[224:227]
    ds_read_b128 v[28:31], v7 offset:44032
    ds_read_b128 v[144:147], v5 offset:256
    v_mfma_f32_16x16x32_bf16 v[228:231], v[12:15], v[52:55], v[228:231]
    ds_read_b128 v[148:151], v5 offset:320
    v_mfma_f32_16x16x32_bf16 v[232:235], v[12:15], v[56:59], v[232:235]
    v_mfma_f32_16x16x32_bf16 v[236:239], v[12:15], v[60:63], v[236:239]
    s_waitcnt lgkmcnt(11)
    v_mfma_f32_16x16x32_bf16 v[64:67], v[16:19], v[48:51], v[64:67]
    s_waitcnt lgkmcnt(0)
    s_barrier
    v_mfma_f32_16x16x32_bf16 v[68:71], v[16:19], v[52:55], v[68:71]
    s_add_u32 m0, s49, 0
    v_add_u32 v4, 0x1b000, v4
    ds_read_b128 v[8:11], v4 offset:0
    v_mfma_f32_16x16x32_bf16 v[72:75], v[16:19], v[56:59], v[72:75]
    s_add_u32 s61, s48, 147456
    v_mfma_f32_16x16x32_bf16 v[76:79], v[16:19], v[60:63], v[76:79]
    v_mfma_f32_16x16x32_bf16 v[80:83], v[20:23], v[48:51], v[80:83]
    ds_read_b128 v[12:15], v4 offset:1024
    v_mfma_f32_16x16x32_bf16 v[84:87], v[20:23], v[52:55], v[84:87]
    buffer_load_dwordx4 v2, s[4:7], s61 offen offset:0 lds
    v_mfma_f32_16x16x32_bf16 v[88:91], v[20:23], v[56:59], v[88:91]
    v_mfma_f32_16x16x32_bf16 v[92:95], v[20:23], v[60:63], v[92:95]
    v_mfma_f32_16x16x32_bf16 v[96:99], v[24:27], v[48:51], v[96:99]
    ds_read_b128 v[16:19], v4 offset:2048
    v_mfma_f32_16x16x32_bf16 v[100:103], v[24:27], v[52:55], v[100:103]
    buffer_load_dwordx4 v2, s[4:7], s61 offen offset:1024 lds
    v_mfma_f32_16x16x32_bf16 v[104:107], v[24:27], v[56:59], v[104:107]
    v_mfma_f32_16x16x32_bf16 v[108:111], v[24:27], v[60:63], v[108:111]
    v_mfma_f32_16x16x32_bf16 v[112:115], v[28:31], v[48:51], v[112:115]
    ds_read_b128 v[20:23], v4 offset:3072
    v_mfma_f32_16x16x32_bf16 v[116:119], v[28:31], v[52:55], v[116:119]
    buffer_load_dwordx4 v2, s[4:7], s61 offen offset:2048 lds
    v_mfma_f32_16x16x32_bf16 v[120:123], v[28:31], v[56:59], v[120:123]
    v_mfma_f32_16x16x32_bf16 v[124:127], v[28:31], v[60:63], v[124:127]
    s_waitcnt lgkmcnt(3)
    v_mfma_f32_16x16x32_bf16 v[192:195], v[8:11], a[0:3], 0
    ds_read_b128 v[24:27], v4 offset:4096
    v_mfma_f32_16x16x32_bf16 v[196:199], v[8:11], a[4:7], 0
    buffer_load_dwordx4 v2, s[4:7], s61 offen offset:3072 lds
    v_mfma_f32_16x16x32_bf16 v[200:203], v[8:11], a[8:11], 0
    s_add_u32 m0, s49, 4096
    s_add_u32 s61, s48, 151552
    v_mfma_f32_16x16x32_bf16 v[204:207], v[8:11], a[12:15], 0
    s_waitcnt lgkmcnt(3)
    v_mfma_f32_16x16x32_bf16 v[152:155], v[12:15], a[0:3], 0
    ds_read_b128 v[28:31], v4 offset:5120
    v_mfma_f32_16x16x32_bf16 v[156:159], v[12:15], a[4:7], 0
    buffer_load_dwordx4 v2, s[4:7], s61 offen offset:0 lds
    v_mfma_f32_16x16x32_bf16 v[160:163], v[12:15], a[8:11], 0
    v_fmac_f32 v64, v136, v128
    v_fmac_f32 v65, v137, v128
    v_mfma_f32_16x16x32_bf16 v[164:167], v[12:15], a[12:15], 0
    s_waitcnt lgkmcnt(3)
    v_fmac_f32 v66, v138, v128
    v_fmac_f32 v67, v139, v128
    v_mfma_f32_16x16x32_bf16 v[192:195], v[16:19], a[16:19], v[192:195]
    ds_read_b128 v[8:11], v4 offset:6144
    v_fmac_f32 v80, v140, v128
    v_mfma_f32_16x16x32_bf16 v[196:199], v[16:19], a[20:23], v[196:199]
    buffer_load_dwordx4 v2, s[4:7], s61 offen offset:1024 lds
    v_mfma_f32_16x16x32_bf16 v[200:203], v[16:19], a[24:27], v[200:203]
    v_fmac_f32 v81, v141, v128
    v_fmac_f32 v82, v142, v128
    v_mfma_f32_16x16x32_bf16 v[204:207], v[16:19], a[28:31], v[204:207]
    s_waitcnt lgkmcnt(3)
    v_fmac_f32 v83, v143, v128
    v_mul_f32 v64, v64, v132
    v_mfma_f32_16x16x32_bf16 v[152:155], v[20:23], a[16:19], v[152:155]
    ds_read_b128 v[12:15], v4 offset:7168
    v_mul_f32 v65, v65, v132
    v_mfma_f32_16x16x32_bf16 v[156:159], v[20:23], a[20:23], v[156:159]
    buffer_load_dwordx4 v2, s[4:7], s61 offen offset:2048 lds
    v_mfma_f32_16x16x32_bf16 v[160:163], v[20:23], a[24:27], v[160:163]
    v_mul_f32 v66, v66, v132
    v_mul_f32 v67, v67, v132
    v_mfma_f32_16x16x32_bf16 v[164:167], v[20:23], a[28:31], v[164:167]
    s_waitcnt lgkmcnt(3)
    v_mul_f32 v64, v64, v80
    v_mul_f32 v65, v65, v81
    v_mfma_f32_16x16x32_bf16 v[192:195], v[24:27], a[32:35], v[192:195]
    ds_read_b128 v[16:19], v4 offset:8192
    v_mul_f32 v66, v66, v82
    v_mfma_f32_16x16x32_bf16 v[196:199], v[24:27], a[36:39], v[196:199]
    buffer_load_dwordx4 v2, s[4:7], s61 offen offset:3072 lds
    v_mfma_f32_16x16x32_bf16 v[200:203], v[24:27], a[40:43], v[200:203]
    s_add_u32 m0, s49, 8192
    s_add_u32 s61, s48, 155648
    v_mul_f32 v67, v67, v83
    v_mfma_f32_16x16x32_bf16 v[204:207], v[24:27], a[44:47], v[204:207]
    s_waitcnt lgkmcnt(3)
    v_cvt_pk_bf16_f32 v176, v64, v65
    v_cvt_pk_bf16_f32 v177, v66, v67
    v_mfma_f32_16x16x32_bf16 v[152:155], v[28:31], a[32:35], v[152:155]
    ds_read_b128 v[20:23], v4 offset:9216
    v_fmac_f32 v68, v136, v129
    v_mfma_f32_16x16x32_bf16 v[156:159], v[28:31], a[36:39], v[156:159]
    buffer_load_dwordx4 v2, s[4:7], s61 offen offset:0 lds
    v_mfma_f32_16x16x32_bf16 v[160:163], v[28:31], a[40:43], v[160:163]
    s_add_u32 m0, s49, 36864
    s_add_u32 s61, s48, 184320
    v_fmac_f32 v69, v137, v129
    v_mfma_f32_16x16x32_bf16 v[164:167], v[28:31], a[44:47], v[164:167]
    s_waitcnt lgkmcnt(3)
    v_fmac_f32 v70, v138, v129
    v_fmac_f32 v71, v139, v129
    v_mfma_f32_16x16x32_bf16 v[192:195], v[8:11], a[48:51], v[192:195]
    ds_read_b128 v[24:27], v4 offset:10240
    v_fmac_f32 v84, v140, v129
    v_mfma_f32_16x16x32_bf16 v[196:199], v[8:11], a[52:55], v[196:199]
    buffer_load_dwordx4 v2, s[4:7], s61 offen offset:0 lds
    v_mfma_f32_16x16x32_bf16 v[200:203], v[8:11], a[56:59], v[200:203]
    v_fmac_f32 v85, v141, v129
    v_fmac_f32 v86, v142, v129
    v_mfma_f32_16x16x32_bf16 v[204:207], v[8:11], a[60:63], v[204:207]
    s_waitcnt lgkmcnt(3)
    v_fmac_f32 v87, v143, v129
    v_mul_f32 v68, v68, v133
    v_mfma_f32_16x16x32_bf16 v[152:155], v[12:15], a[48:51], v[152:155]
    ds_read_b128 v[28:31], v4 offset:11264
    v_mul_f32 v69, v69, v133
    v_mfma_f32_16x16x32_bf16 v[156:159], v[12:15], a[52:55], v[156:159]
    buffer_load_dwordx4 v2, s[4:7], s61 offen offset:1024 lds
    v_mfma_f32_16x16x32_bf16 v[160:163], v[12:15], a[56:59], v[160:163]
    v_mul_f32 v70, v70, v133
    v_mul_f32 v71, v71, v133
    v_mfma_f32_16x16x32_bf16 v[164:167], v[12:15], a[60:63], v[164:167]
    s_waitcnt lgkmcnt(3)
    v_mul_f32 v68, v68, v84
    v_mul_f32 v69, v69, v85
    v_mfma_f32_16x16x32_bf16 v[192:195], v[16:19], a[64:67], v[192:195]
    ds_read_b128 v[8:11], v4 offset:12288
    v_mul_f32 v70, v70, v86
    v_mfma_f32_16x16x32_bf16 v[196:199], v[16:19], a[68:71], v[196:199]
    buffer_load_dwordx4 v2, s[4:7], s61 offen offset:2048 lds
    v_mfma_f32_16x16x32_bf16 v[200:203], v[16:19], a[72:75], v[200:203]
    v_mul_f32 v71, v71, v87
    v_cvt_pk_bf16_f32 v180, v68, v69
    v_mfma_f32_16x16x32_bf16 v[204:207], v[16:19], a[76:79], v[204:207]
    s_waitcnt lgkmcnt(3)
    v_cvt_pk_bf16_f32 v181, v70, v71
    v_fmac_f32 v72, v136, v130
    v_mfma_f32_16x16x32_bf16 v[152:155], v[20:23], a[64:67], v[152:155]
    ds_read_b128 v[12:15], v4 offset:13312
    v_fmac_f32 v73, v137, v130
    v_mfma_f32_16x16x32_bf16 v[156:159], v[20:23], a[68:71], v[156:159]
    buffer_load_dwordx4 v2, s[4:7], s61 offen offset:3072 lds
    v_mfma_f32_16x16x32_bf16 v[160:163], v[20:23], a[72:75], v[160:163]
    s_add_u32 m0, s49, 40960
    s_add_u32 s61, s48, 188416
    v_fmac_f32 v74, v138, v130
    v_mfma_f32_16x16x32_bf16 v[164:167], v[20:23], a[76:79], v[164:167]
    s_waitcnt lgkmcnt(3)
    v_fmac_f32 v75, v139, v130
    v_fmac_f32 v88, v140, v130
    v_mfma_f32_16x16x32_bf16 v[192:195], v[24:27], a[80:83], v[192:195]
    ds_read_b128 v[16:19], v4 offset:14336
    v_fmac_f32 v89, v141, v130
    v_mfma_f32_16x16x32_bf16 v[196:199], v[24:27], a[84:87], v[196:199]
    buffer_load_dwordx4 v2, s[4:7], s61 offen offset:0 lds
    v_mfma_f32_16x16x32_bf16 v[200:203], v[24:27], a[88:91], v[200:203]
    v_fmac_f32 v90, v142, v130
    v_fmac_f32 v91, v143, v130
    v_mfma_f32_16x16x32_bf16 v[204:207], v[24:27], a[92:95], v[204:207]
    s_waitcnt lgkmcnt(3)
    v_mul_f32 v72, v72, v134
    v_mul_f32 v73, v73, v134
    v_mfma_f32_16x16x32_bf16 v[152:155], v[28:31], a[80:83], v[152:155]
    ds_read_b128 v[20:23], v4 offset:15360
    v_mul_f32 v74, v74, v134
    v_mfma_f32_16x16x32_bf16 v[156:159], v[28:31], a[84:87], v[156:159]
    buffer_load_dwordx4 v2, s[4:7], s61 offen offset:1024 lds
    v_mfma_f32_16x16x32_bf16 v[160:163], v[28:31], a[88:91], v[160:163]
    v_mul_f32 v75, v75, v134
    v_mul_f32 v72, v72, v88
    v_mfma_f32_16x16x32_bf16 v[164:167], v[28:31], a[92:95], v[164:167]
    s_waitcnt lgkmcnt(3)
    v_mul_f32 v73, v73, v89
    v_mul_f32 v74, v74, v90
    v_mfma_f32_16x16x32_bf16 v[192:195], v[8:11], a[96:99], v[192:195]
    ds_read_b128 v[24:27], v4 offset:16384
    v_mul_f32 v75, v75, v91
    v_mfma_f32_16x16x32_bf16 v[196:199], v[8:11], a[100:103], v[196:199]
    buffer_load_dwordx4 v2, s[4:7], s61 offen offset:2048 lds
    v_mfma_f32_16x16x32_bf16 v[200:203], v[8:11], a[104:107], v[200:203]
    v_cvt_pk_bf16_f32 v184, v72, v73
    v_cvt_pk_bf16_f32 v185, v74, v75
    v_mfma_f32_16x16x32_bf16 v[204:207], v[8:11], a[108:111], v[204:207]
    s_waitcnt lgkmcnt(3)
    v_fmac_f32 v76, v136, v131
    v_fmac_f32 v77, v137, v131
    v_mfma_f32_16x16x32_bf16 v[152:155], v[12:15], a[96:99], v[152:155]
    ds_read_b128 v[28:31], v4 offset:17408
    v_fmac_f32 v78, v138, v131
    v_mfma_f32_16x16x32_bf16 v[156:159], v[12:15], a[100:103], v[156:159]
    buffer_load_dwordx4 v2, s[4:7], s61 offen offset:3072 lds
    v_mfma_f32_16x16x32_bf16 v[160:163], v[12:15], a[104:107], v[160:163]
    s_add_u32 m0, s49, 45056
    s_add_u32 s61, s48, 192512
    v_fmac_f32 v79, v139, v131
    v_mfma_f32_16x16x32_bf16 v[164:167], v[12:15], a[108:111], v[164:167]
    s_waitcnt lgkmcnt(3)
    v_fmac_f32 v92, v140, v131
    v_fmac_f32 v93, v141, v131
    v_mfma_f32_16x16x32_bf16 v[192:195], v[16:19], a[112:115], v[192:195]
    ds_read_b128 v[8:11], v4 offset:18432
    v_fmac_f32 v94, v142, v131
    v_mfma_f32_16x16x32_bf16 v[196:199], v[16:19], a[116:119], v[196:199]
    buffer_load_dwordx4 v2, s[4:7], s61 offen offset:0 lds
    v_mfma_f32_16x16x32_bf16 v[200:203], v[16:19], a[120:123], v[200:203]
    s_add_u32 m0, s49, 73728
    s_add_u32 s61, s48, 221184
    v_fmac_f32 v95, v143, v131
    v_mfma_f32_16x16x32_bf16 v[204:207], v[16:19], a[124:127], v[204:207]
    s_waitcnt lgkmcnt(3)
    v_mul_f32 v76, v76, v135
    v_mul_f32 v77, v77, v135
    v_mfma_f32_16x16x32_bf16 v[152:155], v[20:23], a[112:115], v[152:155]
    ds_read_b128 v[12:15], v4 offset:19456
    v_mul_f32 v78, v78, v135
    v_mfma_f32_16x16x32_bf16 v[156:159], v[20:23], a[116:119], v[156:159]
    buffer_load_dwordx4 v2, s[4:7], s61 offen offset:0 lds
    v_mfma_f32_16x16x32_bf16 v[160:163], v[20:23], a[120:123], v[160:163]
    v_mul_f32 v79, v79, v135
    v_mul_f32 v76, v76, v92
    v_mfma_f32_16x16x32_bf16 v[164:167], v[20:23], a[124:127], v[164:167]
    s_waitcnt lgkmcnt(3)
    v_mul_f32 v77, v77, v93
    v_mul_f32 v78, v78, v94
    v_mfma_f32_16x16x32_bf16 v[192:195], v[24:27], a[128:131], v[192:195]
    ds_read_b128 v[16:19], v4 offset:20480
    v_mul_f32 v79, v79, v95
    v_mfma_f32_16x16x32_bf16 v[196:199], v[24:27], a[132:135], v[196:199]
    buffer_load_dwordx4 v2, s[4:7], s61 offen offset:1024 lds
    v_mfma_f32_16x16x32_bf16 v[200:203], v[24:27], a[136:139], v[200:203]
    v_cvt_pk_bf16_f32 v188, v76, v77
    v_cvt_pk_bf16_f32 v189, v78, v79
    v_mfma_f32_16x16x32_bf16 v[204:207], v[24:27], a[140:143], v[204:207]
    s_waitcnt lgkmcnt(3)
    ds_read_b128 v[136:139], v5 offset:0
    ds_read_b128 v[140:143], v5 offset:64
    v_mfma_f32_16x16x32_bf16 v[152:155], v[28:31], a[128:131], v[152:155]
    ds_read_b128 v[20:23], v4 offset:21504
    v_fmac_f32 v96, v144, v128
    v_mfma_f32_16x16x32_bf16 v[156:159], v[28:31], a[132:135], v[156:159]
    buffer_load_dwordx4 v2, s[4:7], s61 offen offset:2048 lds
    v_mfma_f32_16x16x32_bf16 v[160:163], v[28:31], a[136:139], v[160:163]
    v_fmac_f32 v97, v145, v128
    v_fmac_f32 v98, v146, v128
    v_mfma_f32_16x16x32_bf16 v[164:167], v[28:31], a[140:143], v[164:167]
    s_waitcnt lgkmcnt(5)
    v_fmac_f32 v99, v147, v128
    v_fmac_f32 v112, v148, v128
    v_mfma_f32_16x16x32_bf16 v[192:195], v[8:11], a[144:147], v[192:195]
    ds_read_b128 v[24:27], v4 offset:22528
    v_fmac_f32 v113, v149, v128
    v_mfma_f32_16x16x32_bf16 v[196:199], v[8:11], a[148:151], v[196:199]
    buffer_load_dwordx4 v2, s[4:7], s61 offen offset:3072 lds
    v_mfma_f32_16x16x32_bf16 v[200:203], v[8:11], a[152:155], v[200:203]
    s_add_u32 m0, s49, 77824
    s_add_u32 s61, s48, 225280
    v_fmac_f32 v114, v150, v128
    v_mfma_f32_16x16x32_bf16 v[204:207], v[8:11], a[156:159], v[204:207]
    s_waitcnt lgkmcnt(5)
    v_fmac_f32 v115, v151, v128
    v_mul_f32 v96, v96, v132
    v_mfma_f32_16x16x32_bf16 v[152:155], v[12:15], a[144:147], v[152:155]
    ds_read_b128 v[28:31], v4 offset:23552
    v_mul_f32 v97, v97, v132
    v_mfma_f32_16x16x32_bf16 v[156:159], v[12:15], a[148:151], v[156:159]
    buffer_load_dwordx4 v2, s[4:7], s61 offen offset:0 lds
    v_mfma_f32_16x16x32_bf16 v[160:163], v[12:15], a[152:155], v[160:163]
    v_mul_f32 v98, v98, v132
    v_mul_f32 v99, v99, v132
    v_mfma_f32_16x16x32_bf16 v[164:167], v[12:15], a[156:159], v[164:167]
    s_waitcnt lgkmcnt(5)
    v_mul_f32 v96, v96, v112
    v_mul_f32 v97, v97, v113
    v_mfma_f32_16x16x32_bf16 v[192:195], v[16:19], a[160:163], v[192:195]
    ds_read_b128 v[8:11], v4 offset:24576
    v_mul_f32 v98, v98, v114
    v_mfma_f32_16x16x32_bf16 v[196:199], v[16:19], a[164:167], v[196:199]
    buffer_load_dwordx4 v2, s[4:7], s61 offen offset:1024 lds
    v_mfma_f32_16x16x32_bf16 v[200:203], v[16:19], a[168:171], v[200:203]
    v_mul_f32 v99, v99, v115
    v_cvt_pk_bf16_f32 v178, v96, v97
    v_mfma_f32_16x16x32_bf16 v[204:207], v[16:19], a[172:175], v[204:207]
    s_waitcnt lgkmcnt(3)
    v_cvt_pk_bf16_f32 v179, v98, v99
    v_mfma_f32_16x16x32_bf16 v[152:155], v[20:23], a[160:163], v[152:155]
    s_add_u32 s66, s51, 0
    ds_read_b128 v[12:15], v4 offset:25600
    v_mfma_f32_16x16x32_bf16 v[156:159], v[20:23], a[164:167], v[156:159]
    buffer_store_dwordx4 v[176:179], v2, s[4:7], s66 offen offset:0 sc1
    v_mfma_f32_16x16x32_bf16 v[160:163], v[20:23], a[168:171], v[160:163]
    v_fmac_f32 v100, v144, v129
    v_fmac_f32 v101, v145, v129
    v_mfma_f32_16x16x32_bf16 v[164:167], v[20:23], a[172:175], v[164:167]
    s_waitcnt lgkmcnt(3)
    v_fmac_f32 v102, v146, v129
    v_fmac_f32 v103, v147, v129
    v_mfma_f32_16x16x32_bf16 v[192:195], v[24:27], a[176:179], v[192:195]
    ds_read_b128 v[16:19], v4 offset:26624
    v_fmac_f32 v116, v148, v129
    v_mfma_f32_16x16x32_bf16 v[196:199], v[24:27], a[180:183], v[196:199]
    buffer_load_dwordx4 v2, s[4:7], s61 offen offset:2048 lds
    v_mfma_f32_16x16x32_bf16 v[200:203], v[24:27], a[184:187], v[200:203]
    v_fmac_f32 v117, v149, v129
    v_fmac_f32 v118, v150, v129
    v_mfma_f32_16x16x32_bf16 v[204:207], v[24:27], a[188:191], v[204:207]
    s_waitcnt lgkmcnt(3)
    v_fmac_f32 v119, v151, v129
    v_mul_f32 v100, v100, v133
    v_mfma_f32_16x16x32_bf16 v[152:155], v[28:31], a[176:179], v[152:155]
    ds_read_b128 v[20:23], v4 offset:27648
    v_mul_f32 v101, v101, v133
    v_mfma_f32_16x16x32_bf16 v[156:159], v[28:31], a[180:183], v[156:159]
    buffer_load_dwordx4 v2, s[4:7], s61 offen offset:3072 lds
    v_mfma_f32_16x16x32_bf16 v[160:163], v[28:31], a[184:187], v[160:163]
    s_add_u32 m0, s49, 81920
    s_add_u32 s61, s48, 229376
    v_mul_f32 v102, v102, v133
    v_mfma_f32_16x16x32_bf16 v[164:167], v[28:31], a[188:191], v[164:167]
    s_waitcnt lgkmcnt(3)
    v_mul_f32 v103, v103, v133
    v_mul_f32 v100, v100, v116
    v_mfma_f32_16x16x32_bf16 v[192:195], v[8:11], a[192:195], v[192:195]
    ds_read_b128 v[24:27], v4 offset:28672
    v_mul_f32 v101, v101, v117
    v_mfma_f32_16x16x32_bf16 v[196:199], v[8:11], a[196:199], v[196:199]
    buffer_load_dwordx4 v2, s[4:7], s61 offen offset:0 lds
    v_mfma_f32_16x16x32_bf16 v[200:203], v[8:11], a[200:203], v[200:203]
    v_mul_f32 v102, v102, v118
    v_mul_f32 v103, v103, v119
    v_mfma_f32_16x16x32_bf16 v[204:207], v[8:11], a[204:207], v[204:207]
    s_waitcnt lgkmcnt(3)
    v_cvt_pk_bf16_f32 v182, v100, v101
    v_cvt_pk_bf16_f32 v183, v102, v103
    v_mfma_f32_16x16x32_bf16 v[152:155], v[12:15], a[192:195], v[152:155]
    ds_read_b128 v[28:31], v4 offset:29696
    v_mfma_f32_16x16x32_bf16 v[156:159], v[12:15], a[196:199], v[156:159]
    buffer_store_dwordx4 v[180:183], v2, s[4:7], s66 offen offset:1024 sc1
    v_mfma_f32_16x16x32_bf16 v[160:163], v[12:15], a[200:203], v[160:163]
    v_fmac_f32 v104, v144, v130
    v_fmac_f32 v105, v145, v130
    v_mfma_f32_16x16x32_bf16 v[164:167], v[12:15], a[204:207], v[164:167]
    s_waitcnt lgkmcnt(3)
    v_fmac_f32 v106, v146, v130
    v_fmac_f32 v107, v147, v130
    v_mfma_f32_16x16x32_bf16 v[192:195], v[16:19], a[208:211], v[192:195]
    ds_read_b128 v[8:11], v4 offset:30720
    v_fmac_f32 v120, v148, v130
    v_mfma_f32_16x16x32_bf16 v[196:199], v[16:19], a[212:215], v[196:199]
    v_fmac_f32 v121, v149, v130
    v_fmac_f32 v122, v150, v130
    v_mfma_f32_16x16x32_bf16 v[200:203], v[16:19], a[216:219], v[200:203]
    v_fmac_f32 v123, v151, v130
    v_mul_f32 v104, v104, v134
    v_mfma_f32_16x16x32_bf16 v[204:207], v[16:19], a[220:223], v[204:207]
    s_waitcnt lgkmcnt(3)
    v_mul_f32 v105, v105, v134
    v_mul_f32 v106, v106, v134
    v_mfma_f32_16x16x32_bf16 v[152:155], v[20:23], a[208:211], v[152:155]
    ds_read_b128 v[12:15], v4 offset:31744
    v_mul_f32 v107, v107, v134
    v_mfma_f32_16x16x32_bf16 v[156:159], v[20:23], a[212:215], v[156:159]
    v_mul_f32 v104, v104, v120
    v_mul_f32 v105, v105, v121
    v_mfma_f32_16x16x32_bf16 v[160:163], v[20:23], a[216:219], v[160:163]
    v_mul_f32 v106, v106, v122
    v_mul_f32 v107, v107, v123
    v_mfma_f32_16x16x32_bf16 v[164:167], v[20:23], a[220:223], v[164:167]
    s_waitcnt lgkmcnt(3)
    v_cvt_pk_bf16_f32 v186, v104, v105
    v_cvt_pk_bf16_f32 v187, v106, v107
    v_mfma_f32_16x16x32_bf16 v[192:195], v[24:27], a[224:227], v[192:195]
    ds_read_b128 v[16:19], v4 offset:32768
    v_mfma_f32_16x16x32_bf16 v[196:199], v[24:27], a[228:231], v[196:199]
    buffer_store_dwordx4 v[184:187], v2, s[4:7], s66 offen offset:2048 sc1
    v_mfma_f32_16x16x32_bf16 v[200:203], v[24:27], a[232:235], v[200:203]
    v_fmac_f32 v108, v144, v131
    v_fmac_f32 v109, v145, v131
    v_mfma_f32_16x16x32_bf16 v[204:207], v[24:27], a[236:239], v[204:207]
    s_waitcnt lgkmcnt(3)
    v_fmac_f32 v110, v146, v131
    v_fmac_f32 v111, v147, v131
    v_mfma_f32_16x16x32_bf16 v[152:155], v[28:31], a[224:227], v[152:155]
    ds_read_b128 v[20:23], v4 offset:33792
    v_fmac_f32 v124, v148, v131
    v_mfma_f32_16x16x32_bf16 v[156:159], v[28:31], a[228:231], v[156:159]
    v_fmac_f32 v125, v149, v131
    v_fmac_f32 v126, v150, v131
    v_mfma_f32_16x16x32_bf16 v[160:163], v[28:31], a[232:235], v[160:163]
    v_fmac_f32 v127, v151, v131
    v_mul_f32 v108, v108, v135
    v_mfma_f32_16x16x32_bf16 v[164:167], v[28:31], a[236:239], v[164:167]
    s_waitcnt lgkmcnt(3)
    v_mul_f32 v109, v109, v135
    v_mul_f32 v110, v110, v135
    v_mfma_f32_16x16x32_bf16 v[192:195], v[8:11], a[240:243], v[192:195]
    ds_read_b128 v[24:27], v4 offset:34816
    v_mul_f32 v111, v111, v135
    v_mfma_f32_16x16x32_bf16 v[196:199], v[8:11], a[244:247], v[196:199]
    v_mul_f32 v108, v108, v124
    v_mul_f32 v109, v109, v125
    v_mfma_f32_16x16x32_bf16 v[200:203], v[8:11], a[248:251], v[200:203]
    v_mul_f32 v110, v110, v126
    v_mul_f32 v111, v111, v127
    v_mfma_f32_16x16x32_bf16 v[204:207], v[8:11], a[252:255], v[204:207]
    s_waitcnt lgkmcnt(3)
    v_cvt_pk_bf16_f32 v190, v108, v109
    v_cvt_pk_bf16_f32 v191, v110, v111
    v_mfma_f32_16x16x32_bf16 v[152:155], v[12:15], a[240:243], v[152:155]
    ds_read_b128 v[28:31], v4 offset:35840
    v_mfma_f32_16x16x32_bf16 v[156:159], v[12:15], a[244:247], v[156:159]
    buffer_store_dwordx4 v[188:191], v2, s[4:7], s66 offen offset:3072 sc1
    v_mfma_f32_16x16x32_bf16 v[160:163], v[12:15], a[248:251], v[160:163]
    ds_read_b128 v[144:147], v5 offset:384
    ds_read_b128 v[148:151], v5 offset:448
    v_mfma_f32_16x16x32_bf16 v[164:167], v[12:15], a[252:255], v[164:167]
    s_waitcnt lgkmcnt(5)
    v_fmac_f32 v208, v136, v128
    v_fmac_f32 v209, v137, v128
    v_mfma_f32_16x16x32_bf16 v[192:195], v[16:19], v[32:35], v[192:195]
    s_waitcnt vmcnt(22)
    s_barrier
    v_add_u32 v4, 0xfffe5000, v4
    v_mfma_f32_16x16x32_bf16 v[196:199], v[16:19], v[36:39], v[196:199]
    ds_read_b128 v[8:11], v4 offset:0
    v_fmac_f32 v210, v138, v128
    v_mfma_f32_16x16x32_bf16 v[200:203], v[16:19], v[40:43], v[200:203]
    v_fmac_f32 v211, v139, v128
    v_fmac_f32 v224, v140, v128
    v_mfma_f32_16x16x32_bf16 v[204:207], v[16:19], v[44:47], v[204:207]
    s_waitcnt lgkmcnt(5)
    v_fmac_f32 v225, v141, v128
    v_fmac_f32 v226, v142, v128
    v_mfma_f32_16x16x32_bf16 v[152:155], v[20:23], v[32:35], v[152:155]
    ds_read_b128 v[12:15], v4 offset:1024
    v_fmac_f32 v227, v143, v128
    v_mfma_f32_16x16x32_bf16 v[156:159], v[20:23], v[36:39], v[156:159]
    v_mul_f32 v208, v208, v132
    v_mul_f32 v209, v209, v132
    v_mfma_f32_16x16x32_bf16 v[160:163], v[20:23], v[40:43], v[160:163]
    v_mul_f32 v210, v210, v132
    v_mul_f32 v211, v211, v132
    v_mfma_f32_16x16x32_bf16 v[164:167], v[20:23], v[44:47], v[164:167]
    s_waitcnt lgkmcnt(5)
    v_mul_f32 v208, v208, v224
    v_mul_f32 v209, v209, v225
    v_mfma_f32_16x16x32_bf16 v[192:195], v[24:27], v[48:51], v[192:195]
    ds_read_b128 v[16:19], v4 offset:2048
    v_mul_f32 v210, v210, v226
    v_mfma_f32_16x16x32_bf16 v[196:199], v[24:27], v[52:55], v[196:199]
    v_mul_f32 v211, v211, v227
    v_cvt_pk_bf16_f32 v240, v208, v209
    v_mfma_f32_16x16x32_bf16 v[200:203], v[24:27], v[56:59], v[200:203]
    v_cvt_pk_bf16_f32 v241, v210, v211
    v_mfma_f32_16x16x32_bf16 v[204:207], v[24:27], v[60:63], v[204:207]
    s_waitcnt lgkmcnt(5)
    s_add_u32 s66, s51, s65
    v_mfma_f32_16x16x32_bf16 v[152:155], v[28:31], v[48:51], v[152:155]
    ds_read_b128 v[20:23], v4 offset:3072
    v_mfma_f32_16x16x32_bf16 v[156:159], v[28:31], v[52:55], v[156:159]
    buffer_store_dwordx2 v[240:241], v3, s[4:7], s66 offen offset:0 sc1
    v_mfma_f32_16x16x32_bf16 v[160:163], v[28:31], v[56:59], v[160:163]
    v_fmac_f32 v212, v136, v129
    v_fmac_f32 v213, v137, v129
    v_mfma_f32_16x16x32_bf16 v[164:167], v[28:31], v[60:63], v[164:167]
    s_waitcnt lgkmcnt(3)
    v_fmac_f32 v214, v138, v129
    v_fmac_f32 v215, v139, v129
    v_mfma_f32_16x16x32_bf16 v[96:99], v[8:11], a[0:3], 0
    ds_read_b128 v[24:27], v4 offset:4096
    v_fmac_f32 v228, v140, v129
    v_mfma_f32_16x16x32_bf16 v[100:103], v[8:11], a[4:7], 0
    v_fmac_f32 v229, v141, v129
    v_fmac_f32 v230, v142, v129
    v_mfma_f32_16x16x32_bf16 v[104:107], v[8:11], a[8:11], 0
    v_fmac_f32 v231, v143, v129
    v_mul_f32 v212, v212, v133
    v_mfma_f32_16x16x32_bf16 v[108:111], v[8:11], a[12:15], 0
    s_waitcnt lgkmcnt(3)
    v_mul_f32 v213, v213, v133
    v_mul_f32 v214, v214, v133
    v_mfma_f32_16x16x32_bf16 v[112:115], v[12:15], a[0:3], 0
    ds_read_b128 v[28:31], v4 offset:5120
    v_mul_f32 v215, v215, v133
    v_mfma_f32_16x16x32_bf16 v[116:119], v[12:15], a[4:7], 0
    v_mul_f32 v212, v212, v228
    v_mul_f32 v213, v213, v229
    v_mfma_f32_16x16x32_bf16 v[120:123], v[12:15], a[8:11], 0
    v_mul_f32 v214, v214, v230
    v_mul_f32 v215, v215, v231
    v_mfma_f32_16x16x32_bf16 v[124:127], v[12:15], a[12:15], 0
    s_waitcnt lgkmcnt(3)
    v_cvt_pk_bf16_f32 v244, v212, v213
    v_cvt_pk_bf16_f32 v245, v214, v215
    v_mfma_f32_16x16x32_bf16 v[96:99], v[16:19], a[16:19], v[96:99]
    ds_read_b128 v[8:11], v4 offset:6144
    v_mfma_f32_16x16x32_bf16 v[100:103], v[16:19], a[20:23], v[100:103]
    buffer_store_dwordx2 v[244:245], v3, s[4:7], s66 offen offset:512 sc1
    v_mfma_f32_16x16x32_bf16 v[104:107], v[16:19], a[24:27], v[104:107]
    v_fmac_f32 v216, v136, v130
    v_fmac_f32 v217, v137, v130
    v_mfma_f32_16x16x32_bf16 v[108:111], v[16:19], a[28:31], v[108:111]
    s_waitcnt lgkmcnt(3)
    v_fmac_f32 v218, v138, v130
    v_fmac_f32 v219, v139, v130
    v_mfma_f32_16x16x32_bf16 v[112:115], v[20:23], a[16:19], v[112:115]
    ds_read_b128 v[12:15], v4 offset:7168
    v_fmac_f32 v232, v140, v130
    v_mfma_f32_16x16x32_bf16 v[116:119], v[20:23], a[20:23], v[116:119]
    v_fmac_f32 v233, v141, v130
    v_fmac_f32 v234, v142, v130
    v_mfma_f32_16x16x32_bf16 v[120:123], v[20:23], a[24:27], v[120:123]
    v_fmac_f32 v235, v143, v130
    v_mul_f32 v216, v216, v134
    v_mfma_f32_16x16x32_bf16 v[124:127], v[20:23], a[28:31], v[124:127]
    s_waitcnt lgkmcnt(3)
    v_mul_f32 v217, v217, v134
    v_mul_f32 v218, v218, v134
    v_mfma_f32_16x16x32_bf16 v[96:99], v[24:27], a[32:35], v[96:99]
    ds_read_b128 v[16:19], v4 offset:8192
    v_mul_f32 v219, v219, v134
    v_mfma_f32_16x16x32_bf16 v[100:103], v[24:27], a[36:39], v[100:103]
    v_mul_f32 v216, v216, v232
    v_mul_f32 v217, v217, v233
    v_mfma_f32_16x16x32_bf16 v[104:107], v[24:27], a[40:43], v[104:107]
    v_mul_f32 v218, v218, v234
    v_mul_f32 v219, v219, v235
    v_mfma_f32_16x16x32_bf16 v[108:111], v[24:27], a[44:47], v[108:111]
    s_waitcnt lgkmcnt(3)
    v_cvt_pk_bf16_f32 v248, v216, v217
    v_cvt_pk_bf16_f32 v249, v218, v219
    v_mfma_f32_16x16x32_bf16 v[112:115], v[28:31], a[32:35], v[112:115]
    ds_read_b128 v[20:23], v4 offset:9216
    v_mfma_f32_16x16x32_bf16 v[116:119], v[28:31], a[36:39], v[116:119]
    buffer_store_dwordx2 v[248:249], v3, s[4:7], s66 offen offset:1024 sc1
    v_mfma_f32_16x16x32_bf16 v[120:123], v[28:31], a[40:43], v[120:123]
    v_fmac_f32 v220, v136, v131
    v_fmac_f32 v221, v137, v131
    v_mfma_f32_16x16x32_bf16 v[124:127], v[28:31], a[44:47], v[124:127]
    s_waitcnt lgkmcnt(3)
    v_fmac_f32 v222, v138, v131
    v_fmac_f32 v223, v139, v131
    v_mfma_f32_16x16x32_bf16 v[96:99], v[8:11], a[48:51], v[96:99]
    ds_read_b128 v[24:27], v4 offset:10240
    v_fmac_f32 v236, v140, v131
    v_mfma_f32_16x16x32_bf16 v[100:103], v[8:11], a[52:55], v[100:103]
    v_fmac_f32 v237, v141, v131
    v_fmac_f32 v238, v142, v131
    v_mfma_f32_16x16x32_bf16 v[104:107], v[8:11], a[56:59], v[104:107]
    v_fmac_f32 v239, v143, v131
    v_mul_f32 v220, v220, v135
    v_mfma_f32_16x16x32_bf16 v[108:111], v[8:11], a[60:63], v[108:111]
    s_waitcnt lgkmcnt(3)
    v_mul_f32 v221, v221, v135
    v_mul_f32 v222, v222, v135
    v_mfma_f32_16x16x32_bf16 v[112:115], v[12:15], a[48:51], v[112:115]
    ds_read_b128 v[28:31], v4 offset:11264
    v_mul_f32 v223, v223, v135
    v_mfma_f32_16x16x32_bf16 v[116:119], v[12:15], a[52:55], v[116:119]
    v_mul_f32 v220, v220, v236
    v_mul_f32 v221, v221, v237
    v_mfma_f32_16x16x32_bf16 v[120:123], v[12:15], a[56:59], v[120:123]
    v_mul_f32 v222, v222, v238
    v_mul_f32 v223, v223, v239
    v_mfma_f32_16x16x32_bf16 v[124:127], v[12:15], a[60:63], v[124:127]
    s_waitcnt lgkmcnt(3)
    v_cvt_pk_bf16_f32 v252, v220, v221
    v_cvt_pk_bf16_f32 v253, v222, v223
    v_mfma_f32_16x16x32_bf16 v[96:99], v[16:19], a[64:67], v[96:99]
    ds_read_b128 v[8:11], v4 offset:12288
    v_mfma_f32_16x16x32_bf16 v[100:103], v[16:19], a[68:71], v[100:103]
    buffer_store_dwordx2 v[252:253], v3, s[4:7], s66 offen offset:1536 sc1
    v_mfma_f32_16x16x32_bf16 v[104:107], v[16:19], a[72:75], v[104:107]
    ds_read_b128 v[136:139], v5 offset:512
    ds_read_b128 v[140:143], v5 offset:576
    v_mfma_f32_16x16x32_bf16 v[108:111], v[16:19], a[76:79], v[108:111]
    s_waitcnt lgkmcnt(5)
    v_fmac_f32 v192, v144, v128
    v_fmac_f32 v193, v145, v128
    v_mfma_f32_16x16x32_bf16 v[112:115], v[20:23], a[64:67], v[112:115]
    ds_read_b128 v[12:15], v4 offset:13312
    v_fmac_f32 v194, v146, v128
    v_mfma_f32_16x16x32_bf16 v[116:119], v[20:23], a[68:71], v[116:119]
    v_fmac_f32 v195, v147, v128
    v_fmac_f32 v152, v148, v128
    v_mfma_f32_16x16x32_bf16 v[120:123], v[20:23], a[72:75], v[120:123]
    v_fmac_f32 v153, v149, v128
    v_fmac_f32 v154, v150, v128
    v_mfma_f32_16x16x32_bf16 v[124:127], v[20:23], a[76:79], v[124:127]
    s_waitcnt lgkmcnt(5)
    v_fmac_f32 v155, v151, v128
    v_mul_f32 v192, v192, v132
    v_mfma_f32_16x16x32_bf16 v[96:99], v[24:27], a[80:83], v[96:99]
    ds_read_b128 v[16:19], v4 offset:14336
    v_mul_f32 v193, v193, v132
    v_mfma_f32_16x16x32_bf16 v[100:103], v[24:27], a[84:87], v[100:103]
    v_mul_f32 v194, v194, v132
    v_mul_f32 v195, v195, v132
    v_mfma_f32_16x16x32_bf16 v[104:107], v[24:27], a[88:91], v[104:107]
    v_mul_f32 v192, v192, v152
    v_mul_f32 v193, v193, v153
    v_mfma_f32_16x16x32_bf16 v[108:111], v[24:27], a[92:95], v[108:111]
    s_waitcnt lgkmcnt(5)
    v_mul_f32 v194, v194, v154
    v_mul_f32 v195, v195, v155
    v_mfma_f32_16x16x32_bf16 v[112:115], v[28:31], a[80:83], v[112:115]
    ds_read_b128 v[20:23], v4 offset:15360
    v_cvt_pk_bf16_f32 v192, v192, v193
    v_mfma_f32_16x16x32_bf16 v[116:119], v[28:31], a[84:87], v[116:119]
    v_cvt_pk_bf16_f32 v193, v194, v195
    v_fmac_f32 v196, v144, v129
    v_mfma_f32_16x16x32_bf16 v[120:123], v[28:31], a[88:91], v[120:123]
    v_fmac_f32 v197, v145, v129
    v_fmac_f32 v198, v146, v129
    v_mfma_f32_16x16x32_bf16 v[124:127], v[28:31], a[92:95], v[124:127]
    s_waitcnt lgkmcnt(5)
    v_fmac_f32 v199, v147, v129
    v_fmac_f32 v156, v148, v129
    v_mfma_f32_16x16x32_bf16 v[96:99], v[8:11], a[96:99], v[96:99]
    ds_read_b128 v[24:27], v4 offset:16384
    v_fmac_f32 v157, v149, v129
    v_mfma_f32_16x16x32_bf16 v[100:103], v[8:11], a[100:103], v[100:103]
    v_fmac_f32 v158, v150, v129
    v_fmac_f32 v159, v151, v129
    v_mfma_f32_16x16x32_bf16 v[104:107], v[8:11], a[104:107], v[104:107]
    v_mul_f32 v196, v196, v133
    v_mul_f32 v197, v197, v133
    v_mfma_f32_16x16x32_bf16 v[108:111], v[8:11], a[108:111], v[108:111]
    s_waitcnt lgkmcnt(3)
    v_mul_f32 v198, v198, v133
    v_mul_f32 v199, v199, v133
    v_mfma_f32_16x16x32_bf16 v[112:115], v[12:15], a[96:99], v[112:115]
    ds_read_b128 v[28:31], v4 offset:17408
    v_mul_f32 v196, v196, v156
    v_mfma_f32_16x16x32_bf16 v[116:119], v[12:15], a[100:103], v[116:119]
    v_mul_f32 v197, v197, v157
    v_mul_f32 v198, v198, v158
    v_mfma_f32_16x16x32_bf16 v[120:123], v[12:15], a[104:107], v[120:123]
    v_mul_f32 v199, v199, v159
    v_cvt_pk_bf16_f32 v196, v196, v197
    v_mfma_f32_16x16x32_bf16 v[124:127], v[12:15], a[108:111], v[124:127]
    s_waitcnt lgkmcnt(3)
    v_cvt_pk_bf16_f32 v197, v198, v199
    v_fmac_f32 v200, v144, v130
    v_mfma_f32_16x16x32_bf16 v[96:99], v[16:19], a[112:115], v[96:99]
    ds_read_b128 v[8:11], v4 offset:18432
    v_fmac_f32 v201, v145, v130
    v_mfma_f32_16x16x32_bf16 v[100:103], v[16:19], a[116:119], v[100:103]
    v_fmac_f32 v202, v146, v130
    v_fmac_f32 v203, v147, v130
    v_mfma_f32_16x16x32_bf16 v[104:107], v[16:19], a[120:123], v[104:107]
    v_fmac_f32 v160, v148, v130
    v_fmac_f32 v161, v149, v130
    v_mfma_f32_16x16x32_bf16 v[108:111], v[16:19], a[124:127], v[108:111]
    s_waitcnt lgkmcnt(3)
    v_fmac_f32 v162, v150, v130
    v_fmac_f32 v163, v151, v130
    v_mfma_f32_16x16x32_bf16 v[112:115], v[20:23], a[112:115], v[112:115]
    ds_read_b128 v[12:15], v4 offset:19456
    v_mul_f32 v200, v200, v134
    v_mfma_f32_16x16x32_bf16 v[116:119], v[20:23], a[116:119], v[116:119]
    v_mul_f32 v201, v201, v134
    v_mul_f32 v202, v202, v134
    v_mfma_f32_16x16x32_bf16 v[120:123], v[20:23], a[120:123], v[120:123]
    v_mul_f32 v203, v203, v134
    v_mul_f32 v200, v200, v160
    v_mfma_f32_16x16x32_bf16 v[124:127], v[20:23], a[124:127], v[124:127]
    s_waitcnt lgkmcnt(3)
    v_mul_f32 v201, v201, v161
    v_mul_f32 v202, v202, v162
    v_mfma_f32_16x16x32_bf16 v[96:99], v[24:27], a[128:131], v[96:99]
    ds_read_b128 v[16:19], v4 offset:20480
    v_mul_f32 v203, v203, v163
    v_mfma_f32_16x16x32_bf16 v[100:103], v[24:27], a[132:135], v[100:103]
    v_min_u32 v0, 17, v1
    v_lshlrev_b32 v0, 3, v0
    v_mfma_f32_16x16x32_bf16 v[104:107], v[24:27], a[136:139], v[104:107]
    s_add_u32 s55, s64, 288
    v_cvt_pk_bf16_f32 v200, v200, v201
    v_cvt_pk_bf16_f32 v201, v202, v203
    v_mfma_f32_16x16x32_bf16 v[108:111], v[24:27], a[140:143], v[108:111]
    s_waitcnt lgkmcnt(3)
    v_fmac_f32 v204, v144, v131
    v_fmac_f32 v205, v145, v131
    v_mfma_f32_16x16x32_bf16 v[112:115], v[28:31], a[128:131], v[112:115]
    ds_read_b128 v[20:23], v4 offset:21504
    v_fmac_f32 v206, v146, v131
    v_mfma_f32_16x16x32_bf16 v[116:119], v[28:31], a[132:135], v[116:119]
    buffer_load_dwordx2 v[6:7], v0, s[4:7], s55 offen sc1
    v_mfma_f32_16x16x32_bf16 v[120:123], v[28:31], a[136:139], v[120:123]
    v_fmac_f32 v207, v147, v131
    v_fmac_f32 v164, v148, v131
    v_mfma_f32_16x16x32_bf16 v[124:127], v[28:31], a[140:143], v[124:127]
    s_waitcnt lgkmcnt(3)
    v_fmac_f32 v165, v149, v131
    v_fmac_f32 v166, v150, v131
    v_mfma_f32_16x16x32_bf16 v[96:99], v[8:11], a[144:147], v[96:99]
    ds_read_b128 v[24:27], v4 offset:22528
    v_fmac_f32 v167, v151, v131
    v_mfma_f32_16x16x32_bf16 v[100:103], v[8:11], a[148:151], v[100:103]
    v_mul_f32 v204, v204, v135
    v_mul_f32 v205, v205, v135
    v_mfma_f32_16x16x32_bf16 v[104:107], v[8:11], a[152:155], v[104:107]
    v_mul_f32 v206, v206, v135
    v_mul_f32 v207, v207, v135
    v_mfma_f32_16x16x32_bf16 v[108:111], v[8:11], a[156:159], v[108:111]
    s_waitcnt lgkmcnt(3)
    v_mul_f32 v204, v204, v164
    v_mul_f32 v205, v205, v165
    v_mfma_f32_16x16x32_bf16 v[112:115], v[12:15], a[144:147], v[112:115]
    ds_read_b128 v[28:31], v4 offset:23552
    v_mul_f32 v206, v206, v166
    v_mfma_f32_16x16x32_bf16 v[116:119], v[12:15], a[148:151], v[116:119]
    v_mul_f32 v207, v207, v167
    v_cvt_pk_bf16_f32 v204, v204, v205
    v_mfma_f32_16x16x32_bf16 v[120:123], v[12:15], a[152:155], v[120:123]
    v_cvt_pk_bf16_f32 v205, v206, v207
    v_mfma_f32_16x16x32_bf16 v[124:127], v[12:15], a[156:159], v[124:127]
    s_waitcnt lgkmcnt(3)
    ds_read_b128 v[144:147], v5 offset:640
    ds_read_b128 v[148:151], v5 offset:704
    v_mfma_f32_16x16x32_bf16 v[96:99], v[16:19], a[160:163], v[96:99]
    ds_read_b128 v[8:11], v4 offset:24576
    v_mfma_f32_16x16x32_bf16 v[100:103], v[16:19], a[164:167], v[100:103]
    v_mfma_f32_16x16x32_bf16 v[104:107], v[16:19], a[168:171], v[104:107]
    v_mfma_f32_16x16x32_bf16 v[108:111], v[16:19], a[172:175], v[108:111]
    s_waitcnt lgkmcnt(5)
    v_mfma_f32_16x16x32_bf16 v[112:115], v[20:23], a[160:163], v[112:115]
    ds_read_b128 v[12:15], v4 offset:25600
    v_mfma_f32_16x16x32_bf16 v[116:119], v[20:23], a[164:167], v[116:119]
    v_mfma_f32_16x16x32_bf16 v[120:123], v[20:23], a[168:171], v[120:123]
    v_mfma_f32_16x16x32_bf16 v[124:127], v[20:23], a[172:175], v[124:127]
    s_waitcnt lgkmcnt(5)
    v_mfma_f32_16x16x32_bf16 v[96:99], v[24:27], a[176:179], v[96:99]
    ds_read_b128 v[16:19], v4 offset:26624
    v_mfma_f32_16x16x32_bf16 v[100:103], v[24:27], a[180:183], v[100:103]
    v_mfma_f32_16x16x32_bf16 v[104:107], v[24:27], a[184:187], v[104:107]
    v_mfma_f32_16x16x32_bf16 v[108:111], v[24:27], a[188:191], v[108:111]
    s_waitcnt lgkmcnt(5)
    v_mfma_f32_16x16x32_bf16 v[112:115], v[28:31], a[176:179], v[112:115]
    ds_read_b128 v[20:23], v4 offset:27648
    v_mfma_f32_16x16x32_bf16 v[116:119], v[28:31], a[180:183], v[116:119]
    v_mfma_f32_16x16x32_bf16 v[120:123], v[28:31], a[184:187], v[120:123]
    v_mfma_f32_16x16x32_bf16 v[124:127], v[28:31], a[188:191], v[124:127]
    s_waitcnt lgkmcnt(3)
    v_mfma_f32_16x16x32_bf16 v[96:99], v[8:11], a[192:195], v[96:99]
    ds_read_b128 v[24:27], v4 offset:28672
    v_mfma_f32_16x16x32_bf16 v[100:103], v[8:11], a[196:199], v[100:103]
    v_mfma_f32_16x16x32_bf16 v[104:107], v[8:11], a[200:203], v[104:107]
    v_mfma_f32_16x16x32_bf16 v[108:111], v[8:11], a[204:207], v[108:111]
    s_waitcnt lgkmcnt(3)
    v_mfma_f32_16x16x32_bf16 v[112:115], v[12:15], a[192:195], v[112:115]
    ds_read_b128 v[28:31], v4 offset:29696
    v_mfma_f32_16x16x32_bf16 v[116:119], v[12:15], a[196:199], v[116:119]
    v_mfma_f32_16x16x32_bf16 v[120:123], v[12:15], a[200:203], v[120:123]
    v_mfma_f32_16x16x32_bf16 v[124:127], v[12:15], a[204:207], v[124:127]
    s_waitcnt lgkmcnt(3)
    v_mfma_f32_16x16x32_bf16 v[96:99], v[16:19], a[208:211], v[96:99]
    ds_read_b128 v[8:11], v4 offset:30720
    v_mfma_f32_16x16x32_bf16 v[100:103], v[16:19], a[212:215], v[100:103]
    v_mfma_f32_16x16x32_bf16 v[104:107], v[16:19], a[216:219], v[104:107]
    v_mfma_f32_16x16x32_bf16 v[108:111], v[16:19], a[220:223], v[108:111]
    s_waitcnt lgkmcnt(3)
    v_mfma_f32_16x16x32_bf16 v[112:115], v[20:23], a[208:211], v[112:115]
    ds_read_b128 v[12:15], v4 offset:31744
    v_mfma_f32_16x16x32_bf16 v[116:119], v[20:23], a[212:215], v[116:119]
    v_mfma_f32_16x16x32_bf16 v[120:123], v[20:23], a[216:219], v[120:123]
    v_mfma_f32_16x16x32_bf16 v[124:127], v[20:23], a[220:223], v[124:127]
    s_waitcnt lgkmcnt(3)
    v_mfma_f32_16x16x32_bf16 v[96:99], v[24:27], a[224:227], v[96:99]
    ds_read_b128 v[16:19], v4 offset:32768
    v_mfma_f32_16x16x32_bf16 v[100:103], v[24:27], a[228:231], v[100:103]
    v_mfma_f32_16x16x32_bf16 v[104:107], v[24:27], a[232:235], v[104:107]
    v_mfma_f32_16x16x32_bf16 v[108:111], v[24:27], a[236:239], v[108:111]
    s_waitcnt lgkmcnt(3)
    v_mfma_f32_16x16x32_bf16 v[112:115], v[28:31], a[224:227], v[112:115]
    ds_read_b128 v[20:23], v4 offset:33792
    v_mfma_f32_16x16x32_bf16 v[116:119], v[28:31], a[228:231], v[116:119]
    v_mfma_f32_16x16x32_bf16 v[120:123], v[28:31], a[232:235], v[120:123]
    v_mfma_f32_16x16x32_bf16 v[124:127], v[28:31], a[236:239], v[124:127]
    s_waitcnt lgkmcnt(3)
    v_mfma_f32_16x16x32_bf16 v[96:99], v[8:11], a[240:243], v[96:99]
    ds_read_b128 v[24:27], v4 offset:34816
    v_mfma_f32_16x16x32_bf16 v[100:103], v[8:11], a[244:247], v[100:103]
    v_mfma_f32_16x16x32_bf16 v[104:107], v[8:11], a[248:251], v[104:107]
    v_mfma_f32_16x16x32_bf16 v[108:111], v[8:11], a[252:255], v[108:111]
    s_waitcnt lgkmcnt(3)
    v_mfma_f32_16x16x32_bf16 v[112:115], v[12:15], a[240:243], v[112:115]
    ds_read_b128 v[28:31], v4 offset:35840
    v_mfma_f32_16x16x32_bf16 v[116:119], v[12:15], a[244:247], v[116:119]
    s_waitcnt vmcnt(0)
    v_cmp_eq_u64 vcc, s[98:99], v[6:7]
    s_nop 0
    s_cmp_eq_u64 vcc, exec
    s_cbranch_scc0 L_pd_slow_79
L_pd_back_80:
    v_mfma_f32_16x16x32_bf16 v[120:123], v[12:15], a[248:251], v[120:123]
    v_mfma_f32_16x16x32_bf16 v[124:127], v[12:15], a[252:255], v[124:127]
    s_waitcnt lgkmcnt(3)
    s_lshr_b32 s55, s22, 2
    s_lshl_b32 s55, s55, 2
    v_mfma_f32_16x16x32_bf16 v[96:99], v[16:19], v[32:35], v[96:99]
    s_barrier
    v_add_u32 v4, 0x9000, v4
    v_mfma_f32_16x16x32_bf16 v[100:103], v[16:19], v[36:39], v[100:103]
    s_add_u32 m0, s49, 110592
    s_add_u32 s61, s48, 258048
    ds_read_b128 v[8:11], v4 offset:0
    v_mfma_f32_16x16x32_bf16 v[104:107], v[16:19], v[40:43], v[104:107]
    buffer_load_dwordx4 v2, s[4:7], s61 offen offset:0 lds
    v_mfma_f32_16x16x32_bf16 v[108:111], v[16:19], v[44:47], v[108:111]
    s_waitcnt lgkmcnt(3)
    s_add_u32 s55, s55, s20
    s_mul_i32 s55, s55, 5248
    v_mfma_f32_16x16x32_bf16 v[112:115], v[20:23], v[32:35], v[112:115]
    s_mul_i32 s60, s47, 497664
    s_add_u32 s55, s55, s60
    ds_read_b128 v[12:15], v4 offset:1024
    v_mfma_f32_16x16x32_bf16 v[116:119], v[20:23], v[36:39], v[116:119]
    s_add_u32 s55, s55, 4526080
    v_min_u32 v0, 40, v1
    v_lshlrev_b32 v0, 7, v0
    v_mfma_f32_16x16x32_bf16 v[120:123], v[20:23], v[40:43], v[120:123]
    buffer_load_dwordx4 v2, s[4:7], s61 offen offset:1024 lds
    v_mfma_f32_16x16x32_bf16 v[124:127], v[20:23], v[44:47], v[124:127]
    s_waitcnt lgkmcnt(3)
    v_mfma_f32_16x16x32_bf16 v[96:99], v[24:27], v[48:51], v[96:99]
    ds_read_b128 v[16:19], v4 offset:2048
    v_mfma_f32_16x16x32_bf16 v[100:103], v[24:27], v[52:55], v[100:103]
    v_mfma_f32_16x16x32_bf16 v[104:107], v[24:27], v[56:59], v[104:107]
    buffer_load_dwordx4 v2, s[4:7], s61 offen offset:2048 lds
    v_mfma_f32_16x16x32_bf16 v[108:111], v[24:27], v[60:63], v[108:111]
    s_waitcnt lgkmcnt(3)
    v_mfma_f32_16x16x32_bf16 v[112:115], v[28:31], v[48:51], v[112:115]
    ds_read_b128 v[20:23], v4 offset:3072
    v_mfma_f32_16x16x32_bf16 v[116:119], v[28:31], v[52:55], v[116:119]
    v_mfma_f32_16x16x32_bf16 v[120:123], v[28:31], v[56:59], v[120:123]
    buffer_load_dwordx4 v2, s[4:7], s61 offen offset:3072 lds
    v_mfma_f32_16x16x32_bf16 v[124:127], v[28:31], v[60:63], v[124:127]
    s_waitcnt lgkmcnt(3)
    s_add_u32 m0, s49, 114688
    s_add_u32 s61, s48, 262144
    v_mfma_f32_16x16x32_bf16 v[64:67], v[8:11], a[0:3], 0
    ds_read_b128 v[24:27], v4 offset:4096
    v_mfma_f32_16x16x32_bf16 v[68:71], v[8:11], a[4:7], 0
    v_mfma_f32_16x16x32_bf16 v[72:75], v[8:11], a[8:11], 0
    buffer_load_dwordx4 v2, s[4:7], s61 offen offset:0 lds
    v_mfma_f32_16x16x32_bf16 v[76:79], v[8:11], a[12:15], 0
    s_waitcnt lgkmcnt(3)
    v_mfma_f32_16x16x32_bf16 v[80:83], v[12:15], a[0:3], 0
    ds_read_b128 v[28:31], v4 offset:5120
    v_mfma_f32_16x16x32_bf16 v[84:87], v[12:15], a[4:7], 0
    v_fmac_f32 v96, v136, v128
    v_fmac_f32 v97, v137, v128
    v_mfma_f32_16x16x32_bf16 v[88:91], v[12:15], a[8:11], 0
    buffer_load_dwordx4 v2, s[4:7], s61 offen offset:1024 lds
    v_mfma_f32_16x16x32_bf16 v[92:95], v[12:15], a[12:15], 0
    s_waitcnt lgkmcnt(3)
    v_fmac_f32 v98, v138, v128
    v_fmac_f32 v99, v139, v128
    v_mfma_f32_16x16x32_bf16 v[64:67], v[16:19], a[16:19], v[64:67]
    ds_read_b128 v[8:11], v4 offset:6144
    v_fmac_f32 v112, v140, v128
    v_mfma_f32_16x16x32_bf16 v[68:71], v[16:19], a[20:23], v[68:71]
    v_fmac_f32 v113, v141, v128
    v_fmac_f32 v114, v142, v128
    v_mfma_f32_16x16x32_bf16 v[72:75], v[16:19], a[24:27], v[72:75]
    buffer_load_dwordx4 v2, s[4:7], s61 offen offset:2048 lds
    v_mfma_f32_16x16x32_bf16 v[76:79], v[16:19], a[28:31], v[76:79]
    s_waitcnt lgkmcnt(3)
    v_fmac_f32 v115, v143, v128
    v_mul_f32 v96, v96, v132
    v_mfma_f32_16x16x32_bf16 v[80:83], v[20:23], a[16:19], v[80:83]
    ds_read_b128 v[12:15], v4 offset:7168
    v_mul_f32 v97, v97, v132
    v_mfma_f32_16x16x32_bf16 v[84:87], v[20:23], a[20:23], v[84:87]
    v_mul_f32 v98, v98, v132
    v_mul_f32 v99, v99, v132
    v_mfma_f32_16x16x32_bf16 v[88:91], v[20:23], a[24:27], v[88:91]
    buffer_load_dwordx4 v2, s[4:7], s61 offen offset:3072 lds
    v_mfma_f32_16x16x32_bf16 v[92:95], v[20:23], a[28:31], v[92:95]
    s_waitcnt lgkmcnt(3)
    s_add_u32 m0, s49, 118784
    s_add_u32 s61, s48, 266240
    v_mfma_f32_16x16x32_bf16 v[64:67], v[24:27], a[32:35], v[64:67]
    ds_read_b128 v[16:19], v4 offset:8192
    v_mul_f32 v96, v96, v112
    v_mfma_f32_16x16x32_bf16 v[68:71], v[24:27], a[36:39], v[68:71]
    v_mul_f32 v97, v97, v113
    v_mul_f32 v98, v98, v114
    v_mfma_f32_16x16x32_bf16 v[72:75], v[24:27], a[40:43], v[72:75]
    buffer_load_dwordx4 v2, s[4:7], s61 offen offset:0 lds
    v_mfma_f32_16x16x32_bf16 v[76:79], v[24:27], a[44:47], v[76:79]
    s_waitcnt lgkmcnt(3)
    v_mul_f32 v99, v99, v115
    v_cvt_pk_bf16_f32 v194, v96, v97
    v_mfma_f32_16x16x32_bf16 v[80:83], v[28:31], a[32:35], v[80:83]
    ds_read_b128 v[20:23], v4 offset:9216
    v_cvt_pk_bf16_f32 v195, v98, v99
    v_mfma_f32_16x16x32_bf16 v[84:87], v[28:31], a[36:39], v[84:87]
    s_add_u32 s66, s51, 16384
    v_mfma_f32_16x16x32_bf16 v[88:91], v[28:31], a[40:43], v[88:91]
    buffer_store_dwordx4 v[192:195], v2, s[4:7], s66 offen offset:0 sc1
    v_mfma_f32_16x16x32_bf16 v[92:95], v[28:31], a[44:47], v[92:95]
    s_waitcnt lgkmcnt(3)
    v_fmac_f32 v100, v136, v129
    v_fmac_f32 v101, v137, v129
    v_mfma_f32_16x16x32_bf16 v[64:67], v[8:11], a[48:51], v[64:67]
    ds_read_b128 v[24:27], v4 offset:10240
    v_fmac_f32 v102, v138, v129
    v_mfma_f32_16x16x32_bf16 v[68:71], v[8:11], a[52:55], v[68:71]
    v_fmac_f32 v103, v139, v129
    v_fmac_f32 v116, v140, v129
    v_mfma_f32_16x16x32_bf16 v[72:75], v[8:11], a[56:59], v[72:75]
    buffer_load_dword v6, v0, s[4:7], s55 offen
    v_mfma_f32_16x16x32_bf16 v[76:79], v[8:11], a[60:63], v[76:79]
    s_waitcnt lgkmcnt(3)
    v_fmac_f32 v117, v141, v129
    v_fmac_f32 v118, v142, v129
    v_mfma_f32_16x16x32_bf16 v[80:83], v[12:15], a[48:51], v[80:83]
    ds_read_b128 v[28:31], v4 offset:11264
    v_fmac_f32 v119, v143, v129
    v_mfma_f32_16x16x32_bf16 v[84:87], v[12:15], a[52:55], v[84:87]
    v_mul_f32 v100, v100, v133
    v_mul_f32 v101, v101, v133
    v_mfma_f32_16x16x32_bf16 v[88:91], v[12:15], a[56:59], v[88:91]
    v_mul_f32 v102, v102, v133
    v_mul_f32 v103, v103, v133
    v_mfma_f32_16x16x32_bf16 v[92:95], v[12:15], a[60:63], v[92:95]
    s_waitcnt lgkmcnt(3)
    v_mul_f32 v100, v100, v116
    v_mul_f32 v101, v101, v117
    v_mfma_f32_16x16x32_bf16 v[64:67], v[16:19], a[64:67], v[64:67]
    ds_read_b128 v[8:11], v4 offset:12288
    v_mul_f32 v102, v102, v118
    v_mfma_f32_16x16x32_bf16 v[68:71], v[16:19], a[68:71], v[68:71]
    v_mul_f32 v103, v103, v119
    v_cvt_pk_bf16_f32 v198, v100, v101
    v_mfma_f32_16x16x32_bf16 v[72:75], v[16:19], a[72:75], v[72:75]
    v_cvt_pk_bf16_f32 v199, v102, v103
    v_mfma_f32_16x16x32_bf16 v[76:79], v[16:19], a[76:79], v[76:79]
    s_waitcnt lgkmcnt(3)
    v_mfma_f32_16x16x32_bf16 v[80:83], v[20:23], a[64:67], v[80:83]
    ds_read_b128 v[12:15], v4 offset:13312
    v_mfma_f32_16x16x32_bf16 v[84:87], v[20:23], a[68:71], v[84:87]
    buffer_store_dwordx4 v[196:199], v2, s[4:7], s66 offen offset:1024 sc1
    v_mfma_f32_16x16x32_bf16 v[88:91], v[20:23], a[72:75], v[88:91]
    v_fmac_f32 v104, v136, v130
    v_fmac_f32 v105, v137, v130
    v_mfma_f32_16x16x32_bf16 v[92:95], v[20:23], a[76:79], v[92:95]
    s_waitcnt lgkmcnt(3)
    v_fmac_f32 v106, v138, v130
    v_fmac_f32 v107, v139, v130
    v_mfma_f32_16x16x32_bf16 v[64:67], v[24:27], a[80:83], v[64:67]
    ds_read_b128 v[16:19], v4 offset:14336
    v_fmac_f32 v120, v140, v130
    v_mfma_f32_16x16x32_bf16 v[68:71], v[24:27], a[84:87], v[68:71]
    v_fmac_f32 v121, v141, v130
    v_fmac_f32 v122, v142, v130
    v_mfma_f32_16x16x32_bf16 v[72:75], v[24:27], a[88:91], v[72:75]
    v_fmac_f32 v123, v143, v130
    v_mul_f32 v104, v104, v134
    v_mfma_f32_16x16x32_bf16 v[76:79], v[24:27], a[92:95], v[76:79]
    s_waitcnt lgkmcnt(3)
    v_mul_f32 v105, v105, v134
    v_mul_f32 v106, v106, v134
    v_mfma_f32_16x16x32_bf16 v[80:83], v[28:31], a[80:83], v[80:83]
    ds_read_b128 v[20:23], v4 offset:15360
    v_mul_f32 v107, v107, v134
    v_mfma_f32_16x16x32_bf16 v[84:87], v[28:31], a[84:87], v[84:87]
    v_mul_f32 v104, v104, v120
    v_mul_f32 v105, v105, v121
    v_mfma_f32_16x16x32_bf16 v[88:91], v[28:31], a[88:91], v[88:91]
    v_mul_f32 v106, v106, v122
    v_mul_f32 v107, v107, v123
    v_mfma_f32_16x16x32_bf16 v[92:95], v[28:31], a[92:95], v[92:95]
    s_waitcnt lgkmcnt(3)
    v_cvt_pk_bf16_f32 v202, v104, v105
    v_cvt_pk_bf16_f32 v203, v106, v107
    v_mfma_f32_16x16x32_bf16 v[64:67], v[8:11], a[96:99], v[64:67]
    ds_read_b128 v[24:27], v4 offset:16384
    v_mfma_f32_16x16x32_bf16 v[68:71], v[8:11], a[100:103], v[68:71]
    buffer_store_dwordx4 v[200:203], v2, s[4:7], s66 offen offset:2048 sc1
    v_mfma_f32_16x16x32_bf16 v[72:75], v[8:11], a[104:107], v[72:75]
    v_fmac_f32 v108, v136, v131
    v_fmac_f32 v109, v137, v131
    v_mfma_f32_16x16x32_bf16 v[76:79], v[8:11], a[108:111], v[76:79]
    s_waitcnt lgkmcnt(3)
    v_fmac_f32 v110, v138, v131
    v_fmac_f32 v111, v139, v131
    v_mfma_f32_16x16x32_bf16 v[80:83], v[12:15], a[96:99], v[80:83]
    ds_read_b128 v[28:31], v4 offset:17408
    v_fmac_f32 v124, v140, v131
    v_mfma_f32_16x16x32_bf16 v[84:87], v[12:15], a[100:103], v[84:87]
    v_fmac_f32 v125, v141, v131
    v_fmac_f32 v126, v142, v131
    v_mfma_f32_16x16x32_bf16 v[88:91], v[12:15], a[104:107], v[88:91]
    v_fmac_f32 v127, v143, v131
    v_mul_f32 v108, v108, v135
    v_mfma_f32_16x16x32_bf16 v[92:95], v[12:15], a[108:111], v[92:95]
    s_waitcnt lgkmcnt(3)
    v_mul_f32 v109, v109, v135
    v_mul_f32 v110, v110, v135
    v_mfma_f32_16x16x32_bf16 v[64:67], v[16:19], a[112:115], v[64:67]
    ds_read_b128 v[8:11], v4 offset:18432
    v_mul_f32 v111, v111, v135
    v_mfma_f32_16x16x32_bf16 v[68:71], v[16:19], a[116:119], v[68:71]
    v_mul_f32 v108, v108, v124
    v_mul_f32 v109, v109, v125
    v_mfma_f32_16x16x32_bf16 v[72:75], v[16:19], a[120:123], v[72:75]
    v_mul_f32 v110, v110, v126
    v_mul_f32 v111, v111, v127
    v_mfma_f32_16x16x32_bf16 v[76:79], v[16:19], a[124:127], v[76:79]
    s_waitcnt lgkmcnt(3)
    v_cvt_pk_bf16_f32 v206, v108, v109
    v_cvt_pk_bf16_f32 v207, v110, v111
    v_mfma_f32_16x16x32_bf16 v[80:83], v[20:23], a[112:115], v[80:83]
    ds_read_b128 v[12:15], v4 offset:19456
    v_mfma_f32_16x16x32_bf16 v[84:87], v[20:23], a[116:119], v[84:87]
    buffer_store_dwordx4 v[204:207], v2, s[4:7], s66 offen offset:3072 sc1
    v_mfma_f32_16x16x32_bf16 v[88:91], v[20:23], a[120:123], v[88:91]
    ds_read_b128 v[136:139], v5 offset:768
    ds_read_b128 v[140:143], v5 offset:832
    v_mfma_f32_16x16x32_bf16 v[92:95], v[20:23], a[124:127], v[92:95]
    s_waitcnt lgkmcnt(5)
    v_mfma_f32_16x16x32_bf16 v[64:67], v[24:27], a[128:131], v[64:67]
    ds_read_b128 v[16:19], v4 offset:20480
    v_mfma_f32_16x16x32_bf16 v[68:71], v[24:27], a[132:135], v[68:71]
    v_mfma_f32_16x16x32_bf16 v[72:75], v[24:27], a[136:139], v[72:75]
    v_mfma_f32_16x16x32_bf16 v[76:79], v[24:27], a[140:143], v[76:79]
    s_waitcnt lgkmcnt(5)
    v_mfma_f32_16x16x32_bf16 v[80:83], v[28:31], a[128:131], v[80:83]
    ds_read_b128 v[20:23], v4 offset:21504
    v_mfma_f32_16x16x32_bf16 v[84:87], v[28:31], a[132:135], v[84:87]
    v_mfma_f32_16x16x32_bf16 v[88:91], v[28:31], a[136:139], v[88:91]
    v_mfma_f32_16x16x32_bf16 v[92:95], v[28:31], a[140:143], v[92:95]
    s_waitcnt lgkmcnt(5)
    v_mfma_f32_16x16x32_bf16 v[64:67], v[8:11], a[144:147], v[64:67]
    ds_read_b128 v[24:27], v4 offset:22528
    v_mfma_f32_16x16x32_bf16 v[68:71], v[8:11], a[148:151], v[68:71]
    v_mfma_f32_16x16x32_bf16 v[72:75], v[8:11], a[152:155], v[72:75]
    v_mfma_f32_16x16x32_bf16 v[76:79], v[8:11], a[156:159], v[76:79]
    s_waitcnt lgkmcnt(5)
    v_mfma_f32_16x16x32_bf16 v[80:83], v[12:15], a[144:147], v[80:83]
    ds_read_b128 v[28:31], v4 offset:23552
    v_mfma_f32_16x16x32_bf16 v[84:87], v[12:15], a[148:151], v[84:87]
    v_mfma_f32_16x16x32_bf16 v[88:91], v[12:15], a[152:155], v[88:91]
    v_mfma_f32_16x16x32_bf16 v[92:95], v[12:15], a[156:159], v[92:95]
    s_waitcnt lgkmcnt(3)
    v_mfma_f32_16x16x32_bf16 v[64:67], v[16:19], a[160:163], v[64:67]
    ds_read_b128 v[8:11], v4 offset:24576
    v_mfma_f32_16x16x32_bf16 v[68:71], v[16:19], a[164:167], v[68:71]
    v_mfma_f32_16x16x32_bf16 v[72:75], v[16:19], a[168:171], v[72:75]
    v_mfma_f32_16x16x32_bf16 v[76:79], v[16:19], a[172:175], v[76:79]
    s_waitcnt lgkmcnt(3)
    v_mfma_f32_16x16x32_bf16 v[80:83], v[20:23], a[160:163], v[80:83]
    ds_read_b128 v[12:15], v4 offset:25600
    v_mfma_f32_16x16x32_bf16 v[84:87], v[20:23], a[164:167], v[84:87]
    v_mfma_f32_16x16x32_bf16 v[88:91], v[20:23], a[168:171], v[88:91]
    v_mfma_f32_16x16x32_bf16 v[92:95], v[20:23], a[172:175], v[92:95]
    s_waitcnt lgkmcnt(3)
    v_mfma_f32_16x16x32_bf16 v[64:67], v[24:27], a[176:179], v[64:67]
    ds_read_b128 v[16:19], v4 offset:26624
    v_mfma_f32_16x16x32_bf16 v[68:71], v[24:27], a[180:183], v[68:71]
    v_mfma_f32_16x16x32_bf16 v[72:75], v[24:27], a[184:187], v[72:75]
    v_mfma_f32_16x16x32_bf16 v[76:79], v[24:27], a[188:191], v[76:79]
    s_waitcnt lgkmcnt(3)
    v_mfma_f32_16x16x32_bf16 v[80:83], v[28:31], a[176:179], v[80:83]
    ds_read_b128 v[20:23], v4 offset:27648
    v_mfma_f32_16x16x32_bf16 v[84:87], v[28:31], a[180:183], v[84:87]
    v_mfma_f32_16x16x32_bf16 v[88:91], v[28:31], a[184:187], v[88:91]
    v_mfma_f32_16x16x32_bf16 v[92:95], v[28:31], a[188:191], v[92:95]
    s_waitcnt lgkmcnt(3)
    v_mfma_f32_16x16x32_bf16 v[64:67], v[8:11], a[192:195], v[64:67]
    ds_read_b128 v[24:27], v4 offset:28672
    v_mfma_f32_16x16x32_bf16 v[68:71], v[8:11], a[196:199], v[68:71]
    v_mfma_f32_16x16x32_bf16 v[72:75], v[8:11], a[200:203], v[72:75]
    v_mfma_f32_16x16x32_bf16 v[76:79], v[8:11], a[204:207], v[76:79]
    s_waitcnt lgkmcnt(3)
    v_mfma_f32_16x16x32_bf16 v[80:83], v[12:15], a[192:195], v[80:83]
    ds_read_b128 v[28:31], v4 offset:29696
    v_mfma_f32_16x16x32_bf16 v[84:87], v[12:15], a[196:199], v[84:87]
    v_mfma_f32_16x16x32_bf16 v[88:91], v[12:15], a[200:203], v[88:91]
    v_mfma_f32_16x16x32_bf16 v[92:95], v[12:15], a[204:207], v[92:95]
    s_waitcnt lgkmcnt(3)
    v_mfma_f32_16x16x32_bf16 v[64:67], v[16:19], a[208:211], v[64:67]
    ds_read_b128 v[8:11], v4 offset:30720
    v_mfma_f32_16x16x32_bf16 v[68:71], v[16:19], a[212:215], v[68:71]
    v_mfma_f32_16x16x32_bf16 v[72:75], v[16:19], a[216:219], v[72:75]
    v_mfma_f32_16x16x32_bf16 v[76:79], v[16:19], a[220:223], v[76:79]
    s_waitcnt lgkmcnt(3)
    v_mfma_f32_16x16x32_bf16 v[80:83], v[20:23], a[208:211], v[80:83]
    ds_read_b128 v[12:15], v4 offset:31744
    v_mfma_f32_16x16x32_bf16 v[84:87], v[20:23], a[212:215], v[84:87]
    v_mfma_f32_16x16x32_bf16 v[88:91], v[20:23], a[216:219], v[88:91]
    v_mfma_f32_16x16x32_bf16 v[92:95], v[20:23], a[220:223], v[92:95]
    s_waitcnt lgkmcnt(3)
    v_mfma_f32_16x16x32_bf16 v[64:67], v[24:27], a[224:227], v[64:67]
    ds_read_b128 v[16:19], v4 offset:32768
    v_mfma_f32_16x16x32_bf16 v[68:71], v[24:27], a[228:231], v[68:71]
    v_mfma_f32_16x16x32_bf16 v[72:75], v[24:27], a[232:235], v[72:75]
    v_mfma_f32_16x16x32_bf16 v[76:79], v[24:27], a[236:239], v[76:79]
    s_waitcnt lgkmcnt(3)
    v_mfma_f32_16x16x32_bf16 v[80:83], v[28:31], a[224:227], v[80:83]
    ds_read_b128 v[20:23], v4 offset:33792
    v_mfma_f32_16x16x32_bf16 v[84:87], v[28:31], a[228:231], v[84:87]
    v_mfma_f32_16x16x32_bf16 v[88:91], v[28:31], a[232:235], v[88:91]
    v_mfma_f32_16x16x32_bf16 v[92:95], v[28:31], a[236:239], v[92:95]
    s_waitcnt lgkmcnt(3)
    v_mfma_f32_16x16x32_bf16 v[64:67], v[8:11], a[240:243], v[64:67]
    ds_read_b128 v[24:27], v4 offset:34816
    v_mfma_f32_16x16x32_bf16 v[68:71], v[8:11], a[244:247], v[68:71]
    v_mfma_f32_16x16x32_bf16 v[72:75], v[8:11], a[248:251], v[72:75]
    v_mfma_f32_16x16x32_bf16 v[76:79], v[8:11], a[252:255], v[76:79]
    s_waitcnt lgkmcnt(3)
    v_mfma_f32_16x16x32_bf16 v[80:83], v[12:15], a[240:243], v[80:83]
    ds_read_b128 v[28:31], v4 offset:35840
    v_mfma_f32_16x16x32_bf16 v[84:87], v[12:15], a[244:247], v[84:87]
    v_mfma_f32_16x16x32_bf16 v[88:91], v[12:15], a[248:251], v[88:91]
    v_mfma_f32_16x16x32_bf16 v[92:95], v[12:15], a[252:255], v[92:95]
    s_waitcnt lgkmcnt(3)
    v_mfma_f32_16x16x32_bf16 v[64:67], v[16:19], v[32:35], v[64:67]
    s_barrier
    v_add_u32 v4, 0x9000, v4
    v_mfma_f32_16x16x32_bf16 v[68:71], v[16:19], v[36:39], v[68:71]
    s_add_u32 m0, s49, 0
    s_add_u32 s61, s48, 294912
    ds_read_b128 v[8:11], v4 offset:0
    v_mfma_f32_16x16x32_bf16 v[72:75], v[16:19], v[40:43], v[72:75]
    buffer_load_dwordx4 v2, s[4:7], s61 offen offset:0 lds
    v_mfma_f32_16x16x32_bf16 v[76:79], v[16:19], v[44:47], v[76:79]
    s_waitcnt lgkmcnt(3)
    v_mfma_f32_16x16x32_bf16 v[80:83], v[20:23], v[32:35], v[80:83]
    ds_read_b128 v[12:15], v4 offset:1024
    v_mfma_f32_16x16x32_bf16 v[84:87], v[20:23], v[36:39], v[84:87]
    v_mfma_f32_16x16x32_bf16 v[88:91], v[20:23], v[40:43], v[88:91]
    buffer_load_dwordx4 v2, s[4:7], s61 offen offset:1024 lds
    v_mfma_f32_16x16x32_bf16 v[92:95], v[20:23], v[44:47], v[92:95]
    s_waitcnt lgkmcnt(3)
    s_add_u32 s71, s67, 0
    s_waitcnt vmcnt(5)
    v_mov_b32 v6, s98
    v_mfma_f32_16x16x32_bf16 v[64:67], v[24:27], v[48:51], v[64:67]
    ds_read_b128 v[16:19], v4 offset:2048
    v_mov_b32 v7, s99
    v_mfma_f32_16x16x32_bf16 v[68:71], v[24:27], v[52:55], v[68:71]
    s_waitcnt vmcnt(2)
    v_mfma_f32_16x16x32_bf16 v[72:75], v[24:27], v[56:59], v[72:75]
    s_mov_b64 exec, 1
    buffer_store_dwordx2 v[6:7], off, s[4:7], s71 sc1
    s_mov_b64 exec, -1
    v_mfma_f32_16x16x32_bf16 v[76:79], v[24:27], v[60:63], v[76:79]
    s_waitcnt lgkmcnt(3)
    v_mfma_f32_16x16x32_bf16 v[80:83], v[28:31], v[48:51], v[80:83]
    ds_read_b128 v[20:23], v4 offset:3072
    v_mfma_f32_16x16x32_bf16 v[84:87], v[28:31], v[52:55], v[84:87]
    v_mfma_f32_16x16x32_bf16 v[88:91], v[28:31], v[56:59], v[88:91]
    buffer_load_dwordx4 v2, s[4:7], s61 offen offset:2048 lds
    v_mfma_f32_16x16x32_bf16 v[92:95], v[28:31], v[60:63], v[92:95]
    s_waitcnt lgkmcnt(3)
    v_mfma_f32_16x16x32_bf16 v[96:99], v[8:11], a[0:3], 0
    ds_read_b128 v[24:27], v4 offset:4096
    v_mfma_f32_16x16x32_bf16 v[100:103], v[8:11], a[4:7], 0
    v_mfma_f32_16x16x32_bf16 v[104:107], v[8:11], a[8:11], 0
    buffer_load_dwordx4 v2, s[4:7], s61 offen offset:3072 lds
    v_mfma_f32_16x16x32_bf16 v[108:111], v[8:11], a[12:15], 0
    s_waitcnt lgkmcnt(3)
    s_add_u32 m0, s49, 4096
    s_add_u32 s61, s48, 299008
    v_mfma_f32_16x16x32_bf16 v[112:115], v[12:15], a[0:3], 0
    ds_read_b128 v[28:31], v4 offset:5120
    v_mfma_f32_16x16x32_bf16 v[116:119], v[12:15], a[4:7], 0
    v_fmac_f32 v64, v144, v128
    v_fmac_f32 v65, v145, v128
    v_mfma_f32_16x16x32_bf16 v[120:123], v[12:15], a[8:11], 0
    buffer_load_dwordx4 v2, s[4:7], s61 offen offset:0 lds
    v_mfma_f32_16x16x32_bf16 v[124:127], v[12:15], a[12:15], 0
    s_waitcnt lgkmcnt(3)
    v_fmac_f32 v66, v146, v128
    v_fmac_f32 v67, v147, v128
    v_mfma_f32_16x16x32_bf16 v[96:99], v[16:19], a[16:19], v[96:99]
    ds_read_b128 v[8:11], v4 offset:6144
    v_fmac_f32 v80, v148, v128
    v_mfma_f32_16x16x32_bf16 v[100:103], v[16:19], a[20:23], v[100:103]
    v_fmac_f32 v81, v149, v128
    v_fmac_f32 v82, v150, v128
    v_mfma_f32_16x16x32_bf16 v[104:107], v[16:19], a[24:27], v[104:107]
    buffer_load_dwordx4 v2, s[4:7], s61 offen offset:1024 lds
    v_mfma_f32_16x16x32_bf16 v[108:111], v[16:19], a[28:31], v[108:111]
    s_waitcnt lgkmcnt(3)
    v_fmac_f32 v83, v151, v128
    v_mul_f32 v64, v64, v132
    v_mfma_f32_16x16x32_bf16 v[112:115], v[20:23], a[16:19], v[112:115]
    ds_read_b128 v[12:15], v4 offset:7168
    v_mul_f32 v65, v65, v132
    v_mfma_f32_16x16x32_bf16 v[116:119], v[20:23], a[20:23], v[116:119]
    v_mul_f32 v66, v66, v132
    v_mul_f32 v67, v67, v132
    v_mfma_f32_16x16x32_bf16 v[120:123], v[20:23], a[24:27], v[120:123]
    buffer_load_dwordx4 v2, s[4:7], s61 offen offset:2048 lds
    v_mfma_f32_16x16x32_bf16 v[124:127], v[20:23], a[28:31], v[124:127]
    s_waitcnt lgkmcnt(3)
    v_mul_f32 v64, v64, v80
    v_mul_f32 v65, v65, v81
    v_mfma_f32_16x16x32_bf16 v[96:99], v[24:27], a[32:35], v[96:99]
    ds_read_b128 v[16:19], v4 offset:8192
    v_mul_f32 v66, v66, v82
    v_mfma_f32_16x16x32_bf16 v[100:103], v[24:27], a[36:39], v[100:103]
    v_mul_f32 v67, v67, v83
    v_cvt_pk_bf16_f32 v208, v64, v65
    v_mfma_f32_16x16x32_bf16 v[104:107], v[24:27], a[40:43], v[104:107]
    buffer_load_dwordx4 v2, s[4:7], s61 offen offset:3072 lds
    v_mfma_f32_16x16x32_bf16 v[108:111], v[24:27], a[44:47], v[108:111]
    s_waitcnt lgkmcnt(3)
    s_add_u32 m0, s49, 8192
    s_add_u32 s61, s48, 303104
    v_mfma_f32_16x16x32_bf16 v[112:115], v[28:31], a[32:35], v[112:115]
    ds_read_b128 v[20:23], v4 offset:9216
    v_cvt_pk_bf16_f32 v209, v66, v67
    v_mfma_f32_16x16x32_bf16 v[116:119], v[28:31], a[36:39], v[116:119]
    v_fmac_f32 v68, v144, v129
    v_fmac_f32 v69, v145, v129
    v_mfma_f32_16x16x32_bf16 v[120:123], v[28:31], a[40:43], v[120:123]
    buffer_load_dwordx4 v2, s[4:7], s61 offen offset:0 lds
    v_mfma_f32_16x16x32_bf16 v[124:127], v[28:31], a[44:47], v[124:127]
    s_waitcnt lgkmcnt(3)
    v_fmac_f32 v70, v146, v129
    v_fmac_f32 v71, v147, v129
    v_mfma_f32_16x16x32_bf16 v[96:99], v[8:11], a[48:51], v[96:99]
    ds_read_b128 v[24:27], v4 offset:10240
    v_fmac_f32 v84, v148, v129
    v_mfma_f32_16x16x32_bf16 v[100:103], v[8:11], a[52:55], v[100:103]
    v_fmac_f32 v85, v149, v129
    v_fmac_f32 v86, v150, v129
    v_mfma_f32_16x16x32_bf16 v[104:107], v[8:11], a[56:59], v[104:107]
    v_fmac_f32 v87, v151, v129
    v_mul_f32 v68, v68, v133
    v_mfma_f32_16x16x32_bf16 v[108:111], v[8:11], a[60:63], v[108:111]
    s_waitcnt lgkmcnt(3)
    v_mul_f32 v69, v69, v133
    v_mul_f32 v70, v70, v133
    v_mfma_f32_16x16x32_bf16 v[112:115], v[12:15], a[48:51], v[112:115]
    ds_read_b128 v[28:31], v4 offset:11264
    v_mul_f32 v71, v71, v133
    v_mfma_f32_16x16x32_bf16 v[116:119], v[12:15], a[52:55], v[116:119]
    v_mul_f32 v68, v68, v84
    v_mul_f32 v69, v69, v85
    v_mfma_f32_16x16x32_bf16 v[120:123], v[12:15], a[56:59], v[120:123]
    v_mul_f32 v70, v70, v86
    v_mul_f32 v71, v71, v87
    v_mfma_f32_16x16x32_bf16 v[124:127], v[12:15], a[60:63], v[124:127]
    s_waitcnt lgkmcnt(3)
    v_cvt_pk_bf16_f32 v212, v68, v69
    v_cvt_pk_bf16_f32 v213, v70, v71
    v_mfma_f32_16x16x32_bf16 v[96:99], v[16:19], a[64:67], v[96:99]
    ds_read_b128 v[8:11], v4 offset:12288
    v_fmac_f32 v72, v144, v130
    v_mfma_f32_16x16x32_bf16 v[100:103], v[16:19], a[68:71], v[100:103]
    v_fmac_f32 v73, v145, v130
    v_fmac_f32 v74, v146, v130
    v_mfma_f32_16x16x32_bf16 v[104:107], v[16:19], a[72:75], v[104:107]
    v_fmac_f32 v75, v147, v130
    v_fmac_f32 v88, v148, v130
    v_mfma_f32_16x16x32_bf16 v[108:111], v[16:19], a[76:79], v[108:111]
    s_waitcnt lgkmcnt(3)
    v_fmac_f32 v89, v149, v130
    v_fmac_f32 v90, v150, v130
    v_mfma_f32_16x16x32_bf16 v[112:115], v[20:23], a[64:67], v[112:115]
    ds_read_b128 v[12:15], v4 offset:13312
    v_fmac_f32 v91, v151, v130
    v_mfma_f32_16x16x32_bf16 v[116:119], v[20:23], a[68:71], v[116:119]
    v_mul_f32 v72, v72, v134
    v_mul_f32 v73, v73, v134
    v_mfma_f32_16x16x32_bf16 v[120:123], v[20:23], a[72:75], v[120:123]
    v_mul_f32 v74, v74, v134
    v_mul_f32 v75, v75, v134
    v_mfma_f32_16x16x32_bf16 v[124:127], v[20:23], a[76:79], v[124:127]
    s_waitcnt lgkmcnt(3)
    v_mul_f32 v72, v72, v88
    v_mul_f32 v73, v73, v89
    v_mfma_f32_16x16x32_bf16 v[96:99], v[24:27], a[80:83], v[96:99]
    ds_read_b128 v[16:19], v4 offset:14336
    v_mul_f32 v74, v74, v90
    v_mfma_f32_16x16x32_bf16 v[100:103], v[24:27], a[84:87], v[100:103]
    v_mul_f32 v75, v75, v91
    v_cvt_pk_bf16_f32 v216, v72, v73
    v_mfma_f32_16x16x32_bf16 v[104:107], v[24:27], a[88:91], v[104:107]
    v_cvt_pk_bf16_f32 v217, v74, v75
    v_fmac_f32 v76, v144, v131
    v_mfma_f32_16x16x32_bf16 v[108:111], v[24:27], a[92:95], v[108:111]
    s_waitcnt lgkmcnt(3)
    v_fmac_f32 v77, v145, v131
    v_fmac_f32 v78, v146, v131
    v_mfma_f32_16x16x32_bf16 v[112:115], v[28:31], a[80:83], v[112:115]
    ds_read_b128 v[20:23], v4 offset:15360
    v_fmac_f32 v79, v147, v131
    v_mfma_f32_16x16x32_bf16 v[116:119], v[28:31], a[84:87], v[116:119]
    v_fmac_f32 v92, v148, v131
    v_fmac_f32 v93, v149, v131
    v_mfma_f32_16x16x32_bf16 v[120:123], v[28:31], a[88:91], v[120:123]
    v_fmac_f32 v94, v150, v131
    v_fmac_f32 v95, v151, v131
    v_mfma_f32_16x16x32_bf16 v[124:127], v[28:31], a[92:95], v[124:127]
    s_waitcnt lgkmcnt(3)
    v_mul_f32 v76, v76, v135
    v_mul_f32 v77, v77, v135
    v_mfma_f32_16x16x32_bf16 v[96:99], v[8:11], a[96:99], v[96:99]
    ds_read_b128 v[24:27], v4 offset:16384
    v_mul_f32 v78, v78, v135
    v_mfma_f32_16x16x32_bf16 v[100:103], v[8:11], a[100:103], v[100:103]
    v_mul_f32 v79, v79, v135
    v_mul_f32 v76, v76, v92
    v_mfma_f32_16x16x32_bf16 v[104:107], v[8:11], a[104:107], v[104:107]
    v_mul_f32 v77, v77, v93
    v_mul_f32 v78, v78, v94
    v_mfma_f32_16x16x32_bf16 v[108:111], v[8:11], a[108:111], v[108:111]
    s_waitcnt lgkmcnt(3)
    v_mul_f32 v79, v79, v95
    v_cvt_pk_bf16_f32 v220, v76, v77
    v_mfma_f32_16x16x32_bf16 v[112:115], v[12:15], a[96:99], v[112:115]
    ds_read_b128 v[28:31], v4 offset:17408
    v_cvt_pk_bf16_f32 v221, v78, v79
    v_mfma_f32_16x16x32_bf16 v[116:119], v[12:15], a[100:103], v[116:119]
    ds_read_b128 v[144:147], v5 offset:896
    ds_read_b128 v[148:151], v5 offset:960
    v_mfma_f32_16x16x32_bf16 v[120:123], v[12:15], a[104:107], v[120:123]
    v_mfma_f32_16x16x32_bf16 v[124:127], v[12:15], a[108:111], v[124:127]
    s_waitcnt lgkmcnt(5)
    v_mfma_f32_16x16x32_bf16 v[96:99], v[16:19], a[112:115], v[96:99]
    ds_read_b128 v[8:11], v4 offset:18432
    v_mfma_f32_16x16x32_bf16 v[100:103], v[16:19], a[116:119], v[100:103]
    v_mfma_f32_16x16x32_bf16 v[104:107], v[16:19], a[120:123], v[104:107]
    v_mfma_f32_16x16x32_bf16 v[108:111], v[16:19], a[124:127], v[108:111]
    s_waitcnt lgkmcnt(5)
    v_mfma_f32_16x16x32_bf16 v[112:115], v[20:23], a[112:115], v[112:115]
    ds_read_b128 v[12:15], v4 offset:19456
    v_mfma_f32_16x16x32_bf16 v[116:119], v[20:23], a[116:119], v[116:119]
    v_mfma_f32_16x16x32_bf16 v[120:123], v[20:23], a[120:123], v[120:123]
    v_mfma_f32_16x16x32_bf16 v[124:127], v[20:23], a[124:127], v[124:127]
    s_waitcnt lgkmcnt(5)
    v_mfma_f32_16x16x32_bf16 v[96:99], v[24:27], a[128:131], v[96:99]
    ds_read_b128 v[16:19], v4 offset:20480
    v_mfma_f32_16x16x32_bf16 v[100:103], v[24:27], a[132:135], v[100:103]
    v_mfma_f32_16x16x32_bf16 v[104:107], v[24:27], a[136:139], v[104:107]
    v_mfma_f32_16x16x32_bf16 v[108:111], v[24:27], a[140:143], v[108:111]
    s_waitcnt lgkmcnt(5)
    v_mfma_f32_16x16x32_bf16 v[112:115], v[28:31], a[128:131], v[112:115]
    ds_read_b128 v[20:23], v4 offset:21504
    v_mfma_f32_16x16x32_bf16 v[116:119], v[28:31], a[132:135], v[116:119]
    v_mfma_f32_16x16x32_bf16 v[120:123], v[28:31], a[136:139], v[120:123]
    v_mfma_f32_16x16x32_bf16 v[124:127], v[28:31], a[140:143], v[124:127]
    s_waitcnt lgkmcnt(3)
    v_mfma_f32_16x16x32_bf16 v[96:99], v[8:11], a[144:147], v[96:99]
    ds_read_b128 v[24:27], v4 offset:22528
    v_mfma_f32_16x16x32_bf16 v[100:103], v[8:11], a[148:151], v[100:103]
    v_mfma_f32_16x16x32_bf16 v[104:107], v[8:11], a[152:155], v[104:107]
    v_mfma_f32_16x16x32_bf16 v[108:111], v[8:11], a[156:159], v[108:111]
    s_waitcnt lgkmcnt(3)
    v_mfma_f32_16x16x32_bf16 v[112:115], v[12:15], a[144:147], v[112:115]
    ds_read_b128 v[28:31], v4 offset:23552
    v_mfma_f32_16x16x32_bf16 v[116:119], v[12:15], a[148:151], v[116:119]
    v_mfma_f32_16x16x32_bf16 v[120:123], v[12:15], a[152:155], v[120:123]
    v_mfma_f32_16x16x32_bf16 v[124:127], v[12:15], a[156:159], v[124:127]
    s_waitcnt lgkmcnt(3)
    v_mfma_f32_16x16x32_bf16 v[96:99], v[16:19], a[160:163], v[96:99]
    ds_read_b128 v[8:11], v4 offset:24576
    v_mfma_f32_16x16x32_bf16 v[100:103], v[16:19], a[164:167], v[100:103]
    v_mfma_f32_16x16x32_bf16 v[104:107], v[16:19], a[168:171], v[104:107]
    v_mfma_f32_16x16x32_bf16 v[108:111], v[16:19], a[172:175], v[108:111]
    s_waitcnt lgkmcnt(3)
    v_mfma_f32_16x16x32_bf16 v[112:115], v[20:23], a[160:163], v[112:115]
    ds_read_b128 v[12:15], v4 offset:25600
    v_mfma_f32_16x16x32_bf16 v[116:119], v[20:23], a[164:167], v[116:119]
    v_mfma_f32_16x16x32_bf16 v[120:123], v[20:23], a[168:171], v[120:123]
    v_mfma_f32_16x16x32_bf16 v[124:127], v[20:23], a[172:175], v[124:127]
    s_waitcnt lgkmcnt(3)
    v_mfma_f32_16x16x32_bf16 v[96:99], v[24:27], a[176:179], v[96:99]
    ds_read_b128 v[16:19], v4 offset:26624
    v_mfma_f32_16x16x32_bf16 v[100:103], v[24:27], a[180:183], v[100:103]
    v_mfma_f32_16x16x32_bf16 v[104:107], v[24:27], a[184:187], v[104:107]
    v_mfma_f32_16x16x32_bf16 v[108:111], v[24:27], a[188:191], v[108:111]
    s_waitcnt lgkmcnt(3)
    v_mfma_f32_16x16x32_bf16 v[112:115], v[28:31], a[176:179], v[112:115]
    ds_read_b128 v[20:23], v4 offset:27648
    v_mfma_f32_16x16x32_bf16 v[116:119], v[28:31], a[180:183], v[116:119]
    v_mfma_f32_16x16x32_bf16 v[120:123], v[28:31], a[184:187], v[120:123]
    v_mfma_f32_16x16x32_bf16 v[124:127], v[28:31], a[188:191], v[124:127]
    s_waitcnt lgkmcnt(3)
    v_mfma_f32_16x16x32_bf16 v[96:99], v[8:11], a[192:195], v[96:99]
    ds_read_b128 v[24:27], v4 offset:28672
    v_mfma_f32_16x16x32_bf16 v[100:103], v[8:11], a[196:199], v[100:103]
    v_mfma_f32_16x16x32_bf16 v[104:107], v[8:11], a[200:203], v[104:107]
    v_mfma_f32_16x16x32_bf16 v[108:111], v[8:11], a[204:207], v[108:111]
    s_waitcnt lgkmcnt(3)
    v_mfma_f32_16x16x32_bf16 v[112:115], v[12:15], a[192:195], v[112:115]
    ds_read_b128 v[28:31], v4 offset:29696
    v_mfma_f32_16x16x32_bf16 v[116:119], v[12:15], a[196:199], v[116:119]
    v_mfma_f32_16x16x32_bf16 v[120:123], v[12:15], a[200:203], v[120:123]
    v_mfma_f32_16x16x32_bf16 v[124:127], v[12:15], a[204:207], v[124:127]
    s_waitcnt lgkmcnt(3)
    v_mfma_f32_16x16x32_bf16 v[96:99], v[16:19], a[208:211], v[96:99]
    ds_read_b128 v[8:11], v4 offset:30720
    v_mfma_f32_16x16x32_bf16 v[100:103], v[16:19], a[212:215], v[100:103]
    v_mfma_f32_16x16x32_bf16 v[104:107], v[16:19], a[216:219], v[104:107]
    v_mfma_f32_16x16x32_bf16 v[108:111], v[16:19], a[220:223], v[108:111]
    s_waitcnt lgkmcnt(3)
    v_mfma_f32_16x16x32_bf16 v[112:115], v[20:23], a[208:211], v[112:115]
    ds_read_b128 v[12:15], v4 offset:31744
    v_mfma_f32_16x16x32_bf16 v[116:119], v[20:23], a[212:215], v[116:119]
    v_mfma_f32_16x16x32_bf16 v[120:123], v[20:23], a[216:219], v[120:123]
    v_mfma_f32_16x16x32_bf16 v[124:127], v[20:23], a[220:223], v[124:127]
    s_waitcnt lgkmcnt(3)
    v_mfma_f32_16x16x32_bf16 v[96:99], v[24:27], a[224:227], v[96:99]
    ds_read_b128 v[16:19], v4 offset:32768
    v_mfma_f32_16x16x32_bf16 v[100:103], v[24:27], a[228:231], v[100:103]
    v_mfma_f32_16x16x32_bf16 v[104:107], v[24:27], a[232:235], v[104:107]
    v_mfma_f32_16x16x32_bf16 v[108:111], v[24:27], a[236:239], v[108:111]
    s_waitcnt lgkmcnt(3)
    v_mfma_f32_16x16x32_bf16 v[112:115], v[28:31], a[224:227], v[112:115]
    ds_read_b128 v[20:23], v4 offset:33792
    v_mfma_f32_16x16x32_bf16 v[116:119], v[28:31], a[228:231], v[116:119]
    v_mfma_f32_16x16x32_bf16 v[120:123], v[28:31], a[232:235], v[120:123]
    v_mfma_f32_16x16x32_bf16 v[124:127], v[28:31], a[236:239], v[124:127]
    s_waitcnt lgkmcnt(3)
    v_mfma_f32_16x16x32_bf16 v[96:99], v[8:11], a[240:243], v[96:99]
    ds_read_b128 v[24:27], v4 offset:34816
    v_mfma_f32_16x16x32_bf16 v[100:103], v[8:11], a[244:247], v[100:103]
    v_mfma_f32_16x16x32_bf16 v[104:107], v[8:11], a[248:251], v[104:107]
    v_mfma_f32_16x16x32_bf16 v[108:111], v[8:11], a[252:255], v[108:111]
    s_waitcnt lgkmcnt(3)
    v_mfma_f32_16x16x32_bf16 v[112:115], v[12:15], a[240:243], v[112:115]
    ds_read_b128 v[28:31], v4 offset:35840
    v_mfma_f32_16x16x32_bf16 v[116:119], v[12:15], a[244:247], v[116:119]
    v_mfma_f32_16x16x32_bf16 v[120:123], v[12:15], a[248:251], v[120:123]
    v_mfma_f32_16x16x32_bf16 v[124:127], v[12:15], a[252:255], v[124:127]
    s_waitcnt lgkmcnt(3)
    v_mfma_f32_16x16x32_bf16 v[96:99], v[16:19], v[32:35], v[96:99]
    s_barrier
    v_add_u32 v4, 0x9000, v4
    v_mfma_f32_16x16x32_bf16 v[100:103], v[16:19], v[36:39], v[100:103]
    s_add_u32 m0, s49, 36864
    s_add_u32 s61, s48, 331776
    ds_read_b128 v[8:11], v4 offset:0
    v_mfma_f32_16x16x32_bf16 v[104:107], v[16:19], v[40:43], v[104:107]
    buffer_load_dwordx4 v2, s[4:7], s61 offen offset:0 lds
    v_mfma_f32_16x16x32_bf16 v[108:111], v[16:19], v[44:47], v[108:111]
    s_waitcnt lgkmcnt(3)
    v_mfma_f32_16x16x32_bf16 v[112:115], v[20:23], v[32:35], v[112:115]
    ds_read_b128 v[12:15], v4 offset:1024
    v_mfma_f32_16x16x32_bf16 v[116:119], v[20:23], v[36:39], v[116:119]
    v_mfma_f32_16x16x32_bf16 v[120:123], v[20:23], v[40:43], v[120:123]
    buffer_load_dwordx4 v2, s[4:7], s61 offen offset:1024 lds
    v_mfma_f32_16x16x32_bf16 v[124:127], v[20:23], v[44:47], v[124:127]
    s_waitcnt lgkmcnt(3)
    v_mfma_f32_16x16x32_bf16 v[96:99], v[24:27], v[48:51], v[96:99]
    ds_read_b128 v[16:19], v4 offset:2048
    v_mfma_f32_16x16x32_bf16 v[100:103], v[24:27], v[52:55], v[100:103]
    v_mfma_f32_16x16x32_bf16 v[104:107], v[24:27], v[56:59], v[104:107]
    buffer_load_dwordx4 v2, s[4:7], s61 offen offset:2048 lds
    v_mfma_f32_16x16x32_bf16 v[108:111], v[24:27], v[60:63], v[108:111]
    s_waitcnt lgkmcnt(3)
    v_mfma_f32_16x16x32_bf16 v[112:115], v[28:31], v[48:51], v[112:115]
    ds_read_b128 v[20:23], v4 offset:3072
    v_mfma_f32_16x16x32_bf16 v[116:119], v[28:31], v[52:55], v[116:119]
    v_mfma_f32_16x16x32_bf16 v[120:123], v[28:31], v[56:59], v[120:123]
    buffer_load_dwordx4 v2, s[4:7], s61 offen offset:3072 lds
    v_mfma_f32_16x16x32_bf16 v[124:127], v[28:31], v[60:63], v[124:127]
    s_waitcnt lgkmcnt(3)
    s_add_u32 m0, s49, 40960
    s_add_u32 s61, s48, 335872
    v_mfma_f32_16x16x32_bf16 v[64:67], v[8:11], a[0:3], 0
    ds_read_b128 v[24:27], v4 offset:4096
    v_mfma_f32_16x16x32_bf16 v[68:71], v[8:11], a[4:7], 0
    v_mfma_f32_16x16x32_bf16 v[72:75], v[8:11], a[8:11], 0
    buffer_load_dwordx4 v2, s[4:7], s61 offen offset:0 lds
    v_mfma_f32_16x16x32_bf16 v[76:79], v[8:11], a[12:15], 0
    s_waitcnt lgkmcnt(3)
    v_mfma_f32_16x16x32_bf16 v[80:83], v[12:15], a[0:3], 0
    ds_read_b128 v[28:31], v4 offset:5120
    v_mfma_f32_16x16x32_bf16 v[84:87], v[12:15], a[4:7], 0
    v_fmac_f32 v96, v136, v128
    v_fmac_f32 v97, v137, v128
    v_mfma_f32_16x16x32_bf16 v[88:91], v[12:15], a[8:11], 0
    buffer_load_dwordx4 v2, s[4:7], s61 offen offset:1024 lds
    v_mfma_f32_16x16x32_bf16 v[92:95], v[12:15], a[12:15], 0
    s_waitcnt lgkmcnt(3)
    v_fmac_f32 v98, v138, v128
    v_fmac_f32 v99, v139, v128
    v_mfma_f32_16x16x32_bf16 v[64:67], v[16:19], a[16:19], v[64:67]
    ds_read_b128 v[8:11], v4 offset:6144
    v_fmac_f32 v112, v140, v128
    v_mfma_f32_16x16x32_bf16 v[68:71], v[16:19], a[20:23], v[68:71]
    v_fmac_f32 v113, v141, v128
    v_fmac_f32 v114, v142, v128
    v_mfma_f32_16x16x32_bf16 v[72:75], v[16:19], a[24:27], v[72:75]
    buffer_load_dwordx4 v2, s[4:7], s61 offen offset:2048 lds
    v_mfma_f32_16x16x32_bf16 v[76:79], v[16:19], a[28:31], v[76:79]
    s_waitcnt lgkmcnt(3)
    v_fmac_f32 v115, v143, v128
    v_mul_f32 v96, v96, v132
    v_mfma_f32_16x16x32_bf16 v[80:83], v[20:23], a[16:19], v[80:83]
    ds_read_b128 v[12:15], v4 offset:7168
    v_mul_f32 v97, v97, v132
    v_mfma_f32_16x16x32_bf16 v[84:87], v[20:23], a[20:23], v[84:87]
    v_mul_f32 v98, v98, v132
    v_mul_f32 v99, v99, v132
    v_mfma_f32_16x16x32_bf16 v[88:91], v[20:23], a[24:27], v[88:91]
    buffer_load_dwordx4 v2, s[4:7], s61 offen offset:3072 lds
    v_mfma_f32_16x16x32_bf16 v[92:95], v[20:23], a[28:31], v[92:95]
    s_waitcnt lgkmcnt(3)
    s_add_u32 m0, s49, 45056
    s_add_u32 s61, s48, 339968
    v_mfma_f32_16x16x32_bf16 v[64:67], v[24:27], a[32:35], v[64:67]
    ds_read_b128 v[16:19], v4 offset:8192
    v_mul_f32 v96, v96, v112
    v_mfma_f32_16x16x32_bf16 v[68:71], v[24:27], a[36:39], v[68:71]
    v_mul_f32 v97, v97, v113
    v_mul_f32 v98, v98, v114
    v_mfma_f32_16x16x32_bf16 v[72:75], v[24:27], a[40:43], v[72:75]
    buffer_load_dwordx4 v2, s[4:7], s61 offen offset:0 lds
    v_mfma_f32_16x16x32_bf16 v[76:79], v[24:27], a[44:47], v[76:79]
    s_waitcnt lgkmcnt(3)
    v_mul_f32 v99, v99, v115
    v_cvt_pk_bf16_f32 v210, v96, v97
    v_mfma_f32_16x16x32_bf16 v[80:83], v[28:31], a[32:35], v[80:83]
    ds_read_b128 v[20:23], v4 offset:9216
    v_cvt_pk_bf16_f32 v211, v98, v99
    v_mfma_f32_16x16x32_bf16 v[84:87], v[28:31], a[36:39], v[84:87]
    s_add_u32 s66, s51, 32768
    v_mfma_f32_16x16x32_bf16 v[88:91], v[28:31], a[40:43], v[88:91]
    buffer_store_dwordx4 v[208:211], v2, s[4:7], s66 offen offset:0 sc1
    v_mfma_f32_16x16x32_bf16 v[92:95], v[28:31], a[44:47], v[92:95]
    s_waitcnt lgkmcnt(3)
    v_fmac_f32 v100, v136, v129
    v_fmac_f32 v101, v137, v129
    v_mfma_f32_16x16x32_bf16 v[64:67], v[8:11], a[48:51], v[64:67]
    ds_read_b128 v[24:27], v4 offset:10240
    v_fmac_f32 v102, v138, v129
    v_mfma_f32_16x16x32_bf16 v[68:71], v[8:11], a[52:55], v[68:71]
    v_fmac_f32 v103, v139, v129
    v_fmac_f32 v116, v140, v129
    v_mfma_f32_16x16x32_bf16 v[72:75], v[8:11], a[56:59], v[72:75]
    v_fmac_f32 v117, v141, v129
    v_fmac_f32 v118, v142, v129
    v_mfma_f32_16x16x32_bf16 v[76:79], v[8:11], a[60:63], v[76:79]
    s_waitcnt lgkmcnt(3)
    v_fmac_f32 v119, v143, v129
    v_mul_f32 v100, v100, v133
    v_mfma_f32_16x16x32_bf16 v[80:83], v[12:15], a[48:51], v[80:83]
    ds_read_b128 v[28:31], v4 offset:11264
    v_mul_f32 v101, v101, v133
    v_mfma_f32_16x16x32_bf16 v[84:87], v[12:15], a[52:55], v[84:87]
    v_mul_f32 v102, v102, v133
    v_mul_f32 v103, v103, v133
    v_mfma_f32_16x16x32_bf16 v[88:91], v[12:15], a[56:59], v[88:91]
    v_mul_f32 v100, v100, v116
    v_mul_f32 v101, v101, v117
    v_mfma_f32_16x16x32_bf16 v[92:95], v[12:15], a[60:63], v[92:95]
    s_waitcnt lgkmcnt(3)
    v_mul_f32 v102, v102, v118
    v_mul_f32 v103, v103, v119
    v_mfma_f32_16x16x32_bf16 v[64:67], v[16:19], a[64:67], v[64:67]
    ds_read_b128 v[8:11], v4 offset:12288
    v_cvt_pk_bf16_f32 v214, v100, v101
    v_mfma_f32_16x16x32_bf16 v[68:71], v[16:19], a[68:71], v[68:71]
    v_cvt_pk_bf16_f32 v215, v102, v103
    v_mfma_f32_16x16x32_bf16 v[72:75], v[16:19], a[72:75], v[72:75]
    buffer_store_dwordx4 v[212:215], v2, s[4:7], s66 offen offset:1024 sc1
    v_mfma_f32_16x16x32_bf16 v[76:79], v[16:19], a[76:79], v[76:79]
    s_waitcnt lgkmcnt(3)
    v_fmac_f32 v104, v136, v130
    v_fmac_f32 v105, v137, v130
    v_mfma_f32_16x16x32_bf16 v[80:83], v[20:23], a[64:67], v[80:83]
    ds_read_b128 v[12:15], v4 offset:13312
    v_fmac_f32 v106, v138, v130
    v_mfma_f32_16x16x32_bf16 v[84:87], v[20:23], a[68:71], v[84:87]
    v_fmac_f32 v107, v139, v130
    v_fmac_f32 v120, v140, v130
    v_mfma_f32_16x16x32_bf16 v[88:91], v[20:23], a[72:75], v[88:91]
    v_fmac_f32 v121, v141, v130
    v_fmac_f32 v122, v142, v130
    v_mfma_f32_16x16x32_bf16 v[92:95], v[20:23], a[76:79], v[92:95]
    s_waitcnt lgkmcnt(3)
    v_fmac_f32 v123, v143, v130
    v_mul_f32 v104, v104, v134
    v_mfma_f32_16x16x32_bf16 v[64:67], v[24:27], a[80:83], v[64:67]
    ds_read_b128 v[16:19], v4 offset:14336
    v_mul_f32 v105, v105, v134
    v_mfma_f32_16x16x32_bf16 v[68:71], v[24:27], a[84:87], v[68:71]
    v_mul_f32 v106, v106, v134
    v_mul_f32 v107, v107, v134
    v_mfma_f32_16x16x32_bf16 v[72:75], v[24:27], a[88:91], v[72:75]
    v_mul_f32 v104, v104, v120
    v_mul_f32 v105, v105, v121
    v_mfma_f32_16x16x32_bf16 v[76:79], v[24:27], a[92:95], v[76:79]
    s_waitcnt lgkmcnt(3)
    v_mul_f32 v106, v106, v122
    v_mul_f32 v107, v107, v123
    v_mfma_f32_16x16x32_bf16 v[80:83], v[28:31], a[80:83], v[80:83]
    ds_read_b128 v[20:23], v4 offset:15360
    v_cvt_pk_bf16_f32 v218, v104, v105
    v_mfma_f32_16x16x32_bf16 v[84:87], v[28:31], a[84:87], v[84:87]
    v_cvt_pk_bf16_f32 v219, v106, v107
    v_mfma_f32_16x16x32_bf16 v[88:91], v[28:31], a[88:91], v[88:91]
    buffer_store_dwordx4 v[216:219], v2, s[4:7], s66 offen offset:2048 sc1
    v_mfma_f32_16x16x32_bf16 v[92:95], v[28:31], a[92:95], v[92:95]
    s_waitcnt lgkmcnt(3)
    v_and_b32 v0, 3, v1
    v_lshlrev_b32 v0, 3, v0
    v_mfma_f32_16x16x32_bf16 v[64:67], v[8:11], a[96:99], v[64:67]
    s_mov_b32 s55, s52
    ds_read_b128 v[24:27], v4 offset:16384
    v_fmac_f32 v108, v136, v131
    v_mfma_f32_16x16x32_bf16 v[68:71], v[8:11], a[100:103], v[68:71]
    v_fmac_f32 v109, v137, v131
    v_fmac_f32 v110, v138, v131
    v_mfma_f32_16x16x32_bf16 v[72:75], v[8:11], a[104:107], v[72:75]
    v_fmac_f32 v111, v139, v131
    v_fmac_f32 v124, v140, v131
    v_mfma_f32_16x16x32_bf16 v[76:79], v[8:11], a[108:111], v[76:79]
    s_waitcnt lgkmcnt(3)
    v_fmac_f32 v125, v141, v131
    v_fmac_f32 v126, v142, v131
    v_mfma_f32_16x16x32_bf16 v[80:83], v[12:15], a[96:99], v[80:83]
    ds_read_b128 v[28:31], v4 offset:17408
    v_fmac_f32 v127, v143, v131
    v_mfma_f32_16x16x32_bf16 v[84:87], v[12:15], a[100:103], v[84:87]
    v_mul_f32 v108, v108, v135
    v_mul_f32 v109, v109, v135
    v_mfma_f32_16x16x32_bf16 v[88:91], v[12:15], a[104:107], v[88:91]
    v_mul_f32 v110, v110, v135
    v_mul_f32 v111, v111, v135
    v_mfma_f32_16x16x32_bf16 v[92:95], v[12:15], a[108:111], v[92:95]
    s_waitcnt lgkmcnt(3)
    v_mul_f32 v108, v108, v124
    v_mul_f32 v109, v109, v125
    v_mfma_f32_16x16x32_bf16 v[64:67], v[16:19], a[112:115], v[64:67]
    ds_read_b128 v[8:11], v4 offset:18432
    v_mul_f32 v110, v110, v126
    v_mfma_f32_16x16x32_bf16 v[68:71], v[16:19], a[116:119], v[68:71]
    v_mul_f32 v111, v111, v127
    v_cvt_pk_bf16_f32 v222, v108, v109
    v_mfma_f32_16x16x32_bf16 v[72:75], v[16:19], a[120:123], v[72:75]
    v_cvt_pk_bf16_f32 v223, v110, v111
    v_mfma_f32_16x16x32_bf16 v[76:79], v[16:19], a[124:127], v[76:79]
    s_waitcnt lgkmcnt(3)
    v_mfma_f32_16x16x32_bf16 v[80:83], v[20:23], a[112:115], v[80:83]
    ds_read_b128 v[12:15], v4 offset:19456
    v_mfma_f32_16x16x32_bf16 v[84:87], v[20:23], a[116:119], v[84:87]
    buffer_store_dwordx4 v[220:223], v2, s[4:7], s66 offen offset:3072 sc1
    v_mfma_f32_16x16x32_bf16 v[88:91], v[20:23], a[120:123], v[88:91]
    ds_read_b128 v[136:139], v5 offset:1024
    ds_read_b128 v[140:143], v5 offset:1088
    v_mfma_f32_16x16x32_bf16 v[92:95], v[20:23], a[124:127], v[92:95]
    s_waitcnt lgkmcnt(5)
    v_mfma_f32_16x16x32_bf16 v[64:67], v[24:27], a[128:131], v[64:67]
    ds_read_b128 v[16:19], v4 offset:20480
    v_mfma_f32_16x16x32_bf16 v[68:71], v[24:27], a[132:135], v[68:71]
    v_mfma_f32_16x16x32_bf16 v[72:75], v[24:27], a[136:139], v[72:75]
    v_mfma_f32_16x16x32_bf16 v[76:79], v[24:27], a[140:143], v[76:79]
    s_waitcnt lgkmcnt(5)
    v_mfma_f32_16x16x32_bf16 v[80:83], v[28:31], a[128:131], v[80:83]
    ds_read_b128 v[20:23], v4 offset:21504
    v_mfma_f32_16x16x32_bf16 v[84:87], v[28:31], a[132:135], v[84:87]
    buffer_load_dwordx2 v[6:7], v0, s[4:7], s55 offen sc1
    v_mfma_f32_16x16x32_bf16 v[88:91], v[28:31], a[136:139], v[88:91]
    v_mfma_f32_16x16x32_bf16 v[92:95], v[28:31], a[140:143], v[92:95]
    s_waitcnt lgkmcnt(5)
    v_mfma_f32_16x16x32_bf16 v[64:67], v[8:11], a[144:147], v[64:67]
    ds_read_b128 v[24:27], v4 offset:22528
    v_mfma_f32_16x16x32_bf16 v[68:71], v[8:11], a[148:151], v[68:71]
    v_mfma_f32_16x16x32_bf16 v[72:75], v[8:11], a[152:155], v[72:75]
    v_mfma_f32_16x16x32_bf16 v[76:79], v[8:11], a[156:159], v[76:79]
    s_waitcnt lgkmcnt(5)
    v_mfma_f32_16x16x32_bf16 v[80:83], v[12:15], a[144:147], v[80:83]
    ds_read_b128 v[28:31], v4 offset:23552
    v_mfma_f32_16x16x32_bf16 v[84:87], v[12:15], a[148:151], v[84:87]
    v_mfma_f32_16x16x32_bf16 v[88:91], v[12:15], a[152:155], v[88:91]
    v_mfma_f32_16x16x32_bf16 v[92:95], v[12:15], a[156:159], v[92:95]
    s_waitcnt lgkmcnt(3)
    v_mfma_f32_16x16x32_bf16 v[64:67], v[16:19], a[160:163], v[64:67]
    ds_read_b128 v[8:11], v4 offset:24576
    v_mfma_f32_16x16x32_bf16 v[68:71], v[16:19], a[164:167], v[68:71]
    v_mfma_f32_16x16x32_bf16 v[72:75], v[16:19], a[168:171], v[72:75]
    v_mfma_f32_16x16x32_bf16 v[76:79], v[16:19], a[172:175], v[76:79]
    s_waitcnt lgkmcnt(3)
    v_mfma_f32_16x16x32_bf16 v[80:83], v[20:23], a[160:163], v[80:83]
    ds_read_b128 v[12:15], v4 offset:25600
    v_mfma_f32_16x16x32_bf16 v[84:87], v[20:23], a[164:167], v[84:87]
    v_mfma_f32_16x16x32_bf16 v[88:91], v[20:23], a[168:171], v[88:91]
    v_mfma_f32_16x16x32_bf16 v[92:95], v[20:23], a[172:175], v[92:95]
    s_waitcnt lgkmcnt(3)
    v_mfma_f32_16x16x32_bf16 v[64:67], v[24:27], a[176:179], v[64:67]
    ds_read_b128 v[16:19], v4 offset:26624
    v_mfma_f32_16x16x32_bf16 v[68:71], v[24:27], a[180:183], v[68:71]
    v_mfma_f32_16x16x32_bf16 v[72:75], v[24:27], a[184:187], v[72:75]
    v_mfma_f32_16x16x32_bf16 v[76:79], v[24:27], a[188:191], v[76:79]
    s_waitcnt lgkmcnt(3)
    v_mfma_f32_16x16x32_bf16 v[80:83], v[28:31], a[176:179], v[80:83]
    ds_read_b128 v[20:23], v4 offset:27648
    v_mfma_f32_16x16x32_bf16 v[84:87], v[28:31], a[180:183], v[84:87]
    v_mfma_f32_16x16x32_bf16 v[88:91], v[28:31], a[184:187], v[88:91]
    v_mfma_f32_16x16x32_bf16 v[92:95], v[28:31], a[188:191], v[92:95]
    s_waitcnt lgkmcnt(3)
    v_mfma_f32_16x16x32_bf16 v[64:67], v[8:11], a[192:195], v[64:67]
    ds_read_b128 v[24:27], v4 offset:28672
    v_mfma_f32_16x16x32_bf16 v[68:71], v[8:11], a[196:199], v[68:71]
    v_mfma_f32_16x16x32_bf16 v[72:75], v[8:11], a[200:203], v[72:75]
    v_mfma_f32_16x16x32_bf16 v[76:79], v[8:11], a[204:207], v[76:79]
    s_waitcnt lgkmcnt(3)
    v_mfma_f32_16x16x32_bf16 v[80:83], v[12:15], a[192:195], v[80:83]
    ds_read_b128 v[28:31], v4 offset:29696
    v_mfma_f32_16x16x32_bf16 v[84:87], v[12:15], a[196:199], v[84:87]
    v_mfma_f32_16x16x32_bf16 v[88:91], v[12:15], a[200:203], v[88:91]
    v_mfma_f32_16x16x32_bf16 v[92:95], v[12:15], a[204:207], v[92:95]
    s_waitcnt lgkmcnt(3)
    v_mfma_f32_16x16x32_bf16 v[64:67], v[16:19], a[208:211], v[64:67]
    ds_read_b128 v[8:11], v4 offset:30720
    v_mfma_f32_16x16x32_bf16 v[68:71], v[16:19], a[212:215], v[68:71]
    v_mfma_f32_16x16x32_bf16 v[72:75], v[16:19], a[216:219], v[72:75]
    v_mfma_f32_16x16x32_bf16 v[76:79], v[16:19], a[220:223], v[76:79]
    s_waitcnt lgkmcnt(3)
    v_mfma_f32_16x16x32_bf16 v[80:83], v[20:23], a[208:211], v[80:83]
    ds_read_b128 v[12:15], v4 offset:31744
    v_mfma_f32_16x16x32_bf16 v[84:87], v[20:23], a[212:215], v[84:87]
    v_mfma_f32_16x16x32_bf16 v[88:91], v[20:23], a[216:219], v[88:91]
    v_mfma_f32_16x16x32_bf16 v[92:95], v[20:23], a[220:223], v[92:95]
    s_waitcnt lgkmcnt(3)
    v_mfma_f32_16x16x32_bf16 v[64:67], v[24:27], a[224:227], v[64:67]
    ds_read_b128 v[16:19], v4 offset:32768
    v_mfma_f32_16x16x32_bf16 v[68:71], v[24:27], a[228:231], v[68:71]
    v_mfma_f32_16x16x32_bf16 v[72:75], v[24:27], a[232:235], v[72:75]
    v_mfma_f32_16x16x32_bf16 v[76:79], v[24:27], a[236:239], v[76:79]
    s_waitcnt lgkmcnt(3)
    v_mfma_f32_16x16x32_bf16 v[80:83], v[28:31], a[224:227], v[80:83]
    ds_read_b128 v[20:23], v4 offset:33792
    v_mfma_f32_16x16x32_bf16 v[84:87], v[28:31], a[228:231], v[84:87]
    v_mfma_f32_16x16x32_bf16 v[88:91], v[28:31], a[232:235], v[88:91]
    v_mfma_f32_16x16x32_bf16 v[92:95], v[28:31], a[236:239], v[92:95]
    s_waitcnt lgkmcnt(3)
    v_mfma_f32_16x16x32_bf16 v[64:67], v[8:11], a[240:243], v[64:67]
    ds_read_b128 v[24:27], v4 offset:34816
    v_mfma_f32_16x16x32_bf16 v[68:71], v[8:11], a[244:247], v[68:71]
    v_mfma_f32_16x16x32_bf16 v[72:75], v[8:11], a[248:251], v[72:75]
    v_mfma_f32_16x16x32_bf16 v[76:79], v[8:11], a[252:255], v[76:79]
    s_waitcnt lgkmcnt(3)
    v_mfma_f32_16x16x32_bf16 v[80:83], v[12:15], a[240:243], v[80:83]
    s_waitcnt vmcnt(0)
    v_cmp_eq_u64 vcc, s[98:99], v[6:7]
    s_nop 0
    s_cmp_eq_u64 vcc, exec
    s_cbranch_scc0 L_p0_slow_82
L_p0_back_83:
    v_mfma_f32_16x16x32_bf16 v[84:87], v[12:15], a[244:247], v[84:87]
    s_add_u32 s60, s56, s65
    ds_read_b128 v[28:31], v4 offset:35840
    v_mfma_f32_16x16x32_bf16 v[88:91], v[12:15], a[248:251], v[88:91]
    buffer_load_dwordx2 v[242:243], v3, s[4:7], s60 offen offset:0 sc1
    v_mfma_f32_16x16x32_bf16 v[92:95], v[12:15], a[252:255], v[92:95]
    s_waitcnt lgkmcnt(3)
    v_mfma_f32_16x16x32_bf16 v[64:67], v[16:19], v[32:35], v[64:67]
    s_barrier
    v_add_u32 v4, 0xfffe5000, v4
    v_mfma_f32_16x16x32_bf16 v[68:71], v[16:19], v[36:39], v[68:71]
    s_add_u32 m0, s49, 73728
    s_add_u32 s61, s48, 368640
    ds_read_b128 v[8:11], v4 offset:0
    v_mfma_f32_16x16x32_bf16 v[72:75], v[16:19], v[40:43], v[72:75]
    buffer_load_dwordx4 v2, s[4:7], s61 offen offset:0 lds
    v_mfma_f32_16x16x32_bf16 v[76:79], v[16:19], v[44:47], v[76:79]
    s_waitcnt lgkmcnt(3)
    v_mfma_f32_16x16x32_bf16 v[80:83], v[20:23], v[32:35], v[80:83]
    ds_read_b128 v[12:15], v4 offset:1024
    v_mfma_f32_16x16x32_bf16 v[84:87], v[20:23], v[36:39], v[84:87]
    v_mfma_f32_16x16x32_bf16 v[88:91], v[20:23], v[40:43], v[88:91]
    buffer_load_dwordx4 v2, s[4:7], s61 offen offset:1024 lds
    v_mfma_f32_16x16x32_bf16 v[92:95], v[20:23], v[44:47], v[92:95]
    s_waitcnt lgkmcnt(3)
    v_mfma_f32_16x16x32_bf16 v[64:67], v[24:27], v[48:51], v[64:67]
    ds_read_b128 v[16:19], v4 offset:2048
    v_mfma_f32_16x16x32_bf16 v[68:71], v[24:27], v[52:55], v[68:71]
    s_add_u32 s71, s67, 32
    v_mov_b32 v6, s98
    v_mov_b32 v7, s99
    v_mfma_f32_16x16x32_bf16 v[72:75], v[24:27], v[56:59], v[72:75]
    buffer_load_dwordx4 v2, s[4:7], s61 offen offset:2048 lds
    v_mfma_f32_16x16x32_bf16 v[76:79], v[24:27], v[60:63], v[76:79]
    s_waitcnt lgkmcnt(3)
    v_mfma_f32_16x16x32_bf16 v[80:83], v[28:31], v[48:51], v[80:83]
    ds_read_b128 v[20:23], v4 offset:3072
    v_mfma_f32_16x16x32_bf16 v[84:87], v[28:31], v[52:55], v[84:87]
    v_mfma_f32_16x16x32_bf16 v[88:91], v[28:31], v[56:59], v[88:91]
    s_mov_b64 exec, 1
    buffer_store_dwordx2 v[6:7], off, s[4:7], s71 sc1
    s_mov_b64 exec, -1
    v_mfma_f32_16x16x32_bf16 v[92:95], v[28:31], v[60:63], v[92:95]
    s_waitcnt lgkmcnt(3)
    v_mfma_f32_16x16x32_bf16 v[96:99], v[8:11], a[0:3], 0
    ds_read_b128 v[24:27], v4 offset:4096
    v_mfma_f32_16x16x32_bf16 v[100:103], v[8:11], a[4:7], 0
    v_mfma_f32_16x16x32_bf16 v[104:107], v[8:11], a[8:11], 0
    buffer_load_dwordx4 v2, s[4:7], s61 offen offset:3072 lds
    v_mfma_f32_16x16x32_bf16 v[108:111], v[8:11], a[12:15], 0
    s_waitcnt lgkmcnt(3)
    s_add_u32 m0, s49, 77824
    s_add_u32 s61, s48, 372736
    v_mfma_f32_16x16x32_bf16 v[112:115], v[12:15], a[0:3], 0
    ds_read_b128 v[28:31], v4 offset:5120
    v_mfma_f32_16x16x32_bf16 v[116:119], v[12:15], a[4:7], 0
    v_fmac_f32 v64, v144, v128
    v_fmac_f32 v65, v145, v128
    v_mfma_f32_16x16x32_bf16 v[120:123], v[12:15], a[8:11], 0
    buffer_load_dwordx4 v2, s[4:7], s61 offen offset:0 lds
    v_mfma_f32_16x16x32_bf16 v[124:127], v[12:15], a[12:15], 0
    s_waitcnt lgkmcnt(3)
    v_fmac_f32 v66, v146, v128
    v_fmac_f32 v67, v147, v128
    v_mfma_f32_16x16x32_bf16 v[96:99], v[16:19], a[16:19], v[96:99]
    ds_read_b128 v[8:11], v4 offset:6144
    v_fmac_f32 v80, v148, v128
    v_mfma_f32_16x16x32_bf16 v[100:103], v[16:19], a[20:23], v[100:103]
    v_fmac_f32 v81, v149, v128
    v_fmac_f32 v82, v150, v128
    v_mfma_f32_16x16x32_bf16 v[104:107], v[16:19], a[24:27], v[104:107]
    buffer_load_dwordx4 v2, s[4:7], s61 offen offset:1024 lds
    v_mfma_f32_16x16x32_bf16 v[108:111], v[16:19], a[28:31], v[108:111]
    s_waitcnt lgkmcnt(3)
    v_fmac_f32 v83, v151, v128
    v_mul_f32 v64, v64, v132
    v_mfma_f32_16x16x32_bf16 v[112:115], v[20:23], a[16:19], v[112:115]
    ds_read_b128 v[12:15], v4 offset:7168
    v_mul_f32 v65, v65, v132
    v_mfma_f32_16x16x32_bf16 v[116:119], v[20:23], a[20:23], v[116:119]
    v_mul_f32 v66, v66, v132
    v_mul_f32 v67, v67, v132
    v_mfma_f32_16x16x32_bf16 v[120:123], v[20:23], a[24:27], v[120:123]
    buffer_load_dwordx4 v2, s[4:7], s61 offen offset:2048 lds
    v_mfma_f32_16x16x32_bf16 v[124:127], v[20:23], a[28:31], v[124:127]
    s_waitcnt lgkmcnt(3)
    v_mul_f32 v64, v64, v80
    v_mul_f32 v65, v65, v81
    v_mfma_f32_16x16x32_bf16 v[96:99], v[24:27], a[32:35], v[96:99]
    ds_read_b128 v[16:19], v4 offset:8192
    v_mul_f32 v66, v66, v82
    v_mfma_f32_16x16x32_bf16 v[100:103], v[24:27], a[36:39], v[100:103]
    v_mul_f32 v67, v67, v83
    v_cvt_pk_bf16_f32 v224, v64, v65
    v_mfma_f32_16x16x32_bf16 v[104:107], v[24:27], a[40:43], v[104:107]
    buffer_load_dwordx4 v2, s[4:7], s61 offen offset:3072 lds
    v_mfma_f32_16x16x32_bf16 v[108:111], v[24:27], a[44:47], v[108:111]
    s_waitcnt lgkmcnt(3)
    s_add_u32 m0, s49, 81920
    s_add_u32 s61, s48, 376832
    v_mfma_f32_16x16x32_bf16 v[112:115], v[28:31], a[32:35], v[112:115]
    ds_read_b128 v[20:23], v4 offset:9216
    v_cvt_pk_bf16_f32 v225, v66, v67
    v_mfma_f32_16x16x32_bf16 v[116:119], v[28:31], a[36:39], v[116:119]
    v_fmac_f32 v68, v144, v129
    v_fmac_f32 v69, v145, v129
    v_mfma_f32_16x16x32_bf16 v[120:123], v[28:31], a[40:43], v[120:123]
    buffer_load_dwordx4 v2, s[4:7], s61 offen offset:0 lds
    v_mfma_f32_16x16x32_bf16 v[124:127], v[28:31], a[44:47], v[124:127]
    s_waitcnt lgkmcnt(3)
    v_fmac_f32 v70, v146, v129
    v_fmac_f32 v71, v147, v129
    v_mfma_f32_16x16x32_bf16 v[96:99], v[8:11], a[48:51], v[96:99]
    ds_read_b128 v[24:27], v4 offset:10240
    v_fmac_f32 v84, v148, v129
    v_mfma_f32_16x16x32_bf16 v[100:103], v[8:11], a[52:55], v[100:103]
    v_fmac_f32 v85, v149, v129
    v_fmac_f32 v86, v150, v129
    v_mfma_f32_16x16x32_bf16 v[104:107], v[8:11], a[56:59], v[104:107]
    buffer_load_dwordx2 v[246:247], v3, s[4:7], s60 offen offset:512 sc1
    v_mfma_f32_16x16x32_bf16 v[108:111], v[8:11], a[60:63], v[108:111]
    s_waitcnt lgkmcnt(3)
    v_fmac_f32 v87, v151, v129
    v_mul_f32 v68, v68, v133
    v_mfma_f32_16x16x32_bf16 v[112:115], v[12:15], a[48:51], v[112:115]
    ds_read_b128 v[28:31], v4 offset:11264
    v_mul_f32 v69, v69, v133
    v_mfma_f32_16x16x32_bf16 v[116:119], v[12:15], a[52:55], v[116:119]
    v_mul_f32 v70, v70, v133
    v_mul_f32 v71, v71, v133
    v_mfma_f32_16x16x32_bf16 v[120:123], v[12:15], a[56:59], v[120:123]
    buffer_load_dwordx2 v[250:251], v3, s[4:7], s60 offen offset:1024 sc1
    v_mfma_f32_16x16x32_bf16 v[124:127], v[12:15], a[60:63], v[124:127]
    s_waitcnt lgkmcnt(3)
    v_mul_f32 v68, v68, v84
    v_mul_f32 v69, v69, v85
    v_mfma_f32_16x16x32_bf16 v[96:99], v[16:19], a[64:67], v[96:99]
    ds_read_b128 v[8:11], v4 offset:12288
    v_mul_f32 v70, v70, v86
    v_mfma_f32_16x16x32_bf16 v[100:103], v[16:19], a[68:71], v[100:103]
    v_mul_f32 v71, v71, v87
    v_cvt_pk_bf16_f32 v228, v68, v69
    v_mfma_f32_16x16x32_bf16 v[104:107], v[16:19], a[72:75], v[104:107]
    buffer_load_dwordx2 v[254:255], v3, s[4:7], s60 offen offset:1536 sc1
    v_mfma_f32_16x16x32_bf16 v[108:111], v[16:19], a[76:79], v[108:111]
    s_waitcnt lgkmcnt(3)
    s_add_u32 s60, s57, s65
    v_cvt_pk_bf16_f32 v229, v70, v71
    v_mfma_f32_16x16x32_bf16 v[112:115], v[20:23], a[64:67], v[112:115]
    ds_read_b128 v[12:15], v4 offset:13312
    v_fmac_f32 v72, v144, v130
    v_mfma_f32_16x16x32_bf16 v[116:119], v[20:23], a[68:71], v[116:119]
    v_fmac_f32 v73, v145, v130
    v_fmac_f32 v74, v146, v130
    v_mfma_f32_16x16x32_bf16 v[120:123], v[20:23], a[72:75], v[120:123]
    buffer_load_dwordx2 a[0:1], v3, s[4:7], s60 offen offset:0 sc1
    v_mfma_f32_16x16x32_bf16 v[124:127], v[20:23], a[76:79], v[124:127]
    s_waitcnt lgkmcnt(3)
    v_fmac_f32 v75, v147, v130
    v_fmac_f32 v88, v148, v130
    v_mfma_f32_16x16x32_bf16 v[96:99], v[24:27], a[80:83], v[96:99]
    ds_read_b128 v[16:19], v4 offset:14336
    v_fmac_f32 v89, v149, v130
    v_mfma_f32_16x16x32_bf16 v[100:103], v[24:27], a[84:87], v[100:103]
    v_fmac_f32 v90, v150, v130
    v_fmac_f32 v91, v151, v130
    v_mfma_f32_16x16x32_bf16 v[104:107], v[24:27], a[88:91], v[104:107]
    buffer_load_dwordx2 a[4:5], v3, s[4:7], s60 offen offset:512 sc1
    v_mfma_f32_16x16x32_bf16 v[108:111], v[24:27], a[92:95], v[108:111]
    s_waitcnt lgkmcnt(3)
    v_mul_f32 v72, v72, v134
    v_mul_f32 v73, v73, v134
    v_mfma_f32_16x16x32_bf16 v[112:115], v[28:31], a[80:83], v[112:115]
    ds_read_b128 v[20:23], v4 offset:15360
    v_mul_f32 v74, v74, v134
    v_mfma_f32_16x16x32_bf16 v[116:119], v[28:31], a[84:87], v[116:119]
    v_mul_f32 v75, v75, v134
    v_mul_f32 v72, v72, v88
    v_mfma_f32_16x16x32_bf16 v[120:123], v[28:31], a[88:91], v[120:123]
    buffer_load_dwordx2 a[8:9], v3, s[4:7], s60 offen offset:1024 sc1
    v_mfma_f32_16x16x32_bf16 v[124:127], v[28:31], a[92:95], v[124:127]
    s_waitcnt lgkmcnt(3)
    v_mul_f32 v73, v73, v89
    v_mul_f32 v74, v74, v90
    v_mfma_f32_16x16x32_bf16 v[96:99], v[8:11], a[96:99], v[96:99]
    ds_read_b128 v[24:27], v4 offset:16384
    v_mul_f32 v75, v75, v91
    v_mfma_f32_16x16x32_bf16 v[100:103], v[8:11], a[100:103], v[100:103]
    v_cvt_pk_bf16_f32 v232, v72, v73
    v_cvt_pk_bf16_f32 v233, v74, v75
    v_mfma_f32_16x16x32_bf16 v[104:107], v[8:11], a[104:107], v[104:107]
    buffer_load_dwordx2 a[12:13], v3, s[4:7], s60 offen offset:1536 sc1
    v_mfma_f32_16x16x32_bf16 v[108:111], v[8:11], a[108:111], v[108:111]
    s_waitcnt lgkmcnt(3)
    s_add_u32 s60, s58, s65
    v_fmac_f32 v76, v144, v131
    v_mfma_f32_16x16x32_bf16 v[112:115], v[12:15], a[96:99], v[112:115]
    ds_read_b128 v[28:31], v4 offset:17408
    v_fmac_f32 v77, v145, v131
    v_mfma_f32_16x16x32_bf16 v[116:119], v[12:15], a[100:103], v[116:119]
    v_fmac_f32 v78, v146, v131
    v_fmac_f32 v79, v147, v131
    v_mfma_f32_16x16x32_bf16 v[120:123], v[12:15], a[104:107], v[120:123]
    buffer_load_dwordx2 a[2:3], v3, s[4:7], s60 offen offset:0 sc1
    v_mfma_f32_16x16x32_bf16 v[124:127], v[12:15], a[108:111], v[124:127]
    s_waitcnt lgkmcnt(3)
    v_fmac_f32 v92, v148, v131
    v_fmac_f32 v93, v149, v131
    v_mfma_f32_16x16x32_bf16 v[96:99], v[16:19], a[112:115], v[96:99]
    ds_read_b128 v[8:11], v4 offset:18432
    v_fmac_f32 v94, v150, v131
    v_mfma_f32_16x16x32_bf16 v[100:103], v[16:19], a[116:119], v[100:103]
    v_fmac_f32 v95, v151, v131
    v_mul_f32 v76, v76, v135
    v_mfma_f32_16x16x32_bf16 v[104:107], v[16:19], a[120:123], v[104:107]
    buffer_load_dwordx2 a[6:7], v3, s[4:7], s60 offen offset:512 sc1
    v_mfma_f32_16x16x32_bf16 v[108:111], v[16:19], a[124:127], v[108:111]
    s_waitcnt lgkmcnt(3)
    v_mul_f32 v77, v77, v135
    v_mul_f32 v78, v78, v135
    v_mfma_f32_16x16x32_bf16 v[112:115], v[20:23], a[112:115], v[112:115]
    ds_read_b128 v[12:15], v4 offset:19456
    v_mul_f32 v79, v79, v135
    v_mfma_f32_16x16x32_bf16 v[116:119], v[20:23], a[116:119], v[116:119]
    v_mul_f32 v76, v76, v92
    v_mul_f32 v77, v77, v93
    v_mfma_f32_16x16x32_bf16 v[120:123], v[20:23], a[120:123], v[120:123]
    buffer_load_dwordx2 a[10:11], v3, s[4:7], s60 offen offset:1024 sc1
    v_mfma_f32_16x16x32_bf16 v[124:127], v[20:23], a[124:127], v[124:127]
    s_waitcnt lgkmcnt(3)
    v_mul_f32 v78, v78, v94
    v_mul_f32 v79, v79, v95
    v_mfma_f32_16x16x32_bf16 v[96:99], v[24:27], a[128:131], v[96:99]
    ds_read_b128 v[16:19], v4 offset:20480
    v_cvt_pk_bf16_f32 v236, v76, v77
    v_mfma_f32_16x16x32_bf16 v[100:103], v[24:27], a[132:135], v[100:103]
    v_cvt_pk_bf16_f32 v237, v78, v79
    v_mfma_f32_16x16x32_bf16 v[104:107], v[24:27], a[136:139], v[104:107]
    buffer_load_dwordx2 a[14:15], v3, s[4:7], s60 offen offset:1536 sc1
    v_mfma_f32_16x16x32_bf16 v[108:111], v[24:27], a[140:143], v[108:111]
    s_waitcnt lgkmcnt(3)
    s_add_u32 s60, s56, 0
    v_mfma_f32_16x16x32_bf16 v[112:115], v[28:31], a[128:131], v[112:115]
    ds_read_b128 v[20:23], v4 offset:21504
    v_mfma_f32_16x16x32_bf16 v[116:119], v[28:31], a[132:135], v[116:119]
    v_mfma_f32_16x16x32_bf16 v[120:123], v[28:31], a[136:139], v[120:123]
    buffer_load_dwordx4 a[16:19], v2, s[4:7], s60 offen offset:0 sc1
    v_mfma_f32_16x16x32_bf16 v[124:127], v[28:31], a[140:143], v[124:127]
    s_waitcnt lgkmcnt(3)
    v_mfma_f32_16x16x32_bf16 v[96:99], v[8:11], a[144:147], v[96:99]
    ds_read_b128 v[24:27], v4 offset:22528
    v_mfma_f32_16x16x32_bf16 v[100:103], v[8:11], a[148:151], v[100:103]
    v_mfma_f32_16x16x32_bf16 v[104:107], v[8:11], a[152:155], v[104:107]
    buffer_load_dwordx4 a[20:23], v2, s[4:7], s60 offen offset:1024 sc1
    v_mfma_f32_16x16x32_bf16 v[108:111], v[8:11], a[156:159], v[108:111]
    s_waitcnt lgkmcnt(3)
    v_mfma_f32_16x16x32_bf16 v[112:115], v[12:15], a[144:147], v[112:115]
    ds_read_b128 v[28:31], v4 offset:23552
    v_mfma_f32_16x16x32_bf16 v[116:119], v[12:15], a[148:151], v[116:119]
    v_mfma_f32_16x16x32_bf16 v[120:123], v[12:15], a[152:155], v[120:123]
    buffer_load_dwordx4 a[24:27], v2, s[4:7], s60 offen offset:2048 sc1
    v_mfma_f32_16x16x32_bf16 v[124:127], v[12:15], a[156:159], v[124:127]
    s_waitcnt lgkmcnt(3)
    v_mfma_f32_16x16x32_bf16 v[96:99], v[16:19], a[160:163], v[96:99]
    ds_read_b128 v[8:11], v4 offset:24576
    v_mfma_f32_16x16x32_bf16 v[100:103], v[16:19], a[164:167], v[100:103]
    v_mfma_f32_16x16x32_bf16 v[104:107], v[16:19], a[168:171], v[104:107]
    buffer_load_dwordx4 a[28:31], v2, s[4:7], s60 offen offset:3072 sc1
    v_mfma_f32_16x16x32_bf16 v[108:111], v[16:19], a[172:175], v[108:111]
    s_waitcnt lgkmcnt(3)
    s_add_u32 s60, s57, 0
    v_mfma_f32_16x16x32_bf16 v[112:115], v[20:23], a[160:163], v[112:115]
    ds_read_b128 v[12:15], v4 offset:25600
    v_mfma_f32_16x16x32_bf16 v[116:119], v[20:23], a[164:167], v[116:119]
    v_mfma_f32_16x16x32_bf16 v[120:123], v[20:23], a[168:171], v[120:123]
    buffer_load_dwordx4 a[32:35], v2, s[4:7], s60 offen offset:0 sc1
    v_mfma_f32_16x16x32_bf16 v[124:127], v[20:23], a[172:175], v[124:127]
    s_waitcnt lgkmcnt(3)
    v_mfma_f32_16x16x32_bf16 v[96:99], v[24:27], a[176:179], v[96:99]
    ds_read_b128 v[16:19], v4 offset:26624
    v_mfma_f32_16x16x32_bf16 v[100:103], v[24:27], a[180:183], v[100:103]
    v_mfma_f32_16x16x32_bf16 v[104:107], v[24:27], a[184:187], v[104:107]
    buffer_load_dwordx4 a[36:39], v2, s[4:7], s60 offen offset:1024 sc1
    v_mfma_f32_16x16x32_bf16 v[108:111], v[24:27], a[188:191], v[108:111]
    s_waitcnt lgkmcnt(3)
    v_mfma_f32_16x16x32_bf16 v[112:115], v[28:31], a[176:179], v[112:115]
    ds_read_b128 v[20:23], v4 offset:27648
    v_mfma_f32_16x16x32_bf16 v[116:119], v[28:31], a[180:183], v[116:119]
    v_mfma_f32_16x16x32_bf16 v[120:123], v[28:31], a[184:187], v[120:123]
    buffer_load_dwordx4 a[40:43], v2, s[4:7], s60 offen offset:2048 sc1
    v_mfma_f32_16x16x32_bf16 v[124:127], v[28:31], a[188:191], v[124:127]
    s_waitcnt lgkmcnt(3)
    v_mfma_f32_16x16x32_bf16 v[96:99], v[8:11], a[192:195], v[96:99]
    ds_read_b128 v[24:27], v4 offset:28672
    v_mfma_f32_16x16x32_bf16 v[100:103], v[8:11], a[196:199], v[100:103]
    v_mfma_f32_16x16x32_bf16 v[104:107], v[8:11], a[200:203], v[104:107]
    buffer_load_dwordx4 a[44:47], v2, s[4:7], s60 offen offset:3072 sc1
    v_mfma_f32_16x16x32_bf16 v[108:111], v[8:11], a[204:207], v[108:111]
    s_waitcnt lgkmcnt(3)
    s_add_u32 s60, s58, 0
    v_mfma_f32_16x16x32_bf16 v[112:115], v[12:15], a[192:195], v[112:115]
    ds_read_b128 v[28:31], v4 offset:29696
    v_mfma_f32_16x16x32_bf16 v[116:119], v[12:15], a[196:199], v[116:119]
    v_mfma_f32_16x16x32_bf16 v[120:123], v[12:15], a[200:203], v[120:123]
    buffer_load_dwordx4 a[48:51], v2, s[4:7], s60 offen offset:0 sc1
    v_mfma_f32_16x16x32_bf16 v[124:127], v[12:15], a[204:207], v[124:127]
    s_waitcnt lgkmcnt(3)
    v_mfma_f32_16x16x32_bf16 v[96:99], v[16:19], a[208:211], v[96:99]
    ds_read_b128 v[8:11], v4 offset:30720
    v_mfma_f32_16x16x32_bf16 v[100:103], v[16:19], a[212:215], v[100:103]
    v_mfma_f32_16x16x32_bf16 v[104:107], v[16:19], a[216:219], v[104:107]
    buffer_load_dwordx4 a[52:55], v2, s[4:7], s60 offen offset:1024 sc1
    v_mfma_f32_16x16x32_bf16 v[108:111], v[16:19], a[220:223], v[108:111]
    s_waitcnt lgkmcnt(3)
    v_mfma_f32_16x16x32_bf16 v[112:115], v[20:23], a[208:211], v[112:115]
    ds_read_b128 v[12:15], v4 offset:31744
    v_mfma_f32_16x16x32_bf16 v[116:119], v[20:23], a[212:215], v[116:119]
    v_mfma_f32_16x16x32_bf16 v[120:123], v[20:23], a[216:219], v[120:123]
    buffer_load_dwordx4 a[56:59], v2, s[4:7], s60 offen offset:2048 sc1
    v_mfma_f32_16x16x32_bf16 v[124:127], v[20:23], a[220:223], v[124:127]
    s_waitcnt lgkmcnt(3)
    v_mfma_f32_16x16x32_bf16 v[96:99], v[24:27], a[224:227], v[96:99]
    ds_read_b128 v[16:19], v4 offset:32768
    v_mfma_f32_16x16x32_bf16 v[100:103], v[24:27], a[228:231], v[100:103]
    v_mfma_f32_16x16x32_bf16 v[104:107], v[24:27], a[232:235], v[104:107]
    buffer_load_dwordx4 a[60:63], v2, s[4:7], s60 offen offset:3072 sc1
    v_mfma_f32_16x16x32_bf16 v[108:111], v[24:27], a[236:239], v[108:111]
    s_waitcnt lgkmcnt(3)
    s_add_u32 s60, s56, 16384
    v_mfma_f32_16x16x32_bf16 v[112:115], v[28:31], a[224:227], v[112:115]
    ds_read_b128 v[20:23], v4 offset:33792
    v_mfma_f32_16x16x32_bf16 v[116:119], v[28:31], a[228:231], v[116:119]
    v_mfma_f32_16x16x32_bf16 v[120:123], v[28:31], a[232:235], v[120:123]
    buffer_load_dwordx4 a[64:67], v2, s[4:7], s60 offen offset:0 sc1
    v_mfma_f32_16x16x32_bf16 v[124:127], v[28:31], a[236:239], v[124:127]
    s_waitcnt lgkmcnt(3)
    v_mfma_f32_16x16x32_bf16 v[96:99], v[8:11], a[240:243], v[96:99]
    ds_read_b128 v[24:27], v4 offset:34816
    v_mfma_f32_16x16x32_bf16 v[100:103], v[8:11], a[244:247], v[100:103]
    v_mfma_f32_16x16x32_bf16 v[104:107], v[8:11], a[248:251], v[104:107]
    buffer_load_dwordx4 a[68:71], v2, s[4:7], s60 offen offset:1024 sc1
    v_mfma_f32_16x16x32_bf16 v[108:111], v[8:11], a[252:255], v[108:111]
    s_waitcnt lgkmcnt(3)
    v_mfma_f32_16x16x32_bf16 v[112:115], v[12:15], a[240:243], v[112:115]
    ds_read_b128 v[28:31], v4 offset:35840
    v_mfma_f32_16x16x32_bf16 v[116:119], v[12:15], a[244:247], v[116:119]
    v_mfma_f32_16x16x32_bf16 v[120:123], v[12:15], a[248:251], v[120:123]
    buffer_load_dwordx4 a[72:75], v2, s[4:7], s60 offen offset:2048 sc1
    v_mfma_f32_16x16x32_bf16 v[124:127], v[12:15], a[252:255], v[124:127]
    s_waitcnt lgkmcnt(3)
    v_mfma_f32_16x16x32_bf16 v[96:99], v[16:19], v[32:35], v[96:99]
    s_barrier
    v_add_u32 v4, 0x9000, v4
    v_mfma_f32_16x16x32_bf16 v[100:103], v[16:19], v[36:39], v[100:103]
    s_add_u32 m0, s49, 110592
    s_add_u32 s61, s48, 405504
    ds_read_b128 v[8:11], v4 offset:0
    v_mfma_f32_16x16x32_bf16 v[104:107], v[16:19], v[40:43], v[104:107]
    buffer_load_dwordx4 a[76:79], v2, s[4:7], s60 offen offset:3072 sc1
    v_mfma_f32_16x16x32_bf16 v[108:111], v[16:19], v[44:47], v[108:111]
    s_waitcnt lgkmcnt(3)
    s_add_u32 s60, s57, 16384
    v_mfma_f32_16x16x32_bf16 v[112:115], v[20:23], v[32:35], v[112:115]
    ds_read_b128 v[12:15], v4 offset:1024
    v_mfma_f32_16x16x32_bf16 v[116:119], v[20:23], v[36:39], v[116:119]
    v_mfma_f32_16x16x32_bf16 v[120:123], v[20:23], v[40:43], v[120:123]
    buffer_load_dwordx4 a[80:83], v2, s[4:7], s60 offen offset:0 sc1
    v_mfma_f32_16x16x32_bf16 v[124:127], v[20:23], v[44:47], v[124:127]
    s_waitcnt lgkmcnt(3)
    v_mfma_f32_16x16x32_bf16 v[96:99], v[24:27], v[48:51], v[96:99]
    ds_read_b128 v[16:19], v4 offset:2048
    v_mfma_f32_16x16x32_bf16 v[100:103], v[24:27], v[52:55], v[100:103]
    v_mfma_f32_16x16x32_bf16 v[104:107], v[24:27], v[56:59], v[104:107]
    buffer_load_dwordx4 a[84:87], v2, s[4:7], s60 offen offset:1024 sc1
    v_mfma_f32_16x16x32_bf16 v[108:111], v[24:27], v[60:63], v[108:111]
    s_waitcnt lgkmcnt(3)
    v_mfma_f32_16x16x32_bf16 v[112:115], v[28:31], v[48:51], v[112:115]
    ds_read_b128 v[20:23], v4 offset:3072
    v_mfma_f32_16x16x32_bf16 v[116:119], v[28:31], v[52:55], v[116:119]
    v_mfma_f32_16x16x32_bf16 v[120:123], v[28:31], v[56:59], v[120:123]
    buffer_load_dwordx4 a[88:91], v2, s[4:7], s60 offen offset:2048 sc1
    v_mfma_f32_16x16x32_bf16 v[124:127], v[28:31], v[60:63], v[124:127]
    s_waitcnt lgkmcnt(3)
    v_mfma_f32_16x16x32_bf16 v[32:35], v[8:11], v[176:179], 0
    ds_read_b128 v[24:27], v4 offset:4096
    v_mfma_f32_16x16x32_bf16 v[40:43], v[8:11], v[180:183], 0
    v_mfma_f32_16x16x32_bf16 v[48:51], v[8:11], v[184:187], 0
    buffer_load_dwordx4 a[92:95], v2, s[4:7], s60 offen offset:3072 sc1
    v_mfma_f32_16x16x32_bf16 v[56:59], v[8:11], v[188:191], 0
    s_waitcnt lgkmcnt(3)
    s_add_u32 s60, s58, 16384
    v_mfma_f32_16x16x32_bf16 v[36:39], v[12:15], v[176:179], 0
    ds_read_b128 v[28:31], v4 offset:5120
    v_mfma_f32_16x16x32_bf16 v[44:47], v[12:15], v[180:183], 0
    v_fmac_f32 v96, v136, v128
    v_fmac_f32 v97, v137, v128
    v_mfma_f32_16x16x32_bf16 v[52:55], v[12:15], v[184:187], 0
    v_fmac_f32 v98, v138, v128
    v_fmac_f32 v99, v139, v128
    v_mfma_f32_16x16x32_bf16 v[60:63], v[12:15], v[188:191], 0
    s_waitcnt lgkmcnt(3)
    v_fmac_f32 v112, v140, v128
    v_fmac_f32 v113, v141, v128
    v_mfma_f32_16x16x32_bf16 v[64:67], v[16:19], v[176:179], 0
    ds_read_b128 v[8:11], v4 offset:6144
    v_fmac_f32 v114, v142, v128
    v_mfma_f32_16x16x32_bf16 v[72:75], v[16:19], v[180:183], 0
    v_fmac_f32 v115, v143, v128
    v_mul_f32 v96, v96, v132
    v_mfma_f32_16x16x32_bf16 v[80:83], v[16:19], v[184:187], 0
    v_mul_f32 v97, v97, v132
    v_mul_f32 v98, v98, v132
    v_mfma_f32_16x16x32_bf16 v[88:91], v[16:19], v[188:191], 0
    s_waitcnt lgkmcnt(3)
    v_mul_f32 v99, v99, v132
    v_mul_f32 v96, v96, v112
    v_mfma_f32_16x16x32_bf16 v[68:71], v[20:23], v[176:179], 0
    ds_read_b128 v[12:15], v4 offset:7168
    v_mul_f32 v97, v97, v113
    v_mfma_f32_16x16x32_bf16 v[76:79], v[20:23], v[180:183], 0
    v_mul_f32 v98, v98, v114
    v_mul_f32 v99, v99, v115
    v_mfma_f32_16x16x32_bf16 v[84:87], v[20:23], v[184:187], 0
    v_cvt_pk_bf16_f32 v226, v96, v97
    v_cvt_pk_bf16_f32 v227, v98, v99
    v_mfma_f32_16x16x32_bf16 v[92:95], v[20:23], v[188:191], 0
    s_waitcnt lgkmcnt(3)
    s_add_u32 s66, s51, 49152
    v_mfma_f32_16x16x32_bf16 v[160:163], v[24:27], v[176:179], 0
    ds_read_b128 v[16:19], v4 offset:8192
    v_mfma_f32_16x16x32_bf16 v[164:167], v[24:27], v[180:183], 0
    buffer_store_dwordx4 v[224:227], v2, s[4:7], s66 offen offset:0 sc1
    v_mfma_f32_16x16x32_bf16 v[168:171], v[24:27], v[184:187], 0
    v_fmac_f32 v100, v136, v129
    v_fmac_f32 v101, v137, v129
    v_mfma_f32_16x16x32_bf16 v[172:175], v[24:27], v[188:191], 0
    s_waitcnt lgkmcnt(3)
    v_fmac_f32 v102, v138, v129
    v_fmac_f32 v103, v139, v129
    v_mfma_f32_16x16x32_bf16 v[32:35], v[28:31], v[192:195], v[32:35]
    ds_read_b128 v[20:23], v4 offset:9216
    v_fmac_f32 v116, v140, v129
    v_mfma_f32_16x16x32_bf16 v[40:43], v[28:31], v[196:199], v[40:43]
    v_fmac_f32 v117, v141, v129
    v_fmac_f32 v118, v142, v129
    v_mfma_f32_16x16x32_bf16 v[48:51], v[28:31], v[200:203], v[48:51]
    v_fmac_f32 v119, v143, v129
    v_mul_f32 v100, v100, v133
    v_mfma_f32_16x16x32_bf16 v[56:59], v[28:31], v[204:207], v[56:59]
    s_waitcnt lgkmcnt(3)
    v_mul_f32 v101, v101, v133
    v_mul_f32 v102, v102, v133
    v_mfma_f32_16x16x32_bf16 v[36:39], v[8:11], v[192:195], v[36:39]
    ds_read_b128 v[24:27], v4 offset:10240
    v_mul_f32 v103, v103, v133
    v_mfma_f32_16x16x32_bf16 v[44:47], v[8:11], v[196:199], v[44:47]
    v_mul_f32 v100, v100, v116
    v_mul_f32 v101, v101, v117
    v_mfma_f32_16x16x32_bf16 v[52:55], v[8:11], v[200:203], v[52:55]
    v_mul_f32 v102, v102, v118
    v_mul_f32 v103, v103, v119
    v_mfma_f32_16x16x32_bf16 v[60:63], v[8:11], v[204:207], v[60:63]
    s_waitcnt lgkmcnt(3)
    v_cvt_pk_bf16_f32 v230, v100, v101
    v_cvt_pk_bf16_f32 v231, v102, v103
    v_mfma_f32_16x16x32_bf16 v[64:67], v[12:15], v[192:195], v[64:67]
    ds_read_b128 v[28:31], v4 offset:11264
    v_mfma_f32_16x16x32_bf16 v[72:75], v[12:15], v[196:199], v[72:75]
    buffer_store_dwordx4 v[228:231], v2, s[4:7], s66 offen offset:1024 sc1
    v_mfma_f32_16x16x32_bf16 v[80:83], v[12:15], v[200:203], v[80:83]
    v_fmac_f32 v104, v136, v130
    v_fmac_f32 v105, v137, v130
    v_mfma_f32_16x16x32_bf16 v[88:91], v[12:15], v[204:207], v[88:91]
    s_waitcnt lgkmcnt(3)
    v_fmac_f32 v106, v138, v130
    v_fmac_f32 v107, v139, v130
    v_mfma_f32_16x16x32_bf16 v[68:71], v[16:19], v[192:195], v[68:71]
    ds_read_b128 v[8:11], v4 offset:12288
    v_fmac_f32 v120, v140, v130
    v_mfma_f32_16x16x32_bf16 v[76:79], v[16:19], v[196:199], v[76:79]
    v_fmac_f32 v121, v141, v130
    v_fmac_f32 v122, v142, v130
    v_mfma_f32_16x16x32_bf16 v[84:87], v[16:19], v[200:203], v[84:87]
    v_fmac_f32 v123, v143, v130
    v_mul_f32 v104, v104, v134
    v_mfma_f32_16x16x32_bf16 v[92:95], v[16:19], v[204:207], v[92:95]
    s_waitcnt lgkmcnt(3)
    v_mul_f32 v105, v105, v134
    v_mul_f32 v106, v106, v134
    v_mfma_f32_16x16x32_bf16 v[160:163], v[20:23], v[192:195], v[160:163]
    ds_read_b128 v[12:15], v4 offset:13312
    v_mul_f32 v107, v107, v134
    v_mfma_f32_16x16x32_bf16 v[164:167], v[20:23], v[196:199], v[164:167]
    v_mul_f32 v104, v104, v120
    v_mul_f32 v105, v105, v121
    v_mfma_f32_16x16x32_bf16 v[168:171], v[20:23], v[200:203], v[168:171]
    v_mul_f32 v106, v106, v122
    v_mul_f32 v107, v107, v123
    v_mfma_f32_16x16x32_bf16 v[172:175], v[20:23], v[204:207], v[172:175]
    s_waitcnt lgkmcnt(3)
    v_cvt_pk_bf16_f32 v234, v104, v105
    v_cvt_pk_bf16_f32 v235, v106, v107
    v_mfma_f32_16x16x32_bf16 v[32:35], v[24:27], v[208:211], v[32:35]
    ds_read_b128 v[16:19], v4 offset:14336
    v_mfma_f32_16x16x32_bf16 v[40:43], v[24:27], v[212:215], v[40:43]
    buffer_store_dwordx4 v[232:235], v2, s[4:7], s66 offen offset:2048 sc1
    v_mfma_f32_16x16x32_bf16 v[48:51], v[24:27], v[216:219], v[48:51]
    v_fmac_f32 v108, v136, v131
    v_fmac_f32 v109, v137, v131
    v_mfma_f32_16x16x32_bf16 v[56:59], v[24:27], v[220:223], v[56:59]
    s_waitcnt lgkmcnt(3)
    v_fmac_f32 v110, v138, v131
    v_fmac_f32 v111, v139, v131
    v_mfma_f32_16x16x32_bf16 v[36:39], v[28:31], v[208:211], v[36:39]
    ds_read_b128 v[20:23], v4 offset:15360
    v_fmac_f32 v124, v140, v131
    v_mfma_f32_16x16x32_bf16 v[44:47], v[28:31], v[212:215], v[44:47]
    v_fmac_f32 v125, v141, v131
    v_fmac_f32 v126, v142, v131
    v_mfma_f32_16x16x32_bf16 v[52:55], v[28:31], v[216:219], v[52:55]
    buffer_load_dwordx4 a[96:99], v2, s[4:7], s60 offen offset:0 sc1
    buffer_load_dwordx4 a[100:103], v2, s[4:7], s60 offen offset:1024 sc1
    buffer_load_dwordx4 a[104:107], v2, s[4:7], s60 offen offset:2048 sc1
    buffer_load_dwordx4 a[108:111], v2, s[4:7], s60 offen offset:3072 sc1
    s_add_u32 s55, s52, 32
    buffer_load_dwordx2 v[6:7], v0, s[4:7], s55 offen sc1
    v_mfma_f32_16x16x32_bf16 v[60:63], v[28:31], v[220:223], v[60:63]
    s_waitcnt lgkmcnt(3)
    v_fmac_f32 v127, v143, v131
    v_mul_f32 v108, v108, v135
    v_mfma_f32_16x16x32_bf16 v[64:67], v[8:11], v[208:211], v[64:67]
    ds_read_b128 v[24:27], v4 offset:16384
    v_mul_f32 v109, v109, v135
    v_mfma_f32_16x16x32_bf16 v[72:75], v[8:11], v[212:215], v[72:75]
    v_mul_f32 v110, v110, v135
    v_mul_f32 v111, v111, v135
    v_mfma_f32_16x16x32_bf16 v[80:83], v[8:11], v[216:219], v[80:83]
    v_mul_f32 v108, v108, v124
    v_mul_f32 v109, v109, v125
    v_mfma_f32_16x16x32_bf16 v[88:91], v[8:11], v[220:223], v[88:91]
    s_waitcnt lgkmcnt(3)
    v_mul_f32 v110, v110, v126
    v_mul_f32 v111, v111, v127
    v_mfma_f32_16x16x32_bf16 v[68:71], v[12:15], v[208:211], v[68:71]
    ds_read_b128 v[28:31], v4 offset:17408
    v_cvt_pk_bf16_f32 v238, v108, v109
    v_mfma_f32_16x16x32_bf16 v[76:79], v[12:15], v[212:215], v[76:79]
    buffer_load_dwordx4 v2, s[4:7], s61 offen offset:0 lds
    v_mfma_f32_16x16x32_bf16 v[84:87], v[12:15], v[216:219], v[84:87]
    v_cvt_pk_bf16_f32 v239, v110, v111
    v_mfma_f32_16x16x32_bf16 v[92:95], v[12:15], v[220:223], v[92:95]
    s_waitcnt lgkmcnt(3)
    v_mfma_f32_16x16x32_bf16 v[160:163], v[16:19], v[208:211], v[160:163]
    ds_read_b128 v[8:11], v4 offset:18432
    v_mfma_f32_16x16x32_bf16 v[164:167], v[16:19], v[212:215], v[164:167]
    buffer_store_dwordx4 v[236:239], v2, s[4:7], s66 offen offset:3072 sc1
    v_mfma_f32_16x16x32_bf16 v[168:171], v[16:19], v[216:219], v[168:171]
    v_mfma_f32_16x16x32_bf16 v[172:175], v[16:19], v[220:223], v[172:175]
    s_waitcnt lgkmcnt(3)
    v_mfma_f32_16x16x32_bf16 v[96:99], v[20:23], v[176:179], 0
    ds_read_b128 v[12:15], v4 offset:19456
    v_mfma_f32_16x16x32_bf16 v[104:107], v[20:23], v[180:183], 0
    buffer_load_dwordx4 v2, s[4:7], s61 offen offset:1024 lds
    v_mfma_f32_16x16x32_bf16 v[112:115], v[20:23], v[184:187], 0
    v_mfma_f32_16x16x32_bf16 v[120:123], v[20:23], v[188:191], 0
    s_waitcnt lgkmcnt(3)
    v_mfma_f32_16x16x32_bf16 v[100:103], v[24:27], v[176:179], 0
    ds_read_b128 v[16:19], v4 offset:20480
    v_mfma_f32_16x16x32_bf16 v[108:111], v[24:27], v[180:183], 0
    buffer_load_dwordx4 v2, s[4:7], s61 offen offset:2048 lds
    v_mfma_f32_16x16x32_bf16 v[116:119], v[24:27], v[184:187], 0
    v_mfma_f32_16x16x32_bf16 v[124:127], v[24:27], v[188:191], 0
    s_waitcnt lgkmcnt(3)
    v_mfma_f32_16x16x32_bf16 v[128:131], v[28:31], v[176:179], 0
    ds_read_b128 v[20:23], v4 offset:21504
    v_mfma_f32_16x16x32_bf16 v[136:139], v[28:31], v[180:183], 0
    buffer_load_dwordx4 v2, s[4:7], s61 offen offset:3072 lds
    v_mfma_f32_16x16x32_bf16 v[144:147], v[28:31], v[184:187], 0
    s_add_u32 m0, s49, 114688
    s_add_u32 s61, s48, 409600
    v_mfma_f32_16x16x32_bf16 v[152:155], v[28:31], v[188:191], 0
    s_waitcnt lgkmcnt(3)
    v_mfma_f32_16x16x32_bf16 v[132:135], v[8:11], v[176:179], 0
    ds_read_b128 v[24:27], v4 offset:22528
    v_mfma_f32_16x16x32_bf16 v[140:143], v[8:11], v[180:183], 0
    buffer_load_dwordx4 v2, s[4:7], s61 offen offset:0 lds
    v_mfma_f32_16x16x32_bf16 v[148:151], v[8:11], v[184:187], 0
    v_mfma_f32_16x16x32_bf16 v[156:159], v[8:11], v[188:191], 0
    s_waitcnt lgkmcnt(3)
    v_mfma_f32_16x16x32_bf16 v[96:99], v[12:15], v[192:195], v[96:99]
    ds_read_b128 v[28:31], v4 offset:23552
    v_mfma_f32_16x16x32_bf16 v[104:107], v[12:15], v[196:199], v[104:107]
    buffer_load_dwordx4 v2, s[4:7], s61 offen offset:1024 lds
    v_mfma_f32_16x16x32_bf16 v[112:115], v[12:15], v[200:203], v[112:115]
    v_mfma_f32_16x16x32_bf16 v[120:123], v[12:15], v[204:207], v[120:123]
    s_waitcnt lgkmcnt(3)
    v_mfma_f32_16x16x32_bf16 v[100:103], v[16:19], v[192:195], v[100:103]
    ds_read_b128 v[8:11], v4 offset:24576
    v_mfma_f32_16x16x32_bf16 v[108:111], v[16:19], v[196:199], v[108:111]
    buffer_load_dwordx4 v2, s[4:7], s61 offen offset:2048 lds
    v_mfma_f32_16x16x32_bf16 v[116:119], v[16:19], v[200:203], v[116:119]
    v_mfma_f32_16x16x32_bf16 v[124:127], v[16:19], v[204:207], v[124:127]
    s_waitcnt lgkmcnt(3)
    v_mfma_f32_16x16x32_bf16 v[128:131], v[20:23], v[192:195], v[128:131]
    ds_read_b128 v[12:15], v4 offset:25600
    v_mfma_f32_16x16x32_bf16 v[136:139], v[20:23], v[196:199], v[136:139]
    buffer_load_dwordx4 v2, s[4:7], s61 offen offset:3072 lds
    v_mfma_f32_16x16x32_bf16 v[144:147], v[20:23], v[200:203], v[144:147]
    s_add_u32 m0, s49, 118784
    s_add_u32 s61, s48, 413696
    v_mfma_f32_16x16x32_bf16 v[152:155], v[20:23], v[204:207], v[152:155]
    s_waitcnt lgkmcnt(3)
    v_mfma_f32_16x16x32_bf16 v[132:135], v[24:27], v[192:195], v[132:135]
    ds_read_b128 v[16:19], v4 offset:26624
    v_mfma_f32_16x16x32_bf16 v[140:143], v[24:27], v[196:199], v[140:143]
    buffer_load_dwordx4 v2, s[4:7], s61 offen offset:0 lds
    v_mfma_f32_16x16x32_bf16 v[148:151], v[24:27], v[200:203], v[148:151]
    v_mfma_f32_16x16x32_bf16 v[156:159], v[24:27], v[204:207], v[156:159]
    s_waitcnt lgkmcnt(3)
    v_mfma_f32_16x16x32_bf16 v[96:99], v[28:31], v[208:211], v[96:99]
    ds_read_b128 v[20:23], v4 offset:27648
    v_mfma_f32_16x16x32_bf16 v[104:107], v[28:31], v[212:215], v[104:107]
    v_mfma_f32_16x16x32_bf16 v[112:115], v[28:31], v[216:219], v[112:115]
    v_mfma_f32_16x16x32_bf16 v[120:123], v[28:31], v[220:223], v[120:123]
    s_waitcnt lgkmcnt(3)
    v_mfma_f32_16x16x32_bf16 v[100:103], v[8:11], v[208:211], v[100:103]
    ds_read_b128 v[24:27], v4 offset:28672
    v_mfma_f32_16x16x32_bf16 v[108:111], v[8:11], v[212:215], v[108:111]
    v_mfma_f32_16x16x32_bf16 v[116:119], v[8:11], v[216:219], v[116:119]
    v_mfma_f32_16x16x32_bf16 v[124:127], v[8:11], v[220:223], v[124:127]
    s_waitcnt lgkmcnt(3)
    v_mfma_f32_16x16x32_bf16 v[128:131], v[12:15], v[208:211], v[128:131]
    s_waitcnt vmcnt(10)
    v_cmp_eq_u64 vcc, s[98:99], v[6:7]
    s_nop 0
    s_cmp_eq_u64 vcc, exec
    s_cbranch_scc0 L_p1_slow_85
L_p1_back_86:
    v_mfma_f32_16x16x32_bf16 v[136:139], v[12:15], v[212:215], v[136:139]
    s_add_u32 s60, s56, 32768
    ds_read_b128 v[28:31], v4 offset:29696
    v_mfma_f32_16x16x32_bf16 v[144:147], v[12:15], v[216:219], v[144:147]
    buffer_load_dwordx4 a[112:115], v2, s[4:7], s60 offen offset:0 sc1
    v_mfma_f32_16x16x32_bf16 v[152:155], v[12:15], v[220:223], v[152:155]
    s_waitcnt lgkmcnt(3)
    v_mfma_f32_16x16x32_bf16 v[132:135], v[16:19], v[208:211], v[132:135]
    ds_read_b128 v[8:11], v4 offset:30720
    v_mfma_f32_16x16x32_bf16 v[140:143], v[16:19], v[212:215], v[140:143]
    v_mfma_f32_16x16x32_bf16 v[148:151], v[16:19], v[216:219], v[148:151]
    buffer_load_dwordx4 a[116:119], v2, s[4:7], s60 offen offset:1024 sc1
    v_mfma_f32_16x16x32_bf16 v[156:159], v[16:19], v[220:223], v[156:159]
    s_waitcnt lgkmcnt(3)
    v_mfma_f32_16x16x32_bf16 v[32:35], v[20:23], v[224:227], v[32:35]
    ds_read_b128 v[12:15], v4 offset:31744
    v_mfma_f32_16x16x32_bf16 v[40:43], v[20:23], v[228:231], v[40:43]
    v_mfma_f32_16x16x32_bf16 v[48:51], v[20:23], v[232:235], v[48:51]
    buffer_load_dwordx4 a[120:123], v2, s[4:7], s60 offen offset:2048 sc1
    v_mfma_f32_16x16x32_bf16 v[56:59], v[20:23], v[236:239], v[56:59]
    s_waitcnt lgkmcnt(3)
    v_mfma_f32_16x16x32_bf16 v[36:39], v[24:27], v[224:227], v[36:39]
    ds_read_b128 v[16:19], v4 offset:32768
    v_mfma_f32_16x16x32_bf16 v[44:47], v[24:27], v[228:231], v[44:47]
    s_add_u32 s71, s67, 64
    v_mov_b32 v6, s98
    v_mov_b32 v7, s99
    v_mfma_f32_16x16x32_bf16 v[52:55], v[24:27], v[232:235], v[52:55]
    buffer_load_dwordx4 a[124:127], v2, s[4:7], s60 offen offset:3072 sc1
    v_mfma_f32_16x16x32_bf16 v[60:63], v[24:27], v[236:239], v[60:63]
    s_waitcnt lgkmcnt(3)
    s_waitcnt vmcnt(12)
    s_add_u32 s60, s57, 32768
    v_mfma_f32_16x16x32_bf16 v[64:67], v[28:31], v[224:227], v[64:67]
    ds_read_b128 v[20:23], v4 offset:33792
    v_mfma_f32_16x16x32_bf16 v[72:75], v[28:31], v[228:231], v[72:75]
    v_mfma_f32_16x16x32_bf16 v[80:83], v[28:31], v[232:235], v[80:83]
    s_mov_b64 exec, 1
    buffer_store_dwordx2 v[6:7], off, s[4:7], s71 sc1
    s_mov_b64 exec, -1
    v_mfma_f32_16x16x32_bf16 v[88:91], v[28:31], v[236:239], v[88:91]
    s_waitcnt lgkmcnt(3)
    v_mfma_f32_16x16x32_bf16 v[68:71], v[8:11], v[224:227], v[68:71]
    ds_read_b128 v[24:27], v4 offset:34816
    v_mfma_f32_16x16x32_bf16 v[76:79], v[8:11], v[228:231], v[76:79]
    v_mfma_f32_16x16x32_bf16 v[84:87], v[8:11], v[232:235], v[84:87]
    buffer_load_dwordx4 a[128:131], v2, s[4:7], s60 offen offset:0 sc1
    v_mfma_f32_16x16x32_bf16 v[92:95], v[8:11], v[236:239], v[92:95]
    s_waitcnt lgkmcnt(3)
    v_mfma_f32_16x16x32_bf16 v[96:99], v[12:15], v[224:227], v[96:99]
    ds_read_b128 v[28:31], v4 offset:35840
    v_mfma_f32_16x16x32_bf16 v[104:107], v[12:15], v[228:231], v[104:107]
    v_mfma_f32_16x16x32_bf16 v[112:115], v[12:15], v[232:235], v[112:115]
    buffer_load_dwordx4 a[132:135], v2, s[4:7], s60 offen offset:1024 sc1
    v_mfma_f32_16x16x32_bf16 v[120:123], v[12:15], v[236:239], v[120:123]
    s_waitcnt lgkmcnt(3)
    v_mfma_f32_16x16x32_bf16 v[100:103], v[16:19], v[224:227], v[100:103]
    s_barrier
    v_add_u32 v4, 0x9000, v4
    v_mfma_f32_16x16x32_bf16 v[108:111], v[16:19], v[228:231], v[108:111]
    s_add_u32 m0, s49, 0
    s_add_u32 s61, s48, 442368
    ds_read_b128 v[8:11], v4 offset:0
    v_mfma_f32_16x16x32_bf16 v[116:119], v[16:19], v[232:235], v[116:119]
    buffer_load_dwordx4 a[136:139], v2, s[4:7], s60 offen offset:2048 sc1
    v_mfma_f32_16x16x32_bf16 v[124:127], v[16:19], v[236:239], v[124:127]
    s_waitcnt lgkmcnt(3)
    v_mfma_f32_16x16x32_bf16 v[128:131], v[20:23], v[224:227], v[128:131]
    ds_read_b128 v[12:15], v4 offset:1024
    v_mfma_f32_16x16x32_bf16 v[136:139], v[20:23], v[228:231], v[136:139]
    v_mfma_f32_16x16x32_bf16 v[144:147], v[20:23], v[232:235], v[144:147]
    buffer_load_dwordx4 a[140:143], v2, s[4:7], s60 offen offset:3072 sc1
    v_mfma_f32_16x16x32_bf16 v[152:155], v[20:23], v[236:239], v[152:155]
    s_waitcnt lgkmcnt(3)
    s_add_u32 s60, s58, 32768
    v_mfma_f32_16x16x32_bf16 v[132:135], v[24:27], v[224:227], v[132:135]
    ds_read_b128 v[16:19], v4 offset:2048
    v_mfma_f32_16x16x32_bf16 v[140:143], v[24:27], v[228:231], v[140:143]
    v_mfma_f32_16x16x32_bf16 v[148:151], v[24:27], v[232:235], v[148:151]
    buffer_load_dwordx4 a[144:147], v2, s[4:7], s60 offen offset:0 sc1
    v_mfma_f32_16x16x32_bf16 v[156:159], v[24:27], v[236:239], v[156:159]
    s_waitcnt lgkmcnt(3)
    v_mfma_f32_16x16x32_bf16 v[160:163], v[28:31], v[224:227], v[160:163]
    ds_read_b128 v[20:23], v4 offset:3072
    v_mfma_f32_16x16x32_bf16 v[164:167], v[28:31], v[228:231], v[164:167]
    v_mfma_f32_16x16x32_bf16 v[168:171], v[28:31], v[232:235], v[168:171]
    buffer_load_dwordx4 a[148:151], v2, s[4:7], s60 offen offset:1024 sc1
    v_mfma_f32_16x16x32_bf16 v[172:175], v[28:31], v[236:239], v[172:175]
    s_waitcnt lgkmcnt(3)
    v_mfma_f32_16x16x32_bf16 v[32:35], v[8:11], v[240:243], v[32:35]
    ds_read_b128 v[24:27], v4 offset:4096
    v_mfma_f32_16x16x32_bf16 v[40:43], v[8:11], v[244:247], v[40:43]
    v_mfma_f32_16x16x32_bf16 v[48:51], v[8:11], v[248:251], v[48:51]
    buffer_load_dwordx4 a[152:155], v2, s[4:7], s60 offen offset:2048 sc1
    v_mfma_f32_16x16x32_bf16 v[56:59], v[8:11], v[252:255], v[56:59]
    s_waitcnt lgkmcnt(3)
    v_mfma_f32_16x16x32_bf16 v[36:39], v[12:15], v[240:243], v[36:39]
    ds_read_b128 v[28:31], v4 offset:5120
    v_mfma_f32_16x16x32_bf16 v[44:47], v[12:15], v[244:247], v[44:47]
    v_mfma_f32_16x16x32_bf16 v[52:55], v[12:15], v[248:251], v[52:55]
    buffer_load_dwordx4 a[156:159], v2, s[4:7], s60 offen offset:3072 sc1
    v_mfma_f32_16x16x32_bf16 v[60:63], v[12:15], v[252:255], v[60:63]
    s_waitcnt lgkmcnt(3)
    v_mfma_f32_16x16x32_bf16 v[64:67], v[16:19], v[240:243], v[64:67]
    ds_read_b128 v[8:11], v4 offset:6144
    v_mfma_f32_16x16x32_bf16 v[72:75], v[16:19], v[244:247], v[72:75]
    v_mfma_f32_16x16x32_bf16 v[80:83], v[16:19], v[248:251], v[80:83]
    buffer_load_dwordx4 v2, s[4:7], s61 offen offset:0 lds
    v_mfma_f32_16x16x32_bf16 v[88:91], v[16:19], v[252:255], v[88:91]
    s_waitcnt lgkmcnt(3)
    v_mfma_f32_16x16x32_bf16 v[68:71], v[20:23], v[240:243], v[68:71]
    ds_read_b128 v[12:15], v4 offset:7168
    v_mfma_f32_16x16x32_bf16 v[76:79], v[20:23], v[244:247], v[76:79]
    v_mfma_f32_16x16x32_bf16 v[84:87], v[20:23], v[248:251], v[84:87]
    buffer_load_dwordx4 v2, s[4:7], s61 offen offset:1024 lds
    v_mfma_f32_16x16x32_bf16 v[92:95], v[20:23], v[252:255], v[92:95]
    s_waitcnt lgkmcnt(3)
    v_mfma_f32_16x16x32_bf16 v[96:99], v[24:27], v[240:243], v[96:99]
    ds_read_b128 v[16:19], v4 offset:8192
    v_mfma_f32_16x16x32_bf16 v[104:107], v[24:27], v[244:247], v[104:107]
    v_mfma_f32_16x16x32_bf16 v[112:115], v[24:27], v[248:251], v[112:115]
    buffer_load_dwordx4 v2, s[4:7], s61 offen offset:2048 lds
    v_mfma_f32_16x16x32_bf16 v[120:123], v[24:27], v[252:255], v[120:123]
    s_waitcnt lgkmcnt(3)
    v_mfma_f32_16x16x32_bf16 v[100:103], v[28:31], v[240:243], v[100:103]
    ds_read_b128 v[20:23], v4 offset:9216
    v_mfma_f32_16x16x32_bf16 v[108:111], v[28:31], v[244:247], v[108:111]
    v_mfma_f32_16x16x32_bf16 v[116:119], v[28:31], v[248:251], v[116:119]
    buffer_load_dwordx4 v2, s[4:7], s61 offen offset:3072 lds
    v_mfma_f32_16x16x32_bf16 v[124:127], v[28:31], v[252:255], v[124:127]
    s_waitcnt lgkmcnt(3)
    s_add_u32 m0, s49, 4096
    s_add_u32 s61, s48, 446464
    v_mfma_f32_16x16x32_bf16 v[128:131], v[8:11], v[240:243], v[128:131]
    ds_read_b128 v[24:27], v4 offset:10240
    v_mfma_f32_16x16x32_bf16 v[136:139], v[8:11], v[244:247], v[136:139]
    v_mfma_f32_16x16x32_bf16 v[144:147], v[8:11], v[248:251], v[144:147]
    buffer_load_dwordx4 v2, s[4:7], s61 offen offset:0 lds
    v_mfma_f32_16x16x32_bf16 v[152:155], v[8:11], v[252:255], v[152:155]
    s_waitcnt lgkmcnt(3)
    v_mfma_f32_16x16x32_bf16 v[132:135], v[12:15], v[240:243], v[132:135]
    ds_read_b128 v[28:31], v4 offset:11264
    v_mfma_f32_16x16x32_bf16 v[140:143], v[12:15], v[244:247], v[140:143]
    v_mfma_f32_16x16x32_bf16 v[148:151], v[12:15], v[248:251], v[148:151]
    buffer_load_dwordx4 v2, s[4:7], s61 offen offset:1024 lds
    v_mfma_f32_16x16x32_bf16 v[156:159], v[12:15], v[252:255], v[156:159]
    s_waitcnt lgkmcnt(3)
    v_mfma_f32_16x16x32_bf16 v[160:163], v[16:19], v[240:243], v[160:163]
    ds_read_b128 v[8:11], v4 offset:12288
    v_mfma_f32_16x16x32_bf16 v[164:167], v[16:19], v[244:247], v[164:167]
    v_mfma_f32_16x16x32_bf16 v[168:171], v[16:19], v[248:251], v[168:171]
    buffer_load_dwordx4 v2, s[4:7], s61 offen offset:2048 lds
    v_mfma_f32_16x16x32_bf16 v[172:175], v[16:19], v[252:255], v[172:175]
    s_waitcnt lgkmcnt(3)
    v_mfma_f32_16x16x32_bf16 v[32:35], v[20:23], a[0:3], v[32:35]
    ds_read_b128 v[12:15], v4 offset:13312
    v_mfma_f32_16x16x32_bf16 v[40:43], v[20:23], a[4:7], v[40:43]
    v_mfma_f32_16x16x32_bf16 v[48:51], v[20:23], a[8:11], v[48:51]
    buffer_load_dwordx4 v2, s[4:7], s61 offen offset:3072 lds
    v_mfma_f32_16x16x32_bf16 v[56:59], v[20:23], a[12:15], v[56:59]
    s_waitcnt lgkmcnt(3)
    s_add_u32 m0, s49, 8192
    s_add_u32 s61, s48, 450560
    v_mfma_f32_16x16x32_bf16 v[36:39], v[24:27], a[0:3], v[36:39]
    ds_read_b128 v[16:19], v4 offset:14336
    v_mfma_f32_16x16x32_bf16 v[44:47], v[24:27], a[4:7], v[44:47]
    v_mfma_f32_16x16x32_bf16 v[52:55], v[24:27], a[8:11], v[52:55]
    buffer_load_dwordx4 v2, s[4:7], s61 offen offset:0 lds
    v_mfma_f32_16x16x32_bf16 v[60:63], v[24:27], a[12:15], v[60:63]
    s_waitcnt lgkmcnt(3)
    v_mfma_f32_16x16x32_bf16 v[64:67], v[28:31], a[0:3], v[64:67]
    ds_read_b128 v[20:23], v4 offset:15360
    v_mfma_f32_16x16x32_bf16 v[72:75], v[28:31], a[4:7], v[72:75]
    v_mfma_f32_16x16x32_bf16 v[80:83], v[28:31], a[8:11], v[80:83]
    v_mfma_f32_16x16x32_bf16 v[88:91], v[28:31], a[12:15], v[88:91]
    s_waitcnt lgkmcnt(3)
    v_mfma_f32_16x16x32_bf16 v[68:71], v[8:11], a[0:3], v[68:71]
    ds_read_b128 v[24:27], v4 offset:16384
    v_mfma_f32_16x16x32_bf16 v[76:79], v[8:11], a[4:7], v[76:79]
    v_mfma_f32_16x16x32_bf16 v[84:87], v[8:11], a[8:11], v[84:87]
    v_mfma_f32_16x16x32_bf16 v[92:95], v[8:11], a[12:15], v[92:95]
    s_waitcnt lgkmcnt(3)
    v_mfma_f32_16x16x32_bf16 v[96:99], v[12:15], a[0:3], v[96:99]
    ds_read_b128 v[28:31], v4 offset:17408
    v_mfma_f32_16x16x32_bf16 v[104:107], v[12:15], a[4:7], v[104:107]
    s_add_u32 s55, s52, 64
    v_mfma_f32_16x16x32_bf16 v[112:115], v[12:15], a[8:11], v[112:115]
    v_mfma_f32_16x16x32_bf16 v[120:123], v[12:15], a[12:15], v[120:123]
    s_waitcnt lgkmcnt(3)
    v_mfma_f32_16x16x32_bf16 v[100:103], v[16:19], a[0:3], v[100:103]
    ds_read_b128 v[8:11], v4 offset:18432
    v_mfma_f32_16x16x32_bf16 v[108:111], v[16:19], a[4:7], v[108:111]
    v_mfma_f32_16x16x32_bf16 v[116:119], v[16:19], a[8:11], v[116:119]
    v_mfma_f32_16x16x32_bf16 v[124:127], v[16:19], a[12:15], v[124:127]
    s_waitcnt lgkmcnt(3)
    v_mfma_f32_16x16x32_bf16 v[128:131], v[20:23], a[0:3], v[128:131]
    ds_read_b128 v[12:15], v4 offset:19456
    v_mfma_f32_16x16x32_bf16 v[136:139], v[20:23], a[4:7], v[136:139]
    v_mfma_f32_16x16x32_bf16 v[144:147], v[20:23], a[8:11], v[144:147]
    v_mfma_f32_16x16x32_bf16 v[152:155], v[20:23], a[12:15], v[152:155]
    s_waitcnt lgkmcnt(3)
    v_mfma_f32_16x16x32_bf16 v[132:135], v[24:27], a[0:3], v[132:135]
    ds_read_b128 v[16:19], v4 offset:20480
    v_mfma_f32_16x16x32_bf16 v[140:143], v[24:27], a[4:7], v[140:143]
    buffer_load_dwordx2 v[6:7], v0, s[4:7], s55 offen sc1
    v_mfma_f32_16x16x32_bf16 v[148:151], v[24:27], a[8:11], v[148:151]
    v_mfma_f32_16x16x32_bf16 v[156:159], v[24:27], a[12:15], v[156:159]
    s_waitcnt lgkmcnt(3)
    v_mfma_f32_16x16x32_bf16 v[160:163], v[28:31], a[0:3], v[160:163]
    ds_read_b128 v[20:23], v4 offset:21504
    v_mfma_f32_16x16x32_bf16 v[164:167], v[28:31], a[4:7], v[164:167]
    v_mfma_f32_16x16x32_bf16 v[168:171], v[28:31], a[8:11], v[168:171]
    v_mfma_f32_16x16x32_bf16 v[172:175], v[28:31], a[12:15], v[172:175]
    s_waitcnt lgkmcnt(3)
    v_mfma_f32_16x16x32_bf16 v[32:35], v[8:11], a[16:19], v[32:35]
    ds_read_b128 v[24:27], v4 offset:22528
    v_mfma_f32_16x16x32_bf16 v[40:43], v[8:11], a[20:23], v[40:43]
    v_mfma_f32_16x16x32_bf16 v[48:51], v[8:11], a[24:27], v[48:51]
    v_mfma_f32_16x16x32_bf16 v[56:59], v[8:11], a[28:31], v[56:59]
    s_waitcnt lgkmcnt(3)
    v_mfma_f32_16x16x32_bf16 v[36:39], v[12:15], a[16:19], v[36:39]
    ds_read_b128 v[28:31], v4 offset:23552
    v_mfma_f32_16x16x32_bf16 v[44:47], v[12:15], a[20:23], v[44:47]
    v_mfma_f32_16x16x32_bf16 v[52:55], v[12:15], a[24:27], v[52:55]
    v_mfma_f32_16x16x32_bf16 v[60:63], v[12:15], a[28:31], v[60:63]
    s_waitcnt lgkmcnt(3)
    v_mfma_f32_16x16x32_bf16 v[64:67], v[16:19], a[16:19], v[64:67]
    ds_read_b128 v[8:11], v4 offset:24576
    v_mfma_f32_16x16x32_bf16 v[72:75], v[16:19], a[20:23], v[72:75]
    v_mfma_f32_16x16x32_bf16 v[80:83], v[16:19], a[24:27], v[80:83]
    v_mfma_f32_16x16x32_bf16 v[88:91], v[16:19], a[28:31], v[88:91]
    s_waitcnt lgkmcnt(3)
    v_mfma_f32_16x16x32_bf16 v[68:71], v[20:23], a[16:19], v[68:71]
    ds_read_b128 v[12:15], v4 offset:25600
    v_mfma_f32_16x16x32_bf16 v[76:79], v[20:23], a[20:23], v[76:79]
    v_mfma_f32_16x16x32_bf16 v[84:87], v[20:23], a[24:27], v[84:87]
    v_mfma_f32_16x16x32_bf16 v[92:95], v[20:23], a[28:31], v[92:95]
    s_waitcnt lgkmcnt(3)
    v_mfma_f32_16x16x32_bf16 v[96:99], v[24:27], a[16:19], v[96:99]
    ds_read_b128 v[16:19], v4 offset:26624
    v_mfma_f32_16x16x32_bf16 v[104:107], v[24:27], a[20:23], v[104:107]
    v_mfma_f32_16x16x32_bf16 v[112:115], v[24:27], a[24:27], v[112:115]
    v_mfma_f32_16x16x32_bf16 v[120:123], v[24:27], a[28:31], v[120:123]
    s_waitcnt lgkmcnt(3)
    v_mfma_f32_16x16x32_bf16 v[100:103], v[28:31], a[16:19], v[100:103]
    ds_read_b128 v[20:23], v4 offset:27648
    v_mfma_f32_16x16x32_bf16 v[108:111], v[28:31], a[20:23], v[108:111]
    v_mfma_f32_16x16x32_bf16 v[116:119], v[28:31], a[24:27], v[116:119]
    v_mfma_f32_16x16x32_bf16 v[124:127], v[28:31], a[28:31], v[124:127]
    s_waitcnt lgkmcnt(3)
    v_mfma_f32_16x16x32_bf16 v[128:131], v[8:11], a[16:19], v[128:131]
    ds_read_b128 v[24:27], v4 offset:28672
    v_mfma_f32_16x16x32_bf16 v[136:139], v[8:11], a[20:23], v[136:139]
    v_mfma_f32_16x16x32_bf16 v[144:147], v[8:11], a[24:27], v[144:147]
    v_mfma_f32_16x16x32_bf16 v[152:155], v[8:11], a[28:31], v[152:155]
    s_waitcnt lgkmcnt(3)
    v_mfma_f32_16x16x32_bf16 v[132:135], v[12:15], a[16:19], v[132:135]
    ds_read_b128 v[28:31], v4 offset:29696
    v_mfma_f32_16x16x32_bf16 v[140:143], v[12:15], a[20:23], v[140:143]
    v_mfma_f32_16x16x32_bf16 v[148:151], v[12:15], a[24:27], v[148:151]
    v_mfma_f32_16x16x32_bf16 v[156:159], v[12:15], a[28:31], v[156:159]
    s_waitcnt lgkmcnt(3)
    v_mfma_f32_16x16x32_bf16 v[160:163], v[16:19], a[16:19], v[160:163]
    ds_read_b128 v[8:11], v4 offset:30720
    v_mfma_f32_16x16x32_bf16 v[164:167], v[16:19], a[20:23], v[164:167]
    v_mfma_f32_16x16x32_bf16 v[168:171], v[16:19], a[24:27], v[168:171]
    v_mfma_f32_16x16x32_bf16 v[172:175], v[16:19], a[28:31], v[172:175]
    s_waitcnt lgkmcnt(3)
    v_mfma_f32_16x16x32_bf16 v[32:35], v[20:23], a[32:35], v[32:35]
    ds_read_b128 v[12:15], v4 offset:31744
    v_mfma_f32_16x16x32_bf16 v[40:43], v[20:23], a[36:39], v[40:43]
    v_mfma_f32_16x16x32_bf16 v[48:51], v[20:23], a[40:43], v[48:51]
    v_mfma_f32_16x16x32_bf16 v[56:59], v[20:23], a[44:47], v[56:59]
    s_waitcnt lgkmcnt(3)
    v_mfma_f32_16x16x32_bf16 v[36:39], v[24:27], a[32:35], v[36:39]
    ds_read_b128 v[16:19], v4 offset:32768
    v_mfma_f32_16x16x32_bf16 v[44:47], v[24:27], a[36:39], v[44:47]
    v_mfma_f32_16x16x32_bf16 v[52:55], v[24:27], a[40:43], v[52:55]
    v_mfma_f32_16x16x32_bf16 v[60:63], v[24:27], a[44:47], v[60:63]
    s_waitcnt lgkmcnt(3)
    v_mfma_f32_16x16x32_bf16 v[64:67], v[28:31], a[32:35], v[64:67]
    ds_read_b128 v[20:23], v4 offset:33792
    v_mfma_f32_16x16x32_bf16 v[72:75], v[28:31], a[36:39], v[72:75]
    v_mfma_f32_16x16x32_bf16 v[80:83], v[28:31], a[40:43], v[80:83]
    v_mfma_f32_16x16x32_bf16 v[88:91], v[28:31], a[44:47], v[88:91]
    s_waitcnt lgkmcnt(3)
    v_mfma_f32_16x16x32_bf16 v[68:71], v[8:11], a[32:35], v[68:71]
    s_waitcnt vmcnt(0)
    v_cmp_eq_u64 vcc, s[98:99], v[6:7]
    s_nop 0
    s_cmp_eq_u64 vcc, exec
    s_cbranch_scc0 L_p2_slow_88
L_p2_back_89:
    v_mfma_f32_16x16x32_bf16 v[76:79], v[8:11], a[36:39], v[76:79]
    s_add_u32 s60, s56, 49152
    ds_read_b128 v[24:27], v4 offset:34816
    v_mfma_f32_16x16x32_bf16 v[84:87], v[8:11], a[40:43], v[84:87]
    buffer_load_dwordx4 a[160:163], v2, s[4:7], s60 offen offset:0 sc1
    v_mfma_f32_16x16x32_bf16 v[92:95], v[8:11], a[44:47], v[92:95]
    s_waitcnt lgkmcnt(3)
    s_and_b32 s68, s46, 1
    s_mul_i32 s69, s68, 5120
    v_mfma_f32_16x16x32_bf16 v[96:99], v[12:15], a[32:35], v[96:99]
    s_add_u32 s69, s69, s53
    s_lshl_b32 s68, s68, 9
    ds_read_b128 v[28:31], v4 offset:35840
    v_mfma_f32_16x16x32_bf16 v[104:107], v[12:15], a[36:39], v[104:107]
    s_add_u32 s68, s68, s53
    v_and_b32 v0, 15, v1
    v_lshlrev_b32 v0, 5, v0
    v_mfma_f32_16x16x32_bf16 v[112:115], v[12:15], a[40:43], v[112:115]
    buffer_load_dwordx4 a[164:167], v2, s[4:7], s60 offen offset:1024 sc1
    v_mfma_f32_16x16x32_bf16 v[120:123], v[12:15], a[44:47], v[120:123]
    s_waitcnt lgkmcnt(3)
    v_lshrrev_b32 v5, 4, v1
    v_lshl_add_u32 v0, v5, 3, v0
    v_mfma_f32_16x16x32_bf16 v[100:103], v[16:19], a[32:35], v[100:103]
    s_barrier
    v_add_u32 v4, 0x9000, v4
    v_mfma_f32_16x16x32_bf16 v[108:111], v[16:19], a[36:39], v[108:111]
    s_add_u32 m0, s63, 36864
    s_add_u32 s61, s62, 479232
    ds_read_b128 v[8:11], v4 offset:0
    v_mfma_f32_16x16x32_bf16 v[116:119], v[16:19], a[40:43], v[116:119]
    buffer_load_dwordx4 a[168:171], v2, s[4:7], s60 offen offset:2048 sc1
    v_mfma_f32_16x16x32_bf16 v[124:127], v[16:19], a[44:47], v[124:127]
    s_waitcnt lgkmcnt(3)
    v_mfma_f32_16x16x32_bf16 v[128:131], v[20:23], a[32:35], v[128:131]
    ds_read_b128 v[12:15], v4 offset:1024
    v_mfma_f32_16x16x32_bf16 v[136:139], v[20:23], a[36:39], v[136:139]
    v_mfma_f32_16x16x32_bf16 v[144:147], v[20:23], a[40:43], v[144:147]
    buffer_load_dwordx4 a[172:175], v2, s[4:7], s60 offen offset:3072 sc1
    v_mfma_f32_16x16x32_bf16 v[152:155], v[20:23], a[44:47], v[152:155]
    s_waitcnt lgkmcnt(3)
    s_add_u32 s60, s57, 49152
    v_mfma_f32_16x16x32_bf16 v[132:135], v[24:27], a[32:35], v[132:135]
    ds_read_b128 v[16:19], v4 offset:2048
    v_mfma_f32_16x16x32_bf16 v[140:143], v[24:27], a[36:39], v[140:143]
    v_mfma_f32_16x16x32_bf16 v[148:151], v[24:27], a[40:43], v[148:151]
    buffer_load_dwordx4 a[176:179], v2, s[4:7], s60 offen offset:0 sc1
    v_mfma_f32_16x16x32_bf16 v[156:159], v[24:27], a[44:47], v[156:159]
    s_waitcnt lgkmcnt(3)
    v_mfma_f32_16x16x32_bf16 v[160:163], v[28:31], a[32:35], v[160:163]
    ds_read_b128 v[20:23], v4 offset:3072
    v_mfma_f32_16x16x32_bf16 v[164:167], v[28:31], a[36:39], v[164:167]
    v_mfma_f32_16x16x32_bf16 v[168:171], v[28:31], a[40:43], v[168:171]
    buffer_load_dwordx4 a[180:183], v2, s[4:7], s60 offen offset:1024 sc1
    v_mfma_f32_16x16x32_bf16 v[172:175], v[28:31], a[44:47], v[172:175]
    s_waitcnt lgkmcnt(3)
    v_mfma_f32_16x16x32_bf16 v[32:35], v[8:11], a[48:51], v[32:35]
    ds_read_b128 v[24:27], v4 offset:4096
    v_mfma_f32_16x16x32_bf16 v[40:43], v[8:11], a[52:55], v[40:43]
    v_mfma_f32_16x16x32_bf16 v[48:51], v[8:11], a[56:59], v[48:51]
    buffer_load_dwordx4 a[184:187], v2, s[4:7], s60 offen offset:2048 sc1
    v_mfma_f32_16x16x32_bf16 v[56:59], v[8:11], a[60:63], v[56:59]
    s_waitcnt lgkmcnt(3)
    v_mfma_f32_16x16x32_bf16 v[36:39], v[12:15], a[48:51], v[36:39]
    ds_read_b128 v[28:31], v4 offset:5120
    v_mfma_f32_16x16x32_bf16 v[44:47], v[12:15], a[52:55], v[44:47]
    v_mfma_f32_16x16x32_bf16 v[52:55], v[12:15], a[56:59], v[52:55]
    buffer_load_dwordx4 a[188:191], v2, s[4:7], s60 offen offset:3072 sc1
    v_mfma_f32_16x16x32_bf16 v[60:63], v[12:15], a[60:63], v[60:63]
    s_waitcnt lgkmcnt(3)
    s_add_u32 s60, s58, 49152
    v_mfma_f32_16x16x32_bf16 v[64:67], v[16:19], a[48:51], v[64:67]
    ds_read_b128 v[8:11], v4 offset:6144
    v_mfma_f32_16x16x32_bf16 v[72:75], v[16:19], a[52:55], v[72:75]
    v_mfma_f32_16x16x32_bf16 v[80:83], v[16:19], a[56:59], v[80:83]
    buffer_load_dwordx4 a[192:195], v2, s[4:7], s60 offen offset:0 sc1
    v_mfma_f32_16x16x32_bf16 v[88:91], v[16:19], a[60:63], v[88:91]
    s_waitcnt lgkmcnt(3)
    v_mfma_f32_16x16x32_bf16 v[68:71], v[20:23], a[48:51], v[68:71]
    ds_read_b128 v[12:15], v4 offset:7168
    v_mfma_f32_16x16x32_bf16 v[76:79], v[20:23], a[52:55], v[76:79]
    v_mfma_f32_16x16x32_bf16 v[84:87], v[20:23], a[56:59], v[84:87]
    buffer_load_dwordx4 a[196:199], v2, s[4:7], s60 offen offset:1024 sc1
    v_mfma_f32_16x16x32_bf16 v[92:95], v[20:23], a[60:63], v[92:95]
    s_waitcnt lgkmcnt(3)
    v_mfma_f32_16x16x32_bf16 v[96:99], v[24:27], a[48:51], v[96:99]
    ds_read_b128 v[16:19], v4 offset:8192
    v_mfma_f32_16x16x32_bf16 v[104:107], v[24:27], a[52:55], v[104:107]
    v_mfma_f32_16x16x32_bf16 v[112:115], v[24:27], a[56:59], v[112:115]
    buffer_load_dwordx4 a[200:203], v2, s[4:7], s60 offen offset:2048 sc1
    v_mfma_f32_16x16x32_bf16 v[120:123], v[24:27], a[60:63], v[120:123]
    s_waitcnt lgkmcnt(3)
    v_mfma_f32_16x16x32_bf16 v[100:103], v[28:31], a[48:51], v[100:103]
    ds_read_b128 v[20:23], v4 offset:9216
    v_mfma_f32_16x16x32_bf16 v[108:111], v[28:31], a[52:55], v[108:111]
    v_mfma_f32_16x16x32_bf16 v[116:119], v[28:31], a[56:59], v[116:119]
    buffer_load_dwordx4 a[204:207], v2, s[4:7], s60 offen offset:3072 sc1
    v_mfma_f32_16x16x32_bf16 v[124:127], v[28:31], a[60:63], v[124:127]
    s_waitcnt lgkmcnt(3)
    v_mfma_f32_16x16x32_bf16 v[128:131], v[8:11], a[48:51], v[128:131]
    ds_read_b128 v[24:27], v4 offset:10240
    v_mfma_f32_16x16x32_bf16 v[136:139], v[8:11], a[52:55], v[136:139]
    v_mfma_f32_16x16x32_bf16 v[144:147], v[8:11], a[56:59], v[144:147]
    buffer_load_dwordx4 v2, s[4:7], s61 offen offset:0 lds
    v_mfma_f32_16x16x32_bf16 v[152:155], v[8:11], a[60:63], v[152:155]
    s_waitcnt lgkmcnt(3)
    v_mfma_f32_16x16x32_bf16 v[132:135], v[12:15], a[48:51], v[132:135]
    ds_read_b128 v[28:31], v4 offset:11264
    v_mfma_f32_16x16x32_bf16 v[140:143], v[12:15], a[52:55], v[140:143]
    v_mfma_f32_16x16x32_bf16 v[148:151], v[12:15], a[56:59], v[148:151]
    buffer_load_dwordx4 v2, s[4:7], s61 offen offset:1024 lds
    v_mfma_f32_16x16x32_bf16 v[156:159], v[12:15], a[60:63], v[156:159]
    s_waitcnt lgkmcnt(3)
    v_mfma_f32_16x16x32_bf16 v[160:163], v[16:19], a[48:51], v[160:163]
    ds_read_b128 v[8:11], v4 offset:12288
    v_mfma_f32_16x16x32_bf16 v[164:167], v[16:19], a[52:55], v[164:167]
    v_mfma_f32_16x16x32_bf16 v[168:171], v[16:19], a[56:59], v[168:171]
    buffer_load_dwordx4 v2, s[4:7], s61 offen offset:2048 lds
    v_mfma_f32_16x16x32_bf16 v[172:175], v[16:19], a[60:63], v[172:175]
    s_waitcnt lgkmcnt(3)
    v_mfma_f32_16x16x32_bf16 v[32:35], v[20:23], a[64:67], v[32:35]
    ds_read_b128 v[12:15], v4 offset:13312
    v_mfma_f32_16x16x32_bf16 v[40:43], v[20:23], a[68:71], v[40:43]
    v_mfma_f32_16x16x32_bf16 v[48:51], v[20:23], a[72:75], v[48:51]
    buffer_load_dwordx4 v2, s[4:7], s61 offen offset:3072 lds
    v_mfma_f32_16x16x32_bf16 v[56:59], v[20:23], a[76:79], v[56:59]
    s_waitcnt lgkmcnt(3)
    s_add_u32 m0, s63, 40960
    s_add_u32 s61, s62, 483328
    v_mfma_f32_16x16x32_bf16 v[36:39], v[24:27], a[64:67], v[36:39]
    ds_read_b128 v[16:19], v4 offset:14336
    v_mfma_f32_16x16x32_bf16 v[44:47], v[24:27], a[68:71], v[44:47]
    v_mfma_f32_16x16x32_bf16 v[52:55], v[24:27], a[72:75], v[52:55]
    buffer_load_dwordx4 v2, s[4:7], s61 offen offset:0 lds
    v_mfma_f32_16x16x32_bf16 v[60:63], v[24:27], a[76:79], v[60:63]
    s_waitcnt lgkmcnt(3)
    v_mfma_f32_16x16x32_bf16 v[32:35], v[28:31], a[80:83], v[32:35]
    s_and_b32 s62, s22, 15
    s_mul_i32 s62, s62, 129024
    ds_read_b128 v[20:23], v4 offset:15360
    v_mfma_f32_16x16x32_bf16 v[40:43], v[28:31], a[84:87], v[40:43]
    s_add_u32 s62, s62, 0
    v_mfma_f32_16x16x32_bf16 v[48:51], v[28:31], a[88:91], v[48:51]
    s_cmp_lg_u32 s101, 0
    s_cselect_b32 s62, 0x10000000, s62
    v_mfma_f32_16x16x32_bf16 v[56:59], v[28:31], a[92:95], v[56:59]
    s_waitcnt lgkmcnt(3)
    s_add_u32 s61, s63, 36864
    s_add_u32 m0, s61, 18432
    v_mfma_f32_16x16x32_bf16 v[36:39], v[8:11], a[80:83], v[36:39]
    s_add_u32 s61, s61, s62
    ds_read_b128 v[24:27], v4 offset:16384
    v_mfma_f32_16x16x32_bf16 v[44:47], v[8:11], a[84:87], v[44:47]
    buffer_load_dwordx4 v2, s[4:7], s61 offen offset:0 lds
    v_mfma_f32_16x16x32_bf16 v[52:55], v[8:11], a[88:91], v[52:55]
    v_mfma_f32_16x16x32_bf16 v[60:63], v[8:11], a[92:95], v[60:63]
    s_waitcnt lgkmcnt(3)
    v_mfma_f32_16x16x32_bf16 v[32:35], v[12:15], a[96:99], v[32:35]
    ds_read_b128 v[28:31], v4 offset:17408
    v_mfma_f32_16x16x32_bf16 v[40:43], v[12:15], a[100:103], v[40:43]
    buffer_load_dwordx4 v2, s[4:7], s61 offen offset:1024 lds
    v_mfma_f32_16x16x32_bf16 v[48:51], v[12:15], a[104:107], v[48:51]
    v_mfma_f32_16x16x32_bf16 v[56:59], v[12:15], a[108:111], v[56:59]
    s_waitcnt lgkmcnt(3)
    v_mfma_f32_16x16x32_bf16 v[36:39], v[16:19], a[96:99], v[36:39]
    ds_read_b128 v[8:11], v4 offset:18432
    v_mfma_f32_16x16x32_bf16 v[44:47], v[16:19], a[100:103], v[44:47]
    buffer_load_dwordx4 v2, s[4:7], s61 offen offset:2048 lds
    v_mfma_f32_16x16x32_bf16 v[52:55], v[16:19], a[104:107], v[52:55]
    v_mfma_f32_16x16x32_bf16 v[60:63], v[16:19], a[108:111], v[60:63]
    s_waitcnt lgkmcnt(3)
    v_mfma_f32_16x16x32_bf16 v[32:35], v[20:23], a[112:115], v[32:35]
    ds_read_b128 v[12:15], v4 offset:19456
    v_mfma_f32_16x16x32_bf16 v[40:43], v[20:23], a[116:119], v[40:43]
    buffer_load_dwordx4 v2, s[4:7], s61 offen offset:3072 lds
    v_mfma_f32_16x16x32_bf16 v[48:51], v[20:23], a[120:123], v[48:51]
    s_add_u32 s61, s63, 40960
    s_add_u32 m0, s61, 18432
    s_add_u32 s61, s61, s62
    v_mfma_f32_16x16x32_bf16 v[56:59], v[20:23], a[124:127], v[56:59]
    s_waitcnt lgkmcnt(3)
    v_mfma_f32_16x16x32_bf16 v[36:39], v[24:27], a[112:115], v[36:39]
    ds_read_b128 v[16:19], v4 offset:20480
    v_mfma_f32_16x16x32_bf16 v[44:47], v[24:27], a[116:119], v[44:47]
    buffer_load_dwordx4 v2, s[4:7], s61 offen offset:0 lds
    v_mfma_f32_16x16x32_bf16 v[52:55], v[24:27], a[120:123], v[52:55]
    v_mfma_f32_16x16x32_bf16 v[60:63], v[24:27], a[124:127], v[60:63]
    s_waitcnt lgkmcnt(3)
    v_mfma_f32_16x16x32_bf16 v[32:35], v[28:31], a[128:131], v[32:35]
    ds_read_b128 v[20:23], v4 offset:21504
    v_mfma_f32_16x16x32_bf16 v[40:43], v[28:31], a[132:135], v[40:43]
    v_mfma_f32_16x16x32_bf16 v[48:51], v[28:31], a[136:139], v[48:51]
    v_mfma_f32_16x16x32_bf16 v[56:59], v[28:31], a[140:143], v[56:59]
    s_waitcnt lgkmcnt(3)
    v_mfma_f32_16x16x32_bf16 v[36:39], v[8:11], a[128:131], v[36:39]
    ds_read_b128 v[24:27], v4 offset:22528
    v_mfma_f32_16x16x32_bf16 v[44:47], v[8:11], a[132:135], v[44:47]
    v_mfma_f32_16x16x32_bf16 v[52:55], v[8:11], a[136:139], v[52:55]
    v_mfma_f32_16x16x32_bf16 v[60:63], v[8:11], a[140:143], v[60:63]
    s_waitcnt lgkmcnt(3)
    v_mfma_f32_16x16x32_bf16 v[32:35], v[12:15], a[144:147], v[32:35]
    ds_read_b128 v[28:31], v4 offset:23552
    v_mfma_f32_16x16x32_bf16 v[40:43], v[12:15], a[148:151], v[40:43]
    v_mfma_f32_16x16x32_bf16 v[48:51], v[12:15], a[152:155], v[48:51]
    v_mfma_f32_16x16x32_bf16 v[56:59], v[12:15], a[156:159], v[56:59]
    s_waitcnt lgkmcnt(3)
    v_mfma_f32_16x16x32_bf16 v[36:39], v[16:19], a[144:147], v[36:39]
    ds_read_b128 v[8:11], v4 offset:24576
    v_mfma_f32_16x16x32_bf16 v[44:47], v[16:19], a[148:151], v[44:47]
    v_mfma_f32_16x16x32_bf16 v[52:55], v[16:19], a[152:155], v[52:55]
    v_mfma_f32_16x16x32_bf16 v[60:63], v[16:19], a[156:159], v[60:63]
    s_waitcnt vmcnt(21) lgkmcnt(3)
    v_mfma_f32_16x16x32_bf16 v[32:35], v[20:23], a[160:163], v[32:35]
    s_waitcnt vmcnt(20)
    ds_read_b128 v[12:15], v4 offset:25600
    v_mfma_f32_16x16x32_bf16 v[40:43], v[20:23], a[164:167], v[40:43]
    s_waitcnt vmcnt(19)
    v_mfma_f32_16x16x32_bf16 v[48:51], v[20:23], a[168:171], v[48:51]
    s_waitcnt vmcnt(18)
    v_mfma_f32_16x16x32_bf16 v[56:59], v[20:23], a[172:175], v[56:59]
    s_waitcnt lgkmcnt(3)
    v_mfma_f32_16x16x32_bf16 v[36:39], v[24:27], a[160:163], v[36:39]
    ds_read_b128 v[16:19], v4 offset:26624
    v_mfma_f32_16x16x32_bf16 v[44:47], v[24:27], a[164:167], v[44:47]
    v_mfma_f32_16x16x32_bf16 v[52:55], v[24:27], a[168:171], v[52:55]
    v_mfma_f32_16x16x32_bf16 v[60:63], v[24:27], a[172:175], v[60:63]
    s_waitcnt vmcnt(17) lgkmcnt(3)
    v_mfma_f32_16x16x32_bf16 v[32:35], v[28:31], a[176:179], v[32:35]
    s_waitcnt vmcnt(16)
    ds_read_b128 v[20:23], v4 offset:27648
    v_mfma_f32_16x16x32_bf16 v[40:43], v[28:31], a[180:183], v[40:43]
    s_waitcnt vmcnt(15)
    v_mfma_f32_16x16x32_bf16 v[48:51], v[28:31], a[184:187], v[48:51]
    s_waitcnt vmcnt(14)
    v_mfma_f32_16x16x32_bf16 v[56:59], v[28:31], a[188:191], v[56:59]
    s_waitcnt lgkmcnt(3)
    v_mfma_f32_16x16x32_bf16 v[36:39], v[8:11], a[176:179], v[36:39]
    ds_read_b128 v[24:27], v4 offset:28672
    v_mfma_f32_16x16x32_bf16 v[44:47], v[8:11], a[180:183], v[44:47]
    v_mfma_f32_16x16x32_bf16 v[52:55], v[8:11], a[184:187], v[52:55]
    v_mfma_f32_16x16x32_bf16 v[60:63], v[8:11], a[188:191], v[60:63]
    s_waitcnt vmcnt(13) lgkmcnt(3)
    v_mfma_f32_16x16x32_bf16 v[32:35], v[12:15], a[192:195], v[32:35]
    s_waitcnt vmcnt(12)
    ds_read_b128 v[28:31], v4 offset:29696
    v_mfma_f32_16x16x32_bf16 v[40:43], v[12:15], a[196:199], v[40:43]
    s_waitcnt vmcnt(11)
    v_mfma_f32_16x16x32_bf16 v[48:51], v[12:15], a[200:203], v[48:51]
    s_waitcnt vmcnt(10)
    v_mfma_f32_16x16x32_bf16 v[56:59], v[12:15], a[204:207], v[56:59]
    s_waitcnt lgkmcnt(3)
    v_mfma_f32_16x16x32_bf16 v[36:39], v[16:19], a[192:195], v[36:39]
    ds_read_b128 v[8:11], v4 offset:30720
    v_mfma_f32_16x16x32_bf16 v[44:47], v[16:19], a[196:199], v[44:47]
    v_mfma_f32_16x16x32_bf16 v[52:55], v[16:19], a[200:203], v[52:55]
    v_mfma_f32_16x16x32_bf16 v[60:63], v[16:19], a[204:207], v[60:63]
    s_waitcnt lgkmcnt(3)
    v_mfma_f32_16x16x32_bf16 v[64:67], v[20:23], a[64:67], v[64:67]
    ds_read_b128 v[12:15], v4 offset:31744
    v_mfma_f32_16x16x32_bf16 v[72:75], v[20:23], a[68:71], v[72:75]
    v_mfma_f32_16x16x32_bf16 v[80:83], v[20:23], a[72:75], v[80:83]
    v_mfma_f32_16x16x32_bf16 v[88:91], v[20:23], a[76:79], v[88:91]
    s_waitcnt lgkmcnt(3)
    v_cvt_pk_bf16_f32 v32, v32, v33
    v_cvt_pk_bf16_f32 v33, v34, v35
    v_mfma_f32_16x16x32_bf16 v[68:71], v[24:27], a[64:67], v[68:71]
    ds_read_b128 v[16:19], v4 offset:32768
    v_cvt_pk_bf16_f32 v34, v36, v37
    v_mfma_f32_16x16x32_bf16 v[76:79], v[24:27], a[68:71], v[76:79]
    v_cvt_pk_bf16_f32 v35, v38, v39
    v_mfma_f32_16x16x32_bf16 v[84:87], v[24:27], a[72:75], v[84:87]
    s_add_u32 s70, s69, 0
    v_mfma_f32_16x16x32_bf16 v[92:95], v[24:27], a[76:79], v[92:95]
    s_waitcnt lgkmcnt(3)
    v_mfma_f32_16x16x32_bf16 v[64:67], v[28:31], a[80:83], v[64:67]
    ds_read_b128 v[20:23], v4 offset:33792
    v_mfma_f32_16x16x32_bf16 v[72:75], v[28:31], a[84:87], v[72:75]
    buffer_store_dwordx4 v[32:35], v2, s[4:7], s70 offen sc1
    v_mfma_f32_16x16x32_bf16 v[80:83], v[28:31], a[88:91], v[80:83]
    v_cvt_pk_bf16_f32 v40, v40, v41
    v_cvt_pk_bf16_f32 v41, v42, v43
    v_mfma_f32_16x16x32_bf16 v[88:91], v[28:31], a[92:95], v[88:91]
    s_waitcnt lgkmcnt(3)
    v_cvt_pk_bf16_f32 v42, v44, v45
    v_cvt_pk_bf16_f32 v43, v46, v47
    v_mfma_f32_16x16x32_bf16 v[68:71], v[8:11], a[80:83], v[68:71]
    s_add_u32 s70, s69, 18432
    ds_read_b128 v[24:27], v4 offset:34816
    v_mfma_f32_16x16x32_bf16 v[76:79], v[8:11], a[84:87], v[76:79]
    buffer_store_dwordx4 v[40:43], v2, s[4:7], s70 offen sc1
    v_mfma_f32_16x16x32_bf16 v[84:87], v[8:11], a[88:91], v[84:87]
    v_cvt_pk_bf16_f32 v48, v48, v49
    v_cvt_pk_bf16_f32 v49, v50, v51
    v_mfma_f32_16x16x32_bf16 v[92:95], v[8:11], a[92:95], v[92:95]
    s_waitcnt lgkmcnt(3)
    v_cvt_pk_bf16_f32 v50, v52, v53
    v_cvt_pk_bf16_f32 v51, v54, v55
    v_mfma_f32_16x16x32_bf16 v[64:67], v[12:15], a[96:99], v[64:67]
    s_add_u32 s70, s69, 36864
    ds_read_b128 v[28:31], v4 offset:35840
    v_mfma_f32_16x16x32_bf16 v[72:75], v[12:15], a[100:103], v[72:75]
    buffer_store_dwordx4 v[48:51], v2, s[4:7], s70 offen sc1
    v_mfma_f32_16x16x32_bf16 v[80:83], v[12:15], a[104:107], v[80:83]
    v_cvt_pk_bf16_f32 v56, v56, v57
    v_cvt_pk_bf16_f32 v57, v58, v59
    v_mfma_f32_16x16x32_bf16 v[88:91], v[12:15], a[108:111], v[88:91]
    s_waitcnt lgkmcnt(3)
    v_cvt_pk_bf16_f32 v58, v60, v61
    v_cvt_pk_bf16_f32 v59, v62, v63
    v_mfma_f32_16x16x32_bf16 v[68:71], v[16:19], a[96:99], v[68:71]
    s_barrier
    v_add_u32 v4, 0xfffe5000, v4
    v_mfma_f32_16x16x32_bf16 v[76:79], v[16:19], a[100:103], v[76:79]
    s_add_u32 s70, s69, 55296
    s_add_u32 s61, s49, 55296
    ds_read_b128 v[8:11], v4 offset:0
    v_mfma_f32_16x16x32_bf16 v[84:87], v[16:19], a[104:107], v[84:87]
    buffer_store_dwordx4 v[56:59], v2, s[4:7], s70 offen sc1
    v_mfma_f32_16x16x32_bf16 v[92:95], v[16:19], a[108:111], v[92:95]
    s_waitcnt lgkmcnt(3)
    s_add_u32 m0, s61, 18432
    s_add_u32 s61, s61, s62
    v_mfma_f32_16x16x32_bf16 v[64:67], v[20:23], a[112:115], v[64:67]
    ds_read_b128 v[12:15], v4 offset:1024
    v_mfma_f32_16x16x32_bf16 v[72:75], v[20:23], a[116:119], v[72:75]
    v_mfma_f32_16x16x32_bf16 v[80:83], v[20:23], a[120:123], v[80:83]
    buffer_load_dwordx4 v2, s[4:7], s61 offen offset:0 lds
    v_mfma_f32_16x16x32_bf16 v[88:91], v[20:23], a[124:127], v[88:91]
    s_waitcnt lgkmcnt(3)
    v_mfma_f32_16x16x32_bf16 v[68:71], v[24:27], a[112:115], v[68:71]
    ds_read_b128 v[16:19], v4 offset:2048
    v_mfma_f32_16x16x32_bf16 v[76:79], v[24:27], a[116:119], v[76:79]
    v_mfma_f32_16x16x32_bf16 v[84:87], v[24:27], a[120:123], v[84:87]
    buffer_load_dwordx4 v2, s[4:7], s61 offen offset:1024 lds
    v_mfma_f32_16x16x32_bf16 v[92:95], v[24:27], a[124:127], v[92:95]
    s_waitcnt lgkmcnt(3)
    v_mfma_f32_16x16x32_bf16 v[64:67], v[28:31], a[128:131], v[64:67]
    ds_read_b128 v[20:23], v4 offset:3072
    v_mfma_f32_16x16x32_bf16 v[72:75], v[28:31], a[132:135], v[72:75]
    v_mfma_f32_16x16x32_bf16 v[80:83], v[28:31], a[136:139], v[80:83]
    buffer_load_dwordx4 v2, s[4:7], s61 offen offset:2048 lds
    v_mfma_f32_16x16x32_bf16 v[88:91], v[28:31], a[140:143], v[88:91]
    s_waitcnt lgkmcnt(3)
    v_mfma_f32_16x16x32_bf16 v[68:71], v[8:11], a[128:131], v[68:71]
    ds_read_b128 v[24:27], v4 offset:4096
    v_mfma_f32_16x16x32_bf16 v[76:79], v[8:11], a[132:135], v[76:79]
    v_mfma_f32_16x16x32_bf16 v[84:87], v[8:11], a[136:139], v[84:87]
    buffer_load_dwordx4 v2, s[4:7], s61 offen offset:3072 lds
    v_mfma_f32_16x16x32_bf16 v[92:95], v[8:11], a[140:143], v[92:95]
    s_waitcnt lgkmcnt(3)
    s_add_u32 s61, s49, 59392
    s_add_u32 m0, s61, 18432
    v_mfma_f32_16x16x32_bf16 v[64:67], v[12:15], a[144:147], v[64:67]
    s_add_u32 s61, s61, s62
    ds_read_b128 v[28:31], v4 offset:5120
    v_mfma_f32_16x16x32_bf16 v[72:75], v[12:15], a[148:151], v[72:75]
    v_mfma_f32_16x16x32_bf16 v[80:83], v[12:15], a[152:155], v[80:83]
    buffer_load_dwordx4 v2, s[4:7], s61 offen offset:0 lds
    v_mfma_f32_16x16x32_bf16 v[88:91], v[12:15], a[156:159], v[88:91]
    s_waitcnt lgkmcnt(3)
    v_mfma_f32_16x16x32_bf16 v[68:71], v[16:19], a[144:147], v[68:71]
    ds_read_b128 v[8:11], v4 offset:6144
    v_mfma_f32_16x16x32_bf16 v[76:79], v[16:19], a[148:151], v[76:79]
    v_mfma_f32_16x16x32_bf16 v[84:87], v[16:19], a[152:155], v[84:87]
    buffer_load_dwordx4 v2, s[4:7], s61 offen offset:1024 lds
    v_mfma_f32_16x16x32_bf16 v[92:95], v[16:19], a[156:159], v[92:95]
    s_waitcnt lgkmcnt(3)
    v_mfma_f32_16x16x32_bf16 v[64:67], v[20:23], a[160:163], v[64:67]
    ds_read_b128 v[12:15], v4 offset:7168
    v_mfma_f32_16x16x32_bf16 v[72:75], v[20:23], a[164:167], v[72:75]
    v_mfma_f32_16x16x32_bf16 v[80:83], v[20:23], a[168:171], v[80:83]
    buffer_load_dwordx4 v2, s[4:7], s61 offen offset:2048 lds
    v_mfma_f32_16x16x32_bf16 v[88:91], v[20:23], a[172:175], v[88:91]
    s_waitcnt lgkmcnt(3)
    v_mfma_f32_16x16x32_bf16 v[68:71], v[24:27], a[160:163], v[68:71]
    ds_read_b128 v[16:19], v4 offset:8192
    v_mfma_f32_16x16x32_bf16 v[76:79], v[24:27], a[164:167], v[76:79]
    v_mfma_f32_16x16x32_bf16 v[84:87], v[24:27], a[168:171], v[84:87]
    buffer_load_dwordx4 v2, s[4:7], s61 offen offset:3072 lds
    v_mfma_f32_16x16x32_bf16 v[92:95], v[24:27], a[172:175], v[92:95]
    s_waitcnt lgkmcnt(3)
    s_add_u32 s61, s49, 63488
    s_add_u32 m0, s61, 18432
    v_mfma_f32_16x16x32_bf16 v[64:67], v[28:31], a[176:179], v[64:67]
    s_add_u32 s61, s61, s62
    ds_read_b128 v[20:23], v4 offset:9216
    v_mfma_f32_16x16x32_bf16 v[72:75], v[28:31], a[180:183], v[72:75]
    v_mfma_f32_16x16x32_bf16 v[80:83], v[28:31], a[184:187], v[80:83]
    buffer_load_dwordx4 v2, s[4:7], s61 offen offset:0 lds
    v_mfma_f32_16x16x32_bf16 v[88:91], v[28:31], a[188:191], v[88:91]
    s_waitcnt lgkmcnt(3)
    v_mfma_f32_16x16x32_bf16 v[68:71], v[8:11], a[176:179], v[68:71]
    ds_read_b128 v[24:27], v4 offset:10240
    v_mfma_f32_16x16x32_bf16 v[76:79], v[8:11], a[180:183], v[76:79]
    v_mfma_f32_16x16x32_bf16 v[84:87], v[8:11], a[184:187], v[84:87]
    v_mfma_f32_16x16x32_bf16 v[92:95], v[8:11], a[188:191], v[92:95]
    s_waitcnt lgkmcnt(3)
    v_mfma_f32_16x16x32_bf16 v[64:67], v[12:15], a[192:195], v[64:67]
    ds_read_b128 v[28:31], v4 offset:11264
    v_mfma_f32_16x16x32_bf16 v[72:75], v[12:15], a[196:199], v[72:75]
    v_mfma_f32_16x16x32_bf16 v[80:83], v[12:15], a[200:203], v[80:83]
    v_mfma_f32_16x16x32_bf16 v[88:91], v[12:15], a[204:207], v[88:91]
    s_waitcnt lgkmcnt(3)
    v_mfma_f32_16x16x32_bf16 v[68:71], v[16:19], a[192:195], v[68:71]
    ds_read_b128 v[8:11], v4 offset:12288
    v_mfma_f32_16x16x32_bf16 v[76:79], v[16:19], a[196:199], v[76:79]
    v_mfma_f32_16x16x32_bf16 v[84:87], v[16:19], a[200:203], v[84:87]
    v_mfma_f32_16x16x32_bf16 v[92:95], v[16:19], a[204:207], v[92:95]
    s_waitcnt lgkmcnt(3)
    v_mfma_f32_16x16x32_bf16 v[96:99], v[20:23], a[64:67], v[96:99]
    ds_read_b128 v[12:15], v4 offset:13312
    v_mfma_f32_16x16x32_bf16 v[104:107], v[20:23], a[68:71], v[104:107]
    v_mfma_f32_16x16x32_bf16 v[112:115], v[20:23], a[72:75], v[112:115]
    v_mfma_f32_16x16x32_bf16 v[120:123], v[20:23], a[76:79], v[120:123]
    s_waitcnt lgkmcnt(3)
    v_cvt_pk_bf16_f32 v64, v64, v65
    v_cvt_pk_bf16_f32 v65, v66, v67
    v_mfma_f32_16x16x32_bf16 v[100:103], v[24:27], a[64:67], v[100:103]
    ds_read_b128 v[16:19], v4 offset:14336
    v_cvt_pk_bf16_f32 v66, v68, v69
    v_mfma_f32_16x16x32_bf16 v[108:111], v[24:27], a[68:71], v[108:111]
    v_cvt_pk_bf16_f32 v67, v70, v71
    v_mfma_f32_16x16x32_bf16 v[116:119], v[24:27], a[72:75], v[116:119]
    s_add_u32 s70, s69, 1024
    v_mfma_f32_16x16x32_bf16 v[124:127], v[24:27], a[76:79], v[124:127]
    s_waitcnt lgkmcnt(3)
    v_mfma_f32_16x16x32_bf16 v[96:99], v[28:31], a[80:83], v[96:99]
    ds_read_b128 v[20:23], v4 offset:15360
    v_mfma_f32_16x16x32_bf16 v[104:107], v[28:31], a[84:87], v[104:107]
    buffer_store_dwordx4 v[64:67], v2, s[4:7], s70 offen sc1
    v_mfma_f32_16x16x32_bf16 v[112:115], v[28:31], a[88:91], v[112:115]
    v_cvt_pk_bf16_f32 v72, v72, v73
    v_cvt_pk_bf16_f32 v73, v74, v75
    v_mfma_f32_16x16x32_bf16 v[120:123], v[28:31], a[92:95], v[120:123]
    s_waitcnt lgkmcnt(3)
    v_cvt_pk_bf16_f32 v74, v76, v77
    v_cvt_pk_bf16_f32 v75, v78, v79
    v_mfma_f32_16x16x32_bf16 v[100:103], v[8:11], a[80:83], v[100:103]
    s_add_u32 s70, s69, 19456
    ds_read_b128 v[24:27], v4 offset:16384
    v_mfma_f32_16x16x32_bf16 v[108:111], v[8:11], a[84:87], v[108:111]
    buffer_store_dwordx4 v[72:75], v2, s[4:7], s70 offen sc1
    v_mfma_f32_16x16x32_bf16 v[116:119], v[8:11], a[88:91], v[116:119]
    v_cvt_pk_bf16_f32 v80, v80, v81
    v_cvt_pk_bf16_f32 v81, v82, v83
    v_mfma_f32_16x16x32_bf16 v[124:127], v[8:11], a[92:95], v[124:127]
    s_waitcnt lgkmcnt(3)
    v_cvt_pk_bf16_f32 v82, v84, v85
    v_cvt_pk_bf16_f32 v83, v86, v87
    v_mfma_f32_16x16x32_bf16 v[96:99], v[12:15], a[96:99], v[96:99]
    s_add_u32 s70, s69, 37888
    ds_read_b128 v[28:31], v4 offset:17408
    v_mfma_f32_16x16x32_bf16 v[104:107], v[12:15], a[100:103], v[104:107]
    buffer_store_dwordx4 v[80:83], v2, s[4:7], s70 offen sc1
    v_mfma_f32_16x16x32_bf16 v[112:115], v[12:15], a[104:107], v[112:115]
    v_cvt_pk_bf16_f32 v88, v88, v89
    v_cvt_pk_bf16_f32 v89, v90, v91
    v_mfma_f32_16x16x32_bf16 v[120:123], v[12:15], a[108:111], v[120:123]
    s_waitcnt lgkmcnt(3)
    v_cvt_pk_bf16_f32 v90, v92, v93
    v_cvt_pk_bf16_f32 v91, v94, v95
    v_mfma_f32_16x16x32_bf16 v[100:103], v[16:19], a[96:99], v[100:103]
    s_add_u32 s70, s69, 56320
    ds_read_b128 v[8:11], v4 offset:18432
    v_mfma_f32_16x16x32_bf16 v[108:111], v[16:19], a[100:103], v[108:111]
    buffer_store_dwordx4 v[88:91], v2, s[4:7], s70 offen sc1
    v_mfma_f32_16x16x32_bf16 v[116:119], v[16:19], a[104:107], v[116:119]
    v_mfma_f32_16x16x32_bf16 v[124:127], v[16:19], a[108:111], v[124:127]
    s_waitcnt lgkmcnt(3)
    v_mfma_f32_16x16x32_bf16 v[96:99], v[20:23], a[112:115], v[96:99]
    ds_read_b128 v[12:15], v4 offset:19456
    v_mfma_f32_16x16x32_bf16 v[104:107], v[20:23], a[116:119], v[104:107]
    v_mfma_f32_16x16x32_bf16 v[112:115], v[20:23], a[120:123], v[112:115]
    v_mfma_f32_16x16x32_bf16 v[120:123], v[20:23], a[124:127], v[120:123]
    s_waitcnt lgkmcnt(3)
    v_mfma_f32_16x16x32_bf16 v[100:103], v[24:27], a[112:115], v[100:103]
    ds_read_b128 v[16:19], v4 offset:20480
    v_mfma_f32_16x16x32_bf16 v[108:111], v[24:27], a[116:119], v[108:111]
    v_mfma_f32_16x16x32_bf16 v[116:119], v[24:27], a[120:123], v[116:119]
    v_mfma_f32_16x16x32_bf16 v[124:127], v[24:27], a[124:127], v[124:127]
    s_waitcnt lgkmcnt(3)
    v_mfma_f32_16x16x32_bf16 v[96:99], v[28:31], a[128:131], v[96:99]
    ds_read_b128 v[20:23], v4 offset:21504
    v_mfma_f32_16x16x32_bf16 v[104:107], v[28:31], a[132:135], v[104:107]
    v_mfma_f32_16x16x32_bf16 v[112:115], v[28:31], a[136:139], v[112:115]
    v_mfma_f32_16x16x32_bf16 v[120:123], v[28:31], a[140:143], v[120:123]
    s_waitcnt lgkmcnt(3)
    v_mfma_f32_16x16x32_bf16 v[100:103], v[8:11], a[128:131], v[100:103]
    ds_read_b128 v[24:27], v4 offset:22528
    v_mfma_f32_16x16x32_bf16 v[108:111], v[8:11], a[132:135], v[108:111]
    v_mfma_f32_16x16x32_bf16 v[116:119], v[8:11], a[136:139], v[116:119]
    v_mfma_f32_16x16x32_bf16 v[124:127], v[8:11], a[140:143], v[124:127]
    s_waitcnt lgkmcnt(3)
    v_mfma_f32_16x16x32_bf16 v[96:99], v[12:15], a[144:147], v[96:99]
    ds_read_b128 v[28:31], v4 offset:23552
    v_mfma_f32_16x16x32_bf16 v[104:107], v[12:15], a[148:151], v[104:107]
    v_mfma_f32_16x16x32_bf16 v[112:115], v[12:15], a[152:155], v[112:115]
    v_mfma_f32_16x16x32_bf16 v[120:123], v[12:15], a[156:159], v[120:123]
    s_waitcnt lgkmcnt(3)
    v_mfma_f32_16x16x32_bf16 v[100:103], v[16:19], a[144:147], v[100:103]
    ds_read_b128 v[8:11], v4 offset:24576
    v_mfma_f32_16x16x32_bf16 v[108:111], v[16:19], a[148:151], v[108:111]
    v_mfma_f32_16x16x32_bf16 v[116:119], v[16:19], a[152:155], v[116:119]
    v_mfma_f32_16x16x32_bf16 v[124:127], v[16:19], a[156:159], v[124:127]
    s_waitcnt lgkmcnt(3)
    v_mfma_f32_16x16x32_bf16 v[96:99], v[20:23], a[160:163], v[96:99]
    ds_read_b128 v[12:15], v4 offset:25600
    v_mfma_f32_16x16x32_bf16 v[104:107], v[20:23], a[164:167], v[104:107]
    v_mfma_f32_16x16x32_bf16 v[112:115], v[20:23], a[168:171], v[112:115]
    v_mfma_f32_16x16x32_bf16 v[120:123], v[20:23], a[172:175], v[120:123]
    s_waitcnt lgkmcnt(3)
    v_mfma_f32_16x16x32_bf16 v[100:103], v[24:27], a[160:163], v[100:103]
    ds_read_b128 v[16:19], v4 offset:26624
    v_mfma_f32_16x16x32_bf16 v[108:111], v[24:27], a[164:167], v[108:111]
    v_mfma_f32_16x16x32_bf16 v[116:119], v[24:27], a[168:171], v[116:119]
    v_mfma_f32_16x16x32_bf16 v[124:127], v[24:27], a[172:175], v[124:127]
    s_waitcnt lgkmcnt(3)
    v_mfma_f32_16x16x32_bf16 v[96:99], v[28:31], a[176:179], v[96:99]
    ds_read_b128 v[20:23], v4 offset:27648
    v_mfma_f32_16x16x32_bf16 v[104:107], v[28:31], a[180:183], v[104:107]
    v_mfma_f32_16x16x32_bf16 v[112:115], v[28:31], a[184:187], v[112:115]
    v_mfma_f32_16x16x32_bf16 v[120:123], v[28:31], a[188:191], v[120:123]
    s_waitcnt lgkmcnt(3)
    v_mfma_f32_16x16x32_bf16 v[100:103], v[8:11], a[176:179], v[100:103]
    ds_read_b128 v[24:27], v4 offset:28672
    v_mfma_f32_16x16x32_bf16 v[108:111], v[8:11], a[180:183], v[108:111]
    v_mfma_f32_16x16x32_bf16 v[116:119], v[8:11], a[184:187], v[116:119]
    v_mfma_f32_16x16x32_bf16 v[124:127], v[8:11], a[188:191], v[124:127]
    s_waitcnt lgkmcnt(3)
    v_mfma_f32_16x16x32_bf16 v[96:99], v[12:15], a[192:195], v[96:99]
    ds_read_b128 v[28:31], v4 offset:29696
    v_mfma_f32_16x16x32_bf16 v[104:107], v[12:15], a[196:199], v[104:107]
    v_mfma_f32_16x16x32_bf16 v[112:115], v[12:15], a[200:203], v[112:115]
    v_mfma_f32_16x16x32_bf16 v[120:123], v[12:15], a[204:207], v[120:123]
    s_waitcnt lgkmcnt(3)
    v_mfma_f32_16x16x32_bf16 v[100:103], v[16:19], a[192:195], v[100:103]
    ds_read_b128 v[8:11], v4 offset:30720
    v_mfma_f32_16x16x32_bf16 v[108:111], v[16:19], a[196:199], v[108:111]
    v_mfma_f32_16x16x32_bf16 v[116:119], v[16:19], a[200:203], v[116:119]
    v_mfma_f32_16x16x32_bf16 v[124:127], v[16:19], a[204:207], v[124:127]
    s_waitcnt lgkmcnt(3)
    v_mfma_f32_16x16x32_bf16 v[128:131], v[20:23], a[64:67], v[128:131]
    ds_read_b128 v[12:15], v4 offset:31744
    v_mfma_f32_16x16x32_bf16 v[136:139], v[20:23], a[68:71], v[136:139]
    v_mfma_f32_16x16x32_bf16 v[144:147], v[20:23], a[72:75], v[144:147]
    v_mfma_f32_16x16x32_bf16 v[152:155], v[20:23], a[76:79], v[152:155]
    s_waitcnt lgkmcnt(3)
    v_cvt_pk_bf16_f32 v96, v96, v97
    v_cvt_pk_bf16_f32 v97, v98, v99
    v_mfma_f32_16x16x32_bf16 v[132:135], v[24:27], a[64:67], v[132:135]
    ds_read_b128 v[16:19], v4 offset:32768
    v_cvt_pk_bf16_f32 v98, v100, v101
    v_mfma_f32_16x16x32_bf16 v[140:143], v[24:27], a[68:71], v[140:143]
    v_cvt_pk_bf16_f32 v99, v102, v103
    v_mfma_f32_16x16x32_bf16 v[148:151], v[24:27], a[72:75], v[148:151]
    s_add_u32 s70, s69, 2048
    v_mfma_f32_16x16x32_bf16 v[156:159], v[24:27], a[76:79], v[156:159]
    s_waitcnt lgkmcnt(3)
    v_mfma_f32_16x16x32_bf16 v[128:131], v[28:31], a[80:83], v[128:131]
    ds_read_b128 v[20:23], v4 offset:33792
    v_mfma_f32_16x16x32_bf16 v[136:139], v[28:31], a[84:87], v[136:139]
    buffer_store_dwordx4 v[96:99], v2, s[4:7], s70 offen sc1
    v_mfma_f32_16x16x32_bf16 v[144:147], v[28:31], a[88:91], v[144:147]
    v_cvt_pk_bf16_f32 v104, v104, v105
    v_cvt_pk_bf16_f32 v105, v106, v107
    v_mfma_f32_16x16x32_bf16 v[152:155], v[28:31], a[92:95], v[152:155]
    s_waitcnt lgkmcnt(3)
    v_cvt_pk_bf16_f32 v106, v108, v109
    v_cvt_pk_bf16_f32 v107, v110, v111
    v_mfma_f32_16x16x32_bf16 v[132:135], v[8:11], a[80:83], v[132:135]
    s_add_u32 s70, s69, 20480
    ds_read_b128 v[24:27], v4 offset:34816
    v_mfma_f32_16x16x32_bf16 v[140:143], v[8:11], a[84:87], v[140:143]
    buffer_store_dwordx4 v[104:107], v2, s[4:7], s70 offen sc1
    v_mfma_f32_16x16x32_bf16 v[148:151], v[8:11], a[88:91], v[148:151]
    v_cvt_pk_bf16_f32 v112, v112, v113
    v_cvt_pk_bf16_f32 v113, v114, v115
    v_mfma_f32_16x16x32_bf16 v[156:159], v[8:11], a[92:95], v[156:159]
    s_waitcnt lgkmcnt(3)
    v_cvt_pk_bf16_f32 v114, v116, v117
    v_cvt_pk_bf16_f32 v115, v118, v119
    v_mfma_f32_16x16x32_bf16 v[128:131], v[12:15], a[96:99], v[128:131]
    s_add_u32 s70, s69, 38912
    ds_read_b128 v[28:31], v4 offset:35840
    v_mfma_f32_16x16x32_bf16 v[136:139], v[12:15], a[100:103], v[136:139]
    buffer_store_dwordx4 v[112:115], v2, s[4:7], s70 offen sc1
    v_mfma_f32_16x16x32_bf16 v[144:147], v[12:15], a[104:107], v[144:147]
    v_cvt_pk_bf16_f32 v120, v120, v121
    v_cvt_pk_bf16_f32 v121, v122, v123
    v_mfma_f32_16x16x32_bf16 v[152:155], v[12:15], a[108:111], v[152:155]
    s_waitcnt lgkmcnt(3)
    v_cvt_pk_bf16_f32 v122, v124, v125
    v_cvt_pk_bf16_f32 v123, v126, v127
    v_mfma_f32_16x16x32_bf16 v[132:135], v[16:19], a[96:99], v[132:135]
    s_waitcnt vmcnt(25)
    s_barrier
    v_add_u32 v4, 0x9000, v4
    v_mfma_f32_16x16x32_bf16 v[140:143], v[16:19], a[100:103], v[140:143]
    s_add_u32 s70, s69, 57344
    s_add_u32 s61, s49, 92160
    ds_read_b128 v[8:11], v4 offset:0
    v_mfma_f32_16x16x32_bf16 v[148:151], v[16:19], a[104:107], v[148:151]
    buffer_store_dwordx4 v[120:123], v2, s[4:7], s70 offen sc1
    v_mfma_f32_16x16x32_bf16 v[156:159], v[16:19], a[108:111], v[156:159]
    s_waitcnt lgkmcnt(3)
    s_add_u32 m0, s61, 18432
    s_add_u32 s61, s61, s62
    v_mfma_f32_16x16x32_bf16 v[128:131], v[20:23], a[112:115], v[128:131]
    ds_read_b128 v[12:15], v4 offset:1024
    v_mfma_f32_16x16x32_bf16 v[136:139], v[20:23], a[116:119], v[136:139]
    v_mfma_f32_16x16x32_bf16 v[144:147], v[20:23], a[120:123], v[144:147]
    buffer_load_dwordx4 v2, s[4:7], s61 offen offset:0 lds
    v_mfma_f32_16x16x32_bf16 v[152:155], v[20:23], a[124:127], v[152:155]
    s_waitcnt lgkmcnt(3)
    v_mfma_f32_16x16x32_bf16 v[132:135], v[24:27], a[112:115], v[132:135]
    ds_read_b128 v[16:19], v4 offset:2048
    v_mfma_f32_16x16x32_bf16 v[140:143], v[24:27], a[116:119], v[140:143]
    v_mfma_f32_16x16x32_bf16 v[148:151], v[24:27], a[120:123], v[148:151]
    buffer_load_dwordx4 v2, s[4:7], s61 offen offset:1024 lds
    v_mfma_f32_16x16x32_bf16 v[156:159], v[24:27], a[124:127], v[156:159]
    s_waitcnt lgkmcnt(3)
    v_mfma_f32_16x16x32_bf16 v[128:131], v[28:31], a[128:131], v[128:131]
    ds_read_b128 v[20:23], v4 offset:3072
    v_mfma_f32_16x16x32_bf16 v[136:139], v[28:31], a[132:135], v[136:139]
    v_mfma_f32_16x16x32_bf16 v[144:147], v[28:31], a[136:139], v[144:147]
    buffer_load_dwordx4 v2, s[4:7], s61 offen offset:2048 lds
    v_mfma_f32_16x16x32_bf16 v[152:155], v[28:31], a[140:143], v[152:155]
    s_waitcnt lgkmcnt(3)
    v_mfma_f32_16x16x32_bf16 v[132:135], v[8:11], a[128:131], v[132:135]
    ds_read_b128 v[24:27], v4 offset:4096
    v_mfma_f32_16x16x32_bf16 v[140:143], v[8:11], a[132:135], v[140:143]
    v_mfma_f32_16x16x32_bf16 v[148:151], v[8:11], a[136:139], v[148:151]
    buffer_load_dwordx4 v2, s[4:7], s61 offen offset:3072 lds
    v_mfma_f32_16x16x32_bf16 v[156:159], v[8:11], a[140:143], v[156:159]
    s_waitcnt lgkmcnt(3)
    s_add_u32 s61, s49, 96256
    s_add_u32 m0, s61, 18432
    v_mfma_f32_16x16x32_bf16 v[128:131], v[12:15], a[144:147], v[128:131]
    s_add_u32 s61, s61, s62
    ds_read_b128 v[28:31], v4 offset:5120
    v_mfma_f32_16x16x32_bf16 v[136:139], v[12:15], a[148:151], v[136:139]
    v_mfma_f32_16x16x32_bf16 v[144:147], v[12:15], a[152:155], v[144:147]
    buffer_load_dwordx4 v2, s[4:7], s61 offen offset:0 lds
    v_mfma_f32_16x16x32_bf16 v[152:155], v[12:15], a[156:159], v[152:155]
    s_waitcnt lgkmcnt(3)
    v_mfma_f32_16x16x32_bf16 v[132:135], v[16:19], a[144:147], v[132:135]
    ds_read_b128 v[8:11], v4 offset:6144
    v_mfma_f32_16x16x32_bf16 v[140:143], v[16:19], a[148:151], v[140:143]
    v_mfma_f32_16x16x32_bf16 v[148:151], v[16:19], a[152:155], v[148:151]
    buffer_load_dwordx4 v2, s[4:7], s61 offen offset:1024 lds
    v_mfma_f32_16x16x32_bf16 v[156:159], v[16:19], a[156:159], v[156:159]
    s_waitcnt lgkmcnt(3)
    v_mfma_f32_16x16x32_bf16 v[128:131], v[20:23], a[160:163], v[128:131]
    ds_read_b128 v[12:15], v4 offset:7168
    v_mfma_f32_16x16x32_bf16 v[136:139], v[20:23], a[164:167], v[136:139]
    v_mfma_f32_16x16x32_bf16 v[144:147], v[20:23], a[168:171], v[144:147]
    buffer_load_dwordx4 v2, s[4:7], s61 offen offset:2048 lds
    v_mfma_f32_16x16x32_bf16 v[152:155], v[20:23], a[172:175], v[152:155]
    s_waitcnt lgkmcnt(3)
    v_mfma_f32_16x16x32_bf16 v[132:135], v[24:27], a[160:163], v[132:135]
    ds_read_b128 v[16:19], v4 offset:8192
    v_mfma_f32_16x16x32_bf16 v[140:143], v[24:27], a[164:167], v[140:143]
    v_mfma_f32_16x16x32_bf16 v[148:151], v[24:27], a[168:171], v[148:151]
    buffer_load_dwordx4 v2, s[4:7], s61 offen offset:3072 lds
    v_mfma_f32_16x16x32_bf16 v[156:159], v[24:27], a[172:175], v[156:159]
    s_waitcnt lgkmcnt(3)
    s_add_u32 s61, s49, 100352
    s_add_u32 m0, s61, 18432
    v_mfma_f32_16x16x32_bf16 v[128:131], v[28:31], a[176:179], v[128:131]
    s_add_u32 s61, s61, s62
    ds_read_b128 v[20:23], v4 offset:9216
    v_mfma_f32_16x16x32_bf16 v[136:139], v[28:31], a[180:183], v[136:139]
    v_mfma_f32_16x16x32_bf16 v[144:147], v[28:31], a[184:187], v[144:147]
    buffer_load_dwordx4 v2, s[4:7], s61 offen offset:0 lds
    v_mfma_f32_16x16x32_bf16 v[152:155], v[28:31], a[188:191], v[152:155]
    s_waitcnt lgkmcnt(3)
    v_mfma_f32_16x16x32_bf16 v[132:135], v[8:11], a[176:179], v[132:135]
    ds_read_b128 v[24:27], v4 offset:10240
    v_mfma_f32_16x16x32_bf16 v[140:143], v[8:11], a[180:183], v[140:143]
    v_mfma_f32_16x16x32_bf16 v[148:151], v[8:11], a[184:187], v[148:151]
    v_mfma_f32_16x16x32_bf16 v[156:159], v[8:11], a[188:191], v[156:159]
    s_waitcnt lgkmcnt(3)
    v_mfma_f32_16x16x32_bf16 v[128:131], v[12:15], a[192:195], v[128:131]
    ds_read_b128 v[28:31], v4 offset:11264
    v_mfma_f32_16x16x32_bf16 v[136:139], v[12:15], a[196:199], v[136:139]
    v_mfma_f32_16x16x32_bf16 v[144:147], v[12:15], a[200:203], v[144:147]
    v_mfma_f32_16x16x32_bf16 v[152:155], v[12:15], a[204:207], v[152:155]
    s_waitcnt lgkmcnt(3)
    v_mfma_f32_16x16x32_bf16 v[132:135], v[16:19], a[192:195], v[132:135]
    ds_read_b128 v[8:11], v4 offset:12288
    v_mfma_f32_16x16x32_bf16 v[140:143], v[16:19], a[196:199], v[140:143]
    v_mfma_f32_16x16x32_bf16 v[148:151], v[16:19], a[200:203], v[148:151]
    v_mfma_f32_16x16x32_bf16 v[156:159], v[16:19], a[204:207], v[156:159]
    s_waitcnt lgkmcnt(3)
    v_mfma_f32_16x16x32_bf16 v[160:163], v[20:23], a[64:67], v[160:163]
    ds_read_b128 v[12:15], v4 offset:13312
    v_mfma_f32_16x16x32_bf16 v[164:167], v[20:23], a[68:71], v[164:167]
    v_mfma_f32_16x16x32_bf16 v[168:171], v[20:23], a[72:75], v[168:171]
    v_mfma_f32_16x16x32_bf16 v[172:175], v[20:23], a[76:79], v[172:175]
    s_waitcnt lgkmcnt(3)
    v_cvt_pk_bf16_f32 v128, v128, v129
    v_cvt_pk_bf16_f32 v129, v130, v131
    v_mfma_f32_16x16x32_bf16 v[160:163], v[24:27], a[80:83], v[160:163]
    ds_read_b128 v[16:19], v4 offset:14336
    v_cvt_pk_bf16_f32 v130, v132, v133
    v_mfma_f32_16x16x32_bf16 v[164:167], v[24:27], a[84:87], v[164:167]
    v_cvt_pk_bf16_f32 v131, v134, v135
    v_mfma_f32_16x16x32_bf16 v[168:171], v[24:27], a[88:91], v[168:171]
    s_add_u32 s70, s69, 3072
    v_mfma_f32_16x16x32_bf16 v[172:175], v[24:27], a[92:95], v[172:175]
    s_waitcnt lgkmcnt(3)
    v_mfma_f32_16x16x32_bf16 v[160:163], v[28:31], a[96:99], v[160:163]
    ds_read_b128 v[20:23], v4 offset:15360
    v_mfma_f32_16x16x32_bf16 v[164:167], v[28:31], a[100:103], v[164:167]
    buffer_store_dwordx4 v[128:131], v2, s[4:7], s70 offen sc1
    v_mfma_f32_16x16x32_bf16 v[168:171], v[28:31], a[104:107], v[168:171]
    v_cvt_pk_bf16_f32 v136, v136, v137
    v_cvt_pk_bf16_f32 v137, v138, v139
    v_mfma_f32_16x16x32_bf16 v[172:175], v[28:31], a[108:111], v[172:175]
    s_waitcnt lgkmcnt(3)
    v_cvt_pk_bf16_f32 v138, v140, v141
    v_cvt_pk_bf16_f32 v139, v142, v143
    v_mfma_f32_16x16x32_bf16 v[160:163], v[8:11], a[112:115], v[160:163]
    s_add_u32 s70, s69, 21504
    ds_read_b128 v[24:27], v4 offset:16384
    v_mfma_f32_16x16x32_bf16 v[164:167], v[8:11], a[116:119], v[164:167]
    buffer_store_dwordx4 v[136:139], v2, s[4:7], s70 offen sc1
    v_mfma_f32_16x16x32_bf16 v[168:171], v[8:11], a[120:123], v[168:171]
    v_cvt_pk_bf16_f32 v144, v144, v145
    v_cvt_pk_bf16_f32 v145, v146, v147
    v_mfma_f32_16x16x32_bf16 v[172:175], v[8:11], a[124:127], v[172:175]
    s_waitcnt lgkmcnt(3)
    v_cvt_pk_bf16_f32 v146, v148, v149
    v_cvt_pk_bf16_f32 v147, v150, v151
    v_mfma_f32_16x16x32_bf16 v[160:163], v[12:15], a[128:131], v[160:163]
    s_add_u32 s70, s69, 39936
    ds_read_b128 v[28:31], v4 offset:17408
    v_mfma_f32_16x16x32_bf16 v[164:167], v[12:15], a[132:135], v[164:167]
    buffer_store_dwordx4 v[144:147], v2, s[4:7], s70 offen sc1
    v_mfma_f32_16x16x32_bf16 v[168:171], v[12:15], a[136:139], v[168:171]
    v_cvt_pk_bf16_f32 v152, v152, v153
    v_cvt_pk_bf16_f32 v153, v154, v155
    v_mfma_f32_16x16x32_bf16 v[172:175], v[12:15], a[140:143], v[172:175]
    s_waitcnt lgkmcnt(3)
    v_cvt_pk_bf16_f32 v154, v156, v157
    v_cvt_pk_bf16_f32 v155, v158, v159
    v_mfma_f32_16x16x32_bf16 v[160:163], v[16:19], a[144:147], v[160:163]
    s_add_u32 s70, s69, 58368
    v_mfma_f32_16x16x32_bf16 v[164:167], v[16:19], a[148:151], v[164:167]
    buffer_store_dwordx4 v[152:155], v2, s[4:7], s70 offen sc1
    v_mfma_f32_16x16x32_bf16 v[168:171], v[16:19], a[152:155], v[168:171]
    v_mfma_f32_16x16x32_bf16 v[172:175], v[16:19], a[156:159], v[172:175]
    s_waitcnt lgkmcnt(2)
    v_mfma_f32_16x16x32_bf16 v[160:163], v[20:23], a[160:163], v[160:163]
    v_mfma_f32_16x16x32_bf16 v[164:167], v[20:23], a[164:167], v[164:167]
    v_mfma_f32_16x16x32_bf16 v[168:171], v[20:23], a[168:171], v[168:171]
    v_mfma_f32_16x16x32_bf16 v[172:175], v[20:23], a[172:175], v[172:175]
    s_waitcnt lgkmcnt(1)
    v_mfma_f32_16x16x32_bf16 v[160:163], v[24:27], a[176:179], v[160:163]
    v_mfma_f32_16x16x32_bf16 v[164:167], v[24:27], a[180:183], v[164:167]
    v_mfma_f32_16x16x32_bf16 v[168:171], v[24:27], a[184:187], v[168:171]
    v_mfma_f32_16x16x32_bf16 v[172:175], v[24:27], a[188:191], v[172:175]
    s_waitcnt lgkmcnt(0)
    v_mfma_f32_16x16x32_bf16 v[160:163], v[28:31], a[192:195], v[160:163]
    v_mfma_f32_16x16x32_bf16 v[164:167], v[28:31], a[196:199], v[164:167]
    v_mfma_f32_16x16x32_bf16 v[168:171], v[28:31], a[200:203], v[168:171]
    v_mfma_f32_16x16x32_bf16 v[172:175], v[28:31], a[204:207], v[172:175]
    s_nop 4
    v_cvt_pk_bf16_f32 v160, v160, v161
    v_cvt_pk_bf16_f32 v161, v162, v163
    s_add_u32 s70, s68, 4096
    buffer_store_dwordx2 v[160:161], v0, s[4:7], s70 offen sc1
    v_cvt_pk_bf16_f32 v164, v164, v165
    v_cvt_pk_bf16_f32 v165, v166, v167
    s_add_u32 s70, s68, 22528
    buffer_store_dwordx2 v[164:165], v0, s[4:7], s70 offen sc1
    v_cvt_pk_bf16_f32 v168, v168, v169
    v_cvt_pk_bf16_f32 v169, v170, v171
    s_add_u32 s70, s68, 40960
    buffer_store_dwordx2 v[168:169], v0, s[4:7], s70 offen sc1
    v_cvt_pk_bf16_f32 v172, v172, v173
    v_cvt_pk_bf16_f32 v173, v174, v175
    s_add_u32 s70, s68, 59392
    buffer_store_dwordx2 v[172:173], v0, s[4:7], s70 offen sc1
    s_lshl_b32 s60, s44, 2
    s_add_u32 s60, s60, s20
    s_lshl_b32 s60, s60, 5
    s_add_u32 s60, s60, s47
    s_lshl_b32 s60, s60, 3
    s_add_u32 s60, s60, s101
    s_add_u32 s60, s60, 4046848
    v_mov_b32 v6, s98
    v_mov_b32 v7, s99
    s_waitcnt vmcnt(0)
    s_mov_b64 exec, 1
    buffer_store_dwordx2 v[6:7], off, s[4:7], s60 sc1
    s_mov_b64 exec, -1
    s_cmp_lg_u32 s101, 0
    s_cbranch_scc1 L_red1_50
    s_barrier
    s_lshl_b32 s47, s21, 5
    s_add_u32 s47, s47, s22
    v_and_b32 v8, 7, v1
    v_lshrrev_b32 v9, 3, v1
    s_lshl_b32 s48, s47, 3
    v_add_u32 v3, s48, v8
    v_mul_u32_u24 v3, 1152, v3
    s_mul_i32 s48, s20, 384
    v_lshl_add_u32 v3, v9, 4, v3
    v_add_u32 v3, s48, v3
    s_lshr_b32 s48, s47, 1
    s_mul_i32 s48, s48, 18432
    s_and_b32 s49, s47, 1
    s_lshl_b32 s49, s49, 7
    s_add_u32 s48, s48, s49
    s_mul_i32 s49, s20, 6144
    s_add_u32 s48, s48, s49
    v_lshlrev_b32 v8, 4, v8
    v_lshl_add_u32 v8, v9, 8, v8
    v_add_u32 v4, s48, v8
    v_lshrrev_b32 v8, 3, v1
    v_and_b32 v9, 7, v1
    s_and_b32 s48, s47, 1
    s_lshl_b32 s48, s48, 3
    v_add_u32 v9, s48, v9
    v_lshlrev_b32 v9, 4, v9
    v_bfe_u32 v10, v8, 1, 1
    v_and_b32 v11, 1, v8
    v_lshl_add_u32 v9, v11, 4, v9
    v_lshl_add_u32 v9, v10, 9, v9
    v_and_b32 v10, 3, v8
    v_lshlrev_b32 v10, 8, v10
    v_sub_u32 v9, v9, v10
    s_mul_i32 s48, s20, 6
    v_lshrrev_b32 v8, 2, v8
    v_add_u32 v8, s48, v8
    v_add_u32 v10, 0, v8
    v_cmp_eq_u32 vcc, 4, v10
    v_cmp_eq_u32 s[56:57], 13, v10
    s_nop 0
    s_or_b64 vcc, vcc, s[56:57]
    v_cndmask_b32 v10, 0, v9, vcc
    v_add3_u32 v5, v4, v10, 0
    v_add_u32 v5, 0, v5
    v_add_u32 v10, 2, v8
    v_cmp_eq_u32 vcc, 4, v10
    v_cmp_eq_u32 s[56:57], 13, v10
    s_nop 0
    s_or_b64 vcc, vcc, s[56:57]
    v_cndmask_b32 v10, 0, v9, vcc
    v_add3_u32 v6, v4, v10, 0
    v_add_u32 v6, 2048, v6
    v_add_u32 v10, 4, v8
    v_cmp_eq_u32 vcc, 4, v10
    v_cmp_eq_u32 s[56:57], 13, v10
    s_nop 0
    s_or_b64 vcc, vcc, s[56:57]
    v_cndmask_b32 v10, 0, v9, vcc
    v_add3_u32 v7, v4, v10, 0
    v_add_u32 v7, 4096, v7
    s_cmp_eq_u32 s20, 3
    s_cbranch_scc1 L_w3a_91
    s_mov_b32 s48, 25690112
    buffer_load_dwordx4 v[16:19], v4, s[4:7], s48 offen offset:0 sc1
    buffer_load_dwordx4 v[52:55], v4, s[4:7], s48 offen offset:2048 sc1
    s_add_u32 s48, s48, 4096
    buffer_load_dwordx4 v[88:91], v4, s[4:7], s48 offen offset:0 sc1
    s_lshr_b32 s49, s47, 3
    s_lshl_b32 s49, s49, 8
    s_add_u32 s49, s49, 4046848
    v_and_b32 v10, 31, v1
    v_lshlrev_b32 v10, 3, v10
    buffer_load_dwordx2 v[176:177], v10, s[4:7], s49 offen sc1
    s_waitcnt vmcnt(0)
    v_cmp_eq_u64 vcc, s[98:99], v[176:177]
    s_nop 0
    s_cmp_eq_u64 vcc, exec
    s_cbranch_scc0 L_pp_slow_92
L_pp_back_93:
    s_mov_b32 s48, 50331648
    buffer_load_dwordx4 v[20:23], v5, s[4:7], s48 offen sc1
    buffer_load_dwordx4 v[56:59], v6, s[4:7], s48 offen sc1
    buffer_load_dwordx4 v[92:95], v7, s[4:7], s48 offen sc1
    s_mov_b32 s48, 52690944
    buffer_load_dwordx4 v[24:27], v5, s[4:7], s48 offen sc1
    buffer_load_dwordx4 v[60:63], v6, s[4:7], s48 offen sc1
    buffer_load_dwordx4 v[96:99], v7, s[4:7], s48 offen sc1
    s_mov_b32 s48, 55050240
    buffer_load_dwordx4 v[28:31], v5, s[4:7], s48 offen sc1
    buffer_load_dwordx4 v[64:67], v6, s[4:7], s48 offen sc1
    buffer_load_dwordx4 v[100:103], v7, s[4:7], s48 offen sc1
    s_mov_b32 s48, 57409536
    buffer_load_dwordx4 v[32:35], v5, s[4:7], s48 offen sc1
    buffer_load_dwordx4 v[68:71], v6, s[4:7], s48 offen sc1
    buffer_load_dwordx4 v[104:107], v7, s[4:7], s48 offen sc1
    s_mov_b32 s48, 59768832
    buffer_load_dwordx4 v[36:39], v5, s[4:7], s48 offen sc1
    buffer_load_dwordx4 v[72:75], v6, s[4:7], s48 offen sc1
    buffer_load_dwordx4 v[108:111], v7, s[4:7], s48 offen sc1
    s_mov_b32 s48, 62128128
    buffer_load_dwordx4 v[40:43], v5, s[4:7], s48 offen sc1
    buffer_load_dwordx4 v[76:79], v6, s[4:7], s48 offen sc1
    buffer_load_dwordx4 v[112:115], v7, s[4:7], s48 offen sc1
    s_mov_b32 s48, 64487424
    buffer_load_dwordx4 v[44:47], v5, s[4:7], s48 offen sc1
    buffer_load_dwordx4 v[80:83], v6, s[4:7], s48 offen sc1
    buffer_load_dwordx4 v[116:119], v7, s[4:7], s48 offen sc1
    s_mov_b32 s48, 66846720
    buffer_load_dwordx4 v[48:51], v5, s[4:7], s48 offen sc1
    buffer_load_dwordx4 v[84:87], v6, s[4:7], s48 offen sc1
    buffer_load_dwordx4 v[120:123], v7, s[4:7], s48 offen sc1
    v_lshlrev_b32 v128, 16, v16
    v_and_b32 v129, 0xffff0000, v16
    v_lshlrev_b32 v130, 16, v17
    v_and_b32 v131, 0xffff0000, v17
    v_lshlrev_b32 v132, 16, v18
    v_and_b32 v133, 0xffff0000, v18
    v_lshlrev_b32 v134, 16, v19
    v_and_b32 v135, 0xffff0000, v19
    v_lshlrev_b32 v136, 16, v52
    v_and_b32 v137, 0xffff0000, v52
    v_lshlrev_b32 v138, 16, v53
    v_and_b32 v139, 0xffff0000, v53
    v_lshlrev_b32 v140, 16, v54
    v_and_b32 v141, 0xffff0000, v54
    v_lshlrev_b32 v142, 16, v55
    v_and_b32 v143, 0xffff0000, v55
    v_lshlrev_b32 v144, 16, v88
    v_and_b32 v145, 0xffff0000, v88
    v_lshlrev_b32 v146, 16, v89
    v_and_b32 v147, 0xffff0000, v89
    v_lshlrev_b32 v148, 16, v90
    v_and_b32 v149, 0xffff0000, v90
    v_lshlrev_b32 v150, 16, v91
    v_and_b32 v151, 0xffff0000, v91
    v_mov_b32 v12, 0x3f80
    v_mov_b32 v13, 0x3f800000
    s_waitcnt vmcnt(23)
    v_dot2c_f32_bf16 v128, v20, v12
    v_dot2c_f32_bf16 v129, v20, v13
    v_dot2c_f32_bf16 v130, v21, v12
    v_dot2c_f32_bf16 v131, v21, v13
    v_dot2c_f32_bf16 v132, v22, v12
    v_dot2c_f32_bf16 v133, v22, v13
    v_dot2c_f32_bf16 v134, v23, v12
    v_dot2c_f32_bf16 v135, v23, v13
    s_waitcnt vmcnt(22)
    v_dot2c_f32_bf16 v136, v56, v12
    v_dot2c_f32_bf16 v137, v56, v13
    v_dot2c_f32_bf16 v138, v57, v12
    v_dot2c_f32_bf16 v139, v57, v13
    v_dot2c_f32_bf16 v140, v58, v12
    v_dot2c_f32_bf16 v141, v58, v13
    v_dot2c_f32_bf16 v142, v59, v12
    v_dot2c_f32_bf16 v143, v59, v13
    s_waitcnt vmcnt(21)
    v_dot2c_f32_bf16 v144, v92, v12
    v_dot2c_f32_bf16 v145, v92, v13
    v_dot2c_f32_bf16 v146, v93, v12
    v_dot2c_f32_bf16 v147, v93, v13
    v_dot2c_f32_bf16 v148, v94, v12
    v_dot2c_f32_bf16 v149, v94, v13
    v_dot2c_f32_bf16 v150, v95, v12
    v_dot2c_f32_bf16 v151, v95, v13
    s_waitcnt vmcnt(20)
    v_dot2c_f32_bf16 v128, v24, v12
    v_dot2c_f32_bf16 v129, v24, v13
    v_dot2c_f32_bf16 v130, v25, v12
    v_dot2c_f32_bf16 v131, v25, v13
    v_dot2c_f32_bf16 v132, v26, v12
    v_dot2c_f32_bf16 v133, v26, v13
    v_dot2c_f32_bf16 v134, v27, v12
    v_dot2c_f32_bf16 v135, v27, v13
    s_waitcnt vmcnt(19)
    v_dot2c_f32_bf16 v136, v60, v12
    v_dot2c_f32_bf16 v137, v60, v13
    v_dot2c_f32_bf16 v138, v61, v12
    v_dot2c_f32_bf16 v139, v61, v13
    v_dot2c_f32_bf16 v140, v62, v12
    v_dot2c_f32_bf16 v141, v62, v13
    v_dot2c_f32_bf16 v142, v63, v12
    v_dot2c_f32_bf16 v143, v63, v13
    s_waitcnt vmcnt(18)
    v_dot2c_f32_bf16 v144, v96, v12
    v_dot2c_f32_bf16 v145, v96, v13
    v_dot2c_f32_bf16 v146, v97, v12
    v_dot2c_f32_bf16 v147, v97, v13
    v_dot2c_f32_bf16 v148, v98, v12
    v_dot2c_f32_bf16 v149, v98, v13
    v_dot2c_f32_bf16 v150, v99, v12
    v_dot2c_f32_bf16 v151, v99, v13
    s_waitcnt vmcnt(17)
    v_dot2c_f32_bf16 v128, v28, v12
    v_dot2c_f32_bf16 v129, v28, v13
    v_dot2c_f32_bf16 v130, v29, v12
    v_dot2c_f32_bf16 v131, v29, v13
    v_dot2c_f32_bf16 v132, v30, v12
    v_dot2c_f32_bf16 v133, v30, v13
    v_dot2c_f32_bf16 v134, v31, v12
    v_dot2c_f32_bf16 v135, v31, v13
    s_waitcnt vmcnt(16)
    v_dot2c_f32_bf16 v136, v64, v12
    v_dot2c_f32_bf16 v137, v64, v13
    v_dot2c_f32_bf16 v138, v65, v12
    v_dot2c_f32_bf16 v139, v65, v13
    v_dot2c_f32_bf16 v140, v66, v12
    v_dot2c_f32_bf16 v141, v66, v13
    v_dot2c_f32_bf16 v142, v67, v12
    v_dot2c_f32_bf16 v143, v67, v13
    s_waitcnt vmcnt(15)
    v_dot2c_f32_bf16 v144, v100, v12
    v_dot2c_f32_bf16 v145, v100, v13
    v_dot2c_f32_bf16 v146, v101, v12
    v_dot2c_f32_bf16 v147, v101, v13
    v_dot2c_f32_bf16 v148, v102, v12
    v_dot2c_f32_bf16 v149, v102, v13
    v_dot2c_f32_bf16 v150, v103, v12
    v_dot2c_f32_bf16 v151, v103, v13
    s_waitcnt vmcnt(14)
    v_dot2c_f32_bf16 v128, v32, v12
    v_dot2c_f32_bf16 v129, v32, v13
    v_dot2c_f32_bf16 v130, v33, v12
    v_dot2c_f32_bf16 v131, v33, v13
    v_dot2c_f32_bf16 v132, v34, v12
    v_dot2c_f32_bf16 v133, v34, v13
    v_dot2c_f32_bf16 v134, v35, v12
    v_dot2c_f32_bf16 v135, v35, v13
    s_waitcnt vmcnt(13)
    v_dot2c_f32_bf16 v136, v68, v12
    v_dot2c_f32_bf16 v137, v68, v13
    v_dot2c_f32_bf16 v138, v69, v12
    v_dot2c_f32_bf16 v139, v69, v13
    v_dot2c_f32_bf16 v140, v70, v12
    v_dot2c_f32_bf16 v141, v70, v13
    v_dot2c_f32_bf16 v142, v71, v12
    v_dot2c_f32_bf16 v143, v71, v13
    s_waitcnt vmcnt(12)
    v_dot2c_f32_bf16 v144, v104, v12
    v_dot2c_f32_bf16 v145, v104, v13
    v_dot2c_f32_bf16 v146, v105, v12
    v_dot2c_f32_bf16 v147, v105, v13
    v_dot2c_f32_bf16 v148, v106, v12
    v_dot2c_f32_bf16 v149, v106, v13
    v_dot2c_f32_bf16 v150, v107, v12
    v_dot2c_f32_bf16 v151, v107, v13
    s_waitcnt vmcnt(11)
    v_dot2c_f32_bf16 v128, v36, v12
    v_dot2c_f32_bf16 v129, v36, v13
    v_dot2c_f32_bf16 v130, v37, v12
    v_dot2c_f32_bf16 v131, v37, v13
    v_dot2c_f32_bf16 v132, v38, v12
    v_dot2c_f32_bf16 v133, v38, v13
    v_dot2c_f32_bf16 v134, v39, v12
    v_dot2c_f32_bf16 v135, v39, v13
    s_waitcnt vmcnt(10)
    v_dot2c_f32_bf16 v136, v72, v12
    v_dot2c_f32_bf16 v137, v72, v13
    v_dot2c_f32_bf16 v138, v73, v12
    v_dot2c_f32_bf16 v139, v73, v13
    v_dot2c_f32_bf16 v140, v74, v12
    v_dot2c_f32_bf16 v141, v74, v13
    v_dot2c_f32_bf16 v142, v75, v12
    v_dot2c_f32_bf16 v143, v75, v13
    s_waitcnt vmcnt(9)
    v_dot2c_f32_bf16 v144, v108, v12
    v_dot2c_f32_bf16 v145, v108, v13
    v_dot2c_f32_bf16 v146, v109, v12
    v_dot2c_f32_bf16 v147, v109, v13
    v_dot2c_f32_bf16 v148, v110, v12
    v_dot2c_f32_bf16 v149, v110, v13
    v_dot2c_f32_bf16 v150, v111, v12
    v_dot2c_f32_bf16 v151, v111, v13
    s_waitcnt vmcnt(8)
    v_dot2c_f32_bf16 v128, v40, v12
    v_dot2c_f32_bf16 v129, v40, v13
    v_dot2c_f32_bf16 v130, v41, v12
    v_dot2c_f32_bf16 v131, v41, v13
    v_dot2c_f32_bf16 v132, v42, v12
    v_dot2c_f32_bf16 v133, v42, v13
    v_dot2c_f32_bf16 v134, v43, v12
    v_dot2c_f32_bf16 v135, v43, v13
    s_waitcnt vmcnt(7)
    v_dot2c_f32_bf16 v136, v76, v12
    v_dot2c_f32_bf16 v137, v76, v13
    v_dot2c_f32_bf16 v138, v77, v12
    v_dot2c_f32_bf16 v139, v77, v13
    v_dot2c_f32_bf16 v140, v78, v12
    v_dot2c_f32_bf16 v141, v78, v13
    v_dot2c_f32_bf16 v142, v79, v12
    v_dot2c_f32_bf16 v143, v79, v13
    s_waitcnt vmcnt(6)
    v_dot2c_f32_bf16 v144, v112, v12
    v_dot2c_f32_bf16 v145, v112, v13
    v_dot2c_f32_bf16 v146, v113, v12
    v_dot2c_f32_bf16 v147, v113, v13
    v_dot2c_f32_bf16 v148, v114, v12
    v_dot2c_f32_bf16 v149, v114, v13
    v_dot2c_f32_bf16 v150, v115, v12
    v_dot2c_f32_bf16 v151, v115, v13
    s_waitcnt vmcnt(5)
    v_dot2c_f32_bf16 v128, v44, v12
    v_dot2c_f32_bf16 v129, v44, v13
    v_dot2c_f32_bf16 v130, v45, v12
    v_dot2c_f32_bf16 v131, v45, v13
    v_dot2c_f32_bf16 v132, v46, v12
    v_dot2c_f32_bf16 v133, v46, v13
    v_dot2c_f32_bf16 v134, v47, v12
    v_dot2c_f32_bf16 v135, v47, v13
    s_waitcnt vmcnt(4)
    v_dot2c_f32_bf16 v136, v80, v12
    v_dot2c_f32_bf16 v137, v80, v13
    v_dot2c_f32_bf16 v138, v81, v12
    v_dot2c_f32_bf16 v139, v81, v13
    v_dot2c_f32_bf16 v140, v82, v12
    v_dot2c_f32_bf16 v141, v82, v13
    v_dot2c_f32_bf16 v142, v83, v12
    v_dot2c_f32_bf16 v143, v83, v13
    s_waitcnt vmcnt(3)
    v_dot2c_f32_bf16 v144, v116, v12
    v_dot2c_f32_bf16 v145, v116, v13
    v_dot2c_f32_bf16 v146, v117, v12
    v_dot2c_f32_bf16 v147, v117, v13
    v_dot2c_f32_bf16 v148, v118, v12
    v_dot2c_f32_bf16 v149, v118, v13
    v_dot2c_f32_bf16 v150, v119, v12
    v_dot2c_f32_bf16 v151, v119, v13
    s_waitcnt vmcnt(2)
    v_dot2c_f32_bf16 v128, v48, v12
    v_dot2c_f32_bf16 v129, v48, v13
    v_dot2c_f32_bf16 v130, v49, v12
    v_dot2c_f32_bf16 v131, v49, v13
    v_dot2c_f32_bf16 v132, v50, v12
    v_dot2c_f32_bf16 v133, v50, v13
    v_dot2c_f32_bf16 v134, v51, v12
    v_dot2c_f32_bf16 v135, v51, v13
    s_waitcnt vmcnt(1)
    v_dot2c_f32_bf16 v136, v84, v12
    v_dot2c_f32_bf16 v137, v84, v13
    v_dot2c_f32_bf16 v138, v85, v12
    v_dot2c_f32_bf16 v139, v85, v13
    v_dot2c_f32_bf16 v140, v86, v12
    v_dot2c_f32_bf16 v141, v86, v13
    v_dot2c_f32_bf16 v142, v87, v12
    v_dot2c_f32_bf16 v143, v87, v13
    s_waitcnt vmcnt(0)
    v_dot2c_f32_bf16 v144, v120, v12
    v_dot2c_f32_bf16 v145, v120, v13
    v_dot2c_f32_bf16 v146, v121, v12
    v_dot2c_f32_bf16 v147, v121, v13
    v_dot2c_f32_bf16 v148, v122, v12
    v_dot2c_f32_bf16 v149, v122, v13
    v_dot2c_f32_bf16 v150, v123, v12
    v_dot2c_f32_bf16 v151, v123, v13
    s_add_u32 s16, s42, 28311552
    s_addc_u32 s17, s43, 0
    s_mov_b32 s18, 0x240000
    s_mov_b32 s19, 0x20000
    v_cvt_pk_bf16_f32 v160, v128, v129
    v_cvt_pk_bf16_f32 v161, v130, v131
    v_cvt_pk_bf16_f32 v162, v132, v133
    v_cvt_pk_bf16_f32 v163, v134, v135
    buffer_store_dwordx4 v[160:163], v3, s[16:19], 0 offen offset:0 sc1
    v_cvt_pk_bf16_f32 v164, v136, v137
    v_cvt_pk_bf16_f32 v165, v138, v139
    v_cvt_pk_bf16_f32 v166, v140, v141
    v_cvt_pk_bf16_f32 v167, v142, v143
    buffer_store_dwordx4 v[164:167], v3, s[16:19], 0 offen offset:128 sc1
    v_cvt_pk_bf16_f32 v168, v144, v145
    v_cvt_pk_bf16_f32 v169, v146, v147
    v_cvt_pk_bf16_f32 v170, v148, v149
    v_cvt_pk_bf16_f32 v171, v150, v151
    buffer_store_dwordx4 v[168:171], v3, s[16:19], 0 offen offset:256 sc1
    v_lshlrev_b32 v128, 16, v160
    v_and_b32 v129, 0xffff0000, v160
    v_lshlrev_b32 v130, 16, v161
    v_and_b32 v131, 0xffff0000, v161
    v_lshlrev_b32 v132, 16, v162
    v_and_b32 v133, 0xffff0000, v162
    v_lshlrev_b32 v134, 16, v163
    v_and_b32 v135, 0xffff0000, v163
    v_lshlrev_b32 v136, 16, v164
    v_and_b32 v137, 0xffff0000, v164
    v_lshlrev_b32 v138, 16, v165
    v_and_b32 v139, 0xffff0000, v165
    v_lshlrev_b32 v140, 16, v166
    v_and_b32 v141, 0xffff0000, v166
    v_lshlrev_b32 v142, 16, v167
    v_and_b32 v143, 0xffff0000, v167
    v_lshlrev_b32 v144, 16, v168
    v_and_b32 v145, 0xffff0000, v168
    v_lshlrev_b32 v146, 16, v169
    v_and_b32 v147, 0xffff0000, v169
    v_lshlrev_b32 v148, 16, v170
    v_and_b32 v149, 0xffff0000, v170
    v_lshlrev_b32 v150, 16, v171
    v_and_b32 v151, 0xffff0000, v171
    v_add_f32 v152, v128, v129
    v_add_f32 v8, v130, v131
    v_add_f32 v152, v152, v132
    v_add_f32 v8, v8, v133
    v_add_f32 v152, v152, v134
    v_add_f32 v8, v8, v135
    v_add_f32 v152, v152, v136
    v_add_f32 v8, v8, v137
    v_add_f32 v152, v152, v138
    v_add_f32 v8, v8, v139
    v_add_f32 v152, v152, v140
    v_add_f32 v8, v8, v141
    v_add_f32 v152, v152, v142
    v_add_f32 v8, v8, v143
    v_add_f32 v152, v152, v144
    v_add_f32 v8, v8, v145
    v_add_f32 v152, v152, v146
    v_add_f32 v8, v8, v147
    v_add_f32 v152, v152, v148
    v_add_f32 v8, v8, v149
    v_add_f32 v152, v152, v150
    v_add_f32 v8, v8, v151
    v_add_f32 v152, v152, v8
    s_nop 1
    v_add_f32_dpp v152, v152, v152 row_ror:8 row_mask:0xf bank_mask:0xf
    v_mov_b32 v8, v152
    s_nop 1
    v_permlane16_swap_b32 v152, v8
    v_add_f32 v152, v152, v8
    v_mov_b32 v8, v152
    s_nop 1
    v_permlane32_swap_b32 v152, v8
    v_add_f32 v152, v152, v8
    v_mul_f32 v9, 0x3baaaaab, v152
    v_sub_f32 v8, v128, v9
    v_mul_f32 v153, v8, v8
    v_sub_f32 v11, v129, v9
    v_fmac_f32 v153, v11, v11
    v_sub_f32 v10, v130, v9
    v_fmac_f32 v153, v10, v10
    v_sub_f32 v11, v131, v9
    v_fmac_f32 v153, v11, v11
    v_sub_f32 v10, v132, v9
    v_fmac_f32 v153, v10, v10
    v_sub_f32 v11, v133, v9
    v_fmac_f32 v153, v11, v11
    v_sub_f32 v10, v134, v9
    v_fmac_f32 v153, v10, v10
    v_sub_f32 v11, v135, v9
    v_fmac_f32 v153, v11, v11
    v_sub_f32 v10, v136, v9
    v_fmac_f32 v153, v10, v10
    v_sub_f32 v11, v137, v9
    v_fmac_f32 v153, v11, v11
    v_sub_f32 v10, v138, v9
    v_fmac_f32 v153, v10, v10
    v_sub_f32 v11, v139, v9
    v_fmac_f32 v153, v11, v11
    v_sub_f32 v10, v140, v9
    v_fmac_f32 v153, v10, v10
    v_sub_f32 v11, v141, v9
    v_fmac_f32 v153, v11, v11
    v_sub_f32 v10, v142, v9
    v_fmac_f32 v153, v10, v10
    v_sub_f32 v11, v143, v9
    v_fmac_f32 v153, v11, v11
    v_sub_f32 v10, v144, v9
    v_fmac_f32 v153, v10, v10
    v_sub_f32 v11, v145, v9
    v_fmac_f32 v153, v11, v11
    v_sub_f32 v10, v146, v9
    v_fmac_f32 v153, v10, v10
    v_sub_f32 v11, v147, v9
    v_fmac_f32 v153, v11, v11
    v_sub_f32 v10, v148, v9
    v_fmac_f32 v153, v10, v10
    v_sub_f32 v11, v149, v9
    v_fmac_f32 v153, v11, v11
    v_sub_f32 v10, v150, v9
    v_fmac_f32 v153, v10, v10
    v_sub_f32 v11, v151, v9
    v_fmac_f32 v153, v11, v11
    s_nop 1
    v_add_f32_dpp v153, v153, v153 row_ror:8 row_mask:0xf bank_mask:0xf
    v_mov_b32 v8, v153
    s_nop 1
    v_permlane16_swap_b32 v153, v8
    v_add_f32 v153, v153, v8
    v_mov_b32 v8, v153
    s_nop 1
    v_permlane32_swap_b32 v153, v8
    v_add_f32 v153, v153, v8
    v_and_b32 v8, 7, v1
    s_mul_i32 s46, s20, 64
    s_add_u32 s46, s46, 160896
    v_lshl_add_u32 v8, v8, 3, s46
    ds_write_b64 v8, v[152:153]
    s_waitcnt lgkmcnt(0)
    s_branch L_join_95
L_w3a_91:
    s_and_b32 s44, s22, 15
    s_mul_i32 s44, s44, 129024
    s_add_u32 s44, s44, 0
    s_mov_b32 m0, 18432
    s_add_u32 s45, s44, 0
    buffer_load_dwordx4 v2, s[4:7], s45 offen offset:0 lds
    buffer_load_dwordx4 v2, s[4:7], s45 offen offset:1024 lds
    buffer_load_dwordx4 v2, s[4:7], s45 offen offset:2048 lds
    buffer_load_dwordx4 v2, s[4:7], s45 offen offset:3072 lds
    s_mov_b32 m0, 22528
    s_add_u32 s45, s44, 4096
    buffer_load_dwordx4 v2, s[4:7], s45 offen offset:0 lds
    buffer_load_dwordx4 v2, s[4:7], s45 offen offset:1024 lds
    buffer_load_dwordx4 v2, s[4:7], s45 offen offset:2048 lds
    buffer_load_dwordx4 v2, s[4:7], s45 offen offset:3072 lds
    s_mov_b32 m0, 26624
    s_add_u32 s45, s44, 8192
    buffer_load_dwordx4 v2, s[4:7], s45 offen offset:0 lds
    buffer_load_dwordx4 v2, s[4:7], s45 offen offset:1024 lds
    buffer_load_dwordx4 v2, s[4:7], s45 offen offset:2048 lds
    buffer_load_dwordx4 v2, s[4:7], s45 offen offset:3072 lds
    s_mov_b32 m0, 30720
    s_add_u32 s45, s44, 12288
    buffer_load_dwordx4 v2, s[4:7], s45 offen offset:0 lds
    buffer_load_dwordx4 v2, s[4:7], s45 offen offset:1024 lds
    buffer_load_dwordx4 v2, s[4:7], s45 offen offset:2048 lds
    buffer_load_dwordx4 v2, s[4:7], s45 offen offset:3072 lds
    s_mov_b32 m0, 34816
    s_add_u32 s45, s44, 16384
    buffer_load_dwordx4 v2, s[4:7], s45 offen offset:0 lds
    buffer_load_dwordx4 v2, s[4:7], s45 offen offset:1024 lds
    buffer_load_dwordx4 v2, s[4:7], s45 offen offset:2048 lds
    buffer_load_dwordx4 v2, s[4:7], s45 offen offset:3072 lds
    s_mov_b32 m0, 38912
    s_add_u32 s45, s44, 20480
    buffer_load_dwordx4 v2, s[4:7], s45 offen offset:0 lds
    buffer_load_dwordx4 v2, s[4:7], s45 offen offset:1024 lds
    buffer_load_dwordx4 v2, s[4:7], s45 offen offset:2048 lds
    buffer_load_dwordx4 v2, s[4:7], s45 offen offset:3072 lds
    s_mov_b32 m0, 43008
    s_add_u32 s45, s44, 24576
    buffer_load_dwordx4 v2, s[4:7], s45 offen offset:0 lds
    buffer_load_dwordx4 v2, s[4:7], s45 offen offset:1024 lds
    buffer_load_dwordx4 v2, s[4:7], s45 offen offset:2048 lds
    buffer_load_dwordx4 v2, s[4:7], s45 offen offset:3072 lds
    s_mov_b32 m0, 47104
    s_add_u32 s45, s44, 28672
    buffer_load_dwordx4 v2, s[4:7], s45 offen offset:0 lds
    buffer_load_dwordx4 v2, s[4:7], s45 offen offset:1024 lds
    buffer_load_dwordx4 v2, s[4:7], s45 offen offset:2048 lds
    buffer_load_dwordx4 v2, s[4:7], s45 offen offset:3072 lds
    s_mov_b32 m0, 51200
    s_add_u32 s45, s44, 32768
    buffer_load_dwordx4 v2, s[4:7], s45 offen offset:0 lds
    buffer_load_dwordx4 v2, s[4:7], s45 offen offset:1024 lds
    buffer_load_dwordx4 v2, s[4:7], s45 offen offset:2048 lds
    buffer_load_dwordx4 v2, s[4:7], s45 offen offset:3072 lds
L_join_95:
    s_barrier
    s_cmp_eq_u32 s20, 3
    s_cbranch_scc1 L_w3b_96
    v_and_b32 v8, 7, v1
    v_lshlrev_b32 v8, 3, v8
    v_add_u32 v8, 160896, v8
    ds_read_b64 v[152:153], v8 offset:0
    ds_read_b64 v[154:155], v8 offset:64
    ds_read_b64 v[156:157], v8 offset:128
    s_waitcnt lgkmcnt(1)
    v_add_f32 v8, v152, v154
    s_waitcnt lgkmcnt(0)
    v_add_f32 v8, v8, v156
    v_mul_f32 v8, 0x3ae38e39, v8
    v_add_f32 v9, v153, v155
    v_add_f32 v9, v9, v157
    v_mul_f32 v10, 0x3baaaaab, v152
    v_sub_f32 v10, v10, v8
    v_mul_f32 v10, v10, v10
    v_fmac_f32 v9, 0x43400000, v10
    v_mul_f32 v10, 0x3baaaaab, v154
    v_sub_f32 v10, v10, v8
    v_mul_f32 v10, v10, v10
    v_fmac_f32 v9, 0x43400000, v10
    v_mul_f32 v10, 0x3baaaaab, v156
    v_sub_f32 v10, v10, v8
    v_mul_f32 v10, v10, v10
    v_fmac_f32 v9, 0x43400000, v10
    v_mul_f32 v9, 0x3ae38e39, v9
    v_cvt_pk_bf16_f32 v9, v9, v9
    v_lshlrev_b32 v9, 16, v9
    v_add_f32 v9, 0x3727c5ac, v9
    v_cvt_pk_bf16_f32 v9, v9, v9
    v_lshlrev_b32 v9, 16, v9
    v_sqrt_f32 v9, v9
    s_nop 0
    v_cvt_pk_bf16_f32 v9, v9, v9
    v_lshlrev_b32 v9, 16, v9
    v_rcp_f32 v9, v9
    v_cvt_pk_bf16_f32 v8, v8, v8
    v_lshlrev_b32 v8, 16, v8
    v_sub_f32 v128, v128, v8
    v_sub_f32 v129, v129, v8
    v_cvt_pk_bf16_f32 v10, v128, v129
    v_lshlrev_b32 v128, 16, v10
    v_and_b32 v129, 0xffff0000, v10
    v_mul_f32 v128, v128, v9
    v_mul_f32 v129, v129, v9
    v_cvt_pk_bf16_f32 v16, v128, v129
    v_sub_f32 v130, v130, v8
    v_sub_f32 v131, v131, v8
    v_cvt_pk_bf16_f32 v10, v130, v131
    v_lshlrev_b32 v130, 16, v10
    v_and_b32 v131, 0xffff0000, v10
    v_mul_f32 v130, v130, v9
    v_mul_f32 v131, v131, v9
    v_cvt_pk_bf16_f32 v17, v130, v131
    v_sub_f32 v132, v132, v8
    v_sub_f32 v133, v133, v8
    v_cvt_pk_bf16_f32 v10, v132, v133
    v_lshlrev_b32 v132, 16, v10
    v_and_b32 v133, 0xffff0000, v10
    v_mul_f32 v132, v132, v9
    v_mul_f32 v133, v133, v9
    v_cvt_pk_bf16_f32 v18, v132, v133
    v_sub_f32 v134, v134, v8
    v_sub_f32 v135, v135, v8
    v_cvt_pk_bf16_f32 v10, v134, v135
    v_lshlrev_b32 v134, 16, v10
    v_and_b32 v135, 0xffff0000, v10
    v_mul_f32 v134, v134, v9
    v_mul_f32 v135, v135, v9
    v_cvt_pk_bf16_f32 v19, v134, v135
    v_sub_f32 v136, v136, v8
    v_sub_f32 v137, v137, v8
    v_cvt_pk_bf16_f32 v10, v136, v137
    v_lshlrev_b32 v136, 16, v10
    v_and_b32 v137, 0xffff0000, v10
    v_mul_f32 v136, v136, v9
    v_mul_f32 v137, v137, v9
    v_cvt_pk_bf16_f32 v20, v136, v137
    v_sub_f32 v138, v138, v8
    v_sub_f32 v139, v139, v8
    v_cvt_pk_bf16_f32 v10, v138, v139
    v_lshlrev_b32 v138, 16, v10
    v_and_b32 v139, 0xffff0000, v10
    v_mul_f32 v138, v138, v9
    v_mul_f32 v139, v139, v9
    v_cvt_pk_bf16_f32 v21, v138, v139
    v_sub_f32 v140, v140, v8
    v_sub_f32 v141, v141, v8
    v_cvt_pk_bf16_f32 v10, v140, v141
    v_lshlrev_b32 v140, 16, v10
    v_and_b32 v141, 0xffff0000, v10
    v_mul_f32 v140, v140, v9
    v_mul_f32 v141, v141, v9
    v_cvt_pk_bf16_f32 v22, v140, v141
    v_sub_f32 v142, v142, v8
    v_sub_f32 v143, v143, v8
    v_cvt_pk_bf16_f32 v10, v142, v143
    v_lshlrev_b32 v142, 16, v10
    v_and_b32 v143, 0xffff0000, v10
    v_mul_f32 v142, v142, v9
    v_mul_f32 v143, v143, v9
    v_cvt_pk_bf16_f32 v23, v142, v143
    v_sub_f32 v144, v144, v8
    v_sub_f32 v145, v145, v8
    v_cvt_pk_bf16_f32 v10, v144, v145
    v_lshlrev_b32 v144, 16, v10
    v_and_b32 v145, 0xffff0000, v10
    v_mul_f32 v144, v144, v9
    v_mul_f32 v145, v145, v9
    v_cvt_pk_bf16_f32 v24, v144, v145
    v_sub_f32 v146, v146, v8
    v_sub_f32 v147, v147, v8
    v_cvt_pk_bf16_f32 v10, v146, v147
    v_lshlrev_b32 v146, 16, v10
    v_and_b32 v147, 0xffff0000, v10
    v_mul_f32 v146, v146, v9
    v_mul_f32 v147, v147, v9
    v_cvt_pk_bf16_f32 v25, v146, v147
    v_sub_f32 v148, v148, v8
    v_sub_f32 v149, v149, v8
    v_cvt_pk_bf16_f32 v10, v148, v149
    v_lshlrev_b32 v148, 16, v10
    v_and_b32 v149, 0xffff0000, v10
    v_mul_f32 v148, v148, v9
    v_mul_f32 v149, v149, v9
    v_cvt_pk_bf16_f32 v26, v148, v149
    v_sub_f32 v150, v150, v8
    v_sub_f32 v151, v151, v8
    v_cvt_pk_bf16_f32 v10, v150, v151
    v_lshlrev_b32 v150, 16, v10
    v_and_b32 v151, 0xffff0000, v10
    v_mul_f32 v150, v150, v9
    v_mul_f32 v151, v151, v9
    v_cvt_pk_bf16_f32 v27, v150, v151
    s_mov_b32 s46, 71303168
    buffer_store_dwordx4 v[16:19], v4, s[4:7], s46 offen offset:0 sc1
    buffer_store_dwordx4 v[20:23], v4, s[4:7], s46 offen offset:2048 sc1
    s_add_u32 s46, s46, 4096
    buffer_store_dwordx4 v[24:27], v4, s[4:7], s46 offen offset:0 sc1
    s_lshl_b32 s46, s47, 2
    s_add_u32 s46, s46, s20
    s_lshl_b32 s46, s46, 3
    s_add_u32 s46, s46, 3940352
    v_mov_b32 v8, s98
    v_mov_b32 v9, s99
    s_waitcnt vmcnt(0)
    s_mov_b64 exec, 1
    buffer_store_dwordx2 v[8:9], off, s[4:7], s46 sc1
    s_mov_b64 exec, -1
L_w3b_96:
    s_lshr_b32 s44, s22, 4
    s_lshl_b32 s52, s21, 1
    s_add_u32 s44, s44, s52
    s_and_b32 s45, s22, 15
    s_mul_i32 s48, s20, 21
    s_lshr_b32 s48, s48, 1
    s_lshl_b32 s48, s48, 10
    s_mul_i32 s47, s45, 129024
    s_add_u32 s47, s47, s48
    s_add_u32 s47, s47, 0
    s_lshl_b32 s46, s44, 3
    s_max_u32 s52, s46, 1
    s_sub_u32 s52, s52, 1
    s_mul_i32 s49, s52, 18432
    s_mul_i32 s50, s20, 9
    s_lshr_b32 s50, s50, 1
    s_lshl_b32 s50, s50, 10
    s_add_u32 s49, s49, s50
    s_add_u32 s49, s49, 71303168
    s_add_u32 s50, s50, 0
    s_lshl_b32 s54, s52, 6
    s_lshl_b32 s52, s20, 1
    s_add_u32 s46, s46, s52
    s_mul_i32 s51, s46, 18432
    s_add_u32 s51, s51, 71303168
    s_lshl_b32 s55, s46, 6
    v_and_b32 v6, 3, v1
    v_min_u32 v6, 2, v6
    v_and_b32 v7, 12, v1
    v_add_lshl_u32 v8, v6, v7, 3
    v_add_u32 v8, s55, v8
    v_and_b32 v7, 4, v1
    v_add_lshl_u32 v9, v6, v7, 3
    v_add_u32 v9, s54, v9
    v_and_b32 v7, 16, v1
    v_cmp_eq_u32 vcc, 0, v7
    s_nop 1
    v_cndmask_b32 v8, v9, v8, vcc
    s_min_u32 s52, s22, 23
    s_mul_i32 s52, s52, 10923
    s_lshr_b32 s52, s52, 16
    s_lshl_b32 s53, s21, 2
    s_add_u32 s52, s52, s53
    s_lshl_b32 s52, s52, 2
    s_add_u32 s52, s52, s20
    s_lshl_b32 s52, s52, 6
    v_and_b32 v7, 4, v1
    v_add_lshl_u32 v7, v6, v7, 3
    v_add_u32 v7, s52, v7
    v_cmp_gt_u32 vcc, 32, v1
    s_nop 1
    v_cndmask_b32 v8, v7, v8, vcc
    s_mov_b32 s52, 3940352
    s_min_u32 s56, s20, 2
    s_add_u32 s57, s56, 2
    s_and_b32 s56, s20, 1
    s_add_u32 s56, s56, 4
    s_cmp_ge_u32 s20, 2
    s_cselect_b32 s57, 6, s57
    s_lshl_b32 s57, s57, 10
    s_lshl_b32 s56, s56, 10
    v_add_u32 v3, 18432, v2
    v_add_u32 v4, s57, v3
    v_add_u32 v5, s56, v3
    v_add_u32 v10, 0, v2
    s_waitcnt vmcnt(0)
    s_waitcnt vmcnt(0)
    s_barrier
    ds_read_b128 v[88:91], v3 offset:0
    ds_read_b128 v[92:95], v3 offset:1024
    ds_read_b128 v[96:99], v3 offset:2048
    ds_read_b128 v[100:103], v3 offset:3072
    ds_read_b128 v[112:115], v3 offset:6144
    ds_read_b128 v[104:107], v3 offset:4096
    ds_read_b128 v[108:111], v3 offset:5120
    v_mov_b32 v11, v8
    s_mov_b32 s23, s52
    buffer_load_dwordx2 v[12:13], v11, s[4:7], s23 offen sc1
    v_and_b32 v6, 15, v1
    v_lshrrev_b32 v7, 4, v1
    v_lshlrev_b32 v7, 2, v7
    v_sub_u32 v6, v6, v7
    v_mov_b32 v8, 0xf149f2ca
    s_or_b32 s52, s44, s20
    s_cmp_eq_u32 s52, 0
    s_cselect_b64 s[56:57], -1, 0
    v_subrev_u32 v7, 0, v6
    v_and_b32 v9, 0xfffffff1, v7
    v_cmp_eq_u32 vcc, 0, v9
    v_add_u32 v7, 16, v7
    v_and_b32 v9, 0xfffffff1, v7
    v_cndmask_b32_e64 v168, v8, 0, vcc
    v_cmp_eq_u32 vcc, 0, v9
    s_nop 1
    v_cndmask_b32_e64 v172, v8, 0, vcc
    v_cndmask_b32_e64 v176, v172, v8, s[56:57]
    v_subrev_u32 v7, 1, v6
    v_and_b32 v9, 0xfffffff1, v7
    v_cmp_eq_u32 vcc, 0, v9
    v_add_u32 v7, 16, v7
    v_and_b32 v9, 0xfffffff1, v7
    v_cndmask_b32_e64 v169, v8, 0, vcc
    v_cmp_eq_u32 vcc, 0, v9
    s_nop 1
    v_cndmask_b32_e64 v173, v8, 0, vcc
    v_cndmask_b32_e64 v177, v173, v8, s[56:57]
    v_subrev_u32 v7, 2, v6
    v_and_b32 v9, 0xfffffff1, v7
    v_cmp_eq_u32 vcc, 0, v9
    v_add_u32 v7, 16, v7
    v_and_b32 v9, 0xfffffff1, v7
    v_cndmask_b32_e64 v170, v8, 0, vcc
    v_cmp_eq_u32 vcc, 0, v9
    s_nop 1
    v_cndmask_b32_e64 v174, v8, 0, vcc
    v_cndmask_b32_e64 v178, v174, v8, s[56:57]
    v_subrev_u32 v7, 3, v6
    v_and_b32 v9, 0xfffffff1, v7
    v_cmp_eq_u32 vcc, 0, v9
    v_add_u32 v7, 16, v7
    v_and_b32 v9, 0xfffffff1, v7
    v_cndmask_b32_e64 v171, v8, 0, vcc
    v_cmp_eq_u32 vcc, 0, v9
    s_nop 1
    v_cndmask_b32_e64 v175, v8, 0, vcc
    v_cndmask_b32_e64 v179, v175, v8, s[56:57]
    s_mul_i32 s53, s45, 2304
    s_add_u32 s53, s53, s51
    s_waitcnt vmcnt(0)
    v_cmp_eq_u64 vcc, s[98:99], v[12:13]
    s_nop 0
    s_cmp_eq_u64 vcc, exec
    s_cbranch_scc0 L_px_slow_97
L_px_back_98:
    s_add_u32 s54, s51, 0
    buffer_load_dwordx4 a[0:3], v2, s[4:7], s54 offen offset:0 sc1
    s_add_u32 s55, s51, 18432
    buffer_load_dwordx4 a[72:75], v2, s[4:7], s55 offen offset:0 sc1
    buffer_load_dwordx4 a[4:7], v2, s[4:7], s54 offen offset:1024 sc1
    buffer_load_dwordx4 a[76:79], v2, s[4:7], s55 offen offset:1024 sc1
    buffer_load_dwordx4 a[8:11], v2, s[4:7], s54 offen offset:2048 sc1
    buffer_load_dwordx4 a[80:83], v2, s[4:7], s55 offen offset:2048 sc1
    s_waitcnt vmcnt(5) lgkmcnt(6)
    s_add_u32 m0, s50, 0
    s_add_u32 s53, s49, 0
    v_mfma_f32_16x16x32_bf16 v[16:19], v[88:91], a[0:3], 0
    buffer_load_dwordx4 v2, s[4:7], s53 offen offset:0 sc1 lds
    s_waitcnt vmcnt(5)
    v_mfma_f32_16x16x32_bf16 v[48:51], v[88:91], a[72:75], 0
    buffer_load_dwordx4 v2, s[4:7], s53 offen offset:1024 sc1 lds
    buffer_load_dwordx4 v2, s[4:7], s53 offen offset:2048 sc1 lds
    buffer_load_dwordx4 v2, s[4:7], s53 offen offset:3072 sc1 lds
    s_add_u32 m0, s50, 4096
    s_add_u32 s53, s49, 4096
    buffer_load_dwordx4 v2, s[4:7], s53 offen offset:0 sc1 lds
    buffer_load_dwordx4 a[12:15], v2, s[4:7], s54 offen offset:3072 sc1
    buffer_load_dwordx4 a[84:87], v2, s[4:7], s55 offen offset:3072 sc1
    s_waitcnt lgkmcnt(5)
    v_mfma_f32_16x16x32_bf16 v[20:23], v[92:95], a[0:3], 0
    s_add_u32 s54, s51, 4096
    ds_read_b128 v[116:119], v3 offset:7168
    ds_read_b128 v[120:123], v3 offset:8192
    v_mfma_f32_16x16x32_bf16 v[52:55], v[92:95], a[72:75], 0
    s_waitcnt lgkmcnt(6)
    ds_read_b128 v[124:127], v3 offset:9216
    v_mfma_f32_16x16x32_bf16 v[24:27], v[96:99], a[0:3], 0
    v_mfma_f32_16x16x32_bf16 v[56:59], v[96:99], a[72:75], 0
    s_waitcnt lgkmcnt(6)
    ds_read_b128 v[128:131], v3 offset:10240
    v_mfma_f32_16x16x32_bf16 v[28:31], v[100:103], a[0:3], 0
    buffer_load_dwordx4 a[16:19], v2, s[4:7], s54 offen offset:0 sc1
    v_mfma_f32_16x16x32_bf16 v[60:63], v[100:103], a[72:75], 0
    s_waitcnt lgkmcnt(6)
    s_add_u32 s55, s51, 22528
    ds_read_b128 v[140:143], v3 offset:13312
    v_mfma_f32_16x16x32_bf16 v[32:35], v[112:115], a[0:3], 0
    ds_read_b128 v[132:135], v3 offset:11264
    v_mfma_f32_16x16x32_bf16 v[64:67], v[112:115], a[72:75], 0
    s_waitcnt lgkmcnt(7)
    v_mfma_f32_16x16x32_bf16 v[36:39], a[0:3], v[104:107], 0
    ds_read_b128 v[136:139], v3 offset:12288
    v_mfma_f32_16x16x32_bf16 v[68:71], a[72:75], v[104:107], 0
    s_waitcnt lgkmcnt(7)
    v_mfma_f32_16x16x32_bf16 v[40:43], a[0:3], v[108:111], 0
    buffer_load_dwordx4 a[88:91], v2, s[4:7], s55 offen offset:0 sc1
    v_mfma_f32_16x16x32_bf16 v[72:75], a[72:75], v[108:111], 0
    s_waitcnt vmcnt(12) lgkmcnt(6)
    v_mfma_f32_16x16x32_bf16 v[16:19], v[116:119], a[4:7], v[16:19]
    s_waitcnt vmcnt(11)
    ds_read_b128 v[88:91], v3 offset:14336
    v_mfma_f32_16x16x32_bf16 v[48:51], v[116:119], a[76:79], v[48:51]
    s_waitcnt lgkmcnt(6)
    ds_read_b128 v[92:95], v3 offset:15360
    v_mfma_f32_16x16x32_bf16 v[20:23], v[120:123], a[4:7], v[20:23]
    buffer_load_dwordx4 a[20:23], v2, s[4:7], s54 offen offset:1024 sc1
    v_mfma_f32_16x16x32_bf16 v[52:55], v[120:123], a[76:79], v[52:55]
    s_waitcnt lgkmcnt(6)
    ds_read_b128 v[96:99], v3 offset:16384
    v_mfma_f32_16x16x32_bf16 v[24:27], v[124:127], a[4:7], v[24:27]
    v_mfma_f32_16x16x32_bf16 v[56:59], v[124:127], a[76:79], v[56:59]
    s_waitcnt lgkmcnt(6)
    ds_read_b128 v[100:103], v3 offset:17408
    v_mfma_f32_16x16x32_bf16 v[28:31], v[128:131], a[4:7], v[28:31]
    buffer_load_dwordx4 a[92:95], v2, s[4:7], s55 offen offset:1024 sc1
    v_mfma_f32_16x16x32_bf16 v[60:63], v[128:131], a[76:79], v[60:63]
    s_waitcnt lgkmcnt(6)
    ds_read_b128 v[112:115], v3 offset:20480
    v_mfma_f32_16x16x32_bf16 v[32:35], v[140:143], a[4:7], v[32:35]
    ds_read_b128 v[104:107], v3 offset:18432
    v_mfma_f32_16x16x32_bf16 v[64:67], v[140:143], a[76:79], v[64:67]
    s_waitcnt lgkmcnt(7)
    v_mfma_f32_16x16x32_bf16 v[36:39], a[4:7], v[132:135], v[36:39]
    ds_read_b128 v[108:111], v3 offset:19456
    v_mfma_f32_16x16x32_bf16 v[68:71], a[76:79], v[132:135], v[68:71]
    s_waitcnt lgkmcnt(7)
    v_mfma_f32_16x16x32_bf16 v[40:43], a[4:7], v[136:139], v[40:43]
    buffer_load_dwordx4 a[24:27], v2, s[4:7], s54 offen offset:2048 sc1
    v_mfma_f32_16x16x32_bf16 v[72:75], a[76:79], v[136:139], v[72:75]
    s_waitcnt vmcnt(13) lgkmcnt(6)
    v_mfma_f32_16x16x32_bf16 v[16:19], v[88:91], a[8:11], v[16:19]
    s_waitcnt vmcnt(12)
    ds_read_b128 v[116:119], v3 offset:21504
    v_mfma_f32_16x16x32_bf16 v[48:51], v[88:91], a[80:83], v[48:51]
    s_waitcnt lgkmcnt(6)
    ds_read_b128 v[120:123], v3 offset:22528
    v_mfma_f32_16x16x32_bf16 v[20:23], v[92:95], a[8:11], v[20:23]
    buffer_load_dwordx4 a[96:99], v2, s[4:7], s55 offen offset:2048 sc1
    v_mfma_f32_16x16x32_bf16 v[52:55], v[92:95], a[80:83], v[52:55]
    s_waitcnt lgkmcnt(6)
    ds_read_b128 v[124:127], v3 offset:23552
    v_mfma_f32_16x16x32_bf16 v[24:27], v[96:99], a[8:11], v[24:27]
    v_mfma_f32_16x16x32_bf16 v[56:59], v[96:99], a[80:83], v[56:59]
    s_waitcnt lgkmcnt(6)
    ds_read_b128 v[128:131], v3 offset:24576
    v_mfma_f32_16x16x32_bf16 v[28:31], v[100:103], a[8:11], v[28:31]
    buffer_load_dwordx4 a[28:31], v2, s[4:7], s54 offen offset:3072 sc1
    v_mfma_f32_16x16x32_bf16 v[60:63], v[100:103], a[80:83], v[60:63]
    s_waitcnt lgkmcnt(6)
    ds_read_b128 v[140:143], v3 offset:27648
    v_mfma_f32_16x16x32_bf16 v[32:35], v[112:115], a[8:11], v[32:35]
    ds_read_b128 v[132:135], v3 offset:25600
    v_mfma_f32_16x16x32_bf16 v[64:67], v[112:115], a[80:83], v[64:67]
    s_waitcnt lgkmcnt(7)
    v_mfma_f32_16x16x32_bf16 v[36:39], a[8:11], v[104:107], v[36:39]
    ds_read_b128 v[136:139], v3 offset:26624
    v_mfma_f32_16x16x32_bf16 v[68:71], a[80:83], v[104:107], v[68:71]
    s_waitcnt lgkmcnt(7)
    v_mfma_f32_16x16x32_bf16 v[40:43], a[8:11], v[108:111], v[40:43]
    buffer_load_dwordx4 a[100:103], v2, s[4:7], s55 offen offset:3072 sc1
    v_mfma_f32_16x16x32_bf16 v[72:75], a[80:83], v[108:111], v[72:75]
    s_waitcnt vmcnt(9) lgkmcnt(6)
    s_add_u32 s54, s51, 8192
    v_mfma_f32_16x16x32_bf16 v[16:19], v[116:119], a[12:15], v[16:19]
    s_waitcnt vmcnt(8)
    ds_read_b128 v[88:91], v3 offset:28672
    v_mfma_f32_16x16x32_bf16 v[48:51], v[116:119], a[84:87], v[48:51]
    s_waitcnt lgkmcnt(6)
    ds_read_b128 v[92:95], v3 offset:29696
    v_mfma_f32_16x16x32_bf16 v[20:23], v[120:123], a[12:15], v[20:23]
    buffer_load_dwordx4 a[32:35], v2, s[4:7], s54 offen offset:0 sc1
    v_mfma_f32_16x16x32_bf16 v[52:55], v[120:123], a[84:87], v[52:55]
    s_waitcnt lgkmcnt(6)
    s_add_u32 s55, s51, 26624
    ds_read_b128 v[96:99], v3 offset:30720
    v_mfma_f32_16x16x32_bf16 v[24:27], v[124:127], a[12:15], v[24:27]
    v_mfma_f32_16x16x32_bf16 v[56:59], v[124:127], a[84:87], v[56:59]
    s_waitcnt lgkmcnt(6)
    ds_read_b128 v[100:103], v3 offset:31744
    v_mfma_f32_16x16x32_bf16 v[28:31], v[128:131], a[12:15], v[28:31]
    buffer_load_dwordx4 a[104:107], v2, s[4:7], s55 offen offset:0 sc1
    v_mfma_f32_16x16x32_bf16 v[60:63], v[128:131], a[84:87], v[60:63]
    s_waitcnt lgkmcnt(6)
    ds_read_b128 v[112:115], v3 offset:34816
    v_mfma_f32_16x16x32_bf16 v[32:35], v[140:143], a[12:15], v[32:35]
    ds_read_b128 v[104:107], v3 offset:32768
    v_mfma_f32_16x16x32_bf16 v[64:67], v[140:143], a[84:87], v[64:67]
    s_waitcnt lgkmcnt(7)
    v_mfma_f32_16x16x32_bf16 v[36:39], a[12:15], v[132:135], v[36:39]
    ds_read_b128 v[108:111], v3 offset:33792
    v_mfma_f32_16x16x32_bf16 v[68:71], a[84:87], v[132:135], v[68:71]
    s_waitcnt lgkmcnt(7)
    v_mfma_f32_16x16x32_bf16 v[40:43], a[12:15], v[136:139], v[40:43]
    buffer_load_dwordx4 a[36:39], v2, s[4:7], s54 offen offset:1024 sc1
    v_mfma_f32_16x16x32_bf16 v[72:75], a[84:87], v[136:139], v[72:75]
    s_waitcnt vmcnt(10) lgkmcnt(6)
    v_mfma_f32_16x16x32_bf16 v[16:19], v[88:91], a[16:19], v[16:19]
    s_waitcnt vmcnt(9)
    ds_read_b128 v[116:119], v3 offset:35840
    v_mfma_f32_16x16x32_bf16 v[48:51], v[88:91], a[88:91], v[48:51]
    s_waitcnt lgkmcnt(6)
    ds_read_b128 v[120:123], v3 offset:36864
    v_mfma_f32_16x16x32_bf16 v[20:23], v[92:95], a[16:19], v[20:23]
    buffer_load_dwordx4 a[108:111], v2, s[4:7], s55 offen offset:1024 sc1
    v_mfma_f32_16x16x32_bf16 v[52:55], v[92:95], a[88:91], v[52:55]
    s_waitcnt lgkmcnt(6)
    ds_read_b128 v[124:127], v3 offset:37888
    v_mfma_f32_16x16x32_bf16 v[24:27], v[96:99], a[16:19], v[24:27]
    v_mfma_f32_16x16x32_bf16 v[56:59], v[96:99], a[88:91], v[56:59]
    s_waitcnt lgkmcnt(6)
    ds_read_b128 v[128:131], v3 offset:38912
    v_mfma_f32_16x16x32_bf16 v[28:31], v[100:103], a[16:19], v[28:31]
    buffer_load_dwordx4 a[40:43], v2, s[4:7], s54 offen offset:2048 sc1
    v_mfma_f32_16x16x32_bf16 v[60:63], v[100:103], a[88:91], v[60:63]
    s_waitcnt lgkmcnt(6)
    ds_read_b128 v[140:143], v3 offset:41984
    v_mfma_f32_16x16x32_bf16 v[32:35], v[112:115], a[16:19], v[32:35]
    ds_read_b128 v[132:135], v3 offset:39936
    v_mfma_f32_16x16x32_bf16 v[64:67], v[112:115], a[88:91], v[64:67]
    s_waitcnt lgkmcnt(7)
    v_mfma_f32_16x16x32_bf16 v[36:39], a[16:19], v[104:107], v[36:39]
    ds_read_b128 v[136:139], v3 offset:40960
    v_mfma_f32_16x16x32_bf16 v[68:71], a[88:91], v[104:107], v[68:71]
    s_waitcnt lgkmcnt(7)
    v_mfma_f32_16x16x32_bf16 v[40:43], a[16:19], v[108:111], v[40:43]
    buffer_load_dwordx4 a[112:115], v2, s[4:7], s55 offen offset:2048 sc1
    v_mfma_f32_16x16x32_bf16 v[72:75], a[88:91], v[108:111], v[72:75]
    s_waitcnt vmcnt(11) lgkmcnt(6)
    v_mfma_f32_16x16x32_bf16 v[16:19], v[116:119], a[20:23], v[16:19]
    s_waitcnt vmcnt(10)
    s_barrier
    ds_read_b128 v[88:91], v3 offset:43008
    v_mfma_f32_16x16x32_bf16 v[48:51], v[116:119], a[92:95], v[48:51]
    s_waitcnt lgkmcnt(6)
    ds_read_b128 v[92:95], v3 offset:44032
    ds_read_b128 v[144:147], v10 offset:0
    v_mfma_f32_16x16x32_bf16 v[20:23], v[120:123], a[20:23], v[20:23]
    buffer_load_dwordx4 a[44:47], v2, s[4:7], s54 offen offset:3072 sc1
    v_mfma_f32_16x16x32_bf16 v[52:55], v[120:123], a[92:95], v[52:55]
    s_waitcnt lgkmcnt(7)
    ds_read_b128 v[96:99], v3 offset:45056
    ds_read_b128 v[148:151], v4 offset:0
    v_mfma_f32_16x16x32_bf16 v[24:27], v[124:127], a[20:23], v[24:27]
    ds_read_b128 v[152:155], v5 offset:0
    ds_read_b128 v[156:159], v10 offset:1024
    v_mfma_f32_16x16x32_bf16 v[56:59], v[124:127], a[92:95], v[56:59]
    s_waitcnt lgkmcnt(10)
    ds_read_b128 v[100:103], v3 offset:46080
    ds_read_b128 v[160:163], v4 offset:7168
    v_mfma_f32_16x16x32_bf16 v[28:31], v[128:131], a[20:23], v[28:31]
    buffer_load_dwordx4 a[116:119], v2, s[4:7], s55 offen offset:3072 sc1
    v_mfma_f32_16x16x32_bf16 v[60:63], v[128:131], a[92:95], v[60:63]
    s_waitcnt lgkmcnt(11)
    s_add_u32 s54, s51, 12288
    ds_read_b128 v[112:115], v3 offset:49152
    v_mfma_f32_16x16x32_bf16 v[32:35], v[140:143], a[20:23], v[32:35]
    ds_read_b128 v[104:107], v3 offset:47104
    ds_read_b128 v[164:167], v5 offset:7168
    v_mfma_f32_16x16x32_bf16 v[64:67], v[140:143], a[92:95], v[64:67]
    s_waitcnt lgkmcnt(13)
    v_mfma_f32_16x16x32_bf16 v[36:39], a[20:23], v[132:135], v[36:39]
    ds_read_b128 v[108:111], v3 offset:48128
    v_mfma_f32_16x16x32_bf16 v[68:71], a[92:95], v[132:135], v[68:71]
    s_waitcnt lgkmcnt(13)
    v_mfma_f32_16x16x32_bf16 v[40:43], a[20:23], v[136:139], v[40:43]
    buffer_load_dwordx4 a[48:51], v2, s[4:7], s54 offen offset:0 sc1
    v_mfma_f32_16x16x32_bf16 v[72:75], a[92:95], v[136:139], v[72:75]
    s_waitcnt vmcnt(12) lgkmcnt(12)
    s_add_u32 s55, s51, 30720
    v_mfma_f32_16x16x32_bf16 v[16:19], v[88:91], a[24:27], v[16:19]
    s_waitcnt vmcnt(11)
    ds_read_b128 v[116:119], v3 offset:50176
    v_mfma_f32_16x16x32_bf16 v[48:51], v[88:91], a[96:99], v[48:51]
    s_waitcnt lgkmcnt(12)
    ds_read_b128 v[120:123], v3 offset:51200
    v_mfma_f32_16x16x32_bf16 v[20:23], v[92:95], a[24:27], v[20:23]
    buffer_load_dwordx4 a[120:123], v2, s[4:7], s55 offen offset:0 sc1
    v_mfma_f32_16x16x32_bf16 v[52:55], v[92:95], a[96:99], v[52:55]
    s_waitcnt lgkmcnt(11)
    ds_read_b128 v[124:127], v3 offset:52224
    v_mfma_f32_16x16x32_bf16 v[24:27], v[96:99], a[24:27], v[24:27]
    v_mfma_f32_16x16x32_bf16 v[56:59], v[96:99], a[96:99], v[56:59]
    s_waitcnt lgkmcnt(8)
    ds_read_b128 v[128:131], v3 offset:53248
    v_mfma_f32_16x16x32_bf16 v[28:31], v[100:103], a[24:27], v[28:31]
    buffer_load_dwordx4 a[52:55], v2, s[4:7], s54 offen offset:1024 sc1
    v_mfma_f32_16x16x32_bf16 v[60:63], v[100:103], a[96:99], v[60:63]
    s_waitcnt lgkmcnt(7)
    ds_read_b128 v[140:143], v3 offset:56320
    v_mfma_f32_16x16x32_bf16 v[32:35], v[112:115], a[24:27], v[32:35]
    ds_read_b128 v[132:135], v3 offset:54272
    v_mfma_f32_16x16x32_bf16 v[64:67], v[112:115], a[96:99], v[64:67]
    s_waitcnt lgkmcnt(8)
    v_mfma_f32_16x16x32_bf16 v[36:39], a[24:27], v[104:107], v[36:39]
    ds_read_b128 v[136:139], v3 offset:55296
    v_mfma_f32_16x16x32_bf16 v[68:71], a[96:99], v[104:107], v[68:71]
    s_waitcnt lgkmcnt(7)
    v_mfma_f32_16x16x32_bf16 v[40:43], a[24:27], v[108:111], v[40:43]
    buffer_load_dwordx4 a[124:127], v2, s[4:7], s55 offen offset:1024 sc1
    v_mfma_f32_16x16x32_bf16 v[72:75], a[96:99], v[108:111], v[72:75]
    v_mfma_f32_16x16x32_bf16 v[80:83], v[148:151], v[144:147], 0
    v_mfma_f32_16x16x32_bf16 v[84:87], v[144:147], v[152:155], 0
    s_waitcnt vmcnt(13) lgkmcnt(6)
    ds_read_b128 v[144:147], v10 offset:2048
    ds_read_b128 v[148:151], v4 offset:14336
    v_mfma_f32_16x16x32_bf16 v[16:19], v[116:119], a[28:31], v[16:19]
    buffer_load_dwordx4 a[56:59], v2, s[4:7], s54 offen offset:2048 sc1
    s_waitcnt vmcnt(13)
    v_mfma_f32_16x16x32_bf16 v[48:51], v[116:119], a[100:103], v[48:51]
    s_waitcnt lgkmcnt(7)
    ds_read_b128 v[88:91], v3 offset:57344
    ds_read_b128 v[92:95], v3 offset:58368
    v_mfma_f32_16x16x32_bf16 v[20:23], v[120:123], a[28:31], v[20:23]
    ds_read_b128 v[152:155], v5 offset:14336
    v_mfma_f32_16x16x32_bf16 v[52:55], v[120:123], a[100:103], v[52:55]
    s_waitcnt lgkmcnt(9)
    ds_read_b128 v[96:99], v3 offset:59392
    v_mfma_f32_16x16x32_bf16 v[24:27], v[124:127], a[28:31], v[24:27]
    buffer_load_dwordx4 a[128:131], v2, s[4:7], s55 offen offset:2048 sc1
    v_mfma_f32_16x16x32_bf16 v[56:59], v[124:127], a[100:103], v[56:59]
    s_waitcnt lgkmcnt(9)
    ds_read_b128 v[100:103], v3 offset:60416
    v_mfma_f32_16x16x32_bf16 v[28:31], v[128:131], a[28:31], v[28:31]
    v_mfma_f32_16x16x32_bf16 v[60:63], v[128:131], a[100:103], v[60:63]
    s_waitcnt lgkmcnt(9)
    ds_read_b128 v[112:115], v3 offset:63488
    v_mfma_f32_16x16x32_bf16 v[32:35], v[140:143], a[28:31], v[32:35]
    buffer_load_dwordx4 a[60:63], v2, s[4:7], s54 offen offset:3072 sc1
    v_mfma_f32_16x16x32_bf16 v[64:67], v[140:143], a[100:103], v[64:67]
    s_waitcnt lgkmcnt(9)
    ds_read_b128 v[104:107], v3 offset:61440
    v_mfma_f32_16x16x32_bf16 v[36:39], a[28:31], v[132:135], v[36:39]
    ds_read_b128 v[108:111], v3 offset:62464
    v_mfma_f32_16x16x32_bf16 v[68:71], a[100:103], v[132:135], v[68:71]
    s_waitcnt lgkmcnt(10)
    v_mfma_f32_16x16x32_bf16 v[40:43], a[28:31], v[136:139], v[40:43]
    buffer_load_dwordx4 a[132:135], v2, s[4:7], s55 offen offset:3072 sc1
    v_mfma_f32_16x16x32_bf16 v[72:75], a[100:103], v[136:139], v[72:75]
    s_add_u32 s54, s51, 16384
    v_mfma_f32_16x16x32_bf16 v[80:83], v[160:163], v[156:159], v[80:83]
    v_mfma_f32_16x16x32_bf16 v[84:87], v[156:159], v[164:167], v[84:87]
    s_waitcnt vmcnt(15) lgkmcnt(7)
    ds_read_b128 v[156:159], v10 offset:3072
    ds_read_b128 v[160:163], v4 offset:21504
    v_mfma_f32_16x16x32_bf16 v[16:19], v[88:91], a[32:35], v[16:19]
    buffer_load_dwordx4 a[64:67], v2, s[4:7], s54 offen offset:0 sc1
    s_waitcnt vmcnt(15)
    v_mfma_f32_16x16x32_bf16 v[48:51], v[88:91], a[104:107], v[48:51]
    s_waitcnt lgkmcnt(8)
    s_add_u32 s55, s51, 34816
    v_add_u32 v3, 64512, v3
    v_mfma_f32_16x16x32_bf16 v[20:23], v[92:95], a[32:35], v[20:23]
    ds_read_b128 v[116:119], v3 offset:0
    ds_read_b128 v[164:167], v5 offset:21504
    v_mfma_f32_16x16x32_bf16 v[52:55], v[92:95], a[104:107], v[52:55]
    s_waitcnt lgkmcnt(8)
    ds_read_b128 v[120:123], v3 offset:1024
    v_mfma_f32_16x16x32_bf16 v[24:27], v[96:99], a[32:35], v[24:27]
    buffer_load_dwordx4 a[136:139], v2, s[4:7], s55 offen offset:0 sc1
    v_mfma_f32_16x16x32_bf16 v[56:59], v[96:99], a[104:107], v[56:59]
    s_waitcnt lgkmcnt(8)
    ds_read_b128 v[124:127], v3 offset:2048
    v_mfma_f32_16x16x32_bf16 v[28:31], v[100:103], a[32:35], v[28:31]
    v_mfma_f32_16x16x32_bf16 v[60:63], v[100:103], a[104:107], v[60:63]
    s_waitcnt lgkmcnt(8)
    ds_read_b128 v[128:131], v3 offset:3072
    v_mfma_f32_16x16x32_bf16 v[32:35], v[112:115], a[32:35], v[32:35]
    buffer_load_dwordx4 a[68:71], v2, s[4:7], s54 offen offset:1024 sc1
    v_mfma_f32_16x16x32_bf16 v[64:67], v[112:115], a[104:107], v[64:67]
    s_waitcnt lgkmcnt(8)
    ds_read_b128 v[140:143], v3 offset:6144
    v_mfma_f32_16x16x32_bf16 v[36:39], a[32:35], v[104:107], v[36:39]
    ds_read_b128 v[132:135], v3 offset:4096
    v_mfma_f32_16x16x32_bf16 v[68:71], a[104:107], v[104:107], v[68:71]
    s_waitcnt lgkmcnt(9)
    v_mfma_f32_16x16x32_bf16 v[40:43], a[32:35], v[108:111], v[40:43]
    ds_read_b128 v[136:139], v3 offset:5120
    v_mfma_f32_16x16x32_bf16 v[72:75], a[104:107], v[108:111], v[72:75]
    v_mfma_f32_16x16x32_bf16 v[80:83], v[148:151], v[144:147], v[80:83]
    v_mfma_f32_16x16x32_bf16 v[84:87], v[144:147], v[152:155], v[84:87]
    s_waitcnt vmcnt(16) lgkmcnt(7)
    ds_read_b128 v[144:147], v10 offset:4096
    ds_read_b128 v[148:151], v4 offset:28672
    v_mfma_f32_16x16x32_bf16 v[16:19], v[116:119], a[36:39], v[16:19]
    buffer_load_dwordx4 a[140:143], v2, s[4:7], s55 offen offset:1024 sc1
    s_waitcnt vmcnt(16)
    v_mfma_f32_16x16x32_bf16 v[48:51], v[116:119], a[108:111], v[48:51]
    s_waitcnt lgkmcnt(7)
    s_lshl_b32 s53, s22, 2
    s_add_u32 s53, s53, s20
    v_mfma_f32_16x16x32_bf16 v[20:23], v[120:123], a[36:39], v[20:23]
    s_mul_i32 s53, s53, 5248
    s_add_u32 s53, s53, 2097152
    ds_read_b128 v[88:91], v3 offset:7168
    v_mfma_f32_16x16x32_bf16 v[52:55], v[120:123], a[108:111], v[52:55]
    s_waitcnt lgkmcnt(7)
    ds_read_b128 v[92:95], v3 offset:8192
    ds_read_b128 v[96:99], v3 offset:9216
    v_mfma_f32_16x16x32_bf16 v[24:27], v[124:127], a[36:39], v[24:27]
    ds_read_b128 v[152:155], v5 offset:28672
    v_min_u32 v11, 40, v1
    v_mfma_f32_16x16x32_bf16 v[56:59], v[124:127], a[108:111], v[56:59]
    s_waitcnt lgkmcnt(9)
    ds_read_b128 v[100:103], v3 offset:10240
    v_lshlrev_b32 v11, 7, v11
    v_mfma_f32_16x16x32_bf16 v[28:31], v[128:131], a[36:39], v[28:31]
    buffer_load_dword v13, v11, s[4:7], s53 offen
    v_mfma_f32_16x16x32_bf16 v[60:63], v[128:131], a[108:111], v[60:63]
    s_waitcnt lgkmcnt(9)
    s_and_b32 s53, s21, 7
    s_lshl_b32 s53, s53, 2
    v_mfma_f32_16x16x32_bf16 v[32:35], v[140:143], a[36:39], v[32:35]
    s_and_b32 s54, s22, 3
    s_add_u32 s53, s53, s54
    s_mul_i32 s53, s53, 497664
    v_mfma_f32_16x16x32_bf16 v[64:67], v[140:143], a[108:111], v[64:67]
    s_waitcnt lgkmcnt(8)
    s_lshr_b32 s54, s22, 2
    s_lshl_b32 s54, s54, 2
    v_mfma_f32_16x16x32_bf16 v[36:39], a[36:39], v[132:135], v[36:39]
    s_add_u32 s54, s54, s20
    ds_read_b128 v[112:115], v3 offset:13312
    ds_read_b128 v[104:107], v3 offset:11264
    v_mfma_f32_16x16x32_bf16 v[68:71], a[108:111], v[132:135], v[68:71]
    s_waitcnt lgkmcnt(9)
    s_mul_i32 s54, s54, 4608
    ds_read_b128 v[108:111], v3 offset:12288
    v_mfma_f32_16x16x32_bf16 v[40:43], a[36:39], v[136:139], v[40:43]
    s_add_u32 s53, s53, s54
    s_add_u32 s53, s53, 4194304
    v_min_u32 v11, 35, v1
    v_mfma_f32_16x16x32_bf16 v[72:75], a[108:111], v[136:139], v[72:75]
    v_lshlrev_b32 v11, 7, v11
    v_mfma_f32_16x16x32_bf16 v[80:83], v[160:163], v[156:159], v[80:83]
    v_mfma_f32_16x16x32_bf16 v[84:87], v[156:159], v[164:167], v[84:87]
    s_waitcnt vmcnt(16) lgkmcnt(7)
    ds_read_b128 v[156:159], v10 offset:5120
    ds_read_b128 v[160:163], v4 offset:35840
    v_mfma_f32_16x16x32_bf16 v[16:19], v[88:91], a[40:43], v[16:19]
    buffer_load_dword v14, v11, s[4:7], s53 offen
    s_waitcnt vmcnt(16)
    v_mfma_f32_16x16x32_bf16 v[48:51], v[88:91], a[112:115], v[48:51]
    s_waitcnt lgkmcnt(8)
    ds_read_b128 v[116:119], v3 offset:14336
    ds_read_b128 v[120:123], v3 offset:15360
    v_mfma_f32_16x16x32_bf16 v[20:23], v[92:95], a[40:43], v[20:23]
    ds_read_b128 v[164:167], v5 offset:35840
    v_mfma_f32_16x16x32_bf16 v[52:55], v[92:95], a[112:115], v[52:55]
    s_waitcnt lgkmcnt(10)
    ds_read_b128 v[124:127], v3 offset:16384
    v_mfma_f32_16x16x32_bf16 v[24:27], v[96:99], a[40:43], v[24:27]
    v_mfma_f32_16x16x32_bf16 v[56:59], v[96:99], a[112:115], v[56:59]
    s_waitcnt lgkmcnt(9)
    ds_read_b128 v[128:131], v3 offset:17408
    v_mfma_f32_16x16x32_bf16 v[28:31], v[100:103], a[40:43], v[28:31]
    v_mfma_f32_16x16x32_bf16 v[60:63], v[100:103], a[112:115], v[60:63]
    s_waitcnt lgkmcnt(9)
    ds_read_b128 v[140:143], v3 offset:20480
    v_mfma_f32_16x16x32_bf16 v[32:35], v[112:115], a[40:43], v[32:35]
    ds_read_b128 v[132:135], v3 offset:18432
    v_mfma_f32_16x16x32_bf16 v[64:67], v[112:115], a[112:115], v[64:67]
    s_waitcnt lgkmcnt(10)
    v_mfma_f32_16x16x32_bf16 v[36:39], a[40:43], v[104:107], v[36:39]
    ds_read_b128 v[136:139], v3 offset:19456
    v_mfma_f32_16x16x32_bf16 v[68:71], a[112:115], v[104:107], v[68:71]
    s_waitcnt lgkmcnt(10)
    v_mfma_f32_16x16x32_bf16 v[40:43], a[40:43], v[108:111], v[40:43]
    v_mfma_f32_16x16x32_bf16 v[72:75], a[112:115], v[108:111], v[72:75]
    v_mfma_f32_16x16x32_bf16 v[80:83], v[148:151], v[144:147], v[80:83]
    v_mfma_f32_16x16x32_bf16 v[84:87], v[144:147], v[152:155], v[84:87]
    s_waitcnt vmcnt(15) lgkmcnt(7)
    ds_read_b128 v[144:147], v10 offset:6144
    ds_read_b128 v[148:151], v4 offset:43008
    v_mfma_f32_16x16x32_bf16 v[16:19], v[116:119], a[44:47], v[16:19]
    s_waitcnt vmcnt(14)
    ds_read_b128 v[88:91], v3 offset:21504
    ds_read_b128 v[152:155], v5 offset:43008
    v_mfma_f32_16x16x32_bf16 v[48:51], v[116:119], a[116:119], v[48:51]
    s_waitcnt lgkmcnt(10)
    ds_read_b128 v[92:95], v3 offset:22528
    v_mfma_f32_16x16x32_bf16 v[20:23], v[120:123], a[44:47], v[20:23]
    v_mfma_f32_16x16x32_bf16 v[52:55], v[120:123], a[116:119], v[52:55]
    s_waitcnt lgkmcnt(9)
    ds_read_b128 v[96:99], v3 offset:23552
    v_mfma_f32_16x16x32_bf16 v[24:27], v[124:127], a[44:47], v[24:27]
    v_mfma_f32_16x16x32_bf16 v[56:59], v[124:127], a[116:119], v[56:59]
    s_waitcnt lgkmcnt(9)
    ds_read_b128 v[100:103], v3 offset:24576
    v_mfma_f32_16x16x32_bf16 v[28:31], v[128:131], a[44:47], v[28:31]
    v_mfma_f32_16x16x32_bf16 v[60:63], v[128:131], a[116:119], v[60:63]
    s_waitcnt lgkmcnt(9)
    ds_read_b128 v[112:115], v3 offset:27648
    v_mfma_f32_16x16x32_bf16 v[32:35], v[140:143], a[44:47], v[32:35]
    ds_read_b128 v[104:107], v3 offset:25600
    v_mfma_f32_16x16x32_bf16 v[64:67], v[140:143], a[116:119], v[64:67]
    s_waitcnt lgkmcnt(10)
    v_mfma_f32_16x16x32_bf16 v[36:39], a[44:47], v[132:135], v[36:39]
    ds_read_b128 v[108:111], v3 offset:26624
    v_mfma_f32_16x16x32_bf16 v[68:71], a[116:119], v[132:135], v[68:71]
    s_waitcnt lgkmcnt(10)
    v_mfma_f32_16x16x32_bf16 v[40:43], a[44:47], v[136:139], v[40:43]
    v_mfma_f32_16x16x32_bf16 v[72:75], a[116:119], v[136:139], v[72:75]
    v_mfma_f32_16x16x32_bf16 v[80:83], v[160:163], v[156:159], v[80:83]
    v_mfma_f32_16x16x32_bf16 v[84:87], v[156:159], v[164:167], v[84:87]
    s_waitcnt vmcnt(13) lgkmcnt(7)
    ds_read_b128 v[156:159], v10 offset:7168
    ds_read_b128 v[160:163], v4 offset:50176
    v_mfma_f32_16x16x32_bf16 v[16:19], v[88:91], a[48:51], v[16:19]
    s_waitcnt vmcnt(12)
    ds_read_b128 v[164:167], v5 offset:50176
    ds_read_b128 v[116:119], v3 offset:28672
    v_mfma_f32_16x16x32_bf16 v[48:51], v[88:91], a[120:123], v[48:51]
    s_waitcnt lgkmcnt(9)
    ds_read_b128 v[120:123], v3 offset:29696
    v_mfma_f32_16x16x32_bf16 v[20:23], v[92:95], a[48:51], v[20:23]
    v_mfma_f32_16x16x32_bf16 v[52:55], v[92:95], a[120:123], v[52:55]
    s_waitcnt lgkmcnt(9)
    ds_read_b128 v[124:127], v3 offset:30720
    v_mfma_f32_16x16x32_bf16 v[24:27], v[96:99], a[48:51], v[24:27]
    v_mfma_f32_16x16x32_bf16 v[56:59], v[96:99], a[120:123], v[56:59]
    ds_read_b128 v[128:131], v3 offset:31744
    v_mfma_f32_16x16x32_bf16 v[80:83], v[148:151], v[144:147], v[80:83]
    v_mfma_f32_16x16x32_bf16 v[84:87], v[144:147], v[152:155], v[84:87]
    s_waitcnt lgkmcnt(10)
    ds_read_b128 v[140:143], v3 offset:34816
    ds_read_b128 v[144:147], v10 offset:8192
    v_mfma_f32_16x16x32_bf16 v[28:31], v[100:103], a[48:51], v[28:31]
    ds_read_b128 v[132:135], v3 offset:32768
    ds_read_b128 v[148:151], v4 offset:57344
    v_mfma_f32_16x16x32_bf16 v[60:63], v[100:103], a[120:123], v[60:63]
    s_waitcnt lgkmcnt(13)
    ds_read_b128 v[152:155], v5 offset:57344
    v_mfma_f32_16x16x32_bf16 v[32:35], v[112:115], a[48:51], v[32:35]
    ds_read_b128 v[136:139], v3 offset:33792
    v_mfma_f32_16x16x32_bf16 v[64:67], v[112:115], a[120:123], v[64:67]
    s_waitcnt lgkmcnt(14)
    v_mfma_f32_16x16x32_bf16 v[36:39], a[48:51], v[104:107], v[36:39]
    v_mfma_f32_16x16x32_bf16 v[68:71], a[120:123], v[104:107], v[68:71]
    s_waitcnt lgkmcnt(13)
    v_mfma_f32_16x16x32_bf16 v[40:43], a[48:51], v[108:111], v[40:43]
    v_mfma_f32_16x16x32_bf16 v[72:75], a[120:123], v[108:111], v[72:75]
    s_waitcnt lgkmcnt(11)
    v_mfma_f32_16x16x32_bf16 v[80:83], v[160:163], v[156:159], v[80:83]
    s_waitcnt lgkmcnt(10)
    v_mfma_f32_16x16x32_bf16 v[84:87], v[156:159], v[164:167], v[84:87]
    s_waitcnt vmcnt(11) lgkmcnt(9)
    v_add_u32 v4, 64512, v4
    v_add_u32 v5, 64512, v5
    v_mfma_f32_16x16x32_bf16 v[16:19], v[116:119], a[52:55], v[16:19]
    s_waitcnt vmcnt(10)
    ds_read_b128 v[156:159], v10 offset:9216
    ds_read_b128 v[160:163], v4 offset:0
    v_mfma_f32_16x16x32_bf16 v[48:51], v[116:119], a[124:127], v[48:51]
    s_waitcnt lgkmcnt(10)
    ds_read_b128 v[164:167], v5 offset:0
    ds_read_b128 v[88:91], v3 offset:35840
    v_mfma_f32_16x16x32_bf16 v[20:23], v[120:123], a[52:55], v[20:23]
    ds_read_b128 v[92:95], v3 offset:36864
    v_mfma_f32_16x16x32_bf16 v[52:55], v[120:123], a[124:127], v[52:55]
    s_waitcnt lgkmcnt(12)
    ds_read_b128 v[96:99], v3 offset:37888
    v_mfma_f32_16x16x32_bf16 v[24:27], v[124:127], a[52:55], v[24:27]
    v_mfma_f32_16x16x32_bf16 v[56:59], v[124:127], a[124:127], v[56:59]
    s_waitcnt lgkmcnt(8)
    ds_read_b128 v[100:103], v3 offset:38912
    v_mfma_f32_16x16x32_bf16 v[80:83], v[148:151], v[144:147], v[80:83]
    s_waitcnt lgkmcnt(8)
    v_mfma_f32_16x16x32_bf16 v[84:87], v[144:147], v[152:155], v[84:87]
    ds_read_b128 v[112:115], v3 offset:41984
    ds_read_b128 v[144:147], v10 offset:10240
    v_mfma_f32_16x16x32_bf16 v[28:31], v[128:131], a[52:55], v[28:31]
    ds_read_b128 v[104:107], v3 offset:39936
    ds_read_b128 v[148:151], v4 offset:7168
    v_mfma_f32_16x16x32_bf16 v[60:63], v[128:131], a[124:127], v[60:63]
    ds_read_b128 v[152:155], v5 offset:7168
    v_mfma_f32_16x16x32_bf16 v[32:35], v[140:143], a[52:55], v[32:35]
    ds_read_b128 v[108:111], v3 offset:40960
    v_mfma_f32_16x16x32_bf16 v[64:67], v[140:143], a[124:127], v[64:67]
    v_mfma_f32_16x16x32_bf16 v[36:39], a[52:55], v[132:135], v[36:39]
    v_mfma_f32_16x16x32_bf16 v[68:71], a[124:127], v[132:135], v[68:71]
    s_waitcnt lgkmcnt(13)
    v_mfma_f32_16x16x32_bf16 v[40:43], a[52:55], v[136:139], v[40:43]
    v_mfma_f32_16x16x32_bf16 v[72:75], a[124:127], v[136:139], v[72:75]
    s_waitcnt lgkmcnt(11)
    v_mfma_f32_16x16x32_bf16 v[80:83], v[160:163], v[156:159], v[80:83]
    s_waitcnt lgkmcnt(10)
    v_mfma_f32_16x16x32_bf16 v[84:87], v[156:159], v[164:167], v[84:87]
    s_waitcnt vmcnt(9) lgkmcnt(9)
    ds_read_b128 v[156:159], v10 offset:11264
    ds_read_b128 v[160:163], v4 offset:14336
    v_mfma_f32_16x16x32_bf16 v[16:19], v[88:91], a[56:59], v[16:19]
    s_waitcnt vmcnt(8)
    ds_read_b128 v[164:167], v5 offset:14336
    ds_read_b128 v[116:119], v3 offset:43008
    v_mfma_f32_16x16x32_bf16 v[48:51], v[88:91], a[128:131], v[48:51]
    s_waitcnt lgkmcnt(12)
    ds_read_b128 v[120:123], v3 offset:44032
    v_mfma_f32_16x16x32_bf16 v[20:23], v[92:95], a[56:59], v[20:23]
    v_mfma_f32_16x16x32_bf16 v[52:55], v[92:95], a[128:131], v[52:55]
    s_waitcnt lgkmcnt(12)
    ds_read_b128 v[124:127], v3 offset:45056
    v_mfma_f32_16x16x32_bf16 v[24:27], v[96:99], a[56:59], v[24:27]
    v_mfma_f32_16x16x32_bf16 v[56:59], v[96:99], a[128:131], v[56:59]
    s_waitcnt lgkmcnt(8)
    ds_read_b128 v[128:131], v3 offset:46080
    v_mfma_f32_16x16x32_bf16 v[80:83], v[148:151], v[144:147], v[80:83]
    s_waitcnt lgkmcnt(8)
    v_mfma_f32_16x16x32_bf16 v[84:87], v[144:147], v[152:155], v[84:87]
    ds_read_b128 v[140:143], v3 offset:49152
    ds_read_b128 v[144:147], v10 offset:12288
    v_mfma_f32_16x16x32_bf16 v[28:31], v[100:103], a[56:59], v[28:31]
    ds_read_b128 v[132:135], v3 offset:47104
    ds_read_b128 v[148:151], v4 offset:21504
    v_mfma_f32_16x16x32_bf16 v[60:63], v[100:103], a[128:131], v[60:63]
    ds_read_b128 v[152:155], v5 offset:21504
    v_mfma_f32_16x16x32_bf16 v[32:35], v[112:115], a[56:59], v[32:35]
    ds_read_b128 v[136:139], v3 offset:48128
    v_mfma_f32_16x16x32_bf16 v[64:67], v[112:115], a[128:131], v[64:67]
    v_mfma_f32_16x16x32_bf16 v[36:39], a[56:59], v[104:107], v[36:39]
    v_mfma_f32_16x16x32_bf16 v[68:71], a[128:131], v[104:107], v[68:71]
    s_waitcnt lgkmcnt(13)
    v_mfma_f32_16x16x32_bf16 v[40:43], a[56:59], v[108:111], v[40:43]
    v_mfma_f32_16x16x32_bf16 v[72:75], a[128:131], v[108:111], v[72:75]
    s_waitcnt lgkmcnt(11)
    v_mfma_f32_16x16x32_bf16 v[80:83], v[160:163], v[156:159], v[80:83]
    s_waitcnt lgkmcnt(10)
    v_mfma_f32_16x16x32_bf16 v[84:87], v[156:159], v[164:167], v[84:87]
    s_waitcnt vmcnt(7) lgkmcnt(9)
    ds_read_b128 v[156:159], v10 offset:13312
    ds_read_b128 v[160:163], v4 offset:28672
    v_mfma_f32_16x16x32_bf16 v[16:19], v[116:119], a[60:63], v[16:19]
    s_waitcnt vmcnt(6)
    ds_read_b128 v[164:167], v5 offset:28672
    ds_read_b128 v[88:91], v3 offset:50176
    v_mfma_f32_16x16x32_bf16 v[48:51], v[116:119], a[132:135], v[48:51]
    s_waitcnt lgkmcnt(12)
    ds_read_b128 v[92:95], v3 offset:51200
    v_mfma_f32_16x16x32_bf16 v[20:23], v[120:123], a[60:63], v[20:23]
    v_mfma_f32_16x16x32_bf16 v[52:55], v[120:123], a[132:135], v[52:55]
    s_waitcnt lgkmcnt(12)
    ds_read_b128 v[96:99], v3 offset:52224
    v_mfma_f32_16x16x32_bf16 v[24:27], v[124:127], a[60:63], v[24:27]
    v_mfma_f32_16x16x32_bf16 v[56:59], v[124:127], a[132:135], v[56:59]
    s_waitcnt lgkmcnt(8)
    ds_read_b128 v[100:103], v3 offset:53248
    v_mfma_f32_16x16x32_bf16 v[80:83], v[148:151], v[144:147], v[80:83]
    s_waitcnt lgkmcnt(8)
    v_mfma_f32_16x16x32_bf16 v[84:87], v[144:147], v[152:155], v[84:87]
    ds_read_b128 v[112:115], v3 offset:56320
    ds_read_b128 v[144:147], v10 offset:14336
    v_mfma_f32_16x16x32_bf16 v[28:31], v[128:131], a[60:63], v[28:31]
    ds_read_b128 v[104:107], v3 offset:54272
    ds_read_b128 v[148:151], v4 offset:35840
    v_mfma_f32_16x16x32_bf16 v[60:63], v[128:131], a[132:135], v[60:63]
    ds_read_b128 v[152:155], v5 offset:35840
    v_mfma_f32_16x16x32_bf16 v[32:35], v[140:143], a[60:63], v[32:35]
    ds_read_b128 v[108:111], v3 offset:55296
    v_mfma_f32_16x16x32_bf16 v[64:67], v[140:143], a[132:135], v[64:67]
    v_mfma_f32_16x16x32_bf16 v[36:39], a[60:63], v[132:135], v[36:39]
    v_mfma_f32_16x16x32_bf16 v[68:71], a[132:135], v[132:135], v[68:71]
    s_waitcnt lgkmcnt(13)
    v_mfma_f32_16x16x32_bf16 v[40:43], a[60:63], v[136:139], v[40:43]
    v_mfma_f32_16x16x32_bf16 v[72:75], a[132:135], v[136:139], v[72:75]
    s_waitcnt lgkmcnt(11)
    v_mfma_f32_16x16x32_bf16 v[80:83], v[160:163], v[156:159], v[80:83]
    s_waitcnt lgkmcnt(10)
    v_mfma_f32_16x16x32_bf16 v[84:87], v[156:159], v[164:167], v[84:87]
    s_waitcnt vmcnt(5) lgkmcnt(9)
    ds_read_b128 v[156:159], v10 offset:15360
    ds_read_b128 v[160:163], v4 offset:43008
    v_mfma_f32_16x16x32_bf16 v[16:19], v[88:91], a[64:67], v[16:19]
    s_waitcnt vmcnt(4)
    ds_read_b128 v[164:167], v5 offset:43008
    ds_read_b128 v[116:119], v3 offset:57344
    v_mfma_f32_16x16x32_bf16 v[48:51], v[88:91], a[136:139], v[48:51]
    s_waitcnt lgkmcnt(12)
    ds_read_b128 v[120:123], v3 offset:58368
    v_mfma_f32_16x16x32_bf16 v[20:23], v[92:95], a[64:67], v[20:23]
    v_mfma_f32_16x16x32_bf16 v[52:55], v[92:95], a[136:139], v[52:55]
    s_waitcnt lgkmcnt(12)
    ds_read_b128 v[124:127], v3 offset:59392
    v_mfma_f32_16x16x32_bf16 v[24:27], v[96:99], a[64:67], v[24:27]
    v_mfma_f32_16x16x32_bf16 v[56:59], v[96:99], a[136:139], v[56:59]
    s_waitcnt lgkmcnt(8)
    ds_read_b128 v[128:131], v3 offset:60416
    v_mfma_f32_16x16x32_bf16 v[80:83], v[148:151], v[144:147], v[80:83]
    s_waitcnt lgkmcnt(8)
    v_mfma_f32_16x16x32_bf16 v[84:87], v[144:147], v[152:155], v[84:87]
    ds_read_b128 v[140:143], v3 offset:63488
    ds_read_b128 v[144:147], v10 offset:16384
    v_mfma_f32_16x16x32_bf16 v[28:31], v[100:103], a[64:67], v[28:31]
    ds_read_b128 v[132:135], v3 offset:61440
    ds_read_b128 v[148:151], v4 offset:50176
    v_mfma_f32_16x16x32_bf16 v[60:63], v[100:103], a[136:139], v[60:63]
    ds_read_b128 v[152:155], v5 offset:50176
    v_mfma_f32_16x16x32_bf16 v[32:35], v[112:115], a[64:67], v[32:35]
    ds_read_b128 v[136:139], v3 offset:62464
    v_mfma_f32_16x16x32_bf16 v[64:67], v[112:115], a[136:139], v[64:67]
    v_mfma_f32_16x16x32_bf16 v[36:39], a[64:67], v[104:107], v[36:39]
    v_mfma_f32_16x16x32_bf16 v[68:71], a[136:139], v[104:107], v[68:71]
    s_waitcnt lgkmcnt(13)
    v_mfma_f32_16x16x32_bf16 v[40:43], a[64:67], v[108:111], v[40:43]
    v_mfma_f32_16x16x32_bf16 v[72:75], a[136:139], v[108:111], v[72:75]
    s_waitcnt lgkmcnt(11)
    v_mfma_f32_16x16x32_bf16 v[80:83], v[160:163], v[156:159], v[80:83]
    s_waitcnt lgkmcnt(10)
    v_mfma_f32_16x16x32_bf16 v[84:87], v[156:159], v[164:167], v[84:87]
    s_waitcnt vmcnt(3) lgkmcnt(9)
    ds_read_b128 v[156:159], v10 offset:17408
    ds_read_b128 v[160:163], v4 offset:57344
    v_mfma_f32_16x16x32_bf16 v[16:19], v[116:119], a[68:71], v[16:19]
    s_waitcnt vmcnt(2)
    ds_read_b128 v[164:167], v5 offset:57344
    v_mfma_f32_16x16x32_bf16 v[48:51], v[116:119], a[140:143], v[48:51]
    s_waitcnt lgkmcnt(11)
    v_mfma_f32_16x16x32_bf16 v[20:23], v[120:123], a[68:71], v[20:23]
    v_mfma_f32_16x16x32_bf16 v[52:55], v[120:123], a[140:143], v[52:55]
    s_waitcnt lgkmcnt(10)
    v_mfma_f32_16x16x32_bf16 v[24:27], v[124:127], a[68:71], v[24:27]
    v_mfma_f32_16x16x32_bf16 v[56:59], v[124:127], a[140:143], v[56:59]
    s_waitcnt lgkmcnt(5)
    v_mfma_f32_16x16x32_bf16 v[80:83], v[148:151], v[144:147], v[80:83]
    s_waitcnt lgkmcnt(4)
    v_mfma_f32_16x16x32_bf16 v[84:87], v[144:147], v[152:155], v[84:87]
    v_mfma_f32_16x16x32_bf16 v[28:31], v[128:131], a[68:71], v[28:31]
    v_mfma_f32_16x16x32_bf16 v[60:63], v[128:131], a[140:143], v[60:63]
    v_mfma_f32_16x16x32_bf16 v[32:35], v[140:143], a[68:71], v[32:35]
    v_mfma_f32_16x16x32_bf16 v[64:67], v[140:143], a[140:143], v[64:67]
    v_mfma_f32_16x16x32_bf16 v[36:39], a[68:71], v[132:135], v[36:39]
    v_mfma_f32_16x16x32_bf16 v[68:71], a[140:143], v[132:135], v[68:71]
    s_waitcnt lgkmcnt(3)
    v_mfma_f32_16x16x32_bf16 v[40:43], a[68:71], v[136:139], v[40:43]
    v_mfma_f32_16x16x32_bf16 v[72:75], a[140:143], v[136:139], v[72:75]
    s_waitcnt lgkmcnt(1)
    v_mfma_f32_16x16x32_bf16 v[80:83], v[160:163], v[156:159], v[80:83]
    s_waitcnt lgkmcnt(0)
    v_mfma_f32_16x16x32_bf16 v[84:87], v[156:159], v[164:167], v[84:87]
    v_lshlrev_b32 v6, 3, v1
    v_add_u32 v6, 148608, v6
    s_mul_i32 s52, s20, 3072
    v_add_u32 v7, s52, v6
    s_lshl_b32 s52, s20, 8
    s_add_u32 s52, s52, 161024
    s_waitcnt vmcnt(1)
    v_lshl_add_u32 v13, v1, 3, s52
    s_waitcnt vmcnt(0)
    v_lshrrev_b32 v14, 2, v1
    v_lshl_add_u32 v14, v14, 3, s52
    v_cvt_pk_bf16_f32 v100, v56, v57
    v_cvt_pk_bf16_f32 v101, v58, v59
    v_cvt_pk_bf16_f32 v104, v60, v61
    v_cvt_pk_bf16_f32 v105, v62, v63
    v_cvt_pk_bf16_f32 v134, v64, v65
    v_cvt_pk_bf16_f32 v137, v66, v67
    v_mov_b32 v102, 0
    v_mov_b32 v103, 0
    v_cvt_pk_bf16_f32 v110, v68, v69
    v_cvt_pk_bf16_f32 v111, v70, v71
    v_cvt_pk_bf16_f32 v116, v72, v73
    v_cvt_pk_bf16_f32 v117, v74, v75
    s_mov_b32 exec_lo, 0xffff0000
    s_mov_b32 exec_hi, 0
    ds_write2_b32 v13, v134, v137 offset0:64 offset1:65
    s_mov_b64 exec, -1
    v_permlane32_swap_b32 v134, v102
    v_permlane32_swap_b32 v137, v103
    s_cmp_eq_u32 s20, 3
    s_cbranch_scc1 L_w3_100
    ds_write_b64 v7, v[100:101] offset:3072
    ds_write_b64 v7, v[102:103] offset:3584
    ds_write_b64 v7, v[104:105] offset:4096
    ds_write_b64 v7, v[110:111] offset:4608
    ds_write_b64 v7, v[116:117] offset:5120
L_w3_100:
    v_cvt_pk_bf16_f32 v140, v80, v81
    v_cvt_pk_bf16_f32 v141, v82, v83
    v_cvt_pk_bf16_f32 v142, v84, v85
    v_cvt_pk_bf16_f32 v143, v86, v87
    s_min_u32 s52, s20, 2
    s_lshl_b32 s53, s52, 1
    s_cmp_ge_u32 s20, 2
    s_cselect_b32 s53, 1, s53
    s_lshl_b32 s53, s53, 9
    s_and_b32 s52, s20, 1
    s_add_u32 s52, s52, 3
    s_lshl_b32 s52, s52, 9
    v_add_u32 v8, s53, v6
    v_add_u32 v9, s52, v6
    s_cmp_lt_u32 s20, 2
    s_cbranch_scc1 L_noswap_101
    v_lshlrev_b32 v10, 3, v1
    v_add_u32 v10, 161024, v10
    s_mov_b32 exec_lo, 0xffff0000
    s_mov_b32 exec_hi, 0
    ds_write_b64 v10, v[140:141]
    s_mov_b64 exec, -1
    v_mov_b32 v10, 0
    v_mov_b32 v11, 0
    s_nop 1
    v_permlane32_swap_b32 v140, v10
    v_permlane32_swap_b32 v141, v11
    v_mov_b32 v140, v10
    v_mov_b32 v141, v11
L_noswap_101:
    ds_write_b64 v8, v[140:141]
    ds_write_b64 v9, v[142:143]
    v_cvt_pk_bf16_f32 v132, v48, v49
    v_cvt_pk_bf16_f32 v133, v50, v51
    v_cvt_pk_bf16_f32 v138, v52, v53
    v_cvt_pk_bf16_f32 v139, v54, v55
    v_mov_b32 v135, 0
    v_mov_b32 v136, 0
    v_cvt_pk_bf16_f32 v94, v24, v25
    v_cvt_pk_bf16_f32 v95, v26, v27
    v_cvt_pk_bf16_f32 v98, v28, v29
    v_cvt_pk_bf16_f32 v99, v30, v31
    v_cvt_pk_bf16_f32 v126, v32, v33
    v_cvt_pk_bf16_f32 v129, v34, v35
    v_mov_b32 v96, 0
    v_mov_b32 v97, 0
    v_cvt_pk_bf16_f32 v108, v36, v37
    v_cvt_pk_bf16_f32 v109, v38, v39
    v_cvt_pk_bf16_f32 v114, v40, v41
    v_cvt_pk_bf16_f32 v115, v42, v43
    s_mov_b32 exec_lo, 0xffff0000
    s_mov_b32 exec_hi, 0
    ds_write2_b32 v13, v126, v129 offset0:32 offset1:33
    s_mov_b64 exec, -1
    v_permlane32_swap_b32 v126, v96
    v_permlane32_swap_b32 v129, v97
    v_cvt_pk_bf16_f32 v124, v16, v17
    v_cvt_pk_bf16_f32 v125, v18, v19
    v_cvt_pk_bf16_f32 v130, v20, v21
    v_cvt_pk_bf16_f32 v131, v22, v23
    v_mov_b32 v127, 0
    v_mov_b32 v128, 0
    v_mov_b32 v144, 0x3f803f80
    v_mov_b32 v145, 0x3f803f80
    v_mov_b32 v146, 0x3f803f80
    v_mov_b32 v147, 0x3f803f80
    v_mfma_f32_16x16x32_bf16 v[32:35], v[94:97], v[132:135], v[172:175]
    v_mfma_f32_16x16x32_bf16 v[36:39], v[100:103], v[132:135], v[168:171]
    v_mfma_f32_16x16x32_bf16 v[20:23], v[94:97], v[124:127], v[168:171]
    v_mfma_f32_16x16x32_bf16 v[40:43], v[96:99], v[136:139], v[172:175]
    v_mfma_f32_16x16x32_bf16 v[44:47], v[102:105], v[136:139], v[168:171]
    v_mfma_f32_16x16x32_bf16 v[28:31], v[96:99], v[128:131], v[168:171]
    s_waitcnt lgkmcnt(0)
    s_barrier
    ds_read_b64 v[88:89], v7 offset:0
    ds_read_b64 v[90:91], v7 offset:512
    ds_read_b64 v[92:93], v7 offset:1024
    ds_read_b64 v[106:107], v7 offset:1536
    ds_read_b64 v[112:113], v7 offset:2048
    ds_read_b64_tr_b16 v[118:119], v14 offset:128
    ds_read_b64_tr_b16 v[120:121], v14 offset:256
    ds_read_b64_tr_b16 v[122:123], v14 offset:384
    s_mov_b32 s52, 0x3eae1a93
    s_waitcnt lgkmcnt(6)
    v_mfma_f32_16x16x32_bf16 v[16:19], v[88:91], v[124:127], v[176:179]
    s_waitcnt lgkmcnt(5)
    v_mfma_f32_16x16x32_bf16 v[24:27], v[90:93], v[128:131], v[176:179]
    v_max3_f32 v48, v32, v33, v34
    v_max3_f32 v49, v40, v41, v42
    s_nop 3
    v_max3_f32 v50, v16, v17, v18
    s_nop 0
    v_max3_f32 v51, v24, v25, v26
    v_max3_f32 v48, v48, v35, v36
    v_max3_f32 v49, v49, v43, v44
    v_max3_f32 v50, v50, v19, v20
    v_max3_f32 v51, v51, v27, v28
    v_max3_f32 v48, v48, v37, v38
    v_max3_f32 v49, v49, v45, v46
    v_max3_f32 v50, v50, v21, v22
    v_max3_f32 v51, v51, v29, v30
    v_max_f32 v48, v48, v39
    v_max_f32 v49, v49, v47
    v_max_f32 v50, v50, v23
    v_max_f32 v51, v51, v31
    v_mov_b32 v52, v48
    v_mov_b32 v53, v49
    v_mov_b32 v54, v50
    v_mov_b32 v55, v51
    v_permlane16_swap_b32 v48, v52
    v_permlane16_swap_b32 v49, v53
    v_permlane16_swap_b32 v50, v54
    v_permlane16_swap_b32 v51, v55
    v_max_f32 v48, v48, v52
    v_max_f32 v49, v49, v53
    v_max_f32 v50, v50, v54
    v_max_f32 v51, v51, v55
    v_mov_b32 v52, v48
    v_mov_b32 v53, v49
    v_mov_b32 v54, v50
    v_mov_b32 v55, v51
    v_permlane32_swap_b32 v48, v52
    v_permlane32_swap_b32 v49, v53
    v_permlane32_swap_b32 v50, v54
    v_permlane32_swap_b32 v51, v55
    v_max_f32 v48, v48, v52
    v_max_f32 v49, v49, v53
    v_max_f32 v50, v50, v54
    v_max_f32 v51, v51, v55
    v_mul_f32 v48, s52, v48
    v_mul_f32 v49, s52, v49
    v_mul_f32 v50, s52, v50
    v_mul_f32 v51, s52, v51
    v_fma_f32 v32, v32, s52, -v48
    v_fma_f32 v40, v40, s52, -v49
    v_fma_f32 v16, v16, s52, -v50
    v_fma_f32 v24, v24, s52, -v51
    v_fma_f32 v33, v33, s52, -v48
    v_fma_f32 v41, v41, s52, -v49
    v_fma_f32 v17, v17, s52, -v50
    v_fma_f32 v25, v25, s52, -v51
    v_fma_f32 v34, v34, s52, -v48
    v_fma_f32 v42, v42, s52, -v49
    v_fma_f32 v18, v18, s52, -v50
    v_fma_f32 v26, v26, s52, -v51
    v_fma_f32 v35, v35, s52, -v48
    v_fma_f32 v43, v43, s52, -v49
    v_fma_f32 v19, v19, s52, -v50
    v_fma_f32 v27, v27, s52, -v51
    v_fma_f32 v36, v36, s52, -v48
    v_fma_f32 v44, v44, s52, -v49
    v_fma_f32 v20, v20, s52, -v50
    v_fma_f32 v28, v28, s52, -v51
    v_fma_f32 v37, v37, s52, -v48
    v_fma_f32 v45, v45, s52, -v49
    v_fma_f32 v21, v21, s52, -v50
    v_fma_f32 v29, v29, s52, -v51
    v_fma_f32 v38, v38, s52, -v48
    v_fma_f32 v46, v46, s52, -v49
    v_fma_f32 v22, v22, s52, -v50
    v_fma_f32 v30, v30, s52, -v51
    v_fma_f32 v39, v39, s52, -v48
    v_fma_f32 v47, v47, s52, -v49
    v_fma_f32 v23, v23, s52, -v50
    v_fma_f32 v31, v31, s52, -v51
    v_exp_f32 v32, v32
    v_exp_f32 v40, v40
    v_exp_f32 v16, v16
    v_exp_f32 v24, v24
    v_exp_f32 v33, v33
    v_exp_f32 v41, v41
    v_exp_f32 v17, v17
    v_exp_f32 v25, v25
    v_exp_f32 v34, v34
    v_exp_f32 v42, v42
    v_exp_f32 v18, v18
    v_exp_f32 v26, v26
    v_exp_f32 v35, v35
    v_exp_f32 v43, v43
    v_exp_f32 v19, v19
    v_exp_f32 v27, v27
    v_exp_f32 v36, v36
    v_exp_f32 v44, v44
    v_exp_f32 v20, v20
    v_exp_f32 v28, v28
    v_exp_f32 v37, v37
    v_exp_f32 v45, v45
    v_exp_f32 v21, v21
    v_exp_f32 v29, v29
    v_exp_f32 v38, v38
    v_exp_f32 v46, v46
    v_exp_f32 v22, v22
    v_exp_f32 v30, v30
    v_exp_f32 v39, v39
    v_exp_f32 v47, v47
    v_exp_f32 v23, v23
    v_exp_f32 v31, v31
    v_cvt_pk_bf16_f32 v56, v32, v33
    v_cvt_pk_bf16_f32 v60, v40, v41
    v_cvt_pk_bf16_f32 v64, v16, v17
    v_cvt_pk_bf16_f32 v68, v24, v25
    v_cvt_pk_bf16_f32 v57, v34, v35
    v_cvt_pk_bf16_f32 v61, v42, v43
    v_cvt_pk_bf16_f32 v65, v18, v19
    v_cvt_pk_bf16_f32 v69, v26, v27
    v_cvt_pk_bf16_f32 v58, v36, v37
    v_cvt_pk_bf16_f32 v62, v44, v45
    v_cvt_pk_bf16_f32 v66, v20, v21
    v_cvt_pk_bf16_f32 v70, v28, v29
    v_cvt_pk_bf16_f32 v59, v38, v39
    v_cvt_pk_bf16_f32 v63, v46, v47
    v_cvt_pk_bf16_f32 v67, v22, v23
    v_cvt_pk_bf16_f32 v71, v30, v31
    v_mfma_f32_16x16x32_bf16 v[188:191], v[144:147], v[56:59], 0
    v_mfma_f32_16x16x32_bf16 v[180:183], v[108:111], v[56:59], 0
    s_waitcnt lgkmcnt(0)
    v_mfma_f32_16x16x32_bf16 v[184:187], v[120:123], v[56:59], 0
    v_mfma_f32_16x16x32_bf16 v[200:203], v[144:147], v[60:63], 0
    v_mfma_f32_16x16x32_bf16 v[192:195], v[114:117], v[60:63], 0
    v_mfma_f32_16x16x32_bf16 v[196:199], v[120:123], v[60:63], 0
    v_mfma_f32_16x16x32_bf16 v[212:215], v[144:147], v[64:67], 0
    v_mfma_f32_16x16x32_bf16 v[204:207], v[106:109], v[64:67], 0
    v_mfma_f32_16x16x32_bf16 v[208:211], v[118:121], v[64:67], 0
    v_mfma_f32_16x16x32_bf16 v[224:227], v[144:147], v[68:71], 0
    v_mfma_f32_16x16x32_bf16 v[216:219], v[112:115], v[68:71], 0
    v_mfma_f32_16x16x32_bf16 v[220:223], v[118:121], v[68:71], 0
    s_lshl_b32 s53, s46, 4
    s_add_u32 s53, s53, s45
    s_lshl_b32 s54, s53, 10
    s_add_u32 s54, s54, 73662464
    s_lshl_b32 s55, s53, 7
    s_add_u32 s55, s55, 75759488
    v_lshlrev_b32 v6, 3, v1
    v_rcp_f32 v188, v188
    v_rcp_f32 v200, v200
    v_rcp_f32 v212, v212
    v_rcp_f32 v224, v224
    v_mul_f32 v180, v180, v188
    v_mul_f32 v181, v181, v188
    v_mul_f32 v182, v182, v188
    v_mul_f32 v183, v183, v188
    v_mul_f32 v184, v184, v188
    v_mul_f32 v185, v185, v188
    v_cvt_pk_bf16_f32 v76, v180, v181
    v_cvt_pk_bf16_f32 v77, v182, v183
    v_cvt_pk_bf16_f32 v82, v184, v185
    v_mul_f32 v192, v192, v200
    v_mul_f32 v193, v193, v200
    v_mul_f32 v194, v194, v200
    v_mul_f32 v195, v195, v200
    v_mul_f32 v198, v198, v200
    v_mul_f32 v199, v199, v200
    v_cvt_pk_bf16_f32 v78, v192, v193
    v_cvt_pk_bf16_f32 v79, v194, v195
    v_cvt_pk_bf16_f32 v83, v198, v199
    s_add_u32 s53, s54, 16384
    buffer_store_dwordx4 v[76:79], v2, s[4:7], s53 offen sc1
    v_mul_f32 v204, v204, v212
    v_mul_f32 v205, v205, v212
    v_mul_f32 v206, v206, v212
    v_mul_f32 v207, v207, v212
    v_mul_f32 v208, v208, v212
    v_mul_f32 v209, v209, v212
    v_cvt_pk_bf16_f32 v72, v204, v205
    v_cvt_pk_bf16_f32 v73, v206, v207
    v_cvt_pk_bf16_f32 v80, v208, v209
    v_mul_f32 v216, v216, v224
    v_mul_f32 v217, v217, v224
    v_mul_f32 v218, v218, v224
    v_mul_f32 v219, v219, v224
    v_mul_f32 v222, v222, v224
    v_mul_f32 v223, v223, v224
    v_cvt_pk_bf16_f32 v74, v216, v217
    v_cvt_pk_bf16_f32 v75, v218, v219
    v_cvt_pk_bf16_f32 v81, v222, v223
    s_add_u32 s53, s54, 0
    buffer_store_dwordx4 v[72:75], v2, s[4:7], s53 offen sc1
    s_mov_b32 exec_lo, 0xffff0000
    s_mov_b32 exec_hi, 0
    buffer_store_dwordx2 v[80:81], v6, s[4:7], s55 offen offset:0 sc1
    buffer_store_dwordx2 v[82:83], v6, s[4:7], s55 offen offset:2048 sc1
    s_mov_b64 exec, -1
    s_lshl_b32 s52, s44, 2
    s_add_u32 s52, s52, s20
    s_lshl_b32 s52, s52, 4
    s_add_u32 s52, s52, s45
    s_lshl_b32 s52, s52, 3
    s_add_u32 s52, s52, 3956736
    v_mov_b32 v8, s98
    v_mov_b32 v9, s99
    s_waitcnt vmcnt(0)
    s_mov_b64 exec, 1
    buffer_store_dwordx2 v[8:9], off, s[4:7], s52 sc1
    s_mov_b64 exec, -1
    s_cmp_ge_u32 s22, 24
    s_cbranch_scc1 L_next_51
    s_mul_i32 s44, s22, 10923
    s_lshr_b32 s44, s44, 16
    s_mul_i32 s52, s44, 6
    s_sub_u32 s45, s22, s52
    s_lshl_b32 s52, s21, 2
    s_add_u32 s44, s44, s52
    s_lshl_b32 s46, s44, 2
    s_add_u32 s46, s46, s20
    s_mul_i32 s47, s45, 110592
    s_mul_i32 s48, s20, 3072
    s_add_u32 s47, s47, s48
    s_add_u32 s47, s47, 2097152
    s_lshl_b32 s49, s46, 14
    s_add_u32 s49, s49, 73662464
    s_lshl_b32 s50, s46, 11
    s_add_u32 s50, s50, 75759616
    v_and_b32 v3, 15, v1
    v_lshrrev_b32 v4, 4, v1
    v_lshlrev_b32 v5, 3, v3
    v_lshl_add_u32 v5, v4, 8, v5
    s_lshl_b32 s52, s46, 4
    v_add_u32 v6, s52, v3
    v_lshlrev_b32 v7, 3, v6
    v_mul_u32_u24 v6, 1152, v6
    v_lshl_add_u32 v6, v4, 4, v6
    s_mul_i32 s51, s45, 192
    s_add_u32 s8, s42, 28311552
    s_addc_u32 s9, s43, 0
    s_mov_b32 s10, 0x240000
    s_mov_b32 s11, 0x20000
    s_mov_b32 m0, s48
    s_nop 0
    buffer_load_dwordx4 v2, s[4:7], s47 offen offset:0 lds
    buffer_load_dwordx4 v2, s[4:7], s47 offen offset:1024 lds
    buffer_load_dwordx4 v2, s[4:7], s47 offen offset:2048 lds
    s_add_u32 s48, s48, 12288
    s_add_u32 s47, s47, 12288
    s_mov_b32 m0, s48
    s_nop 0
    buffer_load_dwordx4 v2, s[4:7], s47 offen offset:0 lds
    buffer_load_dwordx4 v2, s[4:7], s47 offen offset:1024 lds
    buffer_load_dwordx4 v2, s[4:7], s47 offen offset:2048 lds
    s_add_u32 s48, s48, 12288
    s_add_u32 s47, s47, 12288
    s_mov_b32 m0, s48
    s_nop 0
    buffer_load_dwordx4 v2, s[4:7], s47 offen offset:0 lds
    buffer_load_dwordx4 v2, s[4:7], s47 offen offset:1024 lds
    buffer_load_dwordx4 v2, s[4:7], s47 offen offset:2048 lds
    s_add_u32 s48, s48, 12288
    s_add_u32 s47, s47, 12288
    s_mov_b32 m0, s48
    s_nop 0
    buffer_load_dwordx4 v2, s[4:7], s47 offen offset:0 lds
    buffer_load_dwordx4 v2, s[4:7], s47 offen offset:1024 lds
    buffer_load_dwordx4 v2, s[4:7], s47 offen offset:2048 lds
    s_add_u32 s48, s48, 12288
    s_add_u32 s47, s47, 12288
    s_mov_b32 m0, s48
    s_nop 0
    buffer_load_dwordx4 v2, s[4:7], s47 offen offset:0 lds
    buffer_load_dwordx4 v2, s[4:7], s47 offen offset:1024 lds
    buffer_load_dwordx4 v2, s[4:7], s47 offen offset:2048 lds
    s_add_u32 s48, s48, 12288
    s_add_u32 s47, s47, 12288
    s_mov_b32 m0, s48
    s_nop 0
    buffer_load_dwordx4 v2, s[4:7], s47 offen offset:0 lds
    buffer_load_dwordx4 v2, s[4:7], s47 offen offset:1024 lds
    buffer_load_dwordx4 v2, s[4:7], s47 offen offset:2048 lds
    s_add_u32 s48, s48, 12288
    s_add_u32 s47, s47, 12288
    s_mov_b32 m0, s48
    s_nop 0
    buffer_load_dwordx4 v2, s[4:7], s47 offen offset:0 lds
    buffer_load_dwordx4 v2, s[4:7], s47 offen offset:1024 lds
    buffer_load_dwordx4 v2, s[4:7], s47 offen offset:2048 lds
    s_add_u32 s48, s48, 12288
    s_add_u32 s47, s47, 12288
    s_mov_b32 m0, s48
    s_nop 0
    buffer_load_dwordx4 v2, s[4:7], s47 offen offset:0 lds
    buffer_load_dwordx4 v2, s[4:7], s47 offen offset:1024 lds
    buffer_load_dwordx4 v2, s[4:7], s47 offen offset:2048 lds
    s_add_u32 s48, s48, 12288
    s_add_u32 s47, s47, 12288
    s_mov_b32 m0, s48
    s_nop 0
    buffer_load_dwordx4 v2, s[4:7], s47 offen offset:0 lds
    buffer_load_dwordx4 v2, s[4:7], s47 offen offset:1024 lds
    buffer_load_dwordx4 v2, s[4:7], s47 offen offset:2048 lds
    s_add_u32 s48, s48, 12288
    s_add_u32 s47, s47, 12288
    s_lshr_b32 s52, s46, 1
    s_lshl_b32 s52, s52, 7
    s_add_u32 s52, s52, 3956736
    v_and_b32 v10, 15, v1
    v_lshlrev_b32 v10, 3, v10
    s_mul_i32 s53, s45, 2816
    s_min_u32 s53, s53, 13568
    s_add_u32 s53, s53, s49
    buffer_load_dwordx4 v[160:163], v6, s[8:11], s51 offen offset:0 sc1
    buffer_load_dwordx4 v[164:167], v6, s[8:11], s51 offen offset:64 sc1
    buffer_load_dwordx4 v[168:171], v6, s[8:11], s51 offen offset:128 sc1
    v_mov_b32 v8, v2
    s_waitcnt vmcnt(3)
    s_barrier
    buffer_load_dwordx2 v[12:13], v10, s[4:7], s52 offen sc1
    ds_read_b128 a[0:3], v8 offset:0
    ds_read_b128 a[4:7], v8 offset:1024
    ds_read_b128 a[8:11], v8 offset:2048
    ds_read_b128 a[12:15], v8 offset:3072
    ds_read_b128 a[16:19], v8 offset:4096
    ds_read_b128 a[20:23], v8 offset:5120
    ds_read_b128 a[24:27], v8 offset:6144
    ds_read_b128 a[28:31], v8 offset:7168
    ds_read_b128 a[32:35], v8 offset:8192
    ds_read_b128 a[36:39], v8 offset:9216
    ds_read_b128 a[40:43], v8 offset:10240
    ds_read_b128 a[44:47], v8 offset:11264
    ds_read_b128 a[48:51], v8 offset:12288
    ds_read_b128 a[52:55], v8 offset:13312
    ds_read_b128 a[56:59], v8 offset:14336
    ds_read_b128 a[60:63], v8 offset:15360
    ds_read_b128 a[64:67], v8 offset:16384
    ds_read_b128 a[68:71], v8 offset:17408
    ds_read_b128 a[72:75], v8 offset:18432
    ds_read_b128 a[76:79], v8 offset:19456
    ds_read_b128 a[80:83], v8 offset:20480
    ds_read_b128 a[84:87], v8 offset:21504
    ds_read_b128 a[88:91], v8 offset:22528
    ds_read_b128 a[92:95], v8 offset:23552
    ds_read_b128 v[112:115], v8 offset:24576
    ds_read_b128 v[116:119], v8 offset:25600
    ds_read_b128 v[120:123], v8 offset:26624
    ds_read_b128 v[124:127], v8 offset:27648
    ds_read_b128 v[128:131], v8 offset:28672
    ds_read_b128 v[132:135], v8 offset:29696
    ds_read_b128 v[136:139], v8 offset:30720
    ds_read_b128 v[140:143], v8 offset:31744
    ds_read_b128 v[144:147], v8 offset:32768
    ds_read_b128 v[148:151], v8 offset:33792
    s_waitcnt vmcnt(0)
    v_cmp_eq_u64 vcc, s[98:99], v[12:13]
    s_nop 0
    s_cmp_eq_u64 vcc, exec
    s_cbranch_scc0 L_po_slow_102
L_po_back_103:
    buffer_load_dwordx4 v[16:19], v2, s[4:7], s49 offen offset:0 sc1
    buffer_load_dwordx4 v[20:23], v2, s[4:7], s49 offen offset:1024 sc1
    buffer_load_dwordx4 v[24:27], v2, s[4:7], s49 offen offset:2048 sc1
    buffer_load_dwordx4 v[28:31], v2, s[4:7], s49 offen offset:3072 sc1
    s_add_u32 s49, s49, 4096
    buffer_load_dwordx4 v[32:35], v2, s[4:7], s49 offen offset:0 sc1
    buffer_load_dwordx4 v[36:39], v2, s[4:7], s49 offen offset:1024 sc1
    buffer_load_dwordx4 v[40:43], v2, s[4:7], s49 offen offset:2048 sc1
    buffer_load_dwordx4 v[44:47], v2, s[4:7], s49 offen offset:3072 sc1
    s_waitcnt vmcnt(7) lgkmcnt(15)
    s_add_u32 s49, s49, 4096
    v_mfma_f32_16x16x32_bf16 v[88:91], a[0:3], v[16:19], 0
    buffer_load_dwordx4 v[48:51], v2, s[4:7], s49 offen offset:0 sc1
    s_waitcnt lgkmcnt(15)
    v_mfma_f32_16x16x32_bf16 v[92:95], a[4:7], v[16:19], 0
    s_waitcnt lgkmcnt(15)
    v_mfma_f32_16x16x32_bf16 v[96:99], a[8:11], v[16:19], 0
    s_waitcnt lgkmcnt(15)
    v_mfma_f32_16x16x32_bf16 v[100:103], a[12:15], v[16:19], 0
    buffer_load_dwordx4 v[52:55], v2, s[4:7], s49 offen offset:1024 sc1
    s_waitcnt lgkmcnt(15)
    v_mfma_f32_16x16x32_bf16 v[104:107], a[16:19], v[16:19], 0
    s_waitcnt lgkmcnt(15)
    v_mfma_f32_16x16x32_bf16 v[108:111], a[20:23], v[16:19], 0
    s_waitcnt vmcnt(8) lgkmcnt(15)
    v_mfma_f32_16x16x32_bf16 v[88:91], a[24:27], v[20:23], v[88:91]
    buffer_load_dwordx4 v[56:59], v2, s[4:7], s49 offen offset:2048 sc1
    s_waitcnt lgkmcnt(15)
    v_mfma_f32_16x16x32_bf16 v[92:95], a[28:31], v[20:23], v[92:95]
    s_waitcnt lgkmcnt(15)
    v_mfma_f32_16x16x32_bf16 v[96:99], a[32:35], v[20:23], v[96:99]
    s_waitcnt lgkmcnt(15)
    v_mfma_f32_16x16x32_bf16 v[100:103], a[36:39], v[20:23], v[100:103]
    buffer_load_dwordx4 v[60:63], v2, s[4:7], s49 offen offset:3072 sc1
    s_waitcnt lgkmcnt(15)
    v_mfma_f32_16x16x32_bf16 v[104:107], a[40:43], v[20:23], v[104:107]
    s_waitcnt lgkmcnt(15)
    s_add_u32 s49, s49, 4096
    v_mfma_f32_16x16x32_bf16 v[108:111], a[44:47], v[20:23], v[108:111]
    s_waitcnt vmcnt(9) lgkmcnt(15)
    v_mfma_f32_16x16x32_bf16 v[88:91], a[48:51], v[24:27], v[88:91]
    buffer_load_dwordx4 v[64:67], v2, s[4:7], s49 offen offset:0 sc1
    s_waitcnt lgkmcnt(15)
    v_mfma_f32_16x16x32_bf16 v[92:95], a[52:55], v[24:27], v[92:95]
    s_waitcnt lgkmcnt(15)
    v_mfma_f32_16x16x32_bf16 v[96:99], a[56:59], v[24:27], v[96:99]
    s_waitcnt lgkmcnt(15)
    v_mfma_f32_16x16x32_bf16 v[100:103], a[60:63], v[24:27], v[100:103]
    buffer_load_dwordx4 v[68:71], v2, s[4:7], s49 offen offset:1024 sc1
    s_waitcnt lgkmcnt(15)
    v_mfma_f32_16x16x32_bf16 v[104:107], a[64:67], v[24:27], v[104:107]
    s_waitcnt lgkmcnt(15)
    v_mfma_f32_16x16x32_bf16 v[108:111], a[68:71], v[24:27], v[108:111]
    s_waitcnt vmcnt(10) lgkmcnt(15)
    v_mfma_f32_16x16x32_bf16 v[88:91], a[72:75], v[28:31], v[88:91]
    buffer_load_dwordx4 v[72:75], v2, s[4:7], s49 offen offset:2048 sc1
    s_waitcnt lgkmcnt(14)
    v_mfma_f32_16x16x32_bf16 v[92:95], a[76:79], v[28:31], v[92:95]
    s_waitcnt lgkmcnt(13)
    v_mfma_f32_16x16x32_bf16 v[96:99], a[80:83], v[28:31], v[96:99]
    s_waitcnt lgkmcnt(12)
    v_mfma_f32_16x16x32_bf16 v[100:103], a[84:87], v[28:31], v[100:103]
    buffer_load_dwordx4 v[76:79], v2, s[4:7], s49 offen offset:3072 sc1
    s_waitcnt lgkmcnt(11)
    v_mfma_f32_16x16x32_bf16 v[104:107], a[88:91], v[28:31], v[104:107]
    s_waitcnt lgkmcnt(10)
    v_mfma_f32_16x16x32_bf16 v[108:111], a[92:95], v[28:31], v[108:111]
    s_waitcnt vmcnt(11) lgkmcnt(9)
    v_mfma_f32_16x16x32_bf16 v[88:91], v[112:115], v[32:35], v[88:91]
    s_waitcnt lgkmcnt(8)
    ds_read_b128 v[152:155], v8 offset:34816
    v_mfma_f32_16x16x32_bf16 v[92:95], v[116:119], v[32:35], v[92:95]
    s_waitcnt lgkmcnt(8)
    ds_read_b128 v[156:159], v8 offset:35840
    v_mfma_f32_16x16x32_bf16 v[96:99], v[120:123], v[32:35], v[96:99]
    s_waitcnt lgkmcnt(8)
    ds_read_b128 v[112:115], v8 offset:36864
    v_mfma_f32_16x16x32_bf16 v[100:103], v[124:127], v[32:35], v[100:103]
    s_waitcnt lgkmcnt(8)
    ds_read_b128 v[116:119], v8 offset:37888
    v_mfma_f32_16x16x32_bf16 v[104:107], v[128:131], v[32:35], v[104:107]
    s_waitcnt lgkmcnt(8)
    ds_read_b128 v[120:123], v8 offset:38912
    v_mfma_f32_16x16x32_bf16 v[108:111], v[132:135], v[32:35], v[108:111]
    s_waitcnt vmcnt(10) lgkmcnt(8)
    ds_read_b128 v[124:127], v8 offset:39936
    v_mfma_f32_16x16x32_bf16 v[88:91], v[136:139], v[36:39], v[88:91]
    s_waitcnt lgkmcnt(8)
    ds_read_b128 v[128:131], v8 offset:40960
    v_mfma_f32_16x16x32_bf16 v[92:95], v[140:143], v[36:39], v[92:95]
    s_waitcnt lgkmcnt(8)
    ds_read_b128 v[132:135], v8 offset:41984
    v_mfma_f32_16x16x32_bf16 v[96:99], v[144:147], v[36:39], v[96:99]
    s_waitcnt lgkmcnt(8)
    ds_read_b128 v[136:139], v8 offset:43008
    v_mfma_f32_16x16x32_bf16 v[100:103], v[148:151], v[36:39], v[100:103]
    s_waitcnt lgkmcnt(8)
    ds_read_b128 v[140:143], v8 offset:44032
    v_mfma_f32_16x16x32_bf16 v[104:107], v[152:155], v[36:39], v[104:107]
    s_waitcnt lgkmcnt(8)
    ds_read_b128 v[144:147], v8 offset:45056
    v_mfma_f32_16x16x32_bf16 v[108:111], v[156:159], v[36:39], v[108:111]
    s_waitcnt vmcnt(9) lgkmcnt(8)
    ds_read_b128 v[148:151], v8 offset:46080
    v_mfma_f32_16x16x32_bf16 v[88:91], v[112:115], v[40:43], v[88:91]
    s_waitcnt lgkmcnt(8)
    ds_read_b128 v[152:155], v8 offset:47104
    v_mfma_f32_16x16x32_bf16 v[92:95], v[116:119], v[40:43], v[92:95]
    s_waitcnt lgkmcnt(8)
    ds_read_b128 v[156:159], v8 offset:48128
    v_mfma_f32_16x16x32_bf16 v[96:99], v[120:123], v[40:43], v[96:99]
    s_waitcnt lgkmcnt(8)
    ds_read_b128 v[112:115], v8 offset:49152
    v_mfma_f32_16x16x32_bf16 v[100:103], v[124:127], v[40:43], v[100:103]
    s_waitcnt lgkmcnt(8)
    ds_read_b128 v[116:119], v8 offset:50176
    v_mfma_f32_16x16x32_bf16 v[104:107], v[128:131], v[40:43], v[104:107]
    s_waitcnt lgkmcnt(8)
    ds_read_b128 v[120:123], v8 offset:51200
    v_mfma_f32_16x16x32_bf16 v[108:111], v[132:135], v[40:43], v[108:111]
    s_waitcnt vmcnt(8) lgkmcnt(8)
    ds_read_b128 v[124:127], v8 offset:52224
    v_mfma_f32_16x16x32_bf16 v[88:91], v[136:139], v[44:47], v[88:91]
    s_waitcnt lgkmcnt(8)
    ds_read_b128 v[128:131], v8 offset:53248
    v_mfma_f32_16x16x32_bf16 v[92:95], v[140:143], v[44:47], v[92:95]
    s_waitcnt lgkmcnt(8)
    ds_read_b128 v[132:135], v8 offset:54272
    v_mfma_f32_16x16x32_bf16 v[96:99], v[144:147], v[44:47], v[96:99]
    s_waitcnt lgkmcnt(8)
    ds_read_b128 v[136:139], v8 offset:55296
    v_mfma_f32_16x16x32_bf16 v[100:103], v[148:151], v[44:47], v[100:103]
    s_waitcnt lgkmcnt(8)
    ds_read_b128 v[140:143], v8 offset:56320
    v_mfma_f32_16x16x32_bf16 v[104:107], v[152:155], v[44:47], v[104:107]
    s_waitcnt lgkmcnt(8)
    ds_read_b128 v[144:147], v8 offset:57344
    v_mfma_f32_16x16x32_bf16 v[108:111], v[156:159], v[44:47], v[108:111]
    s_waitcnt vmcnt(7) lgkmcnt(8)
    ds_read_b128 v[148:151], v8 offset:58368
    v_mfma_f32_16x16x32_bf16 v[88:91], v[112:115], v[48:51], v[88:91]
    s_waitcnt lgkmcnt(8)
    ds_read_b128 v[152:155], v8 offset:59392
    v_mfma_f32_16x16x32_bf16 v[92:95], v[116:119], v[48:51], v[92:95]
    s_waitcnt lgkmcnt(8)
    ds_read_b128 v[156:159], v8 offset:60416
    v_mfma_f32_16x16x32_bf16 v[96:99], v[120:123], v[48:51], v[96:99]
    s_waitcnt lgkmcnt(8)
    v_add_u32 v8, 61440, v8
    ds_read_b128 v[112:115], v8 offset:0
    v_mfma_f32_16x16x32_bf16 v[100:103], v[124:127], v[48:51], v[100:103]
    s_waitcnt lgkmcnt(8)
    ds_read_b128 v[116:119], v8 offset:1024
    v_mfma_f32_16x16x32_bf16 v[104:107], v[128:131], v[48:51], v[104:107]
    s_waitcnt lgkmcnt(8)
    ds_read_b128 v[120:123], v8 offset:2048
    v_mfma_f32_16x16x32_bf16 v[108:111], v[132:135], v[48:51], v[108:111]
    s_waitcnt vmcnt(6) lgkmcnt(8)
    ds_read_b128 v[124:127], v8 offset:3072
    v_mfma_f32_16x16x32_bf16 v[88:91], v[136:139], v[52:55], v[88:91]
    s_waitcnt lgkmcnt(8)
    ds_read_b128 v[128:131], v8 offset:4096
    v_mfma_f32_16x16x32_bf16 v[92:95], v[140:143], v[52:55], v[92:95]
    s_waitcnt lgkmcnt(8)
    ds_read_b128 v[132:135], v8 offset:5120
    v_mfma_f32_16x16x32_bf16 v[96:99], v[144:147], v[52:55], v[96:99]
    s_waitcnt lgkmcnt(8)
    ds_read_b128 v[136:139], v8 offset:6144
    v_mfma_f32_16x16x32_bf16 v[100:103], v[148:151], v[52:55], v[100:103]
    s_waitcnt lgkmcnt(8)
    ds_read_b128 v[140:143], v8 offset:7168
    v_mfma_f32_16x16x32_bf16 v[104:107], v[152:155], v[52:55], v[104:107]
    s_waitcnt lgkmcnt(8)
    ds_read_b128 v[144:147], v8 offset:8192
    v_mfma_f32_16x16x32_bf16 v[108:111], v[156:159], v[52:55], v[108:111]
    s_waitcnt vmcnt(5) lgkmcnt(8)
    ds_read_b128 v[148:151], v8 offset:9216
    v_mfma_f32_16x16x32_bf16 v[88:91], v[112:115], v[56:59], v[88:91]
    s_waitcnt lgkmcnt(8)
    ds_read_b128 v[152:155], v8 offset:10240
    v_mfma_f32_16x16x32_bf16 v[92:95], v[116:119], v[56:59], v[92:95]
    s_waitcnt lgkmcnt(8)
    ds_read_b128 v[156:159], v8 offset:11264
    v_mfma_f32_16x16x32_bf16 v[96:99], v[120:123], v[56:59], v[96:99]
    s_waitcnt lgkmcnt(8)
    ds_read_b128 v[112:115], v8 offset:12288
    v_mfma_f32_16x16x32_bf16 v[100:103], v[124:127], v[56:59], v[100:103]
    s_waitcnt lgkmcnt(8)
    ds_read_b128 v[116:119], v8 offset:13312
    v_mfma_f32_16x16x32_bf16 v[104:107], v[128:131], v[56:59], v[104:107]
    s_waitcnt lgkmcnt(8)
    ds_read_b128 v[120:123], v8 offset:14336
    v_mfma_f32_16x16x32_bf16 v[108:111], v[132:135], v[56:59], v[108:111]
    ds_read_b128 v[124:127], v8 offset:15360
    buffer_load_dwordx2 v[80:81], v5, s[4:7], s50 offen offset:0 sc1
    buffer_load_dwordx2 v[82:83], v5, s[4:7], s50 offen offset:128 sc1
    s_waitcnt vmcnt(6) lgkmcnt(9)
    v_mfma_f32_16x16x32_bf16 v[88:91], v[136:139], v[60:63], v[88:91]
    s_waitcnt lgkmcnt(8)
    ds_read_b128 v[128:131], v8 offset:16384
    v_mfma_f32_16x16x32_bf16 v[92:95], v[140:143], v[60:63], v[92:95]
    s_waitcnt lgkmcnt(8)
    ds_read_b128 v[132:135], v8 offset:17408
    v_mfma_f32_16x16x32_bf16 v[96:99], v[144:147], v[60:63], v[96:99]
    s_waitcnt lgkmcnt(8)
    ds_read_b128 v[136:139], v8 offset:18432
    v_mfma_f32_16x16x32_bf16 v[100:103], v[148:151], v[60:63], v[100:103]
    s_waitcnt lgkmcnt(8)
    ds_read_b128 v[140:143], v8 offset:19456
    v_mfma_f32_16x16x32_bf16 v[104:107], v[152:155], v[60:63], v[104:107]
    s_waitcnt lgkmcnt(8)
    ds_read_b128 v[144:147], v8 offset:20480
    v_mfma_f32_16x16x32_bf16 v[108:111], v[156:159], v[60:63], v[108:111]
    ds_read_b128 v[148:151], v8 offset:21504
    buffer_load_dwordx2 v[84:85], v5, s[4:7], s50 offen offset:1024 sc1
    buffer_load_dwordx2 v[86:87], v5, s[4:7], s50 offen offset:1152 sc1
    s_waitcnt vmcnt(7) lgkmcnt(9)
    v_mfma_f32_16x16x32_bf16 v[88:91], v[112:115], v[64:67], v[88:91]
    s_waitcnt lgkmcnt(8)
    ds_read_b128 v[152:155], v8 offset:22528
    v_mfma_f32_16x16x32_bf16 v[92:95], v[116:119], v[64:67], v[92:95]
    s_waitcnt lgkmcnt(8)
    ds_read_b128 v[156:159], v8 offset:23552
    v_mfma_f32_16x16x32_bf16 v[96:99], v[120:123], v[64:67], v[96:99]
    s_waitcnt lgkmcnt(8)
    ds_read_b128 v[112:115], v8 offset:24576
    v_mfma_f32_16x16x32_bf16 v[100:103], v[124:127], v[64:67], v[100:103]
    s_waitcnt lgkmcnt(8)
    ds_read_b128 v[116:119], v8 offset:25600
    v_mfma_f32_16x16x32_bf16 v[104:107], v[128:131], v[64:67], v[104:107]
    s_waitcnt lgkmcnt(8)
    ds_read_b128 v[120:123], v8 offset:26624
    v_mfma_f32_16x16x32_bf16 v[108:111], v[132:135], v[64:67], v[108:111]
    s_waitcnt vmcnt(6) lgkmcnt(8)
    ds_read_b128 v[124:127], v8 offset:27648
    v_mfma_f32_16x16x32_bf16 v[88:91], v[136:139], v[68:71], v[88:91]
    s_waitcnt lgkmcnt(8)
    ds_read_b128 v[128:131], v8 offset:28672
    v_mfma_f32_16x16x32_bf16 v[92:95], v[140:143], v[68:71], v[92:95]
    s_waitcnt lgkmcnt(8)
    ds_read_b128 v[132:135], v8 offset:29696
    v_mfma_f32_16x16x32_bf16 v[96:99], v[144:147], v[68:71], v[96:99]
    s_waitcnt lgkmcnt(8)
    ds_read_b128 v[136:139], v8 offset:30720
    v_mfma_f32_16x16x32_bf16 v[100:103], v[148:151], v[68:71], v[100:103]
    s_waitcnt lgkmcnt(8)
    ds_read_b128 v[140:143], v8 offset:31744
    v_mfma_f32_16x16x32_bf16 v[104:107], v[152:155], v[68:71], v[104:107]
    s_waitcnt lgkmcnt(8)
    ds_read_b128 v[144:147], v8 offset:32768
    v_mfma_f32_16x16x32_bf16 v[108:111], v[156:159], v[68:71], v[108:111]
    s_waitcnt vmcnt(5) lgkmcnt(8)
    ds_read_b128 v[148:151], v8 offset:33792
    v_mfma_f32_16x16x32_bf16 v[88:91], v[112:115], v[72:75], v[88:91]
    s_waitcnt lgkmcnt(8)
    ds_read_b128 v[152:155], v8 offset:34816
    v_mfma_f32_16x16x32_bf16 v[92:95], v[116:119], v[72:75], v[92:95]
    s_waitcnt lgkmcnt(8)
    ds_read_b128 v[156:159], v8 offset:35840
    v_mfma_f32_16x16x32_bf16 v[96:99], v[120:123], v[72:75], v[96:99]
    s_waitcnt lgkmcnt(8)
    ds_read_b128 v[112:115], v8 offset:36864
    v_mfma_f32_16x16x32_bf16 v[100:103], v[124:127], v[72:75], v[100:103]
    s_waitcnt lgkmcnt(8)
    ds_read_b128 v[116:119], v8 offset:37888
    v_mfma_f32_16x16x32_bf16 v[104:107], v[128:131], v[72:75], v[104:107]
    s_waitcnt lgkmcnt(8)
    ds_read_b128 v[120:123], v8 offset:38912
    v_mfma_f32_16x16x32_bf16 v[108:111], v[132:135], v[72:75], v[108:111]
    s_waitcnt vmcnt(4) lgkmcnt(8)
    ds_read_b128 v[124:127], v8 offset:39936
    v_mfma_f32_16x16x32_bf16 v[88:91], v[136:139], v[76:79], v[88:91]
    s_waitcnt lgkmcnt(8)
    ds_read_b128 v[128:131], v8 offset:40960
    v_mfma_f32_16x16x32_bf16 v[92:95], v[140:143], v[76:79], v[92:95]
    s_waitcnt lgkmcnt(8)
    ds_read_b128 v[132:135], v8 offset:41984
    v_mfma_f32_16x16x32_bf16 v[96:99], v[144:147], v[76:79], v[96:99]
    s_waitcnt lgkmcnt(8)
    ds_read_b128 v[136:139], v8 offset:43008
    v_mfma_f32_16x16x32_bf16 v[100:103], v[148:151], v[76:79], v[100:103]
    s_waitcnt lgkmcnt(8)
    ds_read_b128 v[140:143], v8 offset:44032
    v_mfma_f32_16x16x32_bf16 v[104:107], v[152:155], v[76:79], v[104:107]
    s_waitcnt lgkmcnt(8)
    ds_read_b128 v[144:147], v8 offset:45056
    v_mfma_f32_16x16x32_bf16 v[108:111], v[156:159], v[76:79], v[108:111]
    s_waitcnt vmcnt(2) lgkmcnt(8)
    ds_read_b128 v[148:151], v8 offset:46080
    v_mfma_f32_16x16x32_bf16 v[88:91], v[112:115], v[80:83], v[88:91]
    s_waitcnt lgkmcnt(8)
    ds_read_b128 v[152:155], v8 offset:47104
    v_mfma_f32_16x16x32_bf16 v[92:95], v[116:119], v[80:83], v[92:95]
    s_waitcnt lgkmcnt(8)
    ds_read_b128 v[156:159], v8 offset:48128
    v_mfma_f32_16x16x32_bf16 v[96:99], v[120:123], v[80:83], v[96:99]
    s_waitcnt lgkmcnt(8)
    v_mfma_f32_16x16x32_bf16 v[100:103], v[124:127], v[80:83], v[100:103]
    s_waitcnt lgkmcnt(7)
    v_mfma_f32_16x16x32_bf16 v[104:107], v[128:131], v[80:83], v[104:107]
    s_waitcnt lgkmcnt(6)
    v_mfma_f32_16x16x32_bf16 v[108:111], v[132:135], v[80:83], v[108:111]
    s_waitcnt vmcnt(0) lgkmcnt(5)
    v_mfma_f32_16x16x32_bf16 v[88:91], v[136:139], v[84:87], v[88:91]
    s_waitcnt lgkmcnt(4)
    v_mfma_f32_16x16x32_bf16 v[92:95], v[140:143], v[84:87], v[92:95]
    s_waitcnt lgkmcnt(3)
    v_mfma_f32_16x16x32_bf16 v[96:99], v[144:147], v[84:87], v[96:99]
    s_waitcnt lgkmcnt(2)
    v_mfma_f32_16x16x32_bf16 v[100:103], v[148:151], v[84:87], v[100:103]
    s_waitcnt lgkmcnt(1)
    v_mfma_f32_16x16x32_bf16 v[104:107], v[152:155], v[84:87], v[104:107]
    s_waitcnt lgkmcnt(0)
    v_mfma_f32_16x16x32_bf16 v[108:111], v[156:159], v[84:87], v[108:111]
    v_lshlrev_b32 v16, 16, v160
    v_and_b32 v17, 0xffff0000, v160
    v_lshlrev_b32 v18, 16, v161
    v_and_b32 v19, 0xffff0000, v161
    v_lshlrev_b32 v20, 16, v162
    v_and_b32 v21, 0xffff0000, v162
    v_lshlrev_b32 v22, 16, v163
    v_and_b32 v23, 0xffff0000, v163
    v_lshlrev_b32 v24, 16, v164
    v_and_b32 v25, 0xffff0000, v164
    v_lshlrev_b32 v26, 16, v165
    v_and_b32 v27, 0xffff0000, v165
    v_lshlrev_b32 v28, 16, v166
    v_and_b32 v29, 0xffff0000, v166
    v_lshlrev_b32 v30, 16, v167
    v_and_b32 v31, 0xffff0000, v167
    v_lshlrev_b32 v32, 16, v168
    v_and_b32 v33, 0xffff0000, v168
    v_lshlrev_b32 v34, 16, v169
    v_and_b32 v35, 0xffff0000, v169
    v_lshlrev_b32 v36, 16, v170
    v_and_b32 v37, 0xffff0000, v170
    v_lshlrev_b32 v38, 16, v171
    v_and_b32 v39, 0xffff0000, v171
    v_add_f32 v16, v16, v88
    v_add_f32 v17, v17, v89
    v_add_f32 v18, v18, v90
    v_add_f32 v19, v19, v91
    v_add_f32 v20, v20, v92
    v_add_f32 v21, v21, v93
    v_add_f32 v22, v22, v94
    v_add_f32 v23, v23, v95
    v_add_f32 v24, v24, v96
    v_add_f32 v25, v25, v97
    v_add_f32 v26, v26, v98
    v_add_f32 v27, v27, v99
    v_add_f32 v28, v28, v100
    v_add_f32 v29, v29, v101
    v_add_f32 v30, v30, v102
    v_add_f32 v31, v31, v103
    v_add_f32 v32, v32, v104
    v_add_f32 v33, v33, v105
    v_add_f32 v34, v34, v106
    v_add_f32 v35, v35, v107
    v_add_f32 v36, v36, v108
    v_add_f32 v37, v37, v109
    v_add_f32 v38, v38, v110
    v_add_f32 v39, v39, v111
    s_mul_i32 s52, s46, 18
    s_mul_i32 s53, s45, 3
    s_add_u32 s52, s52, s53
    s_lshl_b32 s52, s52, 10
    s_add_u32 s52, s52, 76021760
    v_cvt_pk_bf16_f32 v40, v16, v17
    v_cvt_pk_bf16_f32 v41, v18, v19
    v_cvt_pk_bf16_f32 v42, v20, v21
    v_cvt_pk_bf16_f32 v43, v22, v23
    buffer_store_dwordx4 v[40:43], v2, s[4:7], s52 offen offset:0 sc1
    v_cvt_pk_bf16_f32 v44, v24, v25
    v_cvt_pk_bf16_f32 v45, v26, v27
    v_cvt_pk_bf16_f32 v46, v28, v29
    v_cvt_pk_bf16_f32 v47, v30, v31
    buffer_store_dwordx4 v[44:47], v2, s[4:7], s52 offen offset:1024 sc1
    v_cvt_pk_bf16_f32 v48, v32, v33
    v_cvt_pk_bf16_f32 v49, v34, v35
    v_cvt_pk_bf16_f32 v50, v36, v37
    v_cvt_pk_bf16_f32 v51, v38, v39
    buffer_store_dwordx4 v[48:51], v2, s[4:7], s52 offen offset:2048 sc1
    v_lshlrev_b32 v16, 16, v40
    v_and_b32 v17, 0xffff0000, v40
    v_lshlrev_b32 v18, 16, v41
    v_and_b32 v19, 0xffff0000, v41
    v_lshlrev_b32 v20, 16, v42
    v_and_b32 v21, 0xffff0000, v42
    v_lshlrev_b32 v22, 16, v43
    v_and_b32 v23, 0xffff0000, v43
    v_lshlrev_b32 v24, 16, v44
    v_and_b32 v25, 0xffff0000, v44
    v_lshlrev_b32 v26, 16, v45
    v_and_b32 v27, 0xffff0000, v45
    v_lshlrev_b32 v28, 16, v46
    v_and_b32 v29, 0xffff0000, v46
    v_lshlrev_b32 v30, 16, v47
    v_and_b32 v31, 0xffff0000, v47
    v_lshlrev_b32 v32, 16, v48
    v_and_b32 v33, 0xffff0000, v48
    v_lshlrev_b32 v34, 16, v49
    v_and_b32 v35, 0xffff0000, v49
    v_lshlrev_b32 v36, 16, v50
    v_and_b32 v37, 0xffff0000, v50
    v_lshlrev_b32 v38, 16, v51
    v_and_b32 v39, 0xffff0000, v51
    v_add_f32 v56, v16, v17
    v_add_f32 v58, v18, v19
    v_add_f32 v56, v56, v20
    v_add_f32 v58, v58, v21
    v_add_f32 v56, v56, v22
    v_add_f32 v58, v58, v23
    v_add_f32 v56, v56, v24
    v_add_f32 v58, v58, v25
    v_add_f32 v56, v56, v26
    v_add_f32 v58, v58, v27
    v_add_f32 v56, v56, v28
    v_add_f32 v58, v58, v29
    v_add_f32 v56, v56, v30
    v_add_f32 v58, v58, v31
    v_add_f32 v56, v56, v32
    v_add_f32 v58, v58, v33
    v_add_f32 v56, v56, v34
    v_add_f32 v58, v58, v35
    v_add_f32 v56, v56, v36
    v_add_f32 v58, v58, v37
    v_add_f32 v56, v56, v38
    v_add_f32 v58, v58, v39
    v_add_f32 v56, v56, v58
    v_mov_b32 v58, v56
    s_nop 1
    v_permlane16_swap_b32 v56, v58
    v_add_f32 v56, v56, v58
    v_mov_b32 v58, v56
    s_nop 1
    v_permlane32_swap_b32 v56, v58
    v_add_f32 v56, v56, v58
    v_mul_f32 v59, 0x3c2aaaab, v56
    v_sub_f32 v58, v16, v59
    v_mul_f32 v57, v58, v58
    v_sub_f32 v61, v17, v59
    v_fmac_f32 v57, v61, v61
    v_sub_f32 v60, v18, v59
    v_fmac_f32 v57, v60, v60
    v_sub_f32 v61, v19, v59
    v_fmac_f32 v57, v61, v61
    v_sub_f32 v60, v20, v59
    v_fmac_f32 v57, v60, v60
    v_sub_f32 v61, v21, v59
    v_fmac_f32 v57, v61, v61
    v_sub_f32 v60, v22, v59
    v_fmac_f32 v57, v60, v60
    v_sub_f32 v61, v23, v59
    v_fmac_f32 v57, v61, v61
    v_sub_f32 v60, v24, v59
    v_fmac_f32 v57, v60, v60
    v_sub_f32 v61, v25, v59
    v_fmac_f32 v57, v61, v61
    v_sub_f32 v60, v26, v59
    v_fmac_f32 v57, v60, v60
    v_sub_f32 v61, v27, v59
    v_fmac_f32 v57, v61, v61
    v_sub_f32 v60, v28, v59
    v_fmac_f32 v57, v60, v60
    v_sub_f32 v61, v29, v59
    v_fmac_f32 v57, v61, v61
    v_sub_f32 v60, v30, v59
    v_fmac_f32 v57, v60, v60
    v_sub_f32 v61, v31, v59
    v_fmac_f32 v57, v61, v61
    v_sub_f32 v60, v32, v59
    v_fmac_f32 v57, v60, v60
    v_sub_f32 v61, v33, v59
    v_fmac_f32 v57, v61, v61
    v_sub_f32 v60, v34, v59
    v_fmac_f32 v57, v60, v60
    v_sub_f32 v61, v35, v59
    v_fmac_f32 v57, v61, v61
    v_sub_f32 v60, v36, v59
    v_fmac_f32 v57, v60, v60
    v_sub_f32 v61, v37, v59
    v_fmac_f32 v57, v61, v61
    v_sub_f32 v60, v38, v59
    v_fmac_f32 v57, v60, v60
    v_sub_f32 v61, v39, v59
    v_fmac_f32 v57, v61, v61
    v_mov_b32 v58, v57
    s_nop 1
    v_permlane16_swap_b32 v57, v58
    v_add_f32 v57, v57, v58
    v_mov_b32 v58, v57
    s_nop 1
    v_permlane32_swap_b32 v57, v58
    v_add_f32 v57, v57, v58
    s_lshl_b32 s52, s45, 14
    s_add_u32 s52, s52, 78381056
    s_mov_b32 exec_lo, 0xffff
    s_mov_b32 exec_hi, 0
    buffer_store_dwordx2 v[56:57], v7, s[4:7], s52 offen sc1
    s_mov_b64 exec, -1
    s_lshl_b32 s52, s46, 3
    s_add_u32 s52, s52, s45
    s_lshl_b32 s52, s52, 3
    s_add_u32 s52, s52, 3973120
    v_mov_b32 v8, s98
    v_mov_b32 v9, s99
    s_waitcnt vmcnt(0)
    s_mov_b64 exec, 1
    buffer_store_dwordx2 v[8:9], off, s[4:7], s52 sc1
    s_mov_b64 exec, -1
L_next_51:
    s_mov_b32 s100, 71303168
    s_mov_b32 s101, 0x2000
    s_branch L_ffn_49
L_red1_50:
    s_lshl_b32 s47, s21, 5
    s_add_u32 s47, s47, s22
    v_and_b32 v8, 7, v1
    v_lshrrev_b32 v9, 3, v1
    s_lshl_b32 s48, s47, 3
    v_add_u32 v3, s48, v8
    v_mul_u32_u24 v3, 1152, v3
    s_mul_i32 s48, s20, 384
    v_lshl_add_u32 v3, v9, 4, v3
    v_add_u32 v3, s48, v3
    s_lshr_b32 s48, s47, 1
    s_mul_i32 s48, s48, 18432
    s_and_b32 s49, s47, 1
    s_lshl_b32 s49, s49, 7
    s_add_u32 s48, s48, s49
    s_mul_i32 s49, s20, 6144
    s_add_u32 s48, s48, s49
    v_lshlrev_b32 v8, 4, v8
    v_lshl_add_u32 v8, v9, 8, v8
    v_add_u32 v4, s48, v8
    v_lshrrev_b32 v8, 3, v1
    v_and_b32 v9, 7, v1
    s_and_b32 s48, s47, 1
    s_lshl_b32 s48, s48, 3
    v_add_u32 v9, s48, v9
    v_lshlrev_b32 v9, 4, v9
    v_bfe_u32 v10, v8, 1, 1
    v_and_b32 v11, 1, v8
    v_lshl_add_u32 v9, v11, 4, v9
    v_lshl_add_u32 v9, v10, 9, v9
    v_and_b32 v10, 3, v8
    v_lshlrev_b32 v10, 8, v10
    v_sub_u32 v9, v9, v10
    s_mul_i32 s48, s20, 6
    v_lshrrev_b32 v8, 2, v8
    v_add_u32 v8, s48, v8
    v_add_u32 v10, 0, v8
    v_cmp_eq_u32 vcc, 4, v10
    v_cmp_eq_u32 s[56:57], 13, v10
    s_nop 0
    s_or_b64 vcc, vcc, s[56:57]
    v_cndmask_b32 v10, 0, v9, vcc
    v_add3_u32 v5, v4, v10, 0
    v_add_u32 v5, 0, v5
    v_add_u32 v10, 2, v8
    v_cmp_eq_u32 vcc, 4, v10
    v_cmp_eq_u32 s[56:57], 13, v10
    s_nop 0
    s_or_b64 vcc, vcc, s[56:57]
    v_cndmask_b32 v10, 0, v9, vcc
    v_add3_u32 v6, v4, v10, 0
    v_add_u32 v6, 2048, v6
    v_add_u32 v10, 4, v8
    v_cmp_eq_u32 vcc, 4, v10
    v_cmp_eq_u32 s[56:57], 13, v10
    s_nop 0
    s_or_b64 vcc, vcc, s[56:57]
    v_cndmask_b32 v10, 0, v9, vcc
    v_add3_u32 v7, v4, v10, 0
    v_add_u32 v7, 4096, v7
    s_cmp_eq_u32 s20, 3
    s_cbranch_scc1 L_w3a_105
    s_mov_b32 s48, 76021760
    buffer_load_dwordx4 v[16:19], v4, s[4:7], s48 offen offset:0 sc1
    buffer_load_dwordx4 v[52:55], v4, s[4:7], s48 offen offset:2048 sc1
    s_add_u32 s48, s48, 4096
    buffer_load_dwordx4 v[88:91], v4, s[4:7], s48 offen offset:0 sc1
    s_lshr_b32 s49, s47, 3
    s_lshl_b32 s49, s49, 8
    s_add_u32 s49, s49, 4055040
    v_and_b32 v10, 31, v1
    v_lshlrev_b32 v10, 3, v10
    buffer_load_dwordx2 v[176:177], v10, s[4:7], s49 offen sc1
    s_waitcnt vmcnt(0)
    v_cmp_eq_u64 vcc, s[98:99], v[176:177]
    s_nop 0
    s_cmp_eq_u64 vcc, exec
    s_cbranch_scc0 L_pp_slow_106
L_pp_back_107:
    s_mov_b32 s48, 100663296
    buffer_load_dwordx4 v[20:23], v5, s[4:7], s48 offen sc1
    buffer_load_dwordx4 v[56:59], v6, s[4:7], s48 offen sc1
    buffer_load_dwordx4 v[92:95], v7, s[4:7], s48 offen sc1
    s_mov_b32 s48, 103022592
    buffer_load_dwordx4 v[24:27], v5, s[4:7], s48 offen sc1
    buffer_load_dwordx4 v[60:63], v6, s[4:7], s48 offen sc1
    buffer_load_dwordx4 v[96:99], v7, s[4:7], s48 offen sc1
    s_mov_b32 s48, 105381888
    buffer_load_dwordx4 v[28:31], v5, s[4:7], s48 offen sc1
    buffer_load_dwordx4 v[64:67], v6, s[4:7], s48 offen sc1
    buffer_load_dwordx4 v[100:103], v7, s[4:7], s48 offen sc1
    s_mov_b32 s48, 107741184
    buffer_load_dwordx4 v[32:35], v5, s[4:7], s48 offen sc1
    buffer_load_dwordx4 v[68:71], v6, s[4:7], s48 offen sc1
    buffer_load_dwordx4 v[104:107], v7, s[4:7], s48 offen sc1
    s_mov_b32 s48, 110100480
    buffer_load_dwordx4 v[36:39], v5, s[4:7], s48 offen sc1
    buffer_load_dwordx4 v[72:75], v6, s[4:7], s48 offen sc1
    buffer_load_dwordx4 v[108:111], v7, s[4:7], s48 offen sc1
    s_mov_b32 s48, 112459776
    buffer_load_dwordx4 v[40:43], v5, s[4:7], s48 offen sc1
    buffer_load_dwordx4 v[76:79], v6, s[4:7], s48 offen sc1
    buffer_load_dwordx4 v[112:115], v7, s[4:7], s48 offen sc1
    s_mov_b32 s48, 114819072
    buffer_load_dwordx4 v[44:47], v5, s[4:7], s48 offen sc1
    buffer_load_dwordx4 v[80:83], v6, s[4:7], s48 offen sc1
    buffer_load_dwordx4 v[116:119], v7, s[4:7], s48 offen sc1
    s_mov_b32 s48, 117178368
    buffer_load_dwordx4 v[48:51], v5, s[4:7], s48 offen sc1
    buffer_load_dwordx4 v[84:87], v6, s[4:7], s48 offen sc1
    buffer_load_dwordx4 v[120:123], v7, s[4:7], s48 offen sc1
    v_lshlrev_b32 v128, 16, v16
    v_and_b32 v129, 0xffff0000, v16
    v_lshlrev_b32 v130, 16, v17
    v_and_b32 v131, 0xffff0000, v17
    v_lshlrev_b32 v132, 16, v18
    v_and_b32 v133, 0xffff0000, v18
    v_lshlrev_b32 v134, 16, v19
    v_and_b32 v135, 0xffff0000, v19
    v_lshlrev_b32 v136, 16, v52
    v_and_b32 v137, 0xffff0000, v52
    v_lshlrev_b32 v138, 16, v53
    v_and_b32 v139, 0xffff0000, v53
    v_lshlrev_b32 v140, 16, v54
    v_and_b32 v141, 0xffff0000, v54
    v_lshlrev_b32 v142, 16, v55
    v_and_b32 v143, 0xffff0000, v55
    v_lshlrev_b32 v144, 16, v88
    v_and_b32 v145, 0xffff0000, v88
    v_lshlrev_b32 v146, 16, v89
    v_and_b32 v147, 0xffff0000, v89
    v_lshlrev_b32 v148, 16, v90
    v_and_b32 v149, 0xffff0000, v90
    v_lshlrev_b32 v150, 16, v91
    v_and_b32 v151, 0xffff0000, v91
    v_mov_b32 v12, 0x3f80
    v_mov_b32 v13, 0x3f800000
    s_waitcnt vmcnt(23)
    v_dot2c_f32_bf16 v128, v20, v12
    v_dot2c_f32_bf16 v129, v20, v13
    v_dot2c_f32_bf16 v130, v21, v12
    v_dot2c_f32_bf16 v131, v21, v13
    v_dot2c_f32_bf16 v132, v22, v12
    v_dot2c_f32_bf16 v133, v22, v13
    v_dot2c_f32_bf16 v134, v23, v12
    v_dot2c_f32_bf16 v135, v23, v13
    s_waitcnt vmcnt(22)
    v_dot2c_f32_bf16 v136, v56, v12
    v_dot2c_f32_bf16 v137, v56, v13
    v_dot2c_f32_bf16 v138, v57, v12
    v_dot2c_f32_bf16 v139, v57, v13
    v_dot2c_f32_bf16 v140, v58, v12
    v_dot2c_f32_bf16 v141, v58, v13
    v_dot2c_f32_bf16 v142, v59, v12
    v_dot2c_f32_bf16 v143, v59, v13
    s_waitcnt vmcnt(21)
    v_dot2c_f32_bf16 v144, v92, v12
    v_dot2c_f32_bf16 v145, v92, v13
    v_dot2c_f32_bf16 v146, v93, v12
    v_dot2c_f32_bf16 v147, v93, v13
    v_dot2c_f32_bf16 v148, v94, v12
    v_dot2c_f32_bf16 v149, v94, v13
    v_dot2c_f32_bf16 v150, v95, v12
    v_dot2c_f32_bf16 v151, v95, v13
    s_waitcnt vmcnt(20)
    v_dot2c_f32_bf16 v128, v24, v12
    v_dot2c_f32_bf16 v129, v24, v13
    v_dot2c_f32_bf16 v130, v25, v12
    v_dot2c_f32_bf16 v131, v25, v13
    v_dot2c_f32_bf16 v132, v26, v12
    v_dot2c_f32_bf16 v133, v26, v13
    v_dot2c_f32_bf16 v134, v27, v12
    v_dot2c_f32_bf16 v135, v27, v13
    s_waitcnt vmcnt(19)
    v_dot2c_f32_bf16 v136, v60, v12
    v_dot2c_f32_bf16 v137, v60, v13
    v_dot2c_f32_bf16 v138, v61, v12
    v_dot2c_f32_bf16 v139, v61, v13
    v_dot2c_f32_bf16 v140, v62, v12
    v_dot2c_f32_bf16 v141, v62, v13
    v_dot2c_f32_bf16 v142, v63, v12
    v_dot2c_f32_bf16 v143, v63, v13
    s_waitcnt vmcnt(18)
    v_dot2c_f32_bf16 v144, v96, v12
    v_dot2c_f32_bf16 v145, v96, v13
    v_dot2c_f32_bf16 v146, v97, v12
    v_dot2c_f32_bf16 v147, v97, v13
    v_dot2c_f32_bf16 v148, v98, v12
    v_dot2c_f32_bf16 v149, v98, v13
    v_dot2c_f32_bf16 v150, v99, v12
    v_dot2c_f32_bf16 v151, v99, v13
    s_waitcnt vmcnt(17)
    v_dot2c_f32_bf16 v128, v28, v12
    v_dot2c_f32_bf16 v129, v28, v13
    v_dot2c_f32_bf16 v130, v29, v12
    v_dot2c_f32_bf16 v131, v29, v13
    v_dot2c_f32_bf16 v132, v30, v12
    v_dot2c_f32_bf16 v133, v30, v13
    v_dot2c_f32_bf16 v134, v31, v12
    v_dot2c_f32_bf16 v135, v31, v13
    s_waitcnt vmcnt(16)
    v_dot2c_f32_bf16 v136, v64, v12
    v_dot2c_f32_bf16 v137, v64, v13
    v_dot2c_f32_bf16 v138, v65, v12
    v_dot2c_f32_bf16 v139, v65, v13
    v_dot2c_f32_bf16 v140, v66, v12
    v_dot2c_f32_bf16 v141, v66, v13
    v_dot2c_f32_bf16 v142, v67, v12
    v_dot2c_f32_bf16 v143, v67, v13
    s_waitcnt vmcnt(15)
    v_dot2c_f32_bf16 v144, v100, v12
    v_dot2c_f32_bf16 v145, v100, v13
    v_dot2c_f32_bf16 v146, v101, v12
    v_dot2c_f32_bf16 v147, v101, v13
    v_dot2c_f32_bf16 v148, v102, v12
    v_dot2c_f32_bf16 v149, v102, v13
    v_dot2c_f32_bf16 v150, v103, v12
    v_dot2c_f32_bf16 v151, v103, v13
    s_waitcnt vmcnt(14)
    v_dot2c_f32_bf16 v128, v32, v12
    v_dot2c_f32_bf16 v129, v32, v13
    v_dot2c_f32_bf16 v130, v33, v12
    v_dot2c_f32_bf16 v131, v33, v13
    v_dot2c_f32_bf16 v132, v34, v12
    v_dot2c_f32_bf16 v133, v34, v13
    v_dot2c_f32_bf16 v134, v35, v12
    v_dot2c_f32_bf16 v135, v35, v13
    s_waitcnt vmcnt(13)
    v_dot2c_f32_bf16 v136, v68, v12
    v_dot2c_f32_bf16 v137, v68, v13
    v_dot2c_f32_bf16 v138, v69, v12
    v_dot2c_f32_bf16 v139, v69, v13
    v_dot2c_f32_bf16 v140, v70, v12
    v_dot2c_f32_bf16 v141, v70, v13
    v_dot2c_f32_bf16 v142, v71, v12
    v_dot2c_f32_bf16 v143, v71, v13
    s_waitcnt vmcnt(12)
    v_dot2c_f32_bf16 v144, v104, v12
    v_dot2c_f32_bf16 v145, v104, v13
    v_dot2c_f32_bf16 v146, v105, v12
    v_dot2c_f32_bf16 v147, v105, v13
    v_dot2c_f32_bf16 v148, v106, v12
    v_dot2c_f32_bf16 v149, v106, v13
    v_dot2c_f32_bf16 v150, v107, v12
    v_dot2c_f32_bf16 v151, v107, v13
    s_waitcnt vmcnt(11)
    v_dot2c_f32_bf16 v128, v36, v12
    v_dot2c_f32_bf16 v129, v36, v13
    v_dot2c_f32_bf16 v130, v37, v12
    v_dot2c_f32_bf16 v131, v37, v13
    v_dot2c_f32_bf16 v132, v38, v12
    v_dot2c_f32_bf16 v133, v38, v13
    v_dot2c_f32_bf16 v134, v39, v12
    v_dot2c_f32_bf16 v135, v39, v13
    s_waitcnt vmcnt(10)
    v_dot2c_f32_bf16 v136, v72, v12
    v_dot2c_f32_bf16 v137, v72, v13
    v_dot2c_f32_bf16 v138, v73, v12
    v_dot2c_f32_bf16 v139, v73, v13
    v_dot2c_f32_bf16 v140, v74, v12
    v_dot2c_f32_bf16 v141, v74, v13
    v_dot2c_f32_bf16 v142, v75, v12
    v_dot2c_f32_bf16 v143, v75, v13
    s_waitcnt vmcnt(9)
    v_dot2c_f32_bf16 v144, v108, v12
    v_dot2c_f32_bf16 v145, v108, v13
    v_dot2c_f32_bf16 v146, v109, v12
    v_dot2c_f32_bf16 v147, v109, v13
    v_dot2c_f32_bf16 v148, v110, v12
    v_dot2c_f32_bf16 v149, v110, v13
    v_dot2c_f32_bf16 v150, v111, v12
    v_dot2c_f32_bf16 v151, v111, v13
    s_waitcnt vmcnt(8)
    v_dot2c_f32_bf16 v128, v40, v12
    v_dot2c_f32_bf16 v129, v40, v13
    v_dot2c_f32_bf16 v130, v41, v12
    v_dot2c_f32_bf16 v131, v41, v13
    v_dot2c_f32_bf16 v132, v42, v12
    v_dot2c_f32_bf16 v133, v42, v13
    v_dot2c_f32_bf16 v134, v43, v12
    v_dot2c_f32_bf16 v135, v43, v13
    s_waitcnt vmcnt(7)
    v_dot2c_f32_bf16 v136, v76, v12
    v_dot2c_f32_bf16 v137, v76, v13
    v_dot2c_f32_bf16 v138, v77, v12
    v_dot2c_f32_bf16 v139, v77, v13
    v_dot2c_f32_bf16 v140, v78, v12
    v_dot2c_f32_bf16 v141, v78, v13
    v_dot2c_f32_bf16 v142, v79, v12
    v_dot2c_f32_bf16 v143, v79, v13
    s_waitcnt vmcnt(6)
    v_dot2c_f32_bf16 v144, v112, v12
    v_dot2c_f32_bf16 v145, v112, v13
    v_dot2c_f32_bf16 v146, v113, v12
    v_dot2c_f32_bf16 v147, v113, v13
    v_dot2c_f32_bf16 v148, v114, v12
    v_dot2c_f32_bf16 v149, v114, v13
    v_dot2c_f32_bf16 v150, v115, v12
    v_dot2c_f32_bf16 v151, v115, v13
    s_waitcnt vmcnt(5)
    v_dot2c_f32_bf16 v128, v44, v12
    v_dot2c_f32_bf16 v129, v44, v13
    v_dot2c_f32_bf16 v130, v45, v12
    v_dot2c_f32_bf16 v131, v45, v13
    v_dot2c_f32_bf16 v132, v46, v12
    v_dot2c_f32_bf16 v133, v46, v13
    v_dot2c_f32_bf16 v134, v47, v12
    v_dot2c_f32_bf16 v135, v47, v13
    s_waitcnt vmcnt(4)
    v_dot2c_f32_bf16 v136, v80, v12
    v_dot2c_f32_bf16 v137, v80, v13
    v_dot2c_f32_bf16 v138, v81, v12
    v_dot2c_f32_bf16 v139, v81, v13
    v_dot2c_f32_bf16 v140, v82, v12
    v_dot2c_f32_bf16 v141, v82, v13
    v_dot2c_f32_bf16 v142, v83, v12
    v_dot2c_f32_bf16 v143, v83, v13
    s_waitcnt vmcnt(3)
    v_dot2c_f32_bf16 v144, v116, v12
    v_dot2c_f32_bf16 v145, v116, v13
    v_dot2c_f32_bf16 v146, v117, v12
    v_dot2c_f32_bf16 v147, v117, v13
    v_dot2c_f32_bf16 v148, v118, v12
    v_dot2c_f32_bf16 v149, v118, v13
    v_dot2c_f32_bf16 v150, v119, v12
    v_dot2c_f32_bf16 v151, v119, v13
    s_waitcnt vmcnt(2)
    v_dot2c_f32_bf16 v128, v48, v12
    v_dot2c_f32_bf16 v129, v48, v13
    v_dot2c_f32_bf16 v130, v49, v12
    v_dot2c_f32_bf16 v131, v49, v13
    v_dot2c_f32_bf16 v132, v50, v12
    v_dot2c_f32_bf16 v133, v50, v13
    v_dot2c_f32_bf16 v134, v51, v12
    v_dot2c_f32_bf16 v135, v51, v13
    s_waitcnt vmcnt(1)
    v_dot2c_f32_bf16 v136, v84, v12
    v_dot2c_f32_bf16 v137, v84, v13
    v_dot2c_f32_bf16 v138, v85, v12
    v_dot2c_f32_bf16 v139, v85, v13
    v_dot2c_f32_bf16 v140, v86, v12
    v_dot2c_f32_bf16 v141, v86, v13
    v_dot2c_f32_bf16 v142, v87, v12
    v_dot2c_f32_bf16 v143, v87, v13
    s_waitcnt vmcnt(0)
    v_dot2c_f32_bf16 v144, v120, v12
    v_dot2c_f32_bf16 v145, v120, v13
    v_dot2c_f32_bf16 v146, v121, v12
    v_dot2c_f32_bf16 v147, v121, v13
    v_dot2c_f32_bf16 v148, v122, v12
    v_dot2c_f32_bf16 v149, v122, v13
    v_dot2c_f32_bf16 v150, v123, v12
    v_dot2c_f32_bf16 v151, v123, v13
    s_mov_b32 s16, s38
    s_mov_b32 s17, s39
    s_mov_b32 s18, 0x240000
    s_mov_b32 s19, 0x20000
    v_cvt_pk_bf16_f32 v160, v128, v129
    v_cvt_pk_bf16_f32 v161, v130, v131
    v_cvt_pk_bf16_f32 v162, v132, v133
    v_cvt_pk_bf16_f32 v163, v134, v135
    buffer_store_dwordx4 v[160:163], v3, s[16:19], 0 offen offset:0
    v_cvt_pk_bf16_f32 v164, v136, v137
    v_cvt_pk_bf16_f32 v165, v138, v139
    v_cvt_pk_bf16_f32 v166, v140, v141
    v_cvt_pk_bf16_f32 v167, v142, v143
    buffer_store_dwordx4 v[164:167], v3, s[16:19], 0 offen offset:128
    v_cvt_pk_bf16_f32 v168, v144, v145
    v_cvt_pk_bf16_f32 v169, v146, v147
    v_cvt_pk_bf16_f32 v170, v148, v149
    v_cvt_pk_bf16_f32 v171, v150, v151
    buffer_store_dwordx4 v[168:171], v3, s[16:19], 0 offen offset:256
L_w3a_105:
    s_waitcnt vmcnt(0) lgkmcnt(0)
interleave_layers__sliding_local_dilated__glu_gated_bilinear__prompt_kernel_end:
    s_endpgm
L_pn_slow_27:
    s_mov_b32 s97, 0x40000
L_pn_spin_29:
    s_sleep 8
    global_load_dwordx2 v[6:7], v5, s[40:41] sc1
    s_waitcnt vmcnt(0)
    v_cmp_ne_u64 vcc, 0, v[6:7]
    s_sub_u32 s97, s97, 1
    s_cbranch_scc1 L_pn_back_28
    s_cmp_eq_u64 vcc, exec
    s_cbranch_scc1 L_pn_back_28
    s_branch L_pn_spin_29
L_pwo_slow_40:
    s_mov_b32 s97, 0x40000
L_pwo_spin_42:
    s_sleep 8
    buffer_load_dwordx2 v[14:15], v13, s[4:7], s23 offen sc1
    s_waitcnt vmcnt(0)
    v_cmp_eq_u64 vcc, s[98:99], v[14:15]
    s_sub_u32 s97, s97, 1
    s_cbranch_scc1 L_pwo_back_41
    s_cmp_eq_u64 vcc, exec
    s_cbranch_scc1 L_pwo_back_41
    s_branch L_pwo_spin_42
L_px_slow_43:
    s_mov_b32 s97, 0x40000
L_px_spin_45:
    s_sleep 8
    buffer_load_dwordx2 v[12:13], v11, s[4:7], s23 offen sc1
    s_waitcnt vmcnt(0)
    v_cmp_eq_u64 vcc, s[98:99], v[12:13]
    s_sub_u32 s97, s97, 1
    s_cbranch_scc1 L_px_back_44
    s_cmp_eq_u64 vcc, exec
    s_cbranch_scc1 L_px_back_44
    s_branch L_px_spin_45
L_pw_slow_52:
    s_mov_b32 s97, 0x40000
L_pw_spin_54:
    s_sleep 8
    buffer_load_dwordx2 v[12:13], v14, s[4:7], s1 offen sc1
    s_waitcnt vmcnt(0)
    v_cmp_eq_u64 vcc, s[98:99], v[12:13]
    s_sub_u32 s97, s97, 1
    s_cbranch_scc1 L_pw_back_53
    s_cmp_eq_u64 vcc, exec
    s_cbranch_scc1 L_pw_back_53
    s_branch L_pw_spin_54
L_po_slow_55:
    s_mov_b32 s97, 0x40000
L_po_spin_57:
    s_sleep 8
    buffer_load_dwordx2 v[12:13], v10, s[4:7], s52 offen sc1
    s_waitcnt vmcnt(0)
    v_cmp_eq_u64 vcc, s[98:99], v[12:13]
    s_sub_u32 s97, s97, 1
    s_cbranch_scc1 L_po_back_56
    s_cmp_eq_u64 vcc, exec
    s_cbranch_scc1 L_po_back_56
    s_branch L_po_spin_57
L_p1_slow_75:
    s_mov_b32 s97, 0x40000
L_p1_spin_77:
    s_sleep 8
    buffer_load_dwordx2 v[168:169], v0, s[4:7], s55 offen sc1
    s_waitcnt vmcnt(0)
    v_cmp_eq_u64 vcc, s[98:99], v[168:169]
    s_sub_u32 s97, s97, 1
    s_cbranch_scc1 L_p1_back_76
    s_cmp_eq_u64 vcc, exec
    s_cbranch_scc1 L_p1_back_76
    s_branch L_p1_spin_77
L_pd_slow_79:
    s_mov_b32 s97, 0x40000
L_pd_spin_81:
    s_sleep 8
    buffer_load_dwordx2 v[6:7], v0, s[4:7], s55 offen sc1
    s_waitcnt vmcnt(0)
    v_cmp_eq_u64 vcc, s[98:99], v[6:7]
    s_sub_u32 s97, s97, 1
    s_cbranch_scc1 L_pd_back_80
    s_cmp_eq_u64 vcc, exec
    s_cbranch_scc1 L_pd_back_80
    s_branch L_pd_spin_81
L_p0_slow_82:
    s_mov_b32 s97, 0x40000
L_p0_spin_84:
    s_sleep 8
    buffer_load_dwordx2 v[6:7], v0, s[4:7], s55 offen sc1
    s_waitcnt vmcnt(0)
    v_cmp_eq_u64 vcc, s[98:99], v[6:7]
    s_sub_u32 s97, s97, 1
    s_cbranch_scc1 L_p0_back_83
    s_cmp_eq_u64 vcc, exec
    s_cbranch_scc1 L_p0_back_83
    s_branch L_p0_spin_84
L_p1_slow_85:
    s_mov_b32 s97, 0x40000
L_p1_spin_87:
    s_sleep 8
    buffer_load_dwordx2 v[6:7], v0, s[4:7], s55 offen sc1
    s_waitcnt vmcnt(0)
    v_cmp_eq_u64 vcc, s[98:99], v[6:7]
    s_sub_u32 s97, s97, 1
    s_cbranch_scc1 L_p1_back_86
    s_cmp_eq_u64 vcc, exec
    s_cbranch_scc1 L_p1_back_86
    s_branch L_p1_spin_87
L_p2_slow_88:
    s_mov_b32 s97, 0x40000
L_p2_spin_90:
    s_sleep 8
    buffer_load_dwordx2 v[6:7], v0, s[4:7], s55 offen sc1
    s_waitcnt vmcnt(0)
    v_cmp_eq_u64 vcc, s[98:99], v[6:7]
    s_sub_u32 s97, s97, 1
    s_cbranch_scc1 L_p2_back_89
    s_cmp_eq_u64 vcc, exec
    s_cbranch_scc1 L_p2_back_89
    s_branch L_p2_spin_90
L_pp_slow_92:
    s_mov_b32 s97, 0x40000
L_pp_spin_94:
    s_sleep 8
    buffer_load_dwordx2 v[176:177], v10, s[4:7], s49 offen sc1
    s_waitcnt vmcnt(0)
    v_cmp_eq_u64 vcc, s[98:99], v[176:177]
    s_sub_u32 s97, s97, 1
    s_cbranch_scc1 L_pp_back_93
    s_cmp_eq_u64 vcc, exec
    s_cbranch_scc1 L_pp_back_93
    s_branch L_pp_spin_94
L_px_slow_97:
    s_mov_b32 s97, 0x40000
L_px_spin_99:
    s_sleep 8
    buffer_load_dwordx2 v[12:13], v11, s[4:7], s23 offen sc1
    s_waitcnt vmcnt(0)
    v_cmp_eq_u64 vcc, s[98:99], v[12:13]
    s_sub_u32 s97, s97, 1
    s_cbranch_scc1 L_px_back_98
    s_cmp_eq_u64 vcc, exec
    s_cbranch_scc1 L_px_back_98
    s_branch L_px_spin_99
L_po_slow_102:
    s_mov_b32 s97, 0x40000
L_po_spin_104:
    s_sleep 8
    buffer_load_dwordx2 v[12:13], v10, s[4:7], s52 offen sc1
    s_waitcnt vmcnt(0)
    v_cmp_eq_u64 vcc, s[98:99], v[12:13]
    s_sub_u32 s97, s97, 1
    s_cbranch_scc1 L_po_back_103
    s_cmp_eq_u64 vcc, exec
    s_cbranch_scc1 L_po_back_103
    s_branch L_po_spin_104
L_pp_slow_106:
    s_mov_b32 s97, 0x40000
L_pp_spin_108:
    s_sleep 8
    buffer_load_dwordx2 v[176:177], v10, s[4:7], s49 offen sc1
    s_waitcnt vmcnt(0)
    v_cmp_eq_u64 vcc, s[98:99], v[176:177]
    s_sub_u32 s97, s97, 1
    s_cbranch_scc1 L_pp_back_107
    s_cmp_eq_u64 vcc, exec
    s_cbranch_scc1 L_pp_back_107
    s_branch L_pp_spin_108
interleave_layers__sliding_local_dilated__glu_gated_bilinear__prompt_kernel_last:
    s_endpgm
.section .rodata,"a"
.p2align 6
.amdhsa_kernel interleave_layers__sliding_local_dilated__glu_gated_bilinear__prompt_kernel
  .amdhsa_next_free_vgpr 512
  .amdhsa_next_free_sgpr 102
  .amdhsa_accum_offset 256
  .amdhsa_group_segment_fixed_size 0
  .amdhsa_kernarg_size 80
  .amdhsa_user_sgpr_count 2
  .amdhsa_user_sgpr_kernarg_segment_ptr 1
  .amdhsa_system_sgpr_workgroup_id_x 1
  .amdhsa_float_denorm_mode_32 3
.end_amdhsa_kernel
```

```asm
; @launch grid=(256,1,1) block=(256,1,1) lds=163840
.amdgcn_target "amdgcn-amd-amdhsa--gfx950"
.text
.globl interleave_layers__sliding_local_dilated__glu_gated_bilinear__prompt_kernel
.p2align 8
.type interleave_layers__sliding_local_dilated__glu_gated_bilinear__prompt_kernel,@function
interleave_layers__sliding_local_dilated__glu_gated_bilinear__prompt_kernel:
    s_cmp_ge_u32 s2, 256
    s_cbranch_scc1 interleave_layers__sliding_local_dilated__glu_gated_bilinear__prompt_kernel_end
    s_load_dwordx16 s[24:39], s[0:1], 0
    s_load_dwordx4 s[40:43], s[0:1], 64
    v_lshrrev_b32 v1, 6, v0
    s_and_b32 s21, s2, 7
    v_readfirstlane_b32 s20, v1
    s_lshr_b32 s22, s2, 3
    v_and_b32 v1, 63, v0
    v_lshlrev_b32 v2, 4, v1
    s_lshl_b32 s23, s22, 2
    s_add_u32 s23, s23, s20
    s_mul_i32 s23, s23, 5
    v_add_lshl_u32 v219, v1, s23, 7
    s_getpc_b64 s[16:17]
L_pc_1:
    v_min_u32 v219, interleave_layers__sliding_local_dilated__glu_gated_bilinear__prompt_kernel_last-L_pc_1, v219
    s_mov_b64 exec, 31
    global_load_dword v219, v219, s[16:17]
    s_mov_b64 exec, -1
    s_waitcnt lgkmcnt(0)
    s_mov_b32 s4, s42
    s_mov_b32 s5, s43
    s_mov_b32 s6, 0x10000000
    s_mov_b32 s7, 0x20000
    s_mov_b32 s100, 20971520
    s_mov_b32 s101, 0
    s_mov_b32 s8, s24
    s_mov_b32 s9, s25
    s_mov_b32 s10, 0x240000
    s_mov_b32 s11, 0x20000
    s_mov_b32 s12, s26
    s_mov_b32 s13, s27
    s_mov_b32 s14, 0x1e6000
    s_mov_b32 s15, 0x20000
    v_mov_b32 v3, 0
    v_mov_b32 v4, 0
    v_mov_b32 v5, 0
    s_or_b32 s44, s2, s20
    s_cmp_lg_u32 s44, 0
    s_cbranch_scc1 L_nonce_2
    s_memrealtime s[44:45]
    s_waitcnt lgkmcnt(0)
    v_mov_b32 v6, s44
    v_mov_b32 v7, s45
    s_mov_b64 exec, 1
    global_store_dwordx2 v5, v[6:7], s[40:41] sc1
    s_mov_b64 exec, -1
L_nonce_2:
    s_lshl_b32 s52, s2, 2
    s_add_u32 s52, s52, s20
    s_mul_i32 s52, s52, 640
    s_add_u32 s52, s52, 0x8000000
    v_min_u32 v217, 4, v1
    v_lshlrev_b32 v217, 7, v217
    buffer_load_dword v218, v217, s[4:7], s52 offen sc1
    s_cmp_eq_u32 s20, 3
    s_cbranch_scc1 L_w3_3
    s_lshl_b32 s47, s21, 5
    s_add_u32 s47, s47, s22
    v_and_b32 v6, 7, v1
    v_lshrrev_b32 v7, 3, v1
    s_lshl_b32 s48, s47, 3
    v_add_u32 v3, s48, v6
    v_mul_u32_u24 v3, 1152, v3
    s_mul_i32 s48, s20, 384
    v_lshl_add_u32 v3, v7, 4, v3
    v_add_u32 v3, s48, v3
    s_lshr_b32 s48, s47, 1
    s_mul_i32 s48, s48, 18432
    s_and_b32 s49, s47, 1
    s_lshl_b32 s49, s49, 7
    s_add_u32 s48, s48, s49
    s_mul_i32 s49, s20, 6144
    s_add_u32 s48, s48, s49
    v_lshlrev_b32 v6, 4, v6
    v_lshl_add_u32 v6, v7, 8, v6
    v_add_u32 v4, s48, v6
    buffer_load_dwordx4 v[8:11], v3, s[8:11], 0 offen offset:0 nt
    buffer_load_dwordx4 v[12:15], v3, s[8:11], 0 offen offset:128 nt
    buffer_load_dwordx4 v[16:19], v3, s[8:11], 0 offen offset:256 nt
    s_branch L_uend_4
L_w3_3:
    s_mov_b32 s55, 0
    s_mov_b32 s56, 0
    s_mov_b32 s57, 8192
    s_mul_i32 s67, s21, 36
    s_add_u32 s67, s67, s22
    s_lshr_b32 s0, s67, 4
    s_and_b32 s67, s67, 15
    s_mul_i32 s67, s67, 18
    s_add_u32 s67, s67, s0
    s_mul_i32 s44, s67, 3641
    s_lshr_b32 s44, s44, 16
    s_mul_i32 s45, s44, 18
    s_sub_u32 s45, s67, s45
    s_mul_i32 s46, s44, 72
    s_and_b32 s47, s46, 8
    s_and_b32 s46, s46, -16
    s_mul_i32 s48, s45, 110592
    s_add_u32 s46, s46, s48
    s_mov_b32 s48, 3216
    s_mul_i32 s51, s67, 7168
    s_mov_b32 s12, s26
    s_mov_b32 s13, s27
    s_mov_b32 s14, 0x1e6000
    s_mov_b32 s15, 0x20000
    v_add_u32 v64, 0, v1
    v_mul_u32_u24 v65, 4370, v64
    v_lshrrev_b32 v65, 16, v65
    v_mad_i32_i24 v66, v65, -15, v64
    v_mul_u32_u24 v66, 13108, v66
    v_lshrrev_b32 v66, 16, v66
    v_mul_u32_u24 v66, 1072, v66
    v_mad_u32_u24 v65, v65, s48, v66
    v_lshl_add_u32 v64, v64, 4, v65
    s_add_u32 m0, s56, 0
    s_nop 0
    buffer_load_dwordx4 v64, s[12:15], s46 offen nt lds
    v_add_u32 v64, 64, v1
    v_mul_u32_u24 v65, 4370, v64
    v_lshrrev_b32 v65, 16, v65
    v_mad_i32_i24 v66, v65, -15, v64
    v_mul_u32_u24 v66, 13108, v66
    v_lshrrev_b32 v66, 16, v66
    v_mul_u32_u24 v66, 1072, v66
    v_mad_u32_u24 v65, v65, s48, v66
    v_lshl_add_u32 v64, v64, 4, v65
    s_add_u32 m0, s56, 1024
    s_nop 0
    buffer_load_dwordx4 v64, s[12:15], s46 offen nt lds
    v_add_u32 v64, 128, v1
    v_mul_u32_u24 v65, 4370, v64
    v_lshrrev_b32 v65, 16, v65
    v_mad_i32_i24 v66, v65, -15, v64
    v_mul_u32_u24 v66, 13108, v66
    v_lshrrev_b32 v66, 16, v66
    v_mul_u32_u24 v66, 1072, v66
    v_mad_u32_u24 v65, v65, s48, v66
    v_lshl_add_u32 v64, v64, 4, v65
    s_add_u32 m0, s56, 2048
    s_nop 0
    buffer_load_dwordx4 v64, s[12:15], s46 offen nt lds
    v_add_u32 v64, 192, v1
    v_mul_u32_u24 v65, 4370, v64
    v_lshrrev_b32 v65, 16, v65
    v_mad_i32_i24 v66, v65, -15, v64
    v_mul_u32_u24 v66, 13108, v66
    v_lshrrev_b32 v66, 16, v66
    v_mul_u32_u24 v66, 1072, v66
    v_mad_u32_u24 v65, v65, s48, v66
    v_lshl_add_u32 v64, v64, 4, v65
    s_add_u32 m0, s56, 3072
    s_nop 0
    buffer_load_dwordx4 v64, s[12:15], s46 offen nt lds
    v_add_u32 v64, 256, v1
    v_mul_u32_u24 v65, 4370, v64
    v_lshrrev_b32 v65, 16, v65
    v_mad_i32_i24 v66, v65, -15, v64
    v_mul_u32_u24 v66, 13108, v66
    v_lshrrev_b32 v66, 16, v66
    v_mul_u32_u24 v66, 1072, v66
    v_mad_u32_u24 v65, v65, s48, v66
    v_lshl_add_u32 v64, v64, 4, v65
    s_add_u32 m0, s56, 4096
    s_nop 0
    buffer_load_dwordx4 v64, s[12:15], s46 offen nt lds
    v_add_u32 v64, 320, v1
    v_mul_u32_u24 v65, 4370, v64
    v_lshrrev_b32 v65, 16, v65
    v_mad_i32_i24 v66, v65, -15, v64
    v_mul_u32_u24 v66, 13108, v66
    v_lshrrev_b32 v66, 16, v66
    v_mul_u32_u24 v66, 1072, v66
    v_mad_u32_u24 v65, v65, s48, v66
    v_lshl_add_u32 v64, v64, 4, v65
    s_add_u32 m0, s56, 5120
    s_nop 0
    buffer_load_dwordx4 v64, s[12:15], s46 offen nt lds
    v_add_u32 v64, 384, v1
    v_mul_u32_u24 v65, 4370, v64
    v_lshrrev_b32 v65, 16, v65
    v_mad_i32_i24 v66, v65, -15, v64
    v_mul_u32_u24 v66, 13108, v66
    v_lshrrev_b32 v66, 16, v66
    v_mul_u32_u24 v66, 1072, v66
    v_mad_u32_u24 v65, v65, s48, v66
    v_lshl_add_u32 v64, v64, 4, v65
    s_add_u32 m0, s56, 6144
    s_nop 0
    buffer_load_dwordx4 v64, s[12:15], s46 offen nt lds
    v_add_u32 v64, 448, v1
    v_mul_u32_u24 v65, 4370, v64
    v_lshrrev_b32 v65, 16, v65
    v_mad_i32_i24 v66, v65, -15, v64
    v_mul_u32_u24 v66, 13108, v66
    v_lshrrev_b32 v66, 16, v66
    v_mul_u32_u24 v66, 1072, v66
    v_mad_u32_u24 v65, v65, s48, v66
    v_lshl_add_u32 v64, v64, 4, v65
    s_add_u32 m0, s56, 7168
    s_nop 0
    buffer_load_dwordx4 v64, s[12:15], s46 offen nt lds
    s_lshl_b32 s0, s44, 5
    s_add_u32 s0, s0, s45
    s_lshl_b32 s0, s0, 3
    s_add_u32 s0, s0, 131072
    s_cmp_ge_u32 s22, 4
    s_cbranch_scc1 L_uw_5
    s_mov_b32 s55, 1
    s_mul_i32 s67, s21, 36
    s_add_u32 s67, s67, s22
    s_add_u32 s67, s67, 32
    s_lshr_b32 s1, s67, 4
    s_and_b32 s67, s67, 15
    s_mul_i32 s67, s67, 18
    s_add_u32 s67, s67, s1
    s_mul_i32 s84, s67, 3641
    s_lshr_b32 s84, s84, 16
    s_mul_i32 s85, s84, 18
    s_sub_u32 s85, s67, s85
    s_mul_i32 s86, s84, 72
    s_and_b32 s87, s86, 8
    s_and_b32 s86, s86, -16
    s_mul_i32 s88, s85, 110592
    s_add_u32 s86, s86, s88
    s_mov_b32 s88, 3216
    s_mul_i32 s91, s67, 7168
    s_mov_b32 s12, s26
    s_mov_b32 s13, s27
    s_mov_b32 s14, 0x1e6000
    s_mov_b32 s15, 0x20000
    v_add_u32 v64, 0, v1
    v_mul_u32_u24 v65, 4370, v64
    v_lshrrev_b32 v65, 16, v65
    v_mad_i32_i24 v66, v65, -15, v64
    v_mul_u32_u24 v66, 13108, v66
    v_lshrrev_b32 v66, 16, v66
    v_mul_u32_u24 v66, 1072, v66
    v_mad_u32_u24 v65, v65, s88, v66
    v_lshl_add_u32 v64, v64, 4, v65
    s_add_u32 m0, s57, 0
    s_nop 0
    buffer_load_dwordx4 v64, s[12:15], s86 offen nt lds
    v_add_u32 v64, 64, v1
    v_mul_u32_u24 v65, 4370, v64
    v_lshrrev_b32 v65, 16, v65
    v_mad_i32_i24 v66, v65, -15, v64
    v_mul_u32_u24 v66, 13108, v66
    v_lshrrev_b32 v66, 16, v66
    v_mul_u32_u24 v66, 1072, v66
    v_mad_u32_u24 v65, v65, s88, v66
    v_lshl_add_u32 v64, v64, 4, v65
    s_add_u32 m0, s57, 1024
    s_nop 0
    buffer_load_dwordx4 v64, s[12:15], s86 offen nt lds
    v_add_u32 v64, 128, v1
    v_mul_u32_u24 v65, 4370, v64
    v_lshrrev_b32 v65, 16, v65
    v_mad_i32_i24 v66, v65, -15, v64
    v_mul_u32_u24 v66, 13108, v66
    v_lshrrev_b32 v66, 16, v66
    v_mul_u32_u24 v66, 1072, v66
    v_mad_u32_u24 v65, v65, s88, v66
    v_lshl_add_u32 v64, v64, 4, v65
    s_add_u32 m0, s57, 2048
    s_nop 0
    buffer_load_dwordx4 v64, s[12:15], s86 offen nt lds
    v_add_u32 v64, 192, v1
    v_mul_u32_u24 v65, 4370, v64
    v_lshrrev_b32 v65, 16, v65
    v_mad_i32_i24 v66, v65, -15, v64
    v_mul_u32_u24 v66, 13108, v66
    v_lshrrev_b32 v66, 16, v66
    v_mul_u32_u24 v66, 1072, v66
    v_mad_u32_u24 v65, v65, s88, v66
    v_lshl_add_u32 v64, v64, 4, v65
    s_add_u32 m0, s57, 3072
    s_nop 0
    buffer_load_dwordx4 v64, s[12:15], s86 offen nt lds
    v_add_u32 v64, 256, v1
    v_mul_u32_u24 v65, 4370, v64
    v_lshrrev_b32 v65, 16, v65
    v_mad_i32_i24 v66, v65, -15, v64
    v_mul_u32_u24 v66, 13108, v66
    v_lshrrev_b32 v66, 16, v66
    v_mul_u32_u24 v66, 1072, v66
    v_mad_u32_u24 v65, v65, s88, v66
    v_lshl_add_u32 v64, v64, 4, v65
    s_add_u32 m0, s57, 4096
    s_nop 0
    buffer_load_dwordx4 v64, s[12:15], s86 offen nt lds
    v_add_u32 v64, 320, v1
    v_mul_u32_u24 v65, 4370, v64
    v_lshrrev_b32 v65, 16, v65
    v_mad_i32_i24 v66, v65, -15, v64
    v_mul_u32_u24 v66, 13108, v66
    v_lshrrev_b32 v66, 16, v66
    v_mul_u32_u24 v66, 1072, v66
    v_mad_u32_u24 v65, v65, s88, v66
    v_lshl_add_u32 v64, v64, 4, v65
    s_add_u32 m0, s57, 5120
    s_nop 0
    buffer_load_dwordx4 v64, s[12:15], s86 offen nt lds
    v_add_u32 v64, 384, v1
    v_mul_u32_u24 v65, 4370, v64
    v_lshrrev_b32 v65, 16, v65
    v_mad_i32_i24 v66, v65, -15, v64
    v_mul_u32_u24 v66, 13108, v66
    v_lshrrev_b32 v66, 16, v66
    v_mul_u32_u24 v66, 1072, v66
    v_mad_u32_u24 v65, v65, s88, v66
    v_lshl_add_u32 v64, v64, 4, v65
    s_add_u32 m0, s57, 6144
    s_nop 0
    buffer_load_dwordx4 v64, s[12:15], s86 offen nt lds
    v_add_u32 v64, 448, v1
    v_mul_u32_u24 v65, 4370, v64
    v_lshrrev_b32 v65, 16, v65
    v_mad_i32_i24 v66, v65, -15, v64
    v_mul_u32_u24 v66, 13108, v66
    v_lshrrev_b32 v66, 16, v66
    v_mul_u32_u24 v66, 1072, v66
    v_mad_u32_u24 v65, v65, s88, v66
    v_lshl_add_u32 v64, v64, 4, v65
    s_add_u32 m0, s57, 7168
    s_nop 0
    buffer_load_dwordx4 v64, s[12:15], s86 offen nt lds
    s_lshl_b32 s1, s84, 5
    s_add_u32 s1, s1, s85
    s_lshl_b32 s1, s1, 3
    s_add_u32 s1, s1, 131072
    s_branch L_uend_4
L_uw_5:
    s_cmp_ge_u32 s22, 18
    s_cbranch_scc1 L_uend_4
    s_mul_i32 s67, s21, 14
    s_add_u32 s67, s67, s22
    s_sub_u32 s67, s67, 4
    s_cmp_ge_u32 s67, 108
    s_cbranch_scc1 L_uend_4
    s_mov_b32 s55, 2
    s_mul_i32 s84, s67, 3641
    s_lshr_b32 s84, s84, 16
    s_mul_i32 s85, s84, 18
    s_sub_u32 s85, s67, s85
    s_mul_i32 s86, s85, 41472
    s_sub_u32 s87, s85, 16
    s_mul_i32 s87, s87, 331776
    s_add_u32 s87, s87, 18432
    s_cmp_lt_u32 s85, 16
    s_cselect_b32 s86, s86, s87
    s_mov_b32 s88, 82944
    s_mov_b32 s89, 41472
    s_cselect_b32 s88, 4608, s88
    s_cselect_b32 s89, 23040, s89
    s_mul_i32 s87, s84, 192
    s_add_u32 s86, s86, s87
    s_mov_b32 s90, 1152
    s_mul_i32 s91, s67, 6144
    s_mov_b32 s12, s28
    s_mov_b32 s13, s29
    s_mov_b32 s14, 0xa2000
    s_mov_b32 s15, 0x20000
    v_add_u32 v64, 0, v1
    v_mul_u32_u24 v65, 5462, v64
    v_lshrrev_b32 v65, 16, v65
    v_mul_u32_u24 v66, 12, v65
    v_sub_u32 v64, v64, v66
    v_lshlrev_b32 v64, 4, v64
    v_lshrrev_b32 v66, 3, v65
    v_mul_lo_u32 v66, v66, s88
    v_bfe_u32 v67, v65, 2, 1
    v_mul_lo_u32 v67, v67, s89
    v_and_b32 v65, 3, v65
    v_mul_lo_u32 v65, v65, s90
    v_add3_u32 v64, v64, v66, v67
    v_add3_u32 v64, v64, v65, s86
    s_add_u32 m0, s57, 0
    s_nop 0
    buffer_load_dwordx4 v64, s[12:15], 0 offen nt lds
    v_add_u32 v64, 64, v1
    v_mul_u32_u24 v65, 5462, v64
    v_lshrrev_b32 v65, 16, v65
    v_mul_u32_u24 v66, 12, v65
    v_sub_u32 v64, v64, v66
    v_lshlrev_b32 v64, 4, v64
    v_lshrrev_b32 v66, 3, v65
    v_mul_lo_u32 v66, v66, s88
    v_bfe_u32 v67, v65, 2, 1
    v_mul_lo_u32 v67, v67, s89
    v_and_b32 v65, 3, v65
    v_mul_lo_u32 v65, v65, s90
    v_add3_u32 v64, v64, v66, v67
    v_add3_u32 v64, v64, v65, s86
    s_add_u32 m0, s57, 1024
    s_nop 0
    buffer_load_dwordx4 v64, s[12:15], 0 offen nt lds
    v_add_u32 v64, 128, v1
    v_mul_u32_u24 v65, 5462, v64
    v_lshrrev_b32 v65, 16, v65
    v_mul_u32_u24 v66, 12, v65
    v_sub_u32 v64, v64, v66
    v_lshlrev_b32 v64, 4, v64
    v_lshrrev_b32 v66, 3, v65
    v_mul_lo_u32 v66, v66, s88
    v_bfe_u32 v67, v65, 2, 1
    v_mul_lo_u32 v67, v67, s89
    v_and_b32 v65, 3, v65
    v_mul_lo_u32 v65, v65, s90
    v_add3_u32 v64, v64, v66, v67
    v_add3_u32 v64, v64, v65, s86
    s_add_u32 m0, s57, 2048
    s_nop 0
    buffer_load_dwordx4 v64, s[12:15], 0 offen nt lds
    v_add_u32 v64, 192, v1
    v_mul_u32_u24 v65, 5462, v64
    v_lshrrev_b32 v65, 16, v65
    v_mul_u32_u24 v66, 12, v65
    v_sub_u32 v64, v64, v66
    v_lshlrev_b32 v64, 4, v64
    v_lshrrev_b32 v66, 3, v65
    v_mul_lo_u32 v66, v66, s88
    v_bfe_u32 v67, v65, 2, 1
    v_mul_lo_u32 v67, v67, s89
    v_and_b32 v65, 3, v65
    v_mul_lo_u32 v65, v65, s90
    v_add3_u32 v64, v64, v66, v67
    v_add3_u32 v64, v64, v65, s86
    s_add_u32 m0, s57, 3072
    s_nop 0
    buffer_load_dwordx4 v64, s[12:15], 0 offen nt lds
    v_add_u32 v64, 256, v1
    v_mul_u32_u24 v65, 5462, v64
    v_lshrrev_b32 v65, 16, v65
    v_mul_u32_u24 v66, 12, v65
    v_sub_u32 v64, v64, v66
    v_lshlrev_b32 v64, 4, v64
    v_lshrrev_b32 v66, 3, v65
    v_mul_lo_u32 v66, v66, s88
    v_bfe_u32 v67, v65, 2, 1
    v_mul_lo_u32 v67, v67, s89
    v_and_b32 v65, 3, v65
    v_mul_lo_u32 v65, v65, s90
    v_add3_u32 v64, v64, v66, v67
    v_add3_u32 v64, v64, v65, s86
    s_add_u32 m0, s57, 4096
    s_nop 0
    buffer_load_dwordx4 v64, s[12:15], 0 offen nt lds
    v_add_u32 v64, 320, v1
    v_mul_u32_u24 v65, 5462, v64
    v_lshrrev_b32 v65, 16, v65
    v_mul_u32_u24 v66, 12, v65
    v_sub_u32 v64, v64, v66
    v_lshlrev_b32 v64, 4, v64
    v_lshrrev_b32 v66, 3, v65
    v_mul_lo_u32 v66, v66, s88
    v_bfe_u32 v67, v65, 2, 1
    v_mul_lo_u32 v67, v67, s89
    v_and_b32 v65, 3, v65
    v_mul_lo_u32 v65, v65, s90
    v_add3_u32 v64, v64, v66, v67
    v_add3_u32 v64, v64, v65, s86
    s_add_u32 m0, s57, 5120
    s_nop 0
    buffer_load_dwordx4 v64, s[12:15], 0 offen nt lds
    s_lshl_b32 s1, s84, 5
    s_add_u32 s1, s1, s85
    s_lshl_b32 s1, s1, 3
    s_add_u32 s1, s1, 135168
L_uend_4:
    v_add_u32 v64, 0, v1
    v_mul_u32_u24 v65, 3641, v64
    v_lshrrev_b32 v65, 16, v65
    v_mul_u32_u24 v66, 18, v65
    v_sub_u32 v64, v64, v66
    v_lshl_or_b32 v220, v64, 8, v65
    v_add_u32 v64, 64, v1
    v_mul_u32_u24 v65, 3641, v64
    v_lshrrev_b32 v65, 16, v65
    v_mul_u32_u24 v66, 18, v65
    v_sub_u32 v64, v64, v66
    v_lshl_or_b32 v221, v64, 8, v65
    v_add_u32 v64, 128, v1
    v_mul_u32_u24 v65, 3641, v64
    v_lshrrev_b32 v65, 16, v65
    v_mul_u32_u24 v66, 18, v65
    v_sub_u32 v64, v64, v66
    v_lshl_or_b32 v222, v64, 8, v65
    v_add_u32 v64, 192, v1
    v_mul_u32_u24 v65, 3641, v64
    v_lshrrev_b32 v65, 16, v65
    v_mul_u32_u24 v66, 18, v65
    v_sub_u32 v64, v64, v66
    v_lshl_or_b32 v223, v64, 8, v65
    v_add_u32 v64, 256, v1
    v_mul_u32_u24 v65, 3641, v64
    v_lshrrev_b32 v65, 16, v65
    v_mul_u32_u24 v66, 18, v65
    v_sub_u32 v64, v64, v66
    v_lshl_or_b32 v224, v64, 8, v65
    v_add_u32 v64, 320, v1
    v_mul_u32_u24 v65, 3641, v64
    v_lshrrev_b32 v65, 16, v65
    v_mul_u32_u24 v66, 18, v65
    v_sub_u32 v64, v64, v66
    v_lshl_or_b32 v225, v64, 8, v65
    v_add_u32 v64, 384, v1
    v_mul_u32_u24 v65, 3641, v64
    v_lshrrev_b32 v65, 16, v65
    v_mul_u32_u24 v66, 18, v65
    v_sub_u32 v64, v64, v66
    v_lshl_or_b32 v226, v64, 8, v65
    v_add_u32 v64, 448, v1
    v_mul_u32_u24 v65, 3641, v64
    v_lshrrev_b32 v65, 16, v65
    v_mul_u32_u24 v66, 18, v65
    v_sub_u32 v64, v64, v66
    v_lshl_or_b32 v227, v64, 8, v65
    v_add_u32 v64, 512, v1
    v_mul_u32_u24 v65, 3641, v64
    v_lshrrev_b32 v65, 16, v65
    v_mul_u32_u24 v66, 18, v65
    v_sub_u32 v64, v64, v66
    v_lshl_or_b32 v228, v64, 8, v65
    s_lshl_b32 s3, s21, 7
    s_lshl_b32 s52, s22, 2
    s_add_u32 s53, s52, s20
    s_add_u32 s3, s3, s53
    s_lshr_b32 s52, s3, 5
    s_and_b32 s3, s3, 31
    s_mul_i32 s3, s3, 36
    s_add_u32 s3, s3, s52
    s_cmp_ge_u32 s3, 1152
    s_cbranch_scc1 L_ud_6
    s_mul_i32 s64, s3, 1821
    s_lshr_b32 s64, s64, 16
    s_mul_i32 s92, s64, 36
    s_sub_u32 s92, s3, s92
    s_and_b32 s93, s92, 1
    s_lshr_b32 s94, s92, 1
    s_cmp_eq_u32 s93, 0
    s_cselect_b32 s16, s32, s34
    s_cselect_b32 s17, s33, s35
    s_mul_i32 s58, s94, 294912
    s_mul_i32 s95, s64, 288
    s_add_u32 s58, s58, s95
    s_mov_b32 s59, 73728
    s_mov_b32 s60, 36864
    s_mov_b32 s61, 9216
    s_branch L_udone_7
L_ud_6:
    s_sub_u32 s92, s3, 1152
    s_mul_i32 s64, s92, 3641
    s_lshr_b32 s64, s64, 16
    s_mul_i32 s93, s64, 18
    s_sub_u32 s92, s92, s93
    s_and_b32 s93, s64, 3
    s_and_b32 s94, s93, 1
    s_mov_b32 s16, s36
    s_mov_b32 s17, s37
    s_mov_b32 s61, 1152
    s_cmp_eq_u32 s94, 0
    s_mov_b32 s97, -165888
    s_cselect_b32 s97, 165888, s97
    s_mov_b32 s59, 9216
    s_mov_b32 s60, 4608
    s_cmp_ge_u32 s92, 4
    s_cbranch_scc1 L_ush_8
    s_mov_b32 s95, s93
    s_lshl_b32 s96, s92, 5
    s_branch L_urows_10
L_ush_8:
    s_cmp_ge_u32 s92, 6
    s_cbranch_scc1 L_urm_9
    s_sub_u32 s95, s92, 4
    s_lshl_b32 s95, s95, 1
    s_xor_b32 s95, s95, s93
    s_mov_b32 s96, 128
    s_mov_b32 s59, 4608
    s_mov_b32 s60, s97
    s_branch L_urows_10
L_urm_9:
    s_sub_u32 s95, s92, 6
    s_mul_i32 s96, s95, 21846
    s_lshr_b32 s96, s96, 16
    s_mul_i32 s97, s96, 3
    s_sub_u32 s95, s95, s97
    s_add_u32 s95, s95, 1
    s_xor_b32 s95, s95, s93
    s_lshl_b32 s96, s96, 5
L_urows_10:
    s_mul_i32 s95, s95, 144
    s_add_u32 s95, s95, s96
    s_lshr_b32 s96, s64, 2
    s_mul_i32 s96, s96, 576
    s_add_u32 s95, s95, s96
    s_mul_i32 s95, s95, 1152
    s_mul_i32 s96, s93, 288
    s_add_u32 s58, s95, s96
L_udone_7:
    s_mov_b32 s18, 0x510000
    s_mov_b32 s19, 0x20000
    v_bfe_u32 v64, v220, 3, 2
    v_mul_u32_u24 v64, s59, v64
    v_bfe_u32 v65, v220, 2, 1
    v_mul_lo_u32 v65, v65, s60
    v_and_b32 v66, 3, v220
    v_mul_u32_u24 v66, s61, v66
    v_add3_u32 v64, v64, v65, v66
    v_lshrrev_b32 v65, 8, v220
    v_lshl_add_u32 v64, v65, 4, v64
    v_add_u32 v229, s58, v64
    v_bfe_u32 v64, v221, 3, 2
    v_mul_u32_u24 v64, s59, v64
    v_bfe_u32 v65, v221, 2, 1
    v_mul_lo_u32 v65, v65, s60
    v_and_b32 v66, 3, v221
    v_mul_u32_u24 v66, s61, v66
    v_add3_u32 v64, v64, v65, v66
    v_lshrrev_b32 v65, 8, v221
    v_lshl_add_u32 v64, v65, 4, v64
    v_add_u32 v230, s58, v64
    v_bfe_u32 v64, v222, 3, 2
    v_mul_u32_u24 v64, s59, v64
    v_bfe_u32 v65, v222, 2, 1
    v_mul_lo_u32 v65, v65, s60
    v_and_b32 v66, 3, v222
    v_mul_u32_u24 v66, s61, v66
    v_add3_u32 v64, v64, v65, v66
    v_lshrrev_b32 v65, 8, v222
    v_lshl_add_u32 v64, v65, 4, v64
    v_add_u32 v231, s58, v64
    v_bfe_u32 v64, v223, 3, 2
    v_mul_u32_u24 v64, s59, v64
    v_bfe_u32 v65, v223, 2, 1
    v_mul_lo_u32 v65, v65, s60
    v_and_b32 v66, 3, v223
    v_mul_u32_u24 v66, s61, v66
    v_add3_u32 v64, v64, v65, v66
    v_lshrrev_b32 v65, 8, v223
    v_lshl_add_u32 v64, v65, 4, v64
    v_add_u32 v232, s58, v64
    v_bfe_u32 v64, v224, 3, 2
    v_mul_u32_u24 v64, s59, v64
    v_bfe_u32 v65, v224, 2, 1
    v_mul_lo_u32 v65, v65, s60
    v_and_b32 v66, 3, v224
    v_mul_u32_u24 v66, s61, v66
    v_add3_u32 v64, v64, v65, v66
    v_lshrrev_b32 v65, 8, v224
    v_lshl_add_u32 v64, v65, 4, v64
    v_add_u32 v233, s58, v64
    v_bfe_u32 v64, v225, 3, 2
    v_mul_u32_u24 v64, s59, v64
    v_bfe_u32 v65, v225, 2, 1
    v_mul_lo_u32 v65, v65, s60
    v_and_b32 v66, 3, v225
    v_mul_u32_u24 v66, s61, v66
    v_add3_u32 v64, v64, v65, v66
    v_lshrrev_b32 v65, 8, v225
    v_lshl_add_u32 v64, v65, 4, v64
    v_add_u32 v234, s58, v64
    v_bfe_u32 v64, v226, 3, 2
    v_mul_u32_u24 v64, s59, v64
    v_bfe_u32 v65, v226, 2, 1
    v_mul_lo_u32 v65, v65, s60
    v_and_b32 v66, 3, v226
    v_mul_u32_u24 v66, s61, v66
    v_add3_u32 v64, v64, v65, v66
    v_lshrrev_b32 v65, 8, v226
    v_lshl_add_u32 v64, v65, 4, v64
    v_add_u32 v235, s58, v64
    v_bfe_u32 v64, v227, 3, 2
    v_mul_u32_u24 v64, s59, v64
    v_bfe_u32 v65, v227, 2, 1
    v_mul_lo_u32 v65, v65, s60
    v_and_b32 v66, 3, v227
    v_mul_u32_u24 v66, s61, v66
    v_add3_u32 v64, v64, v65, v66
    v_lshrrev_b32 v65, 8, v227
    v_lshl_add_u32 v64, v65, 4, v64
    v_add_u32 v236, s58, v64
    v_bfe_u32 v64, v228, 3, 2
    v_mul_u32_u24 v64, s59, v64
    v_bfe_u32 v65, v228, 2, 1
    v_mul_lo_u32 v65, v65, s60
    v_and_b32 v66, 3, v228
    v_mul_u32_u24 v66, s61, v66
    v_add3_u32 v64, v64, v65, v66
    v_lshrrev_b32 v65, 8, v228
    v_lshl_add_u32 v64, v65, 4, v64
    v_add_u32 v237, s58, v64
    s_mov_b32 s30, -1
    s_mov_b32 s31, -1
    s_mul_i32 s54, s21, 72
    s_add_u32 s54, s54, 1152
    s_cmp_ge_u32 s22, 24
    s_cbranch_scc1 L_ui_11
    s_cmp_lg_u32 s20, 3
    s_cbranch_scc1 L_ue_14
    s_add_u32 s30, s54, s22
    s_add_u32 s30, s30, 48
    s_branch L_ub_13
L_ui_11:
    s_sub_u32 s53, s53, 96
    s_add_u32 s31, s54, s53
    s_add_u32 s30, s31, -16
    s_add_u32 s31, s31, 16
    s_cmp_ge_u32 s53, 16
    s_cbranch_scc1 L_ud_12
    s_lshl_b32 s30, s21, 4
    s_add_u32 s30, s30, s53
    s_add_u32 s30, s30, 1024
    s_lshr_b32 s52, s30, 5
    s_and_b32 s30, s30, 31
    s_mul_i32 s30, s30, 36
    s_add_u32 s30, s30, s52
L_ud_12:
L_ub_13:
L_ue_14:
    v_mov_b32 v238, 0
    v_mov_b32 v239, 0
    v_mov_b32 v240, 0
    v_mov_b32 v241, 0
    v_mov_b32 v242, 0
    v_mov_b32 v243, 0
    v_mov_b32 v244, 0
    v_mov_b32 v245, 0
    v_mov_b32 v246, 0
    s_mov_b32 s14, 0
    s_cmp_eq_u32 s30, -1
    s_cbranch_scc1 L_absent_15
    s_cmp_ge_u32 s30, 1152
    s_cbranch_scc1 L_ud_16
    s_mul_i32 s64, s30, 1821
    s_lshr_b32 s64, s64, 16
    s_mul_i32 s92, s64, 36
    s_sub_u32 s92, s30, s92
    s_and_b32 s93, s92, 1
    s_lshr_b32 s94, s92, 1
    s_cmp_eq_u32 s93, 0
    s_cselect_b32 s12, s32, s34
    s_cselect_b32 s13, s33, s35
    s_mul_i32 s58, s94, 294912
    s_mul_i32 s95, s64, 288
    s_add_u32 s58, s58, s95
    s_mov_b32 s59, 73728
    s_mov_b32 s60, 36864
    s_mov_b32 s61, 9216
    s_branch L_udone_17
L_ud_16:
    s_sub_u32 s92, s30, 1152
    s_mul_i32 s64, s92, 3641
    s_lshr_b32 s64, s64, 16
    s_mul_i32 s93, s64, 18
    s_sub_u32 s92, s92, s93
    s_and_b32 s93, s64, 3
    s_and_b32 s94, s93, 1
    s_mov_b32 s12, s36
    s_mov_b32 s13, s37
    s_mov_b32 s61, 1152
    s_cmp_eq_u32 s94, 0
    s_mov_b32 s97, -165888
    s_cselect_b32 s97, 165888, s97
    s_mov_b32 s59, 9216
    s_mov_b32 s60, 4608
    s_cmp_ge_u32 s92, 4
    s_cbranch_scc1 L_ush_18
    s_mov_b32 s95, s93
    s_lshl_b32 s96, s92, 5
    s_branch L_urows_20
L_ush_18:
    s_cmp_ge_u32 s92, 6
    s_cbranch_scc1 L_urm_19
    s_sub_u32 s95, s92, 4
    s_lshl_b32 s95, s95, 1
    s_xor_b32 s95, s95, s93
    s_mov_b32 s96, 128
    s_mov_b32 s59, 4608
    s_mov_b32 s60, s97
    s_branch L_urows_20
L_urm_19:
    s_sub_u32 s95, s92, 6
    s_mul_i32 s96, s95, 21846
    s_lshr_b32 s96, s96, 16
    s_mul_i32 s97, s96, 3
    s_sub_u32 s95, s95, s97
    s_add_u32 s95, s95, 1
    s_xor_b32 s95, s95, s93
    s_lshl_b32 s96, s96, 5
L_urows_20:
    s_mul_i32 s95, s95, 144
    s_add_u32 s95, s95, s96
    s_lshr_b32 s96, s64, 2
    s_mul_i32 s96, s96, 576
    s_add_u32 s95, s95, s96
    s_mul_i32 s95, s95, 1152
    s_mul_i32 s96, s93, 288
    s_add_u32 s58, s95, s96
L_udone_17:
    s_mov_b32 s14, 0x510000
    s_mov_b32 s15, 0x20000
    v_bfe_u32 v64, v220, 3, 2
    v_mul_u32_u24 v64, s59, v64
    v_bfe_u32 v65, v220, 2, 1
    v_mul_lo_u32 v65, v65, s60
    v_and_b32 v66, 3, v220
    v_mul_u32_u24 v66, s61, v66
    v_add3_u32 v64, v64, v65, v66
    v_lshrrev_b32 v65, 8, v220
    v_lshl_add_u32 v64, v65, 4, v64
    v_add_u32 v238, s58, v64
    v_bfe_u32 v64, v221, 3, 2
    v_mul_u32_u24 v64, s59, v64
    v_bfe_u32 v65, v221, 2, 1
    v_mul_lo_u32 v65, v65, s60
    v_and_b32 v66, 3, v221
    v_mul_u32_u24 v66, s61, v66
    v_add3_u32 v64, v64, v65, v66
    v_lshrrev_b32 v65, 8, v221
    v_lshl_add_u32 v64, v65, 4, v64
    v_add_u32 v239, s58, v64
    v_bfe_u32 v64, v222, 3, 2
    v_mul_u32_u24 v64, s59, v64
    v_bfe_u32 v65, v222, 2, 1
    v_mul_lo_u32 v65, v65, s60
    v_and_b32 v66, 3, v222
    v_mul_u32_u24 v66, s61, v66
    v_add3_u32 v64, v64, v65, v66
    v_lshrrev_b32 v65, 8, v222
    v_lshl_add_u32 v64, v65, 4, v64
    v_add_u32 v240, s58, v64
    v_bfe_u32 v64, v223, 3, 2
    v_mul_u32_u24 v64, s59, v64
    v_bfe_u32 v65, v223, 2, 1
    v_mul_lo_u32 v65, v65, s60
    v_and_b32 v66, 3, v223
    v_mul_u32_u24 v66, s61, v66
    v_add3_u32 v64, v64, v65, v66
    v_lshrrev_b32 v65, 8, v223
    v_lshl_add_u32 v64, v65, 4, v64
    v_add_u32 v241, s58, v64
    v_bfe_u32 v64, v224, 3, 2
    v_mul_u32_u24 v64, s59, v64
    v_bfe_u32 v65, v224, 2, 1
    v_mul_lo_u32 v65, v65, s60
    v_and_b32 v66, 3, v224
    v_mul_u32_u24 v66, s61, v66
    v_add3_u32 v64, v64, v65, v66
    v_lshrrev_b32 v65, 8, v224
    v_lshl_add_u32 v64, v65, 4, v64
    v_add_u32 v242, s58, v64
    v_bfe_u32 v64, v225, 3, 2
    v_mul_u32_u24 v64, s59, v64
    v_bfe_u32 v65, v225, 2, 1
    v_mul_lo_u32 v65, v65, s60
    v_and_b32 v66, 3, v225
    v_mul_u32_u24 v66, s61, v66
    v_add3_u32 v64, v64, v65, v66
    v_lshrrev_b32 v65, 8, v225
    v_lshl_add_u32 v64, v65, 4, v64
    v_add_u32 v243, s58, v64
    v_bfe_u32 v64, v226, 3, 2
    v_mul_u32_u24 v64, s59, v64
    v_bfe_u32 v65, v226, 2, 1
    v_mul_lo_u32 v65, v65, s60
    v_and_b32 v66, 3, v226
    v_mul_u32_u24 v66, s61, v66
    v_add3_u32 v64, v64, v65, v66
    v_lshrrev_b32 v65, 8, v226
    v_lshl_add_u32 v64, v65, 4, v64
    v_add_u32 v244, s58, v64
    v_bfe_u32 v64, v227, 3, 2
    v_mul_u32_u24 v64, s59, v64
    v_bfe_u32 v65, v227, 2, 1
    v_mul_lo_u32 v65, v65, s60
    v_and_b32 v66, 3, v227
    v_mul_u32_u24 v66, s61, v66
    v_add3_u32 v64, v64, v65, v66
    v_lshrrev_b32 v65, 8, v227
    v_lshl_add_u32 v64, v65, 4, v64
    v_add_u32 v245, s58, v64
    v_bfe_u32 v64, v228, 3, 2
    v_mul_u32_u24 v64, s59, v64
    v_bfe_u32 v65, v228, 2, 1
    v_mul_lo_u32 v65, v65, s60
    v_and_b32 v66, 3, v228
    v_mul_u32_u24 v66, s61, v66
    v_add3_u32 v64, v64, v65, v66
    v_lshrrev_b32 v65, 8, v228
    v_lshl_add_u32 v64, v65, 4, v64
    v_add_u32 v246, s58, v64
L_absent_15:
    v_mov_b32 v247, 0
    v_mov_b32 v248, 0
    v_mov_b32 v249, 0
    v_mov_b32 v250, 0
    v_mov_b32 v251, 0
    v_mov_b32 v252, 0
    v_mov_b32 v253, 0
    v_mov_b32 v254, 0
    v_mov_b32 v255, 0
    s_mov_b32 s10, 0
    s_cmp_eq_u32 s31, -1
    s_cbranch_scc1 L_absent_21
    s_cmp_ge_u32 s31, 1152
    s_cbranch_scc1 L_ud_22
    s_mul_i32 s64, s31, 1821
    s_lshr_b32 s64, s64, 16
    s_mul_i32 s92, s64, 36
    s_sub_u32 s92, s31, s92
    s_and_b32 s93, s92, 1
    s_lshr_b32 s94, s92, 1
    s_cmp_eq_u32 s93, 0
    s_cselect_b32 s8, s32, s34
    s_cselect_b32 s9, s33, s35
    s_mul_i32 s58, s94, 294912
    s_mul_i32 s95, s64, 288
    s_add_u32 s58, s58, s95
    s_mov_b32 s59, 73728
    s_mov_b32 s60, 36864
    s_mov_b32 s61, 9216
    s_branch L_udone_23
L_ud_22:
    s_sub_u32 s92, s31, 1152
    s_mul_i32 s64, s92, 3641
    s_lshr_b32 s64, s64, 16
    s_mul_i32 s93, s64, 18
    s_sub_u32 s92, s92, s93
    s_and_b32 s93, s64, 3
    s_and_b32 s94, s93, 1
    s_mov_b32 s8, s36
    s_mov_b32 s9, s37
    s_mov_b32 s61, 1152
    s_cmp_eq_u32 s94, 0
    s_mov_b32 s97, -165888
    s_cselect_b32 s97, 165888, s97
    s_mov_b32 s59, 9216
    s_mov_b32 s60, 4608
    s_cmp_ge_u32 s92, 4
    s_cbranch_scc1 L_ush_24
    s_mov_b32 s95, s93
    s_lshl_b32 s96, s92, 5
    s_branch L_urows_26
L_ush_24:
    s_cmp_ge_u32 s92, 6
    s_cbranch_scc1 L_urm_25
    s_sub_u32 s95, s92, 4
    s_lshl_b32 s95, s95, 1
    s_xor_b32 s95, s95, s93
    s_mov_b32 s96, 128
    s_mov_b32 s59, 4608
    s_mov_b32 s60, s97
    s_branch L_urows_26
L_urm_25:
    s_sub_u32 s95, s92, 6
    s_mul_i32 s96, s95, 21846
    s_lshr_b32 s96, s96, 16
    s_mul_i32 s97, s96, 3
    s_sub_u32 s95, s95, s97
    s_add_u32 s95, s95, 1
    s_xor_b32 s95, s95, s93
    s_lshl_b32 s96, s96, 5
L_urows_26:
    s_mul_i32 s95, s95, 144
    s_add_u32 s95, s95, s96
    s_lshr_b32 s96, s64, 2
    s_mul_i32 s96, s96, 576
    s_add_u32 s95, s95, s96
    s_mul_i32 s95, s95, 1152
    s_mul_i32 s96, s93, 288
    s_add_u32 s58, s95, s96
L_udone_23:
    s_mov_b32 s10, 0x510000
    s_mov_b32 s11, 0x20000
    v_bfe_u32 v64, v220, 3, 2
    v_mul_u32_u24 v64, s59, v64
    v_bfe_u32 v65, v220, 2, 1
    v_mul_lo_u32 v65, v65, s60
    v_and_b32 v66, 3, v220
    v_mul_u32_u24 v66, s61, v66
    v_add3_u32 v64, v64, v65, v66
    v_lshrrev_b32 v65, 8, v220
    v_lshl_add_u32 v64, v65, 4, v64
    v_add_u32 v247, s58, v64
    v_bfe_u32 v64, v221, 3, 2
    v_mul_u32_u24 v64, s59, v64
    v_bfe_u32 v65, v221, 2, 1
    v_mul_lo_u32 v65, v65, s60
    v_and_b32 v66, 3, v221
    v_mul_u32_u24 v66, s61, v66
    v_add3_u32 v64, v64, v65, v66
    v_lshrrev_b32 v65, 8, v221
    v_lshl_add_u32 v64, v65, 4, v64
    v_add_u32 v248, s58, v64
    v_bfe_u32 v64, v222, 3, 2
    v_mul_u32_u24 v64, s59, v64
    v_bfe_u32 v65, v222, 2, 1
    v_mul_lo_u32 v65, v65, s60
    v_and_b32 v66, 3, v222
    v_mul_u32_u24 v66, s61, v66
    v_add3_u32 v64, v64, v65, v66
    v_lshrrev_b32 v65, 8, v222
    v_lshl_add_u32 v64, v65, 4, v64
    v_add_u32 v249, s58, v64
    v_bfe_u32 v64, v223, 3, 2
    v_mul_u32_u24 v64, s59, v64
    v_bfe_u32 v65, v223, 2, 1
    v_mul_lo_u32 v65, v65, s60
    v_and_b32 v66, 3, v223
    v_mul_u32_u24 v66, s61, v66
    v_add3_u32 v64, v64, v65, v66
    v_lshrrev_b32 v65, 8, v223
    v_lshl_add_u32 v64, v65, 4, v64
    v_add_u32 v250, s58, v64
    v_bfe_u32 v64, v224, 3, 2
    v_mul_u32_u24 v64, s59, v64
    v_bfe_u32 v65, v224, 2, 1
    v_mul_lo_u32 v65, v65, s60
    v_and_b32 v66, 3, v224
    v_mul_u32_u24 v66, s61, v66
    v_add3_u32 v64, v64, v65, v66
    v_lshrrev_b32 v65, 8, v224
    v_lshl_add_u32 v64, v65, 4, v64
    v_add_u32 v251, s58, v64
    v_bfe_u32 v64, v225, 3, 2
    v_mul_u32_u24 v64, s59, v64
    v_bfe_u32 v65, v225, 2, 1
    v_mul_lo_u32 v65, v65, s60
    v_and_b32 v66, 3, v225
    v_mul_u32_u24 v66, s61, v66
    v_add3_u32 v64, v64, v65, v66
    v_lshrrev_b32 v65, 8, v225
    v_lshl_add_u32 v64, v65, 4, v64
    v_add_u32 v252, s58, v64
    v_bfe_u32 v64, v226, 3, 2
    v_mul_u32_u24 v64, s59, v64
    v_bfe_u32 v65, v226, 2, 1
    v_mul_lo_u32 v65, v65, s60
    v_and_b32 v66, 3, v226
    v_mul_u32_u24 v66, s61, v66
    v_add3_u32 v64, v64, v65, v66
    v_lshrrev_b32 v65, 8, v226
    v_lshl_add_u32 v64, v65, 4, v64
    v_add_u32 v253, s58, v64
    v_bfe_u32 v64, v227, 3, 2
    v_mul_u32_u24 v64, s59, v64
    v_bfe_u32 v65, v227, 2, 1
    v_mul_lo_u32 v65, v65, s60
    v_and_b32 v66, 3, v227
    v_mul_u32_u24 v66, s61, v66
    v_add3_u32 v64, v64, v65, v66
    v_lshrrev_b32 v65, 8, v227
    v_lshl_add_u32 v64, v65, 4, v64
    v_add_u32 v254, s58, v64
    v_bfe_u32 v64, v228, 3, 2
    v_mul_u32_u24 v64, s59, v64
    v_bfe_u32 v65, v228, 2, 1
    v_mul_lo_u32 v65, v65, s60
    v_and_b32 v66, 3, v228
    v_mul_u32_u24 v66, s61, v66
    v_add3_u32 v64, v64, v65, v66
    v_lshrrev_b32 v65, 8, v228
    v_lshl_add_u32 v64, v65, 4, v64
    v_add_u32 v255, s58, v64
L_absent_21:
    s_cmp_eq_u32 s20, 3
    s_cbranch_scc1 L_w3_30
    s_waitcnt vmcnt(0)
    v_lshlrev_b32 v20, 16, v8
    v_and_b32 v21, 0xffff0000, v8
    v_lshlrev_b32 v22, 16, v9
    v_and_b32 v23, 0xffff0000, v9
    v_lshlrev_b32 v24, 16, v10
    v_and_b32 v25, 0xffff0000, v10
    v_lshlrev_b32 v26, 16, v11
    v_and_b32 v27, 0xffff0000, v11
    v_lshlrev_b32 v28, 16, v12
    v_and_b32 v29, 0xffff0000, v12
    v_lshlrev_b32 v30, 16, v13
    v_and_b32 v31, 0xffff0000, v13
    v_lshlrev_b32 v32, 16, v14
    v_and_b32 v33, 0xffff0000, v14
    v_lshlrev_b32 v34, 16, v15
    v_and_b32 v35, 0xffff0000, v15
    v_lshlrev_b32 v36, 16, v16
    v_and_b32 v37, 0xffff0000, v16
    v_lshlrev_b32 v38, 16, v17
    v_and_b32 v39, 0xffff0000, v17
    v_lshlrev_b32 v40, 16, v18
    v_and_b32 v41, 0xffff0000, v18
    v_lshlrev_b32 v42, 16, v19
    v_and_b32 v43, 0xffff0000, v19
    v_add_f32 v44, v20, v21
    v_add_f32 v64, v22, v23
    v_add_f32 v44, v44, v24
    v_add_f32 v64, v64, v25
    v_add_f32 v44, v44, v26
    v_add_f32 v64, v64, v27
    v_add_f32 v44, v44, v28
    v_add_f32 v64, v64, v29
    v_add_f32 v44, v44, v30
    v_add_f32 v64, v64, v31
    v_add_f32 v44, v44, v32
    v_add_f32 v64, v64, v33
    v_add_f32 v44, v44, v34
    v_add_f32 v64, v64, v35
    v_add_f32 v44, v44, v36
    v_add_f32 v64, v64, v37
    v_add_f32 v44, v44, v38
    v_add_f32 v64, v64, v39
    v_add_f32 v44, v44, v40
    v_add_f32 v64, v64, v41
    v_add_f32 v44, v44, v42
    v_add_f32 v64, v64, v43
    v_add_f32 v44, v44, v64
    s_nop 1
    v_add_f32_dpp v44, v44, v44 row_ror:8 row_mask:0xf bank_mask:0xf
    v_mov_b32 v64, v44
    s_nop 1
    v_permlane16_swap_b32 v44, v64
    v_add_f32 v44, v44, v64
    v_mov_b32 v64, v44
    s_nop 1
    v_permlane32_swap_b32 v44, v64
    v_add_f32 v44, v44, v64
    v_mul_f32 v65, 0x3baaaaab, v44
    v_sub_f32 v64, v20, v65
    v_mul_f32 v45, v64, v64
    v_sub_f32 v67, v21, v65
    v_fmac_f32 v45, v67, v67
    v_sub_f32 v66, v22, v65
    v_fmac_f32 v45, v66, v66
    v_sub_f32 v67, v23, v65
    v_fmac_f32 v45, v67, v67
    v_sub_f32 v66, v24, v65
    v_fmac_f32 v45, v66, v66
    v_sub_f32 v67, v25, v65
    v_fmac_f32 v45, v67, v67
    v_sub_f32 v66, v26, v65
    v_fmac_f32 v45, v66, v66
    v_sub_f32 v67, v27, v65
    v_fmac_f32 v45, v67, v67
    v_sub_f32 v66, v28, v65
    v_fmac_f32 v45, v66, v66
    v_sub_f32 v67, v29, v65
    v_fmac_f32 v45, v67, v67
    v_sub_f32 v66, v30, v65
    v_fmac_f32 v45, v66, v66
    v_sub_f32 v67, v31, v65
    v_fmac_f32 v45, v67, v67
    v_sub_f32 v66, v32, v65
    v_fmac_f32 v45, v66, v66
    v_sub_f32 v67, v33, v65
    v_fmac_f32 v45, v67, v67
    v_sub_f32 v66, v34, v65
    v_fmac_f32 v45, v66, v66
    v_sub_f32 v67, v35, v65
    v_fmac_f32 v45, v67, v67
    v_sub_f32 v66, v36, v65
    v_fmac_f32 v45, v66, v66
    v_sub_f32 v67, v37, v65
    v_fmac_f32 v45, v67, v67
    v_sub_f32 v66, v38, v65
    v_fmac_f32 v45, v66, v66
    v_sub_f32 v67, v39, v65
    v_fmac_f32 v45, v67, v67
    v_sub_f32 v66, v40, v65
    v_fmac_f32 v45, v66, v66
    v_sub_f32 v67, v41, v65
    v_fmac_f32 v45, v67, v67
    v_sub_f32 v66, v42, v65
    v_fmac_f32 v45, v66, v66
    v_sub_f32 v67, v43, v65
    v_fmac_f32 v45, v67, v67
    s_nop 1
    v_add_f32_dpp v45, v45, v45 row_ror:8 row_mask:0xf bank_mask:0xf
    v_mov_b32 v64, v45
    s_nop 1
    v_permlane16_swap_b32 v45, v64
    v_add_f32 v45, v45, v64
    v_mov_b32 v64, v45
    s_nop 1
    v_permlane32_swap_b32 v45, v64
    v_add_f32 v45, v45, v64
    v_and_b32 v64, 7, v1
    s_mul_i32 s46, s20, 64
    s_add_u32 s46, s46, 160896
    v_lshl_add_u32 v64, v64, 3, s46
    ds_write_b64 v64, v[44:45]
    s_waitcnt lgkmcnt(0)
L_w3_30:
    s_barrier
    global_load_dwordx2 v[6:7], v5, s[40:41] sc1
    s_cmp_eq_u32 s20, 3
    s_cbranch_scc1 L_w3_31
    v_and_b32 v64, 7, v1
    v_lshlrev_b32 v64, 3, v64
    v_add_u32 v64, 160896, v64
    ds_read_b64 v[44:45], v64 offset:0
    ds_read_b64 v[46:47], v64 offset:64
    ds_read_b64 v[48:49], v64 offset:128
    s_waitcnt lgkmcnt(1)
    v_add_f32 v64, v44, v46
    s_waitcnt lgkmcnt(0)
    v_add_f32 v64, v64, v48
    v_mul_f32 v64, 0x3ae38e39, v64
    v_add_f32 v65, v45, v47
    v_add_f32 v65, v65, v49
    v_mul_f32 v66, 0x3baaaaab, v44
    v_sub_f32 v66, v66, v64
    v_mul_f32 v66, v66, v66
    v_fmac_f32 v65, 0x43400000, v66
    v_mul_f32 v66, 0x3baaaaab, v46
    v_sub_f32 v66, v66, v64
    v_mul_f32 v66, v66, v66
    v_fmac_f32 v65, 0x43400000, v66
    v_mul_f32 v66, 0x3baaaaab, v48
    v_sub_f32 v66, v66, v64
    v_mul_f32 v66, v66, v66
    v_fmac_f32 v65, 0x43400000, v66
    v_mul_f32 v65, 0x3ae38e39, v65
    v_cvt_pk_bf16_f32 v65, v65, v65
    v_lshlrev_b32 v65, 16, v65
    v_add_f32 v65, 0x3727c5ac, v65
    v_cvt_pk_bf16_f32 v65, v65, v65
    v_lshlrev_b32 v65, 16, v65
    v_sqrt_f32 v65, v65
    s_nop 0
    v_cvt_pk_bf16_f32 v65, v65, v65
    v_lshlrev_b32 v65, 16, v65
    v_rcp_f32 v65, v65
    v_cvt_pk_bf16_f32 v64, v64, v64
    v_lshlrev_b32 v64, 16, v64
    v_sub_f32 v20, v20, v64
    v_sub_f32 v21, v21, v64
    v_cvt_pk_bf16_f32 v66, v20, v21
    v_lshlrev_b32 v20, 16, v66
    v_and_b32 v21, 0xffff0000, v66
    v_mul_f32 v20, v20, v65
    v_mul_f32 v21, v21, v65
    v_cvt_pk_bf16_f32 v52, v20, v21
    v_sub_f32 v22, v22, v64
    v_sub_f32 v23, v23, v64
    v_cvt_pk_bf16_f32 v66, v22, v23
    v_lshlrev_b32 v22, 16, v66
    v_and_b32 v23, 0xffff0000, v66
    v_mul_f32 v22, v22, v65
    v_mul_f32 v23, v23, v65
    v_cvt_pk_bf16_f32 v53, v22, v23
    v_sub_f32 v24, v24, v64
    v_sub_f32 v25, v25, v64
    v_cvt_pk_bf16_f32 v66, v24, v25
    v_lshlrev_b32 v24, 16, v66
    v_and_b32 v25, 0xffff0000, v66
    v_mul_f32 v24, v24, v65
    v_mul_f32 v25, v25, v65
    v_cvt_pk_bf16_f32 v54, v24, v25
    v_sub_f32 v26, v26, v64
    v_sub_f32 v27, v27, v64
    v_cvt_pk_bf16_f32 v66, v26, v27
    v_lshlrev_b32 v26, 16, v66
    v_and_b32 v27, 0xffff0000, v66
    v_mul_f32 v26, v26, v65
    v_mul_f32 v27, v27, v65
    v_cvt_pk_bf16_f32 v55, v26, v27
    v_sub_f32 v28, v28, v64
    v_sub_f32 v29, v29, v64
    v_cvt_pk_bf16_f32 v66, v28, v29
    v_lshlrev_b32 v28, 16, v66
    v_and_b32 v29, 0xffff0000, v66
    v_mul_f32 v28, v28, v65
    v_mul_f32 v29, v29, v65
    v_cvt_pk_bf16_f32 v56, v28, v29
    v_sub_f32 v30, v30, v64
    v_sub_f32 v31, v31, v64
    v_cvt_pk_bf16_f32 v66, v30, v31
    v_lshlrev_b32 v30, 16, v66
    v_and_b32 v31, 0xffff0000, v66
    v_mul_f32 v30, v30, v65
    v_mul_f32 v31, v31, v65
    v_cvt_pk_bf16_f32 v57, v30, v31
    v_sub_f32 v32, v32, v64
    v_sub_f32 v33, v33, v64
    v_cvt_pk_bf16_f32 v66, v32, v33
    v_lshlrev_b32 v32, 16, v66
    v_and_b32 v33, 0xffff0000, v66
    v_mul_f32 v32, v32, v65
    v_mul_f32 v33, v33, v65
    v_cvt_pk_bf16_f32 v58, v32, v33
    v_sub_f32 v34, v34, v64
    v_sub_f32 v35, v35, v64
    v_cvt_pk_bf16_f32 v66, v34, v35
    v_lshlrev_b32 v34, 16, v66
    v_and_b32 v35, 0xffff0000, v66
    v_mul_f32 v34, v34, v65
    v_mul_f32 v35, v35, v65
    v_cvt_pk_bf16_f32 v59, v34, v35
    v_sub_f32 v36, v36, v64
    v_sub_f32 v37, v37, v64
    v_cvt_pk_bf16_f32 v66, v36, v37
    v_lshlrev_b32 v36, 16, v66
    v_and_b32 v37, 0xffff0000, v66
    v_mul_f32 v36, v36, v65
    v_mul_f32 v37, v37, v65
    v_cvt_pk_bf16_f32 v60, v36, v37
    v_sub_f32 v38, v38, v64
    v_sub_f32 v39, v39, v64
    v_cvt_pk_bf16_f32 v66, v38, v39
    v_lshlrev_b32 v38, 16, v66
    v_and_b32 v39, 0xffff0000, v66
    v_mul_f32 v38, v38, v65
    v_mul_f32 v39, v39, v65
    v_cvt_pk_bf16_f32 v61, v38, v39
    v_sub_f32 v40, v40, v64
    v_sub_f32 v41, v41, v64
    v_cvt_pk_bf16_f32 v66, v40, v41
    v_lshlrev_b32 v40, 16, v66
    v_and_b32 v41, 0xffff0000, v66
    v_mul_f32 v40, v40, v65
    v_mul_f32 v41, v41, v65
    v_cvt_pk_bf16_f32 v62, v40, v41
    v_sub_f32 v42, v42, v64
    v_sub_f32 v43, v43, v64
    v_cvt_pk_bf16_f32 v66, v42, v43
    v_lshlrev_b32 v42, 16, v66
    v_and_b32 v43, 0xffff0000, v66
    v_mul_f32 v42, v42, v65
    v_mul_f32 v43, v43, v65
    v_cvt_pk_bf16_f32 v63, v42, v43
    s_mov_b32 s46, 20971520
    buffer_store_dwordx4 v[52:55], v4, s[4:7], s46 offen offset:0 sc1
    buffer_store_dwordx4 v[56:59], v4, s[4:7], s46 offen offset:2048 sc1
    s_add_u32 s46, s46, 4096
    buffer_store_dwordx4 v[60:63], v4, s[4:7], s46 offen offset:0 sc1
    s_lshl_b32 s0, s47, 2
    s_add_u32 s0, s0, s20
    s_lshl_b32 s0, s0, 3
    s_add_u32 s0, s0, 0
    s_mov_b32 s55, 0
    s_branch L_ln_32
L_w3_31:
    v_lshrrev_b32 v64, 4, v1
    v_bfe_u32 v66, v1, 2, 2
    v_lshl_add_u32 v64, v64, 3, v66
    v_mul_u32_u24 v64, 240, v64
    v_add_u32 v64, s56, v64
    v_and_b32 v66, 3, v1
    v_add_u32 v64, s47, v64
    v_and_b32 v67, 1, v66
    v_mul_u32_u24 v67, 160, v67
    v_lshrrev_b32 v65, 1, v66
    v_mul_u32_u24 v65, 80, v65
    v_add3_u32 v65, v65, v67, v64
    v_cmp_eq_u32 vcc, 3, v66
    s_nop 1
    v_cndmask_b32 v65, v65, v64, vcc
    v_lshl_add_u32 v64, v66, 3, v64
    s_waitcnt vmcnt(1)
    ds_read_b64_tr_b16 v[72:73], v64 offset:0
    ds_read_b64_tr_b16 v[74:75], v64 offset:960
    ds_read_b64_tr_b16 v[76:77], v64 offset:40
    ds_read_b64_tr_b16 v[78:79], v64 offset:1000
    ds_read_b64_tr_b16 v[80:81], v64 offset:80
    ds_read_b64_tr_b16 v[82:83], v64 offset:1040
    ds_read_b64_tr_b16 v[84:85], v64 offset:120
    ds_read_b64_tr_b16 v[86:87], v64 offset:1080
    ds_read_b64_tr_b16 v[88:89], v64 offset:160
    ds_read_b64_tr_b16 v[90:91], v64 offset:1120
    ds_read_b64_tr_b16 v[92:93], v64 offset:200
    ds_read_b64_tr_b16 v[94:95], v64 offset:1160
    ds_read_b64_tr_b16 v[96:97], v65 offset:32
    ds_read_b64_tr_b16 v[98:99], v65 offset:992
    v_and_b32 v66, 15, v1
    v_cmp_gt_u32 vcc, 12, v66
    s_waitcnt lgkmcnt(1)
    s_nop 0
    v_cndmask_b32 v96, 0, v96, vcc
    v_cndmask_b32 v97, 0, v97, vcc
    s_waitcnt lgkmcnt(0)
    v_cndmask_b32 v98, 0, v98, vcc
    v_cndmask_b32 v99, 0, v99, vcc
    s_add_u32 s51, s51, 0
    buffer_store_dwordx4 v[72:75], v2, s[4:7], s51 offen offset:0 sc1
    buffer_store_dwordx4 v[76:79], v2, s[4:7], s51 offen offset:1024 sc1
    buffer_store_dwordx4 v[80:83], v2, s[4:7], s51 offen offset:2048 sc1
    buffer_store_dwordx4 v[84:87], v2, s[4:7], s51 offen offset:3072 sc1
    s_add_u32 s51, s51, 4096
    buffer_store_dwordx4 v[88:91], v2, s[4:7], s51 offen offset:0 sc1
    buffer_store_dwordx4 v[92:95], v2, s[4:7], s51 offen offset:1024 sc1
    buffer_store_dwordx4 v[96:99], v2, s[4:7], s51 offen offset:2048 sc1
    s_cmp_eq_u32 s55, 0
    s_cbranch_scc1 L_ln_32
    s_cmp_eq_u32 s55, 2
    s_cbranch_scc1 L_fw_33
    v_lshrrev_b32 v64, 4, v1
    v_bfe_u32 v66, v1, 2, 2
    v_lshl_add_u32 v64, v64, 3, v66
    v_mul_u32_u24 v64, 240, v64
    v_add_u32 v64, s57, v64
    v_and_b32 v66, 3, v1
    v_add_u32 v64, s87, v64
    v_and_b32 v67, 1, v66
    v_mul_u32_u24 v67, 160, v67
    v_lshrrev_b32 v65, 1, v66
    v_mul_u32_u24 v65, 80, v65
    v_add3_u32 v65, v65, v67, v64
    v_cmp_eq_u32 vcc, 3, v66
    s_nop 1
    v_cndmask_b32 v65, v65, v64, vcc
    v_lshl_add_u32 v64, v66, 3, v64
    s_waitcnt vmcnt(8)
    ds_read_b64_tr_b16 v[100:101], v64 offset:0
    ds_read_b64_tr_b16 v[102:103], v64 offset:960
    ds_read_b64_tr_b16 v[104:105], v64 offset:40
    ds_read_b64_tr_b16 v[106:107], v64 offset:1000
    ds_read_b64_tr_b16 v[108:109], v64 offset:80
    ds_read_b64_tr_b16 v[110:111], v64 offset:1040
    ds_read_b64_tr_b16 v[112:113], v64 offset:120
    ds_read_b64_tr_b16 v[114:115], v64 offset:1080
    ds_read_b64_tr_b16 v[116:117], v64 offset:160
    ds_read_b64_tr_b16 v[118:119], v64 offset:1120
    ds_read_b64_tr_b16 v[120:121], v64 offset:200
    ds_read_b64_tr_b16 v[122:123], v64 offset:1160
    ds_read_b64_tr_b16 v[124:125], v65 offset:32
    ds_read_b64_tr_b16 v[126:127], v65 offset:992
    v_and_b32 v66, 15, v1
    v_cmp_gt_u32 vcc, 12, v66
    s_waitcnt lgkmcnt(1)
    s_nop 0
    v_cndmask_b32 v124, 0, v124, vcc
    v_cndmask_b32 v125, 0, v125, vcc
    s_waitcnt lgkmcnt(0)
    v_cndmask_b32 v126, 0, v126, vcc
    v_cndmask_b32 v127, 0, v127, vcc
    s_add_u32 s91, s91, 0
    buffer_store_dwordx4 v[100:103], v2, s[4:7], s91 offen offset:0 sc1
    buffer_store_dwordx4 v[104:107], v2, s[4:7], s91 offen offset:1024 sc1
    buffer_store_dwordx4 v[108:111], v2, s[4:7], s91 offen offset:2048 sc1
    buffer_store_dwordx4 v[112:115], v2, s[4:7], s91 offen offset:3072 sc1
    s_add_u32 s91, s91, 4096
    buffer_store_dwordx4 v[116:119], v2, s[4:7], s91 offen offset:0 sc1
    buffer_store_dwordx4 v[120:123], v2, s[4:7], s91 offen offset:1024 sc1
    buffer_store_dwordx4 v[124:127], v2, s[4:7], s91 offen offset:2048 sc1
    s_branch L_ln_32
L_fw_33:
    v_lshrrev_b32 v64, 4, v1
    v_bfe_u32 v66, v1, 2, 2
    v_lshl_add_u32 v64, v64, 3, v66
    v_mul_u32_u24 v64, 192, v64
    v_add_u32 v64, s57, v64
    v_and_b32 v66, 3, v1
    v_lshl_add_u32 v64, v66, 4, v64
    s_waitcnt vmcnt(8)
    ds_read_b64_tr_b16 v[100:101], v64 offset:0
    ds_read_b64_tr_b16 v[102:103], v64 offset:768
    ds_read_b64_tr_b16 v[104:105], v64 offset:8
    ds_read_b64_tr_b16 v[106:107], v64 offset:776
    ds_read_b64_tr_b16 v[108:109], v64 offset:64
    ds_read_b64_tr_b16 v[110:111], v64 offset:832
    ds_read_b64_tr_b16 v[112:113], v64 offset:72
    ds_read_b64_tr_b16 v[114:115], v64 offset:840
    ds_read_b64_tr_b16 v[116:117], v64 offset:128
    ds_read_b64_tr_b16 v[118:119], v64 offset:896
    ds_read_b64_tr_b16 v[120:121], v64 offset:136
    ds_read_b64_tr_b16 v[122:123], v64 offset:904
    s_add_u32 s91, s91, 2097152
    s_waitcnt lgkmcnt(10)
    buffer_store_dwordx4 v[100:103], v2, s[4:7], s91 offen offset:0 sc1
    s_waitcnt lgkmcnt(8)
    buffer_store_dwordx4 v[104:107], v2, s[4:7], s91 offen offset:1024 sc1
    s_waitcnt lgkmcnt(6)
    buffer_store_dwordx4 v[108:111], v2, s[4:7], s91 offen offset:2048 sc1
    s_waitcnt lgkmcnt(4)
    buffer_store_dwordx4 v[112:115], v2, s[4:7], s91 offen offset:3072 sc1
    s_add_u32 s91, s91, 4096
    s_waitcnt lgkmcnt(2)
    buffer_store_dwordx4 v[116:119], v2, s[4:7], s91 offen offset:0 sc1
    s_waitcnt lgkmcnt(0)
    buffer_store_dwordx4 v[120:123], v2, s[4:7], s91 offen offset:1024 sc1
L_ln_32:
    s_waitcnt vmcnt(0)
    v_cmp_ne_u64 vcc, 0, v[6:7]
    s_nop 0
    s_cmp_eq_u64 vcc, exec
    s_cbranch_scc0 L_pn_slow_27
L_pn_back_28:
    v_readfirstlane_b32 s98, v6
    v_readfirstlane_b32 s99, v7
    s_nop 0
    v_mov_b32 v6, s98
    v_mov_b32 v7, s99
    s_lshl_b32 s0, s0, 2
    s_add_u32 s0, s0, 0x8000000
    s_mov_b64 exec, 1
    buffer_store_dwordx2 v[6:7], off, s[4:7], s0 sc1
    s_mov_b64 exec, -1
    s_cmp_eq_u32 s55, 0
    s_cbranch_scc1 L_norole_34
    s_lshl_b32 s1, s1, 2
    s_add_u32 s1, s1, 0x8000000
    s_mov_b64 exec, 1
    buffer_store_dwordx2 v[6:7], off, s[4:7], s1 sc1
    s_mov_b64 exec, -1
L_norole_34:
    buffer_load_dwordx4 a[144:147], v229, s[16:19], 0 offen nt
    buffer_load_dwordx4 a[148:151], v230, s[16:19], 0 offen nt
    buffer_load_dwordx4 a[152:155], v231, s[16:19], 0 offen nt
    buffer_load_dwordx4 a[156:159], v232, s[16:19], 0 offen nt
    buffer_load_dwordx4 a[160:163], v233, s[16:19], 0 offen nt
    buffer_load_dwordx4 a[164:167], v234, s[16:19], 0 offen nt
    buffer_load_dwordx4 a[168:171], v235, s[16:19], 0 offen nt
    buffer_load_dwordx4 a[172:175], v236, s[16:19], 0 offen nt
    buffer_load_dwordx4 a[176:179], v237, s[16:19], 0 offen nt
    s_lshr_b32 s44, s22, 4
    s_lshl_b32 s52, s21, 1
    s_add_u32 s44, s44, s52
    s_and_b32 s45, s22, 15
    s_mul_i32 s48, s20, 21
    s_lshr_b32 s48, s48, 1
    s_lshl_b32 s48, s48, 10
    s_mul_i32 s47, s45, 129024
    s_add_u32 s47, s47, s48
    s_add_u32 s47, s47, 0
    s_lshl_b32 s46, s44, 3
    s_max_u32 s52, s46, 1
    s_sub_u32 s52, s52, 1
    s_mul_i32 s49, s52, 18432
    s_mul_i32 s50, s20, 9
    s_lshr_b32 s50, s50, 1
    s_lshl_b32 s50, s50, 10
    s_add_u32 s49, s49, s50
    s_add_u32 s49, s49, 20971520
    s_add_u32 s50, s50, 0
    s_lshl_b32 s54, s52, 6
    s_lshl_b32 s52, s20, 1
    s_add_u32 s46, s46, s52
    s_mul_i32 s51, s46, 18432
    s_add_u32 s51, s51, 20971520
    s_lshl_b32 s55, s46, 6
    v_and_b32 v6, 3, v1
    v_min_u32 v6, 2, v6
    v_and_b32 v7, 12, v1
    v_add_lshl_u32 v8, v6, v7, 3
    v_add_u32 v8, s55, v8
    v_and_b32 v7, 4, v1
    v_add_lshl_u32 v9, v6, v7, 3
    v_add_u32 v9, s54, v9
    v_and_b32 v7, 16, v1
    v_cmp_eq_u32 vcc, 0, v7
    s_nop 1
    v_cndmask_b32 v8, v9, v8, vcc
    v_subrev_u32 v7, 32, v1
    v_min_u32 v7, 17, v7
    s_lshl_b32 s52, s45, 8
    s_add_u32 s52, s52, 131072
    v_lshl_add_u32 v7, v7, 3, s52
    v_cmp_gt_u32 vcc, 32, v1
    s_nop 1
    v_cndmask_b32 v8, v7, v8, vcc
    s_mov_b32 s52, 0
    s_min_u32 s56, s20, 2
    s_add_u32 s57, s56, 2
    s_and_b32 s56, s20, 1
    s_add_u32 s56, s56, 4
    s_cmp_ge_u32 s20, 2
    s_cselect_b32 s57, 6, s57
    s_lshl_b32 s57, s57, 10
    s_lshl_b32 s56, s56, 10
    v_add_u32 v3, 18432, v2
    v_add_u32 v4, s57, v3
    v_add_u32 v5, s56, v3
    v_add_u32 v10, 0, v2
    s_mul_i32 s57, s20, 9216
    s_add_u32 s57, s57, 110592
    v_add_u32 v64, s57, v2
    s_waitcnt vmcnt(8)
    ds_write_b128 v64, a[144:147] offset:0
    s_waitcnt vmcnt(7)
    ds_write_b128 v64, a[148:151] offset:1024
    s_waitcnt vmcnt(6)
    ds_write_b128 v64, a[152:155] offset:2048
    s_waitcnt vmcnt(5)
    ds_write_b128 v64, a[156:159] offset:3072
    s_waitcnt vmcnt(4)
    ds_write_b128 v64, a[160:163] offset:4096
    s_waitcnt vmcnt(3)
    ds_write_b128 v64, a[164:167] offset:5120
    s_waitcnt vmcnt(2)
    ds_write_b128 v64, a[168:171] offset:6144
    s_waitcnt vmcnt(1)
    ds_write_b128 v64, a[172:175] offset:7168
    s_waitcnt vmcnt(0)
    ds_write_b128 v64, a[176:179] offset:8192
    s_cmp_ge_u32 s3, 1152
    s_cbranch_scc1 L_ud_38
    s_mul_i32 s64, s3, 1821
    s_lshr_b32 s64, s64, 16
    s_mul_i32 s92, s64, 36
    s_sub_u32 s92, s3, s92
    s_and_b32 s93, s92, 1
    s_lshr_b32 s94, s92, 1
    s_mov_b32 s62, 0
    s_mov_b32 s63, 256
    s_mul_i32 s95, s64, 486
    s_add_u32 s95, s95, s92
    s_lshl_b32 s95, s95, 10
    s_add_u32 s69, s95, 4194304
    s_add_u32 s67, s69, 36864
    s_add_u32 s68, s69, 184320
    s_mov_b32 s70, 36864
    s_mov_b32 s71, 73728
    s_lshl_b32 s95, s64, 1
    s_add_u32 s95, s95, s93
    s_mul_i32 s95, s95, 18
    s_add_u32 s95, s95, s94
    s_mul_i32 s95, s95, 640
    s_add_u32 s65, s95, 2883584
    s_mov_b32 s66, s92
    s_branch L_udone_39
L_ud_38:
    s_sub_u32 s92, s3, 1152
    s_mul_i32 s64, s92, 3641
    s_lshr_b32 s64, s64, 16
    s_mul_i32 s93, s64, 18
    s_sub_u32 s92, s92, s93
    s_and_b32 s93, s64, 3
    s_and_b32 s94, s93, 1
    s_mov_b32 s65, 0
    s_lshl_b32 s62, s94, 5
    s_cmp_eq_u32 s94, 0
    s_cselect_b32 s63, 256, 0
    s_add_u32 s66, s92, 36
    s_mul_i32 s95, s64, 486
    s_add_u32 s95, s95, 324
    s_lshl_b32 s95, s95, 10
    s_add_u32 s95, s95, 4194304
    s_cmp_ge_u32 s92, 3
    s_cbranch_scc1 L_ub_40
    s_sub_u32 s96, s92, 0
    s_mov_b32 s70, 1024
    s_mov_b32 s71, 2048
    s_mul_i32 s97, s96, 5120
    s_add_u32 s97, s97, 0
    s_add_u32 s67, s97, s95
    s_mul_i32 s97, s96, 4096
    s_add_u32 s97, s97, 15360
    s_add_u32 s68, s97, s95
    s_mul_i32 s97, s96, 5120
    s_add_u32 s97, s97, 4096
    s_add_u32 s69, s97, s95
    s_branch L_udone_39
L_ub_40:
    s_cmp_ge_u32 s92, 9
    s_cbranch_scc1 L_uc_41
    s_sub_u32 s96, s92, 3
    s_mov_b32 s70, 1024
    s_mov_b32 s71, 2048
    s_mul_i32 s97, s96, 9216
    s_add_u32 s97, s97, 27648
    s_add_u32 s67, s97, s95
    s_mul_i32 s97, s96, 9216
    s_add_u32 s97, s97, 31744
    s_add_u32 s68, s97, s95
    s_mul_i32 s97, s96, 9216
    s_add_u32 s97, s97, 35840
    s_add_u32 s69, s97, s95
    s_branch L_udone_39
L_uc_41:
    s_sub_u32 s96, s92, 9
    s_mov_b32 s70, 1024
    s_mov_b32 s71, 18432
    s_mul_i32 s97, s96, 2048
    s_add_u32 s97, s97, 82944
    s_add_u32 s67, s97, s95
    s_mul_i32 s97, s96, 2048
    s_add_u32 s97, s97, 119808
    s_add_u32 s68, s97, s95
    s_mul_i32 s97, s96, 1024
    s_add_u32 s97, s97, 156672
    s_add_u32 s69, s97, s95
L_udone_39:
    s_lshl_b32 s95, s64, 6
    s_add_u32 s95, s95, s66
    s_lshl_b32 s95, s95, 3
    s_add_u32 s66, s95, 139264
    v_lshrrev_b32 v64, 4, v1
    v_bfe_u32 v66, v1, 2, 2
    v_lshl_add_u32 v64, v64, 3, v66
    v_mul_u32_u24 v64, 288, v64
    v_add_u32 v64, s57, v64
    v_and_b32 v66, 3, v1
    v_lshl_add_u32 v65, v66, 3, v64
    v_add_u32 v65, s63, v65
    v_lshl_add_u32 v64, v66, 4, v64
    v_add_u32 v64, s62, v64
    ds_read_b64_tr_b16 v[180:181], v64 offset:0
    ds_read_b64_tr_b16 v[182:183], v64 offset:1152
    ds_read_b64_tr_b16 v[184:185], v64 offset:8
    ds_read_b64_tr_b16 v[186:187], v64 offset:1160
    ds_read_b64_tr_b16 v[188:189], v64 offset:64
    ds_read_b64_tr_b16 v[190:191], v64 offset:1216
    ds_read_b64_tr_b16 v[192:193], v64 offset:72
    ds_read_b64_tr_b16 v[194:195], v64 offset:1224
    ds_read_b64_tr_b16 v[196:197], v64 offset:128
    ds_read_b64_tr_b16 v[198:199], v64 offset:1280
    ds_read_b64_tr_b16 v[200:201], v64 offset:136
    ds_read_b64_tr_b16 v[202:203], v64 offset:1288
    ds_read_b64_tr_b16 v[204:205], v64 offset:192
    ds_read_b64_tr_b16 v[206:207], v64 offset:1344
    ds_read_b64_tr_b16 v[208:209], v64 offset:200
    ds_read_b64_tr_b16 v[210:211], v64 offset:1352
    ds_read_b64_tr_b16 v[212:213], v65 offset:0
    ds_read_b64_tr_b16 v[214:215], v65 offset:1152
    s_cmp_eq_u32 s65, 0
    s_cbranch_scc1 L_nocs_42
    v_mov_b32 v68, 0x3f803f80
    v_mov_b32 v69, 0x3f803f80
    v_mov_b32 v70, 0x3f803f80
    v_mov_b32 v71, 0x3f803f80
    s_waitcnt lgkmcnt(15)
    s_nop 0
    v_mfma_f32_16x16x32_bf16 v[72:75], v[180:183], v[68:71], 0
    s_waitcnt lgkmcnt(14)
    v_mfma_f32_16x16x32_bf16 v[76:79], v[184:187], v[68:71], 0
    s_waitcnt lgkmcnt(12)
    v_mfma_f32_16x16x32_bf16 v[80:83], v[188:191], v[68:71], 0
    s_waitcnt lgkmcnt(10)
    v_mfma_f32_16x16x32_bf16 v[84:87], v[192:195], v[68:71], 0
    s_waitcnt lgkmcnt(8)
    v_mfma_f32_16x16x32_bf16 v[88:91], v[196:199], v[68:71], 0
    s_waitcnt lgkmcnt(6)
    v_mfma_f32_16x16x32_bf16 v[92:95], v[200:203], v[68:71], 0
    s_waitcnt lgkmcnt(4)
    v_mfma_f32_16x16x32_bf16 v[96:99], v[204:207], v[68:71], 0
    s_waitcnt lgkmcnt(2)
    v_mfma_f32_16x16x32_bf16 v[100:103], v[208:211], v[68:71], 0
    s_waitcnt lgkmcnt(0)
    v_mfma_f32_16x16x32_bf16 v[104:107], v[212:215], v[68:71], 0
    v_and_b32 v66, 15, v1
    v_add_u32 v67, 1, v66
    v_cmp_gt_u32 vcc, 8, v66
    v_and_b32 v64, 48, v1
    s_nop 0
    v_cndmask_b32 v67, 0, v67, vcc
    v_cmp_eq_u32 vcc, 9, v66
    s_nop 1
    v_cndmask_b32 v67, v67, v66, vcc
    v_lshlrev_b32 v67, 6, v67
    v_add_u32 v67, v67, v64
    v_cmp_eq_u32 vcc, 1, v66
    s_nop 1
    v_cndmask_b32 v72, v72, v76, vcc
    v_cndmask_b32 v73, v73, v77, vcc
    v_cndmask_b32 v74, v74, v78, vcc
    v_cndmask_b32 v75, v75, v79, vcc
    v_cmp_eq_u32 vcc, 2, v66
    s_nop 1
    v_cndmask_b32 v72, v72, v80, vcc
    v_cndmask_b32 v73, v73, v81, vcc
    v_cndmask_b32 v74, v74, v82, vcc
    v_cndmask_b32 v75, v75, v83, vcc
    v_cmp_eq_u32 vcc, 3, v66
    s_nop 1
    v_cndmask_b32 v72, v72, v84, vcc
    v_cndmask_b32 v73, v73, v85, vcc
    v_cndmask_b32 v74, v74, v86, vcc
    v_cndmask_b32 v75, v75, v87, vcc
    v_cmp_eq_u32 vcc, 4, v66
    s_nop 1
    v_cndmask_b32 v72, v72, v88, vcc
    v_cndmask_b32 v73, v73, v89, vcc
    v_cndmask_b32 v74, v74, v90, vcc
    v_cndmask_b32 v75, v75, v91, vcc
    v_cmp_eq_u32 vcc, 5, v66
    s_nop 1
    v_cndmask_b32 v72, v72, v92, vcc
    v_cndmask_b32 v73, v73, v93, vcc
    v_cndmask_b32 v74, v74, v94, vcc
    v_cndmask_b32 v75, v75, v95, vcc
    v_cmp_eq_u32 vcc, 6, v66
    s_nop 1
    v_cndmask_b32 v72, v72, v96, vcc
    v_cndmask_b32 v73, v73, v97, vcc
    v_cndmask_b32 v74, v74, v98, vcc
    v_cndmask_b32 v75, v75, v99, vcc
    v_cmp_eq_u32 vcc, 7, v66
    s_nop 1
    v_cndmask_b32 v72, v72, v100, vcc
    v_cndmask_b32 v73, v73, v101, vcc
    v_cndmask_b32 v74, v74, v102, vcc
    v_cndmask_b32 v75, v75, v103, vcc
    v_cmp_eq_u32 vcc, 8, v66
    s_nop 1
    v_cndmask_b32 v72, v72, v104, vcc
    v_cndmask_b32 v73, v73, v105, vcc
    v_cndmask_b32 v74, v74, v106, vcc
    v_cndmask_b32 v75, v75, v107, vcc
    s_mov_b32 exec_lo, 0x03ff03ff
    s_mov_b32 exec_hi, 0x03ff03ff
    buffer_store_dwordx4 v[72:75], v67, s[4:7], s65 offen sc1
    s_mov_b64 exec, -1
L_nocs_42:
    s_mov_b32 s0, s66
    v_mov_b32 v11, v8
    s_mov_b32 s23, s52
    s_lshl_b32 s23, s23, 2
    s_add_u32 s23, s23, 0x8000000
    v_lshlrev_b32 v11, 2, v11
    buffer_load_dwordx2 v[12:13], v11, s[4:7], s23 offen sc1
    v_and_b32 v6, 15, v1
    v_lshrrev_b32 v7, 4, v1
    v_lshlrev_b32 v7, 2, v7
    v_sub_u32 v6, v6, v7
    v_mov_b32 v8, 0xf149f2ca
    s_or_b32 s52, s44, s20
    s_cmp_eq_u32 s52, 0
    s_cselect_b64 s[56:57], -1, 0
    v_subrev_u32 v7, 0, v6
    v_and_b32 v9, 0xfffffff1, v7
    v_cmp_eq_u32 vcc, 0, v9
    v_add_u32 v7, 16, v7
    v_and_b32 v9, 0xfffffff1, v7
    v_cndmask_b32_e64 v168, v8, 0, vcc
    v_cmp_eq_u32 vcc, 0, v9
    s_nop 1
    v_cndmask_b32_e64 v172, v8, 0, vcc
    v_cndmask_b32_e64 v176, v172, v8, s[56:57]
    v_subrev_u32 v7, 1, v6
    v_and_b32 v9, 0xfffffff1, v7
    v_cmp_eq_u32 vcc, 0, v9
    v_add_u32 v7, 16, v7
    v_and_b32 v9, 0xfffffff1, v7
    v_cndmask_b32_e64 v169, v8, 0, vcc
    v_cmp_eq_u32 vcc, 0, v9
    s_nop 1
    v_cndmask_b32_e64 v173, v8, 0, vcc
    v_cndmask_b32_e64 v177, v173, v8, s[56:57]
    v_subrev_u32 v7, 2, v6
    v_and_b32 v9, 0xfffffff1, v7
    v_cmp_eq_u32 vcc, 0, v9
    v_add_u32 v7, 16, v7
    v_and_b32 v9, 0xfffffff1, v7
    v_cndmask_b32_e64 v170, v8, 0, vcc
    v_cmp_eq_u32 vcc, 0, v9
    s_nop 1
    v_cndmask_b32_e64 v174, v8, 0, vcc
    v_cndmask_b32_e64 v178, v174, v8, s[56:57]
    v_subrev_u32 v7, 3, v6
    v_and_b32 v9, 0xfffffff1, v7
    v_cmp_eq_u32 vcc, 0, v9
    v_add_u32 v7, 16, v7
    v_and_b32 v9, 0xfffffff1, v7
    v_cndmask_b32_e64 v171, v8, 0, vcc
    v_cmp_eq_u32 vcc, 0, v9
    s_nop 1
    v_cndmask_b32_e64 v175, v8, 0, vcc
    v_cndmask_b32_e64 v179, v175, v8, s[56:57]
    s_mul_i32 s53, s45, 2304
    s_add_u32 s53, s53, s51
    s_waitcnt vmcnt(0)
    v_cmp_eq_u64 vcc, s[98:99], v[12:13]
    s_nop 0
    s_cmp_eq_u64 vcc, exec
    s_cbranch_scc0 L_px_slow_43
L_px_back_44:
    s_barrier
    s_add_u32 m0, s48, 18432
    s_add_u32 s53, s47, 0
    buffer_load_dwordx4 v2, s[4:7], s53 offen offset:0 lds
    buffer_load_dwordx4 v2, s[4:7], s53 offen offset:1024 lds
    buffer_load_dwordx4 v2, s[4:7], s53 offen offset:2048 lds
    buffer_load_dwordx4 v2, s[4:7], s53 offen offset:3072 lds
    s_add_u32 m0, s48, 22528
    s_add_u32 s53, s47, 4096
    buffer_load_dwordx4 v2, s[4:7], s53 offen offset:0 lds
    buffer_load_dwordx4 v2, s[4:7], s53 offen offset:1024 lds
    buffer_load_dwordx4 v2, s[4:7], s53 offen offset:2048 lds
    buffer_load_dwordx4 v2, s[4:7], s53 offen offset:3072 lds
    s_add_u32 m0, s48, 26624
    s_add_u32 s53, s47, 8192
    buffer_load_dwordx4 v2, s[4:7], s53 offen offset:0 lds
    buffer_load_dwordx4 v2, s[4:7], s53 offen offset:1024 lds
    buffer_load_dwordx4 v2, s[4:7], s53 offen offset:2048 lds
    s_add_u32 s54, s51, 0
    buffer_load_dwordx4 a[0:3], v2, s[4:7], s54 offen offset:0 sc1
    s_add_u32 s55, s51, 18432
    buffer_load_dwordx4 a[72:75], v2, s[4:7], s55 offen offset:0 sc1
    buffer_load_dwordx4 a[4:7], v2, s[4:7], s54 offen offset:1024 sc1
    buffer_load_dwordx4 a[76:79], v2, s[4:7], s55 offen offset:1024 sc1
    buffer_load_dwordx4 a[8:11], v2, s[4:7], s54 offen offset:2048 sc1
    buffer_load_dwordx4 a[80:83], v2, s[4:7], s55 offen offset:2048 sc1
    buffer_load_dwordx4 a[12:15], v2, s[4:7], s54 offen offset:3072 sc1
    buffer_load_dwordx4 a[84:87], v2, s[4:7], s55 offen offset:3072 sc1
    s_add_u32 s54, s51, 4096
    buffer_load_dwordx4 a[16:19], v2, s[4:7], s54 offen offset:0 sc1
    s_add_u32 s55, s51, 22528
    buffer_load_dwordx4 a[88:91], v2, s[4:7], s55 offen offset:0 sc1
    buffer_load_dwordx4 a[20:23], v2, s[4:7], s54 offen offset:1024 sc1
    buffer_load_dwordx4 a[92:95], v2, s[4:7], s55 offen offset:1024 sc1
    s_add_u32 m0, s48, 61440
    s_add_u32 s53, s47, 43008
    buffer_load_dwordx4 v2, s[4:7], s53 offen offset:0 lds
    buffer_load_dwordx4 v2, s[4:7], s53 offen offset:1024 lds
    buffer_load_dwordx4 v2, s[4:7], s53 offen offset:2048 lds
    buffer_load_dwordx4 v2, s[4:7], s53 offen offset:3072 lds
    s_add_u32 m0, s48, 65536
    s_add_u32 s53, s47, 47104
    buffer_load_dwordx4 v2, s[4:7], s53 offen offset:0 lds
    buffer_load_dwordx4 v2, s[4:7], s53 offen offset:1024 lds
    buffer_load_dwordx4 v2, s[4:7], s53 offen offset:2048 lds
    buffer_load_dwordx4 v2, s[4:7], s53 offen offset:3072 lds
    s_add_u32 m0, s48, 69632
    s_add_u32 s53, s47, 51200
    buffer_load_dwordx4 v2, s[4:7], s53 offen offset:0 lds
    buffer_load_dwordx4 v2, s[4:7], s53 offen offset:1024 lds
    buffer_load_dwordx4 v2, s[4:7], s53 offen offset:2048 lds
    s_waitcnt vmcnt(23)
    s_waitcnt lgkmcnt(0)
    s_barrier
    ds_read_b128 v[88:91], v3 offset:0
    ds_read_b128 v[92:95], v3 offset:1024
    ds_read_b128 v[96:99], v3 offset:2048
    ds_read_b128 v[100:103], v3 offset:3072
    ds_read_b128 v[112:115], v3 offset:6144
    ds_read_b128 v[104:107], v3 offset:4096
    ds_read_b128 v[108:111], v3 offset:5120
    s_waitcnt vmcnt(22) lgkmcnt(6)
    s_add_u32 m0, s50, 0
    s_add_u32 s53, s49, 0
    v_mfma_f32_16x16x32_bf16 v[16:19], v[88:91], a[0:3], 0
    buffer_load_dwordx4 v2, s[4:7], s53 offen offset:0 sc1 lds
    s_waitcnt vmcnt(22)
    v_mfma_f32_16x16x32_bf16 v[48:51], v[88:91], a[72:75], 0
    s_waitcnt lgkmcnt(5)
    ds_read_b128 v[116:119], v3 offset:7168
    ds_read_b128 v[120:123], v3 offset:8192
    v_mfma_f32_16x16x32_bf16 v[20:23], v[92:95], a[0:3], 0
    v_mfma_f32_16x16x32_bf16 v[52:55], v[92:95], a[72:75], 0
    s_waitcnt lgkmcnt(6)
    ds_read_b128 v[124:127], v3 offset:9216
    v_mfma_f32_16x16x32_bf16 v[24:27], v[96:99], a[0:3], 0
    buffer_load_dwordx4 v2, s[4:7], s53 offen offset:1024 sc1 lds
    v_mfma_f32_16x16x32_bf16 v[56:59], v[96:99], a[72:75], 0
    s_waitcnt lgkmcnt(6)
    ds_read_b128 v[128:131], v3 offset:10240
    v_mfma_f32_16x16x32_bf16 v[28:31], v[100:103], a[0:3], 0
    v_mfma_f32_16x16x32_bf16 v[60:63], v[100:103], a[72:75], 0
    s_waitcnt lgkmcnt(6)
    ds_read_b128 v[140:143], v3 offset:13312
    v_mfma_f32_16x16x32_bf16 v[32:35], v[112:115], a[0:3], 0
    buffer_load_dwordx4 v2, s[4:7], s53 offen offset:2048 sc1 lds
    v_mfma_f32_16x16x32_bf16 v[64:67], v[112:115], a[72:75], 0
    s_waitcnt lgkmcnt(6)
    ds_read_b128 v[132:135], v3 offset:11264
    v_mfma_f32_16x16x32_bf16 v[36:39], a[0:3], v[104:107], 0
    ds_read_b128 v[136:139], v3 offset:12288
    v_mfma_f32_16x16x32_bf16 v[68:71], a[72:75], v[104:107], 0
    s_waitcnt lgkmcnt(7)
    v_mfma_f32_16x16x32_bf16 v[40:43], a[0:3], v[108:111], 0
    buffer_load_dwordx4 v2, s[4:7], s53 offen offset:3072 sc1 lds
    v_mfma_f32_16x16x32_bf16 v[72:75], a[72:75], v[108:111], 0
    s_waitcnt vmcnt(24) lgkmcnt(6)
    s_add_u32 m0, s50, 4096
    s_add_u32 s53, s49, 4096
    v_mfma_f32_16x16x32_bf16 v[16:19], v[116:119], a[4:7], v[16:19]
    s_waitcnt vmcnt(23)
    ds_read_b128 v[88:91], v3 offset:14336
    v_mfma_f32_16x16x32_bf16 v[48:51], v[116:119], a[76:79], v[48:51]
    s_waitcnt lgkmcnt(6)
    ds_read_b128 v[92:95], v3 offset:15360
    v_mfma_f32_16x16x32_bf16 v[20:23], v[120:123], a[4:7], v[20:23]
    buffer_load_dwordx4 v2, s[4:7], s53 offen offset:0 sc1 lds
    v_mfma_f32_16x16x32_bf16 v[52:55], v[120:123], a[76:79], v[52:55]
    s_waitcnt lgkmcnt(6)
    ds_read_b128 v[96:99], v3 offset:16384
    v_mfma_f32_16x16x32_bf16 v[24:27], v[124:127], a[4:7], v[24:27]
    v_mfma_f32_16x16x32_bf16 v[56:59], v[124:127], a[76:79], v[56:59]
    s_waitcnt lgkmcnt(6)
    ds_read_b128 v[100:103], v3 offset:17408
    v_mfma_f32_16x16x32_bf16 v[28:31], v[128:131], a[4:7], v[28:31]
    buffer_load_dwordx4 a[24:27], v2, s[4:7], s54 offen offset:2048 sc1
    v_mfma_f32_16x16x32_bf16 v[60:63], v[128:131], a[76:79], v[60:63]
    s_waitcnt lgkmcnt(6)
    ds_read_b128 v[112:115], v3 offset:20480
    v_mfma_f32_16x16x32_bf16 v[32:35], v[140:143], a[4:7], v[32:35]
    ds_read_b128 v[104:107], v3 offset:18432
    v_mfma_f32_16x16x32_bf16 v[64:67], v[140:143], a[76:79], v[64:67]
    s_waitcnt lgkmcnt(7)
    v_mfma_f32_16x16x32_bf16 v[36:39], a[4:7], v[132:135], v[36:39]
    ds_read_b128 v[108:111], v3 offset:19456
    v_mfma_f32_16x16x32_bf16 v[68:71], a[76:79], v[132:135], v[68:71]
    s_waitcnt lgkmcnt(7)
    v_mfma_f32_16x16x32_bf16 v[40:43], a[4:7], v[136:139], v[40:43]
    buffer_load_dwordx4 a[96:99], v2, s[4:7], s55 offen offset:2048 sc1
    v_mfma_f32_16x16x32_bf16 v[72:75], a[76:79], v[136:139], v[72:75]
    s_waitcnt vmcnt(25) lgkmcnt(6)
    v_mfma_f32_16x16x32_bf16 v[16:19], v[88:91], a[8:11], v[16:19]
    s_waitcnt vmcnt(24)
    ds_read_b128 v[116:119], v3 offset:21504
    v_mfma_f32_16x16x32_bf16 v[48:51], v[88:91], a[80:83], v[48:51]
    s_waitcnt lgkmcnt(6)
    ds_read_b128 v[120:123], v3 offset:22528
    v_mfma_f32_16x16x32_bf16 v[20:23], v[92:95], a[8:11], v[20:23]
    buffer_load_dwordx4 a[28:31], v2, s[4:7], s54 offen offset:3072 sc1
    v_mfma_f32_16x16x32_bf16 v[52:55], v[92:95], a[80:83], v[52:55]
    s_waitcnt lgkmcnt(6)
    ds_read_b128 v[124:127], v3 offset:23552
    v_mfma_f32_16x16x32_bf16 v[24:27], v[96:99], a[8:11], v[24:27]
    v_mfma_f32_16x16x32_bf16 v[56:59], v[96:99], a[80:83], v[56:59]
    s_waitcnt lgkmcnt(6)
    ds_read_b128 v[128:131], v3 offset:24576
    v_mfma_f32_16x16x32_bf16 v[28:31], v[100:103], a[8:11], v[28:31]
    buffer_load_dwordx4 a[100:103], v2, s[4:7], s55 offen offset:3072 sc1
    v_mfma_f32_16x16x32_bf16 v[60:63], v[100:103], a[80:83], v[60:63]
    s_waitcnt lgkmcnt(6)
    s_add_u32 s54, s51, 8192
    ds_read_b128 v[140:143], v3 offset:27648
    v_mfma_f32_16x16x32_bf16 v[32:35], v[112:115], a[8:11], v[32:35]
    ds_read_b128 v[132:135], v3 offset:25600
    v_mfma_f32_16x16x32_bf16 v[64:67], v[112:115], a[80:83], v[64:67]
    s_waitcnt lgkmcnt(7)
    v_mfma_f32_16x16x32_bf16 v[36:39], a[8:11], v[104:107], v[36:39]
    ds_read_b128 v[136:139], v3 offset:26624
    v_mfma_f32_16x16x32_bf16 v[68:71], a[80:83], v[104:107], v[68:71]
    s_waitcnt lgkmcnt(7)
    v_mfma_f32_16x16x32_bf16 v[40:43], a[8:11], v[108:111], v[40:43]
    buffer_store_dwordx4 v[180:183], v2, s[4:7], s67 offen sc1
    v_mfma_f32_16x16x32_bf16 v[72:75], a[80:83], v[108:111], v[72:75]
    s_waitcnt vmcnt(26) lgkmcnt(6)
    v_mfma_f32_16x16x32_bf16 v[16:19], v[116:119], a[12:15], v[16:19]
    s_waitcnt vmcnt(25)
    ds_read_b128 v[88:91], v3 offset:28672
    v_mfma_f32_16x16x32_bf16 v[48:51], v[116:119], a[84:87], v[48:51]
    s_waitcnt lgkmcnt(6)
    ds_read_b128 v[92:95], v3 offset:29696
    v_mfma_f32_16x16x32_bf16 v[20:23], v[120:123], a[12:15], v[20:23]
    buffer_load_dwordx4 a[32:35], v2, s[4:7], s54 offen offset:0 sc1
    v_mfma_f32_16x16x32_bf16 v[52:55], v[120:123], a[84:87], v[52:55]
    s_waitcnt lgkmcnt(6)
    s_add_u32 s55, s51, 26624
    ds_read_b128 v[96:99], v3 offset:30720
    v_mfma_f32_16x16x32_bf16 v[24:27], v[124:127], a[12:15], v[24:27]
    v_mfma_f32_16x16x32_bf16 v[56:59], v[124:127], a[84:87], v[56:59]
    s_waitcnt lgkmcnt(6)
    ds_read_b128 v[100:103], v3 offset:31744
    v_mfma_f32_16x16x32_bf16 v[28:31], v[128:131], a[12:15], v[28:31]
    buffer_load_dwordx4 a[104:107], v2, s[4:7], s55 offen offset:0 sc1
    v_mfma_f32_16x16x32_bf16 v[60:63], v[128:131], a[84:87], v[60:63]
    s_waitcnt lgkmcnt(6)
    ds_read_b128 v[112:115], v3 offset:34816
    v_mfma_f32_16x16x32_bf16 v[32:35], v[140:143], a[12:15], v[32:35]
    ds_read_b128 v[104:107], v3 offset:32768
    v_mfma_f32_16x16x32_bf16 v[64:67], v[140:143], a[84:87], v[64:67]
    s_waitcnt lgkmcnt(7)
    v_mfma_f32_16x16x32_bf16 v[36:39], a[12:15], v[132:135], v[36:39]
    ds_read_b128 v[108:111], v3 offset:33792
    v_mfma_f32_16x16x32_bf16 v[68:71], a[84:87], v[132:135], v[68:71]
    s_waitcnt lgkmcnt(7)
    v_mfma_f32_16x16x32_bf16 v[40:43], a[12:15], v[136:139], v[40:43]
    buffer_load_dwordx4 a[36:39], v2, s[4:7], s54 offen offset:1024 sc1
    v_mfma_f32_16x16x32_bf16 v[72:75], a[84:87], v[136:139], v[72:75]
    s_waitcnt vmcnt(27) lgkmcnt(6)
    v_mfma_f32_16x16x32_bf16 v[16:19], v[88:91], a[16:19], v[16:19]
    s_waitcnt vmcnt(26)
    ds_read_b128 v[116:119], v3 offset:35840
    v_mfma_f32_16x16x32_bf16 v[48:51], v[88:91], a[88:91], v[48:51]
    s_waitcnt lgkmcnt(6)
    ds_read_b128 v[120:123], v3 offset:36864
    v_mfma_f32_16x16x32_bf16 v[20:23], v[92:95], a[16:19], v[20:23]
    buffer_load_dwordx4 a[108:111], v2, s[4:7], s55 offen offset:1024 sc1
    v_mfma_f32_16x16x32_bf16 v[52:55], v[92:95], a[88:91], v[52:55]
    s_waitcnt lgkmcnt(6)
    ds_read_b128 v[124:127], v3 offset:37888
    v_mfma_f32_16x16x32_bf16 v[24:27], v[96:99], a[16:19], v[24:27]
    v_mfma_f32_16x16x32_bf16 v[56:59], v[96:99], a[88:91], v[56:59]
    s_waitcnt lgkmcnt(6)
    ds_read_b128 v[128:131], v3 offset:38912
    v_mfma_f32_16x16x32_bf16 v[28:31], v[100:103], a[16:19], v[28:31]
    buffer_load_dwordx4 a[40:43], v2, s[4:7], s54 offen offset:2048 sc1
    v_mfma_f32_16x16x32_bf16 v[60:63], v[100:103], a[88:91], v[60:63]
    s_waitcnt lgkmcnt(6)
    s_add_u32 s92, s67, s70
    ds_read_b128 v[140:143], v3 offset:41984
    v_mfma_f32_16x16x32_bf16 v[32:35], v[112:115], a[16:19], v[32:35]
    ds_read_b128 v[132:135], v3 offset:39936
    v_mfma_f32_16x16x32_bf16 v[64:67], v[112:115], a[88:91], v[64:67]
    s_waitcnt lgkmcnt(7)
    v_mfma_f32_16x16x32_bf16 v[36:39], a[16:19], v[104:107], v[36:39]
    ds_read_b128 v[136:139], v3 offset:40960
    v_mfma_f32_16x16x32_bf16 v[68:71], a[88:91], v[104:107], v[68:71]
    buffer_store_dwordx4 v[184:187], v2, s[4:7], s92 offen sc1
    s_waitcnt lgkmcnt(7)
    v_mfma_f32_16x16x32_bf16 v[40:43], a[16:19], v[108:111], v[40:43]
    v_mfma_f32_16x16x32_bf16 v[72:75], a[88:91], v[108:111], v[72:75]
    s_waitcnt vmcnt(28) lgkmcnt(6)
    v_mfma_f32_16x16x32_bf16 v[16:19], v[116:119], a[20:23], v[16:19]
    s_waitcnt vmcnt(27)
    s_waitcnt vmcnt(16)
    s_waitcnt vmcnt(11)
    s_barrier
    v_mfma_f32_16x16x32_bf16 v[48:51], v[116:119], a[92:95], v[48:51]
    s_waitcnt lgkmcnt(5)
    ds_read_b128 v[88:91], v3 offset:43008
    ds_read_b128 v[92:95], v3 offset:44032
    v_mfma_f32_16x16x32_bf16 v[20:23], v[120:123], a[20:23], v[20:23]
    buffer_load_dwordx4 a[112:115], v2, s[4:7], s55 offen offset:2048 sc1
    v_mfma_f32_16x16x32_bf16 v[52:55], v[120:123], a[92:95], v[52:55]
    s_waitcnt lgkmcnt(6)
    ds_read_b128 v[96:99], v3 offset:45056
    ds_read_b128 v[144:147], v10 offset:0
    v_mfma_f32_16x16x32_bf16 v[24:27], v[124:127], a[20:23], v[24:27]
    ds_read_b128 v[148:151], v4 offset:0
    ds_read_b128 v[152:155], v5 offset:0
    v_mfma_f32_16x16x32_bf16 v[56:59], v[124:127], a[92:95], v[56:59]
    s_waitcnt lgkmcnt(9)
    ds_read_b128 v[100:103], v3 offset:46080
    ds_read_b128 v[156:159], v10 offset:1024
    v_mfma_f32_16x16x32_bf16 v[28:31], v[128:131], a[20:23], v[28:31]
    buffer_load_dwordx4 a[44:47], v2, s[4:7], s54 offen offset:3072 sc1
    v_mfma_f32_16x16x32_bf16 v[60:63], v[128:131], a[92:95], v[60:63]
    s_waitcnt lgkmcnt(10)
    ds_read_b128 v[112:115], v3 offset:49152
    ds_read_b128 v[160:163], v4 offset:7168
    v_mfma_f32_16x16x32_bf16 v[32:35], v[140:143], a[20:23], v[32:35]
    ds_read_b128 v[104:107], v3 offset:47104
    ds_read_b128 v[164:167], v5 offset:7168
    v_mfma_f32_16x16x32_bf16 v[64:67], v[140:143], a[92:95], v[64:67]
    s_waitcnt lgkmcnt(13)
    v_mfma_f32_16x16x32_bf16 v[36:39], a[20:23], v[132:135], v[36:39]
    ds_read_b128 v[108:111], v3 offset:48128
    v_mfma_f32_16x16x32_bf16 v[68:71], a[92:95], v[132:135], v[68:71]
    s_waitcnt lgkmcnt(13)
    v_mfma_f32_16x16x32_bf16 v[40:43], a[20:23], v[136:139], v[40:43]
    buffer_load_dwordx4 a[116:119], v2, s[4:7], s55 offen offset:3072 sc1
    v_mfma_f32_16x16x32_bf16 v[72:75], a[92:95], v[136:139], v[72:75]
    s_waitcnt vmcnt(13) lgkmcnt(12)
    s_add_u32 m0, s48, 104448
    s_add_u32 s53, s47, 86016
    v_mfma_f32_16x16x32_bf16 v[16:19], v[88:91], a[24:27], v[16:19]
    s_waitcnt vmcnt(12)
    ds_read_b128 v[116:119], v3 offset:50176
    v_mfma_f32_16x16x32_bf16 v[48:51], v[88:91], a[96:99], v[48:51]
    s_waitcnt lgkmcnt(12)
    ds_read_b128 v[120:123], v3 offset:51200
    v_mfma_f32_16x16x32_bf16 v[20:23], v[92:95], a[24:27], v[20:23]
    buffer_load_dwordx4 v2, s[4:7], s53 offen offset:0 lds
    v_mfma_f32_16x16x32_bf16 v[52:55], v[92:95], a[96:99], v[52:55]
    s_waitcnt lgkmcnt(12)
    s_add_u32 s92, s67, s71
    ds_read_b128 v[124:127], v3 offset:52224
    v_mfma_f32_16x16x32_bf16 v[24:27], v[96:99], a[24:27], v[24:27]
    v_mfma_f32_16x16x32_bf16 v[56:59], v[96:99], a[96:99], v[56:59]
    s_waitcnt lgkmcnt(9)
    ds_read_b128 v[128:131], v3 offset:53248
    v_mfma_f32_16x16x32_bf16 v[28:31], v[100:103], a[24:27], v[28:31]
    buffer_store_dwordx4 v[188:191], v2, s[4:7], s92 offen sc1
    v_mfma_f32_16x16x32_bf16 v[60:63], v[100:103], a[96:99], v[60:63]
    s_waitcnt lgkmcnt(8)
    ds_read_b128 v[140:143], v3 offset:56320
    v_mfma_f32_16x16x32_bf16 v[32:35], v[112:115], a[24:27], v[32:35]
    ds_read_b128 v[132:135], v3 offset:54272
    v_mfma_f32_16x16x32_bf16 v[64:67], v[112:115], a[96:99], v[64:67]
    s_waitcnt lgkmcnt(8)
    v_mfma_f32_16x16x32_bf16 v[36:39], a[24:27], v[104:107], v[36:39]
    ds_read_b128 v[136:139], v3 offset:55296
    v_mfma_f32_16x16x32_bf16 v[68:71], a[96:99], v[104:107], v[68:71]
    s_waitcnt lgkmcnt(7)
    v_mfma_f32_16x16x32_bf16 v[40:43], a[24:27], v[108:111], v[40:43]
    buffer_load_dwordx4 v2, s[4:7], s53 offen offset:1024 lds
    v_mfma_f32_16x16x32_bf16 v[72:75], a[96:99], v[108:111], v[72:75]
    v_mfma_f32_16x16x32_bf16 v[80:83], v[148:151], v[144:147], 0
    v_mfma_f32_16x16x32_bf16 v[84:87], v[144:147], v[152:155], 0
    s_waitcnt vmcnt(14) lgkmcnt(6)
    ds_read_b128 v[144:147], v10 offset:2048
    ds_read_b128 v[148:151], v4 offset:14336
    v_mfma_f32_16x16x32_bf16 v[16:19], v[116:119], a[28:31], v[16:19]
    buffer_load_dwordx4 v2, s[4:7], s53 offen offset:2048 lds
    s_waitcnt vmcnt(14)
    v_mfma_f32_16x16x32_bf16 v[48:51], v[116:119], a[100:103], v[48:51]
    s_waitcnt lgkmcnt(7)
    ds_read_b128 v[88:91], v3 offset:57344
    ds_read_b128 v[92:95], v3 offset:58368
    v_mfma_f32_16x16x32_bf16 v[20:23], v[120:123], a[28:31], v[20:23]
    ds_read_b128 v[152:155], v5 offset:14336
    v_mfma_f32_16x16x32_bf16 v[52:55], v[120:123], a[100:103], v[52:55]
    s_waitcnt lgkmcnt(9)
    ds_read_b128 v[96:99], v3 offset:59392
    v_mfma_f32_16x16x32_bf16 v[24:27], v[124:127], a[28:31], v[24:27]
    buffer_load_dwordx4 v2, s[4:7], s53 offen offset:3072 lds
    v_mfma_f32_16x16x32_bf16 v[56:59], v[124:127], a[100:103], v[56:59]
    s_waitcnt lgkmcnt(9)
    s_add_u32 m0, s48, 108544
    s_add_u32 s53, s47, 90112
    v_mfma_f32_16x16x32_bf16 v[28:31], v[128:131], a[28:31], v[28:31]
    ds_read_b128 v[100:103], v3 offset:60416
    v_mfma_f32_16x16x32_bf16 v[60:63], v[128:131], a[100:103], v[60:63]
    s_waitcnt lgkmcnt(9)
    ds_read_b128 v[112:115], v3 offset:63488
    v_mfma_f32_16x16x32_bf16 v[32:35], v[140:143], a[28:31], v[32:35]
    buffer_load_dwordx4 v2, s[4:7], s53 offen offset:0 lds
    v_mfma_f32_16x16x32_bf16 v[64:67], v[140:143], a[100:103], v[64:67]
    s_waitcnt lgkmcnt(9)
    ds_read_b128 v[104:107], v3 offset:61440
    v_mfma_f32_16x16x32_bf16 v[36:39], a[28:31], v[132:135], v[36:39]
    ds_read_b128 v[108:111], v3 offset:62464
    v_mfma_f32_16x16x32_bf16 v[68:71], a[100:103], v[132:135], v[68:71]
    s_waitcnt lgkmcnt(10)
    s_add_u32 s92, s92, s70
    v_mfma_f32_16x16x32_bf16 v[40:43], a[28:31], v[136:139], v[40:43]
    buffer_store_dwordx4 v[192:195], v2, s[4:7], s92 offen sc1
    v_mfma_f32_16x16x32_bf16 v[72:75], a[100:103], v[136:139], v[72:75]
    v_mfma_f32_16x16x32_bf16 v[80:83], v[160:163], v[156:159], v[80:83]
    v_mfma_f32_16x16x32_bf16 v[84:87], v[156:159], v[164:167], v[84:87]
    s_waitcnt vmcnt(15) lgkmcnt(7)
    ds_read_b128 v[156:159], v10 offset:3072
    ds_read_b128 v[160:163], v4 offset:21504
    v_mfma_f32_16x16x32_bf16 v[16:19], v[88:91], a[32:35], v[16:19]
    buffer_load_dwordx4 v2, s[4:7], s53 offen offset:1024 lds
    s_waitcnt vmcnt(15)
    v_mfma_f32_16x16x32_bf16 v[48:51], v[88:91], a[104:107], v[48:51]
    s_waitcnt lgkmcnt(8)
    ds_read_b128 v[164:167], v5 offset:21504
    v_add_u32 v3, 64512, v3
    v_mfma_f32_16x16x32_bf16 v[20:23], v[92:95], a[32:35], v[20:23]
    ds_read_b128 v[116:119], v3 offset:0
    v_mfma_f32_16x16x32_bf16 v[52:55], v[92:95], a[104:107], v[52:55]
    s_waitcnt lgkmcnt(8)
    ds_read_b128 v[120:123], v3 offset:1024
    v_mfma_f32_16x16x32_bf16 v[24:27], v[96:99], a[32:35], v[24:27]
    buffer_load_dwordx4 v2, s[4:7], s53 offen offset:2048 lds
    v_mfma_f32_16x16x32_bf16 v[56:59], v[96:99], a[104:107], v[56:59]
    s_waitcnt lgkmcnt(8)
    ds_read_b128 v[124:127], v3 offset:2048
    v_mfma_f32_16x16x32_bf16 v[28:31], v[100:103], a[32:35], v[28:31]
    v_mfma_f32_16x16x32_bf16 v[60:63], v[100:103], a[104:107], v[60:63]
    buffer_load_dwordx4 v2, s[4:7], s53 offen offset:3072 lds
    s_add_u32 m0, s48, 112640
    s_add_u32 s53, s47, 94208
    buffer_load_dwordx4 v2, s[4:7], s53 offen offset:0 lds
    buffer_load_dwordx4 v2, s[4:7], s53 offen offset:1024 lds
    buffer_load_dwordx4 v2, s[4:7], s53 offen offset:2048 lds
    s_waitcnt lgkmcnt(8)
    v_mfma_f32_16x16x32_bf16 v[32:35], v[112:115], a[32:35], v[32:35]
    s_add_u32 s54, s51, 12288
    ds_read_b128 v[128:131], v3 offset:3072
    ds_read_b128 v[140:143], v3 offset:6144
    v_mfma_f32_16x16x32_bf16 v[64:67], v[112:115], a[104:107], v[64:67]
    s_waitcnt lgkmcnt(9)
    v_mfma_f32_16x16x32_bf16 v[36:39], a[32:35], v[104:107], v[36:39]
    ds_read_b128 v[132:135], v3 offset:4096
    v_mfma_f32_16x16x32_bf16 v[68:71], a[104:107], v[104:107], v[68:71]
    s_waitcnt lgkmcnt(9)
    v_mfma_f32_16x16x32_bf16 v[40:43], a[32:35], v[108:111], v[40:43]
    ds_read_b128 v[136:139], v3 offset:5120
    v_mfma_f32_16x16x32_bf16 v[72:75], a[104:107], v[108:111], v[72:75]
    v_mfma_f32_16x16x32_bf16 v[80:83], v[148:151], v[144:147], v[80:83]
    v_mfma_f32_16x16x32_bf16 v[84:87], v[144:147], v[152:155], v[84:87]
    s_waitcnt vmcnt(19) lgkmcnt(6)
    ds_read_b128 v[144:147], v10 offset:4096
    ds_read_b128 v[148:151], v4 offset:28672
    v_mfma_f32_16x16x32_bf16 v[16:19], v[116:119], a[36:39], v[16:19]
    buffer_load_dwordx4 a[48:51], v2, s[4:7], s54 offen offset:0 sc1
    s_waitcnt vmcnt(19)
    v_mfma_f32_16x16x32_bf16 v[48:51], v[116:119], a[108:111], v[48:51]
    s_waitcnt lgkmcnt(7)
    s_add_u32 s55, s51, 30720
    ds_read_b128 v[88:91], v3 offset:7168
    v_mfma_f32_16x16x32_bf16 v[20:23], v[120:123], a[36:39], v[20:23]
    ds_read_b128 v[92:95], v3 offset:8192
    ds_read_b128 v[152:155], v5 offset:28672
    v_mfma_f32_16x16x32_bf16 v[52:55], v[120:123], a[108:111], v[52:55]
    s_waitcnt lgkmcnt(9)
    ds_read_b128 v[96:99], v3 offset:9216
    v_mfma_f32_16x16x32_bf16 v[24:27], v[124:127], a[36:39], v[24:27]
    buffer_load_dwordx4 a[120:123], v2, s[4:7], s55 offen offset:0 sc1
    v_mfma_f32_16x16x32_bf16 v[56:59], v[124:127], a[108:111], v[56:59]
    s_waitcnt lgkmcnt(9)
    ds_read_b128 v[100:103], v3 offset:10240
    v_mfma_f32_16x16x32_bf16 v[28:31], v[128:131], a[36:39], v[28:31]
    v_mfma_f32_16x16x32_bf16 v[60:63], v[128:131], a[108:111], v[60:63]
    buffer_store_dwordx4 v[196:199], v2, s[4:7], s68 offen sc1
    s_waitcnt lgkmcnt(9)
    v_mfma_f32_16x16x32_bf16 v[32:35], v[140:143], a[36:39], v[32:35]
    ds_read_b128 v[112:115], v3 offset:13312
    ds_read_b128 v[104:107], v3 offset:11264
    v_mfma_f32_16x16x32_bf16 v[64:67], v[140:143], a[108:111], v[64:67]
    s_waitcnt lgkmcnt(10)
    v_mfma_f32_16x16x32_bf16 v[36:39], a[36:39], v[132:135], v[36:39]
    ds_read_b128 v[108:111], v3 offset:12288
    v_mfma_f32_16x16x32_bf16 v[68:71], a[108:111], v[132:135], v[68:71]
    s_waitcnt lgkmcnt(10)
    v_mfma_f32_16x16x32_bf16 v[40:43], a[36:39], v[136:139], v[40:43]
    buffer_load_dwordx4 a[52:55], v2, s[4:7], s54 offen offset:1024 sc1
    v_mfma_f32_16x16x32_bf16 v[72:75], a[108:111], v[136:139], v[72:75]
    v_mfma_f32_16x16x32_bf16 v[80:83], v[160:163], v[156:159], v[80:83]
    v_mfma_f32_16x16x32_bf16 v[84:87], v[156:159], v[164:167], v[84:87]
    s_waitcnt vmcnt(21) lgkmcnt(7)
    ds_read_b128 v[156:159], v10 offset:5120
    ds_read_b128 v[160:163], v4 offset:35840
    v_mfma_f32_16x16x32_bf16 v[16:19], v[88:91], a[40:43], v[16:19]
    buffer_load_dwordx4 a[124:127], v2, s[4:7], s55 offen offset:1024 sc1
    s_waitcnt vmcnt(20)
    v_mfma_f32_16x16x32_bf16 v[48:51], v[88:91], a[112:115], v[48:51]
    s_waitcnt lgkmcnt(8)
    ds_read_b128 v[116:119], v3 offset:14336
    ds_read_b128 v[120:123], v3 offset:15360
    v_mfma_f32_16x16x32_bf16 v[20:23], v[92:95], a[40:43], v[20:23]
    ds_read_b128 v[164:167], v5 offset:35840
    v_mfma_f32_16x16x32_bf16 v[52:55], v[92:95], a[112:115], v[52:55]
    s_waitcnt lgkmcnt(9)
    ds_read_b128 v[124:127], v3 offset:16384
    v_mfma_f32_16x16x32_bf16 v[24:27], v[96:99], a[40:43], v[24:27]
    buffer_load_dwordx4 a[56:59], v2, s[4:7], s54 offen offset:2048 sc1
    v_mfma_f32_16x16x32_bf16 v[56:59], v[96:99], a[112:115], v[56:59]
    s_waitcnt lgkmcnt(9)
    ds_read_b128 v[128:131], v3 offset:17408
    v_mfma_f32_16x16x32_bf16 v[28:31], v[100:103], a[40:43], v[28:31]
    v_mfma_f32_16x16x32_bf16 v[60:63], v[100:103], a[112:115], v[60:63]
    s_waitcnt lgkmcnt(9)
    ds_read_b128 v[140:143], v3 offset:20480
    v_mfma_f32_16x16x32_bf16 v[32:35], v[112:115], a[40:43], v[32:35]
    buffer_load_dwordx4 a[128:131], v2, s[4:7], s55 offen offset:2048 sc1
    v_mfma_f32_16x16x32_bf16 v[64:67], v[112:115], a[112:115], v[64:67]
    s_waitcnt lgkmcnt(9)
    ds_read_b128 v[132:135], v3 offset:18432
    v_mfma_f32_16x16x32_bf16 v[36:39], a[40:43], v[104:107], v[36:39]
    ds_read_b128 v[136:139], v3 offset:19456
    v_mfma_f32_16x16x32_bf16 v[68:71], a[112:115], v[104:107], v[68:71]
    s_waitcnt lgkmcnt(10)
    s_add_u32 s92, s68, s70
    v_mfma_f32_16x16x32_bf16 v[40:43], a[40:43], v[108:111], v[40:43]
    buffer_store_dwordx4 v[200:203], v2, s[4:7], s92 offen sc1
    v_mfma_f32_16x16x32_bf16 v[72:75], a[112:115], v[108:111], v[72:75]
    v_mfma_f32_16x16x32_bf16 v[80:83], v[148:151], v[144:147], v[80:83]
    v_mfma_f32_16x16x32_bf16 v[84:87], v[144:147], v[152:155], v[84:87]
    s_waitcnt vmcnt(22) lgkmcnt(7)
    ds_read_b128 v[144:147], v10 offset:6144
    ds_read_b128 v[148:151], v4 offset:43008
    v_mfma_f32_16x16x32_bf16 v[16:19], v[116:119], a[44:47], v[16:19]
    s_waitcnt vmcnt(21)
    s_waitcnt vmcnt(8)
    s_barrier
    ds_read_b128 v[88:91], v3 offset:21504
    v_mfma_f32_16x16x32_bf16 v[48:51], v[116:119], a[116:119], v[48:51]
    s_waitcnt lgkmcnt(9)
    ds_read_b128 v[92:95], v3 offset:22528
    ds_read_b128 v[152:155], v5 offset:43008
    v_mfma_f32_16x16x32_bf16 v[20:23], v[120:123], a[44:47], v[20:23]
    buffer_load_dwordx4 a[60:63], v2, s[4:7], s54 offen offset:3072 sc1
    v_mfma_f32_16x16x32_bf16 v[52:55], v[120:123], a[116:119], v[52:55]
    s_waitcnt lgkmcnt(9)
    ds_read_b128 v[96:99], v3 offset:23552
    v_mfma_f32_16x16x32_bf16 v[24:27], v[124:127], a[44:47], v[24:27]
    v_mfma_f32_16x16x32_bf16 v[56:59], v[124:127], a[116:119], v[56:59]
    s_waitcnt lgkmcnt(9)
    ds_read_b128 v[100:103], v3 offset:24576
    v_mfma_f32_16x16x32_bf16 v[28:31], v[128:131], a[44:47], v[28:31]
    buffer_load_dwordx4 a[132:135], v2, s[4:7], s55 offen offset:3072 sc1
    v_mfma_f32_16x16x32_bf16 v[60:63], v[128:131], a[116:119], v[60:63]
    s_waitcnt lgkmcnt(9)
    s_add_u32 s54, s51, 16384
    ds_read_b128 v[112:115], v3 offset:27648
    v_mfma_f32_16x16x32_bf16 v[32:35], v[140:143], a[44:47], v[32:35]
    ds_read_b128 v[104:107], v3 offset:25600
    v_mfma_f32_16x16x32_bf16 v[64:67], v[140:143], a[116:119], v[64:67]
    s_waitcnt lgkmcnt(10)
    v_mfma_f32_16x16x32_bf16 v[36:39], a[44:47], v[132:135], v[36:39]
    ds_read_b128 v[108:111], v3 offset:26624
    v_mfma_f32_16x16x32_bf16 v[68:71], a[116:119], v[132:135], v[68:71]
    s_waitcnt lgkmcnt(10)
    v_mfma_f32_16x16x32_bf16 v[40:43], a[44:47], v[136:139], v[40:43]
    buffer_load_dwordx4 a[64:67], v2, s[4:7], s54 offen offset:0 sc1
    v_mfma_f32_16x16x32_bf16 v[72:75], a[116:119], v[136:139], v[72:75]
    s_add_u32 s55, s51, 34816
    v_mfma_f32_16x16x32_bf16 v[80:83], v[160:163], v[156:159], v[80:83]
    v_mfma_f32_16x16x32_bf16 v[84:87], v[156:159], v[164:167], v[84:87]
    s_waitcnt vmcnt(10) lgkmcnt(7)
    ds_read_b128 v[156:159], v10 offset:7168
    ds_read_b128 v[160:163], v4 offset:50176
    v_mfma_f32_16x16x32_bf16 v[16:19], v[88:91], a[48:51], v[16:19]
    buffer_load_dwordx4 a[136:139], v2, s[4:7], s55 offen offset:0 sc1
    s_waitcnt vmcnt(10)
    v_mfma_f32_16x16x32_bf16 v[48:51], v[88:91], a[120:123], v[48:51]
    s_waitcnt lgkmcnt(8)
    ds_read_b128 v[164:167], v5 offset:50176
    ds_read_b128 v[116:119], v3 offset:28672
    v_mfma_f32_16x16x32_bf16 v[20:23], v[92:95], a[48:51], v[20:23]
    ds_read_b128 v[120:123], v3 offset:29696
    v_mfma_f32_16x16x32_bf16 v[52:55], v[92:95], a[120:123], v[52:55]
    s_waitcnt lgkmcnt(9)
    s_add_u32 s92, s68, s71
    ds_read_b128 v[124:127], v3 offset:30720
    v_mfma_f32_16x16x32_bf16 v[24:27], v[96:99], a[48:51], v[24:27]
    buffer_store_dwordx4 v[204:207], v2, s[4:7], s92 offen sc1
    v_mfma_f32_16x16x32_bf16 v[56:59], v[96:99], a[120:123], v[56:59]
    ds_read_b128 v[128:131], v3 offset:31744
    v_mfma_f32_16x16x32_bf16 v[80:83], v[148:151], v[144:147], v[80:83]
    v_mfma_f32_16x16x32_bf16 v[84:87], v[144:147], v[152:155], v[84:87]
    s_waitcnt lgkmcnt(10)
    ds_read_b128 v[140:143], v3 offset:34816
    ds_read_b128 v[144:147], v10 offset:8192
    v_mfma_f32_16x16x32_bf16 v[28:31], v[100:103], a[48:51], v[28:31]
    buffer_load_dwordx4 a[68:71], v2, s[4:7], s54 offen offset:1024 sc1
    v_mfma_f32_16x16x32_bf16 v[60:63], v[100:103], a[120:123], v[60:63]
    s_waitcnt lgkmcnt(11)
    ds_read_b128 v[132:135], v3 offset:32768
    ds_read_b128 v[148:151], v4 offset:57344
    v_mfma_f32_16x16x32_bf16 v[32:35], v[112:115], a[48:51], v[32:35]
    ds_read_b128 v[136:139], v3 offset:33792
    ds_read_b128 v[152:155], v5 offset:57344
    v_mfma_f32_16x16x32_bf16 v[64:67], v[112:115], a[120:123], v[64:67]
    s_waitcnt lgkmcnt(14)
    v_mfma_f32_16x16x32_bf16 v[36:39], a[48:51], v[104:107], v[36:39]
    buffer_load_dwordx4 a[140:143], v2, s[4:7], s55 offen offset:1024 sc1
    v_mfma_f32_16x16x32_bf16 v[68:71], a[120:123], v[104:107], v[68:71]
    s_waitcnt lgkmcnt(13)
    v_mfma_f32_16x16x32_bf16 v[40:43], a[48:51], v[108:111], v[40:43]
    v_mfma_f32_16x16x32_bf16 v[72:75], a[120:123], v[108:111], v[72:75]
    s_waitcnt lgkmcnt(11)
    v_mfma_f32_16x16x32_bf16 v[80:83], v[160:163], v[156:159], v[80:83]
    s_waitcnt lgkmcnt(10)
    v_mfma_f32_16x16x32_bf16 v[84:87], v[156:159], v[164:167], v[84:87]
    s_waitcnt vmcnt(11) lgkmcnt(9)
    v_add_u32 v4, 64512, v4
    v_add_u32 v5, 64512, v5
    v_mfma_f32_16x16x32_bf16 v[16:19], v[116:119], a[52:55], v[16:19]
    buffer_load_dwordx4 a[180:183], v238, s[12:15], 0 offen nt
    s_waitcnt vmcnt(11)
    v_mfma_f32_16x16x32_bf16 v[48:51], v[116:119], a[124:127], v[48:51]
    s_waitcnt lgkmcnt(8)
    ds_read_b128 v[156:159], v10 offset:9216
    ds_read_b128 v[160:163], v4 offset:0
    v_mfma_f32_16x16x32_bf16 v[20:23], v[120:123], a[52:55], v[20:23]
    ds_read_b128 v[164:167], v5 offset:0
    ds_read_b128 v[88:91], v3 offset:35840
    v_mfma_f32_16x16x32_bf16 v[52:55], v[120:123], a[124:127], v[52:55]
    s_waitcnt lgkmcnt(11)
    ds_read_b128 v[92:95], v3 offset:36864
    ds_read_b128 v[96:99], v3 offset:37888
    v_mfma_f32_16x16x32_bf16 v[24:27], v[124:127], a[52:55], v[24:27]
    buffer_load_dwordx4 a[184:187], v239, s[12:15], 0 offen nt
    v_mfma_f32_16x16x32_bf16 v[56:59], v[124:127], a[124:127], v[56:59]
    s_waitcnt lgkmcnt(8)
    ds_read_b128 v[100:103], v3 offset:38912
    v_mfma_f32_16x16x32_bf16 v[80:83], v[148:151], v[144:147], v[80:83]
    s_waitcnt lgkmcnt(7)
    v_mfma_f32_16x16x32_bf16 v[84:87], v[144:147], v[152:155], v[84:87]
    ds_read_b128 v[112:115], v3 offset:41984
    ds_read_b128 v[144:147], v10 offset:10240
    v_mfma_f32_16x16x32_bf16 v[28:31], v[128:131], a[52:55], v[28:31]
    buffer_load_dwordx4 a[188:191], v240, s[12:15], 0 offen nt
    v_mfma_f32_16x16x32_bf16 v[60:63], v[128:131], a[124:127], v[60:63]
    s_add_u32 s92, s92, s70
    ds_read_b128 v[104:107], v3 offset:39936
    v_mfma_f32_16x16x32_bf16 v[32:35], v[140:143], a[52:55], v[32:35]
    ds_read_b128 v[108:111], v3 offset:40960
    ds_read_b128 v[148:151], v4 offset:7168
    v_mfma_f32_16x16x32_bf16 v[64:67], v[140:143], a[124:127], v[64:67]
    ds_read_b128 v[152:155], v5 offset:7168
    v_mfma_f32_16x16x32_bf16 v[36:39], a[52:55], v[132:135], v[36:39]
    buffer_store_dwordx4 v[208:211], v2, s[4:7], s92 offen sc1
    v_mfma_f32_16x16x32_bf16 v[68:71], a[124:127], v[132:135], v[68:71]
    v_mfma_f32_16x16x32_bf16 v[40:43], a[52:55], v[136:139], v[40:43]
    v_mfma_f32_16x16x32_bf16 v[72:75], a[124:127], v[136:139], v[72:75]
    s_waitcnt lgkmcnt(11)
    v_mfma_f32_16x16x32_bf16 v[80:83], v[160:163], v[156:159], v[80:83]
    s_waitcnt lgkmcnt(10)
    v_mfma_f32_16x16x32_bf16 v[84:87], v[156:159], v[164:167], v[84:87]
    s_waitcnt vmcnt(13) lgkmcnt(9)
    ds_read_b128 v[156:159], v10 offset:11264
    ds_read_b128 v[160:163], v4 offset:14336
    v_mfma_f32_16x16x32_bf16 v[16:19], v[88:91], a[56:59], v[16:19]
    buffer_load_dwordx4 a[192:195], v241, s[12:15], 0 offen nt
    s_waitcnt vmcnt(13)
    v_mfma_f32_16x16x32_bf16 v[48:51], v[88:91], a[128:131], v[48:51]
    s_waitcnt lgkmcnt(10)
    ds_read_b128 v[164:167], v5 offset:14336
    ds_read_b128 v[116:119], v3 offset:43008
    v_mfma_f32_16x16x32_bf16 v[20:23], v[92:95], a[56:59], v[20:23]
    ds_read_b128 v[120:123], v3 offset:44032
    v_mfma_f32_16x16x32_bf16 v[52:55], v[92:95], a[128:131], v[52:55]
    s_waitcnt lgkmcnt(12)
    ds_read_b128 v[124:127], v3 offset:45056
    v_mfma_f32_16x16x32_bf16 v[24:27], v[96:99], a[56:59], v[24:27]
    buffer_load_dwordx4 a[196:199], v242, s[12:15], 0 offen nt
    v_mfma_f32_16x16x32_bf16 v[56:59], v[96:99], a[128:131], v[56:59]
    s_waitcnt lgkmcnt(7)
    ds_read_b128 v[128:131], v3 offset:46080
    v_mfma_f32_16x16x32_bf16 v[80:83], v[148:151], v[144:147], v[80:83]
    s_waitcnt lgkmcnt(7)
    v_mfma_f32_16x16x32_bf16 v[84:87], v[144:147], v[152:155], v[84:87]
    ds_read_b128 v[140:143], v3 offset:49152
    ds_read_b128 v[144:147], v10 offset:12288
    v_mfma_f32_16x16x32_bf16 v[28:31], v[100:103], a[56:59], v[28:31]
    buffer_load_dwordx4 a[200:203], v243, s[12:15], 0 offen nt
    v_mfma_f32_16x16x32_bf16 v[60:63], v[100:103], a[128:131], v[60:63]
    ds_read_b128 v[132:135], v3 offset:47104
    ds_read_b128 v[148:151], v4 offset:21504
    v_mfma_f32_16x16x32_bf16 v[32:35], v[112:115], a[56:59], v[32:35]
    ds_read_b128 v[136:139], v3 offset:48128
    ds_read_b128 v[152:155], v5 offset:21504
    v_mfma_f32_16x16x32_bf16 v[64:67], v[112:115], a[128:131], v[64:67]
    v_mfma_f32_16x16x32_bf16 v[36:39], a[56:59], v[104:107], v[36:39]
    buffer_load_dwordx4 a[204:207], v244, s[12:15], 0 offen nt
    v_mfma_f32_16x16x32_bf16 v[68:71], a[128:131], v[104:107], v[68:71]
    v_mfma_f32_16x16x32_bf16 v[40:43], a[56:59], v[108:111], v[40:43]
    v_mfma_f32_16x16x32_bf16 v[72:75], a[128:131], v[108:111], v[72:75]
    s_waitcnt lgkmcnt(11)
    v_mfma_f32_16x16x32_bf16 v[80:83], v[160:163], v[156:159], v[80:83]
    s_waitcnt lgkmcnt(10)
    v_mfma_f32_16x16x32_bf16 v[84:87], v[156:159], v[164:167], v[84:87]
    s_waitcnt vmcnt(14) lgkmcnt(9)
    ds_read_b128 v[156:159], v10 offset:13312
    ds_read_b128 v[160:163], v4 offset:28672
    v_mfma_f32_16x16x32_bf16 v[16:19], v[116:119], a[60:63], v[16:19]
    buffer_store_dwordx4 v[212:215], v2, s[4:7], s69 offen sc1
    s_waitcnt vmcnt(14)
    v_mfma_f32_16x16x32_bf16 v[48:51], v[116:119], a[132:135], v[48:51]
    s_waitcnt lgkmcnt(10)
    ds_read_b128 v[164:167], v5 offset:28672
    ds_read_b128 v[88:91], v3 offset:50176
    v_mfma_f32_16x16x32_bf16 v[20:23], v[120:123], a[60:63], v[20:23]
    ds_read_b128 v[92:95], v3 offset:51200
    v_mfma_f32_16x16x32_bf16 v[52:55], v[120:123], a[132:135], v[52:55]
    s_waitcnt lgkmcnt(12)
    ds_read_b128 v[96:99], v3 offset:52224
    v_mfma_f32_16x16x32_bf16 v[24:27], v[124:127], a[60:63], v[24:27]
    buffer_load_dwordx4 a[208:211], v245, s[12:15], 0 offen nt
    v_mfma_f32_16x16x32_bf16 v[56:59], v[124:127], a[132:135], v[56:59]
    s_waitcnt lgkmcnt(8)
    ds_read_b128 v[100:103], v3 offset:53248
    v_mfma_f32_16x16x32_bf16 v[80:83], v[148:151], v[144:147], v[80:83]
    s_waitcnt lgkmcnt(7)
    v_mfma_f32_16x16x32_bf16 v[84:87], v[144:147], v[152:155], v[84:87]
    ds_read_b128 v[112:115], v3 offset:56320
    ds_read_b128 v[144:147], v10 offset:14336
    v_mfma_f32_16x16x32_bf16 v[28:31], v[128:131], a[60:63], v[28:31]
    buffer_load_dwordx4 a[212:215], v246, s[12:15], 0 offen nt
    v_mfma_f32_16x16x32_bf16 v[60:63], v[128:131], a[132:135], v[60:63]
    ds_read_b128 v[104:107], v3 offset:54272
    ds_read_b128 v[148:151], v4 offset:35840
    v_mfma_f32_16x16x32_bf16 v[32:35], v[140:143], a[60:63], v[32:35]
    ds_read_b128 v[108:111], v3 offset:55296
    ds_read_b128 v[152:155], v5 offset:35840
    v_mfma_f32_16x16x32_bf16 v[64:67], v[140:143], a[132:135], v[64:67]
    v_mfma_f32_16x16x32_bf16 v[36:39], a[60:63], v[132:135], v[36:39]
    buffer_load_dwordx4 a[216:219], v247, s[8:11], 0 offen nt
    v_mfma_f32_16x16x32_bf16 v[68:71], a[132:135], v[132:135], v[68:71]
    v_mfma_f32_16x16x32_bf16 v[40:43], a[60:63], v[136:139], v[40:43]
    v_mfma_f32_16x16x32_bf16 v[72:75], a[132:135], v[136:139], v[72:75]
    s_waitcnt lgkmcnt(11)
    v_mfma_f32_16x16x32_bf16 v[80:83], v[160:163], v[156:159], v[80:83]
    s_waitcnt lgkmcnt(10)
    v_mfma_f32_16x16x32_bf16 v[84:87], v[156:159], v[164:167], v[84:87]
    s_waitcnt vmcnt(16) lgkmcnt(9)
    ds_read_b128 v[156:159], v10 offset:15360
    ds_read_b128 v[160:163], v4 offset:43008
    v_mfma_f32_16x16x32_bf16 v[16:19], v[88:91], a[64:67], v[16:19]
    buffer_load_dwordx4 a[220:223], v248, s[8:11], 0 offen nt
    s_waitcnt vmcnt(16)
    v_mfma_f32_16x16x32_bf16 v[48:51], v[88:91], a[136:139], v[48:51]
    s_waitcnt lgkmcnt(10)
    ds_read_b128 v[164:167], v5 offset:43008
    ds_read_b128 v[116:119], v3 offset:57344
    v_mfma_f32_16x16x32_bf16 v[20:23], v[92:95], a[64:67], v[20:23]
    ds_read_b128 v[120:123], v3 offset:58368
    v_mfma_f32_16x16x32_bf16 v[52:55], v[92:95], a[136:139], v[52:55]
    s_waitcnt lgkmcnt(12)
    ds_read_b128 v[124:127], v3 offset:59392
    v_mfma_f32_16x16x32_bf16 v[24:27], v[96:99], a[64:67], v[24:27]
    buffer_load_dwordx4 a[224:227], v249, s[8:11], 0 offen nt
    v_mfma_f32_16x16x32_bf16 v[56:59], v[96:99], a[136:139], v[56:59]
    s_waitcnt lgkmcnt(8)
    ds_read_b128 v[128:131], v3 offset:60416
    v_mfma_f32_16x16x32_bf16 v[80:83], v[148:151], v[144:147], v[80:83]
    s_waitcnt lgkmcnt(7)
    v_mfma_f32_16x16x32_bf16 v[84:87], v[144:147], v[152:155], v[84:87]
    ds_read_b128 v[140:143], v3 offset:63488
    ds_read_b128 v[144:147], v10 offset:16384
    v_mfma_f32_16x16x32_bf16 v[28:31], v[100:103], a[64:67], v[28:31]
    buffer_load_dwordx4 a[228:231], v250, s[8:11], 0 offen nt
    v_mfma_f32_16x16x32_bf16 v[60:63], v[100:103], a[136:139], v[60:63]
    ds_read_b128 v[132:135], v3 offset:61440
    ds_read_b128 v[148:151], v4 offset:50176
    v_mfma_f32_16x16x32_bf16 v[32:35], v[112:115], a[64:67], v[32:35]
    ds_read_b128 v[136:139], v3 offset:62464
    ds_read_b128 v[152:155], v5 offset:50176
    v_mfma_f32_16x16x32_bf16 v[64:67], v[112:115], a[136:139], v[64:67]
    v_mfma_f32_16x16x32_bf16 v[36:39], a[64:67], v[104:107], v[36:39]
    buffer_load_dwordx4 a[232:235], v251, s[8:11], 0 offen nt
    v_mfma_f32_16x16x32_bf16 v[68:71], a[136:139], v[104:107], v[68:71]
    v_mfma_f32_16x16x32_bf16 v[40:43], a[64:67], v[108:111], v[40:43]
    v_mfma_f32_16x16x32_bf16 v[72:75], a[136:139], v[108:111], v[72:75]
    s_waitcnt lgkmcnt(11)
    v_mfma_f32_16x16x32_bf16 v[80:83], v[160:163], v[156:159], v[80:83]
    s_waitcnt lgkmcnt(10)
    v_mfma_f32_16x16x32_bf16 v[84:87], v[156:159], v[164:167], v[84:87]
    s_waitcnt vmcnt(17) lgkmcnt(9)
    ds_read_b128 v[156:159], v10 offset:17408
    ds_read_b128 v[160:163], v4 offset:57344
    v_mfma_f32_16x16x32_bf16 v[16:19], v[116:119], a[68:71], v[16:19]
    buffer_load_dwordx4 a[236:239], v252, s[8:11], 0 offen nt
    s_waitcnt vmcnt(17)
    v_mfma_f32_16x16x32_bf16 v[48:51], v[116:119], a[140:143], v[48:51]
    s_waitcnt lgkmcnt(10)
    ds_read_b128 v[164:167], v5 offset:57344
    v_mfma_f32_16x16x32_bf16 v[20:23], v[120:123], a[68:71], v[20:23]
    v_mfma_f32_16x16x32_bf16 v[52:55], v[120:123], a[140:143], v[52:55]
    s_waitcnt lgkmcnt(10)
    v_mfma_f32_16x16x32_bf16 v[24:27], v[124:127], a[68:71], v[24:27]
    buffer_load_dwordx4 a[240:243], v253, s[8:11], 0 offen nt
    v_mfma_f32_16x16x32_bf16 v[56:59], v[124:127], a[140:143], v[56:59]
    s_waitcnt lgkmcnt(5)
    v_mfma_f32_16x16x32_bf16 v[80:83], v[148:151], v[144:147], v[80:83]
    s_waitcnt lgkmcnt(3)
    v_mfma_f32_16x16x32_bf16 v[84:87], v[144:147], v[152:155], v[84:87]
    v_mfma_f32_16x16x32_bf16 v[28:31], v[128:131], a[68:71], v[28:31]
    buffer_load_dwordx4 a[244:247], v254, s[8:11], 0 offen nt
    v_mfma_f32_16x16x32_bf16 v[60:63], v[128:131], a[140:143], v[60:63]
    v_mfma_f32_16x16x32_bf16 v[32:35], v[140:143], a[68:71], v[32:35]
    v_mfma_f32_16x16x32_bf16 v[64:67], v[140:143], a[140:143], v[64:67]
    v_mfma_f32_16x16x32_bf16 v[36:39], a[68:71], v[132:135], v[36:39]
    buffer_load_dwordx4 a[248:251], v255, s[8:11], 0 offen nt
    v_mfma_f32_16x16x32_bf16 v[68:71], a[140:143], v[132:135], v[68:71]
    v_mfma_f32_16x16x32_bf16 v[40:43], a[68:71], v[136:139], v[40:43]
    v_mfma_f32_16x16x32_bf16 v[72:75], a[140:143], v[136:139], v[72:75]
    s_waitcnt lgkmcnt(1)
    v_mfma_f32_16x16x32_bf16 v[80:83], v[160:163], v[156:159], v[80:83]
    s_waitcnt lgkmcnt(0)
    v_mfma_f32_16x16x32_bf16 v[84:87], v[156:159], v[164:167], v[84:87]
    v_lshlrev_b32 v6, 3, v1
    v_add_u32 v6, 148608, v6
    s_mul_i32 s52, s20, 3072
    v_add_u32 v7, s52, v6
    s_lshl_b32 s52, s20, 8
    s_add_u32 s52, s52, 161024
    v_lshl_add_u32 v13, v1, 3, s52
    v_lshrrev_b32 v14, 2, v1
    v_lshl_add_u32 v14, v14, 3, s52
    v_cvt_pk_bf16_f32 v100, v56, v57
    v_cvt_pk_bf16_f32 v101, v58, v59
    v_cvt_pk_bf16_f32 v104, v60, v61
    v_cvt_pk_bf16_f32 v105, v62, v63
    v_cvt_pk_bf16_f32 v134, v64, v65
    v_cvt_pk_bf16_f32 v137, v66, v67
    v_mov_b32 v102, 0
    v_mov_b32 v103, 0
    v_cvt_pk_bf16_f32 v110, v68, v69
    v_cvt_pk_bf16_f32 v111, v70, v71
    v_cvt_pk_bf16_f32 v116, v72, v73
    v_cvt_pk_bf16_f32 v117, v74, v75
    s_mov_b32 exec_lo, 0xffff0000
    s_mov_b32 exec_hi, 0
    ds_write2_b32 v13, v134, v137 offset0:64 offset1:65
    s_mov_b64 exec, -1
    v_permlane32_swap_b32 v134, v102
    v_permlane32_swap_b32 v137, v103
    s_cmp_eq_u32 s20, 3
    s_cbranch_scc1 L_w3_46
    ds_write_b64 v7, v[100:101] offset:3072
    ds_write_b64 v7, v[102:103] offset:3584
    ds_write_b64 v7, v[104:105] offset:4096
    ds_write_b64 v7, v[110:111] offset:4608
    ds_write_b64 v7, v[116:117] offset:5120
L_w3_46:
    v_cvt_pk_bf16_f32 v140, v80, v81
    v_cvt_pk_bf16_f32 v141, v82, v83
    v_cvt_pk_bf16_f32 v142, v84, v85
    v_cvt_pk_bf16_f32 v143, v86, v87
    s_min_u32 s52, s20, 2
    s_lshl_b32 s53, s52, 1
    s_cmp_ge_u32 s20, 2
    s_cselect_b32 s53, 1, s53
    s_lshl_b32 s53, s53, 9
    s_and_b32 s52, s20, 1
    s_add_u32 s52, s52, 3
    s_lshl_b32 s52, s52, 9
    v_add_u32 v8, s53, v6
    v_add_u32 v9, s52, v6
    s_cmp_lt_u32 s20, 2
    s_cbranch_scc1 L_noswap_47
    v_lshlrev_b32 v10, 3, v1
    v_add_u32 v10, 161024, v10
    s_mov_b32 exec_lo, 0xffff0000
    s_mov_b32 exec_hi, 0
    ds_write_b64 v10, v[140:141]
    s_mov_b64 exec, -1
    v_mov_b32 v10, 0
    v_mov_b32 v11, 0
    s_nop 1
    v_permlane32_swap_b32 v140, v10
    v_permlane32_swap_b32 v141, v11
    v_mov_b32 v140, v10
    v_mov_b32 v141, v11
L_noswap_47:
    ds_write_b64 v8, v[140:141]
    ds_write_b64 v9, v[142:143]
    v_cvt_pk_bf16_f32 v132, v48, v49
    v_cvt_pk_bf16_f32 v133, v50, v51
    v_cvt_pk_bf16_f32 v138, v52, v53
    v_cvt_pk_bf16_f32 v139, v54, v55
    v_mov_b32 v135, 0
    v_mov_b32 v136, 0
    v_cvt_pk_bf16_f32 v94, v24, v25
    v_cvt_pk_bf16_f32 v95, v26, v27
    v_cvt_pk_bf16_f32 v98, v28, v29
    v_cvt_pk_bf16_f32 v99, v30, v31
    v_cvt_pk_bf16_f32 v126, v32, v33
    v_cvt_pk_bf16_f32 v129, v34, v35
    v_mov_b32 v96, 0
    v_mov_b32 v97, 0
    v_cvt_pk_bf16_f32 v108, v36, v37
    v_cvt_pk_bf16_f32 v109, v38, v39
    v_cvt_pk_bf16_f32 v114, v40, v41
    v_cvt_pk_bf16_f32 v115, v42, v43
    s_mov_b32 exec_lo, 0xffff0000
    s_mov_b32 exec_hi, 0
    ds_write2_b32 v13, v126, v129 offset0:32 offset1:33
    s_mov_b64 exec, -1
    v_permlane32_swap_b32 v126, v96
    v_permlane32_swap_b32 v129, v97
    v_cvt_pk_bf16_f32 v124, v16, v17
    v_cvt_pk_bf16_f32 v125, v18, v19
    v_cvt_pk_bf16_f32 v130, v20, v21
    v_cvt_pk_bf16_f32 v131, v22, v23
    v_mov_b32 v127, 0
    v_mov_b32 v128, 0
    v_mov_b32 v144, 0x3f803f80
    v_mov_b32 v145, 0x3f803f80
    v_mov_b32 v146, 0x3f803f80
    v_mov_b32 v147, 0x3f803f80
    v_mfma_f32_16x16x32_bf16 v[32:35], v[94:97], v[132:135], v[172:175]
    v_mfma_f32_16x16x32_bf16 v[36:39], v[100:103], v[132:135], v[168:171]
    v_mfma_f32_16x16x32_bf16 v[20:23], v[94:97], v[124:127], v[168:171]
    v_mfma_f32_16x16x32_bf16 v[40:43], v[96:99], v[136:139], v[172:175]
    v_mfma_f32_16x16x32_bf16 v[44:47], v[102:105], v[136:139], v[168:171]
    v_mfma_f32_16x16x32_bf16 v[28:31], v[96:99], v[128:131], v[168:171]
    s_waitcnt lgkmcnt(0)
    s_barrier
    ds_read_b64 v[88:89], v7 offset:0
    ds_read_b64 v[90:91], v7 offset:512
    ds_read_b64 v[92:93], v7 offset:1024
    ds_read_b64 v[106:107], v7 offset:1536
    ds_read_b64 v[112:113], v7 offset:2048
    ds_read_b64_tr_b16 v[118:119], v14 offset:128
    ds_read_b64_tr_b16 v[120:121], v14 offset:256
    ds_read_b64_tr_b16 v[122:123], v14 offset:384
    s_mov_b32 s52, 0x3eae1a93
    s_waitcnt lgkmcnt(6)
    v_mfma_f32_16x16x32_bf16 v[16:19], v[88:91], v[124:127], v[176:179]
    s_waitcnt lgkmcnt(5)
    v_mfma_f32_16x16x32_bf16 v[24:27], v[90:93], v[128:131], v[176:179]
    v_max3_f32 v48, v32, v33, v34
    v_max3_f32 v49, v40, v41, v42
    s_nop 3
    v_max3_f32 v50, v16, v17, v18
    s_nop 0
    v_max3_f32 v51, v24, v25, v26
    v_max3_f32 v48, v48, v35, v36
    v_max3_f32 v49, v49, v43, v44
    v_max3_f32 v50, v50, v19, v20
    v_max3_f32 v51, v51, v27, v28
    v_max3_f32 v48, v48, v37, v38
    v_max3_f32 v49, v49, v45, v46
    v_max3_f32 v50, v50, v21, v22
    v_max3_f32 v51, v51, v29, v30
    v_max_f32 v48, v48, v39
    v_max_f32 v49, v49, v47
    v_max_f32 v50, v50, v23
    v_max_f32 v51, v51, v31
    v_mov_b32 v52, v48
    v_mov_b32 v53, v49
    v_mov_b32 v54, v50
    v_mov_b32 v55, v51
    v_permlane16_swap_b32 v48, v52
    v_permlane16_swap_b32 v49, v53
    v_permlane16_swap_b32 v50, v54
    v_permlane16_swap_b32 v51, v55
    v_max_f32 v48, v48, v52
    v_max_f32 v49, v49, v53
    v_max_f32 v50, v50, v54
    v_max_f32 v51, v51, v55
    v_mov_b32 v52, v48
    v_mov_b32 v53, v49
    v_mov_b32 v54, v50
    v_mov_b32 v55, v51
    v_permlane32_swap_b32 v48, v52
    v_permlane32_swap_b32 v49, v53
    v_permlane32_swap_b32 v50, v54
    v_permlane32_swap_b32 v51, v55
    v_max_f32 v48, v48, v52
    v_max_f32 v49, v49, v53
    v_max_f32 v50, v50, v54
    v_max_f32 v51, v51, v55
    v_mul_f32 v48, s52, v48
    v_mul_f32 v49, s52, v49
    v_mul_f32 v50, s52, v50
    v_mul_f32 v51, s52, v51
    v_fma_f32 v32, v32, s52, -v48
    v_fma_f32 v40, v40, s52, -v49
    v_fma_f32 v16, v16, s52, -v50
    v_fma_f32 v24, v24, s52, -v51
    v_fma_f32 v33, v33, s52, -v48
    v_fma_f32 v41, v41, s52, -v49
    v_fma_f32 v17, v17, s52, -v50
    v_fma_f32 v25, v25, s52, -v51
    v_fma_f32 v34, v34, s52, -v48
    v_fma_f32 v42, v42, s52, -v49
    v_fma_f32 v18, v18, s52, -v50
    v_fma_f32 v26, v26, s52, -v51
    v_fma_f32 v35, v35, s52, -v48
    v_fma_f32 v43, v43, s52, -v49
    v_fma_f32 v19, v19, s52, -v50
    v_fma_f32 v27, v27, s52, -v51
    v_fma_f32 v36, v36, s52, -v48
    v_fma_f32 v44, v44, s52, -v49
    v_fma_f32 v20, v20, s52, -v50
    v_fma_f32 v28, v28, s52, -v51
    v_fma_f32 v37, v37, s52, -v48
    v_fma_f32 v45, v45, s52, -v49
    v_fma_f32 v21, v21, s52, -v50
    v_fma_f32 v29, v29, s52, -v51
    v_fma_f32 v38, v38, s52, -v48
    v_fma_f32 v46, v46, s52, -v49
    v_fma_f32 v22, v22, s52, -v50
    v_fma_f32 v30, v30, s52, -v51
    v_fma_f32 v39, v39, s52, -v48
    v_fma_f32 v47, v47, s52, -v49
    v_fma_f32 v23, v23, s52, -v50
    v_fma_f32 v31, v31, s52, -v51
    v_exp_f32 v32, v32
    v_exp_f32 v40, v40
    v_exp_f32 v16, v16
    v_exp_f32 v24, v24
    v_exp_f32 v33, v33
    v_exp_f32 v41, v41
    v_exp_f32 v17, v17
    v_exp_f32 v25, v25
    v_exp_f32 v34, v34
    v_exp_f32 v42, v42
    v_exp_f32 v18, v18
    v_exp_f32 v26, v26
    v_exp_f32 v35, v35
    v_exp_f32 v43, v43
    v_exp_f32 v19, v19
    v_exp_f32 v27, v27
    v_exp_f32 v36, v36
    v_exp_f32 v44, v44
    v_exp_f32 v20, v20
    v_exp_f32 v28, v28
    v_exp_f32 v37, v37
    v_exp_f32 v45, v45
    v_exp_f32 v21, v21
    v_exp_f32 v29, v29
    v_exp_f32 v38, v38
    v_exp_f32 v46, v46
    v_exp_f32 v22, v22
    v_exp_f32 v30, v30
    v_exp_f32 v39, v39
    v_exp_f32 v47, v47
    v_exp_f32 v23, v23
    v_exp_f32 v31, v31
    v_cvt_pk_bf16_f32 v56, v32, v33
    v_cvt_pk_bf16_f32 v60, v40, v41
    v_cvt_pk_bf16_f32 v64, v16, v17
    v_cvt_pk_bf16_f32 v68, v24, v25
    v_cvt_pk_bf16_f32 v57, v34, v35
    v_cvt_pk_bf16_f32 v61, v42, v43
    v_cvt_pk_bf16_f32 v65, v18, v19
    v_cvt_pk_bf16_f32 v69, v26, v27
    v_cvt_pk_bf16_f32 v58, v36, v37
    v_cvt_pk_bf16_f32 v62, v44, v45
    v_cvt_pk_bf16_f32 v66, v20, v21
    v_cvt_pk_bf16_f32 v70, v28, v29
    v_cvt_pk_bf16_f32 v59, v38, v39
    v_cvt_pk_bf16_f32 v63, v46, v47
    v_cvt_pk_bf16_f32 v67, v22, v23
    v_cvt_pk_bf16_f32 v71, v30, v31
    v_mfma_f32_16x16x32_bf16 v[188:191], v[144:147], v[56:59], 0
    v_mfma_f32_16x16x32_bf16 v[180:183], v[108:111], v[56:59], 0
    s_waitcnt lgkmcnt(0)
    v_mfma_f32_16x16x32_bf16 v[184:187], v[120:123], v[56:59], 0
    v_mfma_f32_16x16x32_bf16 v[200:203], v[144:147], v[60:63], 0
    v_mfma_f32_16x16x32_bf16 v[192:195], v[114:117], v[60:63], 0
    v_mfma_f32_16x16x32_bf16 v[196:199], v[120:123], v[60:63], 0
    v_mfma_f32_16x16x32_bf16 v[212:215], v[144:147], v[64:67], 0
    v_mfma_f32_16x16x32_bf16 v[204:207], v[106:109], v[64:67], 0
    v_mfma_f32_16x16x32_bf16 v[208:211], v[118:121], v[64:67], 0
    v_mfma_f32_16x16x32_bf16 v[224:227], v[144:147], v[68:71], 0
    v_mfma_f32_16x16x32_bf16 v[216:219], v[112:115], v[68:71], 0
    v_mfma_f32_16x16x32_bf16 v[220:223], v[118:121], v[68:71], 0
    s_lshl_b32 s53, s46, 4
    s_add_u32 s53, s53, s45
    s_lshl_b32 s54, s53, 10
    s_add_u32 s54, s54, 23330816
    s_lshl_b32 s55, s53, 7
    s_add_u32 s55, s55, 25427840
    v_lshlrev_b32 v6, 3, v1
    v_rcp_f32 v188, v188
    v_rcp_f32 v200, v200
    v_rcp_f32 v212, v212
    v_rcp_f32 v224, v224
    v_mul_f32 v180, v180, v188
    v_mul_f32 v181, v181, v188
    v_mul_f32 v182, v182, v188
    v_mul_f32 v183, v183, v188
    v_mul_f32 v184, v184, v188
    v_mul_f32 v185, v185, v188
    v_cvt_pk_bf16_f32 v76, v180, v181
    v_cvt_pk_bf16_f32 v77, v182, v183
    v_cvt_pk_bf16_f32 v82, v184, v185
    v_mul_f32 v192, v192, v200
    v_mul_f32 v193, v193, v200
    v_mul_f32 v194, v194, v200
    v_mul_f32 v195, v195, v200
    v_mul_f32 v198, v198, v200
    v_mul_f32 v199, v199, v200
    v_cvt_pk_bf16_f32 v78, v192, v193
    v_cvt_pk_bf16_f32 v79, v194, v195
    v_cvt_pk_bf16_f32 v83, v198, v199
    s_add_u32 s53, s54, 16384
    buffer_store_dwordx4 v[76:79], v2, s[4:7], s53 offen sc1
    v_mul_f32 v204, v204, v212
    v_mul_f32 v205, v205, v212
    v_mul_f32 v206, v206, v212
    v_mul_f32 v207, v207, v212
    v_mul_f32 v208, v208, v212
    v_mul_f32 v209, v209, v212
    v_cvt_pk_bf16_f32 v72, v204, v205
    v_cvt_pk_bf16_f32 v73, v206, v207
    v_cvt_pk_bf16_f32 v80, v208, v209
    v_mul_f32 v216, v216, v224
    v_mul_f32 v217, v217, v224
    v_mul_f32 v218, v218, v224
    v_mul_f32 v219, v219, v224
    v_mul_f32 v222, v222, v224
    v_mul_f32 v223, v223, v224
    v_cvt_pk_bf16_f32 v74, v216, v217
    v_cvt_pk_bf16_f32 v75, v218, v219
    v_cvt_pk_bf16_f32 v81, v222, v223
    s_add_u32 s53, s54, 0
    buffer_store_dwordx4 v[72:75], v2, s[4:7], s53 offen sc1
    s_mov_b32 exec_lo, 0xffff0000
    s_mov_b32 exec_hi, 0
    buffer_store_dwordx2 v[80:81], v6, s[4:7], s55 offen offset:0 sc1
    buffer_store_dwordx2 v[82:83], v6, s[4:7], s55 offen offset:2048 sc1
    s_mov_b64 exec, -1
    s_lshl_b32 s52, s44, 2
    s_add_u32 s52, s52, s20
    s_lshl_b32 s52, s52, 4
    s_add_u32 s52, s52, s45
    s_lshl_b32 s52, s52, 3
    s_add_u32 s52, s52, 16384
    s_mul_i32 s53, s22, 10923
    s_lshr_b32 s53, s53, 16
    s_mul_i32 s53, s53, 6
    s_sub_u32 s53, s22, s53
    s_lshl_b32 s53, s53, 8
    s_add_u32 s23, s53, 135168
    v_min_u32 v13, 17, v1
    v_lshlrev_b32 v13, 3, v13
    s_lshl_b32 s23, s23, 2
    s_add_u32 s23, s23, 0x8000000
    v_lshlrev_b32 v13, 2, v13
    buffer_load_dwordx2 v[14:15], v13, s[4:7], s23 offen sc1
    v_mov_b32 v8, s98
    v_mov_b32 v9, s99
    s_waitcnt vmcnt(1)
    s_lshl_b32 s52, s52, 2
    s_add_u32 s52, s52, 0x8000000
    s_mov_b64 exec, 1
    buffer_store_dwordx2 v[8:9], off, s[4:7], s52 sc1
    s_mov_b64 exec, -1
    s_lshl_b32 s0, s0, 2
    s_add_u32 s0, s0, 0x8000000
    s_mov_b64 exec, 1
    buffer_store_dwordx2 v[8:9], off, s[4:7], s0 sc1
    s_mov_b64 exec, -1
    s_cmp_ge_u32 s22, 24
    s_cbranch_scc1 L_idle0_48
    s_mul_i32 s44, s22, 10923
    s_lshr_b32 s44, s44, 16
    s_mul_i32 s52, s44, 6
    s_sub_u32 s45, s22, s52
    s_lshl_b32 s52, s21, 2
    s_add_u32 s44, s44, s52
    s_lshl_b32 s46, s44, 2
    s_add_u32 s46, s46, s20
    s_mul_i32 s47, s45, 110592
    s_mul_i32 s48, s20, 3072
    s_add_u32 s47, s47, s48
    s_add_u32 s47, s47, 2097152
    s_lshl_b32 s49, s46, 14
    s_add_u32 s49, s49, 23330816
    s_lshl_b32 s50, s46, 11
    s_add_u32 s50, s50, 25427968
    v_and_b32 v3, 15, v1
    v_lshrrev_b32 v4, 4, v1
    v_lshlrev_b32 v5, 3, v3
    v_lshl_add_u32 v5, v4, 8, v5
    s_lshl_b32 s52, s46, 4
    v_add_u32 v6, s52, v3
    v_lshlrev_b32 v7, 3, v6
    v_mul_u32_u24 v6, 1152, v6
    v_lshl_add_u32 v6, v4, 4, v6
    s_mul_i32 s51, s45, 192
    s_mov_b32 s8, s24
    s_mov_b32 s9, s25
    s_mov_b32 s10, 0x240000
    s_mov_b32 s11, 0x20000
    s_waitcnt vmcnt(2)
    v_cmp_eq_u64 vcc, s[98:99], v[14:15]
    s_nop 0
    s_cmp_eq_u64 vcc, exec
    s_cbranch_scc0 L_pwo_slow_35
L_pwo_back_36:
    s_mov_b32 m0, s48
    s_nop 0
    buffer_load_dwordx4 v2, s[4:7], s47 offen offset:0 lds
    buffer_load_dwordx4 v2, s[4:7], s47 offen offset:1024 lds
    buffer_load_dwordx4 v2, s[4:7], s47 offen offset:2048 lds
    s_add_u32 s48, s48, 12288
    s_add_u32 s47, s47, 12288
    s_mov_b32 m0, s48
    s_nop 0
    buffer_load_dwordx4 v2, s[4:7], s47 offen offset:0 lds
    buffer_load_dwordx4 v2, s[4:7], s47 offen offset:1024 lds
    buffer_load_dwordx4 v2, s[4:7], s47 offen offset:2048 lds
    s_add_u32 s48, s48, 12288
    s_add_u32 s47, s47, 12288
    s_mov_b32 m0, s48
    s_nop 0
    buffer_load_dwordx4 v2, s[4:7], s47 offen offset:0 lds
    buffer_load_dwordx4 v2, s[4:7], s47 offen offset:1024 lds
    buffer_load_dwordx4 v2, s[4:7], s47 offen offset:2048 lds
    s_add_u32 s48, s48, 12288
    s_add_u32 s47, s47, 12288
    s_mov_b32 m0, s48
    s_nop 0
    buffer_load_dwordx4 v2, s[4:7], s47 offen offset:0 lds
    buffer_load_dwordx4 v2, s[4:7], s47 offen offset:1024 lds
    buffer_load_dwordx4 v2, s[4:7], s47 offen offset:2048 lds
    s_add_u32 s48, s48, 12288
    s_add_u32 s47, s47, 12288
    s_mov_b32 m0, s48
    s_nop 0
    buffer_load_dwordx4 v2, s[4:7], s47 offen offset:0 lds
    buffer_load_dwordx4 v2, s[4:7], s47 offen offset:1024 lds
    buffer_load_dwordx4 v2, s[4:7], s47 offen offset:2048 lds
    s_add_u32 s48, s48, 12288
    s_add_u32 s47, s47, 12288
    s_mov_b32 m0, s48
    s_nop 0
    buffer_load_dwordx4 v2, s[4:7], s47 offen offset:0 lds
    buffer_load_dwordx4 v2, s[4:7], s47 offen offset:1024 lds
    buffer_load_dwordx4 v2, s[4:7], s47 offen offset:2048 lds
    s_add_u32 s48, s48, 12288
    s_add_u32 s47, s47, 12288
    s_mov_b32 m0, s48
    s_nop 0
    buffer_load_dwordx4 v2, s[4:7], s47 offen offset:0 lds
    buffer_load_dwordx4 v2, s[4:7], s47 offen offset:1024 lds
    buffer_load_dwordx4 v2, s[4:7], s47 offen offset:2048 lds
    s_add_u32 s48, s48, 12288
    s_add_u32 s47, s47, 12288
    s_mov_b32 m0, s48
    s_nop 0
    buffer_load_dwordx4 v2, s[4:7], s47 offen offset:0 lds
    buffer_load_dwordx4 v2, s[4:7], s47 offen offset:1024 lds
    buffer_load_dwordx4 v2, s[4:7], s47 offen offset:2048 lds
    s_add_u32 s48, s48, 12288
    s_add_u32 s47, s47, 12288
    s_mov_b32 m0, s48
    s_nop 0
    buffer_load_dwordx4 v2, s[4:7], s47 offen offset:0 lds
    buffer_load_dwordx4 v2, s[4:7], s47 offen offset:1024 lds
    buffer_load_dwordx4 v2, s[4:7], s47 offen offset:2048 lds
    s_add_u32 s48, s48, 12288
    s_add_u32 s47, s47, 12288
    s_lshr_b32 s52, s46, 1
    s_lshl_b32 s52, s52, 7
    s_add_u32 s52, s52, 16384
    v_and_b32 v10, 15, v1
    v_lshlrev_b32 v10, 3, v10
    s_mul_i32 s53, s45, 2816
    s_min_u32 s53, s53, 13568
    s_add_u32 s53, s53, s49
    buffer_load_dwordx4 v[160:163], v6, s[8:11], s51 offen offset:0
    buffer_load_dwordx4 v[164:167], v6, s[8:11], s51 offen offset:64
    buffer_load_dwordx4 v[168:171], v6, s[8:11], s51 offen offset:128
    v_mov_b32 v8, v2
    s_waitcnt vmcnt(3)
    s_barrier
    s_lshl_b32 s52, s52, 2
    s_add_u32 s52, s52, 0x8000000
    v_lshlrev_b32 v10, 2, v10
    buffer_load_dwordx2 v[12:13], v10, s[4:7], s52 offen sc1
    ds_read_b128 a[0:3], v8 offset:0
    ds_read_b128 a[4:7], v8 offset:1024
    ds_read_b128 a[8:11], v8 offset:2048
    ds_read_b128 a[12:15], v8 offset:3072
    ds_read_b128 a[16:19], v8 offset:4096
    ds_read_b128 a[20:23], v8 offset:5120
    ds_read_b128 a[24:27], v8 offset:6144
    ds_read_b128 a[28:31], v8 offset:7168
    ds_read_b128 a[32:35], v8 offset:8192
    ds_read_b128 a[36:39], v8 offset:9216
    ds_read_b128 a[40:43], v8 offset:10240
    ds_read_b128 a[44:47], v8 offset:11264
    ds_read_b128 a[48:51], v8 offset:12288
    ds_read_b128 a[52:55], v8 offset:13312
    ds_read_b128 a[56:59], v8 offset:14336
    ds_read_b128 a[60:63], v8 offset:15360
    ds_read_b128 a[64:67], v8 offset:16384
    ds_read_b128 a[68:71], v8 offset:17408
    ds_read_b128 a[72:75], v8 offset:18432
    ds_read_b128 a[76:79], v8 offset:19456
    ds_read_b128 a[80:83], v8 offset:20480
    ds_read_b128 a[84:87], v8 offset:21504
    ds_read_b128 a[88:91], v8 offset:22528
    ds_read_b128 a[92:95], v8 offset:23552
    ds_read_b128 v[112:115], v8 offset:24576
    ds_read_b128 v[116:119], v8 offset:25600
    ds_read_b128 v[120:123], v8 offset:26624
    ds_read_b128 v[124:127], v8 offset:27648
    ds_read_b128 v[128:131], v8 offset:28672
    ds_read_b128 v[132:135], v8 offset:29696
    ds_read_b128 v[136:139], v8 offset:30720
    ds_read_b128 v[140:143], v8 offset:31744
    ds_read_b128 v[144:147], v8 offset:32768
    ds_read_b128 v[148:151], v8 offset:33792
    s_waitcnt vmcnt(0)
    v_cmp_eq_u64 vcc, s[98:99], v[12:13]
    s_nop 0
    s_cmp_eq_u64 vcc, exec
    s_cbranch_scc0 L_po_slow_55
L_po_back_56:
    buffer_load_dwordx4 v[16:19], v2, s[4:7], s49 offen offset:0 sc1
    buffer_load_dwordx4 v[20:23], v2, s[4:7], s49 offen offset:1024 sc1
    buffer_load_dwordx4 v[24:27], v2, s[4:7], s49 offen offset:2048 sc1
    buffer_load_dwordx4 v[28:31], v2, s[4:7], s49 offen offset:3072 sc1
    s_add_u32 s49, s49, 4096
    buffer_load_dwordx4 v[32:35], v2, s[4:7], s49 offen offset:0 sc1
    buffer_load_dwordx4 v[36:39], v2, s[4:7], s49 offen offset:1024 sc1
    buffer_load_dwordx4 v[40:43], v2, s[4:7], s49 offen offset:2048 sc1
    buffer_load_dwordx4 v[44:47], v2, s[4:7], s49 offen offset:3072 sc1
    s_waitcnt vmcnt(7) lgkmcnt(15)
    s_add_u32 s49, s49, 4096
    v_mfma_f32_16x16x32_bf16 v[88:91], a[0:3], v[16:19], 0
    buffer_load_dwordx4 v[48:51], v2, s[4:7], s49 offen offset:0 sc1
    s_waitcnt lgkmcnt(15)
    v_mfma_f32_16x16x32_bf16 v[92:95], a[4:7], v[16:19], 0
    s_waitcnt lgkmcnt(15)
    v_mfma_f32_16x16x32_bf16 v[96:99], a[8:11], v[16:19], 0
    s_waitcnt lgkmcnt(15)
    v_mfma_f32_16x16x32_bf16 v[100:103], a[12:15], v[16:19], 0
    buffer_load_dwordx4 v[52:55], v2, s[4:7], s49 offen offset:1024 sc1
    s_waitcnt lgkmcnt(15)
    v_mfma_f32_16x16x32_bf16 v[104:107], a[16:19], v[16:19], 0
    s_waitcnt lgkmcnt(15)
    v_mfma_f32_16x16x32_bf16 v[108:111], a[20:23], v[16:19], 0
    s_waitcnt vmcnt(8) lgkmcnt(15)
    v_mfma_f32_16x16x32_bf16 v[88:91], a[24:27], v[20:23], v[88:91]
    buffer_load_dwordx4 v[56:59], v2, s[4:7], s49 offen offset:2048 sc1
    s_waitcnt lgkmcnt(15)
    v_mfma_f32_16x16x32_bf16 v[92:95], a[28:31], v[20:23], v[92:95]
    s_waitcnt lgkmcnt(15)
    v_mfma_f32_16x16x32_bf16 v[96:99], a[32:35], v[20:23], v[96:99]
    s_waitcnt lgkmcnt(15)
    v_mfma_f32_16x16x32_bf16 v[100:103], a[36:39], v[20:23], v[100:103]
    buffer_load_dwordx4 v[60:63], v2, s[4:7], s49 offen offset:3072 sc1
    s_waitcnt lgkmcnt(15)
    v_mfma_f32_16x16x32_bf16 v[104:107], a[40:43], v[20:23], v[104:107]
    s_waitcnt lgkmcnt(15)
    s_add_u32 s49, s49, 4096
    v_mfma_f32_16x16x32_bf16 v[108:111], a[44:47], v[20:23], v[108:111]
    s_waitcnt vmcnt(9) lgkmcnt(15)
    v_mfma_f32_16x16x32_bf16 v[88:91], a[48:51], v[24:27], v[88:91]
    buffer_load_dwordx4 v[64:67], v2, s[4:7], s49 offen offset:0 sc1
    s_waitcnt lgkmcnt(15)
    v_mfma_f32_16x16x32_bf16 v[92:95], a[52:55], v[24:27], v[92:95]
    s_waitcnt lgkmcnt(15)
    v_mfma_f32_16x16x32_bf16 v[96:99], a[56:59], v[24:27], v[96:99]
    s_waitcnt lgkmcnt(15)
    v_mfma_f32_16x16x32_bf16 v[100:103], a[60:63], v[24:27], v[100:103]
    buffer_load_dwordx4 v[68:71], v2, s[4:7], s49 offen offset:1024 sc1
    s_waitcnt lgkmcnt(15)
    v_mfma_f32_16x16x32_bf16 v[104:107], a[64:67], v[24:27], v[104:107]
    s_waitcnt lgkmcnt(15)
    v_mfma_f32_16x16x32_bf16 v[108:111], a[68:71], v[24:27], v[108:111]
    s_waitcnt vmcnt(10) lgkmcnt(15)
    v_mfma_f32_16x16x32_bf16 v[88:91], a[72:75], v[28:31], v[88:91]
    buffer_load_dwordx4 v[72:75], v2, s[4:7], s49 offen offset:2048 sc1
    s_waitcnt lgkmcnt(14)
    v_mfma_f32_16x16x32_bf16 v[92:95], a[76:79], v[28:31], v[92:95]
    s_waitcnt lgkmcnt(13)
    v_mfma_f32_16x16x32_bf16 v[96:99], a[80:83], v[28:31], v[96:99]
    s_waitcnt lgkmcnt(12)
    v_mfma_f32_16x16x32_bf16 v[100:103], a[84:87], v[28:31], v[100:103]
    buffer_load_dwordx4 v[76:79], v2, s[4:7], s49 offen offset:3072 sc1
    s_waitcnt lgkmcnt(11)
    v_mfma_f32_16x16x32_bf16 v[104:107], a[88:91], v[28:31], v[104:107]
    s_waitcnt lgkmcnt(10)
    v_mfma_f32_16x16x32_bf16 v[108:111], a[92:95], v[28:31], v[108:111]
    s_waitcnt vmcnt(11) lgkmcnt(9)
    v_mfma_f32_16x16x32_bf16 v[88:91], v[112:115], v[32:35], v[88:91]
    s_waitcnt lgkmcnt(8)
    ds_read_b128 v[152:155], v8 offset:34816
    v_mfma_f32_16x16x32_bf16 v[92:95], v[116:119], v[32:35], v[92:95]
    s_waitcnt lgkmcnt(8)
    ds_read_b128 v[156:159], v8 offset:35840
    v_mfma_f32_16x16x32_bf16 v[96:99], v[120:123], v[32:35], v[96:99]
    s_waitcnt lgkmcnt(8)
    ds_read_b128 v[112:115], v8 offset:36864
    v_mfma_f32_16x16x32_bf16 v[100:103], v[124:127], v[32:35], v[100:103]
    s_waitcnt lgkmcnt(8)
    ds_read_b128 v[116:119], v8 offset:37888
    v_mfma_f32_16x16x32_bf16 v[104:107], v[128:131], v[32:35], v[104:107]
    s_waitcnt lgkmcnt(8)
    ds_read_b128 v[120:123], v8 offset:38912
    v_mfma_f32_16x16x32_bf16 v[108:111], v[132:135], v[32:35], v[108:111]
    s_waitcnt vmcnt(10) lgkmcnt(8)
    ds_read_b128 v[124:127], v8 offset:39936
    v_mfma_f32_16x16x32_bf16 v[88:91], v[136:139], v[36:39], v[88:91]
    s_waitcnt lgkmcnt(8)
    ds_read_b128 v[128:131], v8 offset:40960
    v_mfma_f32_16x16x32_bf16 v[92:95], v[140:143], v[36:39], v[92:95]
    s_waitcnt lgkmcnt(8)
    ds_read_b128 v[132:135], v8 offset:41984
    v_mfma_f32_16x16x32_bf16 v[96:99], v[144:147], v[36:39], v[96:99]
    s_waitcnt lgkmcnt(8)
    ds_read_b128 v[136:139], v8 offset:43008
    v_mfma_f32_16x16x32_bf16 v[100:103], v[148:151], v[36:39], v[100:103]
    s_waitcnt lgkmcnt(8)
    ds_read_b128 v[140:143], v8 offset:44032
    v_mfma_f32_16x16x32_bf16 v[104:107], v[152:155], v[36:39], v[104:107]
    s_waitcnt lgkmcnt(8)
    ds_read_b128 v[144:147], v8 offset:45056
    v_mfma_f32_16x16x32_bf16 v[108:111], v[156:159], v[36:39], v[108:111]
    s_waitcnt vmcnt(9) lgkmcnt(8)
    ds_read_b128 v[148:151], v8 offset:46080
    v_mfma_f32_16x16x32_bf16 v[88:91], v[112:115], v[40:43], v[88:91]
    s_waitcnt lgkmcnt(8)
    ds_read_b128 v[152:155], v8 offset:47104
    v_mfma_f32_16x16x32_bf16 v[92:95], v[116:119], v[40:43], v[92:95]
    s_waitcnt lgkmcnt(8)
    ds_read_b128 v[156:159], v8 offset:48128
    v_mfma_f32_16x16x32_bf16 v[96:99], v[120:123], v[40:43], v[96:99]
    s_waitcnt lgkmcnt(8)
    ds_read_b128 v[112:115], v8 offset:49152
    v_mfma_f32_16x16x32_bf16 v[100:103], v[124:127], v[40:43], v[100:103]
    s_waitcnt lgkmcnt(8)
    ds_read_b128 v[116:119], v8 offset:50176
    v_mfma_f32_16x16x32_bf16 v[104:107], v[128:131], v[40:43], v[104:107]
    s_waitcnt lgkmcnt(8)
    ds_read_b128 v[120:123], v8 offset:51200
    v_mfma_f32_16x16x32_bf16 v[108:111], v[132:135], v[40:43], v[108:111]
    s_waitcnt vmcnt(8) lgkmcnt(8)
    ds_read_b128 v[124:127], v8 offset:52224
    v_mfma_f32_16x16x32_bf16 v[88:91], v[136:139], v[44:47], v[88:91]
    s_waitcnt lgkmcnt(8)
    ds_read_b128 v[128:131], v8 offset:53248
    v_mfma_f32_16x16x32_bf16 v[92:95], v[140:143], v[44:47], v[92:95]
    s_waitcnt lgkmcnt(8)
    ds_read_b128 v[132:135], v8 offset:54272
    v_mfma_f32_16x16x32_bf16 v[96:99], v[144:147], v[44:47], v[96:99]
    s_waitcnt lgkmcnt(8)
    ds_read_b128 v[136:139], v8 offset:55296
    v_mfma_f32_16x16x32_bf16 v[100:103], v[148:151], v[44:47], v[100:103]
    s_waitcnt lgkmcnt(8)
    ds_read_b128 v[140:143], v8 offset:56320
    v_mfma_f32_16x16x32_bf16 v[104:107], v[152:155], v[44:47], v[104:107]
    s_waitcnt lgkmcnt(8)
    ds_read_b128 v[144:147], v8 offset:57344
    v_mfma_f32_16x16x32_bf16 v[108:111], v[156:159], v[44:47], v[108:111]
    s_waitcnt vmcnt(7) lgkmcnt(8)
    ds_read_b128 v[148:151], v8 offset:58368
    v_mfma_f32_16x16x32_bf16 v[88:91], v[112:115], v[48:51], v[88:91]
    s_waitcnt lgkmcnt(8)
    ds_read_b128 v[152:155], v8 offset:59392
    v_mfma_f32_16x16x32_bf16 v[92:95], v[116:119], v[48:51], v[92:95]
    s_waitcnt lgkmcnt(8)
    ds_read_b128 v[156:159], v8 offset:60416
    v_mfma_f32_16x16x32_bf16 v[96:99], v[120:123], v[48:51], v[96:99]
    s_waitcnt lgkmcnt(8)
    v_add_u32 v8, 61440, v8
    ds_read_b128 v[112:115], v8 offset:0
    v_mfma_f32_16x16x32_bf16 v[100:103], v[124:127], v[48:51], v[100:103]
    s_waitcnt lgkmcnt(8)
    ds_read_b128 v[116:119], v8 offset:1024
    v_mfma_f32_16x16x32_bf16 v[104:107], v[128:131], v[48:51], v[104:107]
    s_waitcnt lgkmcnt(8)
    ds_read_b128 v[120:123], v8 offset:2048
    v_mfma_f32_16x16x32_bf16 v[108:111], v[132:135], v[48:51], v[108:111]
    s_waitcnt vmcnt(6) lgkmcnt(8)
    ds_read_b128 v[124:127], v8 offset:3072
    v_mfma_f32_16x16x32_bf16 v[88:91], v[136:139], v[52:55], v[88:91]
    s_waitcnt lgkmcnt(8)
    ds_read_b128 v[128:131], v8 offset:4096
    v_mfma_f32_16x16x32_bf16 v[92:95], v[140:143], v[52:55], v[92:95]
    s_waitcnt lgkmcnt(8)
    ds_read_b128 v[132:135], v8 offset:5120
    v_mfma_f32_16x16x32_bf16 v[96:99], v[144:147], v[52:55], v[96:99]
    s_waitcnt lgkmcnt(8)
    ds_read_b128 v[136:139], v8 offset:6144
    v_mfma_f32_16x16x32_bf16 v[100:103], v[148:151], v[52:55], v[100:103]
    s_waitcnt lgkmcnt(8)
    ds_read_b128 v[140:143], v8 offset:7168
    v_mfma_f32_16x16x32_bf16 v[104:107], v[152:155], v[52:55], v[104:107]
    s_waitcnt lgkmcnt(8)
    ds_read_b128 v[144:147], v8 offset:8192
    v_mfma_f32_16x16x32_bf16 v[108:111], v[156:159], v[52:55], v[108:111]
    s_waitcnt vmcnt(5) lgkmcnt(8)
    ds_read_b128 v[148:151], v8 offset:9216
    v_mfma_f32_16x16x32_bf16 v[88:91], v[112:115], v[56:59], v[88:91]
    s_waitcnt lgkmcnt(8)
    ds_read_b128 v[152:155], v8 offset:10240
    v_mfma_f32_16x16x32_bf16 v[92:95], v[116:119], v[56:59], v[92:95]
    s_waitcnt lgkmcnt(8)
    ds_read_b128 v[156:159], v8 offset:11264
    v_mfma_f32_16x16x32_bf16 v[96:99], v[120:123], v[56:59], v[96:99]
    s_waitcnt lgkmcnt(8)
    ds_read_b128 v[112:115], v8 offset:12288
    v_mfma_f32_16x16x32_bf16 v[100:103], v[124:127], v[56:59], v[100:103]
    s_waitcnt lgkmcnt(8)
    ds_read_b128 v[116:119], v8 offset:13312
    v_mfma_f32_16x16x32_bf16 v[104:107], v[128:131], v[56:59], v[104:107]
    s_waitcnt lgkmcnt(8)
    ds_read_b128 v[120:123], v8 offset:14336
    v_mfma_f32_16x16x32_bf16 v[108:111], v[132:135], v[56:59], v[108:111]
    ds_read_b128 v[124:127], v8 offset:15360
    buffer_load_dwordx2 v[80:81], v5, s[4:7], s50 offen offset:0 sc1
    buffer_load_dwordx2 v[82:83], v5, s[4:7], s50 offen offset:128 sc1
    s_waitcnt vmcnt(6) lgkmcnt(9)
    v_mfma_f32_16x16x32_bf16 v[88:91], v[136:139], v[60:63], v[88:91]
    s_waitcnt lgkmcnt(8)
    ds_read_b128 v[128:131], v8 offset:16384
    v_mfma_f32_16x16x32_bf16 v[92:95], v[140:143], v[60:63], v[92:95]
    s_waitcnt lgkmcnt(8)
    ds_read_b128 v[132:135], v8 offset:17408
    v_mfma_f32_16x16x32_bf16 v[96:99], v[144:147], v[60:63], v[96:99]
    s_waitcnt lgkmcnt(8)
    ds_read_b128 v[136:139], v8 offset:18432
    v_mfma_f32_16x16x32_bf16 v[100:103], v[148:151], v[60:63], v[100:103]
    s_waitcnt lgkmcnt(8)
    ds_read_b128 v[140:143], v8 offset:19456
    v_mfma_f32_16x16x32_bf16 v[104:107], v[152:155], v[60:63], v[104:107]
    s_waitcnt lgkmcnt(8)
    ds_read_b128 v[144:147], v8 offset:20480
    v_mfma_f32_16x16x32_bf16 v[108:111], v[156:159], v[60:63], v[108:111]
    ds_read_b128 v[148:151], v8 offset:21504
    buffer_load_dwordx2 v[84:85], v5, s[4:7], s50 offen offset:1024 sc1
    buffer_load_dwordx2 v[86:87], v5, s[4:7], s50 offen offset:1152 sc1
    s_waitcnt vmcnt(7) lgkmcnt(9)
    v_mfma_f32_16x16x32_bf16 v[88:91], v[112:115], v[64:67], v[88:91]
    s_waitcnt lgkmcnt(8)
    ds_read_b128 v[152:155], v8 offset:22528
    v_mfma_f32_16x16x32_bf16 v[92:95], v[116:119], v[64:67], v[92:95]
    s_waitcnt lgkmcnt(8)
    ds_read_b128 v[156:159], v8 offset:23552
    v_mfma_f32_16x16x32_bf16 v[96:99], v[120:123], v[64:67], v[96:99]
    s_waitcnt lgkmcnt(8)
    ds_read_b128 v[112:115], v8 offset:24576
    v_mfma_f32_16x16x32_bf16 v[100:103], v[124:127], v[64:67], v[100:103]
    s_waitcnt lgkmcnt(8)
    ds_read_b128 v[116:119], v8 offset:25600
    v_mfma_f32_16x16x32_bf16 v[104:107], v[128:131], v[64:67], v[104:107]
    s_waitcnt lgkmcnt(8)
    ds_read_b128 v[120:123], v8 offset:26624
    v_mfma_f32_16x16x32_bf16 v[108:111], v[132:135], v[64:67], v[108:111]
    s_waitcnt vmcnt(6) lgkmcnt(8)
    ds_read_b128 v[124:127], v8 offset:27648
    v_mfma_f32_16x16x32_bf16 v[88:91], v[136:139], v[68:71], v[88:91]
    s_waitcnt lgkmcnt(8)
    ds_read_b128 v[128:131], v8 offset:28672
    v_mfma_f32_16x16x32_bf16 v[92:95], v[140:143], v[68:71], v[92:95]
    s_waitcnt lgkmcnt(8)
    ds_read_b128 v[132:135], v8 offset:29696
    v_mfma_f32_16x16x32_bf16 v[96:99], v[144:147], v[68:71], v[96:99]
    s_waitcnt lgkmcnt(8)
    ds_read_b128 v[136:139], v8 offset:30720
    v_mfma_f32_16x16x32_bf16 v[100:103], v[148:151], v[68:71], v[100:103]
    s_waitcnt lgkmcnt(8)
    ds_read_b128 v[140:143], v8 offset:31744
    v_mfma_f32_16x16x32_bf16 v[104:107], v[152:155], v[68:71], v[104:107]
    s_waitcnt lgkmcnt(8)
    ds_read_b128 v[144:147], v8 offset:32768
    v_mfma_f32_16x16x32_bf16 v[108:111], v[156:159], v[68:71], v[108:111]
    s_waitcnt vmcnt(5) lgkmcnt(8)
    ds_read_b128 v[148:151], v8 offset:33792
    v_mfma_f32_16x16x32_bf16 v[88:91], v[112:115], v[72:75], v[88:91]
    s_waitcnt lgkmcnt(8)
    ds_read_b128 v[152:155], v8 offset:34816
    v_mfma_f32_16x16x32_bf16 v[92:95], v[116:119], v[72:75], v[92:95]
    s_waitcnt lgkmcnt(8)
    ds_read_b128 v[156:159], v8 offset:35840
    v_mfma_f32_16x16x32_bf16 v[96:99], v[120:123], v[72:75], v[96:99]
    s_waitcnt lgkmcnt(8)
    ds_read_b128 v[112:115], v8 offset:36864
    v_mfma_f32_16x16x32_bf16 v[100:103], v[124:127], v[72:75], v[100:103]
    s_waitcnt lgkmcnt(8)
    ds_read_b128 v[116:119], v8 offset:37888
    v_mfma_f32_16x16x32_bf16 v[104:107], v[128:131], v[72:75], v[104:107]
    s_waitcnt lgkmcnt(8)
    ds_read_b128 v[120:123], v8 offset:38912
    v_mfma_f32_16x16x32_bf16 v[108:111], v[132:135], v[72:75], v[108:111]
    s_waitcnt vmcnt(4) lgkmcnt(8)
    ds_read_b128 v[124:127], v8 offset:39936
    v_mfma_f32_16x16x32_bf16 v[88:91], v[136:139], v[76:79], v[88:91]
    s_waitcnt lgkmcnt(8)
    ds_read_b128 v[128:131], v8 offset:40960
    v_mfma_f32_16x16x32_bf16 v[92:95], v[140:143], v[76:79], v[92:95]
    s_waitcnt lgkmcnt(8)
    ds_read_b128 v[132:135], v8 offset:41984
    v_mfma_f32_16x16x32_bf16 v[96:99], v[144:147], v[76:79], v[96:99]
    s_waitcnt lgkmcnt(8)
    ds_read_b128 v[136:139], v8 offset:43008
    v_mfma_f32_16x16x32_bf16 v[100:103], v[148:151], v[76:79], v[100:103]
    s_waitcnt lgkmcnt(8)
    ds_read_b128 v[140:143], v8 offset:44032
    v_mfma_f32_16x16x32_bf16 v[104:107], v[152:155], v[76:79], v[104:107]
    s_waitcnt lgkmcnt(8)
    ds_read_b128 v[144:147], v8 offset:45056
    v_mfma_f32_16x16x32_bf16 v[108:111], v[156:159], v[76:79], v[108:111]
    s_waitcnt vmcnt(2) lgkmcnt(8)
    ds_read_b128 v[148:151], v8 offset:46080
    v_mfma_f32_16x16x32_bf16 v[88:91], v[112:115], v[80:83], v[88:91]
    s_waitcnt lgkmcnt(8)
    ds_read_b128 v[152:155], v8 offset:47104
    v_mfma_f32_16x16x32_bf16 v[92:95], v[116:119], v[80:83], v[92:95]
    s_waitcnt lgkmcnt(8)
    ds_read_b128 v[156:159], v8 offset:48128
    v_mfma_f32_16x16x32_bf16 v[96:99], v[120:123], v[80:83], v[96:99]
    s_waitcnt lgkmcnt(8)
    v_mfma_f32_16x16x32_bf16 v[100:103], v[124:127], v[80:83], v[100:103]
    s_waitcnt lgkmcnt(7)
    v_mfma_f32_16x16x32_bf16 v[104:107], v[128:131], v[80:83], v[104:107]
    s_waitcnt lgkmcnt(6)
    v_mfma_f32_16x16x32_bf16 v[108:111], v[132:135], v[80:83], v[108:111]
    s_waitcnt vmcnt(0) lgkmcnt(5)
    v_mfma_f32_16x16x32_bf16 v[88:91], v[136:139], v[84:87], v[88:91]
    s_waitcnt lgkmcnt(4)
    v_mfma_f32_16x16x32_bf16 v[92:95], v[140:143], v[84:87], v[92:95]
    s_waitcnt lgkmcnt(3)
    v_mfma_f32_16x16x32_bf16 v[96:99], v[144:147], v[84:87], v[96:99]
    s_waitcnt lgkmcnt(2)
    v_mfma_f32_16x16x32_bf16 v[100:103], v[148:151], v[84:87], v[100:103]
    s_waitcnt lgkmcnt(1)
    v_mfma_f32_16x16x32_bf16 v[104:107], v[152:155], v[84:87], v[104:107]
    s_waitcnt lgkmcnt(0)
    v_mfma_f32_16x16x32_bf16 v[108:111], v[156:159], v[84:87], v[108:111]
    v_lshlrev_b32 v16, 16, v160
    v_and_b32 v17, 0xffff0000, v160
    v_lshlrev_b32 v18, 16, v161
    v_and_b32 v19, 0xffff0000, v161
    v_lshlrev_b32 v20, 16, v162
    v_and_b32 v21, 0xffff0000, v162
    v_lshlrev_b32 v22, 16, v163
    v_and_b32 v23, 0xffff0000, v163
    v_lshlrev_b32 v24, 16, v164
    v_and_b32 v25, 0xffff0000, v164
    v_lshlrev_b32 v26, 16, v165
    v_and_b32 v27, 0xffff0000, v165
    v_lshlrev_b32 v28, 16, v166
    v_and_b32 v29, 0xffff0000, v166
    v_lshlrev_b32 v30, 16, v167
    v_and_b32 v31, 0xffff0000, v167
    v_lshlrev_b32 v32, 16, v168
    v_and_b32 v33, 0xffff0000, v168
    v_lshlrev_b32 v34, 16, v169
    v_and_b32 v35, 0xffff0000, v169
    v_lshlrev_b32 v36, 16, v170
    v_and_b32 v37, 0xffff0000, v170
    v_lshlrev_b32 v38, 16, v171
    v_and_b32 v39, 0xffff0000, v171
    v_add_f32 v16, v16, v88
    v_add_f32 v17, v17, v89
    v_add_f32 v18, v18, v90
    v_add_f32 v19, v19, v91
    v_add_f32 v20, v20, v92
    v_add_f32 v21, v21, v93
    v_add_f32 v22, v22, v94
    v_add_f32 v23, v23, v95
    v_add_f32 v24, v24, v96
    v_add_f32 v25, v25, v97
    v_add_f32 v26, v26, v98
    v_add_f32 v27, v27, v99
    v_add_f32 v28, v28, v100
    v_add_f32 v29, v29, v101
    v_add_f32 v30, v30, v102
    v_add_f32 v31, v31, v103
    v_add_f32 v32, v32, v104
    v_add_f32 v33, v33, v105
    v_add_f32 v34, v34, v106
    v_add_f32 v35, v35, v107
    v_add_f32 v36, v36, v108
    v_add_f32 v37, v37, v109
    v_add_f32 v38, v38, v110
    v_add_f32 v39, v39, v111
    s_mul_i32 s52, s46, 18
    s_mul_i32 s53, s45, 3
    s_add_u32 s52, s52, s53
    s_lshl_b32 s52, s52, 10
    s_add_u32 s52, s52, 25690112
    v_cvt_pk_bf16_f32 v40, v16, v17
    v_cvt_pk_bf16_f32 v41, v18, v19
    v_cvt_pk_bf16_f32 v42, v20, v21
    v_cvt_pk_bf16_f32 v43, v22, v23
    buffer_store_dwordx4 v[40:43], v2, s[4:7], s52 offen offset:0 sc1
    v_cvt_pk_bf16_f32 v44, v24, v25
    v_cvt_pk_bf16_f32 v45, v26, v27
    v_cvt_pk_bf16_f32 v46, v28, v29
    v_cvt_pk_bf16_f32 v47, v30, v31
    buffer_store_dwordx4 v[44:47], v2, s[4:7], s52 offen offset:1024 sc1
    v_cvt_pk_bf16_f32 v48, v32, v33
    v_cvt_pk_bf16_f32 v49, v34, v35
    v_cvt_pk_bf16_f32 v50, v36, v37
    v_cvt_pk_bf16_f32 v51, v38, v39
    buffer_store_dwordx4 v[48:51], v2, s[4:7], s52 offen offset:2048 sc1
    v_lshlrev_b32 v16, 16, v40
    v_and_b32 v17, 0xffff0000, v40
    v_lshlrev_b32 v18, 16, v41
    v_and_b32 v19, 0xffff0000, v41
    v_lshlrev_b32 v20, 16, v42
    v_and_b32 v21, 0xffff0000, v42
    v_lshlrev_b32 v22, 16, v43
    v_and_b32 v23, 0xffff0000, v43
    v_lshlrev_b32 v24, 16, v44
    v_and_b32 v25, 0xffff0000, v44
    v_lshlrev_b32 v26, 16, v45
    v_and_b32 v27, 0xffff0000, v45
    v_lshlrev_b32 v28, 16, v46
    v_and_b32 v29, 0xffff0000, v46
    v_lshlrev_b32 v30, 16, v47
    v_and_b32 v31, 0xffff0000, v47
    v_lshlrev_b32 v32, 16, v48
    v_and_b32 v33, 0xffff0000, v48
    v_lshlrev_b32 v34, 16, v49
    v_and_b32 v35, 0xffff0000, v49
    v_lshlrev_b32 v36, 16, v50
    v_and_b32 v37, 0xffff0000, v50
    v_lshlrev_b32 v38, 16, v51
    v_and_b32 v39, 0xffff0000, v51
    v_add_f32 v56, v16, v17
    v_add_f32 v58, v18, v19
    v_add_f32 v56, v56, v20
    v_add_f32 v58, v58, v21
    v_add_f32 v56, v56, v22
    v_add_f32 v58, v58, v23
    v_add_f32 v56, v56, v24
    v_add_f32 v58, v58, v25
    v_add_f32 v56, v56, v26
    v_add_f32 v58, v58, v27
    v_add_f32 v56, v56, v28
    v_add_f32 v58, v58, v29
    v_add_f32 v56, v56, v30
    v_add_f32 v58, v58, v31
    v_add_f32 v56, v56, v32
    v_add_f32 v58, v58, v33
    v_add_f32 v56, v56, v34
    v_add_f32 v58, v58, v35
    v_add_f32 v56, v56, v36
    v_add_f32 v58, v58, v37
    v_add_f32 v56, v56, v38
    v_add_f32 v58, v58, v39
    v_add_f32 v56, v56, v58
    v_mov_b32 v58, v56
    s_nop 1
    v_permlane16_swap_b32 v56, v58
    v_add_f32 v56, v56, v58
    v_mov_b32 v58, v56
    s_nop 1
    v_permlane32_swap_b32 v56, v58
    v_add_f32 v56, v56, v58
    v_mul_f32 v59, 0x3c2aaaab, v56
    v_sub_f32 v58, v16, v59
    v_mul_f32 v57, v58, v58
    v_sub_f32 v61, v17, v59
    v_fmac_f32 v57, v61, v61
    v_sub_f32 v60, v18, v59
    v_fmac_f32 v57, v60, v60
    v_sub_f32 v61, v19, v59
    v_fmac_f32 v57, v61, v61
    v_sub_f32 v60, v20, v59
    v_fmac_f32 v57, v60, v60
    v_sub_f32 v61, v21, v59
    v_fmac_f32 v57, v61, v61
    v_sub_f32 v60, v22, v59
    v_fmac_f32 v57, v60, v60
    v_sub_f32 v61, v23, v59
    v_fmac_f32 v57, v61, v61
    v_sub_f32 v60, v24, v59
    v_fmac_f32 v57, v60, v60
    v_sub_f32 v61, v25, v59
    v_fmac_f32 v57, v61, v61
    v_sub_f32 v60, v26, v59
    v_fmac_f32 v57, v60, v60
    v_sub_f32 v61, v27, v59
    v_fmac_f32 v57, v61, v61
    v_sub_f32 v60, v28, v59
    v_fmac_f32 v57, v60, v60
    v_sub_f32 v61, v29, v59
    v_fmac_f32 v57, v61, v61
    v_sub_f32 v60, v30, v59
    v_fmac_f32 v57, v60, v60
    v_sub_f32 v61, v31, v59
    v_fmac_f32 v57, v61, v61
    v_sub_f32 v60, v32, v59
    v_fmac_f32 v57, v60, v60
    v_sub_f32 v61, v33, v59
    v_fmac_f32 v57, v61, v61
    v_sub_f32 v60, v34, v59
    v_fmac_f32 v57, v60, v60
    v_sub_f32 v61, v35, v59
    v_fmac_f32 v57, v61, v61
    v_sub_f32 v60, v36, v59
    v_fmac_f32 v57, v60, v60
    v_sub_f32 v61, v37, v59
    v_fmac_f32 v57, v61, v61
    v_sub_f32 v60, v38, v59
    v_fmac_f32 v57, v60, v60
    v_sub_f32 v61, v39, v59
    v_fmac_f32 v57, v61, v61
    v_mov_b32 v58, v57
    s_nop 1
    v_permlane16_swap_b32 v57, v58
    v_add_f32 v57, v57, v58
    v_mov_b32 v58, v57
    s_nop 1
    v_permlane32_swap_b32 v57, v58
    v_add_f32 v57, v57, v58
    s_lshl_b32 s52, s45, 14
    s_add_u32 s52, s52, 28049408
    s_mov_b32 exec_lo, 0xffff
    s_mov_b32 exec_hi, 0
    buffer_store_dwordx2 v[56:57], v7, s[4:7], s52 offen sc1
    s_mov_b64 exec, -1
    s_lshl_b32 s52, s46, 3
    s_add_u32 s52, s52, s45
    s_lshl_b32 s52, s52, 3
    s_add_u32 s52, s52, 32768
    s_and_b32 s23, s21, 7
    s_lshl_b32 s23, s23, 2
    s_and_b32 s1, s22, 3
    s_add_u32 s1, s1, s23
    s_lshl_b32 s1, s1, 9
    s_add_u32 s1, s1, 139264
    v_min_u32 v14, 35, v1
    v_lshlrev_b32 v14, 3, v14
    s_lshl_b32 s1, s1, 2
    s_add_u32 s1, s1, 0x8000000
    v_lshlrev_b32 v14, 2, v14
    buffer_load_dwordx2 v[12:13], v14, s[4:7], s1 offen sc1
    v_mov_b32 v8, s98
    v_mov_b32 v9, s99
    s_waitcnt vmcnt(1)
    s_lshl_b32 s52, s52, 2
    s_add_u32 s52, s52, 0x8000000
    s_mov_b64 exec, 1
    buffer_store_dwordx2 v[8:9], off, s[4:7], s52 sc1
    s_mov_b64 exec, -1
    s_mov_b32 s0, 0
    s_cmp_lg_u32 s20, 3
    s_cbranch_scc1 L_ffn_49
    s_mul_i32 s55, s20, 9216
    s_add_u32 s55, s55, 110592
    v_add_u32 v64, s55, v2
    ds_write_b128 v64, a[180:183] offset:0
    ds_write_b128 v64, a[184:187] offset:1024
    ds_write_b128 v64, a[188:191] offset:2048
    ds_write_b128 v64, a[192:195] offset:3072
    ds_write_b128 v64, a[196:199] offset:4096
    ds_write_b128 v64, a[200:203] offset:5120
    ds_write_b128 v64, a[204:207] offset:6144
    ds_write_b128 v64, a[208:211] offset:7168
    ds_write_b128 v64, a[212:215] offset:8192
    s_cmp_ge_u32 s30, 1152
    s_cbranch_scc1 L_ud_58
    s_mul_i32 s64, s30, 1821
    s_lshr_b32 s64, s64, 16
    s_mul_i32 s92, s64, 36
    s_sub_u32 s92, s30, s92
    s_and_b32 s93, s92, 1
    s_lshr_b32 s94, s92, 1
    s_mov_b32 s62, 0
    s_mov_b32 s63, 256
    s_mul_i32 s95, s64, 486
    s_add_u32 s95, s95, s92
    s_lshl_b32 s95, s95, 10
    s_add_u32 s69, s95, 4194304
    s_add_u32 s67, s69, 36864
    s_add_u32 s68, s69, 184320
    s_mov_b32 s70, 36864
    s_mov_b32 s71, 73728
    s_lshl_b32 s95, s64, 1
    s_add_u32 s95, s95, s93
    s_mul_i32 s95, s95, 18
    s_add_u32 s95, s95, s94
    s_mul_i32 s95, s95, 640
    s_add_u32 s65, s95, 2883584
    s_mov_b32 s66, s92
    s_branch L_udone_59
L_ud_58:
    s_sub_u32 s92, s30, 1152
    s_mul_i32 s64, s92, 3641
    s_lshr_b32 s64, s64, 16
    s_mul_i32 s93, s64, 18
    s_sub_u32 s92, s92, s93
    s_and_b32 s93, s64, 3
    s_and_b32 s94, s93, 1
    s_mov_b32 s65, 0
    s_lshl_b32 s62, s94, 5
    s_cmp_eq_u32 s94, 0
    s_cselect_b32 s63, 256, 0
    s_add_u32 s66, s92, 36
    s_mul_i32 s95, s64, 486
    s_add_u32 s95, s95, 324
    s_lshl_b32 s95, s95, 10
    s_add_u32 s95, s95, 4194304
    s_cmp_ge_u32 s92, 3
    s_cbranch_scc1 L_ub_60
    s_sub_u32 s96, s92, 0
    s_mov_b32 s70, 1024
    s_mov_b32 s71, 2048
    s_mul_i32 s97, s96, 5120
    s_add_u32 s97, s97, 0
    s_add_u32 s67, s97, s95
    s_mul_i32 s97, s96, 4096
    s_add_u32 s97, s97, 15360
    s_add_u32 s68, s97, s95
    s_mul_i32 s97, s96, 5120
    s_add_u32 s97, s97, 4096
    s_add_u32 s69, s97, s95
    s_branch L_udone_59
L_ub_60:
    s_cmp_ge_u32 s92, 9
    s_cbranch_scc1 L_uc_61
    s_sub_u32 s96, s92, 3
    s_mov_b32 s70, 1024
    s_mov_b32 s71, 2048
    s_mul_i32 s97, s96, 9216
    s_add_u32 s97, s97, 27648
    s_add_u32 s67, s97, s95
    s_mul_i32 s97, s96, 9216
    s_add_u32 s97, s97, 31744
    s_add_u32 s68, s97, s95
    s_mul_i32 s97, s96, 9216
    s_add_u32 s97, s97, 35840
    s_add_u32 s69, s97, s95
    s_branch L_udone_59
L_uc_61:
    s_sub_u32 s96, s92, 9
    s_mov_b32 s70, 1024
    s_mov_b32 s71, 18432
    s_mul_i32 s97, s96, 2048
    s_add_u32 s97, s97, 82944
    s_add_u32 s67, s97, s95
    s_mul_i32 s97, s96, 2048
    s_add_u32 s97, s97, 119808
    s_add_u32 s68, s97, s95
    s_mul_i32 s97, s96, 1024
    s_add_u32 s97, s97, 156672
    s_add_u32 s69, s97, s95
L_udone_59:
    s_lshl_b32 s95, s64, 6
    s_add_u32 s95, s95, s66
    s_lshl_b32 s95, s95, 3
    s_add_u32 s66, s95, 139264
    v_lshrrev_b32 v64, 4, v1
    v_bfe_u32 v66, v1, 2, 2
    v_lshl_add_u32 v64, v64, 3, v66
    v_mul_u32_u24 v64, 288, v64
    v_add_u32 v64, s55, v64
    v_and_b32 v66, 3, v1
    v_lshl_add_u32 v65, v66, 3, v64
    v_add_u32 v65, s63, v65
    v_lshl_add_u32 v64, v66, 4, v64
    v_add_u32 v64, s62, v64
    ds_read_b64_tr_b16 v[72:73], v64 offset:0
    ds_read_b64_tr_b16 v[74:75], v64 offset:1152
    ds_read_b64_tr_b16 v[76:77], v64 offset:8
    ds_read_b64_tr_b16 v[78:79], v64 offset:1160
    ds_read_b64_tr_b16 v[80:81], v64 offset:64
    ds_read_b64_tr_b16 v[82:83], v64 offset:1216
    ds_read_b64_tr_b16 v[84:85], v64 offset:72
    ds_read_b64_tr_b16 v[86:87], v64 offset:1224
    ds_read_b64_tr_b16 v[88:89], v64 offset:128
    ds_read_b64_tr_b16 v[90:91], v64 offset:1280
    ds_read_b64_tr_b16 v[92:93], v64 offset:136
    ds_read_b64_tr_b16 v[94:95], v64 offset:1288
    ds_read_b64_tr_b16 v[96:97], v64 offset:192
    ds_read_b64_tr_b16 v[98:99], v64 offset:1344
    ds_read_b64_tr_b16 v[100:101], v64 offset:200
    ds_read_b64_tr_b16 v[102:103], v64 offset:1352
    ds_read_b64_tr_b16 v[104:105], v65 offset:0
    ds_read_b64_tr_b16 v[106:107], v65 offset:1152
    s_waitcnt lgkmcnt(15)
    buffer_store_dwordx4 v[72:75], v2, s[4:7], s67 offen sc1
    s_add_u32 s92, s67, s70
    s_waitcnt lgkmcnt(14)
    buffer_store_dwordx4 v[76:79], v2, s[4:7], s92 offen sc1
    s_add_u32 s92, s67, s71
    s_waitcnt lgkmcnt(12)
    buffer_store_dwordx4 v[80:83], v2, s[4:7], s92 offen sc1
    s_add_u32 s92, s92, s70
    s_waitcnt lgkmcnt(10)
    buffer_store_dwordx4 v[84:87], v2, s[4:7], s92 offen sc1
    s_waitcnt lgkmcnt(8)
    buffer_store_dwordx4 v[88:91], v2, s[4:7], s68 offen sc1
    s_add_u32 s92, s68, s70
    s_waitcnt lgkmcnt(6)
    buffer_store_dwordx4 v[92:95], v2, s[4:7], s92 offen sc1
    s_add_u32 s92, s68, s71
    s_waitcnt lgkmcnt(4)
    buffer_store_dwordx4 v[96:99], v2, s[4:7], s92 offen sc1
    s_add_u32 s92, s92, s70
    s_waitcnt lgkmcnt(2)
    buffer_store_dwordx4 v[100:103], v2, s[4:7], s92 offen sc1
    s_waitcnt lgkmcnt(0)
    buffer_store_dwordx4 v[104:107], v2, s[4:7], s69 offen sc1
    s_cmp_eq_u32 s65, 0
    s_cbranch_scc1 L_nocs_62
    v_mov_b32 v68, 0x3f803f80
    v_mov_b32 v69, 0x3f803f80
    v_mov_b32 v70, 0x3f803f80
    v_mov_b32 v71, 0x3f803f80
    s_nop 1
    v_mfma_f32_16x16x32_bf16 v[108:111], v[72:75], v[68:71], 0
    v_mfma_f32_16x16x32_bf16 v[112:115], v[76:79], v[68:71], 0
    v_mfma_f32_16x16x32_bf16 v[116:119], v[80:83], v[68:71], 0
    v_mfma_f32_16x16x32_bf16 v[120:123], v[84:87], v[68:71], 0
    v_mfma_f32_16x16x32_bf16 v[124:127], v[88:91], v[68:71], 0
    v_mfma_f32_16x16x32_bf16 v[128:131], v[92:95], v[68:71], 0
    v_mfma_f32_16x16x32_bf16 v[132:135], v[96:99], v[68:71], 0
    v_mfma_f32_16x16x32_bf16 v[136:139], v[100:103], v[68:71], 0
    v_mfma_f32_16x16x32_bf16 v[140:143], v[104:107], v[68:71], 0
    v_and_b32 v66, 15, v1
    v_add_u32 v67, 1, v66
    v_cmp_gt_u32 vcc, 8, v66
    v_and_b32 v64, 48, v1
    s_nop 0
    v_cndmask_b32 v67, 0, v67, vcc
    v_cmp_eq_u32 vcc, 9, v66
    s_nop 1
    v_cndmask_b32 v67, v67, v66, vcc
    v_lshlrev_b32 v67, 6, v67
    v_add_u32 v67, v67, v64
    v_cmp_eq_u32 vcc, 1, v66
    s_nop 1
    v_cndmask_b32 v108, v108, v112, vcc
    v_cndmask_b32 v109, v109, v113, vcc
    v_cndmask_b32 v110, v110, v114, vcc
    v_cndmask_b32 v111, v111, v115, vcc
    v_cmp_eq_u32 vcc, 2, v66
    s_nop 1
    v_cndmask_b32 v108, v108, v116, vcc
    v_cndmask_b32 v109, v109, v117, vcc
    v_cndmask_b32 v110, v110, v118, vcc
    v_cndmask_b32 v111, v111, v119, vcc
    v_cmp_eq_u32 vcc, 3, v66
    s_nop 1
    v_cndmask_b32 v108, v108, v120, vcc
    v_cndmask_b32 v109, v109, v121, vcc
    v_cndmask_b32 v110, v110, v122, vcc
    v_cndmask_b32 v111, v111, v123, vcc
    v_cmp_eq_u32 vcc, 4, v66
    s_nop 1
    v_cndmask_b32 v108, v108, v124, vcc
    v_cndmask_b32 v109, v109, v125, vcc
    v_cndmask_b32 v110, v110, v126, vcc
    v_cndmask_b32 v111, v111, v127, vcc
    v_cmp_eq_u32 vcc, 5, v66
    s_nop 1
    v_cndmask_b32 v108, v108, v128, vcc
    v_cndmask_b32 v109, v109, v129, vcc
    v_cndmask_b32 v110, v110, v130, vcc
    v_cndmask_b32 v111, v111, v131, vcc
    v_cmp_eq_u32 vcc, 6, v66
    s_nop 1
    v_cndmask_b32 v108, v108, v132, vcc
    v_cndmask_b32 v109, v109, v133, vcc
    v_cndmask_b32 v110, v110, v134, vcc
    v_cndmask_b32 v111, v111, v135, vcc
    v_cmp_eq_u32 vcc, 7, v66
    s_nop 1
    v_cndmask_b32 v108, v108, v136, vcc
    v_cndmask_b32 v109, v109, v137, vcc
    v_cndmask_b32 v110, v110, v138, vcc
    v_cndmask_b32 v111, v111, v139, vcc
    v_cmp_eq_u32 vcc, 8, v66
    s_nop 1
    v_cndmask_b32 v108, v108, v140, vcc
    v_cndmask_b32 v109, v109, v141, vcc
    v_cndmask_b32 v110, v110, v142, vcc
    v_cndmask_b32 v111, v111, v143, vcc
    s_mov_b32 exec_lo, 0x03ff03ff
    s_mov_b32 exec_hi, 0x03ff03ff
    buffer_store_dwordx4 v[108:111], v67, s[4:7], s65 offen sc1
    s_mov_b64 exec, -1
L_nocs_62:
    s_mov_b32 s0, s66
    s_branch L_ffn_49
L_idle0_48:
    s_mul_i32 s55, s20, 9216
    s_add_u32 s55, s55, 110592
    v_add_u32 v64, s55, v2
    ds_write_b128 v64, a[180:183] offset:0
    ds_write_b128 v64, a[184:187] offset:1024
    ds_write_b128 v64, a[188:191] offset:2048
    ds_write_b128 v64, a[192:195] offset:3072
    ds_write_b128 v64, a[196:199] offset:4096
    ds_write_b128 v64, a[200:203] offset:5120
    ds_write_b128 v64, a[204:207] offset:6144
    ds_write_b128 v64, a[208:211] offset:7168
    ds_write_b128 v64, a[212:215] offset:8192
    s_cmp_ge_u32 s30, 1152
    s_cbranch_scc1 L_ud_63
    s_mul_i32 s64, s30, 1821
    s_lshr_b32 s64, s64, 16
    s_mul_i32 s92, s64, 36
    s_sub_u32 s92, s30, s92
    s_and_b32 s93, s92, 1
    s_lshr_b32 s94, s92, 1
    s_mov_b32 s62, 0
    s_mov_b32 s63, 256
    s_mul_i32 s95, s64, 486
    s_add_u32 s95, s95, s92
    s_lshl_b32 s95, s95, 10
    s_add_u32 s69, s95, 4194304
    s_add_u32 s67, s69, 36864
    s_add_u32 s68, s69, 184320
    s_mov_b32 s70, 36864
    s_mov_b32 s71, 73728
    s_lshl_b32 s95, s64, 1
    s_add_u32 s95, s95, s93
    s_mul_i32 s95, s95, 18
    s_add_u32 s95, s95, s94
    s_mul_i32 s95, s95, 640
    s_add_u32 s65, s95, 2883584
    s_mov_b32 s66, s92
    s_branch L_udone_64
L_ud_63:
    s_sub_u32 s92, s30, 1152
    s_mul_i32 s64, s92, 3641
    s_lshr_b32 s64, s64, 16
    s_mul_i32 s93, s64, 18
    s_sub_u32 s92, s92, s93
    s_and_b32 s93, s64, 3
    s_and_b32 s94, s93, 1
    s_mov_b32 s65, 0
    s_lshl_b32 s62, s94, 5
    s_cmp_eq_u32 s94, 0
    s_cselect_b32 s63, 256, 0
    s_add_u32 s66, s92, 36
    s_mul_i32 s95, s64, 486
    s_add_u32 s95, s95, 324
    s_lshl_b32 s95, s95, 10
    s_add_u32 s95, s95, 4194304
    s_cmp_ge_u32 s92, 3
    s_cbranch_scc1 L_ub_65
    s_sub_u32 s96, s92, 0
    s_mov_b32 s70, 1024
    s_mov_b32 s71, 2048
    s_mul_i32 s97, s96, 5120
    s_add_u32 s97, s97, 0
    s_add_u32 s67, s97, s95
    s_mul_i32 s97, s96, 4096
    s_add_u32 s97, s97, 15360
    s_add_u32 s68, s97, s95
    s_mul_i32 s97, s96, 5120
    s_add_u32 s97, s97, 4096
    s_add_u32 s69, s97, s95
    s_branch L_udone_64
L_ub_65:
    s_cmp_ge_u32 s92, 9
    s_cbranch_scc1 L_uc_66
    s_sub_u32 s96, s92, 3
    s_mov_b32 s70, 1024
    s_mov_b32 s71, 2048
    s_mul_i32 s97, s96, 9216
    s_add_u32 s97, s97, 27648
    s_add_u32 s67, s97, s95
    s_mul_i32 s97, s96, 9216
    s_add_u32 s97, s97, 31744
    s_add_u32 s68, s97, s95
    s_mul_i32 s97, s96, 9216
    s_add_u32 s97, s97, 35840
    s_add_u32 s69, s97, s95
    s_branch L_udone_64
L_uc_66:
    s_sub_u32 s96, s92, 9
    s_mov_b32 s70, 1024
    s_mov_b32 s71, 18432
    s_mul_i32 s97, s96, 2048
    s_add_u32 s97, s97, 82944
    s_add_u32 s67, s97, s95
    s_mul_i32 s97, s96, 2048
    s_add_u32 s97, s97, 119808
    s_add_u32 s68, s97, s95
    s_mul_i32 s97, s96, 1024
    s_add_u32 s97, s97, 156672
    s_add_u32 s69, s97, s95
L_udone_64:
    s_lshl_b32 s95, s64, 6
    s_add_u32 s95, s95, s66
    s_lshl_b32 s95, s95, 3
    s_add_u32 s66, s95, 139264
    v_lshrrev_b32 v64, 4, v1
    v_bfe_u32 v66, v1, 2, 2
    v_lshl_add_u32 v64, v64, 3, v66
    v_mul_u32_u24 v64, 288, v64
    v_add_u32 v64, s55, v64
    v_and_b32 v66, 3, v1
    v_lshl_add_u32 v65, v66, 3, v64
    v_add_u32 v65, s63, v65
    v_lshl_add_u32 v64, v66, 4, v64
    v_add_u32 v64, s62, v64
    ds_read_b64_tr_b16 v[72:73], v64 offset:0
    ds_read_b64_tr_b16 v[74:75], v64 offset:1152
    ds_read_b64_tr_b16 v[76:77], v64 offset:8
    ds_read_b64_tr_b16 v[78:79], v64 offset:1160
    ds_read_b64_tr_b16 v[80:81], v64 offset:64
    ds_read_b64_tr_b16 v[82:83], v64 offset:1216
    ds_read_b64_tr_b16 v[84:85], v64 offset:72
    ds_read_b64_tr_b16 v[86:87], v64 offset:1224
    ds_read_b64_tr_b16 v[88:89], v64 offset:128
    ds_read_b64_tr_b16 v[90:91], v64 offset:1280
    ds_read_b64_tr_b16 v[92:93], v64 offset:136
    ds_read_b64_tr_b16 v[94:95], v64 offset:1288
    ds_read_b64_tr_b16 v[96:97], v64 offset:192
    ds_read_b64_tr_b16 v[98:99], v64 offset:1344
    ds_read_b64_tr_b16 v[100:101], v64 offset:200
    ds_read_b64_tr_b16 v[102:103], v64 offset:1352
    ds_read_b64_tr_b16 v[104:105], v65 offset:0
    ds_read_b64_tr_b16 v[106:107], v65 offset:1152
    s_waitcnt lgkmcnt(15)
    buffer_store_dwordx4 v[72:75], v2, s[4:7], s67 offen sc1
    s_add_u32 s92, s67, s70
    s_waitcnt lgkmcnt(14)
    buffer_store_dwordx4 v[76:79], v2, s[4:7], s92 offen sc1
    s_add_u32 s92, s67, s71
    s_waitcnt lgkmcnt(12)
    buffer_store_dwordx4 v[80:83], v2, s[4:7], s92 offen sc1
    s_add_u32 s92, s92, s70
    s_waitcnt lgkmcnt(10)
    buffer_store_dwordx4 v[84:87], v2, s[4:7], s92 offen sc1
    s_waitcnt lgkmcnt(8)
    buffer_store_dwordx4 v[88:91], v2, s[4:7], s68 offen sc1
    s_add_u32 s92, s68, s70
    s_waitcnt lgkmcnt(6)
    buffer_store_dwordx4 v[92:95], v2, s[4:7], s92 offen sc1
    s_add_u32 s92, s68, s71
    s_waitcnt lgkmcnt(4)
    buffer_store_dwordx4 v[96:99], v2, s[4:7], s92 offen sc1
    s_add_u32 s92, s92, s70
    s_waitcnt lgkmcnt(2)
    buffer_store_dwordx4 v[100:103], v2, s[4:7], s92 offen sc1
    s_waitcnt lgkmcnt(0)
    buffer_store_dwordx4 v[104:107], v2, s[4:7], s69 offen sc1
    s_cmp_eq_u32 s65, 0
    s_cbranch_scc1 L_nocs_67
    v_mov_b32 v68, 0x3f803f80
    v_mov_b32 v69, 0x3f803f80
    v_mov_b32 v70, 0x3f803f80
    v_mov_b32 v71, 0x3f803f80
    s_nop 1
    v_mfma_f32_16x16x32_bf16 v[108:111], v[72:75], v[68:71], 0
    v_mfma_f32_16x16x32_bf16 v[112:115], v[76:79], v[68:71], 0
    v_mfma_f32_16x16x32_bf16 v[116:119], v[80:83], v[68:71], 0
    v_mfma_f32_16x16x32_bf16 v[120:123], v[84:87], v[68:71], 0
    v_mfma_f32_16x16x32_bf16 v[124:127], v[88:91], v[68:71], 0
    v_mfma_f32_16x16x32_bf16 v[128:131], v[92:95], v[68:71], 0
    v_mfma_f32_16x16x32_bf16 v[132:135], v[96:99], v[68:71], 0
    v_mfma_f32_16x16x32_bf16 v[136:139], v[100:103], v[68:71], 0
    v_mfma_f32_16x16x32_bf16 v[140:143], v[104:107], v[68:71], 0
    v_and_b32 v66, 15, v1
    v_add_u32 v67, 1, v66
    v_cmp_gt_u32 vcc, 8, v66
    v_and_b32 v64, 48, v1
    s_nop 0
    v_cndmask_b32 v67, 0, v67, vcc
    v_cmp_eq_u32 vcc, 9, v66
    s_nop 1
    v_cndmask_b32 v67, v67, v66, vcc
    v_lshlrev_b32 v67, 6, v67
    v_add_u32 v67, v67, v64
    v_cmp_eq_u32 vcc, 1, v66
    s_nop 1
    v_cndmask_b32 v108, v108, v112, vcc
    v_cndmask_b32 v109, v109, v113, vcc
    v_cndmask_b32 v110, v110, v114, vcc
    v_cndmask_b32 v111, v111, v115, vcc
    v_cmp_eq_u32 vcc, 2, v66
    s_nop 1
    v_cndmask_b32 v108, v108, v116, vcc
    v_cndmask_b32 v109, v109, v117, vcc
    v_cndmask_b32 v110, v110, v118, vcc
    v_cndmask_b32 v111, v111, v119, vcc
    v_cmp_eq_u32 vcc, 3, v66
    s_nop 1
    v_cndmask_b32 v108, v108, v120, vcc
    v_cndmask_b32 v109, v109, v121, vcc
    v_cndmask_b32 v110, v110, v122, vcc
    v_cndmask_b32 v111, v111, v123, vcc
    v_cmp_eq_u32 vcc, 4, v66
    s_nop 1
    v_cndmask_b32 v108, v108, v124, vcc
    v_cndmask_b32 v109, v109, v125, vcc
    v_cndmask_b32 v110, v110, v126, vcc
    v_cndmask_b32 v111, v111, v127, vcc
    v_cmp_eq_u32 vcc, 5, v66
    s_nop 1
    v_cndmask_b32 v108, v108, v128, vcc
    v_cndmask_b32 v109, v109, v129, vcc
    v_cndmask_b32 v110, v110, v130, vcc
    v_cndmask_b32 v111, v111, v131, vcc
    v_cmp_eq_u32 vcc, 6, v66
    s_nop 1
    v_cndmask_b32 v108, v108, v132, vcc
    v_cndmask_b32 v109, v109, v133, vcc
    v_cndmask_b32 v110, v110, v134, vcc
    v_cndmask_b32 v111, v111, v135, vcc
    v_cmp_eq_u32 vcc, 7, v66
    s_nop 1
    v_cndmask_b32 v108, v108, v136, vcc
    v_cndmask_b32 v109, v109, v137, vcc
    v_cndmask_b32 v110, v110, v138, vcc
    v_cndmask_b32 v111, v111, v139, vcc
    v_cmp_eq_u32 vcc, 8, v66
    s_nop 1
    v_cndmask_b32 v108, v108, v140, vcc
    v_cndmask_b32 v109, v109, v141, vcc
    v_cndmask_b32 v110, v110, v142, vcc
    v_cndmask_b32 v111, v111, v143, vcc
    s_mov_b32 exec_lo, 0x03ff03ff
    s_mov_b32 exec_hi, 0x03ff03ff
    buffer_store_dwordx4 v[108:111], v67, s[4:7], s65 offen sc1
    s_mov_b64 exec, -1
L_nocs_67:
    s_mov_b32 s44, s66
    s_mul_i32 s55, s20, 9216
    s_add_u32 s55, s55, 110592
    v_add_u32 v64, s55, v2
    ds_write_b128 v64, a[216:219] offset:0
    ds_write_b128 v64, a[220:223] offset:1024
    ds_write_b128 v64, a[224:227] offset:2048
    ds_write_b128 v64, a[228:231] offset:3072
    ds_write_b128 v64, a[232:235] offset:4096
    ds_write_b128 v64, a[236:239] offset:5120
    ds_write_b128 v64, a[240:243] offset:6144
    ds_write_b128 v64, a[244:247] offset:7168
    ds_write_b128 v64, a[248:251] offset:8192
    s_cmp_ge_u32 s31, 1152
    s_cbranch_scc1 L_ud_68
    s_mul_i32 s64, s31, 1821
    s_lshr_b32 s64, s64, 16
    s_mul_i32 s92, s64, 36
    s_sub_u32 s92, s31, s92
    s_and_b32 s93, s92, 1
    s_lshr_b32 s94, s92, 1
    s_mov_b32 s62, 0
    s_mov_b32 s63, 256
    s_mul_i32 s95, s64, 486
    s_add_u32 s95, s95, s92
    s_lshl_b32 s95, s95, 10
    s_add_u32 s69, s95, 4194304
    s_add_u32 s67, s69, 36864
    s_add_u32 s68, s69, 184320
    s_mov_b32 s70, 36864
    s_mov_b32 s71, 73728
    s_lshl_b32 s95, s64, 1
    s_add_u32 s95, s95, s93
    s_mul_i32 s95, s95, 18
    s_add_u32 s95, s95, s94
    s_mul_i32 s95, s95, 640
    s_add_u32 s65, s95, 2883584
    s_mov_b32 s66, s92
    s_branch L_udone_69
L_ud_68:
    s_sub_u32 s92, s31, 1152
    s_mul_i32 s64, s92, 3641
    s_lshr_b32 s64, s64, 16
    s_mul_i32 s93, s64, 18
    s_sub_u32 s92, s92, s93
    s_and_b32 s93, s64, 3
    s_and_b32 s94, s93, 1
    s_mov_b32 s65, 0
    s_lshl_b32 s62, s94, 5
    s_cmp_eq_u32 s94, 0
    s_cselect_b32 s63, 256, 0
    s_add_u32 s66, s92, 36
    s_mul_i32 s95, s64, 486
    s_add_u32 s95, s95, 324
    s_lshl_b32 s95, s95, 10
    s_add_u32 s95, s95, 4194304
    s_cmp_ge_u32 s92, 3
    s_cbranch_scc1 L_ub_70
    s_sub_u32 s96, s92, 0
    s_mov_b32 s70, 1024
    s_mov_b32 s71, 2048
    s_mul_i32 s97, s96, 5120
    s_add_u32 s97, s97, 0
    s_add_u32 s67, s97, s95
    s_mul_i32 s97, s96, 4096
    s_add_u32 s97, s97, 15360
    s_add_u32 s68, s97, s95
    s_mul_i32 s97, s96, 5120
    s_add_u32 s97, s97, 4096
    s_add_u32 s69, s97, s95
    s_branch L_udone_69
L_ub_70:
    s_cmp_ge_u32 s92, 9
    s_cbranch_scc1 L_uc_71
    s_sub_u32 s96, s92, 3
    s_mov_b32 s70, 1024
    s_mov_b32 s71, 2048
    s_mul_i32 s97, s96, 9216
    s_add_u32 s97, s97, 27648
    s_add_u32 s67, s97, s95
    s_mul_i32 s97, s96, 9216
    s_add_u32 s97, s97, 31744
    s_add_u32 s68, s97, s95
    s_mul_i32 s97, s96, 9216
    s_add_u32 s97, s97, 35840
    s_add_u32 s69, s97, s95
    s_branch L_udone_69
L_uc_71:
    s_sub_u32 s96, s92, 9
    s_mov_b32 s70, 1024
    s_mov_b32 s71, 18432
    s_mul_i32 s97, s96, 2048
    s_add_u32 s97, s97, 82944
    s_add_u32 s67, s97, s95
    s_mul_i32 s97, s96, 2048
    s_add_u32 s97, s97, 119808
    s_add_u32 s68, s97, s95
    s_mul_i32 s97, s96, 1024
    s_add_u32 s97, s97, 156672
    s_add_u32 s69, s97, s95
L_udone_69:
    s_lshl_b32 s95, s64, 6
    s_add_u32 s95, s95, s66
    s_lshl_b32 s95, s95, 3
    s_add_u32 s66, s95, 139264
    v_lshrrev_b32 v64, 4, v1
    v_bfe_u32 v66, v1, 2, 2
    v_lshl_add_u32 v64, v64, 3, v66
    v_mul_u32_u24 v64, 288, v64
    v_add_u32 v64, s55, v64
    v_and_b32 v66, 3, v1
    v_lshl_add_u32 v65, v66, 3, v64
    v_add_u32 v65, s63, v65
    v_lshl_add_u32 v64, v66, 4, v64
    v_add_u32 v64, s62, v64
    ds_read_b64_tr_b16 v[180:181], v64 offset:0
    ds_read_b64_tr_b16 v[182:183], v64 offset:1152
    ds_read_b64_tr_b16 v[184:185], v64 offset:8
    ds_read_b64_tr_b16 v[186:187], v64 offset:1160
    ds_read_b64_tr_b16 v[188:189], v64 offset:64
    ds_read_b64_tr_b16 v[190:191], v64 offset:1216
    ds_read_b64_tr_b16 v[192:193], v64 offset:72
    ds_read_b64_tr_b16 v[194:195], v64 offset:1224
    ds_read_b64_tr_b16 v[196:197], v64 offset:128
    ds_read_b64_tr_b16 v[198:199], v64 offset:1280
    ds_read_b64_tr_b16 v[200:201], v64 offset:136
    ds_read_b64_tr_b16 v[202:203], v64 offset:1288
    ds_read_b64_tr_b16 v[204:205], v64 offset:192
    ds_read_b64_tr_b16 v[206:207], v64 offset:1344
    ds_read_b64_tr_b16 v[208:209], v64 offset:200
    ds_read_b64_tr_b16 v[210:211], v64 offset:1352
    ds_read_b64_tr_b16 v[212:213], v65 offset:0
    ds_read_b64_tr_b16 v[214:215], v65 offset:1152
    s_cmp_eq_u32 s65, 0
    s_cbranch_scc1 L_nocs_72
    v_mov_b32 v68, 0x3f803f80
    v_mov_b32 v69, 0x3f803f80
    v_mov_b32 v70, 0x3f803f80
    v_mov_b32 v71, 0x3f803f80
    s_waitcnt lgkmcnt(15)
    s_nop 0
    v_mfma_f32_16x16x32_bf16 v[72:75], v[180:183], v[68:71], 0
    s_waitcnt lgkmcnt(14)
    v_mfma_f32_16x16x32_bf16 v[76:79], v[184:187], v[68:71], 0
    s_waitcnt lgkmcnt(12)
    v_mfma_f32_16x16x32_bf16 v[80:83], v[188:191], v[68:71], 0
    s_waitcnt lgkmcnt(10)
    v_mfma_f32_16x16x32_bf16 v[84:87], v[192:195], v[68:71], 0
    s_waitcnt lgkmcnt(8)
    v_mfma_f32_16x16x32_bf16 v[88:91], v[196:199], v[68:71], 0
    s_waitcnt lgkmcnt(6)
    v_mfma_f32_16x16x32_bf16 v[92:95], v[200:203], v[68:71], 0
    s_waitcnt lgkmcnt(4)
    v_mfma_f32_16x16x32_bf16 v[96:99], v[204:207], v[68:71], 0
    s_waitcnt lgkmcnt(2)
    v_mfma_f32_16x16x32_bf16 v[100:103], v[208:211], v[68:71], 0
    s_waitcnt lgkmcnt(0)
    v_mfma_f32_16x16x32_bf16 v[104:107], v[212:215], v[68:71], 0
    v_and_b32 v66, 15, v1
    v_add_u32 v67, 1, v66
    v_cmp_gt_u32 vcc, 8, v66
    v_and_b32 v64, 48, v1
    s_nop 0
    v_cndmask_b32 v67, 0, v67, vcc
    v_cmp_eq_u32 vcc, 9, v66
    s_nop 1
    v_cndmask_b32 v67, v67, v66, vcc
    v_lshlrev_b32 v67, 6, v67
    v_add_u32 v67, v67, v64
    v_cmp_eq_u32 vcc, 1, v66
    s_nop 1
    v_cndmask_b32 v72, v72, v76, vcc
    v_cndmask_b32 v73, v73, v77, vcc
    v_cndmask_b32 v74, v74, v78, vcc
    v_cndmask_b32 v75, v75, v79, vcc
    v_cmp_eq_u32 vcc, 2, v66
    s_nop 1
    v_cndmask_b32 v72, v72, v80, vcc
    v_cndmask_b32 v73, v73, v81, vcc
    v_cndmask_b32 v74, v74, v82, vcc
    v_cndmask_b32 v75, v75, v83, vcc
    v_cmp_eq_u32 vcc, 3, v66
    s_nop 1
    v_cndmask_b32 v72, v72, v84, vcc
    v_cndmask_b32 v73, v73, v85, vcc
    v_cndmask_b32 v74, v74, v86, vcc
    v_cndmask_b32 v75, v75, v87, vcc
    v_cmp_eq_u32 vcc, 4, v66
    s_nop 1
    v_cndmask_b32 v72, v72, v88, vcc
    v_cndmask_b32 v73, v73, v89, vcc
    v_cndmask_b32 v74, v74, v90, vcc
    v_cndmask_b32 v75, v75, v91, vcc
    v_cmp_eq_u32 vcc, 5, v66
    s_nop 1
    v_cndmask_b32 v72, v72, v92, vcc
    v_cndmask_b32 v73, v73, v93, vcc
    v_cndmask_b32 v74, v74, v94, vcc
    v_cndmask_b32 v75, v75, v95, vcc
    v_cmp_eq_u32 vcc, 6, v66
    s_nop 1
    v_cndmask_b32 v72, v72, v96, vcc
    v_cndmask_b32 v73, v73, v97, vcc
    v_cndmask_b32 v74, v74, v98, vcc
    v_cndmask_b32 v75, v75, v99, vcc
    v_cmp_eq_u32 vcc, 7, v66
    s_nop 1
    v_cndmask_b32 v72, v72, v100, vcc
    v_cndmask_b32 v73, v73, v101, vcc
    v_cndmask_b32 v74, v74, v102, vcc
    v_cndmask_b32 v75, v75, v103, vcc
    v_cmp_eq_u32 vcc, 8, v66
    s_nop 1
    v_cndmask_b32 v72, v72, v104, vcc
    v_cndmask_b32 v73, v73, v105, vcc
    v_cndmask_b32 v74, v74, v106, vcc
    v_cndmask_b32 v75, v75, v107, vcc
    s_mov_b32 exec_lo, 0x03ff03ff
    s_mov_b32 exec_hi, 0x03ff03ff
    buffer_store_dwordx4 v[72:75], v67, s[4:7], s65 offen sc1
    s_mov_b64 exec, -1
L_nocs_72:
    v_mov_b32 v8, s98
    v_mov_b32 v9, s99
    s_waitcnt vmcnt(0)
    s_lshl_b32 s44, s44, 2
    s_add_u32 s44, s44, 0x8000000
    s_mov_b64 exec, 1
    buffer_store_dwordx2 v[8:9], off, s[4:7], s44 sc1
    s_mov_b64 exec, -1
    s_waitcnt lgkmcnt(15)
    buffer_store_dwordx4 v[180:183], v2, s[4:7], s67 offen sc1
    s_add_u32 s92, s67, s70
    s_waitcnt lgkmcnt(14)
    buffer_store_dwordx4 v[184:187], v2, s[4:7], s92 offen sc1
    s_add_u32 s92, s67, s71
    s_waitcnt lgkmcnt(12)
    buffer_store_dwordx4 v[188:191], v2, s[4:7], s92 offen sc1
    s_add_u32 s92, s92, s70
    s_waitcnt lgkmcnt(10)
    buffer_store_dwordx4 v[192:195], v2, s[4:7], s92 offen sc1
    s_waitcnt lgkmcnt(8)
    buffer_store_dwordx4 v[196:199], v2, s[4:7], s68 offen sc1
    s_add_u32 s92, s68, s70
    s_waitcnt lgkmcnt(6)
    buffer_store_dwordx4 v[200:203], v2, s[4:7], s92 offen sc1
    s_add_u32 s92, s68, s71
    s_waitcnt lgkmcnt(4)
    buffer_store_dwordx4 v[204:207], v2, s[4:7], s92 offen sc1
    s_add_u32 s92, s92, s70
    s_waitcnt lgkmcnt(2)
    buffer_store_dwordx4 v[208:211], v2, s[4:7], s92 offen sc1
    s_waitcnt lgkmcnt(0)
    buffer_store_dwordx4 v[212:215], v2, s[4:7], s69 offen sc1
    s_mov_b32 s0, s66
    s_and_b32 s23, s21, 7
    s_lshl_b32 s23, s23, 2
    s_and_b32 s1, s22, 3
    s_add_u32 s1, s1, s23
    s_lshl_b32 s1, s1, 9
    s_add_u32 s1, s1, 139264
    v_min_u32 v14, 35, v1
    v_lshlrev_b32 v14, 3, v14
    s_lshl_b32 s1, s1, 2
    s_add_u32 s1, s1, 0x8000000
    v_lshlrev_b32 v14, 2, v14
    buffer_load_dwordx2 v[12:13], v14, s[4:7], s1 offen sc1
L_ffn_49:
    s_barrier
    s_lshr_b32 s44, s22, 2
    s_and_b32 s60, s21, 0
    s_add_u32 s44, s44, s60
    s_and_b32 s60, s21, 7
    s_lshl_b32 s60, s60, 2
    s_and_b32 s47, s22, 3
    s_add_u32 s47, s47, s60
    s_lshl_b32 s64, s47, 9
    s_add_u32 s64, s64, 139264
    s_lshr_b32 s45, s47, 2
    s_and_b32 s46, s47, 3
    s_mul_i32 s48, s47, 497664
    s_add_u32 s48, s48, 4194304
    s_mul_i32 s63, s20, 9
    s_lshr_b32 s63, s63, 1
    s_lshl_b32 s63, s63, 10
    s_add_u32 s62, s48, s63
    s_mul_i32 s49, s20, 9216
    s_add_u32 s48, s48, s49
    s_lshl_b32 s54, s44, 4
    s_lshl_b32 s60, s20, 2
    s_add_u32 s54, s54, s60
    s_mul_i32 s50, s54, 18432
    s_mul_i32 s53, s45, 2359296
    s_add_u32 s53, s53, s50
    s_add_u32 s50, s50, 4718592
    s_add_u32 s50, s50, s100
    s_lshr_b32 s60, s46, 1
    s_mul_i32 s60, s60, 9216
    s_add_u32 s53, s53, s60
    s_add_u32 s53, s53, 29360128
    s_add_u32 s53, s53, s100
    v_lshlrev_b32 v3, 3, v1
    v_mov_b32 v4, v2
    s_cmp_lg_u32 s101, 0
    s_cbranch_scc1 L_nopw_73
    s_waitcnt vmcnt(0)
    v_cmp_eq_u64 vcc, s[98:99], v[12:13]
    s_nop 0
    s_cmp_eq_u64 vcc, exec
    s_cbranch_scc0 L_pw_slow_52
L_pw_back_53:
L_nopw_73:
    s_add_u32 m0, s49, 0
    s_add_u32 s61, s48, 0
    buffer_load_dwordx4 v2, s[4:7], s61 offen offset:0 lds
    buffer_load_dwordx4 v2, s[4:7], s61 offen offset:1024 lds
    buffer_load_dwordx4 v2, s[4:7], s61 offen offset:2048 lds
    buffer_load_dwordx4 v2, s[4:7], s61 offen offset:3072 lds
    s_add_u32 m0, s49, 4096
    s_add_u32 s61, s48, 4096
    buffer_load_dwordx4 v2, s[4:7], s61 offen offset:0 lds
    buffer_load_dwordx4 v2, s[4:7], s61 offen offset:1024 lds
    buffer_load_dwordx4 v2, s[4:7], s61 offen offset:2048 lds
    buffer_load_dwordx4 v2, s[4:7], s61 offen offset:3072 lds
    s_add_u32 m0, s49, 8192
    s_add_u32 s61, s48, 8192
    buffer_load_dwordx4 v2, s[4:7], s61 offen offset:0 lds
    s_add_u32 m0, s49, 36864
    s_add_u32 s61, s48, 36864
    buffer_load_dwordx4 v2, s[4:7], s61 offen offset:0 lds
    buffer_load_dwordx4 v2, s[4:7], s61 offen offset:1024 lds
    buffer_load_dwordx4 v2, s[4:7], s61 offen offset:2048 lds
    buffer_load_dwordx4 v2, s[4:7], s61 offen offset:3072 lds
    s_add_u32 m0, s49, 40960
    s_add_u32 s61, s48, 40960
    buffer_load_dwordx4 v2, s[4:7], s61 offen offset:0 lds
    buffer_load_dwordx4 v2, s[4:7], s61 offen offset:1024 lds
    buffer_load_dwordx4 v2, s[4:7], s61 offen offset:2048 lds
    buffer_load_dwordx4 v2, s[4:7], s61 offen offset:3072 lds
    s_add_u32 m0, s49, 45056
    s_add_u32 s61, s48, 45056
    buffer_load_dwordx4 v2, s[4:7], s61 offen offset:0 lds
    s_add_u32 m0, s49, 73728
    s_add_u32 s61, s48, 73728
    buffer_load_dwordx4 v2, s[4:7], s61 offen offset:0 lds
    buffer_load_dwordx4 v2, s[4:7], s61 offen offset:1024 lds
    buffer_load_dwordx4 v2, s[4:7], s61 offen offset:2048 lds
    buffer_load_dwordx4 v2, s[4:7], s61 offen offset:3072 lds
    s_add_u32 m0, s49, 77824
    s_add_u32 s61, s48, 77824
    buffer_load_dwordx4 v2, s[4:7], s61 offen offset:0 lds
    buffer_load_dwordx4 v2, s[4:7], s61 offen offset:1024 lds
    buffer_load_dwordx4 v2, s[4:7], s61 offen offset:2048 lds
    buffer_load_dwordx4 v2, s[4:7], s61 offen offset:3072 lds
    s_add_u32 m0, s49, 81920
    s_add_u32 s61, s48, 81920
    buffer_load_dwordx4 v2, s[4:7], s61 offen offset:0 lds
    s_cmp_lg_u32 s101, 0
    s_cbranch_scc1 L_nocs_74
    s_cmp_ge_u32 s20, 2
    s_cbranch_scc1 L_nocs_74
    s_lshl_b32 s60, s47, 1
    s_add_u32 s60, s60, s20
    s_mul_i32 s60, s60, 11520
    s_add_u32 s60, s60, 2883584
    v_lshrrev_b32 v6, 2, v1
    v_lshlrev_b32 v6, 7, v6
    v_and_b32 v7, 3, v1
    v_lshl_add_u32 v6, v7, 4, v6
    s_lshl_b32 s61, s20, 6
    s_add_u32 s61, s61, 147456
    v_add_u32 v6, s61, v6
    s_mov_b32 exec_hi, 15
    buffer_load_dwordx4 v[64:67], v2, s[4:7], s60 offen offset:0 sc1
    buffer_load_dwordx4 v[68:71], v2, s[4:7], s60 offen offset:640 sc1
    buffer_load_dwordx4 v[72:75], v2, s[4:7], s60 offen offset:1280 sc1
    buffer_load_dwordx4 v[76:79], v2, s[4:7], s60 offen offset:1920 sc1
    buffer_load_dwordx4 v[80:83], v2, s[4:7], s60 offen offset:2560 sc1
    buffer_load_dwordx4 v[84:87], v2, s[4:7], s60 offen offset:3200 sc1
    s_add_u32 s60, s60, 3840
    buffer_load_dwordx4 v[88:91], v2, s[4:7], s60 offen offset:0 sc1
    buffer_load_dwordx4 v[92:95], v2, s[4:7], s60 offen offset:640 sc1
    buffer_load_dwordx4 v[96:99], v2, s[4:7], s60 offen offset:1280 sc1
    buffer_load_dwordx4 v[100:103], v2, s[4:7], s60 offen offset:1920 sc1
    buffer_load_dwordx4 v[104:107], v2, s[4:7], s60 offen offset:2560 sc1
    buffer_load_dwordx4 v[108:111], v2, s[4:7], s60 offen offset:3200 sc1
    s_add_u32 s60, s60, 3840
    buffer_load_dwordx4 v[112:115], v2, s[4:7], s60 offen offset:0 sc1
    buffer_load_dwordx4 v[116:119], v2, s[4:7], s60 offen offset:640 sc1
    buffer_load_dwordx4 v[120:123], v2, s[4:7], s60 offen offset:1280 sc1
    buffer_load_dwordx4 v[124:127], v2, s[4:7], s60 offen offset:1920 sc1
    buffer_load_dwordx4 v[128:131], v2, s[4:7], s60 offen offset:2560 sc1
    buffer_load_dwordx4 v[132:135], v2, s[4:7], s60 offen offset:3200 sc1
    s_waitcnt vmcnt(16)
    v_add_f32 v64, v64, v68
    v_add_f32 v65, v65, v69
    v_add_f32 v66, v66, v70
    v_add_f32 v67, v67, v71
    s_waitcnt vmcnt(15)
    v_add_f32 v64, v64, v72
    v_add_f32 v65, v65, v73
    v_add_f32 v66, v66, v74
    v_add_f32 v67, v67, v75
    s_waitcnt vmcnt(14)
    v_add_f32 v64, v64, v76
    v_add_f32 v65, v65, v77
    v_add_f32 v66, v66, v78
    v_add_f32 v67, v67, v79
    s_waitcnt vmcnt(13)
    v_add_f32 v64, v64, v80
    v_add_f32 v65, v65, v81
    v_add_f32 v66, v66, v82
    v_add_f32 v67, v67, v83
    s_waitcnt vmcnt(12)
    v_add_f32 v64, v64, v84
    v_add_f32 v65, v65, v85
    v_add_f32 v66, v66, v86
    v_add_f32 v67, v67, v87
    s_waitcnt vmcnt(11)
    v_add_f32 v64, v64, v88
    v_add_f32 v65, v65, v89
    v_add_f32 v66, v66, v90
    v_add_f32 v67, v67, v91
    s_waitcnt vmcnt(10)
    v_add_f32 v64, v64, v92
    v_add_f32 v65, v65, v93
    v_add_f32 v66, v66, v94
    v_add_f32 v67, v67, v95
    s_waitcnt vmcnt(9)
    v_add_f32 v64, v64, v96
    v_add_f32 v65, v65, v97
    v_add_f32 v66, v66, v98
    v_add_f32 v67, v67, v99
    s_waitcnt vmcnt(8)
    v_add_f32 v64, v64, v100
    v_add_f32 v65, v65, v101
    v_add_f32 v66, v66, v102
    v_add_f32 v67, v67, v103
    s_waitcnt vmcnt(7)
    v_add_f32 v64, v64, v104
    v_add_f32 v65, v65, v105
    v_add_f32 v66, v66, v106
    v_add_f32 v67, v67, v107
    s_waitcnt vmcnt(6)
    v_add_f32 v64, v64, v108
    v_add_f32 v65, v65, v109
    v_add_f32 v66, v66, v110
    v_add_f32 v67, v67, v111
    s_waitcnt vmcnt(5)
    v_add_f32 v64, v64, v112
    v_add_f32 v65, v65, v113
    v_add_f32 v66, v66, v114
    v_add_f32 v67, v67, v115
    s_waitcnt vmcnt(4)
    v_add_f32 v64, v64, v116
    v_add_f32 v65, v65, v117
    v_add_f32 v66, v66, v118
    v_add_f32 v67, v67, v119
    s_waitcnt vmcnt(3)
    v_add_f32 v64, v64, v120
    v_add_f32 v65, v65, v121
    v_add_f32 v66, v66, v122
    v_add_f32 v67, v67, v123
    s_waitcnt vmcnt(2)
    v_add_f32 v64, v64, v124
    v_add_f32 v65, v65, v125
    v_add_f32 v66, v66, v126
    v_add_f32 v67, v67, v127
    s_waitcnt vmcnt(1)
    v_add_f32 v64, v64, v128
    v_add_f32 v65, v65, v129
    v_add_f32 v66, v66, v130
    v_add_f32 v67, v67, v131
    s_waitcnt vmcnt(0)
    v_add_f32 v64, v64, v132
    v_add_f32 v65, v65, v133
    v_add_f32 v66, v66, v134
    v_add_f32 v67, v67, v135
    ds_write_b128 v6, v[64:67]
    s_mov_b64 exec, -1
    s_waitcnt lgkmcnt(0)
L_nocs_74:
    s_lshr_b32 s60, s54, 2
    s_lshl_b32 s60, s60, 8
    s_add_u32 s55, s101, 32768
    v_and_b32 v7, 7, v1
    v_min_u32 v7, 5, v7
    v_and_b32 v6, 24, v1
    v_add_lshl_u32 v0, v7, v6, 3
    v_add_u32 v0, s60, v0
    s_lshl_b32 s60, s21, 4
    s_lshr_b32 s61, s22, 1
    s_add_u32 s60, s60, s61
    s_lshl_b32 s60, s60, 6
    v_lshl_add_u32 v7, v7, 3, s60
    v_cmp_gt_u32 vcc, 32, v1
    s_nop 1
    v_cndmask_b32 v0, v7, v0, vcc
    s_lshl_b32 s55, s55, 2
    s_add_u32 s55, s55, 0x8000000
    v_lshlrev_b32 v0, 2, v0
    buffer_load_dwordx2 v[168:169], v0, s[4:7], s55 offen sc1
    s_lshl_b32 s60, s44, 5
    s_add_u32 s60, s60, s47
    s_mul_i32 s51, s60, 73728
    s_add_u32 s51, s51, 9699328
    s_add_u32 s51, s51, s100
    s_xor_b32 s61, s60, 1
    s_mul_i32 s56, s61, 73728
    s_add_u32 s56, s56, 9699328
    s_add_u32 s56, s56, s100
    s_xor_b32 s61, s60, 2
    s_mul_i32 s57, s61, 73728
    s_add_u32 s57, s57, 9699328
    s_add_u32 s57, s57, s100
    s_xor_b32 s61, s60, 3
    s_mul_i32 s58, s61, 73728
    s_add_u32 s58, s58, 9699328
    s_add_u32 s58, s58, s100
    s_lshr_b32 s52, s60, 2
    s_lshl_b32 s52, s52, 2
    s_add_u32 s52, s52, s20
    s_lshl_b32 s52, s52, 7
    s_lshl_b32 s61, s101, 2
    s_add_u32 s52, s52, s61
    s_add_u32 s52, s52, 49152
    v_lshrrev_b32 v5, 4, v1
    v_lshlrev_b32 v5, 4, v5
    v_add_u32 v5, 147456, v5
    s_lshl_b32 s60, s20, 12
    s_add_u32 s51, s51, s60
    s_add_u32 s56, s56, s60
    s_add_u32 s57, s57, s60
    s_add_u32 s58, s58, s60
    s_lshl_b32 s65, s20, 11
    s_sub_u32 s65, 65536, s65
    s_lshl_b32 s67, s46, 3
    s_add_u32 s67, s67, s52
    s_waitcnt vmcnt(1)
    s_barrier
    ds_read_b128 v[8:11], v4 offset:0
    ds_read_b128 v[12:15], v4 offset:1024
    ds_read_b128 v[16:19], v4 offset:36864
    ds_read_b128 v[20:23], v4 offset:37888
    s_and_b32 s61, s22, 3
    s_mul_i32 s61, s61, 18432
    s_add_u32 s61, s61, s50
    s_waitcnt vmcnt(0)
    v_cmp_eq_u64 vcc, s[98:99], v[168:169]
    s_nop 0
    s_cmp_eq_u64 vcc, exec
    s_cbranch_scc0 L_p1_slow_75
L_p1_back_76:
    s_cmp_eq_u32 s0, 0
    s_cbranch_scc1 L_nopend_78
    v_mov_b32 v6, s98
    v_mov_b32 v7, s99
    s_lshl_b32 s0, s0, 2
    s_add_u32 s0, s0, 0x8000000
    s_mov_b64 exec, 1
    buffer_store_dwordx2 v[6:7], off, s[4:7], s0 sc1
    s_mov_b64 exec, -1
    s_mov_b32 s0, 0
L_nopend_78:
    s_add_u32 s59, s50, 0
    buffer_load_dwordx4 a[0:3], v2, s[4:7], s59 offen offset:0 sc1
    s_add_u32 s66, s50, 18432
    buffer_load_dwordx4 a[4:7], v2, s[4:7], s66 offen offset:0 sc1
    s_add_u32 s68, s50, 36864
    buffer_load_dwordx4 a[8:11], v2, s[4:7], s68 offen offset:0 sc1
    s_add_u32 s69, s50, 55296
    buffer_load_dwordx4 a[12:15], v2, s[4:7], s69 offen offset:0 sc1
    buffer_load_dwordx4 a[16:19], v2, s[4:7], s59 offen offset:1024 sc1
    buffer_load_dwordx4 a[20:23], v2, s[4:7], s66 offen offset:1024 sc1
    buffer_load_dwordx4 a[24:27], v2, s[4:7], s68 offen offset:1024 sc1
    buffer_load_dwordx4 a[28:31], v2, s[4:7], s69 offen offset:1024 sc1
    s_lshl_b32 s60, s54, 4
    v_add_u32 v6, s60, v1
    v_lshlrev_b32 v6, 3, v6
    s_add_u32 s55, s100, 7077888
    s_add_u32 s60, s55, 0
    buffer_load_dwordx2 v[152:153], v6, s[4:7], s60 offen sc1
    s_add_u32 s60, s55, 16384
    buffer_load_dwordx2 v[154:155], v6, s[4:7], s60 offen sc1
    s_add_u32 s60, s55, 32768
    buffer_load_dwordx2 v[156:157], v6, s[4:7], s60 offen sc1
    s_add_u32 s60, s55, 49152
    buffer_load_dwordx2 v[158:159], v6, s[4:7], s60 offen sc1
    s_add_u32 s60, s55, 65536
    buffer_load_dwordx2 v[160:161], v6, s[4:7], s60 offen sc1
    s_add_u32 s60, s55, 81920
    buffer_load_dwordx2 v[162:163], v6, s[4:7], s60 offen sc1
    v_add_u32 v7, 0x10000, v2
    buffer_load_dwordx4 a[32:35], v2, s[4:7], s59 offen offset:2048 sc1
    buffer_load_dwordx4 a[36:39], v2, s[4:7], s66 offen offset:2048 sc1
    buffer_load_dwordx4 a[40:43], v2, s[4:7], s68 offen offset:2048 sc1
    buffer_load_dwordx4 a[44:47], v2, s[4:7], s69 offen offset:2048 sc1
    s_waitcnt vmcnt(17) lgkmcnt(3)
    v_mfma_f32_16x16x32_bf16 v[208:211], v[8:11], a[0:3], 0
    s_waitcnt vmcnt(16)
    ds_read_b128 v[24:27], v7 offset:8192
    v_mfma_f32_16x16x32_bf16 v[212:215], v[8:11], a[4:7], 0
    s_waitcnt vmcnt(15)
    v_mfma_f32_16x16x32_bf16 v[216:219], v[8:11], a[8:11], 0
    s_waitcnt vmcnt(14)
    v_mfma_f32_16x16x32_bf16 v[220:223], v[8:11], a[12:15], 0
    s_waitcnt lgkmcnt(3)
    v_mfma_f32_16x16x32_bf16 v[224:227], v[12:15], a[0:3], 0
    ds_read_b128 v[28:31], v7 offset:9216
    v_mfma_f32_16x16x32_bf16 v[228:231], v[12:15], a[4:7], 0
    buffer_load_dwordx4 a[48:51], v2, s[4:7], s59 offen offset:3072 sc1
    v_mfma_f32_16x16x32_bf16 v[232:235], v[12:15], a[8:11], 0
    v_mfma_f32_16x16x32_bf16 v[236:239], v[12:15], a[12:15], 0
    s_waitcnt lgkmcnt(3)
    v_mfma_f32_16x16x32_bf16 v[64:67], v[16:19], a[0:3], 0
    ds_read_b128 v[8:11], v4 offset:2048
    v_mfma_f32_16x16x32_bf16 v[68:71], v[16:19], a[4:7], 0
    buffer_load_dwordx4 a[52:55], v2, s[4:7], s66 offen offset:3072 sc1
    v_mfma_f32_16x16x32_bf16 v[72:75], v[16:19], a[8:11], 0
    v_mfma_f32_16x16x32_bf16 v[76:79], v[16:19], a[12:15], 0
    buffer_load_dwordx4 a[56:59], v2, s[4:7], s68 offen offset:3072 sc1
    buffer_load_dwordx4 a[60:63], v2, s[4:7], s69 offen offset:3072 sc1
    s_waitcnt lgkmcnt(3)
    v_mfma_f32_16x16x32_bf16 v[80:83], v[20:23], a[0:3], 0
    s_add_u32 s59, s50, 4096
    ds_read_b128 v[12:15], v4 offset:3072
    v_mfma_f32_16x16x32_bf16 v[84:87], v[20:23], a[4:7], 0
    v_mfma_f32_16x16x32_bf16 v[88:91], v[20:23], a[8:11], 0
    v_mfma_f32_16x16x32_bf16 v[92:95], v[20:23], a[12:15], 0
    s_waitcnt lgkmcnt(3)
    v_mfma_f32_16x16x32_bf16 v[96:99], v[24:27], a[0:3], 0
    ds_read_b128 v[16:19], v4 offset:38912
    v_mfma_f32_16x16x32_bf16 v[100:103], v[24:27], a[4:7], 0
    buffer_load_dwordx4 a[64:67], v2, s[4:7], s59 offen offset:0 sc1
    v_mfma_f32_16x16x32_bf16 v[104:107], v[24:27], a[8:11], 0
    s_add_u32 s66, s50, 22528
    v_mfma_f32_16x16x32_bf16 v[108:111], v[24:27], a[12:15], 0
    s_waitcnt lgkmcnt(3)
    v_mfma_f32_16x16x32_bf16 v[112:115], v[28:31], a[0:3], 0
    ds_read_b128 v[20:23], v4 offset:39936
    v_mfma_f32_16x16x32_bf16 v[116:119], v[28:31], a[4:7], 0
    buffer_load_dwordx4 a[68:71], v2, s[4:7], s66 offen offset:0 sc1
    v_mfma_f32_16x16x32_bf16 v[120:123], v[28:31], a[8:11], 0
    s_add_u32 s68, s50, 40960
    v_mfma_f32_16x16x32_bf16 v[124:127], v[28:31], a[12:15], 0
    s_waitcnt vmcnt(19) lgkmcnt(3)
    v_mfma_f32_16x16x32_bf16 v[208:211], v[8:11], a[16:19], v[208:211]
    s_waitcnt vmcnt(18)
    ds_read_b128 v[24:27], v7 offset:10240
    v_mfma_f32_16x16x32_bf16 v[212:215], v[8:11], a[20:23], v[212:215]
    buffer_load_dwordx4 a[72:75], v2, s[4:7], s68 offen offset:0 sc1
    s_waitcnt vmcnt(18)
    v_mfma_f32_16x16x32_bf16 v[216:219], v[8:11], a[24:27], v[216:219]
    s_waitcnt vmcnt(17)
    s_add_u32 s69, s50, 59392
    v_mfma_f32_16x16x32_bf16 v[220:223], v[8:11], a[28:31], v[220:223]
    s_waitcnt lgkmcnt(3)
    v_mfma_f32_16x16x32_bf16 v[224:227], v[12:15], a[16:19], v[224:227]
    ds_read_b128 v[28:31], v7 offset:11264
    v_mfma_f32_16x16x32_bf16 v[228:231], v[12:15], a[20:23], v[228:231]
    buffer_load_dwordx4 a[76:79], v2, s[4:7], s69 offen offset:0 sc1
    v_mfma_f32_16x16x32_bf16 v[232:235], v[12:15], a[24:27], v[232:235]
    v_mfma_f32_16x16x32_bf16 v[236:239], v[12:15], a[28:31], v[236:239]
    s_waitcnt lgkmcnt(3)
    v_mfma_f32_16x16x32_bf16 v[64:67], v[16:19], a[16:19], v[64:67]
    ds_read_b128 v[8:11], v4 offset:4096
    v_mfma_f32_16x16x32_bf16 v[68:71], v[16:19], a[20:23], v[68:71]
    buffer_load_dwordx4 a[80:83], v2, s[4:7], s59 offen offset:1024 sc1
    v_mfma_f32_16x16x32_bf16 v[72:75], v[16:19], a[24:27], v[72:75]
    v_mfma_f32_16x16x32_bf16 v[76:79], v[16:19], a[28:31], v[76:79]
    s_waitcnt lgkmcnt(3)
    v_mfma_f32_16x16x32_bf16 v[80:83], v[20:23], a[16:19], v[80:83]
    ds_read_b128 v[12:15], v4 offset:5120
    v_mfma_f32_16x16x32_bf16 v[84:87], v[20:23], a[20:23], v[84:87]
    buffer_load_dwordx4 a[84:87], v2, s[4:7], s66 offen offset:1024 sc1
    v_mfma_f32_16x16x32_bf16 v[88:91], v[20:23], a[24:27], v[88:91]
    v_mfma_f32_16x16x32_bf16 v[92:95], v[20:23], a[28:31], v[92:95]
    s_waitcnt lgkmcnt(3)
    v_mfma_f32_16x16x32_bf16 v[96:99], v[24:27], a[16:19], v[96:99]
    ds_read_b128 v[16:19], v4 offset:40960
    v_mfma_f32_16x16x32_bf16 v[100:103], v[24:27], a[20:23], v[100:103]
    buffer_load_dwordx4 a[88:91], v2, s[4:7], s68 offen offset:1024 sc1
    v_mfma_f32_16x16x32_bf16 v[104:107], v[24:27], a[24:27], v[104:107]
    v_mfma_f32_16x16x32_bf16 v[108:111], v[24:27], a[28:31], v[108:111]
    s_waitcnt lgkmcnt(3)
    v_mfma_f32_16x16x32_bf16 v[112:115], v[28:31], a[16:19], v[112:115]
    ds_read_b128 v[20:23], v4 offset:41984
    v_mfma_f32_16x16x32_bf16 v[116:119], v[28:31], a[20:23], v[116:119]
    buffer_load_dwordx4 a[92:95], v2, s[4:7], s69 offen offset:1024 sc1
    v_mfma_f32_16x16x32_bf16 v[120:123], v[28:31], a[24:27], v[120:123]
    v_mfma_f32_16x16x32_bf16 v[124:127], v[28:31], a[28:31], v[124:127]
    s_waitcnt vmcnt(15) lgkmcnt(3)
    v_mfma_f32_16x16x32_bf16 v[208:211], v[8:11], a[32:35], v[208:211]
    s_waitcnt vmcnt(14)
    ds_read_b128 v[24:27], v7 offset:12288
    v_mfma_f32_16x16x32_bf16 v[212:215], v[8:11], a[36:39], v[212:215]
    buffer_load_dwordx4 a[96:99], v2, s[4:7], s59 offen offset:2048 sc1
    s_waitcnt vmcnt(14)
    v_mfma_f32_16x16x32_bf16 v[216:219], v[8:11], a[40:43], v[216:219]
    s_waitcnt vmcnt(13)
    v_mfma_f32_16x16x32_bf16 v[220:223], v[8:11], a[44:47], v[220:223]
    s_waitcnt lgkmcnt(3)
    v_mfma_f32_16x16x32_bf16 v[224:227], v[12:15], a[32:35], v[224:227]
    ds_read_b128 v[28:31], v7 offset:13312
    v_mfma_f32_16x16x32_bf16 v[228:231], v[12:15], a[36:39], v[228:231]
    buffer_load_dwordx4 a[100:103], v2, s[4:7], s66 offen offset:2048 sc1
    v_mfma_f32_16x16x32_bf16 v[232:235], v[12:15], a[40:43], v[232:235]
    v_mfma_f32_16x16x32_bf16 v[236:239], v[12:15], a[44:47], v[236:239]
    s_waitcnt lgkmcnt(3)
    v_mfma_f32_16x16x32_bf16 v[64:67], v[16:19], a[32:35], v[64:67]
    ds_read_b128 v[8:11], v4 offset:6144
    v_mfma_f32_16x16x32_bf16 v[68:71], v[16:19], a[36:39], v[68:71]
    buffer_load_dwordx4 a[104:107], v2, s[4:7], s68 offen offset:2048 sc1
    v_mfma_f32_16x16x32_bf16 v[72:75], v[16:19], a[40:43], v[72:75]
    v_mfma_f32_16x16x32_bf16 v[76:79], v[16:19], a[44:47], v[76:79]
    s_waitcnt lgkmcnt(3)
    v_mfma_f32_16x16x32_bf16 v[80:83], v[20:23], a[32:35], v[80:83]
    ds_read_b128 v[12:15], v4 offset:7168
    v_mfma_f32_16x16x32_bf16 v[84:87], v[20:23], a[36:39], v[84:87]
    buffer_load_dwordx4 a[108:111], v2, s[4:7], s69 offen offset:2048 sc1
    v_mfma_f32_16x16x32_bf16 v[88:91], v[20:23], a[40:43], v[88:91]
    v_mfma_f32_16x16x32_bf16 v[92:95], v[20:23], a[44:47], v[92:95]
    s_waitcnt lgkmcnt(3)
    v_mfma_f32_16x16x32_bf16 v[96:99], v[24:27], a[32:35], v[96:99]
    ds_read_b128 v[16:19], v4 offset:43008
    v_mfma_f32_16x16x32_bf16 v[100:103], v[24:27], a[36:39], v[100:103]
    buffer_load_dwordx4 a[112:115], v2, s[4:7], s59 offen offset:3072 sc1
    v_mfma_f32_16x16x32_bf16 v[104:107], v[24:27], a[40:43], v[104:107]
    v_mfma_f32_16x16x32_bf16 v[108:111], v[24:27], a[44:47], v[108:111]
    s_waitcnt lgkmcnt(3)
    v_mfma_f32_16x16x32_bf16 v[112:115], v[28:31], a[32:35], v[112:115]
    ds_read_b128 v[20:23], v4 offset:44032
    v_mfma_f32_16x16x32_bf16 v[116:119], v[28:31], a[36:39], v[116:119]
    buffer_load_dwordx4 a[116:119], v2, s[4:7], s66 offen offset:3072 sc1
    v_mfma_f32_16x16x32_bf16 v[120:123], v[28:31], a[40:43], v[120:123]
    v_mfma_f32_16x16x32_bf16 v[124:127], v[28:31], a[44:47], v[124:127]
    s_waitcnt vmcnt(17) lgkmcnt(3)
    v_mfma_f32_16x16x32_bf16 v[208:211], v[8:11], a[48:51], v[208:211]
    s_waitcnt vmcnt(16)
    ds_read_b128 v[24:27], v7 offset:14336
    v_mfma_f32_16x16x32_bf16 v[212:215], v[8:11], a[52:55], v[212:215]
    buffer_load_dwordx4 a[120:123], v2, s[4:7], s68 offen offset:3072 sc1
    s_waitcnt vmcnt(16)
    v_mfma_f32_16x16x32_bf16 v[216:219], v[8:11], a[56:59], v[216:219]
    s_waitcnt vmcnt(15)
    v_mfma_f32_16x16x32_bf16 v[220:223], v[8:11], a[60:63], v[220:223]
    s_waitcnt lgkmcnt(3)
    v_mfma_f32_16x16x32_bf16 v[224:227], v[12:15], a[48:51], v[224:227]
    ds_read_b128 v[28:31], v7 offset:15360
    v_mfma_f32_16x16x32_bf16 v[228:231], v[12:15], a[52:55], v[228:231]
    buffer_load_dwordx4 a[124:127], v2, s[4:7], s69 offen offset:3072 sc1
    v_mfma_f32_16x16x32_bf16 v[232:235], v[12:15], a[56:59], v[232:235]
    s_add_u32 s59, s50, 8192
    v_mfma_f32_16x16x32_bf16 v[236:239], v[12:15], a[60:63], v[236:239]
    s_waitcnt lgkmcnt(3)
    v_mfma_f32_16x16x32_bf16 v[64:67], v[16:19], a[48:51], v[64:67]
    ds_read_b128 v[8:11], v4 offset:8192
    v_mfma_f32_16x16x32_bf16 v[68:71], v[16:19], a[52:55], v[68:71]
    buffer_load_dwordx4 a[128:131], v2, s[4:7], s59 offen offset:0 sc1
    v_mfma_f32_16x16x32_bf16 v[72:75], v[16:19], a[56:59], v[72:75]
    s_add_u32 s66, s50, 26624
    v_mfma_f32_16x16x32_bf16 v[76:79], v[16:19], a[60:63], v[76:79]
    s_waitcnt lgkmcnt(3)
    v_mfma_f32_16x16x32_bf16 v[80:83], v[20:23], a[48:51], v[80:83]
    ds_read_b128 v[12:15], v4 offset:9216
    v_mfma_f32_16x16x32_bf16 v[84:87], v[20:23], a[52:55], v[84:87]
    buffer_load_dwordx4 a[132:135], v2, s[4:7], s66 offen offset:0 sc1
    v_mfma_f32_16x16x32_bf16 v[88:91], v[20:23], a[56:59], v[88:91]
    s_add_u32 s68, s50, 45056
    v_mfma_f32_16x16x32_bf16 v[92:95], v[20:23], a[60:63], v[92:95]
    s_waitcnt lgkmcnt(3)
    v_mfma_f32_16x16x32_bf16 v[96:99], v[24:27], a[48:51], v[96:99]
    ds_read_b128 v[16:19], v4 offset:45056
    v_mfma_f32_16x16x32_bf16 v[100:103], v[24:27], a[52:55], v[100:103]
    buffer_load_dwordx4 a[136:139], v2, s[4:7], s68 offen offset:0 sc1
    v_mfma_f32_16x16x32_bf16 v[104:107], v[24:27], a[56:59], v[104:107]
    s_add_u32 s69, s50, 63488
    v_mfma_f32_16x16x32_bf16 v[108:111], v[24:27], a[60:63], v[108:111]
    s_waitcnt lgkmcnt(3)
    v_mfma_f32_16x16x32_bf16 v[112:115], v[28:31], a[48:51], v[112:115]
    ds_read_b128 v[20:23], v4 offset:46080
    v_mfma_f32_16x16x32_bf16 v[116:119], v[28:31], a[52:55], v[116:119]
    buffer_load_dwordx4 a[140:143], v2, s[4:7], s69 offen offset:0 sc1
    v_mfma_f32_16x16x32_bf16 v[120:123], v[28:31], a[56:59], v[120:123]
    v_mfma_f32_16x16x32_bf16 v[124:127], v[28:31], a[60:63], v[124:127]
    s_waitcnt vmcnt(19) lgkmcnt(3)
    v_mfma_f32_16x16x32_bf16 v[208:211], v[8:11], a[64:67], v[208:211]
    s_waitcnt vmcnt(18)
    ds_read_b128 v[24:27], v7 offset:16384
    v_mfma_f32_16x16x32_bf16 v[212:215], v[8:11], a[68:71], v[212:215]
    buffer_load_dwordx4 a[144:147], v2, s[4:7], s59 offen offset:1024 sc1
    s_waitcnt vmcnt(18)
    v_mfma_f32_16x16x32_bf16 v[216:219], v[8:11], a[72:75], v[216:219]
    s_waitcnt vmcnt(17)
    v_mfma_f32_16x16x32_bf16 v[220:223], v[8:11], a[76:79], v[220:223]
    s_waitcnt lgkmcnt(3)
    v_mfma_f32_16x16x32_bf16 v[224:227], v[12:15], a[64:67], v[224:227]
    ds_read_b128 v[28:31], v7 offset:17408
    v_mfma_f32_16x16x32_bf16 v[228:231], v[12:15], a[68:71], v[228:231]
    buffer_load_dwordx4 a[148:151], v2, s[4:7], s66 offen offset:1024 sc1
    v_mfma_f32_16x16x32_bf16 v[232:235], v[12:15], a[72:75], v[232:235]
    v_mfma_f32_16x16x32_bf16 v[236:239], v[12:15], a[76:79], v[236:239]
    s_waitcnt lgkmcnt(3)
    v_mfma_f32_16x16x32_bf16 v[64:67], v[16:19], a[64:67], v[64:67]
    ds_read_b128 v[8:11], v4 offset:10240
    v_mfma_f32_16x16x32_bf16 v[68:71], v[16:19], a[68:71], v[68:71]
    buffer_load_dwordx4 a[152:155], v2, s[4:7], s68 offen offset:1024 sc1
    v_mfma_f32_16x16x32_bf16 v[72:75], v[16:19], a[72:75], v[72:75]
    v_mfma_f32_16x16x32_bf16 v[76:79], v[16:19], a[76:79], v[76:79]
    s_waitcnt lgkmcnt(3)
    v_mfma_f32_16x16x32_bf16 v[80:83], v[20:23], a[64:67], v[80:83]
    ds_read_b128 v[12:15], v4 offset:11264
    v_mfma_f32_16x16x32_bf16 v[84:87], v[20:23], a[68:71], v[84:87]
    buffer_load_dwordx4 a[156:159], v2, s[4:7], s69 offen offset:1024 sc1
    v_mfma_f32_16x16x32_bf16 v[88:91], v[20:23], a[72:75], v[88:91]
    v_mfma_f32_16x16x32_bf16 v[92:95], v[20:23], a[76:79], v[92:95]
    s_waitcnt lgkmcnt(3)
    v_mfma_f32_16x16x32_bf16 v[96:99], v[24:27], a[64:67], v[96:99]
    ds_read_b128 v[16:19], v4 offset:47104
    v_mfma_f32_16x16x32_bf16 v[100:103], v[24:27], a[68:71], v[100:103]
    buffer_load_dwordx4 a[160:163], v2, s[4:7], s59 offen offset:2048 sc1
    v_mfma_f32_16x16x32_bf16 v[104:107], v[24:27], a[72:75], v[104:107]
    v_mfma_f32_16x16x32_bf16 v[108:111], v[24:27], a[76:79], v[108:111]
    s_waitcnt lgkmcnt(3)
    v_mfma_f32_16x16x32_bf16 v[112:115], v[28:31], a[64:67], v[112:115]
    ds_read_b128 v[20:23], v4 offset:48128
    v_mfma_f32_16x16x32_bf16 v[116:119], v[28:31], a[68:71], v[116:119]
    buffer_load_dwordx4 a[164:167], v2, s[4:7], s66 offen offset:2048 sc1
    v_mfma_f32_16x16x32_bf16 v[120:123], v[28:31], a[72:75], v[120:123]
    v_mfma_f32_16x16x32_bf16 v[124:127], v[28:31], a[76:79], v[124:127]
    s_waitcnt vmcnt(21) lgkmcnt(3)
    v_mfma_f32_16x16x32_bf16 v[208:211], v[8:11], a[80:83], v[208:211]
    s_waitcnt vmcnt(20)
    ds_read_b128 v[24:27], v7 offset:18432
    v_mfma_f32_16x16x32_bf16 v[212:215], v[8:11], a[84:87], v[212:215]
    buffer_load_dwordx4 a[168:171], v2, s[4:7], s68 offen offset:2048 sc1
    s_waitcnt vmcnt(20)
    v_mfma_f32_16x16x32_bf16 v[216:219], v[8:11], a[88:91], v[216:219]
    s_waitcnt vmcnt(19)
    v_mfma_f32_16x16x32_bf16 v[220:223], v[8:11], a[92:95], v[220:223]
    s_waitcnt lgkmcnt(3)
    v_mfma_f32_16x16x32_bf16 v[224:227], v[12:15], a[80:83], v[224:227]
    ds_read_b128 v[28:31], v7 offset:19456
    v_mfma_f32_16x16x32_bf16 v[228:231], v[12:15], a[84:87], v[228:231]
    buffer_load_dwordx4 a[172:175], v2, s[4:7], s69 offen offset:2048 sc1
    v_mfma_f32_16x16x32_bf16 v[232:235], v[12:15], a[88:91], v[232:235]
    v_mfma_f32_16x16x32_bf16 v[236:239], v[12:15], a[92:95], v[236:239]
    s_waitcnt lgkmcnt(3)
    v_mfma_f32_16x16x32_bf16 v[64:67], v[16:19], a[80:83], v[64:67]
    ds_read_b128 v[8:11], v4 offset:12288
    v_mfma_f32_16x16x32_bf16 v[68:71], v[16:19], a[84:87], v[68:71]
    buffer_load_dwordx4 a[176:179], v2, s[4:7], s59 offen offset:3072 sc1
    v_mfma_f32_16x16x32_bf16 v[72:75], v[16:19], a[88:91], v[72:75]
    v_mfma_f32_16x16x32_bf16 v[76:79], v[16:19], a[92:95], v[76:79]
    s_waitcnt lgkmcnt(3)
    v_mfma_f32_16x16x32_bf16 v[80:83], v[20:23], a[80:83], v[80:83]
    ds_read_b128 v[12:15], v4 offset:13312
    v_mfma_f32_16x16x32_bf16 v[84:87], v[20:23], a[84:87], v[84:87]
    buffer_load_dwordx4 a[180:183], v2, s[4:7], s66 offen offset:3072 sc1
    v_mfma_f32_16x16x32_bf16 v[88:91], v[20:23], a[88:91], v[88:91]
    v_mfma_f32_16x16x32_bf16 v[92:95], v[20:23], a[92:95], v[92:95]
    s_waitcnt lgkmcnt(3)
    v_mfma_f32_16x16x32_bf16 v[96:99], v[24:27], a[80:83], v[96:99]
    ds_read_b128 v[16:19], v4 offset:49152
    v_mfma_f32_16x16x32_bf16 v[100:103], v[24:27], a[84:87], v[100:103]
    buffer_load_dwordx4 a[184:187], v2, s[4:7], s68 offen offset:3072 sc1
    v_mfma_f32_16x16x32_bf16 v[104:107], v[24:27], a[88:91], v[104:107]
    v_mfma_f32_16x16x32_bf16 v[108:111], v[24:27], a[92:95], v[108:111]
    s_waitcnt lgkmcnt(3)
    v_mfma_f32_16x16x32_bf16 v[112:115], v[28:31], a[80:83], v[112:115]
    ds_read_b128 v[20:23], v4 offset:50176
    v_mfma_f32_16x16x32_bf16 v[116:119], v[28:31], a[84:87], v[116:119]
    buffer_load_dwordx4 a[188:191], v2, s[4:7], s69 offen offset:3072 sc1
    v_mfma_f32_16x16x32_bf16 v[120:123], v[28:31], a[88:91], v[120:123]
    s_add_u32 s59, s50, 12288
    v_mfma_f32_16x16x32_bf16 v[124:127], v[28:31], a[92:95], v[124:127]
    s_waitcnt vmcnt(23) lgkmcnt(3)
    v_mfma_f32_16x16x32_bf16 v[208:211], v[8:11], a[96:99], v[208:211]
    s_waitcnt vmcnt(22)
    ds_read_b128 v[24:27], v7 offset:20480
    v_mfma_f32_16x16x32_bf16 v[212:215], v[8:11], a[100:103], v[212:215]
    buffer_load_dwordx4 a[192:195], v2, s[4:7], s59 offen offset:0 sc1
    s_waitcnt vmcnt(22)
    v_mfma_f32_16x16x32_bf16 v[216:219], v[8:11], a[104:107], v[216:219]
    s_waitcnt vmcnt(21)
    s_add_u32 s66, s50, 30720
    v_mfma_f32_16x16x32_bf16 v[220:223], v[8:11], a[108:111], v[220:223]
    s_waitcnt lgkmcnt(3)
    v_mfma_f32_16x16x32_bf16 v[224:227], v[12:15], a[96:99], v[224:227]
    ds_read_b128 v[28:31], v7 offset:21504
    v_mfma_f32_16x16x32_bf16 v[228:231], v[12:15], a[100:103], v[228:231]
    buffer_load_dwordx4 a[196:199], v2, s[4:7], s66 offen offset:0 sc1
    v_mfma_f32_16x16x32_bf16 v[232:235], v[12:15], a[104:107], v[232:235]
    s_add_u32 s68, s50, 49152
    v_mfma_f32_16x16x32_bf16 v[236:239], v[12:15], a[108:111], v[236:239]
    s_waitcnt lgkmcnt(3)
    v_mfma_f32_16x16x32_bf16 v[64:67], v[16:19], a[96:99], v[64:67]
    ds_read_b128 v[8:11], v4 offset:14336
    v_mfma_f32_16x16x32_bf16 v[68:71], v[16:19], a[100:103], v[68:71]
    buffer_load_dwordx4 a[200:203], v2, s[4:7], s68 offen offset:0 sc1
    v_mfma_f32_16x16x32_bf16 v[72:75], v[16:19], a[104:107], v[72:75]
    s_add_u32 s69, s50, 67584
    v_mfma_f32_16x16x32_bf16 v[76:79], v[16:19], a[108:111], v[76:79]
    s_waitcnt lgkmcnt(3)
    v_mfma_f32_16x16x32_bf16 v[80:83], v[20:23], a[96:99], v[80:83]
    ds_read_b128 v[12:15], v4 offset:15360
    v_mfma_f32_16x16x32_bf16 v[84:87], v[20:23], a[100:103], v[84:87]
    buffer_load_dwordx4 a[204:207], v2, s[4:7], s69 offen offset:0 sc1
    v_mfma_f32_16x16x32_bf16 v[88:91], v[20:23], a[104:107], v[88:91]
    v_mfma_f32_16x16x32_bf16 v[92:95], v[20:23], a[108:111], v[92:95]
    s_waitcnt lgkmcnt(3)
    v_mfma_f32_16x16x32_bf16 v[96:99], v[24:27], a[96:99], v[96:99]
    ds_read_b128 v[16:19], v4 offset:51200
    v_mfma_f32_16x16x32_bf16 v[100:103], v[24:27], a[100:103], v[100:103]
    buffer_load_dwordx4 a[208:211], v2, s[4:7], s59 offen offset:1024 sc1
    v_mfma_f32_16x16x32_bf16 v[104:107], v[24:27], a[104:107], v[104:107]
    v_mfma_f32_16x16x32_bf16 v[108:111], v[24:27], a[108:111], v[108:111]
    s_waitcnt lgkmcnt(3)
    v_mfma_f32_16x16x32_bf16 v[112:115], v[28:31], a[96:99], v[112:115]
    ds_read_b128 v[20:23], v4 offset:52224
    v_mfma_f32_16x16x32_bf16 v[116:119], v[28:31], a[100:103], v[116:119]
    buffer_load_dwordx4 a[212:215], v2, s[4:7], s66 offen offset:1024 sc1
    v_mfma_f32_16x16x32_bf16 v[120:123], v[28:31], a[104:107], v[120:123]
    v_mfma_f32_16x16x32_bf16 v[124:127], v[28:31], a[108:111], v[124:127]
    s_waitcnt vmcnt(25) lgkmcnt(3)
    v_mfma_f32_16x16x32_bf16 v[208:211], v[8:11], a[112:115], v[208:211]
    s_waitcnt vmcnt(24)
    ds_read_b128 v[24:27], v7 offset:22528
    v_mfma_f32_16x16x32_bf16 v[212:215], v[8:11], a[116:119], v[212:215]
    buffer_load_dwordx4 a[216:219], v2, s[4:7], s68 offen offset:1024 sc1
    s_waitcnt vmcnt(24)
    v_mfma_f32_16x16x32_bf16 v[216:219], v[8:11], a[120:123], v[216:219]
    s_waitcnt vmcnt(23)
    v_mfma_f32_16x16x32_bf16 v[220:223], v[8:11], a[124:127], v[220:223]
    s_waitcnt lgkmcnt(3)
    v_mfma_f32_16x16x32_bf16 v[224:227], v[12:15], a[112:115], v[224:227]
    ds_read_b128 v[28:31], v7 offset:23552
    v_mfma_f32_16x16x32_bf16 v[228:231], v[12:15], a[116:119], v[228:231]
    buffer_load_dwordx4 a[220:223], v2, s[4:7], s69 offen offset:1024 sc1
    v_mfma_f32_16x16x32_bf16 v[232:235], v[12:15], a[120:123], v[232:235]
    v_mfma_f32_16x16x32_bf16 v[236:239], v[12:15], a[124:127], v[236:239]
    s_waitcnt lgkmcnt(3)
    v_mfma_f32_16x16x32_bf16 v[64:67], v[16:19], a[112:115], v[64:67]
    ds_read_b128 v[8:11], v4 offset:16384
    v_mfma_f32_16x16x32_bf16 v[68:71], v[16:19], a[116:119], v[68:71]
    buffer_load_dwordx4 a[224:227], v2, s[4:7], s59 offen offset:2048 sc1
    v_mfma_f32_16x16x32_bf16 v[72:75], v[16:19], a[120:123], v[72:75]
    v_mfma_f32_16x16x32_bf16 v[76:79], v[16:19], a[124:127], v[76:79]
    s_waitcnt lgkmcnt(3)
    v_mfma_f32_16x16x32_bf16 v[80:83], v[20:23], a[112:115], v[80:83]
    ds_read_b128 v[12:15], v4 offset:17408
    v_mfma_f32_16x16x32_bf16 v[84:87], v[20:23], a[116:119], v[84:87]
    buffer_load_dwordx4 a[228:231], v2, s[4:7], s66 offen offset:2048 sc1
    v_mfma_f32_16x16x32_bf16 v[88:91], v[20:23], a[120:123], v[88:91]
    v_mfma_f32_16x16x32_bf16 v[92:95], v[20:23], a[124:127], v[92:95]
    s_waitcnt lgkmcnt(3)
    v_mfma_f32_16x16x32_bf16 v[96:99], v[24:27], a[112:115], v[96:99]
    ds_read_b128 v[16:19], v4 offset:53248
    v_mfma_f32_16x16x32_bf16 v[100:103], v[24:27], a[116:119], v[100:103]
    buffer_load_dwordx4 a[232:235], v2, s[4:7], s68 offen offset:2048 sc1
    v_mfma_f32_16x16x32_bf16 v[104:107], v[24:27], a[120:123], v[104:107]
    v_mfma_f32_16x16x32_bf16 v[108:111], v[24:27], a[124:127], v[108:111]
    s_waitcnt lgkmcnt(3)
    v_mfma_f32_16x16x32_bf16 v[112:115], v[28:31], a[112:115], v[112:115]
    ds_read_b128 v[20:23], v4 offset:54272
    v_mfma_f32_16x16x32_bf16 v[116:119], v[28:31], a[116:119], v[116:119]
    buffer_load_dwordx4 a[236:239], v2, s[4:7], s69 offen offset:2048 sc1
    v_mfma_f32_16x16x32_bf16 v[120:123], v[28:31], a[120:123], v[120:123]
    v_mfma_f32_16x16x32_bf16 v[124:127], v[28:31], a[124:127], v[124:127]
    s_waitcnt vmcnt(27) lgkmcnt(3)
    v_mfma_f32_16x16x32_bf16 v[208:211], v[8:11], a[128:131], v[208:211]
    s_waitcnt vmcnt(26)
    ds_read_b128 v[24:27], v7 offset:24576
    v_mfma_f32_16x16x32_bf16 v[212:215], v[8:11], a[132:135], v[212:215]
    buffer_load_dwordx4 a[240:243], v2, s[4:7], s59 offen offset:3072 sc1
    s_waitcnt vmcnt(26)
    v_mfma_f32_16x16x32_bf16 v[216:219], v[8:11], a[136:139], v[216:219]
    s_waitcnt vmcnt(25)
    v_mfma_f32_16x16x32_bf16 v[220:223], v[8:11], a[140:143], v[220:223]
    s_waitcnt lgkmcnt(3)
    v_mfma_f32_16x16x32_bf16 v[224:227], v[12:15], a[128:131], v[224:227]
    ds_read_b128 v[28:31], v7 offset:25600
    v_mfma_f32_16x16x32_bf16 v[228:231], v[12:15], a[132:135], v[228:231]
    buffer_load_dwordx4 a[244:247], v2, s[4:7], s66 offen offset:3072 sc1
    v_mfma_f32_16x16x32_bf16 v[232:235], v[12:15], a[136:139], v[232:235]
    v_mfma_f32_16x16x32_bf16 v[236:239], v[12:15], a[140:143], v[236:239]
    s_waitcnt lgkmcnt(3)
    s_add_u32 m0, s49, 110592
    s_add_u32 s61, s48, 110592
    v_mfma_f32_16x16x32_bf16 v[64:67], v[16:19], a[128:131], v[64:67]
    ds_read_b128 v[8:11], v4 offset:18432
    v_mfma_f32_16x16x32_bf16 v[68:71], v[16:19], a[132:135], v[68:71]
    buffer_load_dwordx4 a[248:251], v2, s[4:7], s68 offen offset:3072 sc1
    v_mfma_f32_16x16x32_bf16 v[72:75], v[16:19], a[136:139], v[72:75]
    v_mfma_f32_16x16x32_bf16 v[76:79], v[16:19], a[140:143], v[76:79]
    s_waitcnt lgkmcnt(3)
    v_mfma_f32_16x16x32_bf16 v[80:83], v[20:23], a[128:131], v[80:83]
    ds_read_b128 v[12:15], v4 offset:19456
    v_mfma_f32_16x16x32_bf16 v[84:87], v[20:23], a[132:135], v[84:87]
    buffer_load_dwordx4 a[252:255], v2, s[4:7], s69 offen offset:3072 sc1
    v_mfma_f32_16x16x32_bf16 v[88:91], v[20:23], a[136:139], v[88:91]
    s_add_u32 s59, s50, 16384
    v_mfma_f32_16x16x32_bf16 v[92:95], v[20:23], a[140:143], v[92:95]
    s_waitcnt lgkmcnt(3)
    v_mfma_f32_16x16x32_bf16 v[96:99], v[24:27], a[128:131], v[96:99]
    ds_read_b128 v[16:19], v4 offset:55296
    v_mfma_f32_16x16x32_bf16 v[100:103], v[24:27], a[132:135], v[100:103]
    buffer_load_dwordx4 v[32:35], v2, s[4:7], s59 offen offset:0 sc1
    v_mfma_f32_16x16x32_bf16 v[104:107], v[24:27], a[136:139], v[104:107]
    s_add_u32 s66, s50, 34816
    v_mfma_f32_16x16x32_bf16 v[108:111], v[24:27], a[140:143], v[108:111]
    s_waitcnt lgkmcnt(3)
    v_mfma_f32_16x16x32_bf16 v[112:115], v[28:31], a[128:131], v[112:115]
    ds_read_b128 v[20:23], v4 offset:56320
    v_mfma_f32_16x16x32_bf16 v[116:119], v[28:31], a[132:135], v[116:119]
    buffer_load_dwordx4 v[36:39], v2, s[4:7], s66 offen offset:0 sc1
    v_mfma_f32_16x16x32_bf16 v[120:123], v[28:31], a[136:139], v[120:123]
    s_add_u32 s68, s50, 53248
    v_mfma_f32_16x16x32_bf16 v[124:127], v[28:31], a[140:143], v[124:127]
    s_waitcnt vmcnt(29) lgkmcnt(3)
    v_mfma_f32_16x16x32_bf16 v[208:211], v[8:11], a[144:147], v[208:211]
    s_waitcnt vmcnt(28)
    ds_read_b128 v[24:27], v7 offset:26624
    v_mfma_f32_16x16x32_bf16 v[212:215], v[8:11], a[148:151], v[212:215]
    buffer_load_dwordx4 v[40:43], v2, s[4:7], s68 offen offset:0 sc1
    s_waitcnt vmcnt(28)
    v_mfma_f32_16x16x32_bf16 v[216:219], v[8:11], a[152:155], v[216:219]
    s_waitcnt vmcnt(27)
    s_add_u32 s69, s50, 71680
    v_mfma_f32_16x16x32_bf16 v[220:223], v[8:11], a[156:159], v[220:223]
    s_waitcnt lgkmcnt(3)
    v_mfma_f32_16x16x32_bf16 v[224:227], v[12:15], a[144:147], v[224:227]
    ds_read_b128 v[28:31], v7 offset:27648
    v_mfma_f32_16x16x32_bf16 v[228:231], v[12:15], a[148:151], v[228:231]
    buffer_load_dwordx4 v[44:47], v2, s[4:7], s69 offen offset:0 sc1
    v_mfma_f32_16x16x32_bf16 v[232:235], v[12:15], a[152:155], v[232:235]
    v_mfma_f32_16x16x32_bf16 v[236:239], v[12:15], a[156:159], v[236:239]
    s_waitcnt lgkmcnt(3)
    v_mfma_f32_16x16x32_bf16 v[64:67], v[16:19], a[144:147], v[64:67]
    ds_read_b128 v[8:11], v4 offset:20480
    v_mfma_f32_16x16x32_bf16 v[68:71], v[16:19], a[148:151], v[68:71]
    buffer_load_dwordx4 v2, s[4:7], s61 offen offset:0 lds
    v_mfma_f32_16x16x32_bf16 v[72:75], v[16:19], a[152:155], v[72:75]
    v_mfma_f32_16x16x32_bf16 v[76:79], v[16:19], a[156:159], v[76:79]
    s_waitcnt lgkmcnt(3)
    v_mfma_f32_16x16x32_bf16 v[80:83], v[20:23], a[144:147], v[80:83]
    ds_read_b128 v[12:15], v4 offset:21504
    v_mfma_f32_16x16x32_bf16 v[84:87], v[20:23], a[148:151], v[84:87]
    buffer_load_dwordx4 v2, s[4:7], s61 offen offset:1024 lds
    v_mfma_f32_16x16x32_bf16 v[88:91], v[20:23], a[152:155], v[88:91]
    v_mfma_f32_16x16x32_bf16 v[92:95], v[20:23], a[156:159], v[92:95]
    s_waitcnt lgkmcnt(3)
    v_mfma_f32_16x16x32_bf16 v[96:99], v[24:27], a[144:147], v[96:99]
    ds_read_b128 v[16:19], v4 offset:57344
    v_mfma_f32_16x16x32_bf16 v[100:103], v[24:27], a[148:151], v[100:103]
    buffer_load_dwordx4 v2, s[4:7], s61 offen offset:2048 lds
    v_mfma_f32_16x16x32_bf16 v[104:107], v[24:27], a[152:155], v[104:107]
    v_mfma_f32_16x16x32_bf16 v[108:111], v[24:27], a[156:159], v[108:111]
    s_waitcnt lgkmcnt(3)
    v_mfma_f32_16x16x32_bf16 v[112:115], v[28:31], a[144:147], v[112:115]
    ds_read_b128 v[20:23], v4 offset:58368
    v_mfma_f32_16x16x32_bf16 v[116:119], v[28:31], a[148:151], v[116:119]
    buffer_load_dwordx4 v2, s[4:7], s61 offen offset:3072 lds
    v_mfma_f32_16x16x32_bf16 v[120:123], v[28:31], a[152:155], v[120:123]
    s_add_u32 m0, s49, 114688
    s_add_u32 s61, s48, 114688
    v_mfma_f32_16x16x32_bf16 v[124:127], v[28:31], a[156:159], v[124:127]
    s_waitcnt vmcnt(31) lgkmcnt(3)
    v_mfma_f32_16x16x32_bf16 v[208:211], v[8:11], a[160:163], v[208:211]
    s_waitcnt vmcnt(30)
    ds_read_b128 v[24:27], v7 offset:28672
    v_mfma_f32_16x16x32_bf16 v[212:215], v[8:11], a[164:167], v[212:215]
    buffer_load_dwordx4 v2, s[4:7], s61 offen offset:0 lds
    s_waitcnt vmcnt(30)
    v_mfma_f32_16x16x32_bf16 v[216:219], v[8:11], a[168:171], v[216:219]
    s_waitcnt vmcnt(29)
    v_mfma_f32_16x16x32_bf16 v[220:223], v[8:11], a[172:175], v[220:223]
    s_waitcnt lgkmcnt(3)
    v_mfma_f32_16x16x32_bf16 v[224:227], v[12:15], a[160:163], v[224:227]
    ds_read_b128 v[28:31], v7 offset:29696
    v_mfma_f32_16x16x32_bf16 v[228:231], v[12:15], a[164:167], v[228:231]
    buffer_load_dwordx4 v2, s[4:7], s61 offen offset:1024 lds
    v_mfma_f32_16x16x32_bf16 v[232:235], v[12:15], a[168:171], v[232:235]
    v_mfma_f32_16x16x32_bf16 v[236:239], v[12:15], a[172:175], v[236:239]
    s_waitcnt lgkmcnt(3)
    v_mfma_f32_16x16x32_bf16 v[64:67], v[16:19], a[160:163], v[64:67]
    ds_read_b128 v[8:11], v4 offset:22528
    v_mfma_f32_16x16x32_bf16 v[68:71], v[16:19], a[164:167], v[68:71]
    buffer_load_dwordx4 v2, s[4:7], s61 offen offset:2048 lds
    v_mfma_f32_16x16x32_bf16 v[72:75], v[16:19], a[168:171], v[72:75]
    v_mfma_f32_16x16x32_bf16 v[76:79], v[16:19], a[172:175], v[76:79]
    s_waitcnt lgkmcnt(3)
    v_mfma_f32_16x16x32_bf16 v[80:83], v[20:23], a[160:163], v[80:83]
    ds_read_b128 v[12:15], v4 offset:23552
    v_mfma_f32_16x16x32_bf16 v[84:87], v[20:23], a[164:167], v[84:87]
    buffer_load_dwordx4 v2, s[4:7], s61 offen offset:3072 lds
    v_mfma_f32_16x16x32_bf16 v[88:91], v[20:23], a[168:171], v[88:91]
    s_add_u32 m0, s49, 118784
    s_add_u32 s61, s48, 118784
    v_mfma_f32_16x16x32_bf16 v[92:95], v[20:23], a[172:175], v[92:95]
    s_waitcnt lgkmcnt(3)
    v_mfma_f32_16x16x32_bf16 v[96:99], v[24:27], a[160:163], v[96:99]
    ds_read_b128 v[16:19], v4 offset:59392
    v_mfma_f32_16x16x32_bf16 v[100:103], v[24:27], a[164:167], v[100:103]
    buffer_load_dwordx4 v2, s[4:7], s61 offen offset:0 lds
    v_mfma_f32_16x16x32_bf16 v[104:107], v[24:27], a[168:171], v[104:107]
    v_mfma_f32_16x16x32_bf16 v[108:111], v[24:27], a[172:175], v[108:111]
    s_waitcnt lgkmcnt(3)
    v_mfma_f32_16x16x32_bf16 v[112:115], v[28:31], a[160:163], v[112:115]
    ds_read_b128 v[20:23], v4 offset:60416
    v_mfma_f32_16x16x32_bf16 v[116:119], v[28:31], a[164:167], v[116:119]
    buffer_load_dwordx4 v[48:51], v2, s[4:7], s59 offen offset:1024 sc1
    v_mfma_f32_16x16x32_bf16 v[120:123], v[28:31], a[168:171], v[120:123]
    v_mfma_f32_16x16x32_bf16 v[124:127], v[28:31], a[172:175], v[124:127]
    s_waitcnt vmcnt(33) lgkmcnt(3)
    v_mfma_f32_16x16x32_bf16 v[208:211], v[8:11], a[176:179], v[208:211]
    s_waitcnt vmcnt(32)
    ds_read_b128 v[24:27], v7 offset:30720
    v_mfma_f32_16x16x32_bf16 v[212:215], v[8:11], a[180:183], v[212:215]
    buffer_load_dwordx4 v[52:55], v2, s[4:7], s66 offen offset:1024 sc1
    s_waitcnt vmcnt(32)
    v_mfma_f32_16x16x32_bf16 v[216:219], v[8:11], a[184:187], v[216:219]
    s_waitcnt vmcnt(31)
    v_mfma_f32_16x16x32_bf16 v[220:223], v[8:11], a[188:191], v[220:223]
    s_waitcnt lgkmcnt(3)
    v_mfma_f32_16x16x32_bf16 v[224:227], v[12:15], a[176:179], v[224:227]
    ds_read_b128 v[28:31], v7 offset:31744
    v_mfma_f32_16x16x32_bf16 v[228:231], v[12:15], a[180:183], v[228:231]
    buffer_load_dwordx4 v[56:59], v2, s[4:7], s68 offen offset:1024 sc1
    v_mfma_f32_16x16x32_bf16 v[232:235], v[12:15], a[184:187], v[232:235]
    v_mfma_f32_16x16x32_bf16 v[236:239], v[12:15], a[188:191], v[236:239]
    s_waitcnt lgkmcnt(3)
    v_mfma_f32_16x16x32_bf16 v[64:67], v[16:19], a[176:179], v[64:67]
    ds_read_b128 v[8:11], v4 offset:24576
    v_mfma_f32_16x16x32_bf16 v[68:71], v[16:19], a[180:183], v[68:71]
    buffer_load_dwordx4 v[60:63], v2, s[4:7], s69 offen offset:1024 sc1
    v_mfma_f32_16x16x32_bf16 v[72:75], v[16:19], a[184:187], v[72:75]
    v_mfma_f32_16x16x32_bf16 v[76:79], v[16:19], a[188:191], v[76:79]
    s_waitcnt lgkmcnt(3)
    v_mfma_f32_16x16x32_bf16 v[80:83], v[20:23], a[176:179], v[80:83]
    ds_read_b128 v[12:15], v4 offset:25600
    v_mfma_f32_16x16x32_bf16 v[84:87], v[20:23], a[180:183], v[84:87]
    v_mfma_f32_16x16x32_bf16 v[88:91], v[20:23], a[184:187], v[88:91]
    v_mfma_f32_16x16x32_bf16 v[92:95], v[20:23], a[188:191], v[92:95]
    s_waitcnt lgkmcnt(3)
    v_mfma_f32_16x16x32_bf16 v[96:99], v[24:27], a[176:179], v[96:99]
    ds_read_b128 v[16:19], v4 offset:61440
    v_mfma_f32_16x16x32_bf16 v[100:103], v[24:27], a[180:183], v[100:103]
    v_mfma_f32_16x16x32_bf16 v[104:107], v[24:27], a[184:187], v[104:107]
    v_mfma_f32_16x16x32_bf16 v[108:111], v[24:27], a[188:191], v[108:111]
    s_waitcnt lgkmcnt(3)
    v_mfma_f32_16x16x32_bf16 v[112:115], v[28:31], a[176:179], v[112:115]
    ds_read_b128 v[20:23], v4 offset:62464
    v_mfma_f32_16x16x32_bf16 v[116:119], v[28:31], a[180:183], v[116:119]
    v_mfma_f32_16x16x32_bf16 v[120:123], v[28:31], a[184:187], v[120:123]
    v_mfma_f32_16x16x32_bf16 v[124:127], v[28:31], a[188:191], v[124:127]
    s_waitcnt vmcnt(32) lgkmcnt(3)
    v_mfma_f32_16x16x32_bf16 v[208:211], v[8:11], a[192:195], v[208:211]
    s_waitcnt vmcnt(31)
    ds_read_b128 v[24:27], v7 offset:32768
    v_mfma_f32_16x16x32_bf16 v[212:215], v[8:11], a[196:199], v[212:215]
    s_waitcnt vmcnt(30)
    v_mfma_f32_16x16x32_bf16 v[216:219], v[8:11], a[200:203], v[216:219]
    s_waitcnt vmcnt(29)
    v_mfma_f32_16x16x32_bf16 v[220:223], v[8:11], a[204:207], v[220:223]
    s_waitcnt lgkmcnt(3)
    v_mfma_f32_16x16x32_bf16 v[224:227], v[12:15], a[192:195], v[224:227]
    ds_read_b128 v[28:31], v7 offset:33792
    v_mfma_f32_16x16x32_bf16 v[228:231], v[12:15], a[196:199], v[228:231]
    v_mfma_f32_16x16x32_bf16 v[232:235], v[12:15], a[200:203], v[232:235]
    v_mfma_f32_16x16x32_bf16 v[236:239], v[12:15], a[204:207], v[236:239]
    s_waitcnt lgkmcnt(3)
    v_mfma_f32_16x16x32_bf16 v[64:67], v[16:19], a[192:195], v[64:67]
    ds_read_b128 v[8:11], v4 offset:26624
    v_mfma_f32_16x16x32_bf16 v[68:71], v[16:19], a[196:199], v[68:71]
    v_mfma_f32_16x16x32_bf16 v[72:75], v[16:19], a[200:203], v[72:75]
    v_mfma_f32_16x16x32_bf16 v[76:79], v[16:19], a[204:207], v[76:79]
    s_waitcnt lgkmcnt(3)
    v_mfma_f32_16x16x32_bf16 v[80:83], v[20:23], a[192:195], v[80:83]
    ds_read_b128 v[12:15], v4 offset:27648
    v_mfma_f32_16x16x32_bf16 v[84:87], v[20:23], a[196:199], v[84:87]
    v_mfma_f32_16x16x32_bf16 v[88:91], v[20:23], a[200:203], v[88:91]
    v_mfma_f32_16x16x32_bf16 v[92:95], v[20:23], a[204:207], v[92:95]
    s_waitcnt lgkmcnt(3)
    v_mfma_f32_16x16x32_bf16 v[96:99], v[24:27], a[192:195], v[96:99]
    ds_read_b128 v[16:19], v4 offset:63488
    v_mfma_f32_16x16x32_bf16 v[100:103], v[24:27], a[196:199], v[100:103]
    v_mfma_f32_16x16x32_bf16 v[104:107], v[24:27], a[200:203], v[104:107]
    v_mfma_f32_16x16x32_bf16 v[108:111], v[24:27], a[204:207], v[108:111]
    s_waitcnt lgkmcnt(3)
    v_mfma_f32_16x16x32_bf16 v[112:115], v[28:31], a[192:195], v[112:115]
    ds_read_b128 v[20:23], v4 offset:64512
    v_mfma_f32_16x16x32_bf16 v[116:119], v[28:31], a[196:199], v[116:119]
    v_mfma_f32_16x16x32_bf16 v[120:123], v[28:31], a[200:203], v[120:123]
    v_mfma_f32_16x16x32_bf16 v[124:127], v[28:31], a[204:207], v[124:127]
    s_waitcnt vmcnt(28) lgkmcnt(3)
    v_mfma_f32_16x16x32_bf16 v[208:211], v[8:11], a[208:211], v[208:211]
    s_waitcnt vmcnt(27)
    ds_read_b128 v[24:27], v7 offset:34816
    v_mfma_f32_16x16x32_bf16 v[212:215], v[8:11], a[212:215], v[212:215]
    s_waitcnt vmcnt(26)
    v_mfma_f32_16x16x32_bf16 v[216:219], v[8:11], a[216:219], v[216:219]
    s_waitcnt vmcnt(25)
    v_mfma_f32_16x16x32_bf16 v[220:223], v[8:11], a[220:223], v[220:223]
    s_waitcnt lgkmcnt(3)
    v_mfma_f32_16x16x32_bf16 v[224:227], v[12:15], a[208:211], v[224:227]
    ds_read_b128 v[28:31], v7 offset:35840
    v_mfma_f32_16x16x32_bf16 v[228:231], v[12:15], a[212:215], v[228:231]
    v_mfma_f32_16x16x32_bf16 v[232:235], v[12:15], a[216:219], v[232:235]
    v_mfma_f32_16x16x32_bf16 v[236:239], v[12:15], a[220:223], v[236:239]
    s_waitcnt lgkmcnt(3)
    v_mfma_f32_16x16x32_bf16 v[64:67], v[16:19], a[208:211], v[64:67]
    ds_read_b128 v[8:11], v4 offset:28672
    v_mfma_f32_16x16x32_bf16 v[68:71], v[16:19], a[212:215], v[68:71]
    v_mfma_f32_16x16x32_bf16 v[72:75], v[16:19], a[216:219], v[72:75]
    v_mfma_f32_16x16x32_bf16 v[76:79], v[16:19], a[220:223], v[76:79]
    s_waitcnt lgkmcnt(3)
    v_mfma_f32_16x16x32_bf16 v[80:83], v[20:23], a[208:211], v[80:83]
    ds_read_b128 v[12:15], v4 offset:29696
    v_mfma_f32_16x16x32_bf16 v[84:87], v[20:23], a[212:215], v[84:87]
    v_mfma_f32_16x16x32_bf16 v[88:91], v[20:23], a[216:219], v[88:91]
    v_mfma_f32_16x16x32_bf16 v[92:95], v[20:23], a[220:223], v[92:95]
    s_waitcnt lgkmcnt(3)
    v_mfma_f32_16x16x32_bf16 v[96:99], v[24:27], a[208:211], v[96:99]
    ds_read_b128 v[16:19], v7 offset:0
    v_mfma_f32_16x16x32_bf16 v[100:103], v[24:27], a[212:215], v[100:103]
    v_mfma_f32_16x16x32_bf16 v[104:107], v[24:27], a[216:219], v[104:107]
    v_mfma_f32_16x16x32_bf16 v[108:111], v[24:27], a[220:223], v[108:111]
    s_waitcnt lgkmcnt(3)
    v_mfma_f32_16x16x32_bf16 v[112:115], v[28:31], a[208:211], v[112:115]
    ds_read_b128 v[20:23], v7 offset:1024
    v_mfma_f32_16x16x32_bf16 v[116:119], v[28:31], a[212:215], v[116:119]
    v_mfma_f32_16x16x32_bf16 v[120:123], v[28:31], a[216:219], v[120:123]
    v_mfma_f32_16x16x32_bf16 v[124:127], v[28:31], a[220:223], v[124:127]
    s_waitcnt vmcnt(24) lgkmcnt(3)
    v_mfma_f32_16x16x32_bf16 v[208:211], v[8:11], a[224:227], v[208:211]
    s_waitcnt vmcnt(23)
    ds_read_b128 v[24:27], v7 offset:36864
    v_mfma_f32_16x16x32_bf16 v[212:215], v[8:11], a[228:231], v[212:215]
    s_waitcnt vmcnt(22)
    v_mfma_f32_16x16x32_bf16 v[216:219], v[8:11], a[232:235], v[216:219]
    s_waitcnt vmcnt(21)
    v_mfma_f32_16x16x32_bf16 v[220:223], v[8:11], a[236:239], v[220:223]
    s_waitcnt lgkmcnt(3)
    v_mfma_f32_16x16x32_bf16 v[224:227], v[12:15], a[224:227], v[224:227]
    ds_read_b128 v[28:31], v7 offset:37888
    v_mfma_f32_16x16x32_bf16 v[228:231], v[12:15], a[228:231], v[228:231]
    v_mfma_f32_16x16x32_bf16 v[232:235], v[12:15], a[232:235], v[232:235]
    v_mfma_f32_16x16x32_bf16 v[236:239], v[12:15], a[236:239], v[236:239]
    s_waitcnt lgkmcnt(3)
    v_mfma_f32_16x16x32_bf16 v[64:67], v[16:19], a[224:227], v[64:67]
    ds_read_b128 v[8:11], v4 offset:30720
    v_mfma_f32_16x16x32_bf16 v[68:71], v[16:19], a[228:231], v[68:71]
    v_mfma_f32_16x16x32_bf16 v[72:75], v[16:19], a[232:235], v[72:75]
    v_mfma_f32_16x16x32_bf16 v[76:79], v[16:19], a[236:239], v[76:79]
    s_waitcnt lgkmcnt(3)
    v_mfma_f32_16x16x32_bf16 v[80:83], v[20:23], a[224:227], v[80:83]
    ds_read_b128 v[12:15], v4 offset:31744
    v_mfma_f32_16x16x32_bf16 v[84:87], v[20:23], a[228:231], v[84:87]
    v_mfma_f32_16x16x32_bf16 v[88:91], v[20:23], a[232:235], v[88:91]
    v_mfma_f32_16x16x32_bf16 v[92:95], v[20:23], a[236:239], v[92:95]
    s_waitcnt lgkmcnt(3)
    v_mfma_f32_16x16x32_bf16 v[96:99], v[24:27], a[224:227], v[96:99]
    ds_read_b128 v[16:19], v7 offset:2048
    v_mfma_f32_16x16x32_bf16 v[100:103], v[24:27], a[228:231], v[100:103]
    v_mfma_f32_16x16x32_bf16 v[104:107], v[24:27], a[232:235], v[104:107]
    v_mfma_f32_16x16x32_bf16 v[108:111], v[24:27], a[236:239], v[108:111]
    s_waitcnt lgkmcnt(3)
    v_mfma_f32_16x16x32_bf16 v[112:115], v[28:31], a[224:227], v[112:115]
    ds_read_b128 v[20:23], v7 offset:3072
    v_mfma_f32_16x16x32_bf16 v[116:119], v[28:31], a[228:231], v[116:119]
    v_mfma_f32_16x16x32_bf16 v[120:123], v[28:31], a[232:235], v[120:123]
    v_mfma_f32_16x16x32_bf16 v[124:127], v[28:31], a[236:239], v[124:127]
    s_waitcnt vmcnt(20) lgkmcnt(3)
    v_mfma_f32_16x16x32_bf16 v[208:211], v[8:11], a[240:243], v[208:211]
    s_waitcnt vmcnt(19)
    ds_read_b128 v[24:27], v7 offset:38912
    v_mfma_f32_16x16x32_bf16 v[212:215], v[8:11], a[244:247], v[212:215]
    s_waitcnt vmcnt(18)
    v_mfma_f32_16x16x32_bf16 v[216:219], v[8:11], a[248:251], v[216:219]
    s_waitcnt vmcnt(17)
    v_mfma_f32_16x16x32_bf16 v[220:223], v[8:11], a[252:255], v[220:223]
    s_waitcnt lgkmcnt(3)
    v_mfma_f32_16x16x32_bf16 v[224:227], v[12:15], a[240:243], v[224:227]
    ds_read_b128 v[28:31], v7 offset:39936
    v_mfma_f32_16x16x32_bf16 v[228:231], v[12:15], a[244:247], v[228:231]
    v_mfma_f32_16x16x32_bf16 v[232:235], v[12:15], a[248:251], v[232:235]
    v_mfma_f32_16x16x32_bf16 v[236:239], v[12:15], a[252:255], v[236:239]
    s_waitcnt lgkmcnt(3)
    v_mfma_f32_16x16x32_bf16 v[64:67], v[16:19], a[240:243], v[64:67]
    ds_read_b128 v[8:11], v4 offset:32768
    v_mfma_f32_16x16x32_bf16 v[68:71], v[16:19], a[244:247], v[68:71]
    v_mfma_f32_16x16x32_bf16 v[72:75], v[16:19], a[248:251], v[72:75]
    v_mfma_f32_16x16x32_bf16 v[76:79], v[16:19], a[252:255], v[76:79]
    s_waitcnt lgkmcnt(3)
    v_mfma_f32_16x16x32_bf16 v[80:83], v[20:23], a[240:243], v[80:83]
    ds_read_b128 v[12:15], v4 offset:33792
    v_mfma_f32_16x16x32_bf16 v[84:87], v[20:23], a[244:247], v[84:87]
    v_mfma_f32_16x16x32_bf16 v[88:91], v[20:23], a[248:251], v[88:91]
    v_mfma_f32_16x16x32_bf16 v[92:95], v[20:23], a[252:255], v[92:95]
    s_waitcnt lgkmcnt(3)
    v_mfma_f32_16x16x32_bf16 v[96:99], v[24:27], a[240:243], v[96:99]
    ds_read_b128 v[16:19], v7 offset:4096
    v_mfma_f32_16x16x32_bf16 v[100:103], v[24:27], a[244:247], v[100:103]
    v_mfma_f32_16x16x32_bf16 v[104:107], v[24:27], a[248:251], v[104:107]
    v_mfma_f32_16x16x32_bf16 v[108:111], v[24:27], a[252:255], v[108:111]
    s_waitcnt lgkmcnt(3)
    v_mfma_f32_16x16x32_bf16 v[112:115], v[28:31], a[240:243], v[112:115]
    ds_read_b128 v[20:23], v7 offset:5120
    v_mfma_f32_16x16x32_bf16 v[116:119], v[28:31], a[244:247], v[116:119]
    v_add_f32 v166, v152, v154
    v_add_f32 v167, v153, v155
    v_mfma_f32_16x16x32_bf16 v[120:123], v[28:31], a[248:251], v[120:123]
    v_add_f32 v166, v166, v156
    v_add_f32 v167, v167, v157
    v_mfma_f32_16x16x32_bf16 v[124:127], v[28:31], a[252:255], v[124:127]
    s_waitcnt vmcnt(16) lgkmcnt(3)
    v_add_f32 v166, v166, v158
    v_add_f32 v167, v167, v159
    v_mfma_f32_16x16x32_bf16 v[208:211], v[8:11], v[32:35], v[208:211]
    s_waitcnt vmcnt(15)
    ds_read_b128 v[24:27], v7 offset:40960
    v_add_f32 v166, v166, v160
    v_mfma_f32_16x16x32_bf16 v[212:215], v[8:11], v[36:39], v[212:215]
    s_waitcnt vmcnt(14)
    v_add_f32 v167, v167, v161
    v_add_f32 v166, v166, v162
    v_mfma_f32_16x16x32_bf16 v[216:219], v[8:11], v[40:43], v[216:219]
    s_waitcnt vmcnt(13)
    v_add_f32 v167, v167, v163
    v_mul_f32 v166, 0xbae38e39, v166
    v_mfma_f32_16x16x32_bf16 v[220:223], v[8:11], v[44:47], v[220:223]
    s_waitcnt lgkmcnt(3)
    v_fmamk_f32 v165, v152, 0x3c2aaaab, v166
    v_mul_f32 v164, v165, v165
    v_mfma_f32_16x16x32_bf16 v[224:227], v[12:15], v[32:35], v[224:227]
    ds_read_b128 v[28:31], v7 offset:41984
    v_fmamk_f32 v165, v154, 0x3c2aaaab, v166
    v_mfma_f32_16x16x32_bf16 v[228:231], v[12:15], v[36:39], v[228:231]
    v_fmac_f32 v164, v165, v165
    v_fmamk_f32 v165, v156, 0x3c2aaaab, v166
    v_mfma_f32_16x16x32_bf16 v[232:235], v[12:15], v[40:43], v[232:235]
    v_fmac_f32 v164, v165, v165
    v_fmamk_f32 v165, v158, 0x3c2aaaab, v166
    v_mfma_f32_16x16x32_bf16 v[236:239], v[12:15], v[44:47], v[236:239]
    s_waitcnt lgkmcnt(3)
    v_fmac_f32 v164, v165, v165
    v_fmamk_f32 v165, v160, 0x3c2aaaab, v166
    v_mfma_f32_16x16x32_bf16 v[64:67], v[16:19], v[32:35], v[64:67]
    ds_read_b128 v[8:11], v4 offset:34816
    v_fmac_f32 v164, v165, v165
    v_mfma_f32_16x16x32_bf16 v[68:71], v[16:19], v[36:39], v[68:71]
    v_fmamk_f32 v165, v162, 0x3c2aaaab, v166
    v_fmac_f32 v164, v165, v165
    v_mfma_f32_16x16x32_bf16 v[72:75], v[16:19], v[40:43], v[72:75]
    v_fmac_f32 v167, 0x42c00000, v164
    v_mov_b32 v165, 0x3727c5ac
    v_mfma_f32_16x16x32_bf16 v[76:79], v[16:19], v[44:47], v[76:79]
    s_waitcnt lgkmcnt(3)
    v_fmac_f32 v165, 0x3ae38e39, v167
    v_rcp_f32 v167, v165
    v_mfma_f32_16x16x32_bf16 v[80:83], v[20:23], v[32:35], v[80:83]
    ds_read_b128 v[12:15], v4 offset:35840
    v_and_b32 v164, 15, v1
    v_mfma_f32_16x16x32_bf16 v[84:87], v[20:23], v[36:39], v[84:87]
    v_lshlrev_b32 v164, 2, v164
    v_mfma_f32_16x16x32_bf16 v[88:91], v[20:23], v[40:43], v[88:91]
    ds_bpermute_b32 v128, v164, v166 offset:0
    ds_bpermute_b32 v132, v164, v167 offset:0
    v_mfma_f32_16x16x32_bf16 v[92:95], v[20:23], v[44:47], v[92:95]
    s_waitcnt lgkmcnt(5)
    ds_bpermute_b32 v129, v164, v166 offset:64
    ds_bpermute_b32 v133, v164, v167 offset:64
    v_mfma_f32_16x16x32_bf16 v[96:99], v[24:27], v[32:35], v[96:99]
    ds_read_b128 v[16:19], v7 offset:6144
    ds_bpermute_b32 v130, v164, v166 offset:128
    v_mfma_f32_16x16x32_bf16 v[100:103], v[24:27], v[36:39], v[100:103]
    ds_bpermute_b32 v134, v164, v167 offset:128
    ds_bpermute_b32 v131, v164, v166 offset:192
    v_mfma_f32_16x16x32_bf16 v[104:107], v[24:27], v[40:43], v[104:107]
    ds_bpermute_b32 v135, v164, v167 offset:192
    v_mfma_f32_16x16x32_bf16 v[108:111], v[24:27], v[44:47], v[108:111]
    s_waitcnt lgkmcnt(11)
    v_mfma_f32_16x16x32_bf16 v[112:115], v[28:31], v[32:35], v[112:115]
    ds_read_b128 v[20:23], v7 offset:7168
    v_mfma_f32_16x16x32_bf16 v[116:119], v[28:31], v[36:39], v[116:119]
    v_mfma_f32_16x16x32_bf16 v[120:123], v[28:31], v[40:43], v[120:123]
    v_mfma_f32_16x16x32_bf16 v[124:127], v[28:31], v[44:47], v[124:127]
    s_waitcnt vmcnt(3) lgkmcnt(11)
    v_mfma_f32_16x16x32_bf16 v[208:211], v[8:11], v[48:51], v[208:211]
    s_waitcnt vmcnt(2)
    ds_read_b128 v[24:27], v7 offset:43008
    v_mfma_f32_16x16x32_bf16 v[212:215], v[8:11], v[52:55], v[212:215]
    s_waitcnt vmcnt(1)
    v_mfma_f32_16x16x32_bf16 v[216:219], v[8:11], v[56:59], v[216:219]
    s_waitcnt vmcnt(0)
    v_mfma_f32_16x16x32_bf16 v[220:223], v[8:11], v[60:63], v[220:223]
    s_waitcnt lgkmcnt(11)
    ds_read_b128 v[136:139], v5 offset:128
    ds_read_b128 v[140:143], v5 offset:192
    v_mfma_f32_16x16x32_bf16 v[224:227], v[12:15], v[48:51], v[224:227]
    ds_read_b128 v[28:31], v7 offset:44032
    ds_read_b128 v[144:147], v5 offset:256
    v_mfma_f32_16x16x32_bf16 v[228:231], v[12:15], v[52:55], v[228:231]
    ds_read_b128 v[148:151], v5 offset:320
    v_mfma_f32_16x16x32_bf16 v[232:235], v[12:15], v[56:59], v[232:235]
    v_mfma_f32_16x16x32_bf16 v[236:239], v[12:15], v[60:63], v[236:239]
    s_waitcnt lgkmcnt(11)
    v_mfma_f32_16x16x32_bf16 v[64:67], v[16:19], v[48:51], v[64:67]
    s_waitcnt lgkmcnt(0)
    s_barrier
    v_mfma_f32_16x16x32_bf16 v[68:71], v[16:19], v[52:55], v[68:71]
    s_add_u32 m0, s49, 0
    v_add_u32 v4, 0x1b000, v4
    ds_read_b128 v[8:11], v4 offset:0
    v_mfma_f32_16x16x32_bf16 v[72:75], v[16:19], v[56:59], v[72:75]
    s_add_u32 s61, s48, 147456
    v_mfma_f32_16x16x32_bf16 v[76:79], v[16:19], v[60:63], v[76:79]
    v_mfma_f32_16x16x32_bf16 v[80:83], v[20:23], v[48:51], v[80:83]
    ds_read_b128 v[12:15], v4 offset:1024
    v_mfma_f32_16x16x32_bf16 v[84:87], v[20:23], v[52:55], v[84:87]
    buffer_load_dwordx4 v2, s[4:7], s61 offen offset:0 lds
    v_mfma_f32_16x16x32_bf16 v[88:91], v[20:23], v[56:59], v[88:91]
    v_mfma_f32_16x16x32_bf16 v[92:95], v[20:23], v[60:63], v[92:95]
    v_mfma_f32_16x16x32_bf16 v[96:99], v[24:27], v[48:51], v[96:99]
    ds_read_b128 v[16:19], v4 offset:2048
    v_mfma_f32_16x16x32_bf16 v[100:103], v[24:27], v[52:55], v[100:103]
    buffer_load_dwordx4 v2, s[4:7], s61 offen offset:1024 lds
    v_mfma_f32_16x16x32_bf16 v[104:107], v[24:27], v[56:59], v[104:107]
    v_mfma_f32_16x16x32_bf16 v[108:111], v[24:27], v[60:63], v[108:111]
    v_mfma_f32_16x16x32_bf16 v[112:115], v[28:31], v[48:51], v[112:115]
    ds_read_b128 v[20:23], v4 offset:3072
    v_mfma_f32_16x16x32_bf16 v[116:119], v[28:31], v[52:55], v[116:119]
    buffer_load_dwordx4 v2, s[4:7], s61 offen offset:2048 lds
    v_mfma_f32_16x16x32_bf16 v[120:123], v[28:31], v[56:59], v[120:123]
    v_mfma_f32_16x16x32_bf16 v[124:127], v[28:31], v[60:63], v[124:127]
    s_waitcnt lgkmcnt(3)
    v_mfma_f32_16x16x32_bf16 v[192:195], v[8:11], a[0:3], 0
    ds_read_b128 v[24:27], v4 offset:4096
    v_mfma_f32_16x16x32_bf16 v[196:199], v[8:11], a[4:7], 0
    buffer_load_dwordx4 v2, s[4:7], s61 offen offset:3072 lds
    v_mfma_f32_16x16x32_bf16 v[200:203], v[8:11], a[8:11], 0
    s_add_u32 m0, s49, 4096
    s_add_u32 s61, s48, 151552
    v_mfma_f32_16x16x32_bf16 v[204:207], v[8:11], a[12:15], 0
    s_waitcnt lgkmcnt(3)
    v_mfma_f32_16x16x32_bf16 v[152:155], v[12:15], a[0:3], 0
    ds_read_b128 v[28:31], v4 offset:5120
    v_mfma_f32_16x16x32_bf16 v[156:159], v[12:15], a[4:7], 0
    buffer_load_dwordx4 v2, s[4:7], s61 offen offset:0 lds
    v_mfma_f32_16x16x32_bf16 v[160:163], v[12:15], a[8:11], 0
    v_fmac_f32 v64, v136, v128
    v_fmac_f32 v65, v137, v128
    v_mfma_f32_16x16x32_bf16 v[164:167], v[12:15], a[12:15], 0
    s_waitcnt lgkmcnt(3)
    v_fmac_f32 v66, v138, v128
    v_fmac_f32 v67, v139, v128
    v_mfma_f32_16x16x32_bf16 v[192:195], v[16:19], a[16:19], v[192:195]
    ds_read_b128 v[8:11], v4 offset:6144
    v_fmac_f32 v80, v140, v128
    v_mfma_f32_16x16x32_bf16 v[196:199], v[16:19], a[20:23], v[196:199]
    buffer_load_dwordx4 v2, s[4:7], s61 offen offset:1024 lds
    v_mfma_f32_16x16x32_bf16 v[200:203], v[16:19], a[24:27], v[200:203]
    v_fmac_f32 v81, v141, v128
    v_fmac_f32 v82, v142, v128
    v_mfma_f32_16x16x32_bf16 v[204:207], v[16:19], a[28:31], v[204:207]
    s_waitcnt lgkmcnt(3)
    v_fmac_f32 v83, v143, v128
    v_mul_f32 v64, v64, v132
    v_mfma_f32_16x16x32_bf16 v[152:155], v[20:23], a[16:19], v[152:155]
    ds_read_b128 v[12:15], v4 offset:7168
    v_mul_f32 v65, v65, v132
    v_mfma_f32_16x16x32_bf16 v[156:159], v[20:23], a[20:23], v[156:159]
    buffer_load_dwordx4 v2, s[4:7], s61 offen offset:2048 lds
    v_mfma_f32_16x16x32_bf16 v[160:163], v[20:23], a[24:27], v[160:163]
    v_mul_f32 v66, v66, v132
    v_mul_f32 v67, v67, v132
    v_mfma_f32_16x16x32_bf16 v[164:167], v[20:23], a[28:31], v[164:167]
    s_waitcnt lgkmcnt(3)
    v_mul_f32 v64, v64, v80
    v_mul_f32 v65, v65, v81
    v_mfma_f32_16x16x32_bf16 v[192:195], v[24:27], a[32:35], v[192:195]
    ds_read_b128 v[16:19], v4 offset:8192
    v_mul_f32 v66, v66, v82
    v_mfma_f32_16x16x32_bf16 v[196:199], v[24:27], a[36:39], v[196:199]
    buffer_load_dwordx4 v2, s[4:7], s61 offen offset:3072 lds
    v_mfma_f32_16x16x32_bf16 v[200:203], v[24:27], a[40:43], v[200:203]
    s_add_u32 m0, s49, 8192
    s_add_u32 s61, s48, 155648
    v_mul_f32 v67, v67, v83
    v_mfma_f32_16x16x32_bf16 v[204:207], v[24:27], a[44:47], v[204:207]
    s_waitcnt lgkmcnt(3)
    v_cvt_pk_bf16_f32 v176, v64, v65
    v_cvt_pk_bf16_f32 v177, v66, v67
    v_mfma_f32_16x16x32_bf16 v[152:155], v[28:31], a[32:35], v[152:155]
    ds_read_b128 v[20:23], v4 offset:9216
    v_fmac_f32 v68, v136, v129
    v_mfma_f32_16x16x32_bf16 v[156:159], v[28:31], a[36:39], v[156:159]
    buffer_load_dwordx4 v2, s[4:7], s61 offen offset:0 lds
    v_mfma_f32_16x16x32_bf16 v[160:163], v[28:31], a[40:43], v[160:163]
    s_add_u32 m0, s49, 36864
    s_add_u32 s61, s48, 184320
    v_fmac_f32 v69, v137, v129
    v_mfma_f32_16x16x32_bf16 v[164:167], v[28:31], a[44:47], v[164:167]
    s_waitcnt lgkmcnt(3)
    v_fmac_f32 v70, v138, v129
    v_fmac_f32 v71, v139, v129
    v_mfma_f32_16x16x32_bf16 v[192:195], v[8:11], a[48:51], v[192:195]
    ds_read_b128 v[24:27], v4 offset:10240
    v_fmac_f32 v84, v140, v129
    v_mfma_f32_16x16x32_bf16 v[196:199], v[8:11], a[52:55], v[196:199]
    buffer_load_dwordx4 v2, s[4:7], s61 offen offset:0 lds
    v_mfma_f32_16x16x32_bf16 v[200:203], v[8:11], a[56:59], v[200:203]
    v_fmac_f32 v85, v141, v129
    v_fmac_f32 v86, v142, v129
    v_mfma_f32_16x16x32_bf16 v[204:207], v[8:11], a[60:63], v[204:207]
    s_waitcnt lgkmcnt(3)
    v_fmac_f32 v87, v143, v129
    v_mul_f32 v68, v68, v133
    v_mfma_f32_16x16x32_bf16 v[152:155], v[12:15], a[48:51], v[152:155]
    ds_read_b128 v[28:31], v4 offset:11264
    v_mul_f32 v69, v69, v133
    v_mfma_f32_16x16x32_bf16 v[156:159], v[12:15], a[52:55], v[156:159]
    buffer_load_dwordx4 v2, s[4:7], s61 offen offset:1024 lds
    v_mfma_f32_16x16x32_bf16 v[160:163], v[12:15], a[56:59], v[160:163]
    v_mul_f32 v70, v70, v133
    v_mul_f32 v71, v71, v133
    v_mfma_f32_16x16x32_bf16 v[164:167], v[12:15], a[60:63], v[164:167]
    s_waitcnt lgkmcnt(3)
    v_mul_f32 v68, v68, v84
    v_mul_f32 v69, v69, v85
    v_mfma_f32_16x16x32_bf16 v[192:195], v[16:19], a[64:67], v[192:195]
    ds_read_b128 v[8:11], v4 offset:12288
    v_mul_f32 v70, v70, v86
    v_mfma_f32_16x16x32_bf16 v[196:199], v[16:19], a[68:71], v[196:199]
    buffer_load_dwordx4 v2, s[4:7], s61 offen offset:2048 lds
    v_mfma_f32_16x16x32_bf16 v[200:203], v[16:19], a[72:75], v[200:203]
    v_mul_f32 v71, v71, v87
    v_cvt_pk_bf16_f32 v180, v68, v69
    v_mfma_f32_16x16x32_bf16 v[204:207], v[16:19], a[76:79], v[204:207]
    s_waitcnt lgkmcnt(3)
    v_cvt_pk_bf16_f32 v181, v70, v71
    v_fmac_f32 v72, v136, v130
    v_mfma_f32_16x16x32_bf16 v[152:155], v[20:23], a[64:67], v[152:155]
    ds_read_b128 v[12:15], v4 offset:13312
    v_fmac_f32 v73, v137, v130
    v_mfma_f32_16x16x32_bf16 v[156:159], v[20:23], a[68:71], v[156:159]
    buffer_load_dwordx4 v2, s[4:7], s61 offen offset:3072 lds
    v_mfma_f32_16x16x32_bf16 v[160:163], v[20:23], a[72:75], v[160:163]
    s_add_u32 m0, s49, 40960
    s_add_u32 s61, s48, 188416
    v_fmac_f32 v74, v138, v130
    v_mfma_f32_16x16x32_bf16 v[164:167], v[20:23], a[76:79], v[164:167]
    s_waitcnt lgkmcnt(3)
    v_fmac_f32 v75, v139, v130
    v_fmac_f32 v88, v140, v130
    v_mfma_f32_16x16x32_bf16 v[192:195], v[24:27], a[80:83], v[192:195]
    ds_read_b128 v[16:19], v4 offset:14336
    v_fmac_f32 v89, v141, v130
    v_mfma_f32_16x16x32_bf16 v[196:199], v[24:27], a[84:87], v[196:199]
    buffer_load_dwordx4 v2, s[4:7], s61 offen offset:0 lds
    v_mfma_f32_16x16x32_bf16 v[200:203], v[24:27], a[88:91], v[200:203]
    v_fmac_f32 v90, v142, v130
    v_fmac_f32 v91, v143, v130
    v_mfma_f32_16x16x32_bf16 v[204:207], v[24:27], a[92:95], v[204:207]
    s_waitcnt lgkmcnt(3)
    v_mul_f32 v72, v72, v134
    v_mul_f32 v73, v73, v134
    v_mfma_f32_16x16x32_bf16 v[152:155], v[28:31], a[80:83], v[152:155]
    ds_read_b128 v[20:23], v4 offset:15360
    v_mul_f32 v74, v74, v134
    v_mfma_f32_16x16x32_bf16 v[156:159], v[28:31], a[84:87], v[156:159]
    buffer_load_dwordx4 v2, s[4:7], s61 offen offset:1024 lds
    v_mfma_f32_16x16x32_bf16 v[160:163], v[28:31], a[88:91], v[160:163]
    v_mul_f32 v75, v75, v134
    v_mul_f32 v72, v72, v88
    v_mfma_f32_16x16x32_bf16 v[164:167], v[28:31], a[92:95], v[164:167]
    s_waitcnt lgkmcnt(3)
    v_mul_f32 v73, v73, v89
    v_mul_f32 v74, v74, v90
    v_mfma_f32_16x16x32_bf16 v[192:195], v[8:11], a[96:99], v[192:195]
    ds_read_b128 v[24:27], v4 offset:16384
    v_mul_f32 v75, v75, v91
    v_mfma_f32_16x16x32_bf16 v[196:199], v[8:11], a[100:103], v[196:199]
    buffer_load_dwordx4 v2, s[4:7], s61 offen offset:2048 lds
    v_mfma_f32_16x16x32_bf16 v[200:203], v[8:11], a[104:107], v[200:203]
    v_cvt_pk_bf16_f32 v184, v72, v73
    v_cvt_pk_bf16_f32 v185, v74, v75
    v_mfma_f32_16x16x32_bf16 v[204:207], v[8:11], a[108:111], v[204:207]
    s_waitcnt lgkmcnt(3)
    v_fmac_f32 v76, v136, v131
    v_fmac_f32 v77, v137, v131
    v_mfma_f32_16x16x32_bf16 v[152:155], v[12:15], a[96:99], v[152:155]
    ds_read_b128 v[28:31], v4 offset:17408
    v_fmac_f32 v78, v138, v131
    v_mfma_f32_16x16x32_bf16 v[156:159], v[12:15], a[100:103], v[156:159]
    buffer_load_dwordx4 v2, s[4:7], s61 offen offset:3072 lds
    v_mfma_f32_16x16x32_bf16 v[160:163], v[12:15], a[104:107], v[160:163]
    s_add_u32 m0, s49, 45056
    s_add_u32 s61, s48, 192512
    v_fmac_f32 v79, v139, v131
    v_mfma_f32_16x16x32_bf16 v[164:167], v[12:15], a[108:111], v[164:167]
    s_waitcnt lgkmcnt(3)
    v_fmac_f32 v92, v140, v131
    v_fmac_f32 v93, v141, v131
    v_mfma_f32_16x16x32_bf16 v[192:195], v[16:19], a[112:115], v[192:195]
    ds_read_b128 v[8:11], v4 offset:18432
    v_fmac_f32 v94, v142, v131
    v_mfma_f32_16x16x32_bf16 v[196:199], v[16:19], a[116:119], v[196:199]
    buffer_load_dwordx4 v2, s[4:7], s61 offen offset:0 lds
    v_mfma_f32_16x16x32_bf16 v[200:203], v[16:19], a[120:123], v[200:203]
    s_add_u32 m0, s49, 73728
    s_add_u32 s61, s48, 221184
    v_fmac_f32 v95, v143, v131
    v_mfma_f32_16x16x32_bf16 v[204:207], v[16:19], a[124:127], v[204:207]
    s_waitcnt lgkmcnt(3)
    v_mul_f32 v76, v76, v135
    v_mul_f32 v77, v77, v135
    v_mfma_f32_16x16x32_bf16 v[152:155], v[20:23], a[112:115], v[152:155]
    ds_read_b128 v[12:15], v4 offset:19456
    v_mul_f32 v78, v78, v135
    v_mfma_f32_16x16x32_bf16 v[156:159], v[20:23], a[116:119], v[156:159]
    buffer_load_dwordx4 v2, s[4:7], s61 offen offset:0 lds
    v_mfma_f32_16x16x32_bf16 v[160:163], v[20:23], a[120:123], v[160:163]
    v_mul_f32 v79, v79, v135
    v_mul_f32 v76, v76, v92
    v_mfma_f32_16x16x32_bf16 v[164:167], v[20:23], a[124:127], v[164:167]
    s_waitcnt lgkmcnt(3)
    v_mul_f32 v77, v77, v93
    v_mul_f32 v78, v78, v94
    v_mfma_f32_16x16x32_bf16 v[192:195], v[24:27], a[128:131], v[192:195]
    ds_read_b128 v[16:19], v4 offset:20480
    v_mul_f32 v79, v79, v95
    v_mfma_f32_16x16x32_bf16 v[196:199], v[24:27], a[132:135], v[196:199]
    buffer_load_dwordx4 v2, s[4:7], s61 offen offset:1024 lds
    v_mfma_f32_16x16x32_bf16 v[200:203], v[24:27], a[136:139], v[200:203]
    v_cvt_pk_bf16_f32 v188, v76, v77
    v_cvt_pk_bf16_f32 v189, v78, v79
    v_mfma_f32_16x16x32_bf16 v[204:207], v[24:27], a[140:143], v[204:207]
    s_waitcnt lgkmcnt(3)
    ds_read_b128 v[136:139], v5 offset:0
    ds_read_b128 v[140:143], v5 offset:64
    v_mfma_f32_16x16x32_bf16 v[152:155], v[28:31], a[128:131], v[152:155]
    ds_read_b128 v[20:23], v4 offset:21504
    v_fmac_f32 v96, v144, v128
    v_mfma_f32_16x16x32_bf16 v[156:159], v[28:31], a[132:135], v[156:159]
    buffer_load_dwordx4 v2, s[4:7], s61 offen offset:2048 lds
    v_mfma_f32_16x16x32_bf16 v[160:163], v[28:31], a[136:139], v[160:163]
    v_fmac_f32 v97, v145, v128
    v_fmac_f32 v98, v146, v128
    v_mfma_f32_16x16x32_bf16 v[164:167], v[28:31], a[140:143], v[164:167]
    s_waitcnt lgkmcnt(5)
    v_fmac_f32 v99, v147, v128
    v_fmac_f32 v112, v148, v128
    v_mfma_f32_16x16x32_bf16 v[192:195], v[8:11], a[144:147], v[192:195]
    ds_read_b128 v[24:27], v4 offset:22528
    v_fmac_f32 v113, v149, v128
    v_mfma_f32_16x16x32_bf16 v[196:199], v[8:11], a[148:151], v[196:199]
    buffer_load_dwordx4 v2, s[4:7], s61 offen offset:3072 lds
    v_mfma_f32_16x16x32_bf16 v[200:203], v[8:11], a[152:155], v[200:203]
    s_add_u32 m0, s49, 77824
    s_add_u32 s61, s48, 225280
    v_fmac_f32 v114, v150, v128
    v_mfma_f32_16x16x32_bf16 v[204:207], v[8:11], a[156:159], v[204:207]
    s_waitcnt lgkmcnt(5)
    v_fmac_f32 v115, v151, v128
    v_mul_f32 v96, v96, v132
    v_mfma_f32_16x16x32_bf16 v[152:155], v[12:15], a[144:147], v[152:155]
    ds_read_b128 v[28:31], v4 offset:23552
    v_mul_f32 v97, v97, v132
    v_mfma_f32_16x16x32_bf16 v[156:159], v[12:15], a[148:151], v[156:159]
    buffer_load_dwordx4 v2, s[4:7], s61 offen offset:0 lds
    v_mfma_f32_16x16x32_bf16 v[160:163], v[12:15], a[152:155], v[160:163]
    v_mul_f32 v98, v98, v132
    v_mul_f32 v99, v99, v132
    v_mfma_f32_16x16x32_bf16 v[164:167], v[12:15], a[156:159], v[164:167]
    s_waitcnt lgkmcnt(5)
    v_mul_f32 v96, v96, v112
    v_mul_f32 v97, v97, v113
    v_mfma_f32_16x16x32_bf16 v[192:195], v[16:19], a[160:163], v[192:195]
    ds_read_b128 v[8:11], v4 offset:24576
    v_mul_f32 v98, v98, v114
    v_mfma_f32_16x16x32_bf16 v[196:199], v[16:19], a[164:167], v[196:199]
    buffer_load_dwordx4 v2, s[4:7], s61 offen offset:1024 lds
    v_mfma_f32_16x16x32_bf16 v[200:203], v[16:19], a[168:171], v[200:203]
    v_mul_f32 v99, v99, v115
    v_cvt_pk_bf16_f32 v178, v96, v97
    v_mfma_f32_16x16x32_bf16 v[204:207], v[16:19], a[172:175], v[204:207]
    s_waitcnt lgkmcnt(3)
    v_cvt_pk_bf16_f32 v179, v98, v99
    v_mfma_f32_16x16x32_bf16 v[152:155], v[20:23], a[160:163], v[152:155]
    s_add_u32 s66, s51, 0
    ds_read_b128 v[12:15], v4 offset:25600
    v_mfma_f32_16x16x32_bf16 v[156:159], v[20:23], a[164:167], v[156:159]
    buffer_store_dwordx4 v[176:179], v2, s[4:7], s66 offen offset:0 sc1
    v_mfma_f32_16x16x32_bf16 v[160:163], v[20:23], a[168:171], v[160:163]
    v_fmac_f32 v100, v144, v129
    v_fmac_f32 v101, v145, v129
    v_mfma_f32_16x16x32_bf16 v[164:167], v[20:23], a[172:175], v[164:167]
    s_waitcnt lgkmcnt(3)
    v_fmac_f32 v102, v146, v129
    v_fmac_f32 v103, v147, v129
    v_mfma_f32_16x16x32_bf16 v[192:195], v[24:27], a[176:179], v[192:195]
    ds_read_b128 v[16:19], v4 offset:26624
    v_fmac_f32 v116, v148, v129
    v_mfma_f32_16x16x32_bf16 v[196:199], v[24:27], a[180:183], v[196:199]
    buffer_load_dwordx4 v2, s[4:7], s61 offen offset:2048 lds
    v_mfma_f32_16x16x32_bf16 v[200:203], v[24:27], a[184:187], v[200:203]
    v_fmac_f32 v117, v149, v129
    v_fmac_f32 v118, v150, v129
    v_mfma_f32_16x16x32_bf16 v[204:207], v[24:27], a[188:191], v[204:207]
    s_waitcnt lgkmcnt(3)
    v_fmac_f32 v119, v151, v129
    v_mul_f32 v100, v100, v133
    v_mfma_f32_16x16x32_bf16 v[152:155], v[28:31], a[176:179], v[152:155]
    ds_read_b128 v[20:23], v4 offset:27648
    v_mul_f32 v101, v101, v133
    v_mfma_f32_16x16x32_bf16 v[156:159], v[28:31], a[180:183], v[156:159]
    buffer_load_dwordx4 v2, s[4:7], s61 offen offset:3072 lds
    v_mfma_f32_16x16x32_bf16 v[160:163], v[28:31], a[184:187], v[160:163]
    s_add_u32 m0, s49, 81920
    s_add_u32 s61, s48, 229376
    v_mul_f32 v102, v102, v133
    v_mfma_f32_16x16x32_bf16 v[164:167], v[28:31], a[188:191], v[164:167]
    s_waitcnt lgkmcnt(3)
    v_mul_f32 v103, v103, v133
    v_mul_f32 v100, v100, v116
    v_mfma_f32_16x16x32_bf16 v[192:195], v[8:11], a[192:195], v[192:195]
    ds_read_b128 v[24:27], v4 offset:28672
    v_mul_f32 v101, v101, v117
    v_mfma_f32_16x16x32_bf16 v[196:199], v[8:11], a[196:199], v[196:199]
    buffer_load_dwordx4 v2, s[4:7], s61 offen offset:0 lds
    v_mfma_f32_16x16x32_bf16 v[200:203], v[8:11], a[200:203], v[200:203]
    v_mul_f32 v102, v102, v118
    v_mul_f32 v103, v103, v119
    v_mfma_f32_16x16x32_bf16 v[204:207], v[8:11], a[204:207], v[204:207]
    s_waitcnt lgkmcnt(3)
    v_cvt_pk_bf16_f32 v182, v100, v101
    v_cvt_pk_bf16_f32 v183, v102, v103
    v_mfma_f32_16x16x32_bf16 v[152:155], v[12:15], a[192:195], v[152:155]
    ds_read_b128 v[28:31], v4 offset:29696
    v_mfma_f32_16x16x32_bf16 v[156:159], v[12:15], a[196:199], v[156:159]
    buffer_store_dwordx4 v[180:183], v2, s[4:7], s66 offen offset:1024 sc1
    v_mfma_f32_16x16x32_bf16 v[160:163], v[12:15], a[200:203], v[160:163]
    v_fmac_f32 v104, v144, v130
    v_fmac_f32 v105, v145, v130
    v_mfma_f32_16x16x32_bf16 v[164:167], v[12:15], a[204:207], v[164:167]
    s_waitcnt lgkmcnt(3)
    v_fmac_f32 v106, v146, v130
    v_fmac_f32 v107, v147, v130
    v_mfma_f32_16x16x32_bf16 v[192:195], v[16:19], a[208:211], v[192:195]
    ds_read_b128 v[8:11], v4 offset:30720
    v_fmac_f32 v120, v148, v130
    v_mfma_f32_16x16x32_bf16 v[196:199], v[16:19], a[212:215], v[196:199]
    v_fmac_f32 v121, v149, v130
    v_fmac_f32 v122, v150, v130
    v_mfma_f32_16x16x32_bf16 v[200:203], v[16:19], a[216:219], v[200:203]
    v_fmac_f32 v123, v151, v130
    v_mul_f32 v104, v104, v134
    v_mfma_f32_16x16x32_bf16 v[204:207], v[16:19], a[220:223], v[204:207]
    s_waitcnt lgkmcnt(3)
    v_mul_f32 v105, v105, v134
    v_mul_f32 v106, v106, v134
    v_mfma_f32_16x16x32_bf16 v[152:155], v[20:23], a[208:211], v[152:155]
    ds_read_b128 v[12:15], v4 offset:31744
    v_mul_f32 v107, v107, v134
    v_mfma_f32_16x16x32_bf16 v[156:159], v[20:23], a[212:215], v[156:159]
    v_mul_f32 v104, v104, v120
    v_mul_f32 v105, v105, v121
    v_mfma_f32_16x16x32_bf16 v[160:163], v[20:23], a[216:219], v[160:163]
    v_mul_f32 v106, v106, v122
    v_mul_f32 v107, v107, v123
    v_mfma_f32_16x16x32_bf16 v[164:167], v[20:23], a[220:223], v[164:167]
    s_waitcnt lgkmcnt(3)
    v_cvt_pk_bf16_f32 v186, v104, v105
    v_cvt_pk_bf16_f32 v187, v106, v107
    v_mfma_f32_16x16x32_bf16 v[192:195], v[24:27], a[224:227], v[192:195]
    ds_read_b128 v[16:19], v4 offset:32768
    v_mfma_f32_16x16x32_bf16 v[196:199], v[24:27], a[228:231], v[196:199]
    buffer_store_dwordx4 v[184:187], v2, s[4:7], s66 offen offset:2048 sc1
    v_mfma_f32_16x16x32_bf16 v[200:203], v[24:27], a[232:235], v[200:203]
    v_fmac_f32 v108, v144, v131
    v_fmac_f32 v109, v145, v131
    v_mfma_f32_16x16x32_bf16 v[204:207], v[24:27], a[236:239], v[204:207]
    s_waitcnt lgkmcnt(3)
    v_fmac_f32 v110, v146, v131
    v_fmac_f32 v111, v147, v131
    v_mfma_f32_16x16x32_bf16 v[152:155], v[28:31], a[224:227], v[152:155]
    ds_read_b128 v[20:23], v4 offset:33792
    v_fmac_f32 v124, v148, v131
    v_mfma_f32_16x16x32_bf16 v[156:159], v[28:31], a[228:231], v[156:159]
    v_fmac_f32 v125, v149, v131
    v_fmac_f32 v126, v150, v131
    v_mfma_f32_16x16x32_bf16 v[160:163], v[28:31], a[232:235], v[160:163]
    v_fmac_f32 v127, v151, v131
    v_mul_f32 v108, v108, v135
    v_mfma_f32_16x16x32_bf16 v[164:167], v[28:31], a[236:239], v[164:167]
    s_waitcnt lgkmcnt(3)
    v_mul_f32 v109, v109, v135
    v_mul_f32 v110, v110, v135
    v_mfma_f32_16x16x32_bf16 v[192:195], v[8:11], a[240:243], v[192:195]
    ds_read_b128 v[24:27], v4 offset:34816
    v_mul_f32 v111, v111, v135
    v_mfma_f32_16x16x32_bf16 v[196:199], v[8:11], a[244:247], v[196:199]
    v_mul_f32 v108, v108, v124
    v_mul_f32 v109, v109, v125
    v_mfma_f32_16x16x32_bf16 v[200:203], v[8:11], a[248:251], v[200:203]
    v_mul_f32 v110, v110, v126
    v_mul_f32 v111, v111, v127
    v_mfma_f32_16x16x32_bf16 v[204:207], v[8:11], a[252:255], v[204:207]
    s_waitcnt lgkmcnt(3)
    v_cvt_pk_bf16_f32 v190, v108, v109
    v_cvt_pk_bf16_f32 v191, v110, v111
    v_mfma_f32_16x16x32_bf16 v[152:155], v[12:15], a[240:243], v[152:155]
    ds_read_b128 v[28:31], v4 offset:35840
    v_mfma_f32_16x16x32_bf16 v[156:159], v[12:15], a[244:247], v[156:159]
    buffer_store_dwordx4 v[188:191], v2, s[4:7], s66 offen offset:3072 sc1
    v_mfma_f32_16x16x32_bf16 v[160:163], v[12:15], a[248:251], v[160:163]
    ds_read_b128 v[144:147], v5 offset:384
    ds_read_b128 v[148:151], v5 offset:448
    v_mfma_f32_16x16x32_bf16 v[164:167], v[12:15], a[252:255], v[164:167]
    s_waitcnt lgkmcnt(5)
    v_fmac_f32 v208, v136, v128
    v_fmac_f32 v209, v137, v128
    v_mfma_f32_16x16x32_bf16 v[192:195], v[16:19], v[32:35], v[192:195]
    s_waitcnt vmcnt(22)
    s_barrier
    v_add_u32 v4, 0xfffe5000, v4
    v_mfma_f32_16x16x32_bf16 v[196:199], v[16:19], v[36:39], v[196:199]
    ds_read_b128 v[8:11], v4 offset:0
    v_fmac_f32 v210, v138, v128
    v_mfma_f32_16x16x32_bf16 v[200:203], v[16:19], v[40:43], v[200:203]
    v_fmac_f32 v211, v139, v128
    v_fmac_f32 v224, v140, v128
    v_mfma_f32_16x16x32_bf16 v[204:207], v[16:19], v[44:47], v[204:207]
    s_waitcnt lgkmcnt(5)
    v_fmac_f32 v225, v141, v128
    v_fmac_f32 v226, v142, v128
    v_mfma_f32_16x16x32_bf16 v[152:155], v[20:23], v[32:35], v[152:155]
    ds_read_b128 v[12:15], v4 offset:1024
    v_fmac_f32 v227, v143, v128
    v_mfma_f32_16x16x32_bf16 v[156:159], v[20:23], v[36:39], v[156:159]
    v_mul_f32 v208, v208, v132
    v_mul_f32 v209, v209, v132
    v_mfma_f32_16x16x32_bf16 v[160:163], v[20:23], v[40:43], v[160:163]
    v_mul_f32 v210, v210, v132
    v_mul_f32 v211, v211, v132
    v_mfma_f32_16x16x32_bf16 v[164:167], v[20:23], v[44:47], v[164:167]
    s_waitcnt lgkmcnt(5)
    v_mul_f32 v208, v208, v224
    v_mul_f32 v209, v209, v225
    v_mfma_f32_16x16x32_bf16 v[192:195], v[24:27], v[48:51], v[192:195]
    ds_read_b128 v[16:19], v4 offset:2048
    v_mul_f32 v210, v210, v226
    v_mfma_f32_16x16x32_bf16 v[196:199], v[24:27], v[52:55], v[196:199]
    v_mul_f32 v211, v211, v227
    v_cvt_pk_bf16_f32 v240, v208, v209
    v_mfma_f32_16x16x32_bf16 v[200:203], v[24:27], v[56:59], v[200:203]
    v_cvt_pk_bf16_f32 v241, v210, v211
    v_mfma_f32_16x16x32_bf16 v[204:207], v[24:27], v[60:63], v[204:207]
    s_waitcnt lgkmcnt(5)
    s_add_u32 s66, s51, s65
    v_mfma_f32_16x16x32_bf16 v[152:155], v[28:31], v[48:51], v[152:155]
    ds_read_b128 v[20:23], v4 offset:3072
    v_mfma_f32_16x16x32_bf16 v[156:159], v[28:31], v[52:55], v[156:159]
    buffer_store_dwordx2 v[240:241], v3, s[4:7], s66 offen offset:0 sc1
    v_mfma_f32_16x16x32_bf16 v[160:163], v[28:31], v[56:59], v[160:163]
    v_fmac_f32 v212, v136, v129
    v_fmac_f32 v213, v137, v129
    v_mfma_f32_16x16x32_bf16 v[164:167], v[28:31], v[60:63], v[164:167]
    s_waitcnt lgkmcnt(3)
    v_fmac_f32 v214, v138, v129
    v_fmac_f32 v215, v139, v129
    v_mfma_f32_16x16x32_bf16 v[96:99], v[8:11], a[0:3], 0
    ds_read_b128 v[24:27], v4 offset:4096
    v_fmac_f32 v228, v140, v129
    v_mfma_f32_16x16x32_bf16 v[100:103], v[8:11], a[4:7], 0
    v_fmac_f32 v229, v141, v129
    v_fmac_f32 v230, v142, v129
    v_mfma_f32_16x16x32_bf16 v[104:107], v[8:11], a[8:11], 0
    v_fmac_f32 v231, v143, v129
    v_mul_f32 v212, v212, v133
    v_mfma_f32_16x16x32_bf16 v[108:111], v[8:11], a[12:15], 0
    s_waitcnt lgkmcnt(3)
    v_mul_f32 v213, v213, v133
    v_mul_f32 v214, v214, v133
    v_mfma_f32_16x16x32_bf16 v[112:115], v[12:15], a[0:3], 0
    ds_read_b128 v[28:31], v4 offset:5120
    v_mul_f32 v215, v215, v133
    v_mfma_f32_16x16x32_bf16 v[116:119], v[12:15], a[4:7], 0
    v_mul_f32 v212, v212, v228
    v_mul_f32 v213, v213, v229
    v_mfma_f32_16x16x32_bf16 v[120:123], v[12:15], a[8:11], 0
    v_mul_f32 v214, v214, v230
    v_mul_f32 v215, v215, v231
    v_mfma_f32_16x16x32_bf16 v[124:127], v[12:15], a[12:15], 0
    s_waitcnt lgkmcnt(3)
    v_cvt_pk_bf16_f32 v244, v212, v213
    v_cvt_pk_bf16_f32 v245, v214, v215
    v_mfma_f32_16x16x32_bf16 v[96:99], v[16:19], a[16:19], v[96:99]
    ds_read_b128 v[8:11], v4 offset:6144
    v_mfma_f32_16x16x32_bf16 v[100:103], v[16:19], a[20:23], v[100:103]
    buffer_store_dwordx2 v[244:245], v3, s[4:7], s66 offen offset:512 sc1
    v_mfma_f32_16x16x32_bf16 v[104:107], v[16:19], a[24:27], v[104:107]
    v_fmac_f32 v216, v136, v130
    v_fmac_f32 v217, v137, v130
    v_mfma_f32_16x16x32_bf16 v[108:111], v[16:19], a[28:31], v[108:111]
    s_waitcnt lgkmcnt(3)
    v_fmac_f32 v218, v138, v130
    v_fmac_f32 v219, v139, v130
    v_mfma_f32_16x16x32_bf16 v[112:115], v[20:23], a[16:19], v[112:115]
    ds_read_b128 v[12:15], v4 offset:7168
    v_fmac_f32 v232, v140, v130
    v_mfma_f32_16x16x32_bf16 v[116:119], v[20:23], a[20:23], v[116:119]
    v_fmac_f32 v233, v141, v130
    v_fmac_f32 v234, v142, v130
    v_mfma_f32_16x16x32_bf16 v[120:123], v[20:23], a[24:27], v[120:123]
    v_fmac_f32 v235, v143, v130
    v_mul_f32 v216, v216, v134
    v_mfma_f32_16x16x32_bf16 v[124:127], v[20:23], a[28:31], v[124:127]
    s_waitcnt lgkmcnt(3)
    v_mul_f32 v217, v217, v134
    v_mul_f32 v218, v218, v134
    v_mfma_f32_16x16x32_bf16 v[96:99], v[24:27], a[32:35], v[96:99]
    ds_read_b128 v[16:19], v4 offset:8192
    v_mul_f32 v219, v219, v134
    v_mfma_f32_16x16x32_bf16 v[100:103], v[24:27], a[36:39], v[100:103]
    v_mul_f32 v216, v216, v232
    v_mul_f32 v217, v217, v233
    v_mfma_f32_16x16x32_bf16 v[104:107], v[24:27], a[40:43], v[104:107]
    v_mul_f32 v218, v218, v234
    v_mul_f32 v219, v219, v235
    v_mfma_f32_16x16x32_bf16 v[108:111], v[24:27], a[44:47], v[108:111]
    s_waitcnt lgkmcnt(3)
    v_cvt_pk_bf16_f32 v248, v216, v217
    v_cvt_pk_bf16_f32 v249, v218, v219
    v_mfma_f32_16x16x32_bf16 v[112:115], v[28:31], a[32:35], v[112:115]
    ds_read_b128 v[20:23], v4 offset:9216
    v_mfma_f32_16x16x32_bf16 v[116:119], v[28:31], a[36:39], v[116:119]
    buffer_store_dwordx2 v[248:249], v3, s[4:7], s66 offen offset:1024 sc1
    v_mfma_f32_16x16x32_bf16 v[120:123], v[28:31], a[40:43], v[120:123]
    v_fmac_f32 v220, v136, v131
    v_fmac_f32 v221, v137, v131
    v_mfma_f32_16x16x32_bf16 v[124:127], v[28:31], a[44:47], v[124:127]
    s_waitcnt lgkmcnt(3)
    v_fmac_f32 v222, v138, v131
    v_fmac_f32 v223, v139, v131
    v_mfma_f32_16x16x32_bf16 v[96:99], v[8:11], a[48:51], v[96:99]
    ds_read_b128 v[24:27], v4 offset:10240
    v_fmac_f32 v236, v140, v131
    v_mfma_f32_16x16x32_bf16 v[100:103], v[8:11], a[52:55], v[100:103]
    v_fmac_f32 v237, v141, v131
    v_fmac_f32 v238, v142, v131
    v_mfma_f32_16x16x32_bf16 v[104:107], v[8:11], a[56:59], v[104:107]
    v_fmac_f32 v239, v143, v131
    v_mul_f32 v220, v220, v135
    v_mfma_f32_16x16x32_bf16 v[108:111], v[8:11], a[60:63], v[108:111]
    s_waitcnt lgkmcnt(3)
    v_mul_f32 v221, v221, v135
    v_mul_f32 v222, v222, v135
    v_mfma_f32_16x16x32_bf16 v[112:115], v[12:15], a[48:51], v[112:115]
    ds_read_b128 v[28:31], v4 offset:11264
    v_mul_f32 v223, v223, v135
    v_mfma_f32_16x16x32_bf16 v[116:119], v[12:15], a[52:55], v[116:119]
    v_mul_f32 v220, v220, v236
    v_mul_f32 v221, v221, v237
    v_mfma_f32_16x16x32_bf16 v[120:123], v[12:15], a[56:59], v[120:123]
    v_mul_f32 v222, v222, v238
    v_mul_f32 v223, v223, v239
    v_mfma_f32_16x16x32_bf16 v[124:127], v[12:15], a[60:63], v[124:127]
    s_waitcnt lgkmcnt(3)
    v_cvt_pk_bf16_f32 v252, v220, v221
    v_cvt_pk_bf16_f32 v253, v222, v223
    v_mfma_f32_16x16x32_bf16 v[96:99], v[16:19], a[64:67], v[96:99]
    ds_read_b128 v[8:11], v4 offset:12288
    v_mfma_f32_16x16x32_bf16 v[100:103], v[16:19], a[68:71], v[100:103]
    buffer_store_dwordx2 v[252:253], v3, s[4:7], s66 offen offset:1536 sc1
    v_mfma_f32_16x16x32_bf16 v[104:107], v[16:19], a[72:75], v[104:107]
    ds_read_b128 v[136:139], v5 offset:512
    ds_read_b128 v[140:143], v5 offset:576
    v_mfma_f32_16x16x32_bf16 v[108:111], v[16:19], a[76:79], v[108:111]
    s_waitcnt lgkmcnt(5)
    v_fmac_f32 v192, v144, v128
    v_fmac_f32 v193, v145, v128
    v_mfma_f32_16x16x32_bf16 v[112:115], v[20:23], a[64:67], v[112:115]
    ds_read_b128 v[12:15], v4 offset:13312
    v_fmac_f32 v194, v146, v128
    v_mfma_f32_16x16x32_bf16 v[116:119], v[20:23], a[68:71], v[116:119]
    v_fmac_f32 v195, v147, v128
    v_fmac_f32 v152, v148, v128
    v_mfma_f32_16x16x32_bf16 v[120:123], v[20:23], a[72:75], v[120:123]
    v_fmac_f32 v153, v149, v128
    v_fmac_f32 v154, v150, v128
    v_mfma_f32_16x16x32_bf16 v[124:127], v[20:23], a[76:79], v[124:127]
    s_waitcnt lgkmcnt(5)
    v_fmac_f32 v155, v151, v128
    v_mul_f32 v192, v192, v132
    v_mfma_f32_16x16x32_bf16 v[96:99], v[24:27], a[80:83], v[96:99]
    ds_read_b128 v[16:19], v4 offset:14336
    v_mul_f32 v193, v193, v132
    v_mfma_f32_16x16x32_bf16 v[100:103], v[24:27], a[84:87], v[100:103]
    v_mul_f32 v194, v194, v132
    v_mul_f32 v195, v195, v132
    v_mfma_f32_16x16x32_bf16 v[104:107], v[24:27], a[88:91], v[104:107]
    v_mul_f32 v192, v192, v152
    v_mul_f32 v193, v193, v153
    v_mfma_f32_16x16x32_bf16 v[108:111], v[24:27], a[92:95], v[108:111]
    s_waitcnt lgkmcnt(5)
    v_mul_f32 v194, v194, v154
    v_mul_f32 v195, v195, v155
    v_mfma_f32_16x16x32_bf16 v[112:115], v[28:31], a[80:83], v[112:115]
    ds_read_b128 v[20:23], v4 offset:15360
    v_cvt_pk_bf16_f32 v192, v192, v193
    v_mfma_f32_16x16x32_bf16 v[116:119], v[28:31], a[84:87], v[116:119]
    v_cvt_pk_bf16_f32 v193, v194, v195
    v_fmac_f32 v196, v144, v129
    v_mfma_f32_16x16x32_bf16 v[120:123], v[28:31], a[88:91], v[120:123]
    v_fmac_f32 v197, v145, v129
    v_fmac_f32 v198, v146, v129
    v_mfma_f32_16x16x32_bf16 v[124:127], v[28:31], a[92:95], v[124:127]
    s_waitcnt lgkmcnt(5)
    v_fmac_f32 v199, v147, v129
    v_fmac_f32 v156, v148, v129
    v_mfma_f32_16x16x32_bf16 v[96:99], v[8:11], a[96:99], v[96:99]
    ds_read_b128 v[24:27], v4 offset:16384
    v_fmac_f32 v157, v149, v129
    v_mfma_f32_16x16x32_bf16 v[100:103], v[8:11], a[100:103], v[100:103]
    v_fmac_f32 v158, v150, v129
    v_fmac_f32 v159, v151, v129
    v_mfma_f32_16x16x32_bf16 v[104:107], v[8:11], a[104:107], v[104:107]
    v_mul_f32 v196, v196, v133
    v_mul_f32 v197, v197, v133
    v_mfma_f32_16x16x32_bf16 v[108:111], v[8:11], a[108:111], v[108:111]
    s_waitcnt lgkmcnt(3)
    v_mul_f32 v198, v198, v133
    v_mul_f32 v199, v199, v133
    v_mfma_f32_16x16x32_bf16 v[112:115], v[12:15], a[96:99], v[112:115]
    ds_read_b128 v[28:31], v4 offset:17408
    v_mul_f32 v196, v196, v156
    v_mfma_f32_16x16x32_bf16 v[116:119], v[12:15], a[100:103], v[116:119]
    v_mul_f32 v197, v197, v157
    v_mul_f32 v198, v198, v158
    v_mfma_f32_16x16x32_bf16 v[120:123], v[12:15], a[104:107], v[120:123]
    v_mul_f32 v199, v199, v159
    v_cvt_pk_bf16_f32 v196, v196, v197
    v_mfma_f32_16x16x32_bf16 v[124:127], v[12:15], a[108:111], v[124:127]
    s_waitcnt lgkmcnt(3)
    v_cvt_pk_bf16_f32 v197, v198, v199
    v_fmac_f32 v200, v144, v130
    v_mfma_f32_16x16x32_bf16 v[96:99], v[16:19], a[112:115], v[96:99]
    ds_read_b128 v[8:11], v4 offset:18432
    v_fmac_f32 v201, v145, v130
    v_mfma_f32_16x16x32_bf16 v[100:103], v[16:19], a[116:119], v[100:103]
    v_fmac_f32 v202, v146, v130
    v_fmac_f32 v203, v147, v130
    v_mfma_f32_16x16x32_bf16 v[104:107], v[16:19], a[120:123], v[104:107]
    v_fmac_f32 v160, v148, v130
    v_fmac_f32 v161, v149, v130
    v_mfma_f32_16x16x32_bf16 v[108:111], v[16:19], a[124:127], v[108:111]
    s_waitcnt lgkmcnt(3)
    v_fmac_f32 v162, v150, v130
    v_fmac_f32 v163, v151, v130
    v_mfma_f32_16x16x32_bf16 v[112:115], v[20:23], a[112:115], v[112:115]
    ds_read_b128 v[12:15], v4 offset:19456
    v_mul_f32 v200, v200, v134
    v_mfma_f32_16x16x32_bf16 v[116:119], v[20:23], a[116:119], v[116:119]
    v_mul_f32 v201, v201, v134
    v_mul_f32 v202, v202, v134
    v_mfma_f32_16x16x32_bf16 v[120:123], v[20:23], a[120:123], v[120:123]
    v_mul_f32 v203, v203, v134
    v_mul_f32 v200, v200, v160
    v_mfma_f32_16x16x32_bf16 v[124:127], v[20:23], a[124:127], v[124:127]
    s_waitcnt lgkmcnt(3)
    v_mul_f32 v201, v201, v161
    v_mul_f32 v202, v202, v162
    v_mfma_f32_16x16x32_bf16 v[96:99], v[24:27], a[128:131], v[96:99]
    ds_read_b128 v[16:19], v4 offset:20480
    v_mul_f32 v203, v203, v163
    v_mfma_f32_16x16x32_bf16 v[100:103], v[24:27], a[132:135], v[100:103]
    v_min_u32 v0, 17, v1
    v_lshlrev_b32 v0, 3, v0
    v_mfma_f32_16x16x32_bf16 v[104:107], v[24:27], a[136:139], v[104:107]
    s_add_u32 s55, s64, 288
    s_lshl_b32 s55, s55, 2
    s_add_u32 s55, s55, 0x8000000
    v_mfma_f32_16x16x32_bf16 v[108:111], v[24:27], a[140:143], v[108:111]
    s_waitcnt lgkmcnt(3)
    v_lshlrev_b32 v0, 2, v0
    v_cvt_pk_bf16_f32 v200, v200, v201
    v_mfma_f32_16x16x32_bf16 v[112:115], v[28:31], a[128:131], v[112:115]
    ds_read_b128 v[20:23], v4 offset:21504
    v_cvt_pk_bf16_f32 v201, v202, v203
    v_mfma_f32_16x16x32_bf16 v[116:119], v[28:31], a[132:135], v[116:119]
    buffer_load_dwordx2 v[6:7], v0, s[4:7], s55 offen sc1
    v_mfma_f32_16x16x32_bf16 v[120:123], v[28:31], a[136:139], v[120:123]
    v_fmac_f32 v204, v144, v131
    v_fmac_f32 v205, v145, v131
    v_mfma_f32_16x16x32_bf16 v[124:127], v[28:31], a[140:143], v[124:127]
    s_waitcnt lgkmcnt(3)
    v_fmac_f32 v206, v146, v131
    v_fmac_f32 v207, v147, v131
    v_mfma_f32_16x16x32_bf16 v[96:99], v[8:11], a[144:147], v[96:99]
    ds_read_b128 v[24:27], v4 offset:22528
    v_fmac_f32 v164, v148, v131
    v_mfma_f32_16x16x32_bf16 v[100:103], v[8:11], a[148:151], v[100:103]
    v_fmac_f32 v165, v149, v131
    v_fmac_f32 v166, v150, v131
    v_mfma_f32_16x16x32_bf16 v[104:107], v[8:11], a[152:155], v[104:107]
    v_fmac_f32 v167, v151, v131
    v_mul_f32 v204, v204, v135
    v_mfma_f32_16x16x32_bf16 v[108:111], v[8:11], a[156:159], v[108:111]
    s_waitcnt lgkmcnt(3)
    v_mul_f32 v205, v205, v135
    v_mul_f32 v206, v206, v135
    v_mfma_f32_16x16x32_bf16 v[112:115], v[12:15], a[144:147], v[112:115]
    ds_read_b128 v[28:31], v4 offset:23552
    v_mul_f32 v207, v207, v135
    v_mfma_f32_16x16x32_bf16 v[116:119], v[12:15], a[148:151], v[116:119]
    v_mul_f32 v204, v204, v164
    v_mul_f32 v205, v205, v165
    v_mfma_f32_16x16x32_bf16 v[120:123], v[12:15], a[152:155], v[120:123]
    v_mul_f32 v206, v206, v166
    v_mul_f32 v207, v207, v167
    v_mfma_f32_16x16x32_bf16 v[124:127], v[12:15], a[156:159], v[124:127]
    s_waitcnt lgkmcnt(3)
    v_cvt_pk_bf16_f32 v204, v204, v205
    v_cvt_pk_bf16_f32 v205, v206, v207
    v_mfma_f32_16x16x32_bf16 v[96:99], v[16:19], a[160:163], v[96:99]
    ds_read_b128 v[8:11], v4 offset:24576
    ds_read_b128 v[144:147], v5 offset:640
    v_mfma_f32_16x16x32_bf16 v[100:103], v[16:19], a[164:167], v[100:103]
    ds_read_b128 v[148:151], v5 offset:704
    v_mfma_f32_16x16x32_bf16 v[104:107], v[16:19], a[168:171], v[104:107]
    v_mfma_f32_16x16x32_bf16 v[108:111], v[16:19], a[172:175], v[108:111]
    s_waitcnt lgkmcnt(5)
    v_mfma_f32_16x16x32_bf16 v[112:115], v[20:23], a[160:163], v[112:115]
    ds_read_b128 v[12:15], v4 offset:25600
    v_mfma_f32_16x16x32_bf16 v[116:119], v[20:23], a[164:167], v[116:119]
    v_mfma_f32_16x16x32_bf16 v[120:123], v[20:23], a[168:171], v[120:123]
    v_mfma_f32_16x16x32_bf16 v[124:127], v[20:23], a[172:175], v[124:127]
    s_waitcnt lgkmcnt(5)
    v_mfma_f32_16x16x32_bf16 v[96:99], v[24:27], a[176:179], v[96:99]
    ds_read_b128 v[16:19], v4 offset:26624
    v_mfma_f32_16x16x32_bf16 v[100:103], v[24:27], a[180:183], v[100:103]
    v_mfma_f32_16x16x32_bf16 v[104:107], v[24:27], a[184:187], v[104:107]
    v_mfma_f32_16x16x32_bf16 v[108:111], v[24:27], a[188:191], v[108:111]
    s_waitcnt lgkmcnt(5)
    v_mfma_f32_16x16x32_bf16 v[112:115], v[28:31], a[176:179], v[112:115]
    ds_read_b128 v[20:23], v4 offset:27648
    v_mfma_f32_16x16x32_bf16 v[116:119], v[28:31], a[180:183], v[116:119]
    v_mfma_f32_16x16x32_bf16 v[120:123], v[28:31], a[184:187], v[120:123]
    v_mfma_f32_16x16x32_bf16 v[124:127], v[28:31], a[188:191], v[124:127]
    s_waitcnt lgkmcnt(5)
    v_mfma_f32_16x16x32_bf16 v[96:99], v[8:11], a[192:195], v[96:99]
    ds_read_b128 v[24:27], v4 offset:28672
    v_mfma_f32_16x16x32_bf16 v[100:103], v[8:11], a[196:199], v[100:103]
    v_mfma_f32_16x16x32_bf16 v[104:107], v[8:11], a[200:203], v[104:107]
    v_mfma_f32_16x16x32_bf16 v[108:111], v[8:11], a[204:207], v[108:111]
    s_waitcnt lgkmcnt(3)
    v_mfma_f32_16x16x32_bf16 v[112:115], v[12:15], a[192:195], v[112:115]
    ds_read_b128 v[28:31], v4 offset:29696
    v_mfma_f32_16x16x32_bf16 v[116:119], v[12:15], a[196:199], v[116:119]
    v_mfma_f32_16x16x32_bf16 v[120:123], v[12:15], a[200:203], v[120:123]
    v_mfma_f32_16x16x32_bf16 v[124:127], v[12:15], a[204:207], v[124:127]
    s_waitcnt lgkmcnt(3)
    v_mfma_f32_16x16x32_bf16 v[96:99], v[16:19], a[208:211], v[96:99]
    ds_read_b128 v[8:11], v4 offset:30720
    v_mfma_f32_16x16x32_bf16 v[100:103], v[16:19], a[212:215], v[100:103]
    v_mfma_f32_16x16x32_bf16 v[104:107], v[16:19], a[216:219], v[104:107]
    v_mfma_f32_16x16x32_bf16 v[108:111], v[16:19], a[220:223], v[108:111]
    s_waitcnt lgkmcnt(3)
    v_mfma_f32_16x16x32_bf16 v[112:115], v[20:23], a[208:211], v[112:115]
    ds_read_b128 v[12:15], v4 offset:31744
    v_mfma_f32_16x16x32_bf16 v[116:119], v[20:23], a[212:215], v[116:119]
    v_mfma_f32_16x16x32_bf16 v[120:123], v[20:23], a[216:219], v[120:123]
    v_mfma_f32_16x16x32_bf16 v[124:127], v[20:23], a[220:223], v[124:127]
    s_waitcnt lgkmcnt(3)
    v_mfma_f32_16x16x32_bf16 v[96:99], v[24:27], a[224:227], v[96:99]
    ds_read_b128 v[16:19], v4 offset:32768
    v_mfma_f32_16x16x32_bf16 v[100:103], v[24:27], a[228:231], v[100:103]
    v_mfma_f32_16x16x32_bf16 v[104:107], v[24:27], a[232:235], v[104:107]
    v_mfma_f32_16x16x32_bf16 v[108:111], v[24:27], a[236:239], v[108:111]
    s_waitcnt lgkmcnt(3)
    v_mfma_f32_16x16x32_bf16 v[112:115], v[28:31], a[224:227], v[112:115]
    ds_read_b128 v[20:23], v4 offset:33792
    v_mfma_f32_16x16x32_bf16 v[116:119], v[28:31], a[228:231], v[116:119]
    v_mfma_f32_16x16x32_bf16 v[120:123], v[28:31], a[232:235], v[120:123]
    v_mfma_f32_16x16x32_bf16 v[124:127], v[28:31], a[236:239], v[124:127]
    s_waitcnt lgkmcnt(3)
    v_mfma_f32_16x16x32_bf16 v[96:99], v[8:11], a[240:243], v[96:99]
    ds_read_b128 v[24:27], v4 offset:34816
    v_mfma_f32_16x16x32_bf16 v[100:103], v[8:11], a[244:247], v[100:103]
    v_mfma_f32_16x16x32_bf16 v[104:107], v[8:11], a[248:251], v[104:107]
    v_mfma_f32_16x16x32_bf16 v[108:111], v[8:11], a[252:255], v[108:111]
    s_waitcnt lgkmcnt(3)
    v_mfma_f32_16x16x32_bf16 v[112:115], v[12:15], a[240:243], v[112:115]
    ds_read_b128 v[28:31], v4 offset:35840
    v_mfma_f32_16x16x32_bf16 v[116:119], v[12:15], a[244:247], v[116:119]
    s_waitcnt vmcnt(0)
    v_cmp_eq_u64 vcc, s[98:99], v[6:7]
    s_nop 0
    s_cmp_eq_u64 vcc, exec
    s_cbranch_scc0 L_pd_slow_79
L_pd_back_80:
    v_mfma_f32_16x16x32_bf16 v[120:123], v[12:15], a[248:251], v[120:123]
    v_mfma_f32_16x16x32_bf16 v[124:127], v[12:15], a[252:255], v[124:127]
    s_waitcnt lgkmcnt(3)
    s_lshr_b32 s55, s22, 2
    s_lshl_b32 s55, s55, 2
    v_mfma_f32_16x16x32_bf16 v[96:99], v[16:19], v[32:35], v[96:99]
    s_barrier
    v_add_u32 v4, 0x9000, v4
    v_mfma_f32_16x16x32_bf16 v[100:103], v[16:19], v[36:39], v[100:103]
    s_add_u32 m0, s49, 110592
    s_add_u32 s61, s48, 258048
    ds_read_b128 v[8:11], v4 offset:0
    v_mfma_f32_16x16x32_bf16 v[104:107], v[16:19], v[40:43], v[104:107]
    buffer_load_dwordx4 v2, s[4:7], s61 offen offset:0 lds
    v_mfma_f32_16x16x32_bf16 v[108:111], v[16:19], v[44:47], v[108:111]
    s_waitcnt lgkmcnt(3)
    s_add_u32 s55, s55, s20
    s_mul_i32 s55, s55, 5248
    v_mfma_f32_16x16x32_bf16 v[112:115], v[20:23], v[32:35], v[112:115]
    s_mul_i32 s60, s47, 497664
    s_add_u32 s55, s55, s60
    ds_read_b128 v[12:15], v4 offset:1024
    v_mfma_f32_16x16x32_bf16 v[116:119], v[20:23], v[36:39], v[116:119]
    s_add_u32 s55, s55, 4526080
    v_min_u32 v0, 40, v1
    v_lshlrev_b32 v0, 7, v0
    v_mfma_f32_16x16x32_bf16 v[120:123], v[20:23], v[40:43], v[120:123]
    buffer_load_dwordx4 v2, s[4:7], s61 offen offset:1024 lds
    v_mfma_f32_16x16x32_bf16 v[124:127], v[20:23], v[44:47], v[124:127]
    s_waitcnt lgkmcnt(3)
    v_mfma_f32_16x16x32_bf16 v[96:99], v[24:27], v[48:51], v[96:99]
    ds_read_b128 v[16:19], v4 offset:2048
    v_mfma_f32_16x16x32_bf16 v[100:103], v[24:27], v[52:55], v[100:103]
    v_mfma_f32_16x16x32_bf16 v[104:107], v[24:27], v[56:59], v[104:107]
    buffer_load_dwordx4 v2, s[4:7], s61 offen offset:2048 lds
    v_mfma_f32_16x16x32_bf16 v[108:111], v[24:27], v[60:63], v[108:111]
    s_waitcnt lgkmcnt(3)
    v_mfma_f32_16x16x32_bf16 v[112:115], v[28:31], v[48:51], v[112:115]
    ds_read_b128 v[20:23], v4 offset:3072
    v_mfma_f32_16x16x32_bf16 v[116:119], v[28:31], v[52:55], v[116:119]
    v_mfma_f32_16x16x32_bf16 v[120:123], v[28:31], v[56:59], v[120:123]
    buffer_load_dwordx4 v2, s[4:7], s61 offen offset:3072 lds
    v_mfma_f32_16x16x32_bf16 v[124:127], v[28:31], v[60:63], v[124:127]
    s_waitcnt lgkmcnt(3)
    s_add_u32 m0, s49, 114688
    s_add_u32 s61, s48, 262144
    v_mfma_f32_16x16x32_bf16 v[64:67], v[8:11], a[0:3], 0
    ds_read_b128 v[24:27], v4 offset:4096
    v_mfma_f32_16x16x32_bf16 v[68:71], v[8:11], a[4:7], 0
    v_mfma_f32_16x16x32_bf16 v[72:75], v[8:11], a[8:11], 0
    buffer_load_dwordx4 v2, s[4:7], s61 offen offset:0 lds
    v_mfma_f32_16x16x32_bf16 v[76:79], v[8:11], a[12:15], 0
    s_waitcnt lgkmcnt(3)
    v_mfma_f32_16x16x32_bf16 v[80:83], v[12:15], a[0:3], 0
    ds_read_b128 v[28:31], v4 offset:5120
    v_mfma_f32_16x16x32_bf16 v[84:87], v[12:15], a[4:7], 0
    v_fmac_f32 v96, v136, v128
    v_fmac_f32 v97, v137, v128
    v_mfma_f32_16x16x32_bf16 v[88:91], v[12:15], a[8:11], 0
    buffer_load_dwordx4 v2, s[4:7], s61 offen offset:1024 lds
    v_mfma_f32_16x16x32_bf16 v[92:95], v[12:15], a[12:15], 0
    s_waitcnt lgkmcnt(3)
    v_fmac_f32 v98, v138, v128
    v_fmac_f32 v99, v139, v128
    v_mfma_f32_16x16x32_bf16 v[64:67], v[16:19], a[16:19], v[64:67]
    ds_read_b128 v[8:11], v4 offset:6144
    v_fmac_f32 v112, v140, v128
    v_mfma_f32_16x16x32_bf16 v[68:71], v[16:19], a[20:23], v[68:71]
    v_fmac_f32 v113, v141, v128
    v_fmac_f32 v114, v142, v128
    v_mfma_f32_16x16x32_bf16 v[72:75], v[16:19], a[24:27], v[72:75]
    buffer_load_dwordx4 v2, s[4:7], s61 offen offset:2048 lds
    v_mfma_f32_16x16x32_bf16 v[76:79], v[16:19], a[28:31], v[76:79]
    s_waitcnt lgkmcnt(3)
    v_fmac_f32 v115, v143, v128
    v_mul_f32 v96, v96, v132
    v_mfma_f32_16x16x32_bf16 v[80:83], v[20:23], a[16:19], v[80:83]
    ds_read_b128 v[12:15], v4 offset:7168
    v_mul_f32 v97, v97, v132
    v_mfma_f32_16x16x32_bf16 v[84:87], v[20:23], a[20:23], v[84:87]
    v_mul_f32 v98, v98, v132
    v_mul_f32 v99, v99, v132
    v_mfma_f32_16x16x32_bf16 v[88:91], v[20:23], a[24:27], v[88:91]
    buffer_load_dwordx4 v2, s[4:7], s61 offen offset:3072 lds
    v_mfma_f32_16x16x32_bf16 v[92:95], v[20:23], a[28:31], v[92:95]
    s_waitcnt lgkmcnt(3)
    s_add_u32 m0, s49, 118784
    s_add_u32 s61, s48, 266240
    v_mfma_f32_16x16x32_bf16 v[64:67], v[24:27], a[32:35], v[64:67]
    ds_read_b128 v[16:19], v4 offset:8192
    v_mul_f32 v96, v96, v112
    v_mfma_f32_16x16x32_bf16 v[68:71], v[24:27], a[36:39], v[68:71]
    v_mul_f32 v97, v97, v113
    v_mul_f32 v98, v98, v114
    v_mfma_f32_16x16x32_bf16 v[72:75], v[24:27], a[40:43], v[72:75]
    buffer_load_dwordx4 v2, s[4:7], s61 offen offset:0 lds
    v_mfma_f32_16x16x32_bf16 v[76:79], v[24:27], a[44:47], v[76:79]
    s_waitcnt lgkmcnt(3)
    v_mul_f32 v99, v99, v115
    v_cvt_pk_bf16_f32 v194, v96, v97
    v_mfma_f32_16x16x32_bf16 v[80:83], v[28:31], a[32:35], v[80:83]
    ds_read_b128 v[20:23], v4 offset:9216
    v_cvt_pk_bf16_f32 v195, v98, v99
    v_mfma_f32_16x16x32_bf16 v[84:87], v[28:31], a[36:39], v[84:87]
    s_add_u32 s66, s51, 16384
    v_mfma_f32_16x16x32_bf16 v[88:91], v[28:31], a[40:43], v[88:91]
    buffer_store_dwordx4 v[192:195], v2, s[4:7], s66 offen offset:0 sc1
    v_mfma_f32_16x16x32_bf16 v[92:95], v[28:31], a[44:47], v[92:95]
    s_waitcnt lgkmcnt(3)
    v_fmac_f32 v100, v136, v129
    v_fmac_f32 v101, v137, v129
    v_mfma_f32_16x16x32_bf16 v[64:67], v[8:11], a[48:51], v[64:67]
    ds_read_b128 v[24:27], v4 offset:10240
    v_fmac_f32 v102, v138, v129
    v_mfma_f32_16x16x32_bf16 v[68:71], v[8:11], a[52:55], v[68:71]
    v_fmac_f32 v103, v139, v129
    v_fmac_f32 v116, v140, v129
    v_mfma_f32_16x16x32_bf16 v[72:75], v[8:11], a[56:59], v[72:75]
    buffer_load_dword v6, v0, s[4:7], s55 offen
    v_mfma_f32_16x16x32_bf16 v[76:79], v[8:11], a[60:63], v[76:79]
    s_waitcnt lgkmcnt(3)
    v_fmac_f32 v117, v141, v129
    v_fmac_f32 v118, v142, v129
    v_mfma_f32_16x16x32_bf16 v[80:83], v[12:15], a[48:51], v[80:83]
    ds_read_b128 v[28:31], v4 offset:11264
    v_fmac_f32 v119, v143, v129
    v_mfma_f32_16x16x32_bf16 v[84:87], v[12:15], a[52:55], v[84:87]
    v_mul_f32 v100, v100, v133
    v_mul_f32 v101, v101, v133
    v_mfma_f32_16x16x32_bf16 v[88:91], v[12:15], a[56:59], v[88:91]
    v_mul_f32 v102, v102, v133
    v_mul_f32 v103, v103, v133
    v_mfma_f32_16x16x32_bf16 v[92:95], v[12:15], a[60:63], v[92:95]
    s_waitcnt lgkmcnt(3)
    v_mul_f32 v100, v100, v116
    v_mul_f32 v101, v101, v117
    v_mfma_f32_16x16x32_bf16 v[64:67], v[16:19], a[64:67], v[64:67]
    ds_read_b128 v[8:11], v4 offset:12288
    v_mul_f32 v102, v102, v118
    v_mfma_f32_16x16x32_bf16 v[68:71], v[16:19], a[68:71], v[68:71]
    v_mul_f32 v103, v103, v119
    v_cvt_pk_bf16_f32 v198, v100, v101
    v_mfma_f32_16x16x32_bf16 v[72:75], v[16:19], a[72:75], v[72:75]
    v_cvt_pk_bf16_f32 v199, v102, v103
    v_mfma_f32_16x16x32_bf16 v[76:79], v[16:19], a[76:79], v[76:79]
    s_waitcnt lgkmcnt(3)
    v_mfma_f32_16x16x32_bf16 v[80:83], v[20:23], a[64:67], v[80:83]
    ds_read_b128 v[12:15], v4 offset:13312
    v_mfma_f32_16x16x32_bf16 v[84:87], v[20:23], a[68:71], v[84:87]
    buffer_store_dwordx4 v[196:199], v2, s[4:7], s66 offen offset:1024 sc1
    v_mfma_f32_16x16x32_bf16 v[88:91], v[20:23], a[72:75], v[88:91]
    v_fmac_f32 v104, v136, v130
    v_fmac_f32 v105, v137, v130
    v_mfma_f32_16x16x32_bf16 v[92:95], v[20:23], a[76:79], v[92:95]
    s_waitcnt lgkmcnt(3)
    v_fmac_f32 v106, v138, v130
    v_fmac_f32 v107, v139, v130
    v_mfma_f32_16x16x32_bf16 v[64:67], v[24:27], a[80:83], v[64:67]
    ds_read_b128 v[16:19], v4 offset:14336
    v_fmac_f32 v120, v140, v130
    v_mfma_f32_16x16x32_bf16 v[68:71], v[24:27], a[84:87], v[68:71]
    v_fmac_f32 v121, v141, v130
    v_fmac_f32 v122, v142, v130
    v_mfma_f32_16x16x32_bf16 v[72:75], v[24:27], a[88:91], v[72:75]
    v_fmac_f32 v123, v143, v130
    v_mul_f32 v104, v104, v134
    v_mfma_f32_16x16x32_bf16 v[76:79], v[24:27], a[92:95], v[76:79]
    s_waitcnt lgkmcnt(3)
    v_mul_f32 v105, v105, v134
    v_mul_f32 v106, v106, v134
    v_mfma_f32_16x16x32_bf16 v[80:83], v[28:31], a[80:83], v[80:83]
    ds_read_b128 v[20:23], v4 offset:15360
    v_mul_f32 v107, v107, v134
    v_mfma_f32_16x16x32_bf16 v[84:87], v[28:31], a[84:87], v[84:87]
    v_mul_f32 v104, v104, v120
    v_mul_f32 v105, v105, v121
    v_mfma_f32_16x16x32_bf16 v[88:91], v[28:31], a[88:91], v[88:91]
    v_mul_f32 v106, v106, v122
    v_mul_f32 v107, v107, v123
    v_mfma_f32_16x16x32_bf16 v[92:95], v[28:31], a[92:95], v[92:95]
    s_waitcnt lgkmcnt(3)
    v_cvt_pk_bf16_f32 v202, v104, v105
    v_cvt_pk_bf16_f32 v203, v106, v107
    v_mfma_f32_16x16x32_bf16 v[64:67], v[8:11], a[96:99], v[64:67]
    ds_read_b128 v[24:27], v4 offset:16384
    v_mfma_f32_16x16x32_bf16 v[68:71], v[8:11], a[100:103], v[68:71]
    buffer_store_dwordx4 v[200:203], v2, s[4:7], s66 offen offset:2048 sc1
    v_mfma_f32_16x16x32_bf16 v[72:75], v[8:11], a[104:107], v[72:75]
    v_fmac_f32 v108, v136, v131
    v_fmac_f32 v109, v137, v131
    v_mfma_f32_16x16x32_bf16 v[76:79], v[8:11], a[108:111], v[76:79]
    s_waitcnt lgkmcnt(3)
    v_fmac_f32 v110, v138, v131
    v_fmac_f32 v111, v139, v131
    v_mfma_f32_16x16x32_bf16 v[80:83], v[12:15], a[96:99], v[80:83]
    ds_read_b128 v[28:31], v4 offset:17408
    v_fmac_f32 v124, v140, v131
    v_mfma_f32_16x16x32_bf16 v[84:87], v[12:15], a[100:103], v[84:87]
    v_fmac_f32 v125, v141, v131
    v_fmac_f32 v126, v142, v131
    v_mfma_f32_16x16x32_bf16 v[88:91], v[12:15], a[104:107], v[88:91]
    v_fmac_f32 v127, v143, v131
    v_mul_f32 v108, v108, v135
    v_mfma_f32_16x16x32_bf16 v[92:95], v[12:15], a[108:111], v[92:95]
    s_waitcnt lgkmcnt(3)
    v_mul_f32 v109, v109, v135
    v_mul_f32 v110, v110, v135
    v_mfma_f32_16x16x32_bf16 v[64:67], v[16:19], a[112:115], v[64:67]
    ds_read_b128 v[8:11], v4 offset:18432
    v_mul_f32 v111, v111, v135
    v_mfma_f32_16x16x32_bf16 v[68:71], v[16:19], a[116:119], v[68:71]
    v_mul_f32 v108, v108, v124
    v_mul_f32 v109, v109, v125
    v_mfma_f32_16x16x32_bf16 v[72:75], v[16:19], a[120:123], v[72:75]
    v_mul_f32 v110, v110, v126
    v_mul_f32 v111, v111, v127
    v_mfma_f32_16x16x32_bf16 v[76:79], v[16:19], a[124:127], v[76:79]
    s_waitcnt lgkmcnt(3)
    v_cvt_pk_bf16_f32 v206, v108, v109
    v_cvt_pk_bf16_f32 v207, v110, v111
    v_mfma_f32_16x16x32_bf16 v[80:83], v[20:23], a[112:115], v[80:83]
    ds_read_b128 v[12:15], v4 offset:19456
    v_mfma_f32_16x16x32_bf16 v[84:87], v[20:23], a[116:119], v[84:87]
    buffer_store_dwordx4 v[204:207], v2, s[4:7], s66 offen offset:3072 sc1
    v_mfma_f32_16x16x32_bf16 v[88:91], v[20:23], a[120:123], v[88:91]
    ds_read_b128 v[136:139], v5 offset:768
    ds_read_b128 v[140:143], v5 offset:832
    v_mfma_f32_16x16x32_bf16 v[92:95], v[20:23], a[124:127], v[92:95]
    s_waitcnt lgkmcnt(5)
    v_mfma_f32_16x16x32_bf16 v[64:67], v[24:27], a[128:131], v[64:67]
    ds_read_b128 v[16:19], v4 offset:20480
    v_mfma_f32_16x16x32_bf16 v[68:71], v[24:27], a[132:135], v[68:71]
    v_mfma_f32_16x16x32_bf16 v[72:75], v[24:27], a[136:139], v[72:75]
    v_mfma_f32_16x16x32_bf16 v[76:79], v[24:27], a[140:143], v[76:79]
    s_waitcnt lgkmcnt(5)
    v_mfma_f32_16x16x32_bf16 v[80:83], v[28:31], a[128:131], v[80:83]
    ds_read_b128 v[20:23], v4 offset:21504
    v_mfma_f32_16x16x32_bf16 v[84:87], v[28:31], a[132:135], v[84:87]
    v_mfma_f32_16x16x32_bf16 v[88:91], v[28:31], a[136:139], v[88:91]
    v_mfma_f32_16x16x32_bf16 v[92:95], v[28:31], a[140:143], v[92:95]
    s_waitcnt lgkmcnt(5)
    v_mfma_f32_16x16x32_bf16 v[64:67], v[8:11], a[144:147], v[64:67]
    ds_read_b128 v[24:27], v4 offset:22528
    v_mfma_f32_16x16x32_bf16 v[68:71], v[8:11], a[148:151], v[68:71]
    v_mfma_f32_16x16x32_bf16 v[72:75], v[8:11], a[152:155], v[72:75]
    v_mfma_f32_16x16x32_bf16 v[76:79], v[8:11], a[156:159], v[76:79]
    s_waitcnt lgkmcnt(5)
    v_mfma_f32_16x16x32_bf16 v[80:83], v[12:15], a[144:147], v[80:83]
    ds_read_b128 v[28:31], v4 offset:23552
    v_mfma_f32_16x16x32_bf16 v[84:87], v[12:15], a[148:151], v[84:87]
    v_mfma_f32_16x16x32_bf16 v[88:91], v[12:15], a[152:155], v[88:91]
    v_mfma_f32_16x16x32_bf16 v[92:95], v[12:15], a[156:159], v[92:95]
    s_waitcnt lgkmcnt(3)
    v_mfma_f32_16x16x32_bf16 v[64:67], v[16:19], a[160:163], v[64:67]
    ds_read_b128 v[8:11], v4 offset:24576
    v_mfma_f32_16x16x32_bf16 v[68:71], v[16:19], a[164:167], v[68:71]
    v_mfma_f32_16x16x32_bf16 v[72:75], v[16:19], a[168:171], v[72:75]
    v_mfma_f32_16x16x32_bf16 v[76:79], v[16:19], a[172:175], v[76:79]
    s_waitcnt lgkmcnt(3)
    v_mfma_f32_16x16x32_bf16 v[80:83], v[20:23], a[160:163], v[80:83]
    ds_read_b128 v[12:15], v4 offset:25600
    v_mfma_f32_16x16x32_bf16 v[84:87], v[20:23], a[164:167], v[84:87]
    v_mfma_f32_16x16x32_bf16 v[88:91], v[20:23], a[168:171], v[88:91]
    v_mfma_f32_16x16x32_bf16 v[92:95], v[20:23], a[172:175], v[92:95]
    s_waitcnt lgkmcnt(3)
    v_mfma_f32_16x16x32_bf16 v[64:67], v[24:27], a[176:179], v[64:67]
    ds_read_b128 v[16:19], v4 offset:26624
    v_mfma_f32_16x16x32_bf16 v[68:71], v[24:27], a[180:183], v[68:71]
    v_mfma_f32_16x16x32_bf16 v[72:75], v[24:27], a[184:187], v[72:75]
    v_mfma_f32_16x16x32_bf16 v[76:79], v[24:27], a[188:191], v[76:79]
    s_waitcnt lgkmcnt(3)
    v_mfma_f32_16x16x32_bf16 v[80:83], v[28:31], a[176:179], v[80:83]
    ds_read_b128 v[20:23], v4 offset:27648
    v_mfma_f32_16x16x32_bf16 v[84:87], v[28:31], a[180:183], v[84:87]
    v_mfma_f32_16x16x32_bf16 v[88:91], v[28:31], a[184:187], v[88:91]
    v_mfma_f32_16x16x32_bf16 v[92:95], v[28:31], a[188:191], v[92:95]
    s_waitcnt lgkmcnt(3)
    v_mfma_f32_16x16x32_bf16 v[64:67], v[8:11], a[192:195], v[64:67]
    ds_read_b128 v[24:27], v4 offset:28672
    v_mfma_f32_16x16x32_bf16 v[68:71], v[8:11], a[196:199], v[68:71]
    v_mfma_f32_16x16x32_bf16 v[72:75], v[8:11], a[200:203], v[72:75]
    v_mfma_f32_16x16x32_bf16 v[76:79], v[8:11], a[204:207], v[76:79]
    s_waitcnt lgkmcnt(3)
    v_mfma_f32_16x16x32_bf16 v[80:83], v[12:15], a[192:195], v[80:83]
    ds_read_b128 v[28:31], v4 offset:29696
    v_mfma_f32_16x16x32_bf16 v[84:87], v[12:15], a[196:199], v[84:87]
    v_mfma_f32_16x16x32_bf16 v[88:91], v[12:15], a[200:203], v[88:91]
    v_mfma_f32_16x16x32_bf16 v[92:95], v[12:15], a[204:207], v[92:95]
    s_waitcnt lgkmcnt(3)
    v_mfma_f32_16x16x32_bf16 v[64:67], v[16:19], a[208:211], v[64:67]
    ds_read_b128 v[8:11], v4 offset:30720
    v_mfma_f32_16x16x32_bf16 v[68:71], v[16:19], a[212:215], v[68:71]
    v_mfma_f32_16x16x32_bf16 v[72:75], v[16:19], a[216:219], v[72:75]
    v_mfma_f32_16x16x32_bf16 v[76:79], v[16:19], a[220:223], v[76:79]
    s_waitcnt lgkmcnt(3)
    v_mfma_f32_16x16x32_bf16 v[80:83], v[20:23], a[208:211], v[80:83]
    ds_read_b128 v[12:15], v4 offset:31744
    v_mfma_f32_16x16x32_bf16 v[84:87], v[20:23], a[212:215], v[84:87]
    v_mfma_f32_16x16x32_bf16 v[88:91], v[20:23], a[216:219], v[88:91]
    v_mfma_f32_16x16x32_bf16 v[92:95], v[20:23], a[220:223], v[92:95]
    s_waitcnt lgkmcnt(3)
    v_mfma_f32_16x16x32_bf16 v[64:67], v[24:27], a[224:227], v[64:67]
    ds_read_b128 v[16:19], v4 offset:32768
    v_mfma_f32_16x16x32_bf16 v[68:71], v[24:27], a[228:231], v[68:71]
    v_mfma_f32_16x16x32_bf16 v[72:75], v[24:27], a[232:235], v[72:75]
    v_mfma_f32_16x16x32_bf16 v[76:79], v[24:27], a[236:239], v[76:79]
    s_waitcnt lgkmcnt(3)
    v_mfma_f32_16x16x32_bf16 v[80:83], v[28:31], a[224:227], v[80:83]
    ds_read_b128 v[20:23], v4 offset:33792
    v_mfma_f32_16x16x32_bf16 v[84:87], v[28:31], a[228:231], v[84:87]
    v_mfma_f32_16x16x32_bf16 v[88:91], v[28:31], a[232:235], v[88:91]
    v_mfma_f32_16x16x32_bf16 v[92:95], v[28:31], a[236:239], v[92:95]
    s_waitcnt lgkmcnt(3)
    v_mfma_f32_16x16x32_bf16 v[64:67], v[8:11], a[240:243], v[64:67]
    ds_read_b128 v[24:27], v4 offset:34816
    v_mfma_f32_16x16x32_bf16 v[68:71], v[8:11], a[244:247], v[68:71]
    v_mfma_f32_16x16x32_bf16 v[72:75], v[8:11], a[248:251], v[72:75]
    v_mfma_f32_16x16x32_bf16 v[76:79], v[8:11], a[252:255], v[76:79]
    s_waitcnt lgkmcnt(3)
    v_mfma_f32_16x16x32_bf16 v[80:83], v[12:15], a[240:243], v[80:83]
    ds_read_b128 v[28:31], v4 offset:35840
    v_mfma_f32_16x16x32_bf16 v[84:87], v[12:15], a[244:247], v[84:87]
    v_mfma_f32_16x16x32_bf16 v[88:91], v[12:15], a[248:251], v[88:91]
    v_mfma_f32_16x16x32_bf16 v[92:95], v[12:15], a[252:255], v[92:95]
    s_waitcnt lgkmcnt(3)
    v_mfma_f32_16x16x32_bf16 v[64:67], v[16:19], v[32:35], v[64:67]
    s_barrier
    v_add_u32 v4, 0x9000, v4
    v_mfma_f32_16x16x32_bf16 v[68:71], v[16:19], v[36:39], v[68:71]
    s_add_u32 m0, s49, 0
    s_add_u32 s61, s48, 294912
    ds_read_b128 v[8:11], v4 offset:0
    v_mfma_f32_16x16x32_bf16 v[72:75], v[16:19], v[40:43], v[72:75]
    buffer_load_dwordx4 v2, s[4:7], s61 offen offset:0 lds
    v_mfma_f32_16x16x32_bf16 v[76:79], v[16:19], v[44:47], v[76:79]
    s_waitcnt lgkmcnt(3)
    v_mfma_f32_16x16x32_bf16 v[80:83], v[20:23], v[32:35], v[80:83]
    ds_read_b128 v[12:15], v4 offset:1024
    v_mfma_f32_16x16x32_bf16 v[84:87], v[20:23], v[36:39], v[84:87]
    v_mfma_f32_16x16x32_bf16 v[88:91], v[20:23], v[40:43], v[88:91]
    buffer_load_dwordx4 v2, s[4:7], s61 offen offset:1024 lds
    v_mfma_f32_16x16x32_bf16 v[92:95], v[20:23], v[44:47], v[92:95]
    s_waitcnt lgkmcnt(3)
    s_add_u32 s71, s67, 0
    s_waitcnt vmcnt(5)
    v_mov_b32 v6, s98
    v_mfma_f32_16x16x32_bf16 v[64:67], v[24:27], v[48:51], v[64:67]
    ds_read_b128 v[16:19], v4 offset:2048
    v_mov_b32 v7, s99
    v_mfma_f32_16x16x32_bf16 v[68:71], v[24:27], v[52:55], v[68:71]
    s_waitcnt vmcnt(2)
    v_mfma_f32_16x16x32_bf16 v[72:75], v[24:27], v[56:59], v[72:75]
    s_lshl_b32 s71, s71, 2
    s_add_u32 s71, s71, 0x8000000
    s_mov_b64 exec, 1
    buffer_store_dwordx2 v[6:7], off, s[4:7], s71 sc1
    s_mov_b64 exec, -1
    v_mfma_f32_16x16x32_bf16 v[76:79], v[24:27], v[60:63], v[76:79]
    s_waitcnt lgkmcnt(3)
    v_mfma_f32_16x16x32_bf16 v[80:83], v[28:31], v[48:51], v[80:83]
    ds_read_b128 v[20:23], v4 offset:3072
    v_mfma_f32_16x16x32_bf16 v[84:87], v[28:31], v[52:55], v[84:87]
    v_mfma_f32_16x16x32_bf16 v[88:91], v[28:31], v[56:59], v[88:91]
    buffer_load_dwordx4 v2, s[4:7], s61 offen offset:2048 lds
    v_mfma_f32_16x16x32_bf16 v[92:95], v[28:31], v[60:63], v[92:95]
    s_waitcnt lgkmcnt(3)
    v_mfma_f32_16x16x32_bf16 v[96:99], v[8:11], a[0:3], 0
    ds_read_b128 v[24:27], v4 offset:4096
    v_mfma_f32_16x16x32_bf16 v[100:103], v[8:11], a[4:7], 0
    v_mfma_f32_16x16x32_bf16 v[104:107], v[8:11], a[8:11], 0
    buffer_load_dwordx4 v2, s[4:7], s61 offen offset:3072 lds
    v_mfma_f32_16x16x32_bf16 v[108:111], v[8:11], a[12:15], 0
    s_waitcnt lgkmcnt(3)
    s_add_u32 m0, s49, 4096
    s_add_u32 s61, s48, 299008
    v_mfma_f32_16x16x32_bf16 v[112:115], v[12:15], a[0:3], 0
    ds_read_b128 v[28:31], v4 offset:5120
    v_mfma_f32_16x16x32_bf16 v[116:119], v[12:15], a[4:7], 0
    v_fmac_f32 v64, v144, v128
    v_fmac_f32 v65, v145, v128
    v_mfma_f32_16x16x32_bf16 v[120:123], v[12:15], a[8:11], 0
    buffer_load_dwordx4 v2, s[4:7], s61 offen offset:0 lds
    v_mfma_f32_16x16x32_bf16 v[124:127], v[12:15], a[12:15], 0
    s_waitcnt lgkmcnt(3)
    v_fmac_f32 v66, v146, v128
    v_fmac_f32 v67, v147, v128
    v_mfma_f32_16x16x32_bf16 v[96:99], v[16:19], a[16:19], v[96:99]
    ds_read_b128 v[8:11], v4 offset:6144
    v_fmac_f32 v80, v148, v128
    v_mfma_f32_16x16x32_bf16 v[100:103], v[16:19], a[20:23], v[100:103]
    v_fmac_f32 v81, v149, v128
    v_fmac_f32 v82, v150, v128
    v_mfma_f32_16x16x32_bf16 v[104:107], v[16:19], a[24:27], v[104:107]
    buffer_load_dwordx4 v2, s[4:7], s61 offen offset:1024 lds
    v_mfma_f32_16x16x32_bf16 v[108:111], v[16:19], a[28:31], v[108:111]
    s_waitcnt lgkmcnt(3)
    v_fmac_f32 v83, v151, v128
    v_mul_f32 v64, v64, v132
    v_mfma_f32_16x16x32_bf16 v[112:115], v[20:23], a[16:19], v[112:115]
    ds_read_b128 v[12:15], v4 offset:7168
    v_mul_f32 v65, v65, v132
    v_mfma_f32_16x16x32_bf16 v[116:119], v[20:23], a[20:23], v[116:119]
    v_mul_f32 v66, v66, v132
    v_mul_f32 v67, v67, v132
    v_mfma_f32_16x16x32_bf16 v[120:123], v[20:23], a[24:27], v[120:123]
    buffer_load_dwordx4 v2, s[4:7], s61 offen offset:2048 lds
    v_mfma_f32_16x16x32_bf16 v[124:127], v[20:23], a[28:31], v[124:127]
    s_waitcnt lgkmcnt(3)
    v_mul_f32 v64, v64, v80
    v_mul_f32 v65, v65, v81
    v_mfma_f32_16x16x32_bf16 v[96:99], v[24:27], a[32:35], v[96:99]
    ds_read_b128 v[16:19], v4 offset:8192
    v_mul_f32 v66, v66, v82
    v_mfma_f32_16x16x32_bf16 v[100:103], v[24:27], a[36:39], v[100:103]
    v_mul_f32 v67, v67, v83
    v_cvt_pk_bf16_f32 v208, v64, v65
    v_mfma_f32_16x16x32_bf16 v[104:107], v[24:27], a[40:43], v[104:107]
    buffer_load_dwordx4 v2, s[4:7], s61 offen offset:3072 lds
    v_mfma_f32_16x16x32_bf16 v[108:111], v[24:27], a[44:47], v[108:111]
    s_waitcnt lgkmcnt(3)
    s_add_u32 m0, s49, 8192
    s_add_u32 s61, s48, 303104
    v_mfma_f32_16x16x32_bf16 v[112:115], v[28:31], a[32:35], v[112:115]
    ds_read_b128 v[20:23], v4 offset:9216
    v_cvt_pk_bf16_f32 v209, v66, v67
    v_mfma_f32_16x16x32_bf16 v[116:119], v[28:31], a[36:39], v[116:119]
    v_fmac_f32 v68, v144, v129
    v_fmac_f32 v69, v145, v129
    v_mfma_f32_16x16x32_bf16 v[120:123], v[28:31], a[40:43], v[120:123]
    buffer_load_dwordx4 v2, s[4:7], s61 offen offset:0 lds
    v_mfma_f32_16x16x32_bf16 v[124:127], v[28:31], a[44:47], v[124:127]
    s_waitcnt lgkmcnt(3)
    v_fmac_f32 v70, v146, v129
    v_fmac_f32 v71, v147, v129
    v_mfma_f32_16x16x32_bf16 v[96:99], v[8:11], a[48:51], v[96:99]
    ds_read_b128 v[24:27], v4 offset:10240
    v_fmac_f32 v84, v148, v129
    v_mfma_f32_16x16x32_bf16 v[100:103], v[8:11], a[52:55], v[100:103]
    v_fmac_f32 v85, v149, v129
    v_fmac_f32 v86, v150, v129
    v_mfma_f32_16x16x32_bf16 v[104:107], v[8:11], a[56:59], v[104:107]
    v_fmac_f32 v87, v151, v129
    v_mul_f32 v68, v68, v133
    v_mfma_f32_16x16x32_bf16 v[108:111], v[8:11], a[60:63], v[108:111]
    s_waitcnt lgkmcnt(3)
    v_mul_f32 v69, v69, v133
    v_mul_f32 v70, v70, v133
    v_mfma_f32_16x16x32_bf16 v[112:115], v[12:15], a[48:51], v[112:115]
    ds_read_b128 v[28:31], v4 offset:11264
    v_mul_f32 v71, v71, v133
    v_mfma_f32_16x16x32_bf16 v[116:119], v[12:15], a[52:55], v[116:119]
    v_mul_f32 v68, v68, v84
    v_mul_f32 v69, v69, v85
    v_mfma_f32_16x16x32_bf16 v[120:123], v[12:15], a[56:59], v[120:123]
    v_mul_f32 v70, v70, v86
    v_mul_f32 v71, v71, v87
    v_mfma_f32_16x16x32_bf16 v[124:127], v[12:15], a[60:63], v[124:127]
    s_waitcnt lgkmcnt(3)
    v_cvt_pk_bf16_f32 v212, v68, v69
    v_cvt_pk_bf16_f32 v213, v70, v71
    v_mfma_f32_16x16x32_bf16 v[96:99], v[16:19], a[64:67], v[96:99]
    ds_read_b128 v[8:11], v4 offset:12288
    v_fmac_f32 v72, v144, v130
    v_mfma_f32_16x16x32_bf16 v[100:103], v[16:19], a[68:71], v[100:103]
    v_fmac_f32 v73, v145, v130
    v_fmac_f32 v74, v146, v130
    v_mfma_f32_16x16x32_bf16 v[104:107], v[16:19], a[72:75], v[104:107]
    v_fmac_f32 v75, v147, v130
    v_fmac_f32 v88, v148, v130
    v_mfma_f32_16x16x32_bf16 v[108:111], v[16:19], a[76:79], v[108:111]
    s_waitcnt lgkmcnt(3)
    v_fmac_f32 v89, v149, v130
    v_fmac_f32 v90, v150, v130
    v_mfma_f32_16x16x32_bf16 v[112:115], v[20:23], a[64:67], v[112:115]
    ds_read_b128 v[12:15], v4 offset:13312
    v_fmac_f32 v91, v151, v130
    v_mfma_f32_16x16x32_bf16 v[116:119], v[20:23], a[68:71], v[116:119]
    v_mul_f32 v72, v72, v134
    v_mul_f32 v73, v73, v134
    v_mfma_f32_16x16x32_bf16 v[120:123], v[20:23], a[72:75], v[120:123]
    v_mul_f32 v74, v74, v134
    v_mul_f32 v75, v75, v134
    v_mfma_f32_16x16x32_bf16 v[124:127], v[20:23], a[76:79], v[124:127]
    s_waitcnt lgkmcnt(3)
    v_mul_f32 v72, v72, v88
    v_mul_f32 v73, v73, v89
    v_mfma_f32_16x16x32_bf16 v[96:99], v[24:27], a[80:83], v[96:99]
    ds_read_b128 v[16:19], v4 offset:14336
    v_mul_f32 v74, v74, v90
    v_mfma_f32_16x16x32_bf16 v[100:103], v[24:27], a[84:87], v[100:103]
    v_mul_f32 v75, v75, v91
    v_cvt_pk_bf16_f32 v216, v72, v73
    v_mfma_f32_16x16x32_bf16 v[104:107], v[24:27], a[88:91], v[104:107]
    v_cvt_pk_bf16_f32 v217, v74, v75
    v_fmac_f32 v76, v144, v131
    v_mfma_f32_16x16x32_bf16 v[108:111], v[24:27], a[92:95], v[108:111]
    s_waitcnt lgkmcnt(3)
    v_fmac_f32 v77, v145, v131
    v_fmac_f32 v78, v146, v131
    v_mfma_f32_16x16x32_bf16 v[112:115], v[28:31], a[80:83], v[112:115]
    ds_read_b128 v[20:23], v4 offset:15360
    v_fmac_f32 v79, v147, v131
    v_mfma_f32_16x16x32_bf16 v[116:119], v[28:31], a[84:87], v[116:119]
    v_fmac_f32 v92, v148, v131
    v_fmac_f32 v93, v149, v131
    v_mfma_f32_16x16x32_bf16 v[120:123], v[28:31], a[88:91], v[120:123]
    v_fmac_f32 v94, v150, v131
    v_fmac_f32 v95, v151, v131
    v_mfma_f32_16x16x32_bf16 v[124:127], v[28:31], a[92:95], v[124:127]
    s_waitcnt lgkmcnt(3)
    v_mul_f32 v76, v76, v135
    v_mul_f32 v77, v77, v135
    v_mfma_f32_16x16x32_bf16 v[96:99], v[8:11], a[96:99], v[96:99]
    ds_read_b128 v[24:27], v4 offset:16384
    v_mul_f32 v78, v78, v135
    v_mfma_f32_16x16x32_bf16 v[100:103], v[8:11], a[100:103], v[100:103]
    v_mul_f32 v79, v79, v135
    v_mul_f32 v76, v76, v92
    v_mfma_f32_16x16x32_bf16 v[104:107], v[8:11], a[104:107], v[104:107]
    v_mul_f32 v77, v77, v93
    v_mul_f32 v78, v78, v94
    v_mfma_f32_16x16x32_bf16 v[108:111], v[8:11], a[108:111], v[108:111]
    s_waitcnt lgkmcnt(3)
    v_mul_f32 v79, v79, v95
    v_cvt_pk_bf16_f32 v220, v76, v77
    v_mfma_f32_16x16x32_bf16 v[112:115], v[12:15], a[96:99], v[112:115]
    ds_read_b128 v[28:31], v4 offset:17408
    v_cvt_pk_bf16_f32 v221, v78, v79
    v_mfma_f32_16x16x32_bf16 v[116:119], v[12:15], a[100:103], v[116:119]
    ds_read_b128 v[144:147], v5 offset:896
    ds_read_b128 v[148:151], v5 offset:960
    v_mfma_f32_16x16x32_bf16 v[120:123], v[12:15], a[104:107], v[120:123]
    v_mfma_f32_16x16x32_bf16 v[124:127], v[12:15], a[108:111], v[124:127]
    s_waitcnt lgkmcnt(5)
    v_mfma_f32_16x16x32_bf16 v[96:99], v[16:19], a[112:115], v[96:99]
    ds_read_b128 v[8:11], v4 offset:18432
    v_mfma_f32_16x16x32_bf16 v[100:103], v[16:19], a[116:119], v[100:103]
    v_mfma_f32_16x16x32_bf16 v[104:107], v[16:19], a[120:123], v[104:107]
    v_mfma_f32_16x16x32_bf16 v[108:111], v[16:19], a[124:127], v[108:111]
    s_waitcnt lgkmcnt(5)
    v_mfma_f32_16x16x32_bf16 v[112:115], v[20:23], a[112:115], v[112:115]
    ds_read_b128 v[12:15], v4 offset:19456
    v_mfma_f32_16x16x32_bf16 v[116:119], v[20:23], a[116:119], v[116:119]
    v_mfma_f32_16x16x32_bf16 v[120:123], v[20:23], a[120:123], v[120:123]
    v_mfma_f32_16x16x32_bf16 v[124:127], v[20:23], a[124:127], v[124:127]
    s_waitcnt lgkmcnt(5)
    v_mfma_f32_16x16x32_bf16 v[96:99], v[24:27], a[128:131], v[96:99]
    ds_read_b128 v[16:19], v4 offset:20480
    v_mfma_f32_16x16x32_bf16 v[100:103], v[24:27], a[132:135], v[100:103]
    v_mfma_f32_16x16x32_bf16 v[104:107], v[24:27], a[136:139], v[104:107]
    v_mfma_f32_16x16x32_bf16 v[108:111], v[24:27], a[140:143], v[108:111]
    s_waitcnt lgkmcnt(5)
    v_mfma_f32_16x16x32_bf16 v[112:115], v[28:31], a[128:131], v[112:115]
    ds_read_b128 v[20:23], v4 offset:21504
    v_mfma_f32_16x16x32_bf16 v[116:119], v[28:31], a[132:135], v[116:119]
    v_mfma_f32_16x16x32_bf16 v[120:123], v[28:31], a[136:139], v[120:123]
    v_mfma_f32_16x16x32_bf16 v[124:127], v[28:31], a[140:143], v[124:127]
    s_waitcnt lgkmcnt(3)
    v_mfma_f32_16x16x32_bf16 v[96:99], v[8:11], a[144:147], v[96:99]
    ds_read_b128 v[24:27], v4 offset:22528
    v_mfma_f32_16x16x32_bf16 v[100:103], v[8:11], a[148:151], v[100:103]
    v_mfma_f32_16x16x32_bf16 v[104:107], v[8:11], a[152:155], v[104:107]
    v_mfma_f32_16x16x32_bf16 v[108:111], v[8:11], a[156:159], v[108:111]
    s_waitcnt lgkmcnt(3)
    v_mfma_f32_16x16x32_bf16 v[112:115], v[12:15], a[144:147], v[112:115]
    ds_read_b128 v[28:31], v4 offset:23552
    v_mfma_f32_16x16x32_bf16 v[116:119], v[12:15], a[148:151], v[116:119]
    v_mfma_f32_16x16x32_bf16 v[120:123], v[12:15], a[152:155], v[120:123]
    v_mfma_f32_16x16x32_bf16 v[124:127], v[12:15], a[156:159], v[124:127]
    s_waitcnt lgkmcnt(3)
    v_mfma_f32_16x16x32_bf16 v[96:99], v[16:19], a[160:163], v[96:99]
    ds_read_b128 v[8:11], v4 offset:24576
    v_mfma_f32_16x16x32_bf16 v[100:103], v[16:19], a[164:167], v[100:103]
    v_mfma_f32_16x16x32_bf16 v[104:107], v[16:19], a[168:171], v[104:107]
    v_mfma_f32_16x16x32_bf16 v[108:111], v[16:19], a[172:175], v[108:111]
    s_waitcnt lgkmcnt(3)
    v_mfma_f32_16x16x32_bf16 v[112:115], v[20:23], a[160:163], v[112:115]
    ds_read_b128 v[12:15], v4 offset:25600
    v_mfma_f32_16x16x32_bf16 v[116:119], v[20:23], a[164:167], v[116:119]
    v_mfma_f32_16x16x32_bf16 v[120:123], v[20:23], a[168:171], v[120:123]
    v_mfma_f32_16x16x32_bf16 v[124:127], v[20:23], a[172:175], v[124:127]
    s_waitcnt lgkmcnt(3)
    v_mfma_f32_16x16x32_bf16 v[96:99], v[24:27], a[176:179], v[96:99]
    ds_read_b128 v[16:19], v4 offset:26624
    v_mfma_f32_16x16x32_bf16 v[100:103], v[24:27], a[180:183], v[100:103]
    v_mfma_f32_16x16x32_bf16 v[104:107], v[24:27], a[184:187], v[104:107]
    v_mfma_f32_16x16x32_bf16 v[108:111], v[24:27], a[188:191], v[108:111]
    s_waitcnt lgkmcnt(3)
    v_mfma_f32_16x16x32_bf16 v[112:115], v[28:31], a[176:179], v[112:115]
    ds_read_b128 v[20:23], v4 offset:27648
    v_mfma_f32_16x16x32_bf16 v[116:119], v[28:31], a[180:183], v[116:119]
    v_mfma_f32_16x16x32_bf16 v[120:123], v[28:31], a[184:187], v[120:123]
    v_mfma_f32_16x16x32_bf16 v[124:127], v[28:31], a[188:191], v[124:127]
    s_waitcnt lgkmcnt(3)
    v_mfma_f32_16x16x32_bf16 v[96:99], v[8:11], a[192:195], v[96:99]
    ds_read_b128 v[24:27], v4 offset:28672
    v_mfma_f32_16x16x32_bf16 v[100:103], v[8:11], a[196:199], v[100:103]
    v_mfma_f32_16x16x32_bf16 v[104:107], v[8:11], a[200:203], v[104:107]
    v_mfma_f32_16x16x32_bf16 v[108:111], v[8:11], a[204:207], v[108:111]
    s_waitcnt lgkmcnt(3)
    v_mfma_f32_16x16x32_bf16 v[112:115], v[12:15], a[192:195], v[112:115]
    ds_read_b128 v[28:31], v4 offset:29696
    v_mfma_f32_16x16x32_bf16 v[116:119], v[12:15], a[196:199], v[116:119]
    v_mfma_f32_16x16x32_bf16 v[120:123], v[12:15], a[200:203], v[120:123]
    v_mfma_f32_16x16x32_bf16 v[124:127], v[12:15], a[204:207], v[124:127]
    s_waitcnt lgkmcnt(3)
    v_mfma_f32_16x16x32_bf16 v[96:99], v[16:19], a[208:211], v[96:99]
    ds_read_b128 v[8:11], v4 offset:30720
    v_mfma_f32_16x16x32_bf16 v[100:103], v[16:19], a[212:215], v[100:103]
    v_mfma_f32_16x16x32_bf16 v[104:107], v[16:19], a[216:219], v[104:107]
    v_mfma_f32_16x16x32_bf16 v[108:111], v[16:19], a[220:223], v[108:111]
    s_waitcnt lgkmcnt(3)
    v_mfma_f32_16x16x32_bf16 v[112:115], v[20:23], a[208:211], v[112:115]
    ds_read_b128 v[12:15], v4 offset:31744
    v_mfma_f32_16x16x32_bf16 v[116:119], v[20:23], a[212:215], v[116:119]
    v_mfma_f32_16x16x32_bf16 v[120:123], v[20:23], a[216:219], v[120:123]
    v_mfma_f32_16x16x32_bf16 v[124:127], v[20:23], a[220:223], v[124:127]
    s_waitcnt lgkmcnt(3)
    v_mfma_f32_16x16x32_bf16 v[96:99], v[24:27], a[224:227], v[96:99]
    ds_read_b128 v[16:19], v4 offset:32768
    v_mfma_f32_16x16x32_bf16 v[100:103], v[24:27], a[228:231], v[100:103]
    v_mfma_f32_16x16x32_bf16 v[104:107], v[24:27], a[232:235], v[104:107]
    v_mfma_f32_16x16x32_bf16 v[108:111], v[24:27], a[236:239], v[108:111]
    s_waitcnt lgkmcnt(3)
    v_mfma_f32_16x16x32_bf16 v[112:115], v[28:31], a[224:227], v[112:115]
    ds_read_b128 v[20:23], v4 offset:33792
    v_mfma_f32_16x16x32_bf16 v[116:119], v[28:31], a[228:231], v[116:119]
    v_mfma_f32_16x16x32_bf16 v[120:123], v[28:31], a[232:235], v[120:123]
    v_mfma_f32_16x16x32_bf16 v[124:127], v[28:31], a[236:239], v[124:127]
    s_waitcnt lgkmcnt(3)
    v_mfma_f32_16x16x32_bf16 v[96:99], v[8:11], a[240:243], v[96:99]
    ds_read_b128 v[24:27], v4 offset:34816
    v_mfma_f32_16x16x32_bf16 v[100:103], v[8:11], a[244:247], v[100:103]
    v_mfma_f32_16x16x32_bf16 v[104:107], v[8:11], a[248:251], v[104:107]
    v_mfma_f32_16x16x32_bf16 v[108:111], v[8:11], a[252:255], v[108:111]
    s_waitcnt lgkmcnt(3)
    v_mfma_f32_16x16x32_bf16 v[112:115], v[12:15], a[240:243], v[112:115]
    ds_read_b128 v[28:31], v4 offset:35840
    v_mfma_f32_16x16x32_bf16 v[116:119], v[12:15], a[244:247], v[116:119]
    v_mfma_f32_16x16x32_bf16 v[120:123], v[12:15], a[248:251], v[120:123]
    v_mfma_f32_16x16x32_bf16 v[124:127], v[12:15], a[252:255], v[124:127]
    s_waitcnt lgkmcnt(3)
    v_mfma_f32_16x16x32_bf16 v[96:99], v[16:19], v[32:35], v[96:99]
    s_barrier
    v_add_u32 v4, 0x9000, v4
    v_mfma_f32_16x16x32_bf16 v[100:103], v[16:19], v[36:39], v[100:103]
    s_add_u32 m0, s49, 36864
    s_add_u32 s61, s48, 331776
    ds_read_b128 v[8:11], v4 offset:0
    v_mfma_f32_16x16x32_bf16 v[104:107], v[16:19], v[40:43], v[104:107]
    buffer_load_dwordx4 v2, s[4:7], s61 offen offset:0 lds
    v_mfma_f32_16x16x32_bf16 v[108:111], v[16:19], v[44:47], v[108:111]
    s_waitcnt lgkmcnt(3)
    v_mfma_f32_16x16x32_bf16 v[112:115], v[20:23], v[32:35], v[112:115]
    ds_read_b128 v[12:15], v4 offset:1024
    v_mfma_f32_16x16x32_bf16 v[116:119], v[20:23], v[36:39], v[116:119]
    v_mfma_f32_16x16x32_bf16 v[120:123], v[20:23], v[40:43], v[120:123]
    buffer_load_dwordx4 v2, s[4:7], s61 offen offset:1024 lds
    v_mfma_f32_16x16x32_bf16 v[124:127], v[20:23], v[44:47], v[124:127]
    s_waitcnt lgkmcnt(3)
    v_mfma_f32_16x16x32_bf16 v[96:99], v[24:27], v[48:51], v[96:99]
    ds_read_b128 v[16:19], v4 offset:2048
    v_mfma_f32_16x16x32_bf16 v[100:103], v[24:27], v[52:55], v[100:103]
    v_mfma_f32_16x16x32_bf16 v[104:107], v[24:27], v[56:59], v[104:107]
    buffer_load_dwordx4 v2, s[4:7], s61 offen offset:2048 lds
    v_mfma_f32_16x16x32_bf16 v[108:111], v[24:27], v[60:63], v[108:111]
    s_waitcnt lgkmcnt(3)
    v_mfma_f32_16x16x32_bf16 v[112:115], v[28:31], v[48:51], v[112:115]
    ds_read_b128 v[20:23], v4 offset:3072
    v_mfma_f32_16x16x32_bf16 v[116:119], v[28:31], v[52:55], v[116:119]
    v_mfma_f32_16x16x32_bf16 v[120:123], v[28:31], v[56:59], v[120:123]
    buffer_load_dwordx4 v2, s[4:7], s61 offen offset:3072 lds
    v_mfma_f32_16x16x32_bf16 v[124:127], v[28:31], v[60:63], v[124:127]
    s_waitcnt lgkmcnt(3)
    s_add_u32 m0, s49, 40960
    s_add_u32 s61, s48, 335872
    v_mfma_f32_16x16x32_bf16 v[64:67], v[8:11], a[0:3], 0
    ds_read_b128 v[24:27], v4 offset:4096
    v_mfma_f32_16x16x32_bf16 v[68:71], v[8:11], a[4:7], 0
    v_mfma_f32_16x16x32_bf16 v[72:75], v[8:11], a[8:11], 0
    buffer_load_dwordx4 v2, s[4:7], s61 offen offset:0 lds
    v_mfma_f32_16x16x32_bf16 v[76:79], v[8:11], a[12:15], 0
    s_waitcnt lgkmcnt(3)
    v_mfma_f32_16x16x32_bf16 v[80:83], v[12:15], a[0:3], 0
    ds_read_b128 v[28:31], v4 offset:5120
    v_mfma_f32_16x16x32_bf16 v[84:87], v[12:15], a[4:7], 0
    v_fmac_f32 v96, v136, v128
    v_fmac_f32 v97, v137, v128
    v_mfma_f32_16x16x32_bf16 v[88:91], v[12:15], a[8:11], 0
    buffer_load_dwordx4 v2, s[4:7], s61 offen offset:1024 lds
    v_mfma_f32_16x16x32_bf16 v[92:95], v[12:15], a[12:15], 0
    s_waitcnt lgkmcnt(3)
    v_fmac_f32 v98, v138, v128
    v_fmac_f32 v99, v139, v128
    v_mfma_f32_16x16x32_bf16 v[64:67], v[16:19], a[16:19], v[64:67]
    ds_read_b128 v[8:11], v4 offset:6144
    v_fmac_f32 v112, v140, v128
    v_mfma_f32_16x16x32_bf16 v[68:71], v[16:19], a[20:23], v[68:71]
    v_fmac_f32 v113, v141, v128
    v_fmac_f32 v114, v142, v128
    v_mfma_f32_16x16x32_bf16 v[72:75], v[16:19], a[24:27], v[72:75]
    buffer_load_dwordx4 v2, s[4:7], s61 offen offset:2048 lds
    v_mfma_f32_16x16x32_bf16 v[76:79], v[16:19], a[28:31], v[76:79]
    s_waitcnt lgkmcnt(3)
    v_fmac_f32 v115, v143, v128
    v_mul_f32 v96, v96, v132
    v_mfma_f32_16x16x32_bf16 v[80:83], v[20:23], a[16:19], v[80:83]
    ds_read_b128 v[12:15], v4 offset:7168
    v_mul_f32 v97, v97, v132
    v_mfma_f32_16x16x32_bf16 v[84:87], v[20:23], a[20:23], v[84:87]
    v_mul_f32 v98, v98, v132
    v_mul_f32 v99, v99, v132
    v_mfma_f32_16x16x32_bf16 v[88:91], v[20:23], a[24:27], v[88:91]
    buffer_load_dwordx4 v2, s[4:7], s61 offen offset:3072 lds
    v_mfma_f32_16x16x32_bf16 v[92:95], v[20:23], a[28:31], v[92:95]
    s_waitcnt lgkmcnt(3)
    s_add_u32 m0, s49, 45056
    s_add_u32 s61, s48, 339968
    v_mfma_f32_16x16x32_bf16 v[64:67], v[24:27], a[32:35], v[64:67]
    ds_read_b128 v[16:19], v4 offset:8192
    v_mul_f32 v96, v96, v112
    v_mfma_f32_16x16x32_bf16 v[68:71], v[24:27], a[36:39], v[68:71]
    v_mul_f32 v97, v97, v113
    v_mul_f32 v98, v98, v114
    v_mfma_f32_16x16x32_bf16 v[72:75], v[24:27], a[40:43], v[72:75]
    buffer_load_dwordx4 v2, s[4:7], s61 offen offset:0 lds
    v_mfma_f32_16x16x32_bf16 v[76:79], v[24:27], a[44:47], v[76:79]
    s_waitcnt lgkmcnt(3)
    v_mul_f32 v99, v99, v115
    v_cvt_pk_bf16_f32 v210, v96, v97
    v_mfma_f32_16x16x32_bf16 v[80:83], v[28:31], a[32:35], v[80:83]
    ds_read_b128 v[20:23], v4 offset:9216
    v_cvt_pk_bf16_f32 v211, v98, v99
    v_mfma_f32_16x16x32_bf16 v[84:87], v[28:31], a[36:39], v[84:87]
    s_add_u32 s66, s51, 32768
    v_mfma_f32_16x16x32_bf16 v[88:91], v[28:31], a[40:43], v[88:91]
    buffer_store_dwordx4 v[208:211], v2, s[4:7], s66 offen offset:0 sc1
    v_mfma_f32_16x16x32_bf16 v[92:95], v[28:31], a[44:47], v[92:95]
    s_waitcnt lgkmcnt(3)
    v_fmac_f32 v100, v136, v129
    v_fmac_f32 v101, v137, v129
    v_mfma_f32_16x16x32_bf16 v[64:67], v[8:11], a[48:51], v[64:67]
    ds_read_b128 v[24:27], v4 offset:10240
    v_fmac_f32 v102, v138, v129
    v_mfma_f32_16x16x32_bf16 v[68:71], v[8:11], a[52:55], v[68:71]
    v_fmac_f32 v103, v139, v129
    v_fmac_f32 v116, v140, v129
    v_mfma_f32_16x16x32_bf16 v[72:75], v[8:11], a[56:59], v[72:75]
    v_fmac_f32 v117, v141, v129
    v_fmac_f32 v118, v142, v129
    v_mfma_f32_16x16x32_bf16 v[76:79], v[8:11], a[60:63], v[76:79]
    s_waitcnt lgkmcnt(3)
    v_fmac_f32 v119, v143, v129
    v_mul_f32 v100, v100, v133
    v_mfma_f32_16x16x32_bf16 v[80:83], v[12:15], a[48:51], v[80:83]
    ds_read_b128 v[28:31], v4 offset:11264
    v_mul_f32 v101, v101, v133
    v_mfma_f32_16x16x32_bf16 v[84:87], v[12:15], a[52:55], v[84:87]
    v_mul_f32 v102, v102, v133
    v_mul_f32 v103, v103, v133
    v_mfma_f32_16x16x32_bf16 v[88:91], v[12:15], a[56:59], v[88:91]
    v_mul_f32 v100, v100, v116
    v_mul_f32 v101, v101, v117
    v_mfma_f32_16x16x32_bf16 v[92:95], v[12:15], a[60:63], v[92:95]
    s_waitcnt lgkmcnt(3)
    v_mul_f32 v102, v102, v118
    v_mul_f32 v103, v103, v119
    v_mfma_f32_16x16x32_bf16 v[64:67], v[16:19], a[64:67], v[64:67]
    ds_read_b128 v[8:11], v4 offset:12288
    v_cvt_pk_bf16_f32 v214, v100, v101
    v_mfma_f32_16x16x32_bf16 v[68:71], v[16:19], a[68:71], v[68:71]
    v_cvt_pk_bf16_f32 v215, v102, v103
    v_mfma_f32_16x16x32_bf16 v[72:75], v[16:19], a[72:75], v[72:75]
    buffer_store_dwordx4 v[212:215], v2, s[4:7], s66 offen offset:1024 sc1
    v_mfma_f32_16x16x32_bf16 v[76:79], v[16:19], a[76:79], v[76:79]
    s_waitcnt lgkmcnt(3)
    v_fmac_f32 v104, v136, v130
    v_fmac_f32 v105, v137, v130
    v_mfma_f32_16x16x32_bf16 v[80:83], v[20:23], a[64:67], v[80:83]
    ds_read_b128 v[12:15], v4 offset:13312
    v_fmac_f32 v106, v138, v130
    v_mfma_f32_16x16x32_bf16 v[84:87], v[20:23], a[68:71], v[84:87]
    v_fmac_f32 v107, v139, v130
    v_fmac_f32 v120, v140, v130
    v_mfma_f32_16x16x32_bf16 v[88:91], v[20:23], a[72:75], v[88:91]
    v_fmac_f32 v121, v141, v130
    v_fmac_f32 v122, v142, v130
    v_mfma_f32_16x16x32_bf16 v[92:95], v[20:23], a[76:79], v[92:95]
    s_waitcnt lgkmcnt(3)
    v_fmac_f32 v123, v143, v130
    v_mul_f32 v104, v104, v134
    v_mfma_f32_16x16x32_bf16 v[64:67], v[24:27], a[80:83], v[64:67]
    ds_read_b128 v[16:19], v4 offset:14336
    v_mul_f32 v105, v105, v134
    v_mfma_f32_16x16x32_bf16 v[68:71], v[24:27], a[84:87], v[68:71]
    v_mul_f32 v106, v106, v134
    v_mul_f32 v107, v107, v134
    v_mfma_f32_16x16x32_bf16 v[72:75], v[24:27], a[88:91], v[72:75]
    v_mul_f32 v104, v104, v120
    v_mul_f32 v105, v105, v121
    v_mfma_f32_16x16x32_bf16 v[76:79], v[24:27], a[92:95], v[76:79]
    s_waitcnt lgkmcnt(3)
    v_mul_f32 v106, v106, v122
    v_mul_f32 v107, v107, v123
    v_mfma_f32_16x16x32_bf16 v[80:83], v[28:31], a[80:83], v[80:83]
    ds_read_b128 v[20:23], v4 offset:15360
    v_cvt_pk_bf16_f32 v218, v104, v105
    v_mfma_f32_16x16x32_bf16 v[84:87], v[28:31], a[84:87], v[84:87]
    v_cvt_pk_bf16_f32 v219, v106, v107
    v_mfma_f32_16x16x32_bf16 v[88:91], v[28:31], a[88:91], v[88:91]
    buffer_store_dwordx4 v[216:219], v2, s[4:7], s66 offen offset:2048 sc1
    v_mfma_f32_16x16x32_bf16 v[92:95], v[28:31], a[92:95], v[92:95]
    s_waitcnt lgkmcnt(3)
    v_and_b32 v0, 3, v1
    v_lshlrev_b32 v0, 3, v0
    v_mfma_f32_16x16x32_bf16 v[64:67], v[8:11], a[96:99], v[64:67]
    s_mov_b32 s55, s52
    ds_read_b128 v[24:27], v4 offset:16384
    v_fmac_f32 v108, v136, v131
    v_mfma_f32_16x16x32_bf16 v[68:71], v[8:11], a[100:103], v[68:71]
    v_fmac_f32 v109, v137, v131
    v_fmac_f32 v110, v138, v131
    v_mfma_f32_16x16x32_bf16 v[72:75], v[8:11], a[104:107], v[72:75]
    v_fmac_f32 v111, v139, v131
    v_fmac_f32 v124, v140, v131
    v_mfma_f32_16x16x32_bf16 v[76:79], v[8:11], a[108:111], v[76:79]
    s_waitcnt lgkmcnt(3)
    v_fmac_f32 v125, v141, v131
    v_fmac_f32 v126, v142, v131
    v_mfma_f32_16x16x32_bf16 v[80:83], v[12:15], a[96:99], v[80:83]
    ds_read_b128 v[28:31], v4 offset:17408
    v_fmac_f32 v127, v143, v131
    v_mfma_f32_16x16x32_bf16 v[84:87], v[12:15], a[100:103], v[84:87]
    v_mul_f32 v108, v108, v135
    v_mul_f32 v109, v109, v135
    v_mfma_f32_16x16x32_bf16 v[88:91], v[12:15], a[104:107], v[88:91]
    v_mul_f32 v110, v110, v135
    v_mul_f32 v111, v111, v135
    v_mfma_f32_16x16x32_bf16 v[92:95], v[12:15], a[108:111], v[92:95]
    s_waitcnt lgkmcnt(3)
    v_mul_f32 v108, v108, v124
    v_mul_f32 v109, v109, v125
    v_mfma_f32_16x16x32_bf16 v[64:67], v[16:19], a[112:115], v[64:67]
    ds_read_b128 v[8:11], v4 offset:18432
    v_mul_f32 v110, v110, v126
    v_mfma_f32_16x16x32_bf16 v[68:71], v[16:19], a[116:119], v[68:71]
    v_mul_f32 v111, v111, v127
    v_cvt_pk_bf16_f32 v222, v108, v109
    v_mfma_f32_16x16x32_bf16 v[72:75], v[16:19], a[120:123], v[72:75]
    v_cvt_pk_bf16_f32 v223, v110, v111
    v_mfma_f32_16x16x32_bf16 v[76:79], v[16:19], a[124:127], v[76:79]
    s_waitcnt lgkmcnt(3)
    v_mfma_f32_16x16x32_bf16 v[80:83], v[20:23], a[112:115], v[80:83]
    ds_read_b128 v[12:15], v4 offset:19456
    v_mfma_f32_16x16x32_bf16 v[84:87], v[20:23], a[116:119], v[84:87]
    buffer_store_dwordx4 v[220:223], v2, s[4:7], s66 offen offset:3072 sc1
    v_mfma_f32_16x16x32_bf16 v[88:91], v[20:23], a[120:123], v[88:91]
    ds_read_b128 v[136:139], v5 offset:1024
    ds_read_b128 v[140:143], v5 offset:1088
    v_mfma_f32_16x16x32_bf16 v[92:95], v[20:23], a[124:127], v[92:95]
    s_waitcnt lgkmcnt(5)
    s_lshl_b32 s55, s55, 2
    s_add_u32 s55, s55, 0x8000000
    v_mfma_f32_16x16x32_bf16 v[64:67], v[24:27], a[128:131], v[64:67]
    ds_read_b128 v[16:19], v4 offset:20480
    v_lshlrev_b32 v0, 2, v0
    v_mfma_f32_16x16x32_bf16 v[68:71], v[24:27], a[132:135], v[68:71]
    v_mfma_f32_16x16x32_bf16 v[72:75], v[24:27], a[136:139], v[72:75]
    v_mfma_f32_16x16x32_bf16 v[76:79], v[24:27], a[140:143], v[76:79]
    s_waitcnt lgkmcnt(5)
    v_mfma_f32_16x16x32_bf16 v[80:83], v[28:31], a[128:131], v[80:83]
    ds_read_b128 v[20:23], v4 offset:21504
    v_mfma_f32_16x16x32_bf16 v[84:87], v[28:31], a[132:135], v[84:87]
    buffer_load_dwordx2 v[6:7], v0, s[4:7], s55 offen sc1
    v_mfma_f32_16x16x32_bf16 v[88:91], v[28:31], a[136:139], v[88:91]
    v_mfma_f32_16x16x32_bf16 v[92:95], v[28:31], a[140:143], v[92:95]
    s_waitcnt lgkmcnt(5)
    v_mfma_f32_16x16x32_bf16 v[64:67], v[8:11], a[144:147], v[64:67]
    ds_read_b128 v[24:27], v4 offset:22528
    v_mfma_f32_16x16x32_bf16 v[68:71], v[8:11], a[148:151], v[68:71]
    v_mfma_f32_16x16x32_bf16 v[72:75], v[8:11], a[152:155], v[72:75]
    v_mfma_f32_16x16x32_bf16 v[76:79], v[8:11], a[156:159], v[76:79]
    s_waitcnt lgkmcnt(5)
    v_mfma_f32_16x16x32_bf16 v[80:83], v[12:15], a[144:147], v[80:83]
    ds_read_b128 v[28:31], v4 offset:23552
    v_mfma_f32_16x16x32_bf16 v[84:87], v[12:15], a[148:151], v[84:87]
    v_mfma_f32_16x16x32_bf16 v[88:91], v[12:15], a[152:155], v[88:91]
    v_mfma_f32_16x16x32_bf16 v[92:95], v[12:15], a[156:159], v[92:95]
    s_waitcnt lgkmcnt(3)
    v_mfma_f32_16x16x32_bf16 v[64:67], v[16:19], a[160:163], v[64:67]
    ds_read_b128 v[8:11], v4 offset:24576
    v_mfma_f32_16x16x32_bf16 v[68:71], v[16:19], a[164:167], v[68:71]
    v_mfma_f32_16x16x32_bf16 v[72:75], v[16:19], a[168:171], v[72:75]
    v_mfma_f32_16x16x32_bf16 v[76:79], v[16:19], a[172:175], v[76:79]
    s_waitcnt lgkmcnt(3)
    v_mfma_f32_16x16x32_bf16 v[80:83], v[20:23], a[160:163], v[80:83]
    ds_read_b128 v[12:15], v4 offset:25600
    v_mfma_f32_16x16x32_bf16 v[84:87], v[20:23], a[164:167], v[84:87]
    v_mfma_f32_16x16x32_bf16 v[88:91], v[20:23], a[168:171], v[88:91]
    v_mfma_f32_16x16x32_bf16 v[92:95], v[20:23], a[172:175], v[92:95]
    s_waitcnt lgkmcnt(3)
    v_mfma_f32_16x16x32_bf16 v[64:67], v[24:27], a[176:179], v[64:67]
    ds_read_b128 v[16:19], v4 offset:26624
    v_mfma_f32_16x16x32_bf16 v[68:71], v[24:27], a[180:183], v[68:71]
    v_mfma_f32_16x16x32_bf16 v[72:75], v[24:27], a[184:187], v[72:75]
    v_mfma_f32_16x16x32_bf16 v[76:79], v[24:27], a[188:191], v[76:79]
    s_waitcnt lgkmcnt(3)
    v_mfma_f32_16x16x32_bf16 v[80:83], v[28:31], a[176:179], v[80:83]
    ds_read_b128 v[20:23], v4 offset:27648
    v_mfma_f32_16x16x32_bf16 v[84:87], v[28:31], a[180:183], v[84:87]
    v_mfma_f32_16x16x32_bf16 v[88:91], v[28:31], a[184:187], v[88:91]
    v_mfma_f32_16x16x32_bf16 v[92:95], v[28:31], a[188:191], v[92:95]
    s_waitcnt lgkmcnt(3)
    v_mfma_f32_16x16x32_bf16 v[64:67], v[8:11], a[192:195], v[64:67]
    ds_read_b128 v[24:27], v4 offset:28672
    v_mfma_f32_16x16x32_bf16 v[68:71], v[8:11], a[196:199], v[68:71]
    v_mfma_f32_16x16x32_bf16 v[72:75], v[8:11], a[200:203], v[72:75]
    v_mfma_f32_16x16x32_bf16 v[76:79], v[8:11], a[204:207], v[76:79]
    s_waitcnt lgkmcnt(3)
    v_mfma_f32_16x16x32_bf16 v[80:83], v[12:15], a[192:195], v[80:83]
    ds_read_b128 v[28:31], v4 offset:29696
    v_mfma_f32_16x16x32_bf16 v[84:87], v[12:15], a[196:199], v[84:87]
    v_mfma_f32_16x16x32_bf16 v[88:91], v[12:15], a[200:203], v[88:91]
    v_mfma_f32_16x16x32_bf16 v[92:95], v[12:15], a[204:207], v[92:95]
    s_waitcnt lgkmcnt(3)
    v_mfma_f32_16x16x32_bf16 v[64:67], v[16:19], a[208:211], v[64:67]
    ds_read_b128 v[8:11], v4 offset:30720
    v_mfma_f32_16x16x32_bf16 v[68:71], v[16:19], a[212:215], v[68:71]
    v_mfma_f32_16x16x32_bf16 v[72:75], v[16:19], a[216:219], v[72:75]
    v_mfma_f32_16x16x32_bf16 v[76:79], v[16:19], a[220:223], v[76:79]
    s_waitcnt lgkmcnt(3)
    v_mfma_f32_16x16x32_bf16 v[80:83], v[20:23], a[208:211], v[80:83]
    ds_read_b128 v[12:15], v4 offset:31744
    v_mfma_f32_16x16x32_bf16 v[84:87], v[20:23], a[212:215], v[84:87]
    v_mfma_f32_16x16x32_bf16 v[88:91], v[20:23], a[216:219], v[88:91]
    v_mfma_f32_16x16x32_bf16 v[92:95], v[20:23], a[220:223], v[92:95]
    s_waitcnt lgkmcnt(3)
    v_mfma_f32_16x16x32_bf16 v[64:67], v[24:27], a[224:227], v[64:67]
    ds_read_b128 v[16:19], v4 offset:32768
    v_mfma_f32_16x16x32_bf16 v[68:71], v[24:27], a[228:231], v[68:71]
    v_mfma_f32_16x16x32_bf16 v[72:75], v[24:27], a[232:235], v[72:75]
    v_mfma_f32_16x16x32_bf16 v[76:79], v[24:27], a[236:239], v[76:79]
    s_waitcnt lgkmcnt(3)
    v_mfma_f32_16x16x32_bf16 v[80:83], v[28:31], a[224:227], v[80:83]
    ds_read_b128 v[20:23], v4 offset:33792
    v_mfma_f32_16x16x32_bf16 v[84:87], v[28:31], a[228:231], v[84:87]
    v_mfma_f32_16x16x32_bf16 v[88:91], v[28:31], a[232:235], v[88:91]
    v_mfma_f32_16x16x32_bf16 v[92:95], v[28:31], a[236:239], v[92:95]
    s_waitcnt lgkmcnt(3)
    v_mfma_f32_16x16x32_bf16 v[64:67], v[8:11], a[240:243], v[64:67]
    ds_read_b128 v[24:27], v4 offset:34816
    v_mfma_f32_16x16x32_bf16 v[68:71], v[8:11], a[244:247], v[68:71]
    v_mfma_f32_16x16x32_bf16 v[72:75], v[8:11], a[248:251], v[72:75]
    v_mfma_f32_16x16x32_bf16 v[76:79], v[8:11], a[252:255], v[76:79]
    s_waitcnt lgkmcnt(3)
    v_mfma_f32_16x16x32_bf16 v[80:83], v[12:15], a[240:243], v[80:83]
    s_waitcnt vmcnt(0)
    v_cmp_eq_u64 vcc, s[98:99], v[6:7]
    s_nop 0
    s_cmp_eq_u64 vcc, exec
    s_cbranch_scc0 L_p0_slow_82
L_p0_back_83:
    v_mfma_f32_16x16x32_bf16 v[84:87], v[12:15], a[244:247], v[84:87]
    s_add_u32 s60, s56, s65
    ds_read_b128 v[28:31], v4 offset:35840
    v_mfma_f32_16x16x32_bf16 v[88:91], v[12:15], a[248:251], v[88:91]
    buffer_load_dwordx2 v[242:243], v3, s[4:7], s60 offen offset:0 sc1
    v_mfma_f32_16x16x32_bf16 v[92:95], v[12:15], a[252:255], v[92:95]
    s_waitcnt lgkmcnt(3)
    v_mfma_f32_16x16x32_bf16 v[64:67], v[16:19], v[32:35], v[64:67]
    s_barrier
    v_add_u32 v4, 0xfffe5000, v4
    v_mfma_f32_16x16x32_bf16 v[68:71], v[16:19], v[36:39], v[68:71]
    s_add_u32 m0, s49, 73728
    s_add_u32 s61, s48, 368640
    ds_read_b128 v[8:11], v4 offset:0
    v_mfma_f32_16x16x32_bf16 v[72:75], v[16:19], v[40:43], v[72:75]
    buffer_load_dwordx4 v2, s[4:7], s61 offen offset:0 lds
    v_mfma_f32_16x16x32_bf16 v[76:79], v[16:19], v[44:47], v[76:79]
    s_waitcnt lgkmcnt(3)
    v_mfma_f32_16x16x32_bf16 v[80:83], v[20:23], v[32:35], v[80:83]
    ds_read_b128 v[12:15], v4 offset:1024
    v_mfma_f32_16x16x32_bf16 v[84:87], v[20:23], v[36:39], v[84:87]
    v_mfma_f32_16x16x32_bf16 v[88:91], v[20:23], v[40:43], v[88:91]
    buffer_load_dwordx4 v2, s[4:7], s61 offen offset:1024 lds
    v_mfma_f32_16x16x32_bf16 v[92:95], v[20:23], v[44:47], v[92:95]
    s_waitcnt lgkmcnt(3)
    v_mfma_f32_16x16x32_bf16 v[64:67], v[24:27], v[48:51], v[64:67]
    ds_read_b128 v[16:19], v4 offset:2048
    v_mfma_f32_16x16x32_bf16 v[68:71], v[24:27], v[52:55], v[68:71]
    s_add_u32 s71, s67, 32
    v_mov_b32 v6, s98
    v_mov_b32 v7, s99
    v_mfma_f32_16x16x32_bf16 v[72:75], v[24:27], v[56:59], v[72:75]
    buffer_load_dwordx4 v2, s[4:7], s61 offen offset:2048 lds
    v_mfma_f32_16x16x32_bf16 v[76:79], v[24:27], v[60:63], v[76:79]
    s_waitcnt lgkmcnt(3)
    v_mfma_f32_16x16x32_bf16 v[80:83], v[28:31], v[48:51], v[80:83]
    ds_read_b128 v[20:23], v4 offset:3072
    v_mfma_f32_16x16x32_bf16 v[84:87], v[28:31], v[52:55], v[84:87]
    v_mfma_f32_16x16x32_bf16 v[88:91], v[28:31], v[56:59], v[88:91]
    s_lshl_b32 s71, s71, 2
    s_add_u32 s71, s71, 0x8000000
    s_mov_b64 exec, 1
    buffer_store_dwordx2 v[6:7], off, s[4:7], s71 sc1
    s_mov_b64 exec, -1
    v_mfma_f32_16x16x32_bf16 v[92:95], v[28:31], v[60:63], v[92:95]
    s_waitcnt lgkmcnt(3)
    v_mfma_f32_16x16x32_bf16 v[96:99], v[8:11], a[0:3], 0
    ds_read_b128 v[24:27], v4 offset:4096
    v_mfma_f32_16x16x32_bf16 v[100:103], v[8:11], a[4:7], 0
    v_mfma_f32_16x16x32_bf16 v[104:107], v[8:11], a[8:11], 0
    buffer_load_dwordx4 v2, s[4:7], s61 offen offset:3072 lds
    v_mfma_f32_16x16x32_bf16 v[108:111], v[8:11], a[12:15], 0
    s_waitcnt lgkmcnt(3)
    s_add_u32 m0, s49, 77824
    s_add_u32 s61, s48, 372736
    v_mfma_f32_16x16x32_bf16 v[112:115], v[12:15], a[0:3], 0
    ds_read_b128 v[28:31], v4 offset:5120
    v_mfma_f32_16x16x32_bf16 v[116:119], v[12:15], a[4:7], 0
    v_fmac_f32 v64, v144, v128
    v_fmac_f32 v65, v145, v128
    v_mfma_f32_16x16x32_bf16 v[120:123], v[12:15], a[8:11], 0
    buffer_load_dwordx4 v2, s[4:7], s61 offen offset:0 lds
    v_mfma_f32_16x16x32_bf16 v[124:127], v[12:15], a[12:15], 0
    s_waitcnt lgkmcnt(3)
    v_fmac_f32 v66, v146, v128
    v_fmac_f32 v67, v147, v128
    v_mfma_f32_16x16x32_bf16 v[96:99], v[16:19], a[16:19], v[96:99]
    ds_read_b128 v[8:11], v4 offset:6144
    v_fmac_f32 v80, v148, v128
    v_mfma_f32_16x16x32_bf16 v[100:103], v[16:19], a[20:23], v[100:103]
    v_fmac_f32 v81, v149, v128
    v_fmac_f32 v82, v150, v128
    v_mfma_f32_16x16x32_bf16 v[104:107], v[16:19], a[24:27], v[104:107]
    buffer_load_dwordx4 v2, s[4:7], s61 offen offset:1024 lds
    v_mfma_f32_16x16x32_bf16 v[108:111], v[16:19], a[28:31], v[108:111]
    s_waitcnt lgkmcnt(3)
    v_fmac_f32 v83, v151, v128
    v_mul_f32 v64, v64, v132
    v_mfma_f32_16x16x32_bf16 v[112:115], v[20:23], a[16:19], v[112:115]
    ds_read_b128 v[12:15], v4 offset:7168
    v_mul_f32 v65, v65, v132
    v_mfma_f32_16x16x32_bf16 v[116:119], v[20:23], a[20:23], v[116:119]
    v_mul_f32 v66, v66, v132
    v_mul_f32 v67, v67, v132
    v_mfma_f32_16x16x32_bf16 v[120:123], v[20:23], a[24:27], v[120:123]
    buffer_load_dwordx4 v2, s[4:7], s61 offen offset:2048 lds
    v_mfma_f32_16x16x32_bf16 v[124:127], v[20:23], a[28:31], v[124:127]
    s_waitcnt lgkmcnt(3)
    v_mul_f32 v64, v64, v80
    v_mul_f32 v65, v65, v81
    v_mfma_f32_16x16x32_bf16 v[96:99], v[24:27], a[32:35], v[96:99]
    ds_read_b128 v[16:19], v4 offset:8192
    v_mul_f32 v66, v66, v82
    v_mfma_f32_16x16x32_bf16 v[100:103], v[24:27], a[36:39], v[100:103]
    v_mul_f32 v67, v67, v83
    v_cvt_pk_bf16_f32 v224, v64, v65
    v_mfma_f32_16x16x32_bf16 v[104:107], v[24:27], a[40:43], v[104:107]
    buffer_load_dwordx4 v2, s[4:7], s61 offen offset:3072 lds
    v_mfma_f32_16x16x32_bf16 v[108:111], v[24:27], a[44:47], v[108:111]
    s_waitcnt lgkmcnt(3)
    s_add_u32 m0, s49, 81920
    s_add_u32 s61, s48, 376832
    v_mfma_f32_16x16x32_bf16 v[112:115], v[28:31], a[32:35], v[112:115]
    ds_read_b128 v[20:23], v4 offset:9216
    v_cvt_pk_bf16_f32 v225, v66, v67
    v_mfma_f32_16x16x32_bf16 v[116:119], v[28:31], a[36:39], v[116:119]
    v_fmac_f32 v68, v144, v129
    v_fmac_f32 v69, v145, v129
    v_mfma_f32_16x16x32_bf16 v[120:123], v[28:31], a[40:43], v[120:123]
    buffer_load_dwordx4 v2, s[4:7], s61 offen offset:0 lds
    v_mfma_f32_16x16x32_bf16 v[124:127], v[28:31], a[44:47], v[124:127]
    s_waitcnt lgkmcnt(3)
    v_fmac_f32 v70, v146, v129
    v_fmac_f32 v71, v147, v129
    v_mfma_f32_16x16x32_bf16 v[96:99], v[8:11], a[48:51], v[96:99]
    ds_read_b128 v[24:27], v4 offset:10240
    v_fmac_f32 v84, v148, v129
    v_mfma_f32_16x16x32_bf16 v[100:103], v[8:11], a[52:55], v[100:103]
    v_fmac_f32 v85, v149, v129
    v_fmac_f32 v86, v150, v129
    v_mfma_f32_16x16x32_bf16 v[104:107], v[8:11], a[56:59], v[104:107]
    buffer_load_dwordx2 v[246:247], v3, s[4:7], s60 offen offset:512 sc1
    v_mfma_f32_16x16x32_bf16 v[108:111], v[8:11], a[60:63], v[108:111]
    s_waitcnt lgkmcnt(3)
    v_fmac_f32 v87, v151, v129
    v_mul_f32 v68, v68, v133
    v_mfma_f32_16x16x32_bf16 v[112:115], v[12:15], a[48:51], v[112:115]
    ds_read_b128 v[28:31], v4 offset:11264
    v_mul_f32 v69, v69, v133
    v_mfma_f32_16x16x32_bf16 v[116:119], v[12:15], a[52:55], v[116:119]
    v_mul_f32 v70, v70, v133
    v_mul_f32 v71, v71, v133
    v_mfma_f32_16x16x32_bf16 v[120:123], v[12:15], a[56:59], v[120:123]
    buffer_load_dwordx2 v[250:251], v3, s[4:7], s60 offen offset:1024 sc1
    v_mfma_f32_16x16x32_bf16 v[124:127], v[12:15], a[60:63], v[124:127]
    s_waitcnt lgkmcnt(3)
    v_mul_f32 v68, v68, v84
    v_mul_f32 v69, v69, v85
    v_mfma_f32_16x16x32_bf16 v[96:99], v[16:19], a[64:67], v[96:99]
    ds_read_b128 v[8:11], v4 offset:12288
    v_mul_f32 v70, v70, v86
    v_mfma_f32_16x16x32_bf16 v[100:103], v[16:19], a[68:71], v[100:103]
    v_mul_f32 v71, v71, v87
    v_cvt_pk_bf16_f32 v228, v68, v69
    v_mfma_f32_16x16x32_bf16 v[104:107], v[16:19], a[72:75], v[104:107]
    buffer_load_dwordx2 v[254:255], v3, s[4:7], s60 offen offset:1536 sc1
    v_mfma_f32_16x16x32_bf16 v[108:111], v[16:19], a[76:79], v[108:111]
    s_waitcnt lgkmcnt(3)
    s_add_u32 s60, s57, s65
    v_cvt_pk_bf16_f32 v229, v70, v71
    v_mfma_f32_16x16x32_bf16 v[112:115], v[20:23], a[64:67], v[112:115]
    ds_read_b128 v[12:15], v4 offset:13312
    v_fmac_f32 v72, v144, v130
    v_mfma_f32_16x16x32_bf16 v[116:119], v[20:23], a[68:71], v[116:119]
    v_fmac_f32 v73, v145, v130
    v_fmac_f32 v74, v146, v130
    v_mfma_f32_16x16x32_bf16 v[120:123], v[20:23], a[72:75], v[120:123]
    buffer_load_dwordx2 a[0:1], v3, s[4:7], s60 offen offset:0 sc1
    v_mfma_f32_16x16x32_bf16 v[124:127], v[20:23], a[76:79], v[124:127]
    s_waitcnt lgkmcnt(3)
    v_fmac_f32 v75, v147, v130
    v_fmac_f32 v88, v148, v130
    v_mfma_f32_16x16x32_bf16 v[96:99], v[24:27], a[80:83], v[96:99]
    ds_read_b128 v[16:19], v4 offset:14336
    v_fmac_f32 v89, v149, v130
    v_mfma_f32_16x16x32_bf16 v[100:103], v[24:27], a[84:87], v[100:103]
    v_fmac_f32 v90, v150, v130
    v_fmac_f32 v91, v151, v130
    v_mfma_f32_16x16x32_bf16 v[104:107], v[24:27], a[88:91], v[104:107]
    buffer_load_dwordx2 a[4:5], v3, s[4:7], s60 offen offset:512 sc1
    v_mfma_f32_16x16x32_bf16 v[108:111], v[24:27], a[92:95], v[108:111]
    s_waitcnt lgkmcnt(3)
    v_mul_f32 v72, v72, v134
    v_mul_f32 v73, v73, v134
    v_mfma_f32_16x16x32_bf16 v[112:115], v[28:31], a[80:83], v[112:115]
    ds_read_b128 v[20:23], v4 offset:15360
    v_mul_f32 v74, v74, v134
    v_mfma_f32_16x16x32_bf16 v[116:119], v[28:31], a[84:87], v[116:119]
    v_mul_f32 v75, v75, v134
    v_mul_f32 v72, v72, v88
    v_mfma_f32_16x16x32_bf16 v[120:123], v[28:31], a[88:91], v[120:123]
    buffer_load_dwordx2 a[8:9], v3, s[4:7], s60 offen offset:1024 sc1
    v_mfma_f32_16x16x32_bf16 v[124:127], v[28:31], a[92:95], v[124:127]
    s_waitcnt lgkmcnt(3)
    v_mul_f32 v73, v73, v89
    v_mul_f32 v74, v74, v90
    v_mfma_f32_16x16x32_bf16 v[96:99], v[8:11], a[96:99], v[96:99]
    ds_read_b128 v[24:27], v4 offset:16384
    v_mul_f32 v75, v75, v91
    v_mfma_f32_16x16x32_bf16 v[100:103], v[8:11], a[100:103], v[100:103]
    v_cvt_pk_bf16_f32 v232, v72, v73
    v_cvt_pk_bf16_f32 v233, v74, v75
    v_mfma_f32_16x16x32_bf16 v[104:107], v[8:11], a[104:107], v[104:107]
    buffer_load_dwordx2 a[12:13], v3, s[4:7], s60 offen offset:1536 sc1
    v_mfma_f32_16x16x32_bf16 v[108:111], v[8:11], a[108:111], v[108:111]
    s_waitcnt lgkmcnt(3)
    s_add_u32 s60, s58, s65
    v_fmac_f32 v76, v144, v131
    v_mfma_f32_16x16x32_bf16 v[112:115], v[12:15], a[96:99], v[112:115]
    ds_read_b128 v[28:31], v4 offset:17408
    v_fmac_f32 v77, v145, v131
    v_mfma_f32_16x16x32_bf16 v[116:119], v[12:15], a[100:103], v[116:119]
    v_fmac_f32 v78, v146, v131
    v_fmac_f32 v79, v147, v131
    v_mfma_f32_16x16x32_bf16 v[120:123], v[12:15], a[104:107], v[120:123]
    buffer_load_dwordx2 a[2:3], v3, s[4:7], s60 offen offset:0 sc1
    v_mfma_f32_16x16x32_bf16 v[124:127], v[12:15], a[108:111], v[124:127]
    s_waitcnt lgkmcnt(3)
    v_fmac_f32 v92, v148, v131
    v_fmac_f32 v93, v149, v131
    v_mfma_f32_16x16x32_bf16 v[96:99], v[16:19], a[112:115], v[96:99]
    ds_read_b128 v[8:11], v4 offset:18432
    v_fmac_f32 v94, v150, v131
    v_mfma_f32_16x16x32_bf16 v[100:103], v[16:19], a[116:119], v[100:103]
    v_fmac_f32 v95, v151, v131
    v_mul_f32 v76, v76, v135
    v_mfma_f32_16x16x32_bf16 v[104:107], v[16:19], a[120:123], v[104:107]
    buffer_load_dwordx2 a[6:7], v3, s[4:7], s60 offen offset:512 sc1
    v_mfma_f32_16x16x32_bf16 v[108:111], v[16:19], a[124:127], v[108:111]
    s_waitcnt lgkmcnt(3)
    v_mul_f32 v77, v77, v135
    v_mul_f32 v78, v78, v135
    v_mfma_f32_16x16x32_bf16 v[112:115], v[20:23], a[112:115], v[112:115]
    ds_read_b128 v[12:15], v4 offset:19456
    v_mul_f32 v79, v79, v135
    v_mfma_f32_16x16x32_bf16 v[116:119], v[20:23], a[116:119], v[116:119]
    v_mul_f32 v76, v76, v92
    v_mul_f32 v77, v77, v93
    v_mfma_f32_16x16x32_bf16 v[120:123], v[20:23], a[120:123], v[120:123]
    buffer_load_dwordx2 a[10:11], v3, s[4:7], s60 offen offset:1024 sc1
    v_mfma_f32_16x16x32_bf16 v[124:127], v[20:23], a[124:127], v[124:127]
    s_waitcnt lgkmcnt(3)
    v_mul_f32 v78, v78, v94
    v_mul_f32 v79, v79, v95
    v_mfma_f32_16x16x32_bf16 v[96:99], v[24:27], a[128:131], v[96:99]
    ds_read_b128 v[16:19], v4 offset:20480
    v_cvt_pk_bf16_f32 v236, v76, v77
    v_mfma_f32_16x16x32_bf16 v[100:103], v[24:27], a[132:135], v[100:103]
    v_cvt_pk_bf16_f32 v237, v78, v79
    v_mfma_f32_16x16x32_bf16 v[104:107], v[24:27], a[136:139], v[104:107]
    buffer_load_dwordx2 a[14:15], v3, s[4:7], s60 offen offset:1536 sc1
    v_mfma_f32_16x16x32_bf16 v[108:111], v[24:27], a[140:143], v[108:111]
    s_waitcnt lgkmcnt(3)
    s_add_u32 s60, s56, 0
    v_mfma_f32_16x16x32_bf16 v[112:115], v[28:31], a[128:131], v[112:115]
    ds_read_b128 v[20:23], v4 offset:21504
    v_mfma_f32_16x16x32_bf16 v[116:119], v[28:31], a[132:135], v[116:119]
    v_mfma_f32_16x16x32_bf16 v[120:123], v[28:31], a[136:139], v[120:123]
    buffer_load_dwordx4 a[16:19], v2, s[4:7], s60 offen offset:0 sc1
    v_mfma_f32_16x16x32_bf16 v[124:127], v[28:31], a[140:143], v[124:127]
    s_waitcnt lgkmcnt(3)
    v_mfma_f32_16x16x32_bf16 v[96:99], v[8:11], a[144:147], v[96:99]
    ds_read_b128 v[24:27], v4 offset:22528
    v_mfma_f32_16x16x32_bf16 v[100:103], v[8:11], a[148:151], v[100:103]
    v_mfma_f32_16x16x32_bf16 v[104:107], v[8:11], a[152:155], v[104:107]
    buffer_load_dwordx4 a[20:23], v2, s[4:7], s60 offen offset:1024 sc1
    v_mfma_f32_16x16x32_bf16 v[108:111], v[8:11], a[156:159], v[108:111]
    s_waitcnt lgkmcnt(3)
    v_mfma_f32_16x16x32_bf16 v[112:115], v[12:15], a[144:147], v[112:115]
    ds_read_b128 v[28:31], v4 offset:23552
    v_mfma_f32_16x16x32_bf16 v[116:119], v[12:15], a[148:151], v[116:119]
    v_mfma_f32_16x16x32_bf16 v[120:123], v[12:15], a[152:155], v[120:123]
    buffer_load_dwordx4 a[24:27], v2, s[4:7], s60 offen offset:2048 sc1
    v_mfma_f32_16x16x32_bf16 v[124:127], v[12:15], a[156:159], v[124:127]
    s_waitcnt lgkmcnt(3)
    v_mfma_f32_16x16x32_bf16 v[96:99], v[16:19], a[160:163], v[96:99]
    ds_read_b128 v[8:11], v4 offset:24576
    v_mfma_f32_16x16x32_bf16 v[100:103], v[16:19], a[164:167], v[100:103]
    v_mfma_f32_16x16x32_bf16 v[104:107], v[16:19], a[168:171], v[104:107]
    buffer_load_dwordx4 a[28:31], v2, s[4:7], s60 offen offset:3072 sc1
    v_mfma_f32_16x16x32_bf16 v[108:111], v[16:19], a[172:175], v[108:111]
    s_waitcnt lgkmcnt(3)
    s_add_u32 s60, s57, 0
    v_mfma_f32_16x16x32_bf16 v[112:115], v[20:23], a[160:163], v[112:115]
    ds_read_b128 v[12:15], v4 offset:25600
    v_mfma_f32_16x16x32_bf16 v[116:119], v[20:23], a[164:167], v[116:119]
    v_mfma_f32_16x16x32_bf16 v[120:123], v[20:23], a[168:171], v[120:123]
    buffer_load_dwordx4 a[32:35], v2, s[4:7], s60 offen offset:0 sc1
    v_mfma_f32_16x16x32_bf16 v[124:127], v[20:23], a[172:175], v[124:127]
    s_waitcnt lgkmcnt(3)
    v_mfma_f32_16x16x32_bf16 v[96:99], v[24:27], a[176:179], v[96:99]
    ds_read_b128 v[16:19], v4 offset:26624
    v_mfma_f32_16x16x32_bf16 v[100:103], v[24:27], a[180:183], v[100:103]
    v_mfma_f32_16x16x32_bf16 v[104:107], v[24:27], a[184:187], v[104:107]
    buffer_load_dwordx4 a[36:39], v2, s[4:7], s60 offen offset:1024 sc1
    v_mfma_f32_16x16x32_bf16 v[108:111], v[24:27], a[188:191], v[108:111]
    s_waitcnt lgkmcnt(3)
    v_mfma_f32_16x16x32_bf16 v[112:115], v[28:31], a[176:179], v[112:115]
    ds_read_b128 v[20:23], v4 offset:27648
    v_mfma_f32_16x16x32_bf16 v[116:119], v[28:31], a[180:183], v[116:119]
    v_mfma_f32_16x16x32_bf16 v[120:123], v[28:31], a[184:187], v[120:123]
    buffer_load_dwordx4 a[40:43], v2, s[4:7], s60 offen offset:2048 sc1
    v_mfma_f32_16x16x32_bf16 v[124:127], v[28:31], a[188:191], v[124:127]
    s_waitcnt lgkmcnt(3)
    v_mfma_f32_16x16x32_bf16 v[96:99], v[8:11], a[192:195], v[96:99]
    ds_read_b128 v[24:27], v4 offset:28672
    v_mfma_f32_16x16x32_bf16 v[100:103], v[8:11], a[196:199], v[100:103]
    v_mfma_f32_16x16x32_bf16 v[104:107], v[8:11], a[200:203], v[104:107]
    buffer_load_dwordx4 a[44:47], v2, s[4:7], s60 offen offset:3072 sc1
    v_mfma_f32_16x16x32_bf16 v[108:111], v[8:11], a[204:207], v[108:111]
    s_waitcnt lgkmcnt(3)
    s_add_u32 s60, s58, 0
    v_mfma_f32_16x16x32_bf16 v[112:115], v[12:15], a[192:195], v[112:115]
    ds_read_b128 v[28:31], v4 offset:29696
    v_mfma_f32_16x16x32_bf16 v[116:119], v[12:15], a[196:199], v[116:119]
    v_mfma_f32_16x16x32_bf16 v[120:123], v[12:15], a[200:203], v[120:123]
    buffer_load_dwordx4 a[48:51], v2, s[4:7], s60 offen offset:0 sc1
    v_mfma_f32_16x16x32_bf16 v[124:127], v[12:15], a[204:207], v[124:127]
    s_waitcnt lgkmcnt(3)
    v_mfma_f32_16x16x32_bf16 v[96:99], v[16:19], a[208:211], v[96:99]
    ds_read_b128 v[8:11], v4 offset:30720
    v_mfma_f32_16x16x32_bf16 v[100:103], v[16:19], a[212:215], v[100:103]
    v_mfma_f32_16x16x32_bf16 v[104:107], v[16:19], a[216:219], v[104:107]
    buffer_load_dwordx4 a[52:55], v2, s[4:7], s60 offen offset:1024 sc1
    v_mfma_f32_16x16x32_bf16 v[108:111], v[16:19], a[220:223], v[108:111]
    s_waitcnt lgkmcnt(3)
    v_mfma_f32_16x16x32_bf16 v[112:115], v[20:23], a[208:211], v[112:115]
    ds_read_b128 v[12:15], v4 offset:31744
    v_mfma_f32_16x16x32_bf16 v[116:119], v[20:23], a[212:215], v[116:119]
    v_mfma_f32_16x16x32_bf16 v[120:123], v[20:23], a[216:219], v[120:123]
    buffer_load_dwordx4 a[56:59], v2, s[4:7], s60 offen offset:2048 sc1
    v_mfma_f32_16x16x32_bf16 v[124:127], v[20:23], a[220:223], v[124:127]
    s_waitcnt lgkmcnt(3)
    v_mfma_f32_16x16x32_bf16 v[96:99], v[24:27], a[224:227], v[96:99]
    ds_read_b128 v[16:19], v4 offset:32768
    v_mfma_f32_16x16x32_bf16 v[100:103], v[24:27], a[228:231], v[100:103]
    v_mfma_f32_16x16x32_bf16 v[104:107], v[24:27], a[232:235], v[104:107]
    buffer_load_dwordx4 a[60:63], v2, s[4:7], s60 offen offset:3072 sc1
    v_mfma_f32_16x16x32_bf16 v[108:111], v[24:27], a[236:239], v[108:111]
    s_waitcnt lgkmcnt(3)
    s_add_u32 s60, s56, 16384
    v_mfma_f32_16x16x32_bf16 v[112:115], v[28:31], a[224:227], v[112:115]
    ds_read_b128 v[20:23], v4 offset:33792
    v_mfma_f32_16x16x32_bf16 v[116:119], v[28:31], a[228:231], v[116:119]
    v_mfma_f32_16x16x32_bf16 v[120:123], v[28:31], a[232:235], v[120:123]
    buffer_load_dwordx4 a[64:67], v2, s[4:7], s60 offen offset:0 sc1
    v_mfma_f32_16x16x32_bf16 v[124:127], v[28:31], a[236:239], v[124:127]
    s_waitcnt lgkmcnt(3)
    v_mfma_f32_16x16x32_bf16 v[96:99], v[8:11], a[240:243], v[96:99]
    ds_read_b128 v[24:27], v4 offset:34816
    v_mfma_f32_16x16x32_bf16 v[100:103], v[8:11], a[244:247], v[100:103]
    v_mfma_f32_16x16x32_bf16 v[104:107], v[8:11], a[248:251], v[104:107]
    buffer_load_dwordx4 a[68:71], v2, s[4:7], s60 offen offset:1024 sc1
    v_mfma_f32_16x16x32_bf16 v[108:111], v[8:11], a[252:255], v[108:111]
    s_waitcnt lgkmcnt(3)
    v_mfma_f32_16x16x32_bf16 v[112:115], v[12:15], a[240:243], v[112:115]
    ds_read_b128 v[28:31], v4 offset:35840
    v_mfma_f32_16x16x32_bf16 v[116:119], v[12:15], a[244:247], v[116:119]
    v_mfma_f32_16x16x32_bf16 v[120:123], v[12:15], a[248:251], v[120:123]
    buffer_load_dwordx4 a[72:75], v2, s[4:7], s60 offen offset:2048 sc1
    v_mfma_f32_16x16x32_bf16 v[124:127], v[12:15], a[252:255], v[124:127]
    s_waitcnt lgkmcnt(3)
    v_mfma_f32_16x16x32_bf16 v[96:99], v[16:19], v[32:35], v[96:99]
    s_barrier
    v_add_u32 v4, 0x9000, v4
    v_mfma_f32_16x16x32_bf16 v[100:103], v[16:19], v[36:39], v[100:103]
    s_add_u32 m0, s49, 110592
    s_add_u32 s61, s48, 405504
    ds_read_b128 v[8:11], v4 offset:0
    v_mfma_f32_16x16x32_bf16 v[104:107], v[16:19], v[40:43], v[104:107]
    buffer_load_dwordx4 a[76:79], v2, s[4:7], s60 offen offset:3072 sc1
    v_mfma_f32_16x16x32_bf16 v[108:111], v[16:19], v[44:47], v[108:111]
    s_waitcnt lgkmcnt(3)
    s_add_u32 s60, s57, 16384
    v_mfma_f32_16x16x32_bf16 v[112:115], v[20:23], v[32:35], v[112:115]
    ds_read_b128 v[12:15], v4 offset:1024
    v_mfma_f32_16x16x32_bf16 v[116:119], v[20:23], v[36:39], v[116:119]
    v_mfma_f32_16x16x32_bf16 v[120:123], v[20:23], v[40:43], v[120:123]
    buffer_load_dwordx4 a[80:83], v2, s[4:7], s60 offen offset:0 sc1
    v_mfma_f32_16x16x32_bf16 v[124:127], v[20:23], v[44:47], v[124:127]
    s_waitcnt lgkmcnt(3)
    v_mfma_f32_16x16x32_bf16 v[96:99], v[24:27], v[48:51], v[96:99]
    ds_read_b128 v[16:19], v4 offset:2048
    v_mfma_f32_16x16x32_bf16 v[100:103], v[24:27], v[52:55], v[100:103]
    v_mfma_f32_16x16x32_bf16 v[104:107], v[24:27], v[56:59], v[104:107]
    buffer_load_dwordx4 a[84:87], v2, s[4:7], s60 offen offset:1024 sc1
    v_mfma_f32_16x16x32_bf16 v[108:111], v[24:27], v[60:63], v[108:111]
    s_waitcnt lgkmcnt(3)
    v_mfma_f32_16x16x32_bf16 v[112:115], v[28:31], v[48:51], v[112:115]
    ds_read_b128 v[20:23], v4 offset:3072
    v_mfma_f32_16x16x32_bf16 v[116:119], v[28:31], v[52:55], v[116:119]
    v_mfma_f32_16x16x32_bf16 v[120:123], v[28:31], v[56:59], v[120:123]
    buffer_load_dwordx4 a[88:91], v2, s[4:7], s60 offen offset:2048 sc1
    v_mfma_f32_16x16x32_bf16 v[124:127], v[28:31], v[60:63], v[124:127]
    s_waitcnt lgkmcnt(3)
    v_mfma_f32_16x16x32_bf16 v[32:35], v[8:11], v[176:179], 0
    ds_read_b128 v[24:27], v4 offset:4096
    v_mfma_f32_16x16x32_bf16 v[40:43], v[8:11], v[180:183], 0
    v_mfma_f32_16x16x32_bf16 v[48:51], v[8:11], v[184:187], 0
    buffer_load_dwordx4 a[92:95], v2, s[4:7], s60 offen offset:3072 sc1
    v_mfma_f32_16x16x32_bf16 v[56:59], v[8:11], v[188:191], 0
    s_waitcnt lgkmcnt(3)
    s_add_u32 s60, s58, 16384
    v_mfma_f32_16x16x32_bf16 v[36:39], v[12:15], v[176:179], 0
    ds_read_b128 v[28:31], v4 offset:5120
    v_mfma_f32_16x16x32_bf16 v[44:47], v[12:15], v[180:183], 0
    v_fmac_f32 v96, v136, v128
    v_fmac_f32 v97, v137, v128
    v_mfma_f32_16x16x32_bf16 v[52:55], v[12:15], v[184:187], 0
    v_fmac_f32 v98, v138, v128
    v_fmac_f32 v99, v139, v128
    v_mfma_f32_16x16x32_bf16 v[60:63], v[12:15], v[188:191], 0
    s_waitcnt lgkmcnt(3)
    v_fmac_f32 v112, v140, v128
    v_fmac_f32 v113, v141, v128
    v_mfma_f32_16x16x32_bf16 v[64:67], v[16:19], v[176:179], 0
    ds_read_b128 v[8:11], v4 offset:6144
    v_fmac_f32 v114, v142, v128
    v_mfma_f32_16x16x32_bf16 v[72:75], v[16:19], v[180:183], 0
    v_fmac_f32 v115, v143, v128
    v_mul_f32 v96, v96, v132
    v_mfma_f32_16x16x32_bf16 v[80:83], v[16:19], v[184:187], 0
    v_mul_f32 v97, v97, v132
    v_mul_f32 v98, v98, v132
    v_mfma_f32_16x16x32_bf16 v[88:91], v[16:19], v[188:191], 0
    s_waitcnt lgkmcnt(3)
    v_mul_f32 v99, v99, v132
    v_mul_f32 v96, v96, v112
    v_mfma_f32_16x16x32_bf16 v[68:71], v[20:23], v[176:179], 0
    ds_read_b128 v[12:15], v4 offset:7168
    v_mul_f32 v97, v97, v113
    v_mfma_f32_16x16x32_bf16 v[76:79], v[20:23], v[180:183], 0
    v_mul_f32 v98, v98, v114
    v_mul_f32 v99, v99, v115
    v_mfma_f32_16x16x32_bf16 v[84:87], v[20:23], v[184:187], 0
    v_cvt_pk_bf16_f32 v226, v96, v97
    v_cvt_pk_bf16_f32 v227, v98, v99
    v_mfma_f32_16x16x32_bf16 v[92:95], v[20:23], v[188:191], 0
    s_waitcnt lgkmcnt(3)
    s_add_u32 s66, s51, 49152
    v_mfma_f32_16x16x32_bf16 v[160:163], v[24:27], v[176:179], 0
    ds_read_b128 v[16:19], v4 offset:8192
    v_mfma_f32_16x16x32_bf16 v[164:167], v[24:27], v[180:183], 0
    buffer_store_dwordx4 v[224:227], v2, s[4:7], s66 offen offset:0 sc1
    v_mfma_f32_16x16x32_bf16 v[168:171], v[24:27], v[184:187], 0
    v_fmac_f32 v100, v136, v129
    v_fmac_f32 v101, v137, v129
    v_mfma_f32_16x16x32_bf16 v[172:175], v[24:27], v[188:191], 0
    s_waitcnt lgkmcnt(3)
    v_fmac_f32 v102, v138, v129
    v_fmac_f32 v103, v139, v129
    v_mfma_f32_16x16x32_bf16 v[32:35], v[28:31], v[192:195], v[32:35]
    ds_read_b128 v[20:23], v4 offset:9216
    v_fmac_f32 v116, v140, v129
    v_mfma_f32_16x16x32_bf16 v[40:43], v[28:31], v[196:199], v[40:43]
    v_fmac_f32 v117, v141, v129
    v_fmac_f32 v118, v142, v129
    v_mfma_f32_16x16x32_bf16 v[48:51], v[28:31], v[200:203], v[48:51]
    v_fmac_f32 v119, v143, v129
    v_mul_f32 v100, v100, v133
    v_mfma_f32_16x16x32_bf16 v[56:59], v[28:31], v[204:207], v[56:59]
    s_waitcnt lgkmcnt(3)
    v_mul_f32 v101, v101, v133
    v_mul_f32 v102, v102, v133
    v_mfma_f32_16x16x32_bf16 v[36:39], v[8:11], v[192:195], v[36:39]
    ds_read_b128 v[24:27], v4 offset:10240
    v_mul_f32 v103, v103, v133
    v_mfma_f32_16x16x32_bf16 v[44:47], v[8:11], v[196:199], v[44:47]
    v_mul_f32 v100, v100, v116
    v_mul_f32 v101, v101, v117
    v_mfma_f32_16x16x32_bf16 v[52:55], v[8:11], v[200:203], v[52:55]
    v_mul_f32 v102, v102, v118
    v_mul_f32 v103, v103, v119
    v_mfma_f32_16x16x32_bf16 v[60:63], v[8:11], v[204:207], v[60:63]
    s_waitcnt lgkmcnt(3)
    v_cvt_pk_bf16_f32 v230, v100, v101
    v_cvt_pk_bf16_f32 v231, v102, v103
    v_mfma_f32_16x16x32_bf16 v[64:67], v[12:15], v[192:195], v[64:67]
    ds_read_b128 v[28:31], v4 offset:11264
    v_mfma_f32_16x16x32_bf16 v[72:75], v[12:15], v[196:199], v[72:75]
    buffer_store_dwordx4 v[228:231], v2, s[4:7], s66 offen offset:1024 sc1
    v_mfma_f32_16x16x32_bf16 v[80:83], v[12:15], v[200:203], v[80:83]
    v_fmac_f32 v104, v136, v130
    v_fmac_f32 v105, v137, v130
    v_mfma_f32_16x16x32_bf16 v[88:91], v[12:15], v[204:207], v[88:91]
    s_waitcnt lgkmcnt(3)
    v_fmac_f32 v106, v138, v130
    v_fmac_f32 v107, v139, v130
    v_mfma_f32_16x16x32_bf16 v[68:71], v[16:19], v[192:195], v[68:71]
    ds_read_b128 v[8:11], v4 offset:12288
    v_fmac_f32 v120, v140, v130
    v_mfma_f32_16x16x32_bf16 v[76:79], v[16:19], v[196:199], v[76:79]
    v_fmac_f32 v121, v141, v130
    v_fmac_f32 v122, v142, v130
    v_mfma_f32_16x16x32_bf16 v[84:87], v[16:19], v[200:203], v[84:87]
    v_fmac_f32 v123, v143, v130
    v_mul_f32 v104, v104, v134
    v_mfma_f32_16x16x32_bf16 v[92:95], v[16:19], v[204:207], v[92:95]
    s_waitcnt lgkmcnt(3)
    v_mul_f32 v105, v105, v134
    v_mul_f32 v106, v106, v134
    v_mfma_f32_16x16x32_bf16 v[160:163], v[20:23], v[192:195], v[160:163]
    ds_read_b128 v[12:15], v4 offset:13312
    v_mul_f32 v107, v107, v134
    v_mfma_f32_16x16x32_bf16 v[164:167], v[20:23], v[196:199], v[164:167]
    v_mul_f32 v104, v104, v120
    v_mul_f32 v105, v105, v121
    v_mfma_f32_16x16x32_bf16 v[168:171], v[20:23], v[200:203], v[168:171]
    v_mul_f32 v106, v106, v122
    v_mul_f32 v107, v107, v123
    v_mfma_f32_16x16x32_bf16 v[172:175], v[20:23], v[204:207], v[172:175]
    s_waitcnt lgkmcnt(3)
    v_cvt_pk_bf16_f32 v234, v104, v105
    v_cvt_pk_bf16_f32 v235, v106, v107
    v_mfma_f32_16x16x32_bf16 v[32:35], v[24:27], v[208:211], v[32:35]
    ds_read_b128 v[16:19], v4 offset:14336
    v_mfma_f32_16x16x32_bf16 v[40:43], v[24:27], v[212:215], v[40:43]
    buffer_store_dwordx4 v[232:235], v2, s[4:7], s66 offen offset:2048 sc1
    v_mfma_f32_16x16x32_bf16 v[48:51], v[24:27], v[216:219], v[48:51]
    v_fmac_f32 v108, v136, v131
    v_fmac_f32 v109, v137, v131
    v_mfma_f32_16x16x32_bf16 v[56:59], v[24:27], v[220:223], v[56:59]
    s_waitcnt lgkmcnt(3)
    v_fmac_f32 v110, v138, v131
    v_fmac_f32 v111, v139, v131
    v_mfma_f32_16x16x32_bf16 v[36:39], v[28:31], v[208:211], v[36:39]
    ds_read_b128 v[20:23], v4 offset:15360
    v_fmac_f32 v124, v140, v131
    v_mfma_f32_16x16x32_bf16 v[44:47], v[28:31], v[212:215], v[44:47]
    v_fmac_f32 v125, v141, v131
    v_fmac_f32 v126, v142, v131
    v_mfma_f32_16x16x32_bf16 v[52:55], v[28:31], v[216:219], v[52:55]
    buffer_load_dwordx4 a[96:99], v2, s[4:7], s60 offen offset:0 sc1
    buffer_load_dwordx4 a[100:103], v2, s[4:7], s60 offen offset:1024 sc1
    buffer_load_dwordx4 a[104:107], v2, s[4:7], s60 offen offset:2048 sc1
    buffer_load_dwordx4 a[108:111], v2, s[4:7], s60 offen offset:3072 sc1
    s_add_u32 s55, s52, 32
    s_lshl_b32 s55, s55, 2
    s_add_u32 s55, s55, 0x8000000
    buffer_load_dwordx2 v[6:7], v0, s[4:7], s55 offen sc1
    v_mfma_f32_16x16x32_bf16 v[60:63], v[28:31], v[220:223], v[60:63]
    s_waitcnt lgkmcnt(3)
    v_fmac_f32 v127, v143, v131
    v_mul_f32 v108, v108, v135
    v_mfma_f32_16x16x32_bf16 v[64:67], v[8:11], v[208:211], v[64:67]
    ds_read_b128 v[24:27], v4 offset:16384
    v_mul_f32 v109, v109, v135
    v_mfma_f32_16x16x32_bf16 v[72:75], v[8:11], v[212:215], v[72:75]
    v_mul_f32 v110, v110, v135
    v_mul_f32 v111, v111, v135
    v_mfma_f32_16x16x32_bf16 v[80:83], v[8:11], v[216:219], v[80:83]
    v_mul_f32 v108, v108, v124
    v_mul_f32 v109, v109, v125
    v_mfma_f32_16x16x32_bf16 v[88:91], v[8:11], v[220:223], v[88:91]
    s_waitcnt lgkmcnt(3)
    v_mul_f32 v110, v110, v126
    v_mul_f32 v111, v111, v127
    v_mfma_f32_16x16x32_bf16 v[68:71], v[12:15], v[208:211], v[68:71]
    ds_read_b128 v[28:31], v4 offset:17408
    v_cvt_pk_bf16_f32 v238, v108, v109
    v_mfma_f32_16x16x32_bf16 v[76:79], v[12:15], v[212:215], v[76:79]
    buffer_load_dwordx4 v2, s[4:7], s61 offen offset:0 lds
    v_mfma_f32_16x16x32_bf16 v[84:87], v[12:15], v[216:219], v[84:87]
    v_cvt_pk_bf16_f32 v239, v110, v111
    v_mfma_f32_16x16x32_bf16 v[92:95], v[12:15], v[220:223], v[92:95]
    s_waitcnt lgkmcnt(3)
    v_mfma_f32_16x16x32_bf16 v[160:163], v[16:19], v[208:211], v[160:163]
    ds_read_b128 v[8:11], v4 offset:18432
    v_mfma_f32_16x16x32_bf16 v[164:167], v[16:19], v[212:215], v[164:167]
    buffer_store_dwordx4 v[236:239], v2, s[4:7], s66 offen offset:3072 sc1
    v_mfma_f32_16x16x32_bf16 v[168:171], v[16:19], v[216:219], v[168:171]
    v_mfma_f32_16x16x32_bf16 v[172:175], v[16:19], v[220:223], v[172:175]
    s_waitcnt lgkmcnt(3)
    v_mfma_f32_16x16x32_bf16 v[96:99], v[20:23], v[176:179], 0
    ds_read_b128 v[12:15], v4 offset:19456
    v_mfma_f32_16x16x32_bf16 v[104:107], v[20:23], v[180:183], 0
    buffer_load_dwordx4 v2, s[4:7], s61 offen offset:1024 lds
    v_mfma_f32_16x16x32_bf16 v[112:115], v[20:23], v[184:187], 0
    v_mfma_f32_16x16x32_bf16 v[120:123], v[20:23], v[188:191], 0
    s_waitcnt lgkmcnt(3)
    v_mfma_f32_16x16x32_bf16 v[100:103], v[24:27], v[176:179], 0
    ds_read_b128 v[16:19], v4 offset:20480
    v_mfma_f32_16x16x32_bf16 v[108:111], v[24:27], v[180:183], 0
    buffer_load_dwordx4 v2, s[4:7], s61 offen offset:2048 lds
    v_mfma_f32_16x16x32_bf16 v[116:119], v[24:27], v[184:187], 0
    v_mfma_f32_16x16x32_bf16 v[124:127], v[24:27], v[188:191], 0
    s_waitcnt lgkmcnt(3)
    v_mfma_f32_16x16x32_bf16 v[128:131], v[28:31], v[176:179], 0
    ds_read_b128 v[20:23], v4 offset:21504
    v_mfma_f32_16x16x32_bf16 v[136:139], v[28:31], v[180:183], 0
    buffer_load_dwordx4 v2, s[4:7], s61 offen offset:3072 lds
    v_mfma_f32_16x16x32_bf16 v[144:147], v[28:31], v[184:187], 0
    s_add_u32 m0, s49, 114688
    s_add_u32 s61, s48, 409600
    v_mfma_f32_16x16x32_bf16 v[152:155], v[28:31], v[188:191], 0
    s_waitcnt lgkmcnt(3)
    v_mfma_f32_16x16x32_bf16 v[132:135], v[8:11], v[176:179], 0
    ds_read_b128 v[24:27], v4 offset:22528
    v_mfma_f32_16x16x32_bf16 v[140:143], v[8:11], v[180:183], 0
    buffer_load_dwordx4 v2, s[4:7], s61 offen offset:0 lds
    v_mfma_f32_16x16x32_bf16 v[148:151], v[8:11], v[184:187], 0
    v_mfma_f32_16x16x32_bf16 v[156:159], v[8:11], v[188:191], 0
    s_waitcnt lgkmcnt(3)
    v_mfma_f32_16x16x32_bf16 v[96:99], v[12:15], v[192:195], v[96:99]
    ds_read_b128 v[28:31], v4 offset:23552
    v_mfma_f32_16x16x32_bf16 v[104:107], v[12:15], v[196:199], v[104:107]
    buffer_load_dwordx4 v2, s[4:7], s61 offen offset:1024 lds
    v_mfma_f32_16x16x32_bf16 v[112:115], v[12:15], v[200:203], v[112:115]
    v_mfma_f32_16x16x32_bf16 v[120:123], v[12:15], v[204:207], v[120:123]
    s_waitcnt lgkmcnt(3)
    v_mfma_f32_16x16x32_bf16 v[100:103], v[16:19], v[192:195], v[100:103]
    ds_read_b128 v[8:11], v4 offset:24576
    v_mfma_f32_16x16x32_bf16 v[108:111], v[16:19], v[196:199], v[108:111]
    buffer_load_dwordx4 v2, s[4:7], s61 offen offset:2048 lds
    v_mfma_f32_16x16x32_bf16 v[116:119], v[16:19], v[200:203], v[116:119]
    v_mfma_f32_16x16x32_bf16 v[124:127], v[16:19], v[204:207], v[124:127]
    s_waitcnt lgkmcnt(3)
    v_mfma_f32_16x16x32_bf16 v[128:131], v[20:23], v[192:195], v[128:131]
    ds_read_b128 v[12:15], v4 offset:25600
    v_mfma_f32_16x16x32_bf16 v[136:139], v[20:23], v[196:199], v[136:139]
    buffer_load_dwordx4 v2, s[4:7], s61 offen offset:3072 lds
    v_mfma_f32_16x16x32_bf16 v[144:147], v[20:23], v[200:203], v[144:147]
    s_add_u32 m0, s49, 118784
    s_add_u32 s61, s48, 413696
    v_mfma_f32_16x16x32_bf16 v[152:155], v[20:23], v[204:207], v[152:155]
    s_waitcnt lgkmcnt(3)
    v_mfma_f32_16x16x32_bf16 v[132:135], v[24:27], v[192:195], v[132:135]
    ds_read_b128 v[16:19], v4 offset:26624
    v_mfma_f32_16x16x32_bf16 v[140:143], v[24:27], v[196:199], v[140:143]
    buffer_load_dwordx4 v2, s[4:7], s61 offen offset:0 lds
    v_mfma_f32_16x16x32_bf16 v[148:151], v[24:27], v[200:203], v[148:151]
    v_mfma_f32_16x16x32_bf16 v[156:159], v[24:27], v[204:207], v[156:159]
    s_waitcnt lgkmcnt(3)
    v_mfma_f32_16x16x32_bf16 v[96:99], v[28:31], v[208:211], v[96:99]
    ds_read_b128 v[20:23], v4 offset:27648
    v_mfma_f32_16x16x32_bf16 v[104:107], v[28:31], v[212:215], v[104:107]
    v_mfma_f32_16x16x32_bf16 v[112:115], v[28:31], v[216:219], v[112:115]
    v_mfma_f32_16x16x32_bf16 v[120:123], v[28:31], v[220:223], v[120:123]
    s_waitcnt lgkmcnt(3)
    v_mfma_f32_16x16x32_bf16 v[100:103], v[8:11], v[208:211], v[100:103]
    ds_read_b128 v[24:27], v4 offset:28672
    v_mfma_f32_16x16x32_bf16 v[108:111], v[8:11], v[212:215], v[108:111]
    v_mfma_f32_16x16x32_bf16 v[116:119], v[8:11], v[216:219], v[116:119]
    v_mfma_f32_16x16x32_bf16 v[124:127], v[8:11], v[220:223], v[124:127]
    s_waitcnt lgkmcnt(3)
    v_mfma_f32_16x16x32_bf16 v[128:131], v[12:15], v[208:211], v[128:131]
    s_waitcnt vmcnt(10)
    v_cmp_eq_u64 vcc, s[98:99], v[6:7]
    s_nop 0
    s_cmp_eq_u64 vcc, exec
    s_cbranch_scc0 L_p1_slow_85
L_p1_back_86:
    v_mfma_f32_16x16x32_bf16 v[136:139], v[12:15], v[212:215], v[136:139]
    s_add_u32 s60, s56, 32768
    ds_read_b128 v[28:31], v4 offset:29696
    v_mfma_f32_16x16x32_bf16 v[144:147], v[12:15], v[216:219], v[144:147]
    buffer_load_dwordx4 a[112:115], v2, s[4:7], s60 offen offset:0 sc1
    v_mfma_f32_16x16x32_bf16 v[152:155], v[12:15], v[220:223], v[152:155]
    s_waitcnt lgkmcnt(3)
    v_mfma_f32_16x16x32_bf16 v[132:135], v[16:19], v[208:211], v[132:135]
    ds_read_b128 v[8:11], v4 offset:30720
    v_mfma_f32_16x16x32_bf16 v[140:143], v[16:19], v[212:215], v[140:143]
    v_mfma_f32_16x16x32_bf16 v[148:151], v[16:19], v[216:219], v[148:151]
    buffer_load_dwordx4 a[116:119], v2, s[4:7], s60 offen offset:1024 sc1
    v_mfma_f32_16x16x32_bf16 v[156:159], v[16:19], v[220:223], v[156:159]
    s_waitcnt lgkmcnt(3)
    v_mfma_f32_16x16x32_bf16 v[32:35], v[20:23], v[224:227], v[32:35]
    ds_read_b128 v[12:15], v4 offset:31744
    v_mfma_f32_16x16x32_bf16 v[40:43], v[20:23], v[228:231], v[40:43]
    v_mfma_f32_16x16x32_bf16 v[48:51], v[20:23], v[232:235], v[48:51]
    buffer_load_dwordx4 a[120:123], v2, s[4:7], s60 offen offset:2048 sc1
    v_mfma_f32_16x16x32_bf16 v[56:59], v[20:23], v[236:239], v[56:59]
    s_waitcnt lgkmcnt(3)
    v_mfma_f32_16x16x32_bf16 v[36:39], v[24:27], v[224:227], v[36:39]
    ds_read_b128 v[16:19], v4 offset:32768
    v_mfma_f32_16x16x32_bf16 v[44:47], v[24:27], v[228:231], v[44:47]
    s_add_u32 s71, s67, 64
    v_mov_b32 v6, s98
    v_mov_b32 v7, s99
    v_mfma_f32_16x16x32_bf16 v[52:55], v[24:27], v[232:235], v[52:55]
    buffer_load_dwordx4 a[124:127], v2, s[4:7], s60 offen offset:3072 sc1
    v_mfma_f32_16x16x32_bf16 v[60:63], v[24:27], v[236:239], v[60:63]
    s_waitcnt lgkmcnt(3)
    s_waitcnt vmcnt(12)
    s_add_u32 s60, s57, 32768
    v_mfma_f32_16x16x32_bf16 v[64:67], v[28:31], v[224:227], v[64:67]
    ds_read_b128 v[20:23], v4 offset:33792
    v_mfma_f32_16x16x32_bf16 v[72:75], v[28:31], v[228:231], v[72:75]
    v_mfma_f32_16x16x32_bf16 v[80:83], v[28:31], v[232:235], v[80:83]
    s_lshl_b32 s71, s71, 2
    s_add_u32 s71, s71, 0x8000000
    s_mov_b64 exec, 1
    buffer_store_dwordx2 v[6:7], off, s[4:7], s71 sc1
    s_mov_b64 exec, -1
    v_mfma_f32_16x16x32_bf16 v[88:91], v[28:31], v[236:239], v[88:91]
    s_waitcnt lgkmcnt(3)
    v_mfma_f32_16x16x32_bf16 v[68:71], v[8:11], v[224:227], v[68:71]
    ds_read_b128 v[24:27], v4 offset:34816
    v_mfma_f32_16x16x32_bf16 v[76:79], v[8:11], v[228:231], v[76:79]
    v_mfma_f32_16x16x32_bf16 v[84:87], v[8:11], v[232:235], v[84:87]
    buffer_load_dwordx4 a[128:131], v2, s[4:7], s60 offen offset:0 sc1
    v_mfma_f32_16x16x32_bf16 v[92:95], v[8:11], v[236:239], v[92:95]
    s_waitcnt lgkmcnt(3)
    v_mfma_f32_16x16x32_bf16 v[96:99], v[12:15], v[224:227], v[96:99]
    ds_read_b128 v[28:31], v4 offset:35840
    v_mfma_f32_16x16x32_bf16 v[104:107], v[12:15], v[228:231], v[104:107]
    v_mfma_f32_16x16x32_bf16 v[112:115], v[12:15], v[232:235], v[112:115]
    buffer_load_dwordx4 a[132:135], v2, s[4:7], s60 offen offset:1024 sc1
    v_mfma_f32_16x16x32_bf16 v[120:123], v[12:15], v[236:239], v[120:123]
    s_waitcnt lgkmcnt(3)
    v_mfma_f32_16x16x32_bf16 v[100:103], v[16:19], v[224:227], v[100:103]
    s_barrier
    v_add_u32 v4, 0x9000, v4
    v_mfma_f32_16x16x32_bf16 v[108:111], v[16:19], v[228:231], v[108:111]
    s_add_u32 m0, s49, 0
    s_add_u32 s61, s48, 442368
    ds_read_b128 v[8:11], v4 offset:0
    v_mfma_f32_16x16x32_bf16 v[116:119], v[16:19], v[232:235], v[116:119]
    buffer_load_dwordx4 a[136:139], v2, s[4:7], s60 offen offset:2048 sc1
    v_mfma_f32_16x16x32_bf16 v[124:127], v[16:19], v[236:239], v[124:127]
    s_waitcnt lgkmcnt(3)
    v_mfma_f32_16x16x32_bf16 v[128:131], v[20:23], v[224:227], v[128:131]
    ds_read_b128 v[12:15], v4 offset:1024
    v_mfma_f32_16x16x32_bf16 v[136:139], v[20:23], v[228:231], v[136:139]
    v_mfma_f32_16x16x32_bf16 v[144:147], v[20:23], v[232:235], v[144:147]
    buffer_load_dwordx4 a[140:143], v2, s[4:7], s60 offen offset:3072 sc1
    v_mfma_f32_16x16x32_bf16 v[152:155], v[20:23], v[236:239], v[152:155]
    s_waitcnt lgkmcnt(3)
    s_add_u32 s60, s58, 32768
    v_mfma_f32_16x16x32_bf16 v[132:135], v[24:27], v[224:227], v[132:135]
    ds_read_b128 v[16:19], v4 offset:2048
    v_mfma_f32_16x16x32_bf16 v[140:143], v[24:27], v[228:231], v[140:143]
    v_mfma_f32_16x16x32_bf16 v[148:151], v[24:27], v[232:235], v[148:151]
    buffer_load_dwordx4 a[144:147], v2, s[4:7], s60 offen offset:0 sc1
    v_mfma_f32_16x16x32_bf16 v[156:159], v[24:27], v[236:239], v[156:159]
    s_waitcnt lgkmcnt(3)
    v_mfma_f32_16x16x32_bf16 v[160:163], v[28:31], v[224:227], v[160:163]
    ds_read_b128 v[20:23], v4 offset:3072
    v_mfma_f32_16x16x32_bf16 v[164:167], v[28:31], v[228:231], v[164:167]
    v_mfma_f32_16x16x32_bf16 v[168:171], v[28:31], v[232:235], v[168:171]
    buffer_load_dwordx4 a[148:151], v2, s[4:7], s60 offen offset:1024 sc1
    v_mfma_f32_16x16x32_bf16 v[172:175], v[28:31], v[236:239], v[172:175]
    s_waitcnt lgkmcnt(3)
    v_mfma_f32_16x16x32_bf16 v[32:35], v[8:11], v[240:243], v[32:35]
    ds_read_b128 v[24:27], v4 offset:4096
    v_mfma_f32_16x16x32_bf16 v[40:43], v[8:11], v[244:247], v[40:43]
    v_mfma_f32_16x16x32_bf16 v[48:51], v[8:11], v[248:251], v[48:51]
    buffer_load_dwordx4 a[152:155], v2, s[4:7], s60 offen offset:2048 sc1
    v_mfma_f32_16x16x32_bf16 v[56:59], v[8:11], v[252:255], v[56:59]
    s_waitcnt lgkmcnt(3)
    v_mfma_f32_16x16x32_bf16 v[36:39], v[12:15], v[240:243], v[36:39]
    ds_read_b128 v[28:31], v4 offset:5120
    v_mfma_f32_16x16x32_bf16 v[44:47], v[12:15], v[244:247], v[44:47]
    v_mfma_f32_16x16x32_bf16 v[52:55], v[12:15], v[248:251], v[52:55]
    buffer_load_dwordx4 a[156:159], v2, s[4:7], s60 offen offset:3072 sc1
    v_mfma_f32_16x16x32_bf16 v[60:63], v[12:15], v[252:255], v[60:63]
    s_waitcnt lgkmcnt(3)
    v_mfma_f32_16x16x32_bf16 v[64:67], v[16:19], v[240:243], v[64:67]
    ds_read_b128 v[8:11], v4 offset:6144
    v_mfma_f32_16x16x32_bf16 v[72:75], v[16:19], v[244:247], v[72:75]
    v_mfma_f32_16x16x32_bf16 v[80:83], v[16:19], v[248:251], v[80:83]
    buffer_load_dwordx4 v2, s[4:7], s61 offen offset:0 lds
    v_mfma_f32_16x16x32_bf16 v[88:91], v[16:19], v[252:255], v[88:91]
    s_waitcnt lgkmcnt(3)
    v_mfma_f32_16x16x32_bf16 v[68:71], v[20:23], v[240:243], v[68:71]
    ds_read_b128 v[12:15], v4 offset:7168
    v_mfma_f32_16x16x32_bf16 v[76:79], v[20:23], v[244:247], v[76:79]
    v_mfma_f32_16x16x32_bf16 v[84:87], v[20:23], v[248:251], v[84:87]
    buffer_load_dwordx4 v2, s[4:7], s61 offen offset:1024 lds
    v_mfma_f32_16x16x32_bf16 v[92:95], v[20:23], v[252:255], v[92:95]
    s_waitcnt lgkmcnt(3)
    v_mfma_f32_16x16x32_bf16 v[96:99], v[24:27], v[240:243], v[96:99]
    ds_read_b128 v[16:19], v4 offset:8192
    v_mfma_f32_16x16x32_bf16 v[104:107], v[24:27], v[244:247], v[104:107]
    v_mfma_f32_16x16x32_bf16 v[112:115], v[24:27], v[248:251], v[112:115]
    buffer_load_dwordx4 v2, s[4:7], s61 offen offset:2048 lds
    v_mfma_f32_16x16x32_bf16 v[120:123], v[24:27], v[252:255], v[120:123]
    s_waitcnt lgkmcnt(3)
    v_mfma_f32_16x16x32_bf16 v[100:103], v[28:31], v[240:243], v[100:103]
    ds_read_b128 v[20:23], v4 offset:9216
    v_mfma_f32_16x16x32_bf16 v[108:111], v[28:31], v[244:247], v[108:111]
    v_mfma_f32_16x16x32_bf16 v[116:119], v[28:31], v[248:251], v[116:119]
    buffer_load_dwordx4 v2, s[4:7], s61 offen offset:3072 lds
    v_mfma_f32_16x16x32_bf16 v[124:127], v[28:31], v[252:255], v[124:127]
    s_waitcnt lgkmcnt(3)
    s_add_u32 m0, s49, 4096
    s_add_u32 s61, s48, 446464
    v_mfma_f32_16x16x32_bf16 v[128:131], v[8:11], v[240:243], v[128:131]
    ds_read_b128 v[24:27], v4 offset:10240
    v_mfma_f32_16x16x32_bf16 v[136:139], v[8:11], v[244:247], v[136:139]
    v_mfma_f32_16x16x32_bf16 v[144:147], v[8:11], v[248:251], v[144:147]
    buffer_load_dwordx4 v2, s[4:7], s61 offen offset:0 lds
    v_mfma_f32_16x16x32_bf16 v[152:155], v[8:11], v[252:255], v[152:155]
    s_waitcnt lgkmcnt(3)
    v_mfma_f32_16x16x32_bf16 v[132:135], v[12:15], v[240:243], v[132:135]
    ds_read_b128 v[28:31], v4 offset:11264
    v_mfma_f32_16x16x32_bf16 v[140:143], v[12:15], v[244:247], v[140:143]
    v_mfma_f32_16x16x32_bf16 v[148:151], v[12:15], v[248:251], v[148:151]
    buffer_load_dwordx4 v2, s[4:7], s61 offen offset:1024 lds
    v_mfma_f32_16x16x32_bf16 v[156:159], v[12:15], v[252:255], v[156:159]
    s_waitcnt lgkmcnt(3)
    v_mfma_f32_16x16x32_bf16 v[160:163], v[16:19], v[240:243], v[160:163]
    ds_read_b128 v[8:11], v4 offset:12288
    v_mfma_f32_16x16x32_bf16 v[164:167], v[16:19], v[244:247], v[164:167]
    v_mfma_f32_16x16x32_bf16 v[168:171], v[16:19], v[248:251], v[168:171]
    buffer_load_dwordx4 v2, s[4:7], s61 offen offset:2048 lds
    v_mfma_f32_16x16x32_bf16 v[172:175], v[16:19], v[252:255], v[172:175]
    s_waitcnt lgkmcnt(3)
    v_mfma_f32_16x16x32_bf16 v[32:35], v[20:23], a[0:3], v[32:35]
    ds_read_b128 v[12:15], v4 offset:13312
    v_mfma_f32_16x16x32_bf16 v[40:43], v[20:23], a[4:7], v[40:43]
    v_mfma_f32_16x16x32_bf16 v[48:51], v[20:23], a[8:11], v[48:51]
    buffer_load_dwordx4 v2, s[4:7], s61 offen offset:3072 lds
    v_mfma_f32_16x16x32_bf16 v[56:59], v[20:23], a[12:15], v[56:59]
    s_waitcnt lgkmcnt(3)
    s_add_u32 m0, s49, 8192
    s_add_u32 s61, s48, 450560
    v_mfma_f32_16x16x32_bf16 v[36:39], v[24:27], a[0:3], v[36:39]
    ds_read_b128 v[16:19], v4 offset:14336
    v_mfma_f32_16x16x32_bf16 v[44:47], v[24:27], a[4:7], v[44:47]
    v_mfma_f32_16x16x32_bf16 v[52:55], v[24:27], a[8:11], v[52:55]
    buffer_load_dwordx4 v2, s[4:7], s61 offen offset:0 lds
    v_mfma_f32_16x16x32_bf16 v[60:63], v[24:27], a[12:15], v[60:63]
    s_waitcnt lgkmcnt(3)
    v_mfma_f32_16x16x32_bf16 v[64:67], v[28:31], a[0:3], v[64:67]
    ds_read_b128 v[20:23], v4 offset:15360
    v_mfma_f32_16x16x32_bf16 v[72:75], v[28:31], a[4:7], v[72:75]
    v_mfma_f32_16x16x32_bf16 v[80:83], v[28:31], a[8:11], v[80:83]
    v_mfma_f32_16x16x32_bf16 v[88:91], v[28:31], a[12:15], v[88:91]
    s_waitcnt lgkmcnt(3)
    v_mfma_f32_16x16x32_bf16 v[68:71], v[8:11], a[0:3], v[68:71]
    ds_read_b128 v[24:27], v4 offset:16384
    v_mfma_f32_16x16x32_bf16 v[76:79], v[8:11], a[4:7], v[76:79]
    v_mfma_f32_16x16x32_bf16 v[84:87], v[8:11], a[8:11], v[84:87]
    v_mfma_f32_16x16x32_bf16 v[92:95], v[8:11], a[12:15], v[92:95]
    s_waitcnt lgkmcnt(3)
    v_mfma_f32_16x16x32_bf16 v[96:99], v[12:15], a[0:3], v[96:99]
    ds_read_b128 v[28:31], v4 offset:17408
    v_mfma_f32_16x16x32_bf16 v[104:107], v[12:15], a[4:7], v[104:107]
    s_add_u32 s55, s52, 64
    v_mfma_f32_16x16x32_bf16 v[112:115], v[12:15], a[8:11], v[112:115]
    v_mfma_f32_16x16x32_bf16 v[120:123], v[12:15], a[12:15], v[120:123]
    s_waitcnt lgkmcnt(3)
    v_mfma_f32_16x16x32_bf16 v[100:103], v[16:19], a[0:3], v[100:103]
    ds_read_b128 v[8:11], v4 offset:18432
    v_mfma_f32_16x16x32_bf16 v[108:111], v[16:19], a[4:7], v[108:111]
    v_mfma_f32_16x16x32_bf16 v[116:119], v[16:19], a[8:11], v[116:119]
    v_mfma_f32_16x16x32_bf16 v[124:127], v[16:19], a[12:15], v[124:127]
    s_waitcnt lgkmcnt(3)
    s_lshl_b32 s55, s55, 2
    s_add_u32 s55, s55, 0x8000000
    v_mfma_f32_16x16x32_bf16 v[128:131], v[20:23], a[0:3], v[128:131]
    ds_read_b128 v[12:15], v4 offset:19456
    v_mfma_f32_16x16x32_bf16 v[136:139], v[20:23], a[4:7], v[136:139]
    v_mfma_f32_16x16x32_bf16 v[144:147], v[20:23], a[8:11], v[144:147]
    v_mfma_f32_16x16x32_bf16 v[152:155], v[20:23], a[12:15], v[152:155]
    s_waitcnt lgkmcnt(3)
    v_mfma_f32_16x16x32_bf16 v[132:135], v[24:27], a[0:3], v[132:135]
    ds_read_b128 v[16:19], v4 offset:20480
    v_mfma_f32_16x16x32_bf16 v[140:143], v[24:27], a[4:7], v[140:143]
    buffer_load_dwordx2 v[6:7], v0, s[4:7], s55 offen sc1
    v_mfma_f32_16x16x32_bf16 v[148:151], v[24:27], a[8:11], v[148:151]
    v_mfma_f32_16x16x32_bf16 v[156:159], v[24:27], a[12:15], v[156:159]
    s_waitcnt lgkmcnt(3)
    v_mfma_f32_16x16x32_bf16 v[160:163], v[28:31], a[0:3], v[160:163]
    ds_read_b128 v[20:23], v4 offset:21504
    v_mfma_f32_16x16x32_bf16 v[164:167], v[28:31], a[4:7], v[164:167]
    v_mfma_f32_16x16x32_bf16 v[168:171], v[28:31], a[8:11], v[168:171]
    v_mfma_f32_16x16x32_bf16 v[172:175], v[28:31], a[12:15], v[172:175]
    s_waitcnt lgkmcnt(3)
    v_mfma_f32_16x16x32_bf16 v[32:35], v[8:11], a[16:19], v[32:35]
    ds_read_b128 v[24:27], v4 offset:22528
    v_mfma_f32_16x16x32_bf16 v[40:43], v[8:11], a[20:23], v[40:43]
    v_mfma_f32_16x16x32_bf16 v[48:51], v[8:11], a[24:27], v[48:51]
    v_mfma_f32_16x16x32_bf16 v[56:59], v[8:11], a[28:31], v[56:59]
    s_waitcnt lgkmcnt(3)
    v_mfma_f32_16x16x32_bf16 v[36:39], v[12:15], a[16:19], v[36:39]
    ds_read_b128 v[28:31], v4 offset:23552
    v_mfma_f32_16x16x32_bf16 v[44:47], v[12:15], a[20:23], v[44:47]
    v_mfma_f32_16x16x32_bf16 v[52:55], v[12:15], a[24:27], v[52:55]
    v_mfma_f32_16x16x32_bf16 v[60:63], v[12:15], a[28:31], v[60:63]
    s_waitcnt lgkmcnt(3)
    v_mfma_f32_16x16x32_bf16 v[64:67], v[16:19], a[16:19], v[64:67]
    ds_read_b128 v[8:11], v4 offset:24576
    v_mfma_f32_16x16x32_bf16 v[72:75], v[16:19], a[20:23], v[72:75]
    v_mfma_f32_16x16x32_bf16 v[80:83], v[16:19], a[24:27], v[80:83]
    v_mfma_f32_16x16x32_bf16 v[88:91], v[16:19], a[28:31], v[88:91]
    s_waitcnt lgkmcnt(3)
    v_mfma_f32_16x16x32_bf16 v[68:71], v[20:23], a[16:19], v[68:71]
    ds_read_b128 v[12:15], v4 offset:25600
    v_mfma_f32_16x16x32_bf16 v[76:79], v[20:23], a[20:23], v[76:79]
    v_mfma_f32_16x16x32_bf16 v[84:87], v[20:23], a[24:27], v[84:87]
    v_mfma_f32_16x16x32_bf16 v[92:95], v[20:23], a[28:31], v[92:95]
    s_waitcnt lgkmcnt(3)
    v_mfma_f32_16x16x32_bf16 v[96:99], v[24:27], a[16:19], v[96:99]
    ds_read_b128 v[16:19], v4 offset:26624
    v_mfma_f32_16x16x32_bf16 v[104:107], v[24:27], a[20:23], v[104:107]
    v_mfma_f32_16x16x32_bf16 v[112:115], v[24:27], a[24:27], v[112:115]
    v_mfma_f32_16x16x32_bf16 v[120:123], v[24:27], a[28:31], v[120:123]
    s_waitcnt lgkmcnt(3)
    v_mfma_f32_16x16x32_bf16 v[100:103], v[28:31], a[16:19], v[100:103]
    ds_read_b128 v[20:23], v4 offset:27648
    v_mfma_f32_16x16x32_bf16 v[108:111], v[28:31], a[20:23], v[108:111]
    v_mfma_f32_16x16x32_bf16 v[116:119], v[28:31], a[24:27], v[116:119]
    v_mfma_f32_16x16x32_bf16 v[124:127], v[28:31], a[28:31], v[124:127]
    s_waitcnt lgkmcnt(3)
    v_mfma_f32_16x16x32_bf16 v[128:131], v[8:11], a[16:19], v[128:131]
    ds_read_b128 v[24:27], v4 offset:28672
    v_mfma_f32_16x16x32_bf16 v[136:139], v[8:11], a[20:23], v[136:139]
    v_mfma_f32_16x16x32_bf16 v[144:147], v[8:11], a[24:27], v[144:147]
    v_mfma_f32_16x16x32_bf16 v[152:155], v[8:11], a[28:31], v[152:155]
    s_waitcnt lgkmcnt(3)
    v_mfma_f32_16x16x32_bf16 v[132:135], v[12:15], a[16:19], v[132:135]
    ds_read_b128 v[28:31], v4 offset:29696
    v_mfma_f32_16x16x32_bf16 v[140:143], v[12:15], a[20:23], v[140:143]
    v_mfma_f32_16x16x32_bf16 v[148:151], v[12:15], a[24:27], v[148:151]
    v_mfma_f32_16x16x32_bf16 v[156:159], v[12:15], a[28:31], v[156:159]
    s_waitcnt lgkmcnt(3)
    v_mfma_f32_16x16x32_bf16 v[160:163], v[16:19], a[16:19], v[160:163]
    ds_read_b128 v[8:11], v4 offset:30720
    v_mfma_f32_16x16x32_bf16 v[164:167], v[16:19], a[20:23], v[164:167]
    v_mfma_f32_16x16x32_bf16 v[168:171], v[16:19], a[24:27], v[168:171]
    v_mfma_f32_16x16x32_bf16 v[172:175], v[16:19], a[28:31], v[172:175]
    s_waitcnt lgkmcnt(3)
    v_mfma_f32_16x16x32_bf16 v[32:35], v[20:23], a[32:35], v[32:35]
    ds_read_b128 v[12:15], v4 offset:31744
    v_mfma_f32_16x16x32_bf16 v[40:43], v[20:23], a[36:39], v[40:43]
    v_mfma_f32_16x16x32_bf16 v[48:51], v[20:23], a[40:43], v[48:51]
    v_mfma_f32_16x16x32_bf16 v[56:59], v[20:23], a[44:47], v[56:59]
    s_waitcnt lgkmcnt(3)
    v_mfma_f32_16x16x32_bf16 v[36:39], v[24:27], a[32:35], v[36:39]
    ds_read_b128 v[16:19], v4 offset:32768
    v_mfma_f32_16x16x32_bf16 v[44:47], v[24:27], a[36:39], v[44:47]
    v_mfma_f32_16x16x32_bf16 v[52:55], v[24:27], a[40:43], v[52:55]
    v_mfma_f32_16x16x32_bf16 v[60:63], v[24:27], a[44:47], v[60:63]
    s_waitcnt lgkmcnt(3)
    v_mfma_f32_16x16x32_bf16 v[64:67], v[28:31], a[32:35], v[64:67]
    ds_read_b128 v[20:23], v4 offset:33792
    v_mfma_f32_16x16x32_bf16 v[72:75], v[28:31], a[36:39], v[72:75]
    v_mfma_f32_16x16x32_bf16 v[80:83], v[28:31], a[40:43], v[80:83]
    v_mfma_f32_16x16x32_bf16 v[88:91], v[28:31], a[44:47], v[88:91]
    s_waitcnt lgkmcnt(3)
    v_mfma_f32_16x16x32_bf16 v[68:71], v[8:11], a[32:35], v[68:71]
    s_waitcnt vmcnt(0)
    v_cmp_eq_u64 vcc, s[98:99], v[6:7]
    s_nop 0
    s_cmp_eq_u64 vcc, exec
    s_cbranch_scc0 L_p2_slow_88
L_p2_back_89:
    v_mfma_f32_16x16x32_bf16 v[76:79], v[8:11], a[36:39], v[76:79]
    s_add_u32 s60, s56, 49152
    ds_read_b128 v[24:27], v4 offset:34816
    v_mfma_f32_16x16x32_bf16 v[84:87], v[8:11], a[40:43], v[84:87]
    buffer_load_dwordx4 a[160:163], v2, s[4:7], s60 offen offset:0 sc1
    v_mfma_f32_16x16x32_bf16 v[92:95], v[8:11], a[44:47], v[92:95]
    s_waitcnt lgkmcnt(3)
    s_and_b32 s68, s46, 1
    s_mul_i32 s69, s68, 5120
    v_mfma_f32_16x16x32_bf16 v[96:99], v[12:15], a[32:35], v[96:99]
    s_add_u32 s69, s69, s53
    s_lshl_b32 s68, s68, 9
    ds_read_b128 v[28:31], v4 offset:35840
    v_mfma_f32_16x16x32_bf16 v[104:107], v[12:15], a[36:39], v[104:107]
    s_add_u32 s68, s68, s53
    v_and_b32 v0, 15, v1
    v_lshlrev_b32 v0, 5, v0
    v_mfma_f32_16x16x32_bf16 v[112:115], v[12:15], a[40:43], v[112:115]
    buffer_load_dwordx4 a[164:167], v2, s[4:7], s60 offen offset:1024 sc1
    v_mfma_f32_16x16x32_bf16 v[120:123], v[12:15], a[44:47], v[120:123]
    s_waitcnt lgkmcnt(3)
    v_lshrrev_b32 v5, 4, v1
    v_lshl_add_u32 v0, v5, 3, v0
    v_mfma_f32_16x16x32_bf16 v[100:103], v[16:19], a[32:35], v[100:103]
    s_barrier
    v_add_u32 v4, 0x9000, v4
    v_mfma_f32_16x16x32_bf16 v[108:111], v[16:19], a[36:39], v[108:111]
    s_add_u32 m0, s63, 36864
    s_add_u32 s61, s62, 479232
    ds_read_b128 v[8:11], v4 offset:0
    v_mfma_f32_16x16x32_bf16 v[116:119], v[16:19], a[40:43], v[116:119]
    buffer_load_dwordx4 a[168:171], v2, s[4:7], s60 offen offset:2048 sc1
    v_mfma_f32_16x16x32_bf16 v[124:127], v[16:19], a[44:47], v[124:127]
    s_waitcnt lgkmcnt(3)
    v_mfma_f32_16x16x32_bf16 v[128:131], v[20:23], a[32:35], v[128:131]
    ds_read_b128 v[12:15], v4 offset:1024
    v_mfma_f32_16x16x32_bf16 v[136:139], v[20:23], a[36:39], v[136:139]
    v_mfma_f32_16x16x32_bf16 v[144:147], v[20:23], a[40:43], v[144:147]
    buffer_load_dwordx4 a[172:175], v2, s[4:7], s60 offen offset:3072 sc1
    v_mfma_f32_16x16x32_bf16 v[152:155], v[20:23], a[44:47], v[152:155]
    s_waitcnt lgkmcnt(3)
    s_add_u32 s60, s57, 49152
    v_mfma_f32_16x16x32_bf16 v[132:135], v[24:27], a[32:35], v[132:135]
    ds_read_b128 v[16:19], v4 offset:2048
    v_mfma_f32_16x16x32_bf16 v[140:143], v[24:27], a[36:39], v[140:143]
    v_mfma_f32_16x16x32_bf16 v[148:151], v[24:27], a[40:43], v[148:151]
    buffer_load_dwordx4 a[176:179], v2, s[4:7], s60 offen offset:0 sc1
    v_mfma_f32_16x16x32_bf16 v[156:159], v[24:27], a[44:47], v[156:159]
    s_waitcnt lgkmcnt(3)
    v_mfma_f32_16x16x32_bf16 v[160:163], v[28:31], a[32:35], v[160:163]
    ds_read_b128 v[20:23], v4 offset:3072
    v_mfma_f32_16x16x32_bf16 v[164:167], v[28:31], a[36:39], v[164:167]
    v_mfma_f32_16x16x32_bf16 v[168:171], v[28:31], a[40:43], v[168:171]
    buffer_load_dwordx4 a[180:183], v2, s[4:7], s60 offen offset:1024 sc1
    v_mfma_f32_16x16x32_bf16 v[172:175], v[28:31], a[44:47], v[172:175]
    s_waitcnt lgkmcnt(3)
    v_mfma_f32_16x16x32_bf16 v[32:35], v[8:11], a[48:51], v[32:35]
    ds_read_b128 v[24:27], v4 offset:4096
    v_mfma_f32_16x16x32_bf16 v[40:43], v[8:11], a[52:55], v[40:43]
    v_mfma_f32_16x16x32_bf16 v[48:51], v[8:11], a[56:59], v[48:51]
    buffer_load_dwordx4 a[184:187], v2, s[4:7], s60 offen offset:2048 sc1
    v_mfma_f32_16x16x32_bf16 v[56:59], v[8:11], a[60:63], v[56:59]
    s_waitcnt lgkmcnt(3)
    v_mfma_f32_16x16x32_bf16 v[36:39], v[12:15], a[48:51], v[36:39]
    ds_read_b128 v[28:31], v4 offset:5120
    v_mfma_f32_16x16x32_bf16 v[44:47], v[12:15], a[52:55], v[44:47]
    v_mfma_f32_16x16x32_bf16 v[52:55], v[12:15], a[56:59], v[52:55]
    buffer_load_dwordx4 a[188:191], v2, s[4:7], s60 offen offset:3072 sc1
    v_mfma_f32_16x16x32_bf16 v[60:63], v[12:15], a[60:63], v[60:63]
    s_waitcnt lgkmcnt(3)
    s_add_u32 s60, s58, 49152
    v_mfma_f32_16x16x32_bf16 v[64:67], v[16:19], a[48:51], v[64:67]
    ds_read_b128 v[8:11], v4 offset:6144
    v_mfma_f32_16x16x32_bf16 v[72:75], v[16:19], a[52:55], v[72:75]
    v_mfma_f32_16x16x32_bf16 v[80:83], v[16:19], a[56:59], v[80:83]
    buffer_load_dwordx4 a[192:195], v2, s[4:7], s60 offen offset:0 sc1
    v_mfma_f32_16x16x32_bf16 v[88:91], v[16:19], a[60:63], v[88:91]
    s_waitcnt lgkmcnt(3)
    v_mfma_f32_16x16x32_bf16 v[68:71], v[20:23], a[48:51], v[68:71]
    ds_read_b128 v[12:15], v4 offset:7168
    v_mfma_f32_16x16x32_bf16 v[76:79], v[20:23], a[52:55], v[76:79]
    v_mfma_f32_16x16x32_bf16 v[84:87], v[20:23], a[56:59], v[84:87]
    buffer_load_dwordx4 a[196:199], v2, s[4:7], s60 offen offset:1024 sc1
    v_mfma_f32_16x16x32_bf16 v[92:95], v[20:23], a[60:63], v[92:95]
    s_waitcnt lgkmcnt(3)
    v_mfma_f32_16x16x32_bf16 v[96:99], v[24:27], a[48:51], v[96:99]
    ds_read_b128 v[16:19], v4 offset:8192
    v_mfma_f32_16x16x32_bf16 v[104:107], v[24:27], a[52:55], v[104:107]
    v_mfma_f32_16x16x32_bf16 v[112:115], v[24:27], a[56:59], v[112:115]
    buffer_load_dwordx4 a[200:203], v2, s[4:7], s60 offen offset:2048 sc1
    v_mfma_f32_16x16x32_bf16 v[120:123], v[24:27], a[60:63], v[120:123]
    s_waitcnt lgkmcnt(3)
    v_mfma_f32_16x16x32_bf16 v[100:103], v[28:31], a[48:51], v[100:103]
    ds_read_b128 v[20:23], v4 offset:9216
    v_mfma_f32_16x16x32_bf16 v[108:111], v[28:31], a[52:55], v[108:111]
    v_mfma_f32_16x16x32_bf16 v[116:119], v[28:31], a[56:59], v[116:119]
    buffer_load_dwordx4 a[204:207], v2, s[4:7], s60 offen offset:3072 sc1
    v_mfma_f32_16x16x32_bf16 v[124:127], v[28:31], a[60:63], v[124:127]
    s_waitcnt lgkmcnt(3)
    v_mfma_f32_16x16x32_bf16 v[128:131], v[8:11], a[48:51], v[128:131]
    ds_read_b128 v[24:27], v4 offset:10240
    v_mfma_f32_16x16x32_bf16 v[136:139], v[8:11], a[52:55], v[136:139]
    v_mfma_f32_16x16x32_bf16 v[144:147], v[8:11], a[56:59], v[144:147]
    buffer_load_dwordx4 v2, s[4:7], s61 offen offset:0 lds
    v_mfma_f32_16x16x32_bf16 v[152:155], v[8:11], a[60:63], v[152:155]
    s_waitcnt lgkmcnt(3)
    v_mfma_f32_16x16x32_bf16 v[132:135], v[12:15], a[48:51], v[132:135]
    ds_read_b128 v[28:31], v4 offset:11264
    v_mfma_f32_16x16x32_bf16 v[140:143], v[12:15], a[52:55], v[140:143]
    v_mfma_f32_16x16x32_bf16 v[148:151], v[12:15], a[56:59], v[148:151]
    buffer_load_dwordx4 v2, s[4:7], s61 offen offset:1024 lds
    v_mfma_f32_16x16x32_bf16 v[156:159], v[12:15], a[60:63], v[156:159]
    s_waitcnt lgkmcnt(3)
    v_mfma_f32_16x16x32_bf16 v[160:163], v[16:19], a[48:51], v[160:163]
    ds_read_b128 v[8:11], v4 offset:12288
    v_mfma_f32_16x16x32_bf16 v[164:167], v[16:19], a[52:55], v[164:167]
    v_mfma_f32_16x16x32_bf16 v[168:171], v[16:19], a[56:59], v[168:171]
    buffer_load_dwordx4 v2, s[4:7], s61 offen offset:2048 lds
    v_mfma_f32_16x16x32_bf16 v[172:175], v[16:19], a[60:63], v[172:175]
    s_waitcnt lgkmcnt(3)
    v_mfma_f32_16x16x32_bf16 v[32:35], v[20:23], a[64:67], v[32:35]
    ds_read_b128 v[12:15], v4 offset:13312
    v_mfma_f32_16x16x32_bf16 v[40:43], v[20:23], a[68:71], v[40:43]
    v_mfma_f32_16x16x32_bf16 v[48:51], v[20:23], a[72:75], v[48:51]
    buffer_load_dwordx4 v2, s[4:7], s61 offen offset:3072 lds
    v_mfma_f32_16x16x32_bf16 v[56:59], v[20:23], a[76:79], v[56:59]
    s_waitcnt lgkmcnt(3)
    s_add_u32 m0, s63, 40960
    s_add_u32 s61, s62, 483328
    v_mfma_f32_16x16x32_bf16 v[36:39], v[24:27], a[64:67], v[36:39]
    ds_read_b128 v[16:19], v4 offset:14336
    v_mfma_f32_16x16x32_bf16 v[44:47], v[24:27], a[68:71], v[44:47]
    v_mfma_f32_16x16x32_bf16 v[52:55], v[24:27], a[72:75], v[52:55]
    buffer_load_dwordx4 v2, s[4:7], s61 offen offset:0 lds
    v_mfma_f32_16x16x32_bf16 v[60:63], v[24:27], a[76:79], v[60:63]
    s_waitcnt lgkmcnt(3)
    v_mfma_f32_16x16x32_bf16 v[32:35], v[28:31], a[80:83], v[32:35]
    s_and_b32 s62, s22, 15
    s_mul_i32 s62, s62, 129024
    ds_read_b128 v[20:23], v4 offset:15360
    v_mfma_f32_16x16x32_bf16 v[40:43], v[28:31], a[84:87], v[40:43]
    s_add_u32 s62, s62, 0
    v_mfma_f32_16x16x32_bf16 v[48:51], v[28:31], a[88:91], v[48:51]
    s_cmp_lg_u32 s101, 0
    s_cselect_b32 s62, 0x10000000, s62
    v_mfma_f32_16x16x32_bf16 v[56:59], v[28:31], a[92:95], v[56:59]
    s_waitcnt lgkmcnt(3)
    s_add_u32 s61, s63, 36864
    s_add_u32 m0, s61, 18432
    v_mfma_f32_16x16x32_bf16 v[36:39], v[8:11], a[80:83], v[36:39]
    s_add_u32 s61, s61, s62
    ds_read_b128 v[24:27], v4 offset:16384
    v_mfma_f32_16x16x32_bf16 v[44:47], v[8:11], a[84:87], v[44:47]
    buffer_load_dwordx4 v2, s[4:7], s61 offen offset:0 lds
    v_mfma_f32_16x16x32_bf16 v[52:55], v[8:11], a[88:91], v[52:55]
    v_mfma_f32_16x16x32_bf16 v[60:63], v[8:11], a[92:95], v[60:63]
    s_waitcnt lgkmcnt(3)
    v_mfma_f32_16x16x32_bf16 v[32:35], v[12:15], a[96:99], v[32:35]
    ds_read_b128 v[28:31], v4 offset:17408
    v_mfma_f32_16x16x32_bf16 v[40:43], v[12:15], a[100:103], v[40:43]
    buffer_load_dwordx4 v2, s[4:7], s61 offen offset:1024 lds
    v_mfma_f32_16x16x32_bf16 v[48:51], v[12:15], a[104:107], v[48:51]
    v_mfma_f32_16x16x32_bf16 v[56:59], v[12:15], a[108:111], v[56:59]
    s_waitcnt lgkmcnt(3)
    v_mfma_f32_16x16x32_bf16 v[36:39], v[16:19], a[96:99], v[36:39]
    ds_read_b128 v[8:11], v4 offset:18432
    v_mfma_f32_16x16x32_bf16 v[44:47], v[16:19], a[100:103], v[44:47]
    buffer_load_dwordx4 v2, s[4:7], s61 offen offset:2048 lds
    v_mfma_f32_16x16x32_bf16 v[52:55], v[16:19], a[104:107], v[52:55]
    v_mfma_f32_16x16x32_bf16 v[60:63], v[16:19], a[108:111], v[60:63]
    s_waitcnt lgkmcnt(3)
    v_mfma_f32_16x16x32_bf16 v[32:35], v[20:23], a[112:115], v[32:35]
    ds_read_b128 v[12:15], v4 offset:19456
    v_mfma_f32_16x16x32_bf16 v[40:43], v[20:23], a[116:119], v[40:43]
    buffer_load_dwordx4 v2, s[4:7], s61 offen offset:3072 lds
    v_mfma_f32_16x16x32_bf16 v[48:51], v[20:23], a[120:123], v[48:51]
    s_add_u32 s61, s63, 40960
    s_add_u32 m0, s61, 18432
    s_add_u32 s61, s61, s62
    v_mfma_f32_16x16x32_bf16 v[56:59], v[20:23], a[124:127], v[56:59]
    s_waitcnt lgkmcnt(3)
    v_mfma_f32_16x16x32_bf16 v[36:39], v[24:27], a[112:115], v[36:39]
    ds_read_b128 v[16:19], v4 offset:20480
    v_mfma_f32_16x16x32_bf16 v[44:47], v[24:27], a[116:119], v[44:47]
    buffer_load_dwordx4 v2, s[4:7], s61 offen offset:0 lds
    v_mfma_f32_16x16x32_bf16 v[52:55], v[24:27], a[120:123], v[52:55]
    v_mfma_f32_16x16x32_bf16 v[60:63], v[24:27], a[124:127], v[60:63]
    s_waitcnt lgkmcnt(3)
    v_mfma_f32_16x16x32_bf16 v[32:35], v[28:31], a[128:131], v[32:35]
    ds_read_b128 v[20:23], v4 offset:21504
    v_mfma_f32_16x16x32_bf16 v[40:43], v[28:31], a[132:135], v[40:43]
    v_mfma_f32_16x16x32_bf16 v[48:51], v[28:31], a[136:139], v[48:51]
    v_mfma_f32_16x16x32_bf16 v[56:59], v[28:31], a[140:143], v[56:59]
    s_waitcnt lgkmcnt(3)
    v_mfma_f32_16x16x32_bf16 v[36:39], v[8:11], a[128:131], v[36:39]
    ds_read_b128 v[24:27], v4 offset:22528
    v_mfma_f32_16x16x32_bf16 v[44:47], v[8:11], a[132:135], v[44:47]
    v_mfma_f32_16x16x32_bf16 v[52:55], v[8:11], a[136:139], v[52:55]
    v_mfma_f32_16x16x32_bf16 v[60:63], v[8:11], a[140:143], v[60:63]
    s_waitcnt lgkmcnt(3)
    v_mfma_f32_16x16x32_bf16 v[32:35], v[12:15], a[144:147], v[32:35]
    ds_read_b128 v[28:31], v4 offset:23552
    v_mfma_f32_16x16x32_bf16 v[40:43], v[12:15], a[148:151], v[40:43]
    v_mfma_f32_16x16x32_bf16 v[48:51], v[12:15], a[152:155], v[48:51]
    v_mfma_f32_16x16x32_bf16 v[56:59], v[12:15], a[156:159], v[56:59]
    s_waitcnt lgkmcnt(3)
    v_mfma_f32_16x16x32_bf16 v[36:39], v[16:19], a[144:147], v[36:39]
    ds_read_b128 v[8:11], v4 offset:24576
    v_mfma_f32_16x16x32_bf16 v[44:47], v[16:19], a[148:151], v[44:47]
    v_mfma_f32_16x16x32_bf16 v[52:55], v[16:19], a[152:155], v[52:55]
    v_mfma_f32_16x16x32_bf16 v[60:63], v[16:19], a[156:159], v[60:63]
    s_waitcnt vmcnt(21) lgkmcnt(3)
    v_mfma_f32_16x16x32_bf16 v[32:35], v[20:23], a[160:163], v[32:35]
    s_waitcnt vmcnt(20)
    ds_read_b128 v[12:15], v4 offset:25600
    v_mfma_f32_16x16x32_bf16 v[40:43], v[20:23], a[164:167], v[40:43]
    s_waitcnt vmcnt(19)
    v_mfma_f32_16x16x32_bf16 v[48:51], v[20:23], a[168:171], v[48:51]
    s_waitcnt vmcnt(18)
    v_mfma_f32_16x16x32_bf16 v[56:59], v[20:23], a[172:175], v[56:59]
    s_waitcnt lgkmcnt(3)
    v_mfma_f32_16x16x32_bf16 v[36:39], v[24:27], a[160:163], v[36:39]
    ds_read_b128 v[16:19], v4 offset:26624
    v_mfma_f32_16x16x32_bf16 v[44:47], v[24:27], a[164:167], v[44:47]
    v_mfma_f32_16x16x32_bf16 v[52:55], v[24:27], a[168:171], v[52:55]
    v_mfma_f32_16x16x32_bf16 v[60:63], v[24:27], a[172:175], v[60:63]
    s_waitcnt vmcnt(17) lgkmcnt(3)
    v_mfma_f32_16x16x32_bf16 v[32:35], v[28:31], a[176:179], v[32:35]
    s_waitcnt vmcnt(16)
    ds_read_b128 v[20:23], v4 offset:27648
    v_mfma_f32_16x16x32_bf16 v[40:43], v[28:31], a[180:183], v[40:43]
    s_waitcnt vmcnt(15)
    v_mfma_f32_16x16x32_bf16 v[48:51], v[28:31], a[184:187], v[48:51]
    s_waitcnt vmcnt(14)
    v_mfma_f32_16x16x32_bf16 v[56:59], v[28:31], a[188:191], v[56:59]
    s_waitcnt lgkmcnt(3)
    v_mfma_f32_16x16x32_bf16 v[36:39], v[8:11], a[176:179], v[36:39]
    ds_read_b128 v[24:27], v4 offset:28672
    v_mfma_f32_16x16x32_bf16 v[44:47], v[8:11], a[180:183], v[44:47]
    v_mfma_f32_16x16x32_bf16 v[52:55], v[8:11], a[184:187], v[52:55]
    v_mfma_f32_16x16x32_bf16 v[60:63], v[8:11], a[188:191], v[60:63]
    s_waitcnt vmcnt(13) lgkmcnt(3)
    v_mfma_f32_16x16x32_bf16 v[32:35], v[12:15], a[192:195], v[32:35]
    s_waitcnt vmcnt(12)
    ds_read_b128 v[28:31], v4 offset:29696
    v_mfma_f32_16x16x32_bf16 v[40:43], v[12:15], a[196:199], v[40:43]
    s_waitcnt vmcnt(11)
    v_mfma_f32_16x16x32_bf16 v[48:51], v[12:15], a[200:203], v[48:51]
    s_waitcnt vmcnt(10)
    v_mfma_f32_16x16x32_bf16 v[56:59], v[12:15], a[204:207], v[56:59]
    s_waitcnt lgkmcnt(3)
    v_mfma_f32_16x16x32_bf16 v[36:39], v[16:19], a[192:195], v[36:39]
    ds_read_b128 v[8:11], v4 offset:30720
    v_mfma_f32_16x16x32_bf16 v[44:47], v[16:19], a[196:199], v[44:47]
    v_mfma_f32_16x16x32_bf16 v[52:55], v[16:19], a[200:203], v[52:55]
    v_mfma_f32_16x16x32_bf16 v[60:63], v[16:19], a[204:207], v[60:63]
    s_waitcnt lgkmcnt(3)
    v_mfma_f32_16x16x32_bf16 v[64:67], v[20:23], a[64:67], v[64:67]
    ds_read_b128 v[12:15], v4 offset:31744
    v_mfma_f32_16x16x32_bf16 v[72:75], v[20:23], a[68:71], v[72:75]
    v_mfma_f32_16x16x32_bf16 v[80:83], v[20:23], a[72:75], v[80:83]
    v_mfma_f32_16x16x32_bf16 v[88:91], v[20:23], a[76:79], v[88:91]
    s_waitcnt lgkmcnt(3)
    v_cvt_pk_bf16_f32 v32, v32, v33
    v_cvt_pk_bf16_f32 v33, v34, v35
    v_mfma_f32_16x16x32_bf16 v[68:71], v[24:27], a[64:67], v[68:71]
    ds_read_b128 v[16:19], v4 offset:32768
    v_cvt_pk_bf16_f32 v34, v36, v37
    v_mfma_f32_16x16x32_bf16 v[76:79], v[24:27], a[68:71], v[76:79]
    v_cvt_pk_bf16_f32 v35, v38, v39
    v_mfma_f32_16x16x32_bf16 v[84:87], v[24:27], a[72:75], v[84:87]
    s_add_u32 s70, s69, 0
    v_mfma_f32_16x16x32_bf16 v[92:95], v[24:27], a[76:79], v[92:95]
    s_waitcnt lgkmcnt(3)
    v_mfma_f32_16x16x32_bf16 v[64:67], v[28:31], a[80:83], v[64:67]
    ds_read_b128 v[20:23], v4 offset:33792
    v_mfma_f32_16x16x32_bf16 v[72:75], v[28:31], a[84:87], v[72:75]
    buffer_store_dwordx4 v[32:35], v2, s[4:7], s70 offen sc1
    v_mfma_f32_16x16x32_bf16 v[80:83], v[28:31], a[88:91], v[80:83]
    v_cvt_pk_bf16_f32 v40, v40, v41
    v_cvt_pk_bf16_f32 v41, v42, v43
    v_mfma_f32_16x16x32_bf16 v[88:91], v[28:31], a[92:95], v[88:91]
    s_waitcnt lgkmcnt(3)
    v_cvt_pk_bf16_f32 v42, v44, v45
    v_cvt_pk_bf16_f32 v43, v46, v47
    v_mfma_f32_16x16x32_bf16 v[68:71], v[8:11], a[80:83], v[68:71]
    s_add_u32 s70, s69, 18432
    ds_read_b128 v[24:27], v4 offset:34816
    v_mfma_f32_16x16x32_bf16 v[76:79], v[8:11], a[84:87], v[76:79]
    buffer_store_dwordx4 v[40:43], v2, s[4:7], s70 offen sc1
    v_mfma_f32_16x16x32_bf16 v[84:87], v[8:11], a[88:91], v[84:87]
    v_cvt_pk_bf16_f32 v48, v48, v49
    v_cvt_pk_bf16_f32 v49, v50, v51
    v_mfma_f32_16x16x32_bf16 v[92:95], v[8:11], a[92:95], v[92:95]
    s_waitcnt lgkmcnt(3)
    v_cvt_pk_bf16_f32 v50, v52, v53
    v_cvt_pk_bf16_f32 v51, v54, v55
    v_mfma_f32_16x16x32_bf16 v[64:67], v[12:15], a[96:99], v[64:67]
    s_add_u32 s70, s69, 36864
    ds_read_b128 v[28:31], v4 offset:35840
    v_mfma_f32_16x16x32_bf16 v[72:75], v[12:15], a[100:103], v[72:75]
    buffer_store_dwordx4 v[48:51], v2, s[4:7], s70 offen sc1
    v_mfma_f32_16x16x32_bf16 v[80:83], v[12:15], a[104:107], v[80:83]
    v_cvt_pk_bf16_f32 v56, v56, v57
    v_cvt_pk_bf16_f32 v57, v58, v59
    v_mfma_f32_16x16x32_bf16 v[88:91], v[12:15], a[108:111], v[88:91]
    s_waitcnt lgkmcnt(3)
    v_cvt_pk_bf16_f32 v58, v60, v61
    v_cvt_pk_bf16_f32 v59, v62, v63
    v_mfma_f32_16x16x32_bf16 v[68:71], v[16:19], a[96:99], v[68:71]
    s_barrier
    v_add_u32 v4, 0xfffe5000, v4
    v_mfma_f32_16x16x32_bf16 v[76:79], v[16:19], a[100:103], v[76:79]
    s_add_u32 s70, s69, 55296
    s_add_u32 s61, s49, 55296
    ds_read_b128 v[8:11], v4 offset:0
    v_mfma_f32_16x16x32_bf16 v[84:87], v[16:19], a[104:107], v[84:87]
    buffer_store_dwordx4 v[56:59], v2, s[4:7], s70 offen sc1
    v_mfma_f32_16x16x32_bf16 v[92:95], v[16:19], a[108:111], v[92:95]
    s_waitcnt lgkmcnt(3)
    s_add_u32 m0, s61, 18432
    s_add_u32 s61, s61, s62
    v_mfma_f32_16x16x32_bf16 v[64:67], v[20:23], a[112:115], v[64:67]
    ds_read_b128 v[12:15], v4 offset:1024
    v_mfma_f32_16x16x32_bf16 v[72:75], v[20:23], a[116:119], v[72:75]
    v_mfma_f32_16x16x32_bf16 v[80:83], v[20:23], a[120:123], v[80:83]
    buffer_load_dwordx4 v2, s[4:7], s61 offen offset:0 lds
    v_mfma_f32_16x16x32_bf16 v[88:91], v[20:23], a[124:127], v[88:91]
    s_waitcnt lgkmcnt(3)
    v_mfma_f32_16x16x32_bf16 v[68:71], v[24:27], a[112:115], v[68:71]
    ds_read_b128 v[16:19], v4 offset:2048
    v_mfma_f32_16x16x32_bf16 v[76:79], v[24:27], a[116:119], v[76:79]
    v_mfma_f32_16x16x32_bf16 v[84:87], v[24:27], a[120:123], v[84:87]
    buffer_load_dwordx4 v2, s[4:7], s61 offen offset:1024 lds
    v_mfma_f32_16x16x32_bf16 v[92:95], v[24:27], a[124:127], v[92:95]
    s_waitcnt lgkmcnt(3)
    v_mfma_f32_16x16x32_bf16 v[64:67], v[28:31], a[128:131], v[64:67]
    ds_read_b128 v[20:23], v4 offset:3072
    v_mfma_f32_16x16x32_bf16 v[72:75], v[28:31], a[132:135], v[72:75]
    v_mfma_f32_16x16x32_bf16 v[80:83], v[28:31], a[136:139], v[80:83]
    buffer_load_dwordx4 v2, s[4:7], s61 offen offset:2048 lds
    v_mfma_f32_16x16x32_bf16 v[88:91], v[28:31], a[140:143], v[88:91]
    s_waitcnt lgkmcnt(3)
    v_mfma_f32_16x16x32_bf16 v[68:71], v[8:11], a[128:131], v[68:71]
    ds_read_b128 v[24:27], v4 offset:4096
    v_mfma_f32_16x16x32_bf16 v[76:79], v[8:11], a[132:135], v[76:79]
    v_mfma_f32_16x16x32_bf16 v[84:87], v[8:11], a[136:139], v[84:87]
    buffer_load_dwordx4 v2, s[4:7], s61 offen offset:3072 lds
    v_mfma_f32_16x16x32_bf16 v[92:95], v[8:11], a[140:143], v[92:95]
    s_waitcnt lgkmcnt(3)
    s_add_u32 s61, s49, 59392
    s_add_u32 m0, s61, 18432
    v_mfma_f32_16x16x32_bf16 v[64:67], v[12:15], a[144:147], v[64:67]
    s_add_u32 s61, s61, s62
    ds_read_b128 v[28:31], v4 offset:5120
    v_mfma_f32_16x16x32_bf16 v[72:75], v[12:15], a[148:151], v[72:75]
    v_mfma_f32_16x16x32_bf16 v[80:83], v[12:15], a[152:155], v[80:83]
    buffer_load_dwordx4 v2, s[4:7], s61 offen offset:0 lds
    v_mfma_f32_16x16x32_bf16 v[88:91], v[12:15], a[156:159], v[88:91]
    s_waitcnt lgkmcnt(3)
    v_mfma_f32_16x16x32_bf16 v[68:71], v[16:19], a[144:147], v[68:71]
    ds_read_b128 v[8:11], v4 offset:6144
    v_mfma_f32_16x16x32_bf16 v[76:79], v[16:19], a[148:151], v[76:79]
    v_mfma_f32_16x16x32_bf16 v[84:87], v[16:19], a[152:155], v[84:87]
    buffer_load_dwordx4 v2, s[4:7], s61 offen offset:1024 lds
    v_mfma_f32_16x16x32_bf16 v[92:95], v[16:19], a[156:159], v[92:95]
    s_waitcnt lgkmcnt(3)
    v_mfma_f32_16x16x32_bf16 v[64:67], v[20:23], a[160:163], v[64:67]
    ds_read_b128 v[12:15], v4 offset:7168
    v_mfma_f32_16x16x32_bf16 v[72:75], v[20:23], a[164:167], v[72:75]
    v_mfma_f32_16x16x32_bf16 v[80:83], v[20:23], a[168:171], v[80:83]
    buffer_load_dwordx4 v2, s[4:7], s61 offen offset:2048 lds
    v_mfma_f32_16x16x32_bf16 v[88:91], v[20:23], a[172:175], v[88:91]
    s_waitcnt lgkmcnt(3)
    v_mfma_f32_16x16x32_bf16 v[68:71], v[24:27], a[160:163], v[68:71]
    ds_read_b128 v[16:19], v4 offset:8192
    v_mfma_f32_16x16x32_bf16 v[76:79], v[24:27], a[164:167], v[76:79]
    v_mfma_f32_16x16x32_bf16 v[84:87], v[24:27], a[168:171], v[84:87]
    buffer_load_dwordx4 v2, s[4:7], s61 offen offset:3072 lds
    v_mfma_f32_16x16x32_bf16 v[92:95], v[24:27], a[172:175], v[92:95]
    s_waitcnt lgkmcnt(3)
    s_add_u32 s61, s49, 63488
    s_add_u32 m0, s61, 18432
    v_mfma_f32_16x16x32_bf16 v[64:67], v[28:31], a[176:179], v[64:67]
    s_add_u32 s61, s61, s62
    ds_read_b128 v[20:23], v4 offset:9216
    v_mfma_f32_16x16x32_bf16 v[72:75], v[28:31], a[180:183], v[72:75]
    v_mfma_f32_16x16x32_bf16 v[80:83], v[28:31], a[184:187], v[80:83]
    buffer_load_dwordx4 v2, s[4:7], s61 offen offset:0 lds
    v_mfma_f32_16x16x32_bf16 v[88:91], v[28:31], a[188:191], v[88:91]
    s_waitcnt lgkmcnt(3)
    v_mfma_f32_16x16x32_bf16 v[68:71], v[8:11], a[176:179], v[68:71]
    ds_read_b128 v[24:27], v4 offset:10240
    v_mfma_f32_16x16x32_bf16 v[76:79], v[8:11], a[180:183], v[76:79]
    v_mfma_f32_16x16x32_bf16 v[84:87], v[8:11], a[184:187], v[84:87]
    v_mfma_f32_16x16x32_bf16 v[92:95], v[8:11], a[188:191], v[92:95]
    s_waitcnt lgkmcnt(3)
    v_mfma_f32_16x16x32_bf16 v[64:67], v[12:15], a[192:195], v[64:67]
    ds_read_b128 v[28:31], v4 offset:11264
    v_mfma_f32_16x16x32_bf16 v[72:75], v[12:15], a[196:199], v[72:75]
    v_mfma_f32_16x16x32_bf16 v[80:83], v[12:15], a[200:203], v[80:83]
    v_mfma_f32_16x16x32_bf16 v[88:91], v[12:15], a[204:207], v[88:91]
    s_waitcnt lgkmcnt(3)
    v_mfma_f32_16x16x32_bf16 v[68:71], v[16:19], a[192:195], v[68:71]
    ds_read_b128 v[8:11], v4 offset:12288
    v_mfma_f32_16x16x32_bf16 v[76:79], v[16:19], a[196:199], v[76:79]
    v_mfma_f32_16x16x32_bf16 v[84:87], v[16:19], a[200:203], v[84:87]
    v_mfma_f32_16x16x32_bf16 v[92:95], v[16:19], a[204:207], v[92:95]
    s_waitcnt lgkmcnt(3)
    v_mfma_f32_16x16x32_bf16 v[96:99], v[20:23], a[64:67], v[96:99]
    ds_read_b128 v[12:15], v4 offset:13312
    v_mfma_f32_16x16x32_bf16 v[104:107], v[20:23], a[68:71], v[104:107]
    v_mfma_f32_16x16x32_bf16 v[112:115], v[20:23], a[72:75], v[112:115]
    v_mfma_f32_16x16x32_bf16 v[120:123], v[20:23], a[76:79], v[120:123]
    s_waitcnt lgkmcnt(3)
    v_cvt_pk_bf16_f32 v64, v64, v65
    v_cvt_pk_bf16_f32 v65, v66, v67
    v_mfma_f32_16x16x32_bf16 v[100:103], v[24:27], a[64:67], v[100:103]
    ds_read_b128 v[16:19], v4 offset:14336
    v_cvt_pk_bf16_f32 v66, v68, v69
    v_mfma_f32_16x16x32_bf16 v[108:111], v[24:27], a[68:71], v[108:111]
    v_cvt_pk_bf16_f32 v67, v70, v71
    v_mfma_f32_16x16x32_bf16 v[116:119], v[24:27], a[72:75], v[116:119]
    s_add_u32 s70, s69, 1024
    v_mfma_f32_16x16x32_bf16 v[124:127], v[24:27], a[76:79], v[124:127]
    s_waitcnt lgkmcnt(3)
    v_mfma_f32_16x16x32_bf16 v[96:99], v[28:31], a[80:83], v[96:99]
    ds_read_b128 v[20:23], v4 offset:15360
    v_mfma_f32_16x16x32_bf16 v[104:107], v[28:31], a[84:87], v[104:107]
    buffer_store_dwordx4 v[64:67], v2, s[4:7], s70 offen sc1
    v_mfma_f32_16x16x32_bf16 v[112:115], v[28:31], a[88:91], v[112:115]
    v_cvt_pk_bf16_f32 v72, v72, v73
    v_cvt_pk_bf16_f32 v73, v74, v75
    v_mfma_f32_16x16x32_bf16 v[120:123], v[28:31], a[92:95], v[120:123]
    s_waitcnt lgkmcnt(3)
    v_cvt_pk_bf16_f32 v74, v76, v77
    v_cvt_pk_bf16_f32 v75, v78, v79
    v_mfma_f32_16x16x32_bf16 v[100:103], v[8:11], a[80:83], v[100:103]
    s_add_u32 s70, s69, 19456
    ds_read_b128 v[24:27], v4 offset:16384
    v_mfma_f32_16x16x32_bf16 v[108:111], v[8:11], a[84:87], v[108:111]
    buffer_store_dwordx4 v[72:75], v2, s[4:7], s70 offen sc1
    v_mfma_f32_16x16x32_bf16 v[116:119], v[8:11], a[88:91], v[116:119]
    v_cvt_pk_bf16_f32 v80, v80, v81
    v_cvt_pk_bf16_f32 v81, v82, v83
    v_mfma_f32_16x16x32_bf16 v[124:127], v[8:11], a[92:95], v[124:127]
    s_waitcnt lgkmcnt(3)
    v_cvt_pk_bf16_f32 v82, v84, v85
    v_cvt_pk_bf16_f32 v83, v86, v87
    v_mfma_f32_16x16x32_bf16 v[96:99], v[12:15], a[96:99], v[96:99]
    s_add_u32 s70, s69, 37888
    ds_read_b128 v[28:31], v4 offset:17408
    v_mfma_f32_16x16x32_bf16 v[104:107], v[12:15], a[100:103], v[104:107]
    buffer_store_dwordx4 v[80:83], v2, s[4:7], s70 offen sc1
    v_mfma_f32_16x16x32_bf16 v[112:115], v[12:15], a[104:107], v[112:115]
    v_cvt_pk_bf16_f32 v88, v88, v89
    v_cvt_pk_bf16_f32 v89, v90, v91
    v_mfma_f32_16x16x32_bf16 v[120:123], v[12:15], a[108:111], v[120:123]
    s_waitcnt lgkmcnt(3)
    v_cvt_pk_bf16_f32 v90, v92, v93
    v_cvt_pk_bf16_f32 v91, v94, v95
    v_mfma_f32_16x16x32_bf16 v[100:103], v[16:19], a[96:99], v[100:103]
    s_add_u32 s70, s69, 56320
    ds_read_b128 v[8:11], v4 offset:18432
    v_mfma_f32_16x16x32_bf16 v[108:111], v[16:19], a[100:103], v[108:111]
    buffer_store_dwordx4 v[88:91], v2, s[4:7], s70 offen sc1
    v_mfma_f32_16x16x32_bf16 v[116:119], v[16:19], a[104:107], v[116:119]
    v_mfma_f32_16x16x32_bf16 v[124:127], v[16:19], a[108:111], v[124:127]
    s_waitcnt lgkmcnt(3)
    v_mfma_f32_16x16x32_bf16 v[96:99], v[20:23], a[112:115], v[96:99]
    ds_read_b128 v[12:15], v4 offset:19456
    v_mfma_f32_16x16x32_bf16 v[104:107], v[20:23], a[116:119], v[104:107]
    v_mfma_f32_16x16x32_bf16 v[112:115], v[20:23], a[120:123], v[112:115]
    v_mfma_f32_16x16x32_bf16 v[120:123], v[20:23], a[124:127], v[120:123]
    s_waitcnt lgkmcnt(3)
    v_mfma_f32_16x16x32_bf16 v[100:103], v[24:27], a[112:115], v[100:103]
    ds_read_b128 v[16:19], v4 offset:20480
    v_mfma_f32_16x16x32_bf16 v[108:111], v[24:27], a[116:119], v[108:111]
    v_mfma_f32_16x16x32_bf16 v[116:119], v[24:27], a[120:123], v[116:119]
    v_mfma_f32_16x16x32_bf16 v[124:127], v[24:27], a[124:127], v[124:127]
    s_waitcnt lgkmcnt(3)
    v_mfma_f32_16x16x32_bf16 v[96:99], v[28:31], a[128:131], v[96:99]
    ds_read_b128 v[20:23], v4 offset:21504
    v_mfma_f32_16x16x32_bf16 v[104:107], v[28:31], a[132:135], v[104:107]
    v_mfma_f32_16x16x32_bf16 v[112:115], v[28:31], a[136:139], v[112:115]
    v_mfma_f32_16x16x32_bf16 v[120:123], v[28:31], a[140:143], v[120:123]
    s_waitcnt lgkmcnt(3)
    v_mfma_f32_16x16x32_bf16 v[100:103], v[8:11], a[128:131], v[100:103]
    ds_read_b128 v[24:27], v4 offset:22528
    v_mfma_f32_16x16x32_bf16 v[108:111], v[8:11], a[132:135], v[108:111]
    v_mfma_f32_16x16x32_bf16 v[116:119], v[8:11], a[136:139], v[116:119]
    v_mfma_f32_16x16x32_bf16 v[124:127], v[8:11], a[140:143], v[124:127]
    s_waitcnt lgkmcnt(3)
    v_mfma_f32_16x16x32_bf16 v[96:99], v[12:15], a[144:147], v[96:99]
    ds_read_b128 v[28:31], v4 offset:23552
    v_mfma_f32_16x16x32_bf16 v[104:107], v[12:15], a[148:151], v[104:107]
    v_mfma_f32_16x16x32_bf16 v[112:115], v[12:15], a[152:155], v[112:115]
    v_mfma_f32_16x16x32_bf16 v[120:123], v[12:15], a[156:159], v[120:123]
    s_waitcnt lgkmcnt(3)
    v_mfma_f32_16x16x32_bf16 v[100:103], v[16:19], a[144:147], v[100:103]
    ds_read_b128 v[8:11], v4 offset:24576
    v_mfma_f32_16x16x32_bf16 v[108:111], v[16:19], a[148:151], v[108:111]
    v_mfma_f32_16x16x32_bf16 v[116:119], v[16:19], a[152:155], v[116:119]
    v_mfma_f32_16x16x32_bf16 v[124:127], v[16:19], a[156:159], v[124:127]
    s_waitcnt lgkmcnt(3)
    v_mfma_f32_16x16x32_bf16 v[96:99], v[20:23], a[160:163], v[96:99]
    ds_read_b128 v[12:15], v4 offset:25600
    v_mfma_f32_16x16x32_bf16 v[104:107], v[20:23], a[164:167], v[104:107]
    v_mfma_f32_16x16x32_bf16 v[112:115], v[20:23], a[168:171], v[112:115]
    v_mfma_f32_16x16x32_bf16 v[120:123], v[20:23], a[172:175], v[120:123]
    s_waitcnt lgkmcnt(3)
    v_mfma_f32_16x16x32_bf16 v[100:103], v[24:27], a[160:163], v[100:103]
    ds_read_b128 v[16:19], v4 offset:26624
    v_mfma_f32_16x16x32_bf16 v[108:111], v[24:27], a[164:167], v[108:111]
    v_mfma_f32_16x16x32_bf16 v[116:119], v[24:27], a[168:171], v[116:119]
    v_mfma_f32_16x16x32_bf16 v[124:127], v[24:27], a[172:175], v[124:127]
    s_waitcnt lgkmcnt(3)
    v_mfma_f32_16x16x32_bf16 v[96:99], v[28:31], a[176:179], v[96:99]
    ds_read_b128 v[20:23], v4 offset:27648
    v_mfma_f32_16x16x32_bf16 v[104:107], v[28:31], a[180:183], v[104:107]
    v_mfma_f32_16x16x32_bf16 v[112:115], v[28:31], a[184:187], v[112:115]
    v_mfma_f32_16x16x32_bf16 v[120:123], v[28:31], a[188:191], v[120:123]
    s_waitcnt lgkmcnt(3)
    v_mfma_f32_16x16x32_bf16 v[100:103], v[8:11], a[176:179], v[100:103]
    ds_read_b128 v[24:27], v4 offset:28672
    v_mfma_f32_16x16x32_bf16 v[108:111], v[8:11], a[180:183], v[108:111]
    v_mfma_f32_16x16x32_bf16 v[116:119], v[8:11], a[184:187], v[116:119]
    v_mfma_f32_16x16x32_bf16 v[124:127], v[8:11], a[188:191], v[124:127]
    s_waitcnt lgkmcnt(3)
    v_mfma_f32_16x16x32_bf16 v[96:99], v[12:15], a[192:195], v[96:99]
    ds_read_b128 v[28:31], v4 offset:29696
    v_mfma_f32_16x16x32_bf16 v[104:107], v[12:15], a[196:199], v[104:107]
    v_mfma_f32_16x16x32_bf16 v[112:115], v[12:15], a[200:203], v[112:115]
    v_mfma_f32_16x16x32_bf16 v[120:123], v[12:15], a[204:207], v[120:123]
    s_waitcnt lgkmcnt(3)
    v_mfma_f32_16x16x32_bf16 v[100:103], v[16:19], a[192:195], v[100:103]
    ds_read_b128 v[8:11], v4 offset:30720
    v_mfma_f32_16x16x32_bf16 v[108:111], v[16:19], a[196:199], v[108:111]
    v_mfma_f32_16x16x32_bf16 v[116:119], v[16:19], a[200:203], v[116:119]
    v_mfma_f32_16x16x32_bf16 v[124:127], v[16:19], a[204:207], v[124:127]
    s_waitcnt lgkmcnt(3)
    v_mfma_f32_16x16x32_bf16 v[128:131], v[20:23], a[64:67], v[128:131]
    ds_read_b128 v[12:15], v4 offset:31744
    v_mfma_f32_16x16x32_bf16 v[136:139], v[20:23], a[68:71], v[136:139]
    v_mfma_f32_16x16x32_bf16 v[144:147], v[20:23], a[72:75], v[144:147]
    v_mfma_f32_16x16x32_bf16 v[152:155], v[20:23], a[76:79], v[152:155]
    s_waitcnt lgkmcnt(3)
    v_cvt_pk_bf16_f32 v96, v96, v97
    v_cvt_pk_bf16_f32 v97, v98, v99
    v_mfma_f32_16x16x32_bf16 v[132:135], v[24:27], a[64:67], v[132:135]
    ds_read_b128 v[16:19], v4 offset:32768
    v_cvt_pk_bf16_f32 v98, v100, v101
    v_mfma_f32_16x16x32_bf16 v[140:143], v[24:27], a[68:71], v[140:143]
    v_cvt_pk_bf16_f32 v99, v102, v103
    v_mfma_f32_16x16x32_bf16 v[148:151], v[24:27], a[72:75], v[148:151]
    s_add_u32 s70, s69, 2048
    v_mfma_f32_16x16x32_bf16 v[156:159], v[24:27], a[76:79], v[156:159]
    s_waitcnt lgkmcnt(3)
    v_mfma_f32_16x16x32_bf16 v[128:131], v[28:31], a[80:83], v[128:131]
    ds_read_b128 v[20:23], v4 offset:33792
    v_mfma_f32_16x16x32_bf16 v[136:139], v[28:31], a[84:87], v[136:139]
    buffer_store_dwordx4 v[96:99], v2, s[4:7], s70 offen sc1
    v_mfma_f32_16x16x32_bf16 v[144:147], v[28:31], a[88:91], v[144:147]
    v_cvt_pk_bf16_f32 v104, v104, v105
    v_cvt_pk_bf16_f32 v105, v106, v107
    v_mfma_f32_16x16x32_bf16 v[152:155], v[28:31], a[92:95], v[152:155]
    s_waitcnt lgkmcnt(3)
    v_cvt_pk_bf16_f32 v106, v108, v109
    v_cvt_pk_bf16_f32 v107, v110, v111
    v_mfma_f32_16x16x32_bf16 v[132:135], v[8:11], a[80:83], v[132:135]
    s_add_u32 s70, s69, 20480
    ds_read_b128 v[24:27], v4 offset:34816
    v_mfma_f32_16x16x32_bf16 v[140:143], v[8:11], a[84:87], v[140:143]
    buffer_store_dwordx4 v[104:107], v2, s[4:7], s70 offen sc1
    v_mfma_f32_16x16x32_bf16 v[148:151], v[8:11], a[88:91], v[148:151]
    v_cvt_pk_bf16_f32 v112, v112, v113
    v_cvt_pk_bf16_f32 v113, v114, v115
    v_mfma_f32_16x16x32_bf16 v[156:159], v[8:11], a[92:95], v[156:159]
    s_waitcnt lgkmcnt(3)
    v_cvt_pk_bf16_f32 v114, v116, v117
    v_cvt_pk_bf16_f32 v115, v118, v119
    v_mfma_f32_16x16x32_bf16 v[128:131], v[12:15], a[96:99], v[128:131]
    s_add_u32 s70, s69, 38912
    ds_read_b128 v[28:31], v4 offset:35840
    v_mfma_f32_16x16x32_bf16 v[136:139], v[12:15], a[100:103], v[136:139]
    buffer_store_dwordx4 v[112:115], v2, s[4:7], s70 offen sc1
    v_mfma_f32_16x16x32_bf16 v[144:147], v[12:15], a[104:107], v[144:147]
    v_cvt_pk_bf16_f32 v120, v120, v121
    v_cvt_pk_bf16_f32 v121, v122, v123
    v_mfma_f32_16x16x32_bf16 v[152:155], v[12:15], a[108:111], v[152:155]
    s_waitcnt lgkmcnt(3)
    v_cvt_pk_bf16_f32 v122, v124, v125
    v_cvt_pk_bf16_f32 v123, v126, v127
    v_mfma_f32_16x16x32_bf16 v[132:135], v[16:19], a[96:99], v[132:135]
    s_waitcnt vmcnt(25)
    s_barrier
    v_add_u32 v4, 0x9000, v4
    v_mfma_f32_16x16x32_bf16 v[140:143], v[16:19], a[100:103], v[140:143]
    s_add_u32 s70, s69, 57344
    s_add_u32 s61, s49, 92160
    ds_read_b128 v[8:11], v4 offset:0
    v_mfma_f32_16x16x32_bf16 v[148:151], v[16:19], a[104:107], v[148:151]
    buffer_store_dwordx4 v[120:123], v2, s[4:7], s70 offen sc1
    v_mfma_f32_16x16x32_bf16 v[156:159], v[16:19], a[108:111], v[156:159]
    s_waitcnt lgkmcnt(3)
    s_add_u32 m0, s61, 18432
    s_add_u32 s61, s61, s62
    v_mfma_f32_16x16x32_bf16 v[128:131], v[20:23], a[112:115], v[128:131]
    ds_read_b128 v[12:15], v4 offset:1024
    v_mfma_f32_16x16x32_bf16 v[136:139], v[20:23], a[116:119], v[136:139]
    v_mfma_f32_16x16x32_bf16 v[144:147], v[20:23], a[120:123], v[144:147]
    buffer_load_dwordx4 v2, s[4:7], s61 offen offset:0 lds
    v_mfma_f32_16x16x32_bf16 v[152:155], v[20:23], a[124:127], v[152:155]
    s_waitcnt lgkmcnt(3)
    v_mfma_f32_16x16x32_bf16 v[132:135], v[24:27], a[112:115], v[132:135]
    ds_read_b128 v[16:19], v4 offset:2048
    v_mfma_f32_16x16x32_bf16 v[140:143], v[24:27], a[116:119], v[140:143]
    v_mfma_f32_16x16x32_bf16 v[148:151], v[24:27], a[120:123], v[148:151]
    buffer_load_dwordx4 v2, s[4:7], s61 offen offset:1024 lds
    v_mfma_f32_16x16x32_bf16 v[156:159], v[24:27], a[124:127], v[156:159]
    s_waitcnt lgkmcnt(3)
    v_mfma_f32_16x16x32_bf16 v[128:131], v[28:31], a[128:131], v[128:131]
    ds_read_b128 v[20:23], v4 offset:3072
    v_mfma_f32_16x16x32_bf16 v[136:139], v[28:31], a[132:135], v[136:139]
    v_mfma_f32_16x16x32_bf16 v[144:147], v[28:31], a[136:139], v[144:147]
    buffer_load_dwordx4 v2, s[4:7], s61 offen offset:2048 lds
    v_mfma_f32_16x16x32_bf16 v[152:155], v[28:31], a[140:143], v[152:155]
    s_waitcnt lgkmcnt(3)
    v_mfma_f32_16x16x32_bf16 v[132:135], v[8:11], a[128:131], v[132:135]
    ds_read_b128 v[24:27], v4 offset:4096
    v_mfma_f32_16x16x32_bf16 v[140:143], v[8:11], a[132:135], v[140:143]
    v_mfma_f32_16x16x32_bf16 v[148:151], v[8:11], a[136:139], v[148:151]
    buffer_load_dwordx4 v2, s[4:7], s61 offen offset:3072 lds
    v_mfma_f32_16x16x32_bf16 v[156:159], v[8:11], a[140:143], v[156:159]
    s_waitcnt lgkmcnt(3)
    s_add_u32 s61, s49, 96256
    s_add_u32 m0, s61, 18432
    v_mfma_f32_16x16x32_bf16 v[128:131], v[12:15], a[144:147], v[128:131]
    s_add_u32 s61, s61, s62
    ds_read_b128 v[28:31], v4 offset:5120
    v_mfma_f32_16x16x32_bf16 v[136:139], v[12:15], a[148:151], v[136:139]
    v_mfma_f32_16x16x32_bf16 v[144:147], v[12:15], a[152:155], v[144:147]
    buffer_load_dwordx4 v2, s[4:7], s61 offen offset:0 lds
    v_mfma_f32_16x16x32_bf16 v[152:155], v[12:15], a[156:159], v[152:155]
    s_waitcnt lgkmcnt(3)
    v_mfma_f32_16x16x32_bf16 v[132:135], v[16:19], a[144:147], v[132:135]
    ds_read_b128 v[8:11], v4 offset:6144
    v_mfma_f32_16x16x32_bf16 v[140:143], v[16:19], a[148:151], v[140:143]
    v_mfma_f32_16x16x32_bf16 v[148:151], v[16:19], a[152:155], v[148:151]
    buffer_load_dwordx4 v2, s[4:7], s61 offen offset:1024 lds
    v_mfma_f32_16x16x32_bf16 v[156:159], v[16:19], a[156:159], v[156:159]
    s_waitcnt lgkmcnt(3)
    v_mfma_f32_16x16x32_bf16 v[128:131], v[20:23], a[160:163], v[128:131]
    ds_read_b128 v[12:15], v4 offset:7168
    v_mfma_f32_16x16x32_bf16 v[136:139], v[20:23], a[164:167], v[136:139]
    v_mfma_f32_16x16x32_bf16 v[144:147], v[20:23], a[168:171], v[144:147]
    buffer_load_dwordx4 v2, s[4:7], s61 offen offset:2048 lds
    v_mfma_f32_16x16x32_bf16 v[152:155], v[20:23], a[172:175], v[152:155]
    s_waitcnt lgkmcnt(3)
    v_mfma_f32_16x16x32_bf16 v[132:135], v[24:27], a[160:163], v[132:135]
    ds_read_b128 v[16:19], v4 offset:8192
    v_mfma_f32_16x16x32_bf16 v[140:143], v[24:27], a[164:167], v[140:143]
    v_mfma_f32_16x16x32_bf16 v[148:151], v[24:27], a[168:171], v[148:151]
    buffer_load_dwordx4 v2, s[4:7], s61 offen offset:3072 lds
    v_mfma_f32_16x16x32_bf16 v[156:159], v[24:27], a[172:175], v[156:159]
    s_waitcnt lgkmcnt(3)
    s_add_u32 s61, s49, 100352
    s_add_u32 m0, s61, 18432
    v_mfma_f32_16x16x32_bf16 v[128:131], v[28:31], a[176:179], v[128:131]
    s_add_u32 s61, s61, s62
    ds_read_b128 v[20:23], v4 offset:9216
    v_mfma_f32_16x16x32_bf16 v[136:139], v[28:31], a[180:183], v[136:139]
    v_mfma_f32_16x16x32_bf16 v[144:147], v[28:31], a[184:187], v[144:147]
    buffer_load_dwordx4 v2, s[4:7], s61 offen offset:0 lds
    v_mfma_f32_16x16x32_bf16 v[152:155], v[28:31], a[188:191], v[152:155]
    s_waitcnt lgkmcnt(3)
    v_mfma_f32_16x16x32_bf16 v[132:135], v[8:11], a[176:179], v[132:135]
    ds_read_b128 v[24:27], v4 offset:10240
    v_mfma_f32_16x16x32_bf16 v[140:143], v[8:11], a[180:183], v[140:143]
    v_mfma_f32_16x16x32_bf16 v[148:151], v[8:11], a[184:187], v[148:151]
    v_mfma_f32_16x16x32_bf16 v[156:159], v[8:11], a[188:191], v[156:159]
    s_waitcnt lgkmcnt(3)
    v_mfma_f32_16x16x32_bf16 v[128:131], v[12:15], a[192:195], v[128:131]
    ds_read_b128 v[28:31], v4 offset:11264
    v_mfma_f32_16x16x32_bf16 v[136:139], v[12:15], a[196:199], v[136:139]
    v_mfma_f32_16x16x32_bf16 v[144:147], v[12:15], a[200:203], v[144:147]
    v_mfma_f32_16x16x32_bf16 v[152:155], v[12:15], a[204:207], v[152:155]
    s_waitcnt lgkmcnt(3)
    v_mfma_f32_16x16x32_bf16 v[132:135], v[16:19], a[192:195], v[132:135]
    ds_read_b128 v[8:11], v4 offset:12288
    v_mfma_f32_16x16x32_bf16 v[140:143], v[16:19], a[196:199], v[140:143]
    v_mfma_f32_16x16x32_bf16 v[148:151], v[16:19], a[200:203], v[148:151]
    v_mfma_f32_16x16x32_bf16 v[156:159], v[16:19], a[204:207], v[156:159]
    s_waitcnt lgkmcnt(3)
    v_mfma_f32_16x16x32_bf16 v[160:163], v[20:23], a[64:67], v[160:163]
    ds_read_b128 v[12:15], v4 offset:13312
    v_mfma_f32_16x16x32_bf16 v[164:167], v[20:23], a[68:71], v[164:167]
    v_mfma_f32_16x16x32_bf16 v[168:171], v[20:23], a[72:75], v[168:171]
    v_mfma_f32_16x16x32_bf16 v[172:175], v[20:23], a[76:79], v[172:175]
    s_waitcnt lgkmcnt(3)
    v_cvt_pk_bf16_f32 v128, v128, v129
    v_cvt_pk_bf16_f32 v129, v130, v131
    v_mfma_f32_16x16x32_bf16 v[160:163], v[24:27], a[80:83], v[160:163]
    ds_read_b128 v[16:19], v4 offset:14336
    v_cvt_pk_bf16_f32 v130, v132, v133
    v_mfma_f32_16x16x32_bf16 v[164:167], v[24:27], a[84:87], v[164:167]
    v_cvt_pk_bf16_f32 v131, v134, v135
    v_mfma_f32_16x16x32_bf16 v[168:171], v[24:27], a[88:91], v[168:171]
    s_add_u32 s70, s69, 3072
    v_mfma_f32_16x16x32_bf16 v[172:175], v[24:27], a[92:95], v[172:175]
    s_waitcnt lgkmcnt(3)
    v_mfma_f32_16x16x32_bf16 v[160:163], v[28:31], a[96:99], v[160:163]
    ds_read_b128 v[20:23], v4 offset:15360
    v_mfma_f32_16x16x32_bf16 v[164:167], v[28:31], a[100:103], v[164:167]
    buffer_store_dwordx4 v[128:131], v2, s[4:7], s70 offen sc1
    v_mfma_f32_16x16x32_bf16 v[168:171], v[28:31], a[104:107], v[168:171]
    v_cvt_pk_bf16_f32 v136, v136, v137
    v_cvt_pk_bf16_f32 v137, v138, v139
    v_mfma_f32_16x16x32_bf16 v[172:175], v[28:31], a[108:111], v[172:175]
    s_waitcnt lgkmcnt(3)
    v_cvt_pk_bf16_f32 v138, v140, v141
    v_cvt_pk_bf16_f32 v139, v142, v143
    v_mfma_f32_16x16x32_bf16 v[160:163], v[8:11], a[112:115], v[160:163]
    s_add_u32 s70, s69, 21504
    ds_read_b128 v[24:27], v4 offset:16384
    v_mfma_f32_16x16x32_bf16 v[164:167], v[8:11], a[116:119], v[164:167]
    buffer_store_dwordx4 v[136:139], v2, s[4:7], s70 offen sc1
    v_mfma_f32_16x16x32_bf16 v[168:171], v[8:11], a[120:123], v[168:171]
    v_cvt_pk_bf16_f32 v144, v144, v145
    v_cvt_pk_bf16_f32 v145, v146, v147
    v_mfma_f32_16x16x32_bf16 v[172:175], v[8:11], a[124:127], v[172:175]
    s_waitcnt lgkmcnt(3)
    v_cvt_pk_bf16_f32 v146, v148, v149
    v_cvt_pk_bf16_f32 v147, v150, v151
    v_mfma_f32_16x16x32_bf16 v[160:163], v[12:15], a[128:131], v[160:163]
    s_add_u32 s70, s69, 39936
    ds_read_b128 v[28:31], v4 offset:17408
    v_mfma_f32_16x16x32_bf16 v[164:167], v[12:15], a[132:135], v[164:167]
    buffer_store_dwordx4 v[144:147], v2, s[4:7], s70 offen sc1
    v_mfma_f32_16x16x32_bf16 v[168:171], v[12:15], a[136:139], v[168:171]
    v_cvt_pk_bf16_f32 v152, v152, v153
    v_cvt_pk_bf16_f32 v153, v154, v155
    v_mfma_f32_16x16x32_bf16 v[172:175], v[12:15], a[140:143], v[172:175]
    s_waitcnt lgkmcnt(3)
    v_cvt_pk_bf16_f32 v154, v156, v157
    v_cvt_pk_bf16_f32 v155, v158, v159
    v_mfma_f32_16x16x32_bf16 v[160:163], v[16:19], a[144:147], v[160:163]
    s_add_u32 s70, s69, 58368
    v_mfma_f32_16x16x32_bf16 v[164:167], v[16:19], a[148:151], v[164:167]
    buffer_store_dwordx4 v[152:155], v2, s[4:7], s70 offen sc1
    v_mfma_f32_16x16x32_bf16 v[168:171], v[16:19], a[152:155], v[168:171]
    v_mfma_f32_16x16x32_bf16 v[172:175], v[16:19], a[156:159], v[172:175]
    s_waitcnt lgkmcnt(2)
    v_mfma_f32_16x16x32_bf16 v[160:163], v[20:23], a[160:163], v[160:163]
    v_mfma_f32_16x16x32_bf16 v[164:167], v[20:23], a[164:167], v[164:167]
    v_mfma_f32_16x16x32_bf16 v[168:171], v[20:23], a[168:171], v[168:171]
    v_mfma_f32_16x16x32_bf16 v[172:175], v[20:23], a[172:175], v[172:175]
    s_waitcnt lgkmcnt(1)
    v_mfma_f32_16x16x32_bf16 v[160:163], v[24:27], a[176:179], v[160:163]
    v_mfma_f32_16x16x32_bf16 v[164:167], v[24:27], a[180:183], v[164:167]
    v_mfma_f32_16x16x32_bf16 v[168:171], v[24:27], a[184:187], v[168:171]
    v_mfma_f32_16x16x32_bf16 v[172:175], v[24:27], a[188:191], v[172:175]
    s_waitcnt lgkmcnt(0)
    v_mfma_f32_16x16x32_bf16 v[160:163], v[28:31], a[192:195], v[160:163]
    v_mfma_f32_16x16x32_bf16 v[164:167], v[28:31], a[196:199], v[164:167]
    v_mfma_f32_16x16x32_bf16 v[168:171], v[28:31], a[200:203], v[168:171]
    v_mfma_f32_16x16x32_bf16 v[172:175], v[28:31], a[204:207], v[172:175]
    s_nop 4
    v_cvt_pk_bf16_f32 v160, v160, v161
    v_cvt_pk_bf16_f32 v161, v162, v163
    s_add_u32 s70, s68, 4096
    buffer_store_dwordx2 v[160:161], v0, s[4:7], s70 offen sc1
    v_cvt_pk_bf16_f32 v164, v164, v165
    v_cvt_pk_bf16_f32 v165, v166, v167
    s_add_u32 s70, s68, 22528
    buffer_store_dwordx2 v[164:165], v0, s[4:7], s70 offen sc1
    v_cvt_pk_bf16_f32 v168, v168, v169
    v_cvt_pk_bf16_f32 v169, v170, v171
    s_add_u32 s70, s68, 40960
    buffer_store_dwordx2 v[168:169], v0, s[4:7], s70 offen sc1
    v_cvt_pk_bf16_f32 v172, v172, v173
    v_cvt_pk_bf16_f32 v173, v174, v175
    s_add_u32 s70, s68, 59392
    buffer_store_dwordx2 v[172:173], v0, s[4:7], s70 offen sc1
    s_lshl_b32 s60, s44, 2
    s_add_u32 s60, s60, s20
    s_lshl_b32 s60, s60, 5
    s_add_u32 s60, s60, s47
    s_lshl_b32 s60, s60, 3
    s_add_u32 s60, s60, s101
    s_add_u32 s60, s60, 114688
    v_mov_b32 v6, s98
    v_mov_b32 v7, s99
    s_waitcnt vmcnt(0)
    s_lshl_b32 s60, s60, 2
    s_add_u32 s60, s60, 0x8000000
    s_mov_b64 exec, 1
    buffer_store_dwordx2 v[6:7], off, s[4:7], s60 sc1
    s_mov_b64 exec, -1
    s_cmp_lg_u32 s101, 0
    s_cbranch_scc1 L_red1_50
    s_barrier
    s_lshl_b32 s47, s21, 5
    s_add_u32 s47, s47, s22
    v_and_b32 v8, 7, v1
    v_lshrrev_b32 v9, 3, v1
    s_lshl_b32 s48, s47, 3
    v_add_u32 v3, s48, v8
    v_mul_u32_u24 v3, 1152, v3
    s_mul_i32 s48, s20, 384
    v_lshl_add_u32 v3, v9, 4, v3
    v_add_u32 v3, s48, v3
    s_lshr_b32 s48, s47, 1
    s_mul_i32 s48, s48, 18432
    s_and_b32 s49, s47, 1
    s_lshl_b32 s49, s49, 7
    s_add_u32 s48, s48, s49
    s_mul_i32 s49, s20, 6144
    s_add_u32 s48, s48, s49
    v_lshlrev_b32 v8, 4, v8
    v_lshl_add_u32 v8, v9, 8, v8
    v_add_u32 v4, s48, v8
    v_lshrrev_b32 v8, 3, v1
    v_and_b32 v9, 7, v1
    s_and_b32 s48, s47, 1
    s_lshl_b32 s48, s48, 3
    v_add_u32 v9, s48, v9
    v_lshlrev_b32 v9, 4, v9
    v_bfe_u32 v10, v8, 1, 1
    v_and_b32 v11, 1, v8
    v_lshl_add_u32 v9, v11, 4, v9
    v_lshl_add_u32 v9, v10, 9, v9
    v_and_b32 v10, 3, v8
    v_lshlrev_b32 v10, 8, v10
    v_sub_u32 v9, v9, v10
    s_mul_i32 s48, s20, 6
    v_lshrrev_b32 v8, 2, v8
    v_add_u32 v8, s48, v8
    v_add_u32 v10, 0, v8
    v_cmp_eq_u32 vcc, 4, v10
    v_cmp_eq_u32 s[56:57], 13, v10
    s_nop 0
    s_or_b64 vcc, vcc, s[56:57]
    v_cndmask_b32 v10, 0, v9, vcc
    v_add3_u32 v5, v4, v10, 0
    v_add_u32 v5, 0, v5
    v_add_u32 v10, 2, v8
    v_cmp_eq_u32 vcc, 4, v10
    v_cmp_eq_u32 s[56:57], 13, v10
    s_nop 0
    s_or_b64 vcc, vcc, s[56:57]
    v_cndmask_b32 v10, 0, v9, vcc
    v_add3_u32 v6, v4, v10, 0
    v_add_u32 v6, 2048, v6
    v_add_u32 v10, 4, v8
    v_cmp_eq_u32 vcc, 4, v10
    v_cmp_eq_u32 s[56:57], 13, v10
    s_nop 0
    s_or_b64 vcc, vcc, s[56:57]
    v_cndmask_b32 v10, 0, v9, vcc
    v_add3_u32 v7, v4, v10, 0
    v_add_u32 v7, 4096, v7
    s_cmp_eq_u32 s20, 3
    s_cbranch_scc1 L_w3a_91
    s_mov_b32 s48, 25690112
    buffer_load_dwordx4 v[16:19], v4, s[4:7], s48 offen offset:0 sc1
    buffer_load_dwordx4 v[52:55], v4, s[4:7], s48 offen offset:2048 sc1
    s_add_u32 s48, s48, 4096
    buffer_load_dwordx4 v[88:91], v4, s[4:7], s48 offen offset:0 sc1
    s_lshr_b32 s49, s47, 3
    s_lshl_b32 s49, s49, 8
    s_add_u32 s49, s49, 114688
    v_and_b32 v10, 31, v1
    v_lshlrev_b32 v10, 3, v10
    s_lshl_b32 s49, s49, 2
    s_add_u32 s49, s49, 0x8000000
    v_lshlrev_b32 v10, 2, v10
    buffer_load_dwordx2 v[176:177], v10, s[4:7], s49 offen sc1
    s_waitcnt vmcnt(0)
    v_cmp_eq_u64 vcc, s[98:99], v[176:177]
    s_nop 0
    s_cmp_eq_u64 vcc, exec
    s_cbranch_scc0 L_pp_slow_92
L_pp_back_93:
    s_mov_b32 s48, 50331648
    buffer_load_dwordx4 v[20:23], v5, s[4:7], s48 offen sc1
    buffer_load_dwordx4 v[56:59], v6, s[4:7], s48 offen sc1
    buffer_load_dwordx4 v[92:95], v7, s[4:7], s48 offen sc1
    s_mov_b32 s48, 52690944
    buffer_load_dwordx4 v[24:27], v5, s[4:7], s48 offen sc1
    buffer_load_dwordx4 v[60:63], v6, s[4:7], s48 offen sc1
    buffer_load_dwordx4 v[96:99], v7, s[4:7], s48 offen sc1
    s_mov_b32 s48, 55050240
    buffer_load_dwordx4 v[28:31], v5, s[4:7], s48 offen sc1
    buffer_load_dwordx4 v[64:67], v6, s[4:7], s48 offen sc1
    buffer_load_dwordx4 v[100:103], v7, s[4:7], s48 offen sc1
    s_mov_b32 s48, 57409536
    buffer_load_dwordx4 v[32:35], v5, s[4:7], s48 offen sc1
    buffer_load_dwordx4 v[68:71], v6, s[4:7], s48 offen sc1
    buffer_load_dwordx4 v[104:107], v7, s[4:7], s48 offen sc1
    s_mov_b32 s48, 59768832
    buffer_load_dwordx4 v[36:39], v5, s[4:7], s48 offen sc1
    buffer_load_dwordx4 v[72:75], v6, s[4:7], s48 offen sc1
    buffer_load_dwordx4 v[108:111], v7, s[4:7], s48 offen sc1
    s_mov_b32 s48, 62128128
    buffer_load_dwordx4 v[40:43], v5, s[4:7], s48 offen sc1
    buffer_load_dwordx4 v[76:79], v6, s[4:7], s48 offen sc1
    buffer_load_dwordx4 v[112:115], v7, s[4:7], s48 offen sc1
    s_mov_b32 s48, 64487424
    buffer_load_dwordx4 v[44:47], v5, s[4:7], s48 offen sc1
    buffer_load_dwordx4 v[80:83], v6, s[4:7], s48 offen sc1
    buffer_load_dwordx4 v[116:119], v7, s[4:7], s48 offen sc1
    s_mov_b32 s48, 66846720
    buffer_load_dwordx4 v[48:51], v5, s[4:7], s48 offen sc1
    buffer_load_dwordx4 v[84:87], v6, s[4:7], s48 offen sc1
    buffer_load_dwordx4 v[120:123], v7, s[4:7], s48 offen sc1
    v_lshlrev_b32 v128, 16, v16
    v_and_b32 v129, 0xffff0000, v16
    v_lshlrev_b32 v130, 16, v17
    v_and_b32 v131, 0xffff0000, v17
    v_lshlrev_b32 v132, 16, v18
    v_and_b32 v133, 0xffff0000, v18
    v_lshlrev_b32 v134, 16, v19
    v_and_b32 v135, 0xffff0000, v19
    v_lshlrev_b32 v136, 16, v52
    v_and_b32 v137, 0xffff0000, v52
    v_lshlrev_b32 v138, 16, v53
    v_and_b32 v139, 0xffff0000, v53
    v_lshlrev_b32 v140, 16, v54
    v_and_b32 v141, 0xffff0000, v54
    v_lshlrev_b32 v142, 16, v55
    v_and_b32 v143, 0xffff0000, v55
    v_lshlrev_b32 v144, 16, v88
    v_and_b32 v145, 0xffff0000, v88
    v_lshlrev_b32 v146, 16, v89
    v_and_b32 v147, 0xffff0000, v89
    v_lshlrev_b32 v148, 16, v90
    v_and_b32 v149, 0xffff0000, v90
    v_lshlrev_b32 v150, 16, v91
    v_and_b32 v151, 0xffff0000, v91
    v_mov_b32 v12, 0x3f80
    v_mov_b32 v13, 0x3f800000
    s_waitcnt vmcnt(23)
    v_dot2c_f32_bf16 v128, v20, v12
    v_dot2c_f32_bf16 v129, v20, v13
    v_dot2c_f32_bf16 v130, v21, v12
    v_dot2c_f32_bf16 v131, v21, v13
    v_dot2c_f32_bf16 v132, v22, v12
    v_dot2c_f32_bf16 v133, v22, v13
    v_dot2c_f32_bf16 v134, v23, v12
    v_dot2c_f32_bf16 v135, v23, v13
    s_waitcnt vmcnt(22)
    v_dot2c_f32_bf16 v136, v56, v12
    v_dot2c_f32_bf16 v137, v56, v13
    v_dot2c_f32_bf16 v138, v57, v12
    v_dot2c_f32_bf16 v139, v57, v13
    v_dot2c_f32_bf16 v140, v58, v12
    v_dot2c_f32_bf16 v141, v58, v13
    v_dot2c_f32_bf16 v142, v59, v12
    v_dot2c_f32_bf16 v143, v59, v13
    s_waitcnt vmcnt(21)
    v_dot2c_f32_bf16 v144, v92, v12
    v_dot2c_f32_bf16 v145, v92, v13
    v_dot2c_f32_bf16 v146, v93, v12
    v_dot2c_f32_bf16 v147, v93, v13
    v_dot2c_f32_bf16 v148, v94, v12
    v_dot2c_f32_bf16 v149, v94, v13
    v_dot2c_f32_bf16 v150, v95, v12
    v_dot2c_f32_bf16 v151, v95, v13
    s_waitcnt vmcnt(20)
    v_dot2c_f32_bf16 v128, v24, v12
    v_dot2c_f32_bf16 v129, v24, v13
    v_dot2c_f32_bf16 v130, v25, v12
    v_dot2c_f32_bf16 v131, v25, v13
    v_dot2c_f32_bf16 v132, v26, v12
    v_dot2c_f32_bf16 v133, v26, v13
    v_dot2c_f32_bf16 v134, v27, v12
    v_dot2c_f32_bf16 v135, v27, v13
    s_waitcnt vmcnt(19)
    v_dot2c_f32_bf16 v136, v60, v12
    v_dot2c_f32_bf16 v137, v60, v13
    v_dot2c_f32_bf16 v138, v61, v12
    v_dot2c_f32_bf16 v139, v61, v13
    v_dot2c_f32_bf16 v140, v62, v12
    v_dot2c_f32_bf16 v141, v62, v13
    v_dot2c_f32_bf16 v142, v63, v12
    v_dot2c_f32_bf16 v143, v63, v13
    s_waitcnt vmcnt(18)
    v_dot2c_f32_bf16 v144, v96, v12
    v_dot2c_f32_bf16 v145, v96, v13
    v_dot2c_f32_bf16 v146, v97, v12
    v_dot2c_f32_bf16 v147, v97, v13
    v_dot2c_f32_bf16 v148, v98, v12
    v_dot2c_f32_bf16 v149, v98, v13
    v_dot2c_f32_bf16 v150, v99, v12
    v_dot2c_f32_bf16 v151, v99, v13
    s_waitcnt vmcnt(17)
    v_dot2c_f32_bf16 v128, v28, v12
    v_dot2c_f32_bf16 v129, v28, v13
    v_dot2c_f32_bf16 v130, v29, v12
    v_dot2c_f32_bf16 v131, v29, v13
    v_dot2c_f32_bf16 v132, v30, v12
    v_dot2c_f32_bf16 v133, v30, v13
    v_dot2c_f32_bf16 v134, v31, v12
    v_dot2c_f32_bf16 v135, v31, v13
    s_waitcnt vmcnt(16)
    v_dot2c_f32_bf16 v136, v64, v12
    v_dot2c_f32_bf16 v137, v64, v13
    v_dot2c_f32_bf16 v138, v65, v12
    v_dot2c_f32_bf16 v139, v65, v13
    v_dot2c_f32_bf16 v140, v66, v12
    v_dot2c_f32_bf16 v141, v66, v13
    v_dot2c_f32_bf16 v142, v67, v12
    v_dot2c_f32_bf16 v143, v67, v13
    s_waitcnt vmcnt(15)
    v_dot2c_f32_bf16 v144, v100, v12
    v_dot2c_f32_bf16 v145, v100, v13
    v_dot2c_f32_bf16 v146, v101, v12
    v_dot2c_f32_bf16 v147, v101, v13
    v_dot2c_f32_bf16 v148, v102, v12
    v_dot2c_f32_bf16 v149, v102, v13
    v_dot2c_f32_bf16 v150, v103, v12
    v_dot2c_f32_bf16 v151, v103, v13
    s_waitcnt vmcnt(14)
    v_dot2c_f32_bf16 v128, v32, v12
    v_dot2c_f32_bf16 v129, v32, v13
    v_dot2c_f32_bf16 v130, v33, v12
    v_dot2c_f32_bf16 v131, v33, v13
    v_dot2c_f32_bf16 v132, v34, v12
    v_dot2c_f32_bf16 v133, v34, v13
    v_dot2c_f32_bf16 v134, v35, v12
    v_dot2c_f32_bf16 v135, v35, v13
    s_waitcnt vmcnt(13)
    v_dot2c_f32_bf16 v136, v68, v12
    v_dot2c_f32_bf16 v137, v68, v13
    v_dot2c_f32_bf16 v138, v69, v12
    v_dot2c_f32_bf16 v139, v69, v13
    v_dot2c_f32_bf16 v140, v70, v12
    v_dot2c_f32_bf16 v141, v70, v13
    v_dot2c_f32_bf16 v142, v71, v12
    v_dot2c_f32_bf16 v143, v71, v13
    s_waitcnt vmcnt(12)
    v_dot2c_f32_bf16 v144, v104, v12
    v_dot2c_f32_bf16 v145, v104, v13
    v_dot2c_f32_bf16 v146, v105, v12
    v_dot2c_f32_bf16 v147, v105, v13
    v_dot2c_f32_bf16 v148, v106, v12
    v_dot2c_f32_bf16 v149, v106, v13
    v_dot2c_f32_bf16 v150, v107, v12
    v_dot2c_f32_bf16 v151, v107, v13
    s_waitcnt vmcnt(11)
    v_dot2c_f32_bf16 v128, v36, v12
    v_dot2c_f32_bf16 v129, v36, v13
    v_dot2c_f32_bf16 v130, v37, v12
    v_dot2c_f32_bf16 v131, v37, v13
    v_dot2c_f32_bf16 v132, v38, v12
    v_dot2c_f32_bf16 v133, v38, v13
    v_dot2c_f32_bf16 v134, v39, v12
    v_dot2c_f32_bf16 v135, v39, v13
    s_waitcnt vmcnt(10)
    v_dot2c_f32_bf16 v136, v72, v12
    v_dot2c_f32_bf16 v137, v72, v13
    v_dot2c_f32_bf16 v138, v73, v12
    v_dot2c_f32_bf16 v139, v73, v13
    v_dot2c_f32_bf16 v140, v74, v12
    v_dot2c_f32_bf16 v141, v74, v13
    v_dot2c_f32_bf16 v142, v75, v12
    v_dot2c_f32_bf16 v143, v75, v13
    s_waitcnt vmcnt(9)
    v_dot2c_f32_bf16 v144, v108, v12
    v_dot2c_f32_bf16 v145, v108, v13
    v_dot2c_f32_bf16 v146, v109, v12
    v_dot2c_f32_bf16 v147, v109, v13
    v_dot2c_f32_bf16 v148, v110, v12
    v_dot2c_f32_bf16 v149, v110, v13
    v_dot2c_f32_bf16 v150, v111, v12
    v_dot2c_f32_bf16 v151, v111, v13
    s_waitcnt vmcnt(8)
    v_dot2c_f32_bf16 v128, v40, v12
    v_dot2c_f32_bf16 v129, v40, v13
    v_dot2c_f32_bf16 v130, v41, v12
    v_dot2c_f32_bf16 v131, v41, v13
    v_dot2c_f32_bf16 v132, v42, v12
    v_dot2c_f32_bf16 v133, v42, v13
    v_dot2c_f32_bf16 v134, v43, v12
    v_dot2c_f32_bf16 v135, v43, v13
    s_waitcnt vmcnt(7)
    v_dot2c_f32_bf16 v136, v76, v12
    v_dot2c_f32_bf16 v137, v76, v13
    v_dot2c_f32_bf16 v138, v77, v12
    v_dot2c_f32_bf16 v139, v77, v13
    v_dot2c_f32_bf16 v140, v78, v12
    v_dot2c_f32_bf16 v141, v78, v13
    v_dot2c_f32_bf16 v142, v79, v12
    v_dot2c_f32_bf16 v143, v79, v13
    s_waitcnt vmcnt(6)
    v_dot2c_f32_bf16 v144, v112, v12
    v_dot2c_f32_bf16 v145, v112, v13
    v_dot2c_f32_bf16 v146, v113, v12
    v_dot2c_f32_bf16 v147, v113, v13
    v_dot2c_f32_bf16 v148, v114, v12
    v_dot2c_f32_bf16 v149, v114, v13
    v_dot2c_f32_bf16 v150, v115, v12
    v_dot2c_f32_bf16 v151, v115, v13
    s_waitcnt vmcnt(5)
    v_dot2c_f32_bf16 v128, v44, v12
    v_dot2c_f32_bf16 v129, v44, v13
    v_dot2c_f32_bf16 v130, v45, v12
    v_dot2c_f32_bf16 v131, v45, v13
    v_dot2c_f32_bf16 v132, v46, v12
    v_dot2c_f32_bf16 v133, v46, v13
    v_dot2c_f32_bf16 v134, v47, v12
    v_dot2c_f32_bf16 v135, v47, v13
    s_waitcnt vmcnt(4)
    v_dot2c_f32_bf16 v136, v80, v12
    v_dot2c_f32_bf16 v137, v80, v13
    v_dot2c_f32_bf16 v138, v81, v12
    v_dot2c_f32_bf16 v139, v81, v13
    v_dot2c_f32_bf16 v140, v82, v12
    v_dot2c_f32_bf16 v141, v82, v13
    v_dot2c_f32_bf16 v142, v83, v12
    v_dot2c_f32_bf16 v143, v83, v13
    s_waitcnt vmcnt(3)
    v_dot2c_f32_bf16 v144, v116, v12
    v_dot2c_f32_bf16 v145, v116, v13
    v_dot2c_f32_bf16 v146, v117, v12
    v_dot2c_f32_bf16 v147, v117, v13
    v_dot2c_f32_bf16 v148, v118, v12
    v_dot2c_f32_bf16 v149, v118, v13
    v_dot2c_f32_bf16 v150, v119, v12
    v_dot2c_f32_bf16 v151, v119, v13
    s_waitcnt vmcnt(2)
    v_dot2c_f32_bf16 v128, v48, v12
    v_dot2c_f32_bf16 v129, v48, v13
    v_dot2c_f32_bf16 v130, v49, v12
    v_dot2c_f32_bf16 v131, v49, v13
    v_dot2c_f32_bf16 v132, v50, v12
    v_dot2c_f32_bf16 v133, v50, v13
    v_dot2c_f32_bf16 v134, v51, v12
    v_dot2c_f32_bf16 v135, v51, v13
    s_waitcnt vmcnt(1)
    v_dot2c_f32_bf16 v136, v84, v12
    v_dot2c_f32_bf16 v137, v84, v13
    v_dot2c_f32_bf16 v138, v85, v12
    v_dot2c_f32_bf16 v139, v85, v13
    v_dot2c_f32_bf16 v140, v86, v12
    v_dot2c_f32_bf16 v141, v86, v13
    v_dot2c_f32_bf16 v142, v87, v12
    v_dot2c_f32_bf16 v143, v87, v13
    s_waitcnt vmcnt(0)
    v_dot2c_f32_bf16 v144, v120, v12
    v_dot2c_f32_bf16 v145, v120, v13
    v_dot2c_f32_bf16 v146, v121, v12
    v_dot2c_f32_bf16 v147, v121, v13
    v_dot2c_f32_bf16 v148, v122, v12
    v_dot2c_f32_bf16 v149, v122, v13
    v_dot2c_f32_bf16 v150, v123, v12
    v_dot2c_f32_bf16 v151, v123, v13
    s_add_u32 s16, s42, 28311552
    s_addc_u32 s17, s43, 0
    s_mov_b32 s18, 0x240000
    s_mov_b32 s19, 0x20000
    v_cvt_pk_bf16_f32 v160, v128, v129
    v_cvt_pk_bf16_f32 v161, v130, v131
    v_cvt_pk_bf16_f32 v162, v132, v133
    v_cvt_pk_bf16_f32 v163, v134, v135
    buffer_store_dwordx4 v[160:163], v3, s[16:19], 0 offen offset:0 sc1
    v_cvt_pk_bf16_f32 v164, v136, v137
    v_cvt_pk_bf16_f32 v165, v138, v139
    v_cvt_pk_bf16_f32 v166, v140, v141
    v_cvt_pk_bf16_f32 v167, v142, v143
    buffer_store_dwordx4 v[164:167], v3, s[16:19], 0 offen offset:128 sc1
    v_cvt_pk_bf16_f32 v168, v144, v145
    v_cvt_pk_bf16_f32 v169, v146, v147
    v_cvt_pk_bf16_f32 v170, v148, v149
    v_cvt_pk_bf16_f32 v171, v150, v151
    buffer_store_dwordx4 v[168:171], v3, s[16:19], 0 offen offset:256 sc1
    v_lshlrev_b32 v128, 16, v160
    v_and_b32 v129, 0xffff0000, v160
    v_lshlrev_b32 v130, 16, v161
    v_and_b32 v131, 0xffff0000, v161
    v_lshlrev_b32 v132, 16, v162
    v_and_b32 v133, 0xffff0000, v162
    v_lshlrev_b32 v134, 16, v163
    v_and_b32 v135, 0xffff0000, v163
    v_lshlrev_b32 v136, 16, v164
    v_and_b32 v137, 0xffff0000, v164
    v_lshlrev_b32 v138, 16, v165
    v_and_b32 v139, 0xffff0000, v165
    v_lshlrev_b32 v140, 16, v166
    v_and_b32 v141, 0xffff0000, v166
    v_lshlrev_b32 v142, 16, v167
    v_and_b32 v143, 0xffff0000, v167
    v_lshlrev_b32 v144, 16, v168
    v_and_b32 v145, 0xffff0000, v168
    v_lshlrev_b32 v146, 16, v169
    v_and_b32 v147, 0xffff0000, v169
    v_lshlrev_b32 v148, 16, v170
    v_and_b32 v149, 0xffff0000, v170
    v_lshlrev_b32 v150, 16, v171
    v_and_b32 v151, 0xffff0000, v171
    v_add_f32 v152, v128, v129
    v_add_f32 v8, v130, v131
    v_add_f32 v152, v152, v132
    v_add_f32 v8, v8, v133
    v_add_f32 v152, v152, v134
    v_add_f32 v8, v8, v135
    v_add_f32 v152, v152, v136
    v_add_f32 v8, v8, v137
    v_add_f32 v152, v152, v138
    v_add_f32 v8, v8, v139
    v_add_f32 v152, v152, v140
    v_add_f32 v8, v8, v141
    v_add_f32 v152, v152, v142
    v_add_f32 v8, v8, v143
    v_add_f32 v152, v152, v144
    v_add_f32 v8, v8, v145
    v_add_f32 v152, v152, v146
    v_add_f32 v8, v8, v147
    v_add_f32 v152, v152, v148
    v_add_f32 v8, v8, v149
    v_add_f32 v152, v152, v150
    v_add_f32 v8, v8, v151
    v_add_f32 v152, v152, v8
    s_nop 1
    v_add_f32_dpp v152, v152, v152 row_ror:8 row_mask:0xf bank_mask:0xf
    v_mov_b32 v8, v152
    s_nop 1
    v_permlane16_swap_b32 v152, v8
    v_add_f32 v152, v152, v8
    v_mov_b32 v8, v152
    s_nop 1
    v_permlane32_swap_b32 v152, v8
    v_add_f32 v152, v152, v8
    v_mul_f32 v9, 0x3baaaaab, v152
    v_sub_f32 v8, v128, v9
    v_mul_f32 v153, v8, v8
    v_sub_f32 v11, v129, v9
    v_fmac_f32 v153, v11, v11
    v_sub_f32 v10, v130, v9
    v_fmac_f32 v153, v10, v10
    v_sub_f32 v11, v131, v9
    v_fmac_f32 v153, v11, v11
    v_sub_f32 v10, v132, v9
    v_fmac_f32 v153, v10, v10
    v_sub_f32 v11, v133, v9
    v_fmac_f32 v153, v11, v11
    v_sub_f32 v10, v134, v9
    v_fmac_f32 v153, v10, v10
    v_sub_f32 v11, v135, v9
    v_fmac_f32 v153, v11, v11
    v_sub_f32 v10, v136, v9
    v_fmac_f32 v153, v10, v10
    v_sub_f32 v11, v137, v9
    v_fmac_f32 v153, v11, v11
    v_sub_f32 v10, v138, v9
    v_fmac_f32 v153, v10, v10
    v_sub_f32 v11, v139, v9
    v_fmac_f32 v153, v11, v11
    v_sub_f32 v10, v140, v9
    v_fmac_f32 v153, v10, v10
    v_sub_f32 v11, v141, v9
    v_fmac_f32 v153, v11, v11
    v_sub_f32 v10, v142, v9
    v_fmac_f32 v153, v10, v10
    v_sub_f32 v11, v143, v9
    v_fmac_f32 v153, v11, v11
    v_sub_f32 v10, v144, v9
    v_fmac_f32 v153, v10, v10
    v_sub_f32 v11, v145, v9
    v_fmac_f32 v153, v11, v11
    v_sub_f32 v10, v146, v9
    v_fmac_f32 v153, v10, v10
    v_sub_f32 v11, v147, v9
    v_fmac_f32 v153, v11, v11
    v_sub_f32 v10, v148, v9
    v_fmac_f32 v153, v10, v10
    v_sub_f32 v11, v149, v9
    v_fmac_f32 v153, v11, v11
    v_sub_f32 v10, v150, v9
    v_fmac_f32 v153, v10, v10
    v_sub_f32 v11, v151, v9
    v_fmac_f32 v153, v11, v11
    s_nop 1
    v_add_f32_dpp v153, v153, v153 row_ror:8 row_mask:0xf bank_mask:0xf
    v_mov_b32 v8, v153
    s_nop 1
    v_permlane16_swap_b32 v153, v8
    v_add_f32 v153, v153, v8
    v_mov_b32 v8, v153
    s_nop 1
    v_permlane32_swap_b32 v153, v8
    v_add_f32 v153, v153, v8
    v_and_b32 v8, 7, v1
    s_mul_i32 s46, s20, 64
    s_add_u32 s46, s46, 160896
    v_lshl_add_u32 v8, v8, 3, s46
    ds_write_b64 v8, v[152:153]
    s_waitcnt lgkmcnt(0)
    s_branch L_join_95
L_w3a_91:
    s_and_b32 s44, s22, 15
    s_mul_i32 s44, s44, 129024
    s_add_u32 s44, s44, 0
    s_mov_b32 m0, 18432
    s_add_u32 s45, s44, 0
    buffer_load_dwordx4 v2, s[4:7], s45 offen offset:0 lds
    buffer_load_dwordx4 v2, s[4:7], s45 offen offset:1024 lds
    buffer_load_dwordx4 v2, s[4:7], s45 offen offset:2048 lds
    buffer_load_dwordx4 v2, s[4:7], s45 offen offset:3072 lds
    s_mov_b32 m0, 22528
    s_add_u32 s45, s44, 4096
    buffer_load_dwordx4 v2, s[4:7], s45 offen offset:0 lds
    buffer_load_dwordx4 v2, s[4:7], s45 offen offset:1024 lds
    buffer_load_dwordx4 v2, s[4:7], s45 offen offset:2048 lds
    buffer_load_dwordx4 v2, s[4:7], s45 offen offset:3072 lds
    s_mov_b32 m0, 26624
    s_add_u32 s45, s44, 8192
    buffer_load_dwordx4 v2, s[4:7], s45 offen offset:0 lds
    buffer_load_dwordx4 v2, s[4:7], s45 offen offset:1024 lds
    buffer_load_dwordx4 v2, s[4:7], s45 offen offset:2048 lds
    buffer_load_dwordx4 v2, s[4:7], s45 offen offset:3072 lds
    s_mov_b32 m0, 30720
    s_add_u32 s45, s44, 12288
    buffer_load_dwordx4 v2, s[4:7], s45 offen offset:0 lds
    buffer_load_dwordx4 v2, s[4:7], s45 offen offset:1024 lds
    buffer_load_dwordx4 v2, s[4:7], s45 offen offset:2048 lds
    buffer_load_dwordx4 v2, s[4:7], s45 offen offset:3072 lds
    s_mov_b32 m0, 34816
    s_add_u32 s45, s44, 16384
    buffer_load_dwordx4 v2, s[4:7], s45 offen offset:0 lds
    buffer_load_dwordx4 v2, s[4:7], s45 offen offset:1024 lds
    buffer_load_dwordx4 v2, s[4:7], s45 offen offset:2048 lds
    buffer_load_dwordx4 v2, s[4:7], s45 offen offset:3072 lds
    s_mov_b32 m0, 38912
    s_add_u32 s45, s44, 20480
    buffer_load_dwordx4 v2, s[4:7], s45 offen offset:0 lds
    buffer_load_dwordx4 v2, s[4:7], s45 offen offset:1024 lds
    buffer_load_dwordx4 v2, s[4:7], s45 offen offset:2048 lds
    buffer_load_dwordx4 v2, s[4:7], s45 offen offset:3072 lds
    s_mov_b32 m0, 43008
    s_add_u32 s45, s44, 24576
    buffer_load_dwordx4 v2, s[4:7], s45 offen offset:0 lds
    buffer_load_dwordx4 v2, s[4:7], s45 offen offset:1024 lds
    buffer_load_dwordx4 v2, s[4:7], s45 offen offset:2048 lds
    buffer_load_dwordx4 v2, s[4:7], s45 offen offset:3072 lds
    s_mov_b32 m0, 47104
    s_add_u32 s45, s44, 28672
    buffer_load_dwordx4 v2, s[4:7], s45 offen offset:0 lds
    buffer_load_dwordx4 v2, s[4:7], s45 offen offset:1024 lds
    buffer_load_dwordx4 v2, s[4:7], s45 offen offset:2048 lds
    buffer_load_dwordx4 v2, s[4:7], s45 offen offset:3072 lds
    s_mov_b32 m0, 51200
    s_add_u32 s45, s44, 32768
    buffer_load_dwordx4 v2, s[4:7], s45 offen offset:0 lds
    buffer_load_dwordx4 v2, s[4:7], s45 offen offset:1024 lds
    buffer_load_dwordx4 v2, s[4:7], s45 offen offset:2048 lds
    buffer_load_dwordx4 v2, s[4:7], s45 offen offset:3072 lds
L_join_95:
    s_barrier
    s_cmp_eq_u32 s20, 3
    s_cbranch_scc1 L_w3b_96
    v_and_b32 v8, 7, v1
    v_lshlrev_b32 v8, 3, v8
    v_add_u32 v8, 160896, v8
    ds_read_b64 v[152:153], v8 offset:0
    ds_read_b64 v[154:155], v8 offset:64
    ds_read_b64 v[156:157], v8 offset:128
    s_waitcnt lgkmcnt(1)
    v_add_f32 v8, v152, v154
    s_waitcnt lgkmcnt(0)
    v_add_f32 v8, v8, v156
    v_mul_f32 v8, 0x3ae38e39, v8
    v_add_f32 v9, v153, v155
    v_add_f32 v9, v9, v157
    v_mul_f32 v10, 0x3baaaaab, v152
    v_sub_f32 v10, v10, v8
    v_mul_f32 v10, v10, v10
    v_fmac_f32 v9, 0x43400000, v10
    v_mul_f32 v10, 0x3baaaaab, v154
    v_sub_f32 v10, v10, v8
    v_mul_f32 v10, v10, v10
    v_fmac_f32 v9, 0x43400000, v10
    v_mul_f32 v10, 0x3baaaaab, v156
    v_sub_f32 v10, v10, v8
    v_mul_f32 v10, v10, v10
    v_fmac_f32 v9, 0x43400000, v10
    v_mul_f32 v9, 0x3ae38e39, v9
    v_cvt_pk_bf16_f32 v9, v9, v9
    v_lshlrev_b32 v9, 16, v9
    v_add_f32 v9, 0x3727c5ac, v9
    v_cvt_pk_bf16_f32 v9, v9, v9
    v_lshlrev_b32 v9, 16, v9
    v_sqrt_f32 v9, v9
    s_nop 0
    v_cvt_pk_bf16_f32 v9, v9, v9
    v_lshlrev_b32 v9, 16, v9
    v_rcp_f32 v9, v9
    v_cvt_pk_bf16_f32 v8, v8, v8
    v_lshlrev_b32 v8, 16, v8
    v_sub_f32 v128, v128, v8
    v_sub_f32 v129, v129, v8
    v_cvt_pk_bf16_f32 v10, v128, v129
    v_lshlrev_b32 v128, 16, v10
    v_and_b32 v129, 0xffff0000, v10
    v_mul_f32 v128, v128, v9
    v_mul_f32 v129, v129, v9
    v_cvt_pk_bf16_f32 v16, v128, v129
    v_sub_f32 v130, v130, v8
    v_sub_f32 v131, v131, v8
    v_cvt_pk_bf16_f32 v10, v130, v131
    v_lshlrev_b32 v130, 16, v10
    v_and_b32 v131, 0xffff0000, v10
    v_mul_f32 v130, v130, v9
    v_mul_f32 v131, v131, v9
    v_cvt_pk_bf16_f32 v17, v130, v131
    v_sub_f32 v132, v132, v8
    v_sub_f32 v133, v133, v8
    v_cvt_pk_bf16_f32 v10, v132, v133
    v_lshlrev_b32 v132, 16, v10
    v_and_b32 v133, 0xffff0000, v10
    v_mul_f32 v132, v132, v9
    v_mul_f32 v133, v133, v9
    v_cvt_pk_bf16_f32 v18, v132, v133
    v_sub_f32 v134, v134, v8
    v_sub_f32 v135, v135, v8
    v_cvt_pk_bf16_f32 v10, v134, v135
    v_lshlrev_b32 v134, 16, v10
    v_and_b32 v135, 0xffff0000, v10
    v_mul_f32 v134, v134, v9
    v_mul_f32 v135, v135, v9
    v_cvt_pk_bf16_f32 v19, v134, v135
    v_sub_f32 v136, v136, v8
    v_sub_f32 v137, v137, v8
    v_cvt_pk_bf16_f32 v10, v136, v137
    v_lshlrev_b32 v136, 16, v10
    v_and_b32 v137, 0xffff0000, v10
    v_mul_f32 v136, v136, v9
    v_mul_f32 v137, v137, v9
    v_cvt_pk_bf16_f32 v20, v136, v137
    v_sub_f32 v138, v138, v8
    v_sub_f32 v139, v139, v8
    v_cvt_pk_bf16_f32 v10, v138, v139
    v_lshlrev_b32 v138, 16, v10
    v_and_b32 v139, 0xffff0000, v10
    v_mul_f32 v138, v138, v9
    v_mul_f32 v139, v139, v9
    v_cvt_pk_bf16_f32 v21, v138, v139
    v_sub_f32 v140, v140, v8
    v_sub_f32 v141, v141, v8
    v_cvt_pk_bf16_f32 v10, v140, v141
    v_lshlrev_b32 v140, 16, v10
    v_and_b32 v141, 0xffff0000, v10
    v_mul_f32 v140, v140, v9
    v_mul_f32 v141, v141, v9
    v_cvt_pk_bf16_f32 v22, v140, v141
    v_sub_f32 v142, v142, v8
    v_sub_f32 v143, v143, v8
    v_cvt_pk_bf16_f32 v10, v142, v143
    v_lshlrev_b32 v142, 16, v10
    v_and_b32 v143, 0xffff0000, v10
    v_mul_f32 v142, v142, v9
    v_mul_f32 v143, v143, v9
    v_cvt_pk_bf16_f32 v23, v142, v143
    v_sub_f32 v144, v144, v8
    v_sub_f32 v145, v145, v8
    v_cvt_pk_bf16_f32 v10, v144, v145
    v_lshlrev_b32 v144, 16, v10
    v_and_b32 v145, 0xffff0000, v10
    v_mul_f32 v144, v144, v9
    v_mul_f32 v145, v145, v9
    v_cvt_pk_bf16_f32 v24, v144, v145
    v_sub_f32 v146, v146, v8
    v_sub_f32 v147, v147, v8
    v_cvt_pk_bf16_f32 v10, v146, v147
    v_lshlrev_b32 v146, 16, v10
    v_and_b32 v147, 0xffff0000, v10
    v_mul_f32 v146, v146, v9
    v_mul_f32 v147, v147, v9
    v_cvt_pk_bf16_f32 v25, v146, v147
    v_sub_f32 v148, v148, v8
    v_sub_f32 v149, v149, v8
    v_cvt_pk_bf16_f32 v10, v148, v149
    v_lshlrev_b32 v148, 16, v10
    v_and_b32 v149, 0xffff0000, v10
    v_mul_f32 v148, v148, v9
    v_mul_f32 v149, v149, v9
    v_cvt_pk_bf16_f32 v26, v148, v149
    v_sub_f32 v150, v150, v8
    v_sub_f32 v151, v151, v8
    v_cvt_pk_bf16_f32 v10, v150, v151
    v_lshlrev_b32 v150, 16, v10
    v_and_b32 v151, 0xffff0000, v10
    v_mul_f32 v150, v150, v9
    v_mul_f32 v151, v151, v9
    v_cvt_pk_bf16_f32 v27, v150, v151
    s_mov_b32 s46, 71303168
    buffer_store_dwordx4 v[16:19], v4, s[4:7], s46 offen offset:0 sc1
    buffer_store_dwordx4 v[20:23], v4, s[4:7], s46 offen offset:2048 sc1
    s_add_u32 s46, s46, 4096
    buffer_store_dwordx4 v[24:27], v4, s[4:7], s46 offen offset:0 sc1
    s_lshl_b32 s46, s47, 2
    s_add_u32 s46, s46, s20
    s_lshl_b32 s46, s46, 3
    s_add_u32 s46, s46, 8192
    v_mov_b32 v8, s98
    v_mov_b32 v9, s99
    s_waitcnt vmcnt(0)
    s_lshl_b32 s46, s46, 2
    s_add_u32 s46, s46, 0x8000000
    s_mov_b64 exec, 1
    buffer_store_dwordx2 v[8:9], off, s[4:7], s46 sc1
    s_mov_b64 exec, -1
L_w3b_96:
    s_lshr_b32 s44, s22, 4
    s_lshl_b32 s52, s21, 1
    s_add_u32 s44, s44, s52
    s_and_b32 s45, s22, 15
    s_mul_i32 s48, s20, 21
    s_lshr_b32 s48, s48, 1
    s_lshl_b32 s48, s48, 10
    s_mul_i32 s47, s45, 129024
    s_add_u32 s47, s47, s48
    s_add_u32 s47, s47, 0
    s_lshl_b32 s46, s44, 3
    s_max_u32 s52, s46, 1
    s_sub_u32 s52, s52, 1
    s_mul_i32 s49, s52, 18432
    s_mul_i32 s50, s20, 9
    s_lshr_b32 s50, s50, 1
    s_lshl_b32 s50, s50, 10
    s_add_u32 s49, s49, s50
    s_add_u32 s49, s49, 71303168
    s_add_u32 s50, s50, 0
    s_lshl_b32 s54, s52, 6
    s_lshl_b32 s52, s20, 1
    s_add_u32 s46, s46, s52
    s_mul_i32 s51, s46, 18432
    s_add_u32 s51, s51, 71303168
    s_lshl_b32 s55, s46, 6
    v_and_b32 v6, 3, v1
    v_min_u32 v6, 2, v6
    v_and_b32 v7, 12, v1
    v_add_lshl_u32 v8, v6, v7, 3
    v_add_u32 v8, s55, v8
    v_and_b32 v7, 4, v1
    v_add_lshl_u32 v9, v6, v7, 3
    v_add_u32 v9, s54, v9
    v_and_b32 v7, 16, v1
    v_cmp_eq_u32 vcc, 0, v7
    s_nop 1
    v_cndmask_b32 v8, v9, v8, vcc
    s_min_u32 s52, s22, 23
    s_mul_i32 s52, s52, 10923
    s_lshr_b32 s52, s52, 16
    s_lshl_b32 s53, s21, 2
    s_add_u32 s52, s52, s53
    s_lshl_b32 s52, s52, 2
    s_add_u32 s52, s52, s20
    s_lshl_b32 s52, s52, 6
    v_and_b32 v7, 4, v1
    v_add_lshl_u32 v7, v6, v7, 3
    v_add_u32 v7, s52, v7
    v_cmp_gt_u32 vcc, 32, v1
    s_nop 1
    v_cndmask_b32 v8, v7, v8, vcc
    s_mov_b32 s52, 8192
    s_min_u32 s56, s20, 2
    s_add_u32 s57, s56, 2
    s_and_b32 s56, s20, 1
    s_add_u32 s56, s56, 4
    s_cmp_ge_u32 s20, 2
    s_cselect_b32 s57, 6, s57
    s_lshl_b32 s57, s57, 10
    s_lshl_b32 s56, s56, 10
    v_add_u32 v3, 18432, v2
    v_add_u32 v4, s57, v3
    v_add_u32 v5, s56, v3
    v_add_u32 v10, 0, v2
    s_waitcnt vmcnt(0)
    s_waitcnt vmcnt(0)
    s_barrier
    ds_read_b128 v[88:91], v3 offset:0
    ds_read_b128 v[92:95], v3 offset:1024
    ds_read_b128 v[96:99], v3 offset:2048
    ds_read_b128 v[100:103], v3 offset:3072
    ds_read_b128 v[112:115], v3 offset:6144
    ds_read_b128 v[104:107], v3 offset:4096
    ds_read_b128 v[108:111], v3 offset:5120
    v_mov_b32 v11, v8
    s_mov_b32 s23, s52
    s_lshl_b32 s23, s23, 2
    s_add_u32 s23, s23, 0x8000000
    v_lshlrev_b32 v11, 2, v11
    buffer_load_dwordx2 v[12:13], v11, s[4:7], s23 offen sc1
    v_and_b32 v6, 15, v1
    v_lshrrev_b32 v7, 4, v1
    v_lshlrev_b32 v7, 2, v7
    v_sub_u32 v6, v6, v7
    v_mov_b32 v8, 0xf149f2ca
    s_or_b32 s52, s44, s20
    s_cmp_eq_u32 s52, 0
    s_cselect_b64 s[56:57], -1, 0
    v_subrev_u32 v7, 0, v6
    v_and_b32 v9, 0xfffffff1, v7
    v_cmp_eq_u32 vcc, 0, v9
    v_add_u32 v7, 16, v7
    v_and_b32 v9, 0xfffffff1, v7
    v_cndmask_b32_e64 v168, v8, 0, vcc
    v_cmp_eq_u32 vcc, 0, v9
    s_nop 1
    v_cndmask_b32_e64 v172, v8, 0, vcc
    v_cndmask_b32_e64 v176, v172, v8, s[56:57]
    v_subrev_u32 v7, 1, v6
    v_and_b32 v9, 0xfffffff1, v7
    v_cmp_eq_u32 vcc, 0, v9
    v_add_u32 v7, 16, v7
    v_and_b32 v9, 0xfffffff1, v7
    v_cndmask_b32_e64 v169, v8, 0, vcc
    v_cmp_eq_u32 vcc, 0, v9
    s_nop 1
    v_cndmask_b32_e64 v173, v8, 0, vcc
    v_cndmask_b32_e64 v177, v173, v8, s[56:57]
    v_subrev_u32 v7, 2, v6
    v_and_b32 v9, 0xfffffff1, v7
    v_cmp_eq_u32 vcc, 0, v9
    v_add_u32 v7, 16, v7
    v_and_b32 v9, 0xfffffff1, v7
    v_cndmask_b32_e64 v170, v8, 0, vcc
    v_cmp_eq_u32 vcc, 0, v9
    s_nop 1
    v_cndmask_b32_e64 v174, v8, 0, vcc
    v_cndmask_b32_e64 v178, v174, v8, s[56:57]
    v_subrev_u32 v7, 3, v6
    v_and_b32 v9, 0xfffffff1, v7
    v_cmp_eq_u32 vcc, 0, v9
    v_add_u32 v7, 16, v7
    v_and_b32 v9, 0xfffffff1, v7
    v_cndmask_b32_e64 v171, v8, 0, vcc
    v_cmp_eq_u32 vcc, 0, v9
    s_nop 1
    v_cndmask_b32_e64 v175, v8, 0, vcc
    v_cndmask_b32_e64 v179, v175, v8, s[56:57]
    s_mul_i32 s53, s45, 2304
    s_add_u32 s53, s53, s51
    s_waitcnt vmcnt(0)
    v_cmp_eq_u64 vcc, s[98:99], v[12:13]
    s_nop 0
    s_cmp_eq_u64 vcc, exec
    s_cbranch_scc0 L_px_slow_97
L_px_back_98:
    s_add_u32 s54, s51, 0
    buffer_load_dwordx4 a[0:3], v2, s[4:7], s54 offen offset:0 sc1
    s_add_u32 s55, s51, 18432
    buffer_load_dwordx4 a[72:75], v2, s[4:7], s55 offen offset:0 sc1
    buffer_load_dwordx4 a[4:7], v2, s[4:7], s54 offen offset:1024 sc1
    buffer_load_dwordx4 a[76:79], v2, s[4:7], s55 offen offset:1024 sc1
    buffer_load_dwordx4 a[8:11], v2, s[4:7], s54 offen offset:2048 sc1
    buffer_load_dwordx4 a[80:83], v2, s[4:7], s55 offen offset:2048 sc1
    s_waitcnt vmcnt(5) lgkmcnt(6)
    s_add_u32 m0, s50, 0
    s_add_u32 s53, s49, 0
    v_mfma_f32_16x16x32_bf16 v[16:19], v[88:91], a[0:3], 0
    buffer_load_dwordx4 v2, s[4:7], s53 offen offset:0 sc1 lds
    s_waitcnt vmcnt(5)
    v_mfma_f32_16x16x32_bf16 v[48:51], v[88:91], a[72:75], 0
    buffer_load_dwordx4 v2, s[4:7], s53 offen offset:1024 sc1 lds
    buffer_load_dwordx4 v2, s[4:7], s53 offen offset:2048 sc1 lds
    buffer_load_dwordx4 v2, s[4:7], s53 offen offset:3072 sc1 lds
    s_add_u32 m0, s50, 4096
    s_add_u32 s53, s49, 4096
    buffer_load_dwordx4 v2, s[4:7], s53 offen offset:0 sc1 lds
    buffer_load_dwordx4 a[12:15], v2, s[4:7], s54 offen offset:3072 sc1
    buffer_load_dwordx4 a[84:87], v2, s[4:7], s55 offen offset:3072 sc1
    s_waitcnt lgkmcnt(5)
    v_mfma_f32_16x16x32_bf16 v[20:23], v[92:95], a[0:3], 0
    s_add_u32 s54, s51, 4096
    ds_read_b128 v[116:119], v3 offset:7168
    ds_read_b128 v[120:123], v3 offset:8192
    v_mfma_f32_16x16x32_bf16 v[52:55], v[92:95], a[72:75], 0
    s_waitcnt lgkmcnt(6)
    ds_read_b128 v[124:127], v3 offset:9216
    v_mfma_f32_16x16x32_bf16 v[24:27], v[96:99], a[0:3], 0
    v_mfma_f32_16x16x32_bf16 v[56:59], v[96:99], a[72:75], 0
    s_waitcnt lgkmcnt(6)
    ds_read_b128 v[128:131], v3 offset:10240
    v_mfma_f32_16x16x32_bf16 v[28:31], v[100:103], a[0:3], 0
    buffer_load_dwordx4 a[16:19], v2, s[4:7], s54 offen offset:0 sc1
    v_mfma_f32_16x16x32_bf16 v[60:63], v[100:103], a[72:75], 0
    s_waitcnt lgkmcnt(6)
    s_add_u32 s55, s51, 22528
    ds_read_b128 v[140:143], v3 offset:13312
    v_mfma_f32_16x16x32_bf16 v[32:35], v[112:115], a[0:3], 0
    ds_read_b128 v[132:135], v3 offset:11264
    v_mfma_f32_16x16x32_bf16 v[64:67], v[112:115], a[72:75], 0
    s_waitcnt lgkmcnt(7)
    v_mfma_f32_16x16x32_bf16 v[36:39], a[0:3], v[104:107], 0
    ds_read_b128 v[136:139], v3 offset:12288
    v_mfma_f32_16x16x32_bf16 v[68:71], a[72:75], v[104:107], 0
    s_waitcnt lgkmcnt(7)
    v_mfma_f32_16x16x32_bf16 v[40:43], a[0:3], v[108:111], 0
    buffer_load_dwordx4 a[88:91], v2, s[4:7], s55 offen offset:0 sc1
    v_mfma_f32_16x16x32_bf16 v[72:75], a[72:75], v[108:111], 0
    s_waitcnt vmcnt(12) lgkmcnt(6)
    v_mfma_f32_16x16x32_bf16 v[16:19], v[116:119], a[4:7], v[16:19]
    s_waitcnt vmcnt(11)
    ds_read_b128 v[88:91], v3 offset:14336
    v_mfma_f32_16x16x32_bf16 v[48:51], v[116:119], a[76:79], v[48:51]
    s_waitcnt lgkmcnt(6)
    ds_read_b128 v[92:95], v3 offset:15360
    v_mfma_f32_16x16x32_bf16 v[20:23], v[120:123], a[4:7], v[20:23]
    buffer_load_dwordx4 a[20:23], v2, s[4:7], s54 offen offset:1024 sc1
    v_mfma_f32_16x16x32_bf16 v[52:55], v[120:123], a[76:79], v[52:55]
    s_waitcnt lgkmcnt(6)
    ds_read_b128 v[96:99], v3 offset:16384
    v_mfma_f32_16x16x32_bf16 v[24:27], v[124:127], a[4:7], v[24:27]
    v_mfma_f32_16x16x32_bf16 v[56:59], v[124:127], a[76:79], v[56:59]
    s_waitcnt lgkmcnt(6)
    ds_read_b128 v[100:103], v3 offset:17408
    v_mfma_f32_16x16x32_bf16 v[28:31], v[128:131], a[4:7], v[28:31]
    buffer_load_dwordx4 a[92:95], v2, s[4:7], s55 offen offset:1024 sc1
    v_mfma_f32_16x16x32_bf16 v[60:63], v[128:131], a[76:79], v[60:63]
    s_waitcnt lgkmcnt(6)
    ds_read_b128 v[112:115], v3 offset:20480
    v_mfma_f32_16x16x32_bf16 v[32:35], v[140:143], a[4:7], v[32:35]
    ds_read_b128 v[104:107], v3 offset:18432
    v_mfma_f32_16x16x32_bf16 v[64:67], v[140:143], a[76:79], v[64:67]
    s_waitcnt lgkmcnt(7)
    v_mfma_f32_16x16x32_bf16 v[36:39], a[4:7], v[132:135], v[36:39]
    ds_read_b128 v[108:111], v3 offset:19456
    v_mfma_f32_16x16x32_bf16 v[68:71], a[76:79], v[132:135], v[68:71]
    s_waitcnt lgkmcnt(7)
    v_mfma_f32_16x16x32_bf16 v[40:43], a[4:7], v[136:139], v[40:43]
    buffer_load_dwordx4 a[24:27], v2, s[4:7], s54 offen offset:2048 sc1
    v_mfma_f32_16x16x32_bf16 v[72:75], a[76:79], v[136:139], v[72:75]
    s_waitcnt vmcnt(13) lgkmcnt(6)
    v_mfma_f32_16x16x32_bf16 v[16:19], v[88:91], a[8:11], v[16:19]
    s_waitcnt vmcnt(12)
    ds_read_b128 v[116:119], v3 offset:21504
    v_mfma_f32_16x16x32_bf16 v[48:51], v[88:91], a[80:83], v[48:51]
    s_waitcnt lgkmcnt(6)
    ds_read_b128 v[120:123], v3 offset:22528
    v_mfma_f32_16x16x32_bf16 v[20:23], v[92:95], a[8:11], v[20:23]
    buffer_load_dwordx4 a[96:99], v2, s[4:7], s55 offen offset:2048 sc1
    v_mfma_f32_16x16x32_bf16 v[52:55], v[92:95], a[80:83], v[52:55]
    s_waitcnt lgkmcnt(6)
    ds_read_b128 v[124:127], v3 offset:23552
    v_mfma_f32_16x16x32_bf16 v[24:27], v[96:99], a[8:11], v[24:27]
    v_mfma_f32_16x16x32_bf16 v[56:59], v[96:99], a[80:83], v[56:59]
    s_waitcnt lgkmcnt(6)
    ds_read_b128 v[128:131], v3 offset:24576
    v_mfma_f32_16x16x32_bf16 v[28:31], v[100:103], a[8:11], v[28:31]
    buffer_load_dwordx4 a[28:31], v2, s[4:7], s54 offen offset:3072 sc1
    v_mfma_f32_16x16x32_bf16 v[60:63], v[100:103], a[80:83], v[60:63]
    s_waitcnt lgkmcnt(6)
    ds_read_b128 v[140:143], v3 offset:27648
    v_mfma_f32_16x16x32_bf16 v[32:35], v[112:115], a[8:11], v[32:35]
    ds_read_b128 v[132:135], v3 offset:25600
    v_mfma_f32_16x16x32_bf16 v[64:67], v[112:115], a[80:83], v[64:67]
    s_waitcnt lgkmcnt(7)
    v_mfma_f32_16x16x32_bf16 v[36:39], a[8:11], v[104:107], v[36:39]
    ds_read_b128 v[136:139], v3 offset:26624
    v_mfma_f32_16x16x32_bf16 v[68:71], a[80:83], v[104:107], v[68:71]
    s_waitcnt lgkmcnt(7)
    v_mfma_f32_16x16x32_bf16 v[40:43], a[8:11], v[108:111], v[40:43]
    buffer_load_dwordx4 a[100:103], v2, s[4:7], s55 offen offset:3072 sc1
    v_mfma_f32_16x16x32_bf16 v[72:75], a[80:83], v[108:111], v[72:75]
    s_waitcnt vmcnt(9) lgkmcnt(6)
    s_add_u32 s54, s51, 8192
    v_mfma_f32_16x16x32_bf16 v[16:19], v[116:119], a[12:15], v[16:19]
    s_waitcnt vmcnt(8)
    ds_read_b128 v[88:91], v3 offset:28672
    v_mfma_f32_16x16x32_bf16 v[48:51], v[116:119], a[84:87], v[48:51]
    s_waitcnt lgkmcnt(6)
    ds_read_b128 v[92:95], v3 offset:29696
    v_mfma_f32_16x16x32_bf16 v[20:23], v[120:123], a[12:15], v[20:23]
    buffer_load_dwordx4 a[32:35], v2, s[4:7], s54 offen offset:0 sc1
    v_mfma_f32_16x16x32_bf16 v[52:55], v[120:123], a[84:87], v[52:55]
    s_waitcnt lgkmcnt(6)
    s_add_u32 s55, s51, 26624
    ds_read_b128 v[96:99], v3 offset:30720
    v_mfma_f32_16x16x32_bf16 v[24:27], v[124:127], a[12:15], v[24:27]
    v_mfma_f32_16x16x32_bf16 v[56:59], v[124:127], a[84:87], v[56:59]
    s_waitcnt lgkmcnt(6)
    ds_read_b128 v[100:103], v3 offset:31744
    v_mfma_f32_16x16x32_bf16 v[28:31], v[128:131], a[12:15], v[28:31]
    buffer_load_dwordx4 a[104:107], v2, s[4:7], s55 offen offset:0 sc1
    v_mfma_f32_16x16x32_bf16 v[60:63], v[128:131], a[84:87], v[60:63]
    s_waitcnt lgkmcnt(6)
    ds_read_b128 v[112:115], v3 offset:34816
    v_mfma_f32_16x16x32_bf16 v[32:35], v[140:143], a[12:15], v[32:35]
    ds_read_b128 v[104:107], v3 offset:32768
    v_mfma_f32_16x16x32_bf16 v[64:67], v[140:143], a[84:87], v[64:67]
    s_waitcnt lgkmcnt(7)
    v_mfma_f32_16x16x32_bf16 v[36:39], a[12:15], v[132:135], v[36:39]
    ds_read_b128 v[108:111], v3 offset:33792
    v_mfma_f32_16x16x32_bf16 v[68:71], a[84:87], v[132:135], v[68:71]
    s_waitcnt lgkmcnt(7)
    v_mfma_f32_16x16x32_bf16 v[40:43], a[12:15], v[136:139], v[40:43]
    buffer_load_dwordx4 a[36:39], v2, s[4:7], s54 offen offset:1024 sc1
    v_mfma_f32_16x16x32_bf16 v[72:75], a[84:87], v[136:139], v[72:75]
    s_waitcnt vmcnt(10) lgkmcnt(6)
    v_mfma_f32_16x16x32_bf16 v[16:19], v[88:91], a[16:19], v[16:19]
    s_waitcnt vmcnt(9)
    ds_read_b128 v[116:119], v3 offset:35840
    v_mfma_f32_16x16x32_bf16 v[48:51], v[88:91], a[88:91], v[48:51]
    s_waitcnt lgkmcnt(6)
    ds_read_b128 v[120:123], v3 offset:36864
    v_mfma_f32_16x16x32_bf16 v[20:23], v[92:95], a[16:19], v[20:23]
    buffer_load_dwordx4 a[108:111], v2, s[4:7], s55 offen offset:1024 sc1
    v_mfma_f32_16x16x32_bf16 v[52:55], v[92:95], a[88:91], v[52:55]
    s_waitcnt lgkmcnt(6)
    ds_read_b128 v[124:127], v3 offset:37888
    v_mfma_f32_16x16x32_bf16 v[24:27], v[96:99], a[16:19], v[24:27]
    v_mfma_f32_16x16x32_bf16 v[56:59], v[96:99], a[88:91], v[56:59]
    s_waitcnt lgkmcnt(6)
    ds_read_b128 v[128:131], v3 offset:38912
    v_mfma_f32_16x16x32_bf16 v[28:31], v[100:103], a[16:19], v[28:31]
    buffer_load_dwordx4 a[40:43], v2, s[4:7], s54 offen offset:2048 sc1
    v_mfma_f32_16x16x32_bf16 v[60:63], v[100:103], a[88:91], v[60:63]
    s_waitcnt lgkmcnt(6)
    ds_read_b128 v[140:143], v3 offset:41984
    v_mfma_f32_16x16x32_bf16 v[32:35], v[112:115], a[16:19], v[32:35]
    ds_read_b128 v[132:135], v3 offset:39936
    v_mfma_f32_16x16x32_bf16 v[64:67], v[112:115], a[88:91], v[64:67]
    s_waitcnt lgkmcnt(7)
    v_mfma_f32_16x16x32_bf16 v[36:39], a[16:19], v[104:107], v[36:39]
    ds_read_b128 v[136:139], v3 offset:40960
    v_mfma_f32_16x16x32_bf16 v[68:71], a[88:91], v[104:107], v[68:71]
    s_waitcnt lgkmcnt(7)
    v_mfma_f32_16x16x32_bf16 v[40:43], a[16:19], v[108:111], v[40:43]
    buffer_load_dwordx4 a[112:115], v2, s[4:7], s55 offen offset:2048 sc1
    v_mfma_f32_16x16x32_bf16 v[72:75], a[88:91], v[108:111], v[72:75]
    s_waitcnt vmcnt(11) lgkmcnt(6)
    v_mfma_f32_16x16x32_bf16 v[16:19], v[116:119], a[20:23], v[16:19]
    s_waitcnt vmcnt(10)
    s_barrier
    ds_read_b128 v[88:91], v3 offset:43008
    v_mfma_f32_16x16x32_bf16 v[48:51], v[116:119], a[92:95], v[48:51]
    s_waitcnt lgkmcnt(6)
    ds_read_b128 v[92:95], v3 offset:44032
    ds_read_b128 v[144:147], v10 offset:0
    v_mfma_f32_16x16x32_bf16 v[20:23], v[120:123], a[20:23], v[20:23]
    buffer_load_dwordx4 a[44:47], v2, s[4:7], s54 offen offset:3072 sc1
    v_mfma_f32_16x16x32_bf16 v[52:55], v[120:123], a[92:95], v[52:55]
    s_waitcnt lgkmcnt(7)
    ds_read_b128 v[96:99], v3 offset:45056
    ds_read_b128 v[148:151], v4 offset:0
    v_mfma_f32_16x16x32_bf16 v[24:27], v[124:127], a[20:23], v[24:27]
    ds_read_b128 v[152:155], v5 offset:0
    ds_read_b128 v[156:159], v10 offset:1024
    v_mfma_f32_16x16x32_bf16 v[56:59], v[124:127], a[92:95], v[56:59]
    s_waitcnt lgkmcnt(10)
    ds_read_b128 v[100:103], v3 offset:46080
    ds_read_b128 v[160:163], v4 offset:7168
    v_mfma_f32_16x16x32_bf16 v[28:31], v[128:131], a[20:23], v[28:31]
    buffer_load_dwordx4 a[116:119], v2, s[4:7], s55 offen offset:3072 sc1
    v_mfma_f32_16x16x32_bf16 v[60:63], v[128:131], a[92:95], v[60:63]
    s_waitcnt lgkmcnt(11)
    s_add_u32 s54, s51, 12288
    ds_read_b128 v[112:115], v3 offset:49152
    v_mfma_f32_16x16x32_bf16 v[32:35], v[140:143], a[20:23], v[32:35]
    ds_read_b128 v[104:107], v3 offset:47104
    ds_read_b128 v[164:167], v5 offset:7168
    v_mfma_f32_16x16x32_bf16 v[64:67], v[140:143], a[92:95], v[64:67]
    s_waitcnt lgkmcnt(13)
    v_mfma_f32_16x16x32_bf16 v[36:39], a[20:23], v[132:135], v[36:39]
    ds_read_b128 v[108:111], v3 offset:48128
    v_mfma_f32_16x16x32_bf16 v[68:71], a[92:95], v[132:135], v[68:71]
    s_waitcnt lgkmcnt(13)
    v_mfma_f32_16x16x32_bf16 v[40:43], a[20:23], v[136:139], v[40:43]
    buffer_load_dwordx4 a[48:51], v2, s[4:7], s54 offen offset:0 sc1
    v_mfma_f32_16x16x32_bf16 v[72:75], a[92:95], v[136:139], v[72:75]
    s_waitcnt vmcnt(12) lgkmcnt(12)
    s_add_u32 s55, s51, 30720
    v_mfma_f32_16x16x32_bf16 v[16:19], v[88:91], a[24:27], v[16:19]
    s_waitcnt vmcnt(11)
    ds_read_b128 v[116:119], v3 offset:50176
    v_mfma_f32_16x16x32_bf16 v[48:51], v[88:91], a[96:99], v[48:51]
    s_waitcnt lgkmcnt(12)
    ds_read_b128 v[120:123], v3 offset:51200
    v_mfma_f32_16x16x32_bf16 v[20:23], v[92:95], a[24:27], v[20:23]
    buffer_load_dwordx4 a[120:123], v2, s[4:7], s55 offen offset:0 sc1
    v_mfma_f32_16x16x32_bf16 v[52:55], v[92:95], a[96:99], v[52:55]
    s_waitcnt lgkmcnt(11)
    ds_read_b128 v[124:127], v3 offset:52224
    v_mfma_f32_16x16x32_bf16 v[24:27], v[96:99], a[24:27], v[24:27]
    v_mfma_f32_16x16x32_bf16 v[56:59], v[96:99], a[96:99], v[56:59]
    s_waitcnt lgkmcnt(8)
    ds_read_b128 v[128:131], v3 offset:53248
    v_mfma_f32_16x16x32_bf16 v[28:31], v[100:103], a[24:27], v[28:31]
    buffer_load_dwordx4 a[52:55], v2, s[4:7], s54 offen offset:1024 sc1
    v_mfma_f32_16x16x32_bf16 v[60:63], v[100:103], a[96:99], v[60:63]
    s_waitcnt lgkmcnt(7)
    ds_read_b128 v[140:143], v3 offset:56320
    v_mfma_f32_16x16x32_bf16 v[32:35], v[112:115], a[24:27], v[32:35]
    ds_read_b128 v[132:135], v3 offset:54272
    v_mfma_f32_16x16x32_bf16 v[64:67], v[112:115], a[96:99], v[64:67]
    s_waitcnt lgkmcnt(8)
    v_mfma_f32_16x16x32_bf16 v[36:39], a[24:27], v[104:107], v[36:39]
    ds_read_b128 v[136:139], v3 offset:55296
    v_mfma_f32_16x16x32_bf16 v[68:71], a[96:99], v[104:107], v[68:71]
    s_waitcnt lgkmcnt(7)
    v_mfma_f32_16x16x32_bf16 v[40:43], a[24:27], v[108:111], v[40:43]
    buffer_load_dwordx4 a[124:127], v2, s[4:7], s55 offen offset:1024 sc1
    v_mfma_f32_16x16x32_bf16 v[72:75], a[96:99], v[108:111], v[72:75]
    v_mfma_f32_16x16x32_bf16 v[80:83], v[148:151], v[144:147], 0
    v_mfma_f32_16x16x32_bf16 v[84:87], v[144:147], v[152:155], 0
    s_waitcnt vmcnt(13) lgkmcnt(6)
    ds_read_b128 v[144:147], v10 offset:2048
    ds_read_b128 v[148:151], v4 offset:14336
    v_mfma_f32_16x16x32_bf16 v[16:19], v[116:119], a[28:31], v[16:19]
    buffer_load_dwordx4 a[56:59], v2, s[4:7], s54 offen offset:2048 sc1
    s_waitcnt vmcnt(13)
    v_mfma_f32_16x16x32_bf16 v[48:51], v[116:119], a[100:103], v[48:51]
    s_waitcnt lgkmcnt(7)
    ds_read_b128 v[88:91], v3 offset:57344
    ds_read_b128 v[92:95], v3 offset:58368
    v_mfma_f32_16x16x32_bf16 v[20:23], v[120:123], a[28:31], v[20:23]
    ds_read_b128 v[152:155], v5 offset:14336
    v_mfma_f32_16x16x32_bf16 v[52:55], v[120:123], a[100:103], v[52:55]
    s_waitcnt lgkmcnt(9)
    ds_read_b128 v[96:99], v3 offset:59392
    v_mfma_f32_16x16x32_bf16 v[24:27], v[124:127], a[28:31], v[24:27]
    buffer_load_dwordx4 a[128:131], v2, s[4:7], s55 offen offset:2048 sc1
    v_mfma_f32_16x16x32_bf16 v[56:59], v[124:127], a[100:103], v[56:59]
    s_waitcnt lgkmcnt(9)
    ds_read_b128 v[100:103], v3 offset:60416
    v_mfma_f32_16x16x32_bf16 v[28:31], v[128:131], a[28:31], v[28:31]
    v_mfma_f32_16x16x32_bf16 v[60:63], v[128:131], a[100:103], v[60:63]
    s_waitcnt lgkmcnt(9)
    ds_read_b128 v[112:115], v3 offset:63488
    v_mfma_f32_16x16x32_bf16 v[32:35], v[140:143], a[28:31], v[32:35]
    buffer_load_dwordx4 a[60:63], v2, s[4:7], s54 offen offset:3072 sc1
    v_mfma_f32_16x16x32_bf16 v[64:67], v[140:143], a[100:103], v[64:67]
    s_waitcnt lgkmcnt(9)
    ds_read_b128 v[104:107], v3 offset:61440
    v_mfma_f32_16x16x32_bf16 v[36:39], a[28:31], v[132:135], v[36:39]
    ds_read_b128 v[108:111], v3 offset:62464
    v_mfma_f32_16x16x32_bf16 v[68:71], a[100:103], v[132:135], v[68:71]
    s_waitcnt lgkmcnt(10)
    v_mfma_f32_16x16x32_bf16 v[40:43], a[28:31], v[136:139], v[40:43]
    buffer_load_dwordx4 a[132:135], v2, s[4:7], s55 offen offset:3072 sc1
    v_mfma_f32_16x16x32_bf16 v[72:75], a[100:103], v[136:139], v[72:75]
    s_add_u32 s54, s51, 16384
    v_mfma_f32_16x16x32_bf16 v[80:83], v[160:163], v[156:159], v[80:83]
    v_mfma_f32_16x16x32_bf16 v[84:87], v[156:159], v[164:167], v[84:87]
    s_waitcnt vmcnt(15) lgkmcnt(7)
    ds_read_b128 v[156:159], v10 offset:3072
    ds_read_b128 v[160:163], v4 offset:21504
    v_mfma_f32_16x16x32_bf16 v[16:19], v[88:91], a[32:35], v[16:19]
    buffer_load_dwordx4 a[64:67], v2, s[4:7], s54 offen offset:0 sc1
    s_waitcnt vmcnt(15)
    v_mfma_f32_16x16x32_bf16 v[48:51], v[88:91], a[104:107], v[48:51]
    s_waitcnt lgkmcnt(8)
    s_add_u32 s55, s51, 34816
    v_add_u32 v3, 64512, v3
    v_mfma_f32_16x16x32_bf16 v[20:23], v[92:95], a[32:35], v[20:23]
    ds_read_b128 v[116:119], v3 offset:0
    ds_read_b128 v[164:167], v5 offset:21504
    v_mfma_f32_16x16x32_bf16 v[52:55], v[92:95], a[104:107], v[52:55]
    s_waitcnt lgkmcnt(8)
    ds_read_b128 v[120:123], v3 offset:1024
    v_mfma_f32_16x16x32_bf16 v[24:27], v[96:99], a[32:35], v[24:27]
    buffer_load_dwordx4 a[136:139], v2, s[4:7], s55 offen offset:0 sc1
    v_mfma_f32_16x16x32_bf16 v[56:59], v[96:99], a[104:107], v[56:59]
    s_waitcnt lgkmcnt(8)
    ds_read_b128 v[124:127], v3 offset:2048
    v_mfma_f32_16x16x32_bf16 v[28:31], v[100:103], a[32:35], v[28:31]
    v_mfma_f32_16x16x32_bf16 v[60:63], v[100:103], a[104:107], v[60:63]
    s_waitcnt lgkmcnt(8)
    ds_read_b128 v[128:131], v3 offset:3072
    v_mfma_f32_16x16x32_bf16 v[32:35], v[112:115], a[32:35], v[32:35]
    buffer_load_dwordx4 a[68:71], v2, s[4:7], s54 offen offset:1024 sc1
    v_mfma_f32_16x16x32_bf16 v[64:67], v[112:115], a[104:107], v[64:67]
    s_waitcnt lgkmcnt(8)
    ds_read_b128 v[140:143], v3 offset:6144
    v_mfma_f32_16x16x32_bf16 v[36:39], a[32:35], v[104:107], v[36:39]
    ds_read_b128 v[132:135], v3 offset:4096
    v_mfma_f32_16x16x32_bf16 v[68:71], a[104:107], v[104:107], v[68:71]
    s_waitcnt lgkmcnt(9)
    v_mfma_f32_16x16x32_bf16 v[40:43], a[32:35], v[108:111], v[40:43]
    ds_read_b128 v[136:139], v3 offset:5120
    v_mfma_f32_16x16x32_bf16 v[72:75], a[104:107], v[108:111], v[72:75]
    v_mfma_f32_16x16x32_bf16 v[80:83], v[148:151], v[144:147], v[80:83]
    v_mfma_f32_16x16x32_bf16 v[84:87], v[144:147], v[152:155], v[84:87]
    s_waitcnt vmcnt(16) lgkmcnt(7)
    ds_read_b128 v[144:147], v10 offset:4096
    ds_read_b128 v[148:151], v4 offset:28672
    v_mfma_f32_16x16x32_bf16 v[16:19], v[116:119], a[36:39], v[16:19]
    buffer_load_dwordx4 a[140:143], v2, s[4:7], s55 offen offset:1024 sc1
    s_waitcnt vmcnt(16)
    v_mfma_f32_16x16x32_bf16 v[48:51], v[116:119], a[108:111], v[48:51]
    s_waitcnt lgkmcnt(7)
    s_lshl_b32 s53, s22, 2
    s_add_u32 s53, s53, s20
    v_mfma_f32_16x16x32_bf16 v[20:23], v[120:123], a[36:39], v[20:23]
    s_mul_i32 s53, s53, 5248
    s_add_u32 s53, s53, 2097152
    ds_read_b128 v[88:91], v3 offset:7168
    v_mfma_f32_16x16x32_bf16 v[52:55], v[120:123], a[108:111], v[52:55]
    s_waitcnt lgkmcnt(7)
    ds_read_b128 v[92:95], v3 offset:8192
    ds_read_b128 v[96:99], v3 offset:9216
    v_mfma_f32_16x16x32_bf16 v[24:27], v[124:127], a[36:39], v[24:27]
    ds_read_b128 v[152:155], v5 offset:28672
    v_min_u32 v11, 40, v1
    v_mfma_f32_16x16x32_bf16 v[56:59], v[124:127], a[108:111], v[56:59]
    s_waitcnt lgkmcnt(9)
    ds_read_b128 v[100:103], v3 offset:10240
    v_lshlrev_b32 v11, 7, v11
    v_mfma_f32_16x16x32_bf16 v[28:31], v[128:131], a[36:39], v[28:31]
    buffer_load_dword v13, v11, s[4:7], s53 offen
    v_mfma_f32_16x16x32_bf16 v[60:63], v[128:131], a[108:111], v[60:63]
    s_waitcnt lgkmcnt(9)
    s_and_b32 s53, s21, 7
    s_lshl_b32 s53, s53, 2
    v_mfma_f32_16x16x32_bf16 v[32:35], v[140:143], a[36:39], v[32:35]
    s_and_b32 s54, s22, 3
    s_add_u32 s53, s53, s54
    s_mul_i32 s53, s53, 497664
    v_mfma_f32_16x16x32_bf16 v[64:67], v[140:143], a[108:111], v[64:67]
    s_waitcnt lgkmcnt(8)
    s_lshr_b32 s54, s22, 2
    s_lshl_b32 s54, s54, 2
    v_mfma_f32_16x16x32_bf16 v[36:39], a[36:39], v[132:135], v[36:39]
    s_add_u32 s54, s54, s20
    ds_read_b128 v[112:115], v3 offset:13312
    ds_read_b128 v[104:107], v3 offset:11264
    v_mfma_f32_16x16x32_bf16 v[68:71], a[108:111], v[132:135], v[68:71]
    s_waitcnt lgkmcnt(9)
    s_mul_i32 s54, s54, 4608
    ds_read_b128 v[108:111], v3 offset:12288
    v_mfma_f32_16x16x32_bf16 v[40:43], a[36:39], v[136:139], v[40:43]
    s_add_u32 s53, s53, s54
    s_add_u32 s53, s53, 4194304
    v_min_u32 v11, 35, v1
    v_mfma_f32_16x16x32_bf16 v[72:75], a[108:111], v[136:139], v[72:75]
    v_lshlrev_b32 v11, 7, v11
    v_mfma_f32_16x16x32_bf16 v[80:83], v[160:163], v[156:159], v[80:83]
    v_mfma_f32_16x16x32_bf16 v[84:87], v[156:159], v[164:167], v[84:87]
    s_waitcnt vmcnt(16) lgkmcnt(7)
    ds_read_b128 v[156:159], v10 offset:5120
    ds_read_b128 v[160:163], v4 offset:35840
    v_mfma_f32_16x16x32_bf16 v[16:19], v[88:91], a[40:43], v[16:19]
    buffer_load_dword v14, v11, s[4:7], s53 offen
    s_waitcnt vmcnt(16)
    v_mfma_f32_16x16x32_bf16 v[48:51], v[88:91], a[112:115], v[48:51]
    s_waitcnt lgkmcnt(8)
    ds_read_b128 v[116:119], v3 offset:14336
    ds_read_b128 v[120:123], v3 offset:15360
    v_mfma_f32_16x16x32_bf16 v[20:23], v[92:95], a[40:43], v[20:23]
    ds_read_b128 v[164:167], v5 offset:35840
    v_mfma_f32_16x16x32_bf16 v[52:55], v[92:95], a[112:115], v[52:55]
    s_waitcnt lgkmcnt(10)
    ds_read_b128 v[124:127], v3 offset:16384
    v_mfma_f32_16x16x32_bf16 v[24:27], v[96:99], a[40:43], v[24:27]
    v_mfma_f32_16x16x32_bf16 v[56:59], v[96:99], a[112:115], v[56:59]
    s_waitcnt lgkmcnt(9)
    ds_read_b128 v[128:131], v3 offset:17408
    v_mfma_f32_16x16x32_bf16 v[28:31], v[100:103], a[40:43], v[28:31]
    v_mfma_f32_16x16x32_bf16 v[60:63], v[100:103], a[112:115], v[60:63]
    s_waitcnt lgkmcnt(9)
    ds_read_b128 v[140:143], v3 offset:20480
    v_mfma_f32_16x16x32_bf16 v[32:35], v[112:115], a[40:43], v[32:35]
    ds_read_b128 v[132:135], v3 offset:18432
    v_mfma_f32_16x16x32_bf16 v[64:67], v[112:115], a[112:115], v[64:67]
    s_waitcnt lgkmcnt(10)
    v_mfma_f32_16x16x32_bf16 v[36:39], a[40:43], v[104:107], v[36:39]
    ds_read_b128 v[136:139], v3 offset:19456
    v_mfma_f32_16x16x32_bf16 v[68:71], a[112:115], v[104:107], v[68:71]
    s_waitcnt lgkmcnt(10)
    v_mfma_f32_16x16x32_bf16 v[40:43], a[40:43], v[108:111], v[40:43]
    v_mfma_f32_16x16x32_bf16 v[72:75], a[112:115], v[108:111], v[72:75]
    v_mfma_f32_16x16x32_bf16 v[80:83], v[148:151], v[144:147], v[80:83]
    v_mfma_f32_16x16x32_bf16 v[84:87], v[144:147], v[152:155], v[84:87]
    s_waitcnt vmcnt(15) lgkmcnt(7)
    ds_read_b128 v[144:147], v10 offset:6144
    ds_read_b128 v[148:151], v4 offset:43008
    v_mfma_f32_16x16x32_bf16 v[16:19], v[116:119], a[44:47], v[16:19]
    s_waitcnt vmcnt(14)
    ds_read_b128 v[88:91], v3 offset:21504
    ds_read_b128 v[152:155], v5 offset:43008
    v_mfma_f32_16x16x32_bf16 v[48:51], v[116:119], a[116:119], v[48:51]
    s_waitcnt lgkmcnt(10)
    ds_read_b128 v[92:95], v3 offset:22528
    v_mfma_f32_16x16x32_bf16 v[20:23], v[120:123], a[44:47], v[20:23]
    v_mfma_f32_16x16x32_bf16 v[52:55], v[120:123], a[116:119], v[52:55]
    s_waitcnt lgkmcnt(9)
    ds_read_b128 v[96:99], v3 offset:23552
    v_mfma_f32_16x16x32_bf16 v[24:27], v[124:127], a[44:47], v[24:27]
    v_mfma_f32_16x16x32_bf16 v[56:59], v[124:127], a[116:119], v[56:59]
    s_waitcnt lgkmcnt(9)
    ds_read_b128 v[100:103], v3 offset:24576
    v_mfma_f32_16x16x32_bf16 v[28:31], v[128:131], a[44:47], v[28:31]
    v_mfma_f32_16x16x32_bf16 v[60:63], v[128:131], a[116:119], v[60:63]
    s_waitcnt lgkmcnt(9)
    ds_read_b128 v[112:115], v3 offset:27648
    v_mfma_f32_16x16x32_bf16 v[32:35], v[140:143], a[44:47], v[32:35]
    ds_read_b128 v[104:107], v3 offset:25600
    v_mfma_f32_16x16x32_bf16 v[64:67], v[140:143], a[116:119], v[64:67]
    s_waitcnt lgkmcnt(10)
    v_mfma_f32_16x16x32_bf16 v[36:39], a[44:47], v[132:135], v[36:39]
    ds_read_b128 v[108:111], v3 offset:26624
    v_mfma_f32_16x16x32_bf16 v[68:71], a[116:119], v[132:135], v[68:71]
    s_waitcnt lgkmcnt(10)
    v_mfma_f32_16x16x32_bf16 v[40:43], a[44:47], v[136:139], v[40:43]
    v_mfma_f32_16x16x32_bf16 v[72:75], a[116:119], v[136:139], v[72:75]
    v_mfma_f32_16x16x32_bf16 v[80:83], v[160:163], v[156:159], v[80:83]
    v_mfma_f32_16x16x32_bf16 v[84:87], v[156:159], v[164:167], v[84:87]
    s_waitcnt vmcnt(13) lgkmcnt(7)
    ds_read_b128 v[156:159], v10 offset:7168
    ds_read_b128 v[160:163], v4 offset:50176
    v_mfma_f32_16x16x32_bf16 v[16:19], v[88:91], a[48:51], v[16:19]
    s_waitcnt vmcnt(12)
    ds_read_b128 v[164:167], v5 offset:50176
    ds_read_b128 v[116:119], v3 offset:28672
    v_mfma_f32_16x16x32_bf16 v[48:51], v[88:91], a[120:123], v[48:51]
    s_waitcnt lgkmcnt(9)
    ds_read_b128 v[120:123], v3 offset:29696
    v_mfma_f32_16x16x32_bf16 v[20:23], v[92:95], a[48:51], v[20:23]
    v_mfma_f32_16x16x32_bf16 v[52:55], v[92:95], a[120:123], v[52:55]
    s_waitcnt lgkmcnt(9)
    ds_read_b128 v[124:127], v3 offset:30720
    v_mfma_f32_16x16x32_bf16 v[24:27], v[96:99], a[48:51], v[24:27]
    v_mfma_f32_16x16x32_bf16 v[56:59], v[96:99], a[120:123], v[56:59]
    ds_read_b128 v[128:131], v3 offset:31744
    v_mfma_f32_16x16x32_bf16 v[80:83], v[148:151], v[144:147], v[80:83]
    v_mfma_f32_16x16x32_bf16 v[84:87], v[144:147], v[152:155], v[84:87]
    s_waitcnt lgkmcnt(10)
    ds_read_b128 v[140:143], v3 offset:34816
    ds_read_b128 v[144:147], v10 offset:8192
    v_mfma_f32_16x16x32_bf16 v[28:31], v[100:103], a[48:51], v[28:31]
    ds_read_b128 v[132:135], v3 offset:32768
    ds_read_b128 v[148:151], v4 offset:57344
    v_mfma_f32_16x16x32_bf16 v[60:63], v[100:103], a[120:123], v[60:63]
    s_waitcnt lgkmcnt(13)
    ds_read_b128 v[152:155], v5 offset:57344
    v_mfma_f32_16x16x32_bf16 v[32:35], v[112:115], a[48:51], v[32:35]
    ds_read_b128 v[136:139], v3 offset:33792
    v_mfma_f32_16x16x32_bf16 v[64:67], v[112:115], a[120:123], v[64:67]
    s_waitcnt lgkmcnt(14)
    v_mfma_f32_16x16x32_bf16 v[36:39], a[48:51], v[104:107], v[36:39]
    v_mfma_f32_16x16x32_bf16 v[68:71], a[120:123], v[104:107], v[68:71]
    s_waitcnt lgkmcnt(13)
    v_mfma_f32_16x16x32_bf16 v[40:43], a[48:51], v[108:111], v[40:43]
    v_mfma_f32_16x16x32_bf16 v[72:75], a[120:123], v[108:111], v[72:75]
    s_waitcnt lgkmcnt(11)
    v_mfma_f32_16x16x32_bf16 v[80:83], v[160:163], v[156:159], v[80:83]
    s_waitcnt lgkmcnt(10)
    v_mfma_f32_16x16x32_bf16 v[84:87], v[156:159], v[164:167], v[84:87]
    s_waitcnt vmcnt(11) lgkmcnt(9)
    v_add_u32 v4, 64512, v4
    v_add_u32 v5, 64512, v5
    v_mfma_f32_16x16x32_bf16 v[16:19], v[116:119], a[52:55], v[16:19]
    s_waitcnt vmcnt(10)
    ds_read_b128 v[156:159], v10 offset:9216
    ds_read_b128 v[160:163], v4 offset:0
    v_mfma_f32_16x16x32_bf16 v[48:51], v[116:119], a[124:127], v[48:51]
    s_waitcnt lgkmcnt(10)
    ds_read_b128 v[164:167], v5 offset:0
    ds_read_b128 v[88:91], v3 offset:35840
    v_mfma_f32_16x16x32_bf16 v[20:23], v[120:123], a[52:55], v[20:23]
    ds_read_b128 v[92:95], v3 offset:36864
    v_mfma_f32_16x16x32_bf16 v[52:55], v[120:123], a[124:127], v[52:55]
    s_waitcnt lgkmcnt(12)
    ds_read_b128 v[96:99], v3 offset:37888
    v_mfma_f32_16x16x32_bf16 v[24:27], v[124:127], a[52:55], v[24:27]
    v_mfma_f32_16x16x32_bf16 v[56:59], v[124:127], a[124:127], v[56:59]
    s_waitcnt lgkmcnt(8)
    ds_read_b128 v[100:103], v3 offset:38912
    v_mfma_f32_16x16x32_bf16 v[80:83], v[148:151], v[144:147], v[80:83]
    s_waitcnt lgkmcnt(8)
    v_mfma_f32_16x16x32_bf16 v[84:87], v[144:147], v[152:155], v[84:87]
    ds_read_b128 v[112:115], v3 offset:41984
    ds_read_b128 v[144:147], v10 offset:10240
    v_mfma_f32_16x16x32_bf16 v[28:31], v[128:131], a[52:55], v[28:31]
    ds_read_b128 v[104:107], v3 offset:39936
    ds_read_b128 v[148:151], v4 offset:7168
    v_mfma_f32_16x16x32_bf16 v[60:63], v[128:131], a[124:127], v[60:63]
    ds_read_b128 v[152:155], v5 offset:7168
    v_mfma_f32_16x16x32_bf16 v[32:35], v[140:143], a[52:55], v[32:35]
    ds_read_b128 v[108:111], v3 offset:40960
    v_mfma_f32_16x16x32_bf16 v[64:67], v[140:143], a[124:127], v[64:67]
    v_mfma_f32_16x16x32_bf16 v[36:39], a[52:55], v[132:135], v[36:39]
    v_mfma_f32_16x16x32_bf16 v[68:71], a[124:127], v[132:135], v[68:71]
    s_waitcnt lgkmcnt(13)
    v_mfma_f32_16x16x32_bf16 v[40:43], a[52:55], v[136:139], v[40:43]
    v_mfma_f32_16x16x32_bf16 v[72:75], a[124:127], v[136:139], v[72:75]
    s_waitcnt lgkmcnt(11)
    v_mfma_f32_16x16x32_bf16 v[80:83], v[160:163], v[156:159], v[80:83]
    s_waitcnt lgkmcnt(10)
    v_mfma_f32_16x16x32_bf16 v[84:87], v[156:159], v[164:167], v[84:87]
    s_waitcnt vmcnt(9) lgkmcnt(9)
    ds_read_b128 v[156:159], v10 offset:11264
    ds_read_b128 v[160:163], v4 offset:14336
    v_mfma_f32_16x16x32_bf16 v[16:19], v[88:91], a[56:59], v[16:19]
    s_waitcnt vmcnt(8)
    ds_read_b128 v[164:167], v5 offset:14336
    ds_read_b128 v[116:119], v3 offset:43008
    v_mfma_f32_16x16x32_bf16 v[48:51], v[88:91], a[128:131], v[48:51]
    s_waitcnt lgkmcnt(12)
    ds_read_b128 v[120:123], v3 offset:44032
    v_mfma_f32_16x16x32_bf16 v[20:23], v[92:95], a[56:59], v[20:23]
    v_mfma_f32_16x16x32_bf16 v[52:55], v[92:95], a[128:131], v[52:55]
    s_waitcnt lgkmcnt(12)
    ds_read_b128 v[124:127], v3 offset:45056
    v_mfma_f32_16x16x32_bf16 v[24:27], v[96:99], a[56:59], v[24:27]
    v_mfma_f32_16x16x32_bf16 v[56:59], v[96:99], a[128:131], v[56:59]
    s_waitcnt lgkmcnt(8)
    ds_read_b128 v[128:131], v3 offset:46080
    v_mfma_f32_16x16x32_bf16 v[80:83], v[148:151], v[144:147], v[80:83]
    s_waitcnt lgkmcnt(8)
    v_mfma_f32_16x16x32_bf16 v[84:87], v[144:147], v[152:155], v[84:87]
    ds_read_b128 v[140:143], v3 offset:49152
    ds_read_b128 v[144:147], v10 offset:12288
    v_mfma_f32_16x16x32_bf16 v[28:31], v[100:103], a[56:59], v[28:31]
    ds_read_b128 v[132:135], v3 offset:47104
    ds_read_b128 v[148:151], v4 offset:21504
    v_mfma_f32_16x16x32_bf16 v[60:63], v[100:103], a[128:131], v[60:63]
    ds_read_b128 v[152:155], v5 offset:21504
    v_mfma_f32_16x16x32_bf16 v[32:35], v[112:115], a[56:59], v[32:35]
    ds_read_b128 v[136:139], v3 offset:48128
    v_mfma_f32_16x16x32_bf16 v[64:67], v[112:115], a[128:131], v[64:67]
    v_mfma_f32_16x16x32_bf16 v[36:39], a[56:59], v[104:107], v[36:39]
    v_mfma_f32_16x16x32_bf16 v[68:71], a[128:131], v[104:107], v[68:71]
    s_waitcnt lgkmcnt(13)
    v_mfma_f32_16x16x32_bf16 v[40:43], a[56:59], v[108:111], v[40:43]
    v_mfma_f32_16x16x32_bf16 v[72:75], a[128:131], v[108:111], v[72:75]
    s_waitcnt lgkmcnt(11)
    v_mfma_f32_16x16x32_bf16 v[80:83], v[160:163], v[156:159], v[80:83]
    s_waitcnt lgkmcnt(10)
    v_mfma_f32_16x16x32_bf16 v[84:87], v[156:159], v[164:167], v[84:87]
    s_waitcnt vmcnt(7) lgkmcnt(9)
    ds_read_b128 v[156:159], v10 offset:13312
    ds_read_b128 v[160:163], v4 offset:28672
    v_mfma_f32_16x16x32_bf16 v[16:19], v[116:119], a[60:63], v[16:19]
    s_waitcnt vmcnt(6)
    ds_read_b128 v[164:167], v5 offset:28672
    ds_read_b128 v[88:91], v3 offset:50176
    v_mfma_f32_16x16x32_bf16 v[48:51], v[116:119], a[132:135], v[48:51]
    s_waitcnt lgkmcnt(12)
    ds_read_b128 v[92:95], v3 offset:51200
    v_mfma_f32_16x16x32_bf16 v[20:23], v[120:123], a[60:63], v[20:23]
    v_mfma_f32_16x16x32_bf16 v[52:55], v[120:123], a[132:135], v[52:55]
    s_waitcnt lgkmcnt(12)
    ds_read_b128 v[96:99], v3 offset:52224
    v_mfma_f32_16x16x32_bf16 v[24:27], v[124:127], a[60:63], v[24:27]
    v_mfma_f32_16x16x32_bf16 v[56:59], v[124:127], a[132:135], v[56:59]
    s_waitcnt lgkmcnt(8)
    ds_read_b128 v[100:103], v3 offset:53248
    v_mfma_f32_16x16x32_bf16 v[80:83], v[148:151], v[144:147], v[80:83]
    s_waitcnt lgkmcnt(8)
    v_mfma_f32_16x16x32_bf16 v[84:87], v[144:147], v[152:155], v[84:87]
    ds_read_b128 v[112:115], v3 offset:56320
    ds_read_b128 v[144:147], v10 offset:14336
    v_mfma_f32_16x16x32_bf16 v[28:31], v[128:131], a[60:63], v[28:31]
    ds_read_b128 v[104:107], v3 offset:54272
    ds_read_b128 v[148:151], v4 offset:35840
    v_mfma_f32_16x16x32_bf16 v[60:63], v[128:131], a[132:135], v[60:63]
    ds_read_b128 v[152:155], v5 offset:35840
    v_mfma_f32_16x16x32_bf16 v[32:35], v[140:143], a[60:63], v[32:35]
    ds_read_b128 v[108:111], v3 offset:55296
    v_mfma_f32_16x16x32_bf16 v[64:67], v[140:143], a[132:135], v[64:67]
    v_mfma_f32_16x16x32_bf16 v[36:39], a[60:63], v[132:135], v[36:39]
    v_mfma_f32_16x16x32_bf16 v[68:71], a[132:135], v[132:135], v[68:71]
    s_waitcnt lgkmcnt(13)
    v_mfma_f32_16x16x32_bf16 v[40:43], a[60:63], v[136:139], v[40:43]
    v_mfma_f32_16x16x32_bf16 v[72:75], a[132:135], v[136:139], v[72:75]
    s_waitcnt lgkmcnt(11)
    v_mfma_f32_16x16x32_bf16 v[80:83], v[160:163], v[156:159], v[80:83]
    s_waitcnt lgkmcnt(10)
    v_mfma_f32_16x16x32_bf16 v[84:87], v[156:159], v[164:167], v[84:87]
    s_waitcnt vmcnt(5) lgkmcnt(9)
    ds_read_b128 v[156:159], v10 offset:15360
    ds_read_b128 v[160:163], v4 offset:43008
    v_mfma_f32_16x16x32_bf16 v[16:19], v[88:91], a[64:67], v[16:19]
    s_waitcnt vmcnt(4)
    ds_read_b128 v[164:167], v5 offset:43008
    ds_read_b128 v[116:119], v3 offset:57344
    v_mfma_f32_16x16x32_bf16 v[48:51], v[88:91], a[136:139], v[48:51]
    s_waitcnt lgkmcnt(12)
    ds_read_b128 v[120:123], v3 offset:58368
    v_mfma_f32_16x16x32_bf16 v[20:23], v[92:95], a[64:67], v[20:23]
    v_mfma_f32_16x16x32_bf16 v[52:55], v[92:95], a[136:139], v[52:55]
    s_waitcnt lgkmcnt(12)
    ds_read_b128 v[124:127], v3 offset:59392
    v_mfma_f32_16x16x32_bf16 v[24:27], v[96:99], a[64:67], v[24:27]
    v_mfma_f32_16x16x32_bf16 v[56:59], v[96:99], a[136:139], v[56:59]
    s_waitcnt lgkmcnt(8)
    ds_read_b128 v[128:131], v3 offset:60416
    v_mfma_f32_16x16x32_bf16 v[80:83], v[148:151], v[144:147], v[80:83]
    s_waitcnt lgkmcnt(8)
    v_mfma_f32_16x16x32_bf16 v[84:87], v[144:147], v[152:155], v[84:87]
    ds_read_b128 v[140:143], v3 offset:63488
    ds_read_b128 v[144:147], v10 offset:16384
    v_mfma_f32_16x16x32_bf16 v[28:31], v[100:103], a[64:67], v[28:31]
    ds_read_b128 v[132:135], v3 offset:61440
    ds_read_b128 v[148:151], v4 offset:50176
    v_mfma_f32_16x16x32_bf16 v[60:63], v[100:103], a[136:139], v[60:63]
    ds_read_b128 v[152:155], v5 offset:50176
    v_mfma_f32_16x16x32_bf16 v[32:35], v[112:115], a[64:67], v[32:35]
    ds_read_b128 v[136:139], v3 offset:62464
    v_mfma_f32_16x16x32_bf16 v[64:67], v[112:115], a[136:139], v[64:67]
    v_mfma_f32_16x16x32_bf16 v[36:39], a[64:67], v[104:107], v[36:39]
    v_mfma_f32_16x16x32_bf16 v[68:71], a[136:139], v[104:107], v[68:71]
    s_waitcnt lgkmcnt(13)
    v_mfma_f32_16x16x32_bf16 v[40:43], a[64:67], v[108:111], v[40:43]
    v_mfma_f32_16x16x32_bf16 v[72:75], a[136:139], v[108:111], v[72:75]
    s_waitcnt lgkmcnt(11)
    v_mfma_f32_16x16x32_bf16 v[80:83], v[160:163], v[156:159], v[80:83]
    s_waitcnt lgkmcnt(10)
    v_mfma_f32_16x16x32_bf16 v[84:87], v[156:159], v[164:167], v[84:87]
    s_waitcnt vmcnt(3) lgkmcnt(9)
    ds_read_b128 v[156:159], v10 offset:17408
    ds_read_b128 v[160:163], v4 offset:57344
    v_mfma_f32_16x16x32_bf16 v[16:19], v[116:119], a[68:71], v[16:19]
    s_waitcnt vmcnt(2)
    ds_read_b128 v[164:167], v5 offset:57344
    v_mfma_f32_16x16x32_bf16 v[48:51], v[116:119], a[140:143], v[48:51]
    s_waitcnt lgkmcnt(11)
    v_mfma_f32_16x16x32_bf16 v[20:23], v[120:123], a[68:71], v[20:23]
    v_mfma_f32_16x16x32_bf16 v[52:55], v[120:123], a[140:143], v[52:55]
    s_waitcnt lgkmcnt(10)
    v_mfma_f32_16x16x32_bf16 v[24:27], v[124:127], a[68:71], v[24:27]
    v_mfma_f32_16x16x32_bf16 v[56:59], v[124:127], a[140:143], v[56:59]
    s_waitcnt lgkmcnt(5)
    v_mfma_f32_16x16x32_bf16 v[80:83], v[148:151], v[144:147], v[80:83]
    s_waitcnt lgkmcnt(4)
    v_mfma_f32_16x16x32_bf16 v[84:87], v[144:147], v[152:155], v[84:87]
    v_mfma_f32_16x16x32_bf16 v[28:31], v[128:131], a[68:71], v[28:31]
    v_mfma_f32_16x16x32_bf16 v[60:63], v[128:131], a[140:143], v[60:63]
    v_mfma_f32_16x16x32_bf16 v[32:35], v[140:143], a[68:71], v[32:35]
    v_mfma_f32_16x16x32_bf16 v[64:67], v[140:143], a[140:143], v[64:67]
    v_mfma_f32_16x16x32_bf16 v[36:39], a[68:71], v[132:135], v[36:39]
    v_mfma_f32_16x16x32_bf16 v[68:71], a[140:143], v[132:135], v[68:71]
    s_waitcnt lgkmcnt(3)
    v_mfma_f32_16x16x32_bf16 v[40:43], a[68:71], v[136:139], v[40:43]
    v_mfma_f32_16x16x32_bf16 v[72:75], a[140:143], v[136:139], v[72:75]
    s_waitcnt lgkmcnt(1)
    v_mfma_f32_16x16x32_bf16 v[80:83], v[160:163], v[156:159], v[80:83]
    s_waitcnt lgkmcnt(0)
    v_mfma_f32_16x16x32_bf16 v[84:87], v[156:159], v[164:167], v[84:87]
    v_lshlrev_b32 v6, 3, v1
    v_add_u32 v6, 148608, v6
    s_mul_i32 s52, s20, 3072
    v_add_u32 v7, s52, v6
    s_lshl_b32 s52, s20, 8
    s_add_u32 s52, s52, 161024
    s_waitcnt vmcnt(1)
    v_lshl_add_u32 v13, v1, 3, s52
    s_waitcnt vmcnt(0)
    v_lshrrev_b32 v14, 2, v1
    v_lshl_add_u32 v14, v14, 3, s52
    v_cvt_pk_bf16_f32 v100, v56, v57
    v_cvt_pk_bf16_f32 v101, v58, v59
    v_cvt_pk_bf16_f32 v104, v60, v61
    v_cvt_pk_bf16_f32 v105, v62, v63
    v_cvt_pk_bf16_f32 v134, v64, v65
    v_cvt_pk_bf16_f32 v137, v66, v67
    v_mov_b32 v102, 0
    v_mov_b32 v103, 0
    v_cvt_pk_bf16_f32 v110, v68, v69
    v_cvt_pk_bf16_f32 v111, v70, v71
    v_cvt_pk_bf16_f32 v116, v72, v73
    v_cvt_pk_bf16_f32 v117, v74, v75
    s_mov_b32 exec_lo, 0xffff0000
    s_mov_b32 exec_hi, 0
    ds_write2_b32 v13, v134, v137 offset0:64 offset1:65
    s_mov_b64 exec, -1
    v_permlane32_swap_b32 v134, v102
    v_permlane32_swap_b32 v137, v103
    s_cmp_eq_u32 s20, 3
    s_cbranch_scc1 L_w3_100
    ds_write_b64 v7, v[100:101] offset:3072
    ds_write_b64 v7, v[102:103] offset:3584
    ds_write_b64 v7, v[104:105] offset:4096
    ds_write_b64 v7, v[110:111] offset:4608
    ds_write_b64 v7, v[116:117] offset:5120
L_w3_100:
    v_cvt_pk_bf16_f32 v140, v80, v81
    v_cvt_pk_bf16_f32 v141, v82, v83
    v_cvt_pk_bf16_f32 v142, v84, v85
    v_cvt_pk_bf16_f32 v143, v86, v87
    s_min_u32 s52, s20, 2
    s_lshl_b32 s53, s52, 1
    s_cmp_ge_u32 s20, 2
    s_cselect_b32 s53, 1, s53
    s_lshl_b32 s53, s53, 9
    s_and_b32 s52, s20, 1
    s_add_u32 s52, s52, 3
    s_lshl_b32 s52, s52, 9
    v_add_u32 v8, s53, v6
    v_add_u32 v9, s52, v6
    s_cmp_lt_u32 s20, 2
    s_cbranch_scc1 L_noswap_101
    v_lshlrev_b32 v10, 3, v1
    v_add_u32 v10, 161024, v10
    s_mov_b32 exec_lo, 0xffff0000
    s_mov_b32 exec_hi, 0
    ds_write_b64 v10, v[140:141]
    s_mov_b64 exec, -1
    v_mov_b32 v10, 0
    v_mov_b32 v11, 0
    s_nop 1
    v_permlane32_swap_b32 v140, v10
    v_permlane32_swap_b32 v141, v11
    v_mov_b32 v140, v10
    v_mov_b32 v141, v11
L_noswap_101:
    ds_write_b64 v8, v[140:141]
    ds_write_b64 v9, v[142:143]
    v_cvt_pk_bf16_f32 v132, v48, v49
    v_cvt_pk_bf16_f32 v133, v50, v51
    v_cvt_pk_bf16_f32 v138, v52, v53
    v_cvt_pk_bf16_f32 v139, v54, v55
    v_mov_b32 v135, 0
    v_mov_b32 v136, 0
    v_cvt_pk_bf16_f32 v94, v24, v25
    v_cvt_pk_bf16_f32 v95, v26, v27
    v_cvt_pk_bf16_f32 v98, v28, v29
    v_cvt_pk_bf16_f32 v99, v30, v31
    v_cvt_pk_bf16_f32 v126, v32, v33
    v_cvt_pk_bf16_f32 v129, v34, v35
    v_mov_b32 v96, 0
    v_mov_b32 v97, 0
    v_cvt_pk_bf16_f32 v108, v36, v37
    v_cvt_pk_bf16_f32 v109, v38, v39
    v_cvt_pk_bf16_f32 v114, v40, v41
    v_cvt_pk_bf16_f32 v115, v42, v43
    s_mov_b32 exec_lo, 0xffff0000
    s_mov_b32 exec_hi, 0
    ds_write2_b32 v13, v126, v129 offset0:32 offset1:33
    s_mov_b64 exec, -1
    v_permlane32_swap_b32 v126, v96
    v_permlane32_swap_b32 v129, v97
    v_cvt_pk_bf16_f32 v124, v16, v17
    v_cvt_pk_bf16_f32 v125, v18, v19
    v_cvt_pk_bf16_f32 v130, v20, v21
    v_cvt_pk_bf16_f32 v131, v22, v23
    v_mov_b32 v127, 0
    v_mov_b32 v128, 0
    v_mov_b32 v144, 0x3f803f80
    v_mov_b32 v145, 0x3f803f80
    v_mov_b32 v146, 0x3f803f80
    v_mov_b32 v147, 0x3f803f80
    v_mfma_f32_16x16x32_bf16 v[32:35], v[94:97], v[132:135], v[172:175]
    v_mfma_f32_16x16x32_bf16 v[36:39], v[100:103], v[132:135], v[168:171]
    v_mfma_f32_16x16x32_bf16 v[20:23], v[94:97], v[124:127], v[168:171]
    v_mfma_f32_16x16x32_bf16 v[40:43], v[96:99], v[136:139], v[172:175]
    v_mfma_f32_16x16x32_bf16 v[44:47], v[102:105], v[136:139], v[168:171]
    v_mfma_f32_16x16x32_bf16 v[28:31], v[96:99], v[128:131], v[168:171]
    s_waitcnt lgkmcnt(0)
    s_barrier
    ds_read_b64 v[88:89], v7 offset:0
    ds_read_b64 v[90:91], v7 offset:512
    ds_read_b64 v[92:93], v7 offset:1024
    ds_read_b64 v[106:107], v7 offset:1536
    ds_read_b64 v[112:113], v7 offset:2048
    ds_read_b64_tr_b16 v[118:119], v14 offset:128
    ds_read_b64_tr_b16 v[120:121], v14 offset:256
    ds_read_b64_tr_b16 v[122:123], v14 offset:384
    s_mov_b32 s52, 0x3eae1a93
    s_waitcnt lgkmcnt(6)
    v_mfma_f32_16x16x32_bf16 v[16:19], v[88:91], v[124:127], v[176:179]
    s_waitcnt lgkmcnt(5)
    v_mfma_f32_16x16x32_bf16 v[24:27], v[90:93], v[128:131], v[176:179]
    v_max3_f32 v48, v32, v33, v34
    v_max3_f32 v49, v40, v41, v42
    s_nop 3
    v_max3_f32 v50, v16, v17, v18
    s_nop 0
    v_max3_f32 v51, v24, v25, v26
    v_max3_f32 v48, v48, v35, v36
    v_max3_f32 v49, v49, v43, v44
    v_max3_f32 v50, v50, v19, v20
    v_max3_f32 v51, v51, v27, v28
    v_max3_f32 v48, v48, v37, v38
    v_max3_f32 v49, v49, v45, v46
    v_max3_f32 v50, v50, v21, v22
    v_max3_f32 v51, v51, v29, v30
    v_max_f32 v48, v48, v39
    v_max_f32 v49, v49, v47
    v_max_f32 v50, v50, v23
    v_max_f32 v51, v51, v31
    v_mov_b32 v52, v48
    v_mov_b32 v53, v49
    v_mov_b32 v54, v50
    v_mov_b32 v55, v51
    v_permlane16_swap_b32 v48, v52
    v_permlane16_swap_b32 v49, v53
    v_permlane16_swap_b32 v50, v54
    v_permlane16_swap_b32 v51, v55
    v_max_f32 v48, v48, v52
    v_max_f32 v49, v49, v53
    v_max_f32 v50, v50, v54
    v_max_f32 v51, v51, v55
    v_mov_b32 v52, v48
    v_mov_b32 v53, v49
    v_mov_b32 v54, v50
    v_mov_b32 v55, v51
    v_permlane32_swap_b32 v48, v52
    v_permlane32_swap_b32 v49, v53
    v_permlane32_swap_b32 v50, v54
    v_permlane32_swap_b32 v51, v55
    v_max_f32 v48, v48, v52
    v_max_f32 v49, v49, v53
    v_max_f32 v50, v50, v54
    v_max_f32 v51, v51, v55
    v_mul_f32 v48, s52, v48
    v_mul_f32 v49, s52, v49
    v_mul_f32 v50, s52, v50
    v_mul_f32 v51, s52, v51
    v_fma_f32 v32, v32, s52, -v48
    v_fma_f32 v40, v40, s52, -v49
    v_fma_f32 v16, v16, s52, -v50
    v_fma_f32 v24, v24, s52, -v51
    v_fma_f32 v33, v33, s52, -v48
    v_fma_f32 v41, v41, s52, -v49
    v_fma_f32 v17, v17, s52, -v50
    v_fma_f32 v25, v25, s52, -v51
    v_fma_f32 v34, v34, s52, -v48
    v_fma_f32 v42, v42, s52, -v49
    v_fma_f32 v18, v18, s52, -v50
    v_fma_f32 v26, v26, s52, -v51
    v_fma_f32 v35, v35, s52, -v48
    v_fma_f32 v43, v43, s52, -v49
    v_fma_f32 v19, v19, s52, -v50
    v_fma_f32 v27, v27, s52, -v51
    v_fma_f32 v36, v36, s52, -v48
    v_fma_f32 v44, v44, s52, -v49
    v_fma_f32 v20, v20, s52, -v50
    v_fma_f32 v28, v28, s52, -v51
    v_fma_f32 v37, v37, s52, -v48
    v_fma_f32 v45, v45, s52, -v49
    v_fma_f32 v21, v21, s52, -v50
    v_fma_f32 v29, v29, s52, -v51
    v_fma_f32 v38, v38, s52, -v48
    v_fma_f32 v46, v46, s52, -v49
    v_fma_f32 v22, v22, s52, -v50
    v_fma_f32 v30, v30, s52, -v51
    v_fma_f32 v39, v39, s52, -v48
    v_fma_f32 v47, v47, s52, -v49
    v_fma_f32 v23, v23, s52, -v50
    v_fma_f32 v31, v31, s52, -v51
    v_exp_f32 v32, v32
    v_exp_f32 v40, v40
    v_exp_f32 v16, v16
    v_exp_f32 v24, v24
    v_exp_f32 v33, v33
    v_exp_f32 v41, v41
    v_exp_f32 v17, v17
    v_exp_f32 v25, v25
    v_exp_f32 v34, v34
    v_exp_f32 v42, v42
    v_exp_f32 v18, v18
    v_exp_f32 v26, v26
    v_exp_f32 v35, v35
    v_exp_f32 v43, v43
    v_exp_f32 v19, v19
    v_exp_f32 v27, v27
    v_exp_f32 v36, v36
    v_exp_f32 v44, v44
    v_exp_f32 v20, v20
    v_exp_f32 v28, v28
    v_exp_f32 v37, v37
    v_exp_f32 v45, v45
    v_exp_f32 v21, v21
    v_exp_f32 v29, v29
    v_exp_f32 v38, v38
    v_exp_f32 v46, v46
    v_exp_f32 v22, v22
    v_exp_f32 v30, v30
    v_exp_f32 v39, v39
    v_exp_f32 v47, v47
    v_exp_f32 v23, v23
    v_exp_f32 v31, v31
    v_cvt_pk_bf16_f32 v56, v32, v33
    v_cvt_pk_bf16_f32 v60, v40, v41
    v_cvt_pk_bf16_f32 v64, v16, v17
    v_cvt_pk_bf16_f32 v68, v24, v25
    v_cvt_pk_bf16_f32 v57, v34, v35
    v_cvt_pk_bf16_f32 v61, v42, v43
    v_cvt_pk_bf16_f32 v65, v18, v19
    v_cvt_pk_bf16_f32 v69, v26, v27
    v_cvt_pk_bf16_f32 v58, v36, v37
    v_cvt_pk_bf16_f32 v62, v44, v45
    v_cvt_pk_bf16_f32 v66, v20, v21
    v_cvt_pk_bf16_f32 v70, v28, v29
    v_cvt_pk_bf16_f32 v59, v38, v39
    v_cvt_pk_bf16_f32 v63, v46, v47
    v_cvt_pk_bf16_f32 v67, v22, v23
    v_cvt_pk_bf16_f32 v71, v30, v31
    v_mfma_f32_16x16x32_bf16 v[188:191], v[144:147], v[56:59], 0
    v_mfma_f32_16x16x32_bf16 v[180:183], v[108:111], v[56:59], 0
    s_waitcnt lgkmcnt(0)
    v_mfma_f32_16x16x32_bf16 v[184:187], v[120:123], v[56:59], 0
    v_mfma_f32_16x16x32_bf16 v[200:203], v[144:147], v[60:63], 0
    v_mfma_f32_16x16x32_bf16 v[192:195], v[114:117], v[60:63], 0
    v_mfma_f32_16x16x32_bf16 v[196:199], v[120:123], v[60:63], 0
    v_mfma_f32_16x16x32_bf16 v[212:215], v[144:147], v[64:67], 0
    v_mfma_f32_16x16x32_bf16 v[204:207], v[106:109], v[64:67], 0
    v_mfma_f32_16x16x32_bf16 v[208:211], v[118:121], v[64:67], 0
    v_mfma_f32_16x16x32_bf16 v[224:227], v[144:147], v[68:71], 0
    v_mfma_f32_16x16x32_bf16 v[216:219], v[112:115], v[68:71], 0
    v_mfma_f32_16x16x32_bf16 v[220:223], v[118:121], v[68:71], 0
    s_lshl_b32 s53, s46, 4
    s_add_u32 s53, s53, s45
    s_lshl_b32 s54, s53, 10
    s_add_u32 s54, s54, 73662464
    s_lshl_b32 s55, s53, 7
    s_add_u32 s55, s55, 75759488
    v_lshlrev_b32 v6, 3, v1
    v_rcp_f32 v188, v188
    v_rcp_f32 v200, v200
    v_rcp_f32 v212, v212
    v_rcp_f32 v224, v224
    v_mul_f32 v180, v180, v188
    v_mul_f32 v181, v181, v188
    v_mul_f32 v182, v182, v188
    v_mul_f32 v183, v183, v188
    v_mul_f32 v184, v184, v188
    v_mul_f32 v185, v185, v188
    v_cvt_pk_bf16_f32 v76, v180, v181
    v_cvt_pk_bf16_f32 v77, v182, v183
    v_cvt_pk_bf16_f32 v82, v184, v185
    v_mul_f32 v192, v192, v200
    v_mul_f32 v193, v193, v200
    v_mul_f32 v194, v194, v200
    v_mul_f32 v195, v195, v200
    v_mul_f32 v198, v198, v200
    v_mul_f32 v199, v199, v200
    v_cvt_pk_bf16_f32 v78, v192, v193
    v_cvt_pk_bf16_f32 v79, v194, v195
    v_cvt_pk_bf16_f32 v83, v198, v199
    s_add_u32 s53, s54, 16384
    buffer_store_dwordx4 v[76:79], v2, s[4:7], s53 offen sc1
    v_mul_f32 v204, v204, v212
    v_mul_f32 v205, v205, v212
    v_mul_f32 v206, v206, v212
    v_mul_f32 v207, v207, v212
    v_mul_f32 v208, v208, v212
    v_mul_f32 v209, v209, v212
    v_cvt_pk_bf16_f32 v72, v204, v205
    v_cvt_pk_bf16_f32 v73, v206, v207
    v_cvt_pk_bf16_f32 v80, v208, v209
    v_mul_f32 v216, v216, v224
    v_mul_f32 v217, v217, v224
    v_mul_f32 v218, v218, v224
    v_mul_f32 v219, v219, v224
    v_mul_f32 v222, v222, v224
    v_mul_f32 v223, v223, v224
    v_cvt_pk_bf16_f32 v74, v216, v217
    v_cvt_pk_bf16_f32 v75, v218, v219
    v_cvt_pk_bf16_f32 v81, v222, v223
    s_add_u32 s53, s54, 0
    buffer_store_dwordx4 v[72:75], v2, s[4:7], s53 offen sc1
    s_mov_b32 exec_lo, 0xffff0000
    s_mov_b32 exec_hi, 0
    buffer_store_dwordx2 v[80:81], v6, s[4:7], s55 offen offset:0 sc1
    buffer_store_dwordx2 v[82:83], v6, s[4:7], s55 offen offset:2048 sc1
    s_mov_b64 exec, -1
    s_lshl_b32 s52, s44, 2
    s_add_u32 s52, s52, s20
    s_lshl_b32 s52, s52, 4
    s_add_u32 s52, s52, s45
    s_lshl_b32 s52, s52, 3
    s_add_u32 s52, s52, 24576
    v_mov_b32 v8, s98
    v_mov_b32 v9, s99
    s_waitcnt vmcnt(0)
    s_lshl_b32 s52, s52, 2
    s_add_u32 s52, s52, 0x8000000
    s_mov_b64 exec, 1
    buffer_store_dwordx2 v[8:9], off, s[4:7], s52 sc1
    s_mov_b64 exec, -1
    s_cmp_ge_u32 s22, 24
    s_cbranch_scc1 L_next_51
    s_mul_i32 s44, s22, 10923
    s_lshr_b32 s44, s44, 16
    s_mul_i32 s52, s44, 6
    s_sub_u32 s45, s22, s52
    s_lshl_b32 s52, s21, 2
    s_add_u32 s44, s44, s52
    s_lshl_b32 s46, s44, 2
    s_add_u32 s46, s46, s20
    s_mul_i32 s47, s45, 110592
    s_mul_i32 s48, s20, 3072
    s_add_u32 s47, s47, s48
    s_add_u32 s47, s47, 2097152
    s_lshl_b32 s49, s46, 14
    s_add_u32 s49, s49, 73662464
    s_lshl_b32 s50, s46, 11
    s_add_u32 s50, s50, 75759616
    v_and_b32 v3, 15, v1
    v_lshrrev_b32 v4, 4, v1
    v_lshlrev_b32 v5, 3, v3
    v_lshl_add_u32 v5, v4, 8, v5
    s_lshl_b32 s52, s46, 4
    v_add_u32 v6, s52, v3
    v_lshlrev_b32 v7, 3, v6
    v_mul_u32_u24 v6, 1152, v6
    v_lshl_add_u32 v6, v4, 4, v6
    s_mul_i32 s51, s45, 192
    s_add_u32 s8, s42, 28311552
    s_addc_u32 s9, s43, 0
    s_mov_b32 s10, 0x240000
    s_mov_b32 s11, 0x20000
    s_mov_b32 m0, s48
    s_nop 0
    buffer_load_dwordx4 v2, s[4:7], s47 offen offset:0 lds
    buffer_load_dwordx4 v2, s[4:7], s47 offen offset:1024 lds
    buffer_load_dwordx4 v2, s[4:7], s47 offen offset:2048 lds
    s_add_u32 s48, s48, 12288
    s_add_u32 s47, s47, 12288
    s_mov_b32 m0, s48
    s_nop 0
    buffer_load_dwordx4 v2, s[4:7], s47 offen offset:0 lds
    buffer_load_dwordx4 v2, s[4:7], s47 offen offset:1024 lds
    buffer_load_dwordx4 v2, s[4:7], s47 offen offset:2048 lds
    s_add_u32 s48, s48, 12288
    s_add_u32 s47, s47, 12288
    s_mov_b32 m0, s48
    s_nop 0
    buffer_load_dwordx4 v2, s[4:7], s47 offen offset:0 lds
    buffer_load_dwordx4 v2, s[4:7], s47 offen offset:1024 lds
    buffer_load_dwordx4 v2, s[4:7], s47 offen offset:2048 lds
    s_add_u32 s48, s48, 12288
    s_add_u32 s47, s47, 12288
    s_mov_b32 m0, s48
    s_nop 0
    buffer_load_dwordx4 v2, s[4:7], s47 offen offset:0 lds
    buffer_load_dwordx4 v2, s[4:7], s47 offen offset:1024 lds
    buffer_load_dwordx4 v2, s[4:7], s47 offen offset:2048 lds
    s_add_u32 s48, s48, 12288
    s_add_u32 s47, s47, 12288
    s_mov_b32 m0, s48
    s_nop 0
    buffer_load_dwordx4 v2, s[4:7], s47 offen offset:0 lds
    buffer_load_dwordx4 v2, s[4:7], s47 offen offset:1024 lds
    buffer_load_dwordx4 v2, s[4:7], s47 offen offset:2048 lds
    s_add_u32 s48, s48, 12288
    s_add_u32 s47, s47, 12288
    s_mov_b32 m0, s48
    s_nop 0
    buffer_load_dwordx4 v2, s[4:7], s47 offen offset:0 lds
    buffer_load_dwordx4 v2, s[4:7], s47 offen offset:1024 lds
    buffer_load_dwordx4 v2, s[4:7], s47 offen offset:2048 lds
    s_add_u32 s48, s48, 12288
    s_add_u32 s47, s47, 12288
    s_mov_b32 m0, s48
    s_nop 0
    buffer_load_dwordx4 v2, s[4:7], s47 offen offset:0 lds
    buffer_load_dwordx4 v2, s[4:7], s47 offen offset:1024 lds
    buffer_load_dwordx4 v2, s[4:7], s47 offen offset:2048 lds
    s_add_u32 s48, s48, 12288
    s_add_u32 s47, s47, 12288
    s_mov_b32 m0, s48
    s_nop 0
    buffer_load_dwordx4 v2, s[4:7], s47 offen offset:0 lds
    buffer_load_dwordx4 v2, s[4:7], s47 offen offset:1024 lds
    buffer_load_dwordx4 v2, s[4:7], s47 offen offset:2048 lds
    s_add_u32 s48, s48, 12288
    s_add_u32 s47, s47, 12288
    s_mov_b32 m0, s48
    s_nop 0
    buffer_load_dwordx4 v2, s[4:7], s47 offen offset:0 lds
    buffer_load_dwordx4 v2, s[4:7], s47 offen offset:1024 lds
    buffer_load_dwordx4 v2, s[4:7], s47 offen offset:2048 lds
    s_add_u32 s48, s48, 12288
    s_add_u32 s47, s47, 12288
    s_lshr_b32 s52, s46, 1
    s_lshl_b32 s52, s52, 7
    s_add_u32 s52, s52, 24576
    v_and_b32 v10, 15, v1
    v_lshlrev_b32 v10, 3, v10
    s_mul_i32 s53, s45, 2816
    s_min_u32 s53, s53, 13568
    s_add_u32 s53, s53, s49
    buffer_load_dwordx4 v[160:163], v6, s[8:11], s51 offen offset:0 sc1
    buffer_load_dwordx4 v[164:167], v6, s[8:11], s51 offen offset:64 sc1
    buffer_load_dwordx4 v[168:171], v6, s[8:11], s51 offen offset:128 sc1
    v_mov_b32 v8, v2
    s_waitcnt vmcnt(3)
    s_barrier
    s_lshl_b32 s52, s52, 2
    s_add_u32 s52, s52, 0x8000000
    v_lshlrev_b32 v10, 2, v10
    buffer_load_dwordx2 v[12:13], v10, s[4:7], s52 offen sc1
    ds_read_b128 a[0:3], v8 offset:0
    ds_read_b128 a[4:7], v8 offset:1024
    ds_read_b128 a[8:11], v8 offset:2048
    ds_read_b128 a[12:15], v8 offset:3072
    ds_read_b128 a[16:19], v8 offset:4096
    ds_read_b128 a[20:23], v8 offset:5120
    ds_read_b128 a[24:27], v8 offset:6144
    ds_read_b128 a[28:31], v8 offset:7168
    ds_read_b128 a[32:35], v8 offset:8192
    ds_read_b128 a[36:39], v8 offset:9216
    ds_read_b128 a[40:43], v8 offset:10240
    ds_read_b128 a[44:47], v8 offset:11264
    ds_read_b128 a[48:51], v8 offset:12288
    ds_read_b128 a[52:55], v8 offset:13312
    ds_read_b128 a[56:59], v8 offset:14336
    ds_read_b128 a[60:63], v8 offset:15360
    ds_read_b128 a[64:67], v8 offset:16384
    ds_read_b128 a[68:71], v8 offset:17408
    ds_read_b128 a[72:75], v8 offset:18432
    ds_read_b128 a[76:79], v8 offset:19456
    ds_read_b128 a[80:83], v8 offset:20480
    ds_read_b128 a[84:87], v8 offset:21504
    ds_read_b128 a[88:91], v8 offset:22528
    ds_read_b128 a[92:95], v8 offset:23552
    ds_read_b128 v[112:115], v8 offset:24576
    ds_read_b128 v[116:119], v8 offset:25600
    ds_read_b128 v[120:123], v8 offset:26624
    ds_read_b128 v[124:127], v8 offset:27648
    ds_read_b128 v[128:131], v8 offset:28672
    ds_read_b128 v[132:135], v8 offset:29696
    ds_read_b128 v[136:139], v8 offset:30720
    ds_read_b128 v[140:143], v8 offset:31744
    ds_read_b128 v[144:147], v8 offset:32768
    ds_read_b128 v[148:151], v8 offset:33792
    s_waitcnt vmcnt(0)
    v_cmp_eq_u64 vcc, s[98:99], v[12:13]
    s_nop 0
    s_cmp_eq_u64 vcc, exec
    s_cbranch_scc0 L_po_slow_102
L_po_back_103:
    buffer_load_dwordx4 v[16:19], v2, s[4:7], s49 offen offset:0 sc1
    buffer_load_dwordx4 v[20:23], v2, s[4:7], s49 offen offset:1024 sc1
    buffer_load_dwordx4 v[24:27], v2, s[4:7], s49 offen offset:2048 sc1
    buffer_load_dwordx4 v[28:31], v2, s[4:7], s49 offen offset:3072 sc1
    s_add_u32 s49, s49, 4096
    buffer_load_dwordx4 v[32:35], v2, s[4:7], s49 offen offset:0 sc1
    buffer_load_dwordx4 v[36:39], v2, s[4:7], s49 offen offset:1024 sc1
    buffer_load_dwordx4 v[40:43], v2, s[4:7], s49 offen offset:2048 sc1
    buffer_load_dwordx4 v[44:47], v2, s[4:7], s49 offen offset:3072 sc1
    s_waitcnt vmcnt(7) lgkmcnt(15)
    s_add_u32 s49, s49, 4096
    v_mfma_f32_16x16x32_bf16 v[88:91], a[0:3], v[16:19], 0
    buffer_load_dwordx4 v[48:51], v2, s[4:7], s49 offen offset:0 sc1
    s_waitcnt lgkmcnt(15)
    v_mfma_f32_16x16x32_bf16 v[92:95], a[4:7], v[16:19], 0
    s_waitcnt lgkmcnt(15)
    v_mfma_f32_16x16x32_bf16 v[96:99], a[8:11], v[16:19], 0
    s_waitcnt lgkmcnt(15)
    v_mfma_f32_16x16x32_bf16 v[100:103], a[12:15], v[16:19], 0
    buffer_load_dwordx4 v[52:55], v2, s[4:7], s49 offen offset:1024 sc1
    s_waitcnt lgkmcnt(15)
    v_mfma_f32_16x16x32_bf16 v[104:107], a[16:19], v[16:19], 0
    s_waitcnt lgkmcnt(15)
    v_mfma_f32_16x16x32_bf16 v[108:111], a[20:23], v[16:19], 0
    s_waitcnt vmcnt(8) lgkmcnt(15)
    v_mfma_f32_16x16x32_bf16 v[88:91], a[24:27], v[20:23], v[88:91]
    buffer_load_dwordx4 v[56:59], v2, s[4:7], s49 offen offset:2048 sc1
    s_waitcnt lgkmcnt(15)
    v_mfma_f32_16x16x32_bf16 v[92:95], a[28:31], v[20:23], v[92:95]
    s_waitcnt lgkmcnt(15)
    v_mfma_f32_16x16x32_bf16 v[96:99], a[32:35], v[20:23], v[96:99]
    s_waitcnt lgkmcnt(15)
    v_mfma_f32_16x16x32_bf16 v[100:103], a[36:39], v[20:23], v[100:103]
    buffer_load_dwordx4 v[60:63], v2, s[4:7], s49 offen offset:3072 sc1
    s_waitcnt lgkmcnt(15)
    v_mfma_f32_16x16x32_bf16 v[104:107], a[40:43], v[20:23], v[104:107]
    s_waitcnt lgkmcnt(15)
    s_add_u32 s49, s49, 4096
    v_mfma_f32_16x16x32_bf16 v[108:111], a[44:47], v[20:23], v[108:111]
    s_waitcnt vmcnt(9) lgkmcnt(15)
    v_mfma_f32_16x16x32_bf16 v[88:91], a[48:51], v[24:27], v[88:91]
    buffer_load_dwordx4 v[64:67], v2, s[4:7], s49 offen offset:0 sc1
    s_waitcnt lgkmcnt(15)
    v_mfma_f32_16x16x32_bf16 v[92:95], a[52:55], v[24:27], v[92:95]
    s_waitcnt lgkmcnt(15)
    v_mfma_f32_16x16x32_bf16 v[96:99], a[56:59], v[24:27], v[96:99]
    s_waitcnt lgkmcnt(15)
    v_mfma_f32_16x16x32_bf16 v[100:103], a[60:63], v[24:27], v[100:103]
    buffer_load_dwordx4 v[68:71], v2, s[4:7], s49 offen offset:1024 sc1
    s_waitcnt lgkmcnt(15)
    v_mfma_f32_16x16x32_bf16 v[104:107], a[64:67], v[24:27], v[104:107]
    s_waitcnt lgkmcnt(15)
    v_mfma_f32_16x16x32_bf16 v[108:111], a[68:71], v[24:27], v[108:111]
    s_waitcnt vmcnt(10) lgkmcnt(15)
    v_mfma_f32_16x16x32_bf16 v[88:91], a[72:75], v[28:31], v[88:91]
    buffer_load_dwordx4 v[72:75], v2, s[4:7], s49 offen offset:2048 sc1
    s_waitcnt lgkmcnt(14)
    v_mfma_f32_16x16x32_bf16 v[92:95], a[76:79], v[28:31], v[92:95]
    s_waitcnt lgkmcnt(13)
    v_mfma_f32_16x16x32_bf16 v[96:99], a[80:83], v[28:31], v[96:99]
    s_waitcnt lgkmcnt(12)
    v_mfma_f32_16x16x32_bf16 v[100:103], a[84:87], v[28:31], v[100:103]
    buffer_load_dwordx4 v[76:79], v2, s[4:7], s49 offen offset:3072 sc1
    s_waitcnt lgkmcnt(11)
    v_mfma_f32_16x16x32_bf16 v[104:107], a[88:91], v[28:31], v[104:107]
    s_waitcnt lgkmcnt(10)
    v_mfma_f32_16x16x32_bf16 v[108:111], a[92:95], v[28:31], v[108:111]
    s_waitcnt vmcnt(11) lgkmcnt(9)
    v_mfma_f32_16x16x32_bf16 v[88:91], v[112:115], v[32:35], v[88:91]
    s_waitcnt lgkmcnt(8)
    ds_read_b128 v[152:155], v8 offset:34816
    v_mfma_f32_16x16x32_bf16 v[92:95], v[116:119], v[32:35], v[92:95]
    s_waitcnt lgkmcnt(8)
    ds_read_b128 v[156:159], v8 offset:35840
    v_mfma_f32_16x16x32_bf16 v[96:99], v[120:123], v[32:35], v[96:99]
    s_waitcnt lgkmcnt(8)
    ds_read_b128 v[112:115], v8 offset:36864
    v_mfma_f32_16x16x32_bf16 v[100:103], v[124:127], v[32:35], v[100:103]
    s_waitcnt lgkmcnt(8)
    ds_read_b128 v[116:119], v8 offset:37888
    v_mfma_f32_16x16x32_bf16 v[104:107], v[128:131], v[32:35], v[104:107]
    s_waitcnt lgkmcnt(8)
    ds_read_b128 v[120:123], v8 offset:38912
    v_mfma_f32_16x16x32_bf16 v[108:111], v[132:135], v[32:35], v[108:111]
    s_waitcnt vmcnt(10) lgkmcnt(8)
    ds_read_b128 v[124:127], v8 offset:39936
    v_mfma_f32_16x16x32_bf16 v[88:91], v[136:139], v[36:39], v[88:91]
    s_waitcnt lgkmcnt(8)
    ds_read_b128 v[128:131], v8 offset:40960
    v_mfma_f32_16x16x32_bf16 v[92:95], v[140:143], v[36:39], v[92:95]
    s_waitcnt lgkmcnt(8)
    ds_read_b128 v[132:135], v8 offset:41984
    v_mfma_f32_16x16x32_bf16 v[96:99], v[144:147], v[36:39], v[96:99]
    s_waitcnt lgkmcnt(8)
    ds_read_b128 v[136:139], v8 offset:43008
    v_mfma_f32_16x16x32_bf16 v[100:103], v[148:151], v[36:39], v[100:103]
    s_waitcnt lgkmcnt(8)
    ds_read_b128 v[140:143], v8 offset:44032
    v_mfma_f32_16x16x32_bf16 v[104:107], v[152:155], v[36:39], v[104:107]
    s_waitcnt lgkmcnt(8)
    ds_read_b128 v[144:147], v8 offset:45056
    v_mfma_f32_16x16x32_bf16 v[108:111], v[156:159], v[36:39], v[108:111]
    s_waitcnt vmcnt(9) lgkmcnt(8)
    ds_read_b128 v[148:151], v8 offset:46080
    v_mfma_f32_16x16x32_bf16 v[88:91], v[112:115], v[40:43], v[88:91]
    s_waitcnt lgkmcnt(8)
    ds_read_b128 v[152:155], v8 offset:47104
    v_mfma_f32_16x16x32_bf16 v[92:95], v[116:119], v[40:43], v[92:95]
    s_waitcnt lgkmcnt(8)
    ds_read_b128 v[156:159], v8 offset:48128
    v_mfma_f32_16x16x32_bf16 v[96:99], v[120:123], v[40:43], v[96:99]
    s_waitcnt lgkmcnt(8)
    ds_read_b128 v[112:115], v8 offset:49152
    v_mfma_f32_16x16x32_bf16 v[100:103], v[124:127], v[40:43], v[100:103]
    s_waitcnt lgkmcnt(8)
    ds_read_b128 v[116:119], v8 offset:50176
    v_mfma_f32_16x16x32_bf16 v[104:107], v[128:131], v[40:43], v[104:107]
    s_waitcnt lgkmcnt(8)
    ds_read_b128 v[120:123], v8 offset:51200
    v_mfma_f32_16x16x32_bf16 v[108:111], v[132:135], v[40:43], v[108:111]
    s_waitcnt vmcnt(8) lgkmcnt(8)
    ds_read_b128 v[124:127], v8 offset:52224
    v_mfma_f32_16x16x32_bf16 v[88:91], v[136:139], v[44:47], v[88:91]
    s_waitcnt lgkmcnt(8)
    ds_read_b128 v[128:131], v8 offset:53248
    v_mfma_f32_16x16x32_bf16 v[92:95], v[140:143], v[44:47], v[92:95]
    s_waitcnt lgkmcnt(8)
    ds_read_b128 v[132:135], v8 offset:54272
    v_mfma_f32_16x16x32_bf16 v[96:99], v[144:147], v[44:47], v[96:99]
    s_waitcnt lgkmcnt(8)
    ds_read_b128 v[136:139], v8 offset:55296
    v_mfma_f32_16x16x32_bf16 v[100:103], v[148:151], v[44:47], v[100:103]
    s_waitcnt lgkmcnt(8)
    ds_read_b128 v[140:143], v8 offset:56320
    v_mfma_f32_16x16x32_bf16 v[104:107], v[152:155], v[44:47], v[104:107]
    s_waitcnt lgkmcnt(8)
    ds_read_b128 v[144:147], v8 offset:57344
    v_mfma_f32_16x16x32_bf16 v[108:111], v[156:159], v[44:47], v[108:111]
    s_waitcnt vmcnt(7) lgkmcnt(8)
    ds_read_b128 v[148:151], v8 offset:58368
    v_mfma_f32_16x16x32_bf16 v[88:91], v[112:115], v[48:51], v[88:91]
    s_waitcnt lgkmcnt(8)
    ds_read_b128 v[152:155], v8 offset:59392
    v_mfma_f32_16x16x32_bf16 v[92:95], v[116:119], v[48:51], v[92:95]
    s_waitcnt lgkmcnt(8)
    ds_read_b128 v[156:159], v8 offset:60416
    v_mfma_f32_16x16x32_bf16 v[96:99], v[120:123], v[48:51], v[96:99]
    s_waitcnt lgkmcnt(8)
    v_add_u32 v8, 61440, v8
    ds_read_b128 v[112:115], v8 offset:0
    v_mfma_f32_16x16x32_bf16 v[100:103], v[124:127], v[48:51], v[100:103]
    s_waitcnt lgkmcnt(8)
    ds_read_b128 v[116:119], v8 offset:1024
    v_mfma_f32_16x16x32_bf16 v[104:107], v[128:131], v[48:51], v[104:107]
    s_waitcnt lgkmcnt(8)
    ds_read_b128 v[120:123], v8 offset:2048
    v_mfma_f32_16x16x32_bf16 v[108:111], v[132:135], v[48:51], v[108:111]
    s_waitcnt vmcnt(6) lgkmcnt(8)
    ds_read_b128 v[124:127], v8 offset:3072
    v_mfma_f32_16x16x32_bf16 v[88:91], v[136:139], v[52:55], v[88:91]
    s_waitcnt lgkmcnt(8)
    ds_read_b128 v[128:131], v8 offset:4096
    v_mfma_f32_16x16x32_bf16 v[92:95], v[140:143], v[52:55], v[92:95]
    s_waitcnt lgkmcnt(8)
    ds_read_b128 v[132:135], v8 offset:5120
    v_mfma_f32_16x16x32_bf16 v[96:99], v[144:147], v[52:55], v[96:99]
    s_waitcnt lgkmcnt(8)
    ds_read_b128 v[136:139], v8 offset:6144
    v_mfma_f32_16x16x32_bf16 v[100:103], v[148:151], v[52:55], v[100:103]
    s_waitcnt lgkmcnt(8)
    ds_read_b128 v[140:143], v8 offset:7168
    v_mfma_f32_16x16x32_bf16 v[104:107], v[152:155], v[52:55], v[104:107]
    s_waitcnt lgkmcnt(8)
    ds_read_b128 v[144:147], v8 offset:8192
    v_mfma_f32_16x16x32_bf16 v[108:111], v[156:159], v[52:55], v[108:111]
    s_waitcnt vmcnt(5) lgkmcnt(8)
    ds_read_b128 v[148:151], v8 offset:9216
    v_mfma_f32_16x16x32_bf16 v[88:91], v[112:115], v[56:59], v[88:91]
    s_waitcnt lgkmcnt(8)
    ds_read_b128 v[152:155], v8 offset:10240
    v_mfma_f32_16x16x32_bf16 v[92:95], v[116:119], v[56:59], v[92:95]
    s_waitcnt lgkmcnt(8)
    ds_read_b128 v[156:159], v8 offset:11264
    v_mfma_f32_16x16x32_bf16 v[96:99], v[120:123], v[56:59], v[96:99]
    s_waitcnt lgkmcnt(8)
    ds_read_b128 v[112:115], v8 offset:12288
    v_mfma_f32_16x16x32_bf16 v[100:103], v[124:127], v[56:59], v[100:103]
    s_waitcnt lgkmcnt(8)
    ds_read_b128 v[116:119], v8 offset:13312
    v_mfma_f32_16x16x32_bf16 v[104:107], v[128:131], v[56:59], v[104:107]
    s_waitcnt lgkmcnt(8)
    ds_read_b128 v[120:123], v8 offset:14336
    v_mfma_f32_16x16x32_bf16 v[108:111], v[132:135], v[56:59], v[108:111]
    ds_read_b128 v[124:127], v8 offset:15360
    buffer_load_dwordx2 v[80:81], v5, s[4:7], s50 offen offset:0 sc1
    buffer_load_dwordx2 v[82:83], v5, s[4:7], s50 offen offset:128 sc1
    s_waitcnt vmcnt(6) lgkmcnt(9)
    v_mfma_f32_16x16x32_bf16 v[88:91], v[136:139], v[60:63], v[88:91]
    s_waitcnt lgkmcnt(8)
    ds_read_b128 v[128:131], v8 offset:16384
    v_mfma_f32_16x16x32_bf16 v[92:95], v[140:143], v[60:63], v[92:95]
    s_waitcnt lgkmcnt(8)
    ds_read_b128 v[132:135], v8 offset:17408
    v_mfma_f32_16x16x32_bf16 v[96:99], v[144:147], v[60:63], v[96:99]
    s_waitcnt lgkmcnt(8)
    ds_read_b128 v[136:139], v8 offset:18432
    v_mfma_f32_16x16x32_bf16 v[100:103], v[148:151], v[60:63], v[100:103]
    s_waitcnt lgkmcnt(8)
    ds_read_b128 v[140:143], v8 offset:19456
    v_mfma_f32_16x16x32_bf16 v[104:107], v[152:155], v[60:63], v[104:107]
    s_waitcnt lgkmcnt(8)
    ds_read_b128 v[144:147], v8 offset:20480
    v_mfma_f32_16x16x32_bf16 v[108:111], v[156:159], v[60:63], v[108:111]
    ds_read_b128 v[148:151], v8 offset:21504
    buffer_load_dwordx2 v[84:85], v5, s[4:7], s50 offen offset:1024 sc1
    buffer_load_dwordx2 v[86:87], v5, s[4:7], s50 offen offset:1152 sc1
    s_waitcnt vmcnt(7) lgkmcnt(9)
    v_mfma_f32_16x16x32_bf16 v[88:91], v[112:115], v[64:67], v[88:91]
    s_waitcnt lgkmcnt(8)
    ds_read_b128 v[152:155], v8 offset:22528
    v_mfma_f32_16x16x32_bf16 v[92:95], v[116:119], v[64:67], v[92:95]
    s_waitcnt lgkmcnt(8)
    ds_read_b128 v[156:159], v8 offset:23552
    v_mfma_f32_16x16x32_bf16 v[96:99], v[120:123], v[64:67], v[96:99]
    s_waitcnt lgkmcnt(8)
    ds_read_b128 v[112:115], v8 offset:24576
    v_mfma_f32_16x16x32_bf16 v[100:103], v[124:127], v[64:67], v[100:103]
    s_waitcnt lgkmcnt(8)
    ds_read_b128 v[116:119], v8 offset:25600
    v_mfma_f32_16x16x32_bf16 v[104:107], v[128:131], v[64:67], v[104:107]
    s_waitcnt lgkmcnt(8)
    ds_read_b128 v[120:123], v8 offset:26624
    v_mfma_f32_16x16x32_bf16 v[108:111], v[132:135], v[64:67], v[108:111]
    s_waitcnt vmcnt(6) lgkmcnt(8)
    ds_read_b128 v[124:127], v8 offset:27648
    v_mfma_f32_16x16x32_bf16 v[88:91], v[136:139], v[68:71], v[88:91]
    s_waitcnt lgkmcnt(8)
    ds_read_b128 v[128:131], v8 offset:28672
    v_mfma_f32_16x16x32_bf16 v[92:95], v[140:143], v[68:71], v[92:95]
    s_waitcnt lgkmcnt(8)
    ds_read_b128 v[132:135], v8 offset:29696
    v_mfma_f32_16x16x32_bf16 v[96:99], v[144:147], v[68:71], v[96:99]
    s_waitcnt lgkmcnt(8)
    ds_read_b128 v[136:139], v8 offset:30720
    v_mfma_f32_16x16x32_bf16 v[100:103], v[148:151], v[68:71], v[100:103]
    s_waitcnt lgkmcnt(8)
    ds_read_b128 v[140:143], v8 offset:31744
    v_mfma_f32_16x16x32_bf16 v[104:107], v[152:155], v[68:71], v[104:107]
    s_waitcnt lgkmcnt(8)
    ds_read_b128 v[144:147], v8 offset:32768
    v_mfma_f32_16x16x32_bf16 v[108:111], v[156:159], v[68:71], v[108:111]
    s_waitcnt vmcnt(5) lgkmcnt(8)
    ds_read_b128 v[148:151], v8 offset:33792
    v_mfma_f32_16x16x32_bf16 v[88:91], v[112:115], v[72:75], v[88:91]
    s_waitcnt lgkmcnt(8)
    ds_read_b128 v[152:155], v8 offset:34816
    v_mfma_f32_16x16x32_bf16 v[92:95], v[116:119], v[72:75], v[92:95]
    s_waitcnt lgkmcnt(8)
    ds_read_b128 v[156:159], v8 offset:35840
    v_mfma_f32_16x16x32_bf16 v[96:99], v[120:123], v[72:75], v[96:99]
    s_waitcnt lgkmcnt(8)
    ds_read_b128 v[112:115], v8 offset:36864
    v_mfma_f32_16x16x32_bf16 v[100:103], v[124:127], v[72:75], v[100:103]
    s_waitcnt lgkmcnt(8)
    ds_read_b128 v[116:119], v8 offset:37888
    v_mfma_f32_16x16x32_bf16 v[104:107], v[128:131], v[72:75], v[104:107]
    s_waitcnt lgkmcnt(8)
    ds_read_b128 v[120:123], v8 offset:38912
    v_mfma_f32_16x16x32_bf16 v[108:111], v[132:135], v[72:75], v[108:111]
    s_waitcnt vmcnt(4) lgkmcnt(8)
    ds_read_b128 v[124:127], v8 offset:39936
    v_mfma_f32_16x16x32_bf16 v[88:91], v[136:139], v[76:79], v[88:91]
    s_waitcnt lgkmcnt(8)
    ds_read_b128 v[128:131], v8 offset:40960
    v_mfma_f32_16x16x32_bf16 v[92:95], v[140:143], v[76:79], v[92:95]
    s_waitcnt lgkmcnt(8)
    ds_read_b128 v[132:135], v8 offset:41984
    v_mfma_f32_16x16x32_bf16 v[96:99], v[144:147], v[76:79], v[96:99]
    s_waitcnt lgkmcnt(8)
    ds_read_b128 v[136:139], v8 offset:43008
    v_mfma_f32_16x16x32_bf16 v[100:103], v[148:151], v[76:79], v[100:103]
    s_waitcnt lgkmcnt(8)
    ds_read_b128 v[140:143], v8 offset:44032
    v_mfma_f32_16x16x32_bf16 v[104:107], v[152:155], v[76:79], v[104:107]
    s_waitcnt lgkmcnt(8)
    ds_read_b128 v[144:147], v8 offset:45056
    v_mfma_f32_16x16x32_bf16 v[108:111], v[156:159], v[76:79], v[108:111]
    s_waitcnt vmcnt(2) lgkmcnt(8)
    ds_read_b128 v[148:151], v8 offset:46080
    v_mfma_f32_16x16x32_bf16 v[88:91], v[112:115], v[80:83], v[88:91]
    s_waitcnt lgkmcnt(8)
    ds_read_b128 v[152:155], v8 offset:47104
    v_mfma_f32_16x16x32_bf16 v[92:95], v[116:119], v[80:83], v[92:95]
    s_waitcnt lgkmcnt(8)
    ds_read_b128 v[156:159], v8 offset:48128
    v_mfma_f32_16x16x32_bf16 v[96:99], v[120:123], v[80:83], v[96:99]
    s_waitcnt lgkmcnt(8)
    v_mfma_f32_16x16x32_bf16 v[100:103], v[124:127], v[80:83], v[100:103]
    s_waitcnt lgkmcnt(7)
    v_mfma_f32_16x16x32_bf16 v[104:107], v[128:131], v[80:83], v[104:107]
    s_waitcnt lgkmcnt(6)
    v_mfma_f32_16x16x32_bf16 v[108:111], v[132:135], v[80:83], v[108:111]
    s_waitcnt vmcnt(0) lgkmcnt(5)
    v_mfma_f32_16x16x32_bf16 v[88:91], v[136:139], v[84:87], v[88:91]
    s_waitcnt lgkmcnt(4)
    v_mfma_f32_16x16x32_bf16 v[92:95], v[140:143], v[84:87], v[92:95]
    s_waitcnt lgkmcnt(3)
    v_mfma_f32_16x16x32_bf16 v[96:99], v[144:147], v[84:87], v[96:99]
    s_waitcnt lgkmcnt(2)
    v_mfma_f32_16x16x32_bf16 v[100:103], v[148:151], v[84:87], v[100:103]
    s_waitcnt lgkmcnt(1)
    v_mfma_f32_16x16x32_bf16 v[104:107], v[152:155], v[84:87], v[104:107]
    s_waitcnt lgkmcnt(0)
    v_mfma_f32_16x16x32_bf16 v[108:111], v[156:159], v[84:87], v[108:111]
    v_lshlrev_b32 v16, 16, v160
    v_and_b32 v17, 0xffff0000, v160
    v_lshlrev_b32 v18, 16, v161
    v_and_b32 v19, 0xffff0000, v161
    v_lshlrev_b32 v20, 16, v162
    v_and_b32 v21, 0xffff0000, v162
    v_lshlrev_b32 v22, 16, v163
    v_and_b32 v23, 0xffff0000, v163
    v_lshlrev_b32 v24, 16, v164
    v_and_b32 v25, 0xffff0000, v164
    v_lshlrev_b32 v26, 16, v165
    v_and_b32 v27, 0xffff0000, v165
    v_lshlrev_b32 v28, 16, v166
    v_and_b32 v29, 0xffff0000, v166
    v_lshlrev_b32 v30, 16, v167
    v_and_b32 v31, 0xffff0000, v167
    v_lshlrev_b32 v32, 16, v168
    v_and_b32 v33, 0xffff0000, v168
    v_lshlrev_b32 v34, 16, v169
    v_and_b32 v35, 0xffff0000, v169
    v_lshlrev_b32 v36, 16, v170
    v_and_b32 v37, 0xffff0000, v170
    v_lshlrev_b32 v38, 16, v171
    v_and_b32 v39, 0xffff0000, v171
    v_add_f32 v16, v16, v88
    v_add_f32 v17, v17, v89
    v_add_f32 v18, v18, v90
    v_add_f32 v19, v19, v91
    v_add_f32 v20, v20, v92
    v_add_f32 v21, v21, v93
    v_add_f32 v22, v22, v94
    v_add_f32 v23, v23, v95
    v_add_f32 v24, v24, v96
    v_add_f32 v25, v25, v97
    v_add_f32 v26, v26, v98
    v_add_f32 v27, v27, v99
    v_add_f32 v28, v28, v100
    v_add_f32 v29, v29, v101
    v_add_f32 v30, v30, v102
    v_add_f32 v31, v31, v103
    v_add_f32 v32, v32, v104
    v_add_f32 v33, v33, v105
    v_add_f32 v34, v34, v106
    v_add_f32 v35, v35, v107
    v_add_f32 v36, v36, v108
    v_add_f32 v37, v37, v109
    v_add_f32 v38, v38, v110
    v_add_f32 v39, v39, v111
    s_mul_i32 s52, s46, 18
    s_mul_i32 s53, s45, 3
    s_add_u32 s52, s52, s53
    s_lshl_b32 s52, s52, 10
    s_add_u32 s52, s52, 76021760
    v_cvt_pk_bf16_f32 v40, v16, v17
    v_cvt_pk_bf16_f32 v41, v18, v19
    v_cvt_pk_bf16_f32 v42, v20, v21
    v_cvt_pk_bf16_f32 v43, v22, v23
    buffer_store_dwordx4 v[40:43], v2, s[4:7], s52 offen offset:0 sc1
    v_cvt_pk_bf16_f32 v44, v24, v25
    v_cvt_pk_bf16_f32 v45, v26, v27
    v_cvt_pk_bf16_f32 v46, v28, v29
    v_cvt_pk_bf16_f32 v47, v30, v31
    buffer_store_dwordx4 v[44:47], v2, s[4:7], s52 offen offset:1024 sc1
    v_cvt_pk_bf16_f32 v48, v32, v33
    v_cvt_pk_bf16_f32 v49, v34, v35
    v_cvt_pk_bf16_f32 v50, v36, v37
    v_cvt_pk_bf16_f32 v51, v38, v39
    buffer_store_dwordx4 v[48:51], v2, s[4:7], s52 offen offset:2048 sc1
    v_lshlrev_b32 v16, 16, v40
    v_and_b32 v17, 0xffff0000, v40
    v_lshlrev_b32 v18, 16, v41
    v_and_b32 v19, 0xffff0000, v41
    v_lshlrev_b32 v20, 16, v42
    v_and_b32 v21, 0xffff0000, v42
    v_lshlrev_b32 v22, 16, v43
    v_and_b32 v23, 0xffff0000, v43
    v_lshlrev_b32 v24, 16, v44
    v_and_b32 v25, 0xffff0000, v44
    v_lshlrev_b32 v26, 16, v45
    v_and_b32 v27, 0xffff0000, v45
    v_lshlrev_b32 v28, 16, v46
    v_and_b32 v29, 0xffff0000, v46
    v_lshlrev_b32 v30, 16, v47
    v_and_b32 v31, 0xffff0000, v47
    v_lshlrev_b32 v32, 16, v48
    v_and_b32 v33, 0xffff0000, v48
    v_lshlrev_b32 v34, 16, v49
    v_and_b32 v35, 0xffff0000, v49
    v_lshlrev_b32 v36, 16, v50
    v_and_b32 v37, 0xffff0000, v50
    v_lshlrev_b32 v38, 16, v51
    v_and_b32 v39, 0xffff0000, v51
    v_add_f32 v56, v16, v17
    v_add_f32 v58, v18, v19
    v_add_f32 v56, v56, v20
    v_add_f32 v58, v58, v21
    v_add_f32 v56, v56, v22
    v_add_f32 v58, v58, v23
    v_add_f32 v56, v56, v24
    v_add_f32 v58, v58, v25
    v_add_f32 v56, v56, v26
    v_add_f32 v58, v58, v27
    v_add_f32 v56, v56, v28
    v_add_f32 v58, v58, v29
    v_add_f32 v56, v56, v30
    v_add_f32 v58, v58, v31
    v_add_f32 v56, v56, v32
    v_add_f32 v58, v58, v33
    v_add_f32 v56, v56, v34
    v_add_f32 v58, v58, v35
    v_add_f32 v56, v56, v36
    v_add_f32 v58, v58, v37
    v_add_f32 v56, v56, v38
    v_add_f32 v58, v58, v39
    v_add_f32 v56, v56, v58
    v_mov_b32 v58, v56
    s_nop 1
    v_permlane16_swap_b32 v56, v58
    v_add_f32 v56, v56, v58
    v_mov_b32 v58, v56
    s_nop 1
    v_permlane32_swap_b32 v56, v58
    v_add_f32 v56, v56, v58
    v_mul_f32 v59, 0x3c2aaaab, v56
    v_sub_f32 v58, v16, v59
    v_mul_f32 v57, v58, v58
    v_sub_f32 v61, v17, v59
    v_fmac_f32 v57, v61, v61
    v_sub_f32 v60, v18, v59
    v_fmac_f32 v57, v60, v60
    v_sub_f32 v61, v19, v59
    v_fmac_f32 v57, v61, v61
    v_sub_f32 v60, v20, v59
    v_fmac_f32 v57, v60, v60
    v_sub_f32 v61, v21, v59
    v_fmac_f32 v57, v61, v61
    v_sub_f32 v60, v22, v59
    v_fmac_f32 v57, v60, v60
    v_sub_f32 v61, v23, v59
    v_fmac_f32 v57, v61, v61
    v_sub_f32 v60, v24, v59
    v_fmac_f32 v57, v60, v60
    v_sub_f32 v61, v25, v59
    v_fmac_f32 v57, v61, v61
    v_sub_f32 v60, v26, v59
    v_fmac_f32 v57, v60, v60
    v_sub_f32 v61, v27, v59
    v_fmac_f32 v57, v61, v61
    v_sub_f32 v60, v28, v59
    v_fmac_f32 v57, v60, v60
    v_sub_f32 v61, v29, v59
    v_fmac_f32 v57, v61, v61
    v_sub_f32 v60, v30, v59
    v_fmac_f32 v57, v60, v60
    v_sub_f32 v61, v31, v59
    v_fmac_f32 v57, v61, v61
    v_sub_f32 v60, v32, v59
    v_fmac_f32 v57, v60, v60
    v_sub_f32 v61, v33, v59
    v_fmac_f32 v57, v61, v61
    v_sub_f32 v60, v34, v59
    v_fmac_f32 v57, v60, v60
    v_sub_f32 v61, v35, v59
    v_fmac_f32 v57, v61, v61
    v_sub_f32 v60, v36, v59
    v_fmac_f32 v57, v60, v60
    v_sub_f32 v61, v37, v59
    v_fmac_f32 v57, v61, v61
    v_sub_f32 v60, v38, v59
    v_fmac_f32 v57, v60, v60
    v_sub_f32 v61, v39, v59
    v_fmac_f32 v57, v61, v61
    v_mov_b32 v58, v57
    s_nop 1
    v_permlane16_swap_b32 v57, v58
    v_add_f32 v57, v57, v58
    v_mov_b32 v58, v57
    s_nop 1
    v_permlane32_swap_b32 v57, v58
    v_add_f32 v57, v57, v58
    s_lshl_b32 s52, s45, 14
    s_add_u32 s52, s52, 78381056
    s_mov_b32 exec_lo, 0xffff
    s_mov_b32 exec_hi, 0
    buffer_store_dwordx2 v[56:57], v7, s[4:7], s52 offen sc1
    s_mov_b64 exec, -1
    s_lshl_b32 s52, s46, 3
    s_add_u32 s52, s52, s45
    s_lshl_b32 s52, s52, 3
    s_add_u32 s52, s52, 40960
    v_mov_b32 v8, s98
    v_mov_b32 v9, s99
    s_waitcnt vmcnt(0)
    s_lshl_b32 s52, s52, 2
    s_add_u32 s52, s52, 0x8000000
    s_mov_b64 exec, 1
    buffer_store_dwordx2 v[8:9], off, s[4:7], s52 sc1
    s_mov_b64 exec, -1
L_next_51:
    s_mov_b32 s100, 71303168
    s_mov_b32 s101, 0x2000
    s_branch L_ffn_49
L_red1_50:
    s_lshl_b32 s47, s21, 5
    s_add_u32 s47, s47, s22
    v_and_b32 v8, 7, v1
    v_lshrrev_b32 v9, 3, v1
    s_lshl_b32 s48, s47, 3
    v_add_u32 v3, s48, v8
    v_mul_u32_u24 v3, 1152, v3
    s_mul_i32 s48, s20, 384
    v_lshl_add_u32 v3, v9, 4, v3
    v_add_u32 v3, s48, v3
    s_lshr_b32 s48, s47, 1
    s_mul_i32 s48, s48, 18432
    s_and_b32 s49, s47, 1
    s_lshl_b32 s49, s49, 7
    s_add_u32 s48, s48, s49
    s_mul_i32 s49, s20, 6144
    s_add_u32 s48, s48, s49
    v_lshlrev_b32 v8, 4, v8
    v_lshl_add_u32 v8, v9, 8, v8
    v_add_u32 v4, s48, v8
    v_lshrrev_b32 v8, 3, v1
    v_and_b32 v9, 7, v1
    s_and_b32 s48, s47, 1
    s_lshl_b32 s48, s48, 3
    v_add_u32 v9, s48, v9
    v_lshlrev_b32 v9, 4, v9
    v_bfe_u32 v10, v8, 1, 1
    v_and_b32 v11, 1, v8
    v_lshl_add_u32 v9, v11, 4, v9
    v_lshl_add_u32 v9, v10, 9, v9
    v_and_b32 v10, 3, v8
    v_lshlrev_b32 v10, 8, v10
    v_sub_u32 v9, v9, v10
    s_mul_i32 s48, s20, 6
    v_lshrrev_b32 v8, 2, v8
    v_add_u32 v8, s48, v8
    v_add_u32 v10, 0, v8
    v_cmp_eq_u32 vcc, 4, v10
    v_cmp_eq_u32 s[56:57], 13, v10
    s_nop 0
    s_or_b64 vcc, vcc, s[56:57]
    v_cndmask_b32 v10, 0, v9, vcc
    v_add3_u32 v5, v4, v10, 0
    v_add_u32 v5, 0, v5
    v_add_u32 v10, 2, v8
    v_cmp_eq_u32 vcc, 4, v10
    v_cmp_eq_u32 s[56:57], 13, v10
    s_nop 0
    s_or_b64 vcc, vcc, s[56:57]
    v_cndmask_b32 v10, 0, v9, vcc
    v_add3_u32 v6, v4, v10, 0
    v_add_u32 v6, 2048, v6
    v_add_u32 v10, 4, v8
    v_cmp_eq_u32 vcc, 4, v10
    v_cmp_eq_u32 s[56:57], 13, v10
    s_nop 0
    s_or_b64 vcc, vcc, s[56:57]
    v_cndmask_b32 v10, 0, v9, vcc
    v_add3_u32 v7, v4, v10, 0
    v_add_u32 v7, 4096, v7
    s_cmp_eq_u32 s20, 3
    s_cbranch_scc1 L_w3a_105
    s_mov_b32 s48, 76021760
    buffer_load_dwordx4 v[16:19], v4, s[4:7], s48 offen offset:0 sc1
    buffer_load_dwordx4 v[52:55], v4, s[4:7], s48 offen offset:2048 sc1
    s_add_u32 s48, s48, 4096
    buffer_load_dwordx4 v[88:91], v4, s[4:7], s48 offen offset:0 sc1
    s_lshr_b32 s49, s47, 3
    s_lshl_b32 s49, s49, 8
    s_add_u32 s49, s49, 122880
    v_and_b32 v10, 31, v1
    v_lshlrev_b32 v10, 3, v10
    s_lshl_b32 s49, s49, 2
    s_add_u32 s49, s49, 0x8000000
    v_lshlrev_b32 v10, 2, v10
    buffer_load_dwordx2 v[176:177], v10, s[4:7], s49 offen sc1
    s_waitcnt vmcnt(0)
    v_cmp_eq_u64 vcc, s[98:99], v[176:177]
    s_nop 0
    s_cmp_eq_u64 vcc, exec
    s_cbranch_scc0 L_pp_slow_106
L_pp_back_107:
    s_mov_b32 s48, 100663296
    buffer_load_dwordx4 v[20:23], v5, s[4:7], s48 offen sc1
    buffer_load_dwordx4 v[56:59], v6, s[4:7], s48 offen sc1
    buffer_load_dwordx4 v[92:95], v7, s[4:7], s48 offen sc1
    s_mov_b32 s48, 103022592
    buffer_load_dwordx4 v[24:27], v5, s[4:7], s48 offen sc1
    buffer_load_dwordx4 v[60:63], v6, s[4:7], s48 offen sc1
    buffer_load_dwordx4 v[96:99], v7, s[4:7], s48 offen sc1
    s_mov_b32 s48, 105381888
    buffer_load_dwordx4 v[28:31], v5, s[4:7], s48 offen sc1
    buffer_load_dwordx4 v[64:67], v6, s[4:7], s48 offen sc1
    buffer_load_dwordx4 v[100:103], v7, s[4:7], s48 offen sc1
    s_mov_b32 s48, 107741184
    buffer_load_dwordx4 v[32:35], v5, s[4:7], s48 offen sc1
    buffer_load_dwordx4 v[68:71], v6, s[4:7], s48 offen sc1
    buffer_load_dwordx4 v[104:107], v7, s[4:7], s48 offen sc1
    s_mov_b32 s48, 110100480
    buffer_load_dwordx4 v[36:39], v5, s[4:7], s48 offen sc1
    buffer_load_dwordx4 v[72:75], v6, s[4:7], s48 offen sc1
    buffer_load_dwordx4 v[108:111], v7, s[4:7], s48 offen sc1
    s_mov_b32 s48, 112459776
    buffer_load_dwordx4 v[40:43], v5, s[4:7], s48 offen sc1
    buffer_load_dwordx4 v[76:79], v6, s[4:7], s48 offen sc1
    buffer_load_dwordx4 v[112:115], v7, s[4:7], s48 offen sc1
    s_mov_b32 s48, 114819072
    buffer_load_dwordx4 v[44:47], v5, s[4:7], s48 offen sc1
    buffer_load_dwordx4 v[80:83], v6, s[4:7], s48 offen sc1
    buffer_load_dwordx4 v[116:119], v7, s[4:7], s48 offen sc1
    s_mov_b32 s48, 117178368
    buffer_load_dwordx4 v[48:51], v5, s[4:7], s48 offen sc1
    buffer_load_dwordx4 v[84:87], v6, s[4:7], s48 offen sc1
    buffer_load_dwordx4 v[120:123], v7, s[4:7], s48 offen sc1
    v_lshlrev_b32 v128, 16, v16
    v_and_b32 v129, 0xffff0000, v16
    v_lshlrev_b32 v130, 16, v17
    v_and_b32 v131, 0xffff0000, v17
    v_lshlrev_b32 v132, 16, v18
    v_and_b32 v133, 0xffff0000, v18
    v_lshlrev_b32 v134, 16, v19
    v_and_b32 v135, 0xffff0000, v19
    v_lshlrev_b32 v136, 16, v52
    v_and_b32 v137, 0xffff0000, v52
    v_lshlrev_b32 v138, 16, v53
    v_and_b32 v139, 0xffff0000, v53
    v_lshlrev_b32 v140, 16, v54
    v_and_b32 v141, 0xffff0000, v54
    v_lshlrev_b32 v142, 16, v55
    v_and_b32 v143, 0xffff0000, v55
    v_lshlrev_b32 v144, 16, v88
    v_and_b32 v145, 0xffff0000, v88
    v_lshlrev_b32 v146, 16, v89
    v_and_b32 v147, 0xffff0000, v89
    v_lshlrev_b32 v148, 16, v90
    v_and_b32 v149, 0xffff0000, v90
    v_lshlrev_b32 v150, 16, v91
    v_and_b32 v151, 0xffff0000, v91
    v_mov_b32 v12, 0x3f80
    v_mov_b32 v13, 0x3f800000
    s_waitcnt vmcnt(23)
    v_dot2c_f32_bf16 v128, v20, v12
    v_dot2c_f32_bf16 v129, v20, v13
    v_dot2c_f32_bf16 v130, v21, v12
    v_dot2c_f32_bf16 v131, v21, v13
    v_dot2c_f32_bf16 v132, v22, v12
    v_dot2c_f32_bf16 v133, v22, v13
    v_dot2c_f32_bf16 v134, v23, v12
    v_dot2c_f32_bf16 v135, v23, v13
    s_waitcnt vmcnt(22)
    v_dot2c_f32_bf16 v136, v56, v12
    v_dot2c_f32_bf16 v137, v56, v13
    v_dot2c_f32_bf16 v138, v57, v12
    v_dot2c_f32_bf16 v139, v57, v13
    v_dot2c_f32_bf16 v140, v58, v12
    v_dot2c_f32_bf16 v141, v58, v13
    v_dot2c_f32_bf16 v142, v59, v12
    v_dot2c_f32_bf16 v143, v59, v13
    s_waitcnt vmcnt(21)
    v_dot2c_f32_bf16 v144, v92, v12
    v_dot2c_f32_bf16 v145, v92, v13
    v_dot2c_f32_bf16 v146, v93, v12
    v_dot2c_f32_bf16 v147, v93, v13
    v_dot2c_f32_bf16 v148, v94, v12
    v_dot2c_f32_bf16 v149, v94, v13
    v_dot2c_f32_bf16 v150, v95, v12
    v_dot2c_f32_bf16 v151, v95, v13
    s_waitcnt vmcnt(20)
    v_dot2c_f32_bf16 v128, v24, v12
    v_dot2c_f32_bf16 v129, v24, v13
    v_dot2c_f32_bf16 v130, v25, v12
    v_dot2c_f32_bf16 v131, v25, v13
    v_dot2c_f32_bf16 v132, v26, v12
    v_dot2c_f32_bf16 v133, v26, v13
    v_dot2c_f32_bf16 v134, v27, v12
    v_dot2c_f32_bf16 v135, v27, v13
    s_waitcnt vmcnt(19)
    v_dot2c_f32_bf16 v136, v60, v12
    v_dot2c_f32_bf16 v137, v60, v13
    v_dot2c_f32_bf16 v138, v61, v12
    v_dot2c_f32_bf16 v139, v61, v13
    v_dot2c_f32_bf16 v140, v62, v12
    v_dot2c_f32_bf16 v141, v62, v13
    v_dot2c_f32_bf16 v142, v63, v12
    v_dot2c_f32_bf16 v143, v63, v13
    s_waitcnt vmcnt(18)
    v_dot2c_f32_bf16 v144, v96, v12
    v_dot2c_f32_bf16 v145, v96, v13
    v_dot2c_f32_bf16 v146, v97, v12
    v_dot2c_f32_bf16 v147, v97, v13
    v_dot2c_f32_bf16 v148, v98, v12
    v_dot2c_f32_bf16 v149, v98, v13
    v_dot2c_f32_bf16 v150, v99, v12
    v_dot2c_f32_bf16 v151, v99, v13
    s_waitcnt vmcnt(17)
    v_dot2c_f32_bf16 v128, v28, v12
    v_dot2c_f32_bf16 v129, v28, v13
    v_dot2c_f32_bf16 v130, v29, v12
    v_dot2c_f32_bf16 v131, v29, v13
    v_dot2c_f32_bf16 v132, v30, v12
    v_dot2c_f32_bf16 v133, v30, v13
    v_dot2c_f32_bf16 v134, v31, v12
    v_dot2c_f32_bf16 v135, v31, v13
    s_waitcnt vmcnt(16)
    v_dot2c_f32_bf16 v136, v64, v12
    v_dot2c_f32_bf16 v137, v64, v13
    v_dot2c_f32_bf16 v138, v65, v12
    v_dot2c_f32_bf16 v139, v65, v13
    v_dot2c_f32_bf16 v140, v66, v12
    v_dot2c_f32_bf16 v141, v66, v13
    v_dot2c_f32_bf16 v142, v67, v12
    v_dot2c_f32_bf16 v143, v67, v13
    s_waitcnt vmcnt(15)
    v_dot2c_f32_bf16 v144, v100, v12
    v_dot2c_f32_bf16 v145, v100, v13
    v_dot2c_f32_bf16 v146, v101, v12
    v_dot2c_f32_bf16 v147, v101, v13
    v_dot2c_f32_bf16 v148, v102, v12
    v_dot2c_f32_bf16 v149, v102, v13
    v_dot2c_f32_bf16 v150, v103, v12
    v_dot2c_f32_bf16 v151, v103, v13
    s_waitcnt vmcnt(14)
    v_dot2c_f32_bf16 v128, v32, v12
    v_dot2c_f32_bf16 v129, v32, v13
    v_dot2c_f32_bf16 v130, v33, v12
    v_dot2c_f32_bf16 v131, v33, v13
    v_dot2c_f32_bf16 v132, v34, v12
    v_dot2c_f32_bf16 v133, v34, v13
    v_dot2c_f32_bf16 v134, v35, v12
    v_dot2c_f32_bf16 v135, v35, v13
    s_waitcnt vmcnt(13)
    v_dot2c_f32_bf16 v136, v68, v12
    v_dot2c_f32_bf16 v137, v68, v13
    v_dot2c_f32_bf16 v138, v69, v12
    v_dot2c_f32_bf16 v139, v69, v13
    v_dot2c_f32_bf16 v140, v70, v12
    v_dot2c_f32_bf16 v141, v70, v13
    v_dot2c_f32_bf16 v142, v71, v12
    v_dot2c_f32_bf16 v143, v71, v13
    s_waitcnt vmcnt(12)
    v_dot2c_f32_bf16 v144, v104, v12
    v_dot2c_f32_bf16 v145, v104, v13
    v_dot2c_f32_bf16 v146, v105, v12
    v_dot2c_f32_bf16 v147, v105, v13
    v_dot2c_f32_bf16 v148, v106, v12
    v_dot2c_f32_bf16 v149, v106, v13
    v_dot2c_f32_bf16 v150, v107, v12
    v_dot2c_f32_bf16 v151, v107, v13
    s_waitcnt vmcnt(11)
    v_dot2c_f32_bf16 v128, v36, v12
    v_dot2c_f32_bf16 v129, v36, v13
    v_dot2c_f32_bf16 v130, v37, v12
    v_dot2c_f32_bf16 v131, v37, v13
    v_dot2c_f32_bf16 v132, v38, v12
    v_dot2c_f32_bf16 v133, v38, v13
    v_dot2c_f32_bf16 v134, v39, v12
    v_dot2c_f32_bf16 v135, v39, v13
    s_waitcnt vmcnt(10)
    v_dot2c_f32_bf16 v136, v72, v12
    v_dot2c_f32_bf16 v137, v72, v13
    v_dot2c_f32_bf16 v138, v73, v12
    v_dot2c_f32_bf16 v139, v73, v13
    v_dot2c_f32_bf16 v140, v74, v12
    v_dot2c_f32_bf16 v141, v74, v13
    v_dot2c_f32_bf16 v142, v75, v12
    v_dot2c_f32_bf16 v143, v75, v13
    s_waitcnt vmcnt(9)
    v_dot2c_f32_bf16 v144, v108, v12
    v_dot2c_f32_bf16 v145, v108, v13
    v_dot2c_f32_bf16 v146, v109, v12
    v_dot2c_f32_bf16 v147, v109, v13
    v_dot2c_f32_bf16 v148, v110, v12
    v_dot2c_f32_bf16 v149, v110, v13
    v_dot2c_f32_bf16 v150, v111, v12
    v_dot2c_f32_bf16 v151, v111, v13
    s_waitcnt vmcnt(8)
    v_dot2c_f32_bf16 v128, v40, v12
    v_dot2c_f32_bf16 v129, v40, v13
    v_dot2c_f32_bf16 v130, v41, v12
    v_dot2c_f32_bf16 v131, v41, v13
    v_dot2c_f32_bf16 v132, v42, v12
    v_dot2c_f32_bf16 v133, v42, v13
    v_dot2c_f32_bf16 v134, v43, v12
    v_dot2c_f32_bf16 v135, v43, v13
    s_waitcnt vmcnt(7)
    v_dot2c_f32_bf16 v136, v76, v12
    v_dot2c_f32_bf16 v137, v76, v13
    v_dot2c_f32_bf16 v138, v77, v12
    v_dot2c_f32_bf16 v139, v77, v13
    v_dot2c_f32_bf16 v140, v78, v12
    v_dot2c_f32_bf16 v141, v78, v13
    v_dot2c_f32_bf16 v142, v79, v12
    v_dot2c_f32_bf16 v143, v79, v13
    s_waitcnt vmcnt(6)
    v_dot2c_f32_bf16 v144, v112, v12
    v_dot2c_f32_bf16 v145, v112, v13
    v_dot2c_f32_bf16 v146, v113, v12
    v_dot2c_f32_bf16 v147, v113, v13
    v_dot2c_f32_bf16 v148, v114, v12
    v_dot2c_f32_bf16 v149, v114, v13
    v_dot2c_f32_bf16 v150, v115, v12
    v_dot2c_f32_bf16 v151, v115, v13
    s_waitcnt vmcnt(5)
    v_dot2c_f32_bf16 v128, v44, v12
    v_dot2c_f32_bf16 v129, v44, v13
    v_dot2c_f32_bf16 v130, v45, v12
    v_dot2c_f32_bf16 v131, v45, v13
    v_dot2c_f32_bf16 v132, v46, v12
    v_dot2c_f32_bf16 v133, v46, v13
    v_dot2c_f32_bf16 v134, v47, v12
    v_dot2c_f32_bf16 v135, v47, v13
    s_waitcnt vmcnt(4)
    v_dot2c_f32_bf16 v136, v80, v12
    v_dot2c_f32_bf16 v137, v80, v13
    v_dot2c_f32_bf16 v138, v81, v12
    v_dot2c_f32_bf16 v139, v81, v13
    v_dot2c_f32_bf16 v140, v82, v12
    v_dot2c_f32_bf16 v141, v82, v13
    v_dot2c_f32_bf16 v142, v83, v12
    v_dot2c_f32_bf16 v143, v83, v13
    s_waitcnt vmcnt(3)
    v_dot2c_f32_bf16 v144, v116, v12
    v_dot2c_f32_bf16 v145, v116, v13
    v_dot2c_f32_bf16 v146, v117, v12
    v_dot2c_f32_bf16 v147, v117, v13
    v_dot2c_f32_bf16 v148, v118, v12
    v_dot2c_f32_bf16 v149, v118, v13
    v_dot2c_f32_bf16 v150, v119, v12
    v_dot2c_f32_bf16 v151, v119, v13
    s_waitcnt vmcnt(2)
    v_dot2c_f32_bf16 v128, v48, v12
    v_dot2c_f32_bf16 v129, v48, v13
    v_dot2c_f32_bf16 v130, v49, v12
    v_dot2c_f32_bf16 v131, v49, v13
    v_dot2c_f32_bf16 v132, v50, v12
    v_dot2c_f32_bf16 v133, v50, v13
    v_dot2c_f32_bf16 v134, v51, v12
    v_dot2c_f32_bf16 v135, v51, v13
    s_waitcnt vmcnt(1)
    v_dot2c_f32_bf16 v136, v84, v12
    v_dot2c_f32_bf16 v137, v84, v13
    v_dot2c_f32_bf16 v138, v85, v12
    v_dot2c_f32_bf16 v139, v85, v13
    v_dot2c_f32_bf16 v140, v86, v12
    v_dot2c_f32_bf16 v141, v86, v13
    v_dot2c_f32_bf16 v142, v87, v12
    v_dot2c_f32_bf16 v143, v87, v13
    s_waitcnt vmcnt(0)
    v_dot2c_f32_bf16 v144, v120, v12
    v_dot2c_f32_bf16 v145, v120, v13
    v_dot2c_f32_bf16 v146, v121, v12
    v_dot2c_f32_bf16 v147, v121, v13
    v_dot2c_f32_bf16 v148, v122, v12
    v_dot2c_f32_bf16 v149, v122, v13
    v_dot2c_f32_bf16 v150, v123, v12
    v_dot2c_f32_bf16 v151, v123, v13
    s_mov_b32 s16, s38
    s_mov_b32 s17, s39
    s_mov_b32 s18, 0x240000
    s_mov_b32 s19, 0x20000
    v_cvt_pk_bf16_f32 v160, v128, v129
    v_cvt_pk_bf16_f32 v161, v130, v131
    v_cvt_pk_bf16_f32 v162, v132, v133
    v_cvt_pk_bf16_f32 v163, v134, v135
    buffer_store_dwordx4 v[160:163], v3, s[16:19], 0 offen offset:0 sc1
    v_cvt_pk_bf16_f32 v164, v136, v137
    v_cvt_pk_bf16_f32 v165, v138, v139
    v_cvt_pk_bf16_f32 v166, v140, v141
    v_cvt_pk_bf16_f32 v167, v142, v143
    buffer_store_dwordx4 v[164:167], v3, s[16:19], 0 offen offset:128 sc1
    v_cvt_pk_bf16_f32 v168, v144, v145
    v_cvt_pk_bf16_f32 v169, v146, v147
    v_cvt_pk_bf16_f32 v170, v148, v149
    v_cvt_pk_bf16_f32 v171, v150, v151
    buffer_store_dwordx4 v[168:171], v3, s[16:19], 0 offen offset:256 sc1
L_w3a_105:
    s_waitcnt vmcnt(0) lgkmcnt(0)
interleave_layers__sliding_local_dilated__glu_gated_bilinear__prompt_kernel_end:
    s_endpgm
L_pn_slow_27:
    s_mov_b32 s97, 0x40000
L_pn_spin_29:
    s_sleep 16
    global_load_dwordx2 v[6:7], v5, s[40:41] sc1
    s_waitcnt vmcnt(0)
    v_cmp_ne_u64 vcc, 0, v[6:7]
    s_sub_u32 s97, s97, 1
    s_cbranch_scc1 L_pn_back_28
    s_cmp_eq_u64 vcc, exec
    s_cbranch_scc1 L_pn_back_28
    s_branch L_pn_spin_29
L_pwo_slow_35:
    s_mov_b32 s97, 0x40000
L_pwo_spin_37:
    s_sleep 16
    buffer_load_dwordx2 v[14:15], v13, s[4:7], s23 offen sc1
    s_waitcnt vmcnt(0)
    v_cmp_eq_u64 vcc, s[98:99], v[14:15]
    s_sub_u32 s97, s97, 1
    s_cbranch_scc1 L_pwo_back_36
    s_cmp_eq_u64 vcc, exec
    s_cbranch_scc1 L_pwo_back_36
    s_branch L_pwo_spin_37
L_px_slow_43:
    s_mov_b32 s97, 0x40000
L_px_spin_45:
    s_sleep 16
    buffer_load_dwordx2 v[12:13], v11, s[4:7], s23 offen sc1
    s_waitcnt vmcnt(0)
    v_cmp_eq_u64 vcc, s[98:99], v[12:13]
    s_sub_u32 s97, s97, 1
    s_cbranch_scc1 L_px_back_44
    s_cmp_eq_u64 vcc, exec
    s_cbranch_scc1 L_px_back_44
    s_branch L_px_spin_45
L_pw_slow_52:
    s_mov_b32 s97, 0x40000
L_pw_spin_54:
    s_sleep 16
    buffer_load_dwordx2 v[12:13], v14, s[4:7], s1 offen sc1
    s_waitcnt vmcnt(0)
    v_cmp_eq_u64 vcc, s[98:99], v[12:13]
    s_sub_u32 s97, s97, 1
    s_cbranch_scc1 L_pw_back_53
    s_cmp_eq_u64 vcc, exec
    s_cbranch_scc1 L_pw_back_53
    s_branch L_pw_spin_54
L_po_slow_55:
    s_mov_b32 s97, 0x40000
L_po_spin_57:
    s_sleep 16
    buffer_load_dwordx2 v[12:13], v10, s[4:7], s52 offen sc1
    s_waitcnt vmcnt(0)
    v_cmp_eq_u64 vcc, s[98:99], v[12:13]
    s_sub_u32 s97, s97, 1
    s_cbranch_scc1 L_po_back_56
    s_cmp_eq_u64 vcc, exec
    s_cbranch_scc1 L_po_back_56
    s_branch L_po_spin_57
L_p1_slow_75:
    s_mov_b32 s97, 0x40000
L_p1_spin_77:
    s_sleep 16
    buffer_load_dwordx2 v[168:169], v0, s[4:7], s55 offen sc1
    s_waitcnt vmcnt(0)
    v_cmp_eq_u64 vcc, s[98:99], v[168:169]
    s_sub_u32 s97, s97, 1
    s_cbranch_scc1 L_p1_back_76
    s_cmp_eq_u64 vcc, exec
    s_cbranch_scc1 L_p1_back_76
    s_branch L_p1_spin_77
L_pd_slow_79:
    s_mov_b32 s97, 0x40000
L_pd_spin_81:
    s_sleep 16
    buffer_load_dwordx2 v[6:7], v0, s[4:7], s55 offen sc1
    s_waitcnt vmcnt(0)
    v_cmp_eq_u64 vcc, s[98:99], v[6:7]
    s_sub_u32 s97, s97, 1
    s_cbranch_scc1 L_pd_back_80
    s_cmp_eq_u64 vcc, exec
    s_cbranch_scc1 L_pd_back_80
    s_branch L_pd_spin_81
L_p0_slow_82:
    s_mov_b32 s97, 0x40000
L_p0_spin_84:
    s_sleep 16
    buffer_load_dwordx2 v[6:7], v0, s[4:7], s55 offen sc1
    s_waitcnt vmcnt(0)
    v_cmp_eq_u64 vcc, s[98:99], v[6:7]
    s_sub_u32 s97, s97, 1
    s_cbranch_scc1 L_p0_back_83
    s_cmp_eq_u64 vcc, exec
    s_cbranch_scc1 L_p0_back_83
    s_branch L_p0_spin_84
L_p1_slow_85:
    s_mov_b32 s97, 0x40000
L_p1_spin_87:
    s_sleep 16
    buffer_load_dwordx2 v[6:7], v0, s[4:7], s55 offen sc1
    s_waitcnt vmcnt(0)
    v_cmp_eq_u64 vcc, s[98:99], v[6:7]
    s_sub_u32 s97, s97, 1
    s_cbranch_scc1 L_p1_back_86
    s_cmp_eq_u64 vcc, exec
    s_cbranch_scc1 L_p1_back_86
    s_branch L_p1_spin_87
L_p2_slow_88:
    s_mov_b32 s97, 0x40000
L_p2_spin_90:
    s_sleep 16
    buffer_load_dwordx2 v[6:7], v0, s[4:7], s55 offen sc1
    s_waitcnt vmcnt(0)
    v_cmp_eq_u64 vcc, s[98:99], v[6:7]
    s_sub_u32 s97, s97, 1
    s_cbranch_scc1 L_p2_back_89
    s_cmp_eq_u64 vcc, exec
    s_cbranch_scc1 L_p2_back_89
    s_branch L_p2_spin_90
L_pp_slow_92:
    s_mov_b32 s97, 0x40000
L_pp_spin_94:
    s_sleep 16
    buffer_load_dwordx2 v[176:177], v10, s[4:7], s49 offen sc1
    s_waitcnt vmcnt(0)
    v_cmp_eq_u64 vcc, s[98:99], v[176:177]
    s_sub_u32 s97, s97, 1
    s_cbranch_scc1 L_pp_back_93
    s_cmp_eq_u64 vcc, exec
    s_cbranch_scc1 L_pp_back_93
    s_branch L_pp_spin_94
L_px_slow_97:
    s_mov_b32 s97, 0x40000
L_px_spin_99:
    s_sleep 16
    buffer_load_dwordx2 v[12:13], v11, s[4:7], s23 offen sc1
    s_waitcnt vmcnt(0)
    v_cmp_eq_u64 vcc, s[98:99], v[12:13]
    s_sub_u32 s97, s97, 1
    s_cbranch_scc1 L_px_back_98
    s_cmp_eq_u64 vcc, exec
    s_cbranch_scc1 L_px_back_98
    s_branch L_px_spin_99
L_po_slow_102:
    s_mov_b32 s97, 0x40000
L_po_spin_104:
    s_sleep 16
    buffer_load_dwordx2 v[12:13], v10, s[4:7], s52 offen sc1
    s_waitcnt vmcnt(0)
    v_cmp_eq_u64 vcc, s[98:99], v[12:13]
    s_sub_u32 s97, s97, 1
    s_cbranch_scc1 L_po_back_103
    s_cmp_eq_u64 vcc, exec
    s_cbranch_scc1 L_po_back_103
    s_branch L_po_spin_104
L_pp_slow_106:
    s_mov_b32 s97, 0x40000
L_pp_spin_108:
    s_sleep 16
    buffer_load_dwordx2 v[176:177], v10, s[4:7], s49 offen sc1
    s_waitcnt vmcnt(0)
    v_cmp_eq_u64 vcc, s[98:99], v[176:177]
    s_sub_u32 s97, s97, 1
    s_cbranch_scc1 L_pp_back_107
    s_cmp_eq_u64 vcc, exec
    s_cbranch_scc1 L_pp_back_107
    s_branch L_pp_spin_108
interleave_layers__sliding_local_dilated__glu_gated_bilinear__prompt_kernel_last:
    s_endpgm
.section .rodata,"a"
.p2align 6
.amdhsa_kernel interleave_layers__sliding_local_dilated__glu_gated_bilinear__prompt_kernel
  .amdhsa_next_free_vgpr 512
  .amdhsa_next_free_sgpr 102
  .amdhsa_accum_offset 256
  .amdhsa_group_segment_fixed_size 0
  .amdhsa_kernarg_size 80
  .amdhsa_user_sgpr_count 2
  .amdhsa_user_sgpr_kernarg_segment_ptr 1
  .amdhsa_system_sgpr_workgroup_id_x 1
  .amdhsa_float_denorm_mode_32 3
.end_amdhsa_kernel
```

```asm
; @launch grid=(256,1,1) block=(256,1,1) lds=163840
.amdgcn_target "amdgcn-amd-amdhsa--gfx950"
.text
.globl interleave_layers__sliding_local_dilated__glu_gated_bilinear__prompt_kernel
.p2align 8
.type interleave_layers__sliding_local_dilated__glu_gated_bilinear__prompt_kernel,@function
interleave_layers__sliding_local_dilated__glu_gated_bilinear__prompt_kernel:
    s_cmp_ge_u32 s2, 256
    s_cbranch_scc1 interleave_layers__sliding_local_dilated__glu_gated_bilinear__prompt_kernel_end
    s_load_dwordx16 s[24:39], s[0:1], 0
    s_load_dwordx4 s[40:43], s[0:1], 64
    v_lshrrev_b32 v1, 6, v0
    s_and_b32 s21, s2, 7
    v_readfirstlane_b32 s20, v1
    s_lshr_b32 s22, s2, 3
    v_and_b32 v1, 63, v0
    v_lshlrev_b32 v2, 4, v1
    s_lshl_b32 s23, s22, 2
    s_add_u32 s23, s23, s20
    s_mul_i32 s23, s23, 5
    v_add_lshl_u32 v219, v1, s23, 7
    s_getpc_b64 s[16:17]
L_pc_1:
    v_min_u32 v219, interleave_layers__sliding_local_dilated__glu_gated_bilinear__prompt_kernel_last-L_pc_1, v219
    s_mov_b64 exec, 31
    global_load_dword v219, v219, s[16:17]
    s_mov_b64 exec, -1
    s_waitcnt lgkmcnt(0)
    s_mov_b32 s4, s42
    s_mov_b32 s5, s43
    s_mov_b32 s6, 0x10000000
    s_mov_b32 s7, 0x20000
    s_mov_b32 s100, 20971520
    s_mov_b32 s101, 0
    s_mov_b32 s8, s24
    s_mov_b32 s9, s25
    s_mov_b32 s10, 0x240000
    s_mov_b32 s11, 0x20000
    s_mov_b32 s12, s26
    s_mov_b32 s13, s27
    s_mov_b32 s14, 0x1e6000
    s_mov_b32 s15, 0x20000
    v_mov_b32 v3, 0
    v_mov_b32 v4, 0
    v_mov_b32 v5, 0
    s_or_b32 s44, s2, s20
    s_cmp_lg_u32 s44, 0
    s_cbranch_scc1 L_nonce_2
    s_memrealtime s[44:45]
    s_waitcnt lgkmcnt(0)
    v_mov_b32 v6, s44
    v_mov_b32 v7, s45
    s_mov_b64 exec, 1
    global_store_dwordx2 v5, v[6:7], s[40:41] sc1
    s_mov_b64 exec, -1
L_nonce_2:
    s_lshl_b32 s52, s2, 2
    s_add_u32 s52, s52, s20
    s_mul_i32 s52, s52, 768
    s_add_u32 s52, s52, 0x8000000
    v_min_u32 v217, 5, v1
    v_lshlrev_b32 v217, 7, v217
    buffer_load_dword v218, v217, s[4:7], s52 offen sc1
    s_cmp_eq_u32 s20, 3
    s_cbranch_scc1 L_w3_3
    s_lshl_b32 s47, s21, 5
    s_add_u32 s47, s47, s22
    v_and_b32 v6, 7, v1
    v_lshrrev_b32 v7, 3, v1
    s_lshl_b32 s48, s47, 3
    v_add_u32 v3, s48, v6
    v_mul_u32_u24 v3, 1152, v3
    s_mul_i32 s48, s20, 384
    v_lshl_add_u32 v3, v7, 4, v3
    v_add_u32 v3, s48, v3
    s_lshr_b32 s48, s47, 1
    s_mul_i32 s48, s48, 18432
    s_and_b32 s49, s47, 1
    s_lshl_b32 s49, s49, 7
    s_add_u32 s48, s48, s49
    s_mul_i32 s49, s20, 6144
    s_add_u32 s48, s48, s49
    v_lshlrev_b32 v6, 4, v6
    v_lshl_add_u32 v6, v7, 8, v6
    v_add_u32 v4, s48, v6
    buffer_load_dwordx4 v[8:11], v3, s[8:11], 0 offen offset:0 nt
    buffer_load_dwordx4 v[12:15], v3, s[8:11], 0 offen offset:128 nt
    buffer_load_dwordx4 v[16:19], v3, s[8:11], 0 offen offset:256 nt
    s_branch L_uend_4
L_w3_3:
    s_mov_b32 s55, 0
    s_mov_b32 s56, 0
    s_mov_b32 s57, 8192
    s_mul_i32 s67, s21, 36
    s_add_u32 s67, s67, s22
    s_lshr_b32 s0, s67, 4
    s_and_b32 s67, s67, 15
    s_mul_i32 s67, s67, 18
    s_add_u32 s67, s67, s0
    s_mul_i32 s44, s67, 3641
    s_lshr_b32 s44, s44, 16
    s_mul_i32 s45, s44, 18
    s_sub_u32 s45, s67, s45
    s_mul_i32 s46, s44, 72
    s_and_b32 s47, s46, 8
    s_and_b32 s46, s46, -16
    s_mul_i32 s48, s45, 110592
    s_add_u32 s46, s46, s48
    s_mov_b32 s48, 3216
    s_mul_i32 s51, s67, 7168
    s_mov_b32 s12, s26
    s_mov_b32 s13, s27
    s_mov_b32 s14, 0x1e6000
    s_mov_b32 s15, 0x20000
    v_add_u32 v64, 0, v1
    v_mul_u32_u24 v65, 4370, v64
    v_lshrrev_b32 v65, 16, v65
    v_mad_i32_i24 v66, v65, -15, v64
    v_mul_u32_u24 v66, 13108, v66
    v_lshrrev_b32 v66, 16, v66
    v_mul_u32_u24 v66, 1072, v66
    v_mad_u32_u24 v65, v65, s48, v66
    v_lshl_add_u32 v64, v64, 4, v65
    s_add_u32 m0, s56, 0
    s_nop 0
    buffer_load_dwordx4 v64, s[12:15], s46 offen nt lds
    v_add_u32 v64, 64, v1
    v_mul_u32_u24 v65, 4370, v64
    v_lshrrev_b32 v65, 16, v65
    v_mad_i32_i24 v66, v65, -15, v64
    v_mul_u32_u24 v66, 13108, v66
    v_lshrrev_b32 v66, 16, v66
    v_mul_u32_u24 v66, 1072, v66
    v_mad_u32_u24 v65, v65, s48, v66
    v_lshl_add_u32 v64, v64, 4, v65
    s_add_u32 m0, s56, 1024
    s_nop 0
    buffer_load_dwordx4 v64, s[12:15], s46 offen nt lds
    v_add_u32 v64, 128, v1
    v_mul_u32_u24 v65, 4370, v64
    v_lshrrev_b32 v65, 16, v65
    v_mad_i32_i24 v66, v65, -15, v64
    v_mul_u32_u24 v66, 13108, v66
    v_lshrrev_b32 v66, 16, v66
    v_mul_u32_u24 v66, 1072, v66
    v_mad_u32_u24 v65, v65, s48, v66
    v_lshl_add_u32 v64, v64, 4, v65
    s_add_u32 m0, s56, 2048
    s_nop 0
    buffer_load_dwordx4 v64, s[12:15], s46 offen nt lds
    v_add_u32 v64, 192, v1
    v_mul_u32_u24 v65, 4370, v64
    v_lshrrev_b32 v65, 16, v65
    v_mad_i32_i24 v66, v65, -15, v64
    v_mul_u32_u24 v66, 13108, v66
    v_lshrrev_b32 v66, 16, v66
    v_mul_u32_u24 v66, 1072, v66
    v_mad_u32_u24 v65, v65, s48, v66
    v_lshl_add_u32 v64, v64, 4, v65
    s_add_u32 m0, s56, 3072
    s_nop 0
    buffer_load_dwordx4 v64, s[12:15], s46 offen nt lds
    v_add_u32 v64, 256, v1
    v_mul_u32_u24 v65, 4370, v64
    v_lshrrev_b32 v65, 16, v65
    v_mad_i32_i24 v66, v65, -15, v64
    v_mul_u32_u24 v66, 13108, v66
    v_lshrrev_b32 v66, 16, v66
    v_mul_u32_u24 v66, 1072, v66
    v_mad_u32_u24 v65, v65, s48, v66
    v_lshl_add_u32 v64, v64, 4, v65
    s_add_u32 m0, s56, 4096
    s_nop 0
    buffer_load_dwordx4 v64, s[12:15], s46 offen nt lds
    v_add_u32 v64, 320, v1
    v_mul_u32_u24 v65, 4370, v64
    v_lshrrev_b32 v65, 16, v65
    v_mad_i32_i24 v66, v65, -15, v64
    v_mul_u32_u24 v66, 13108, v66
    v_lshrrev_b32 v66, 16, v66
    v_mul_u32_u24 v66, 1072, v66
    v_mad_u32_u24 v65, v65, s48, v66
    v_lshl_add_u32 v64, v64, 4, v65
    s_add_u32 m0, s56, 5120
    s_nop 0
    buffer_load_dwordx4 v64, s[12:15], s46 offen nt lds
    v_add_u32 v64, 384, v1
    v_mul_u32_u24 v65, 4370, v64
    v_lshrrev_b32 v65, 16, v65
    v_mad_i32_i24 v66, v65, -15, v64
    v_mul_u32_u24 v66, 13108, v66
    v_lshrrev_b32 v66, 16, v66
    v_mul_u32_u24 v66, 1072, v66
    v_mad_u32_u24 v65, v65, s48, v66
    v_lshl_add_u32 v64, v64, 4, v65
    s_add_u32 m0, s56, 6144
    s_nop 0
    buffer_load_dwordx4 v64, s[12:15], s46 offen nt lds
    v_add_u32 v64, 448, v1
    v_mul_u32_u24 v65, 4370, v64
    v_lshrrev_b32 v65, 16, v65
    v_mad_i32_i24 v66, v65, -15, v64
    v_mul_u32_u24 v66, 13108, v66
    v_lshrrev_b32 v66, 16, v66
    v_mul_u32_u24 v66, 1072, v66
    v_mad_u32_u24 v65, v65, s48, v66
    v_lshl_add_u32 v64, v64, 4, v65
    s_add_u32 m0, s56, 7168
    s_nop 0
    buffer_load_dwordx4 v64, s[12:15], s46 offen nt lds
    s_lshl_b32 s0, s44, 5
    s_add_u32 s0, s0, s45
    s_lshl_b32 s0, s0, 3
    s_add_u32 s0, s0, 131072
    s_cmp_ge_u32 s22, 4
    s_cbranch_scc1 L_uw_5
    s_mov_b32 s55, 1
    s_mul_i32 s67, s21, 36
    s_add_u32 s67, s67, s22
    s_add_u32 s67, s67, 32
    s_lshr_b32 s1, s67, 4
    s_and_b32 s67, s67, 15
    s_mul_i32 s67, s67, 18
    s_add_u32 s67, s67, s1
    s_mul_i32 s84, s67, 3641
    s_lshr_b32 s84, s84, 16
    s_mul_i32 s85, s84, 18
    s_sub_u32 s85, s67, s85
    s_mul_i32 s86, s84, 72
    s_and_b32 s87, s86, 8
    s_and_b32 s86, s86, -16
    s_mul_i32 s88, s85, 110592
    s_add_u32 s86, s86, s88
    s_mov_b32 s88, 3216
    s_mul_i32 s91, s67, 7168
    s_mov_b32 s12, s26
    s_mov_b32 s13, s27
    s_mov_b32 s14, 0x1e6000
    s_mov_b32 s15, 0x20000
    v_add_u32 v64, 0, v1
    v_mul_u32_u24 v65, 4370, v64
    v_lshrrev_b32 v65, 16, v65
    v_mad_i32_i24 v66, v65, -15, v64
    v_mul_u32_u24 v66, 13108, v66
    v_lshrrev_b32 v66, 16, v66
    v_mul_u32_u24 v66, 1072, v66
    v_mad_u32_u24 v65, v65, s88, v66
    v_lshl_add_u32 v64, v64, 4, v65
    s_add_u32 m0, s57, 0
    s_nop 0
    buffer_load_dwordx4 v64, s[12:15], s86 offen nt lds
    v_add_u32 v64, 64, v1
    v_mul_u32_u24 v65, 4370, v64
    v_lshrrev_b32 v65, 16, v65
    v_mad_i32_i24 v66, v65, -15, v64
    v_mul_u32_u24 v66, 13108, v66
    v_lshrrev_b32 v66, 16, v66
    v_mul_u32_u24 v66, 1072, v66
    v_mad_u32_u24 v65, v65, s88, v66
    v_lshl_add_u32 v64, v64, 4, v65
    s_add_u32 m0, s57, 1024
    s_nop 0
    buffer_load_dwordx4 v64, s[12:15], s86 offen nt lds
    v_add_u32 v64, 128, v1
    v_mul_u32_u24 v65, 4370, v64
    v_lshrrev_b32 v65, 16, v65
    v_mad_i32_i24 v66, v65, -15, v64
    v_mul_u32_u24 v66, 13108, v66
    v_lshrrev_b32 v66, 16, v66
    v_mul_u32_u24 v66, 1072, v66
    v_mad_u32_u24 v65, v65, s88, v66
    v_lshl_add_u32 v64, v64, 4, v65
    s_add_u32 m0, s57, 2048
    s_nop 0
    buffer_load_dwordx4 v64, s[12:15], s86 offen nt lds
    v_add_u32 v64, 192, v1
    v_mul_u32_u24 v65, 4370, v64
    v_lshrrev_b32 v65, 16, v65
    v_mad_i32_i24 v66, v65, -15, v64
    v_mul_u32_u24 v66, 13108, v66
    v_lshrrev_b32 v66, 16, v66
    v_mul_u32_u24 v66, 1072, v66
    v_mad_u32_u24 v65, v65, s88, v66
    v_lshl_add_u32 v64, v64, 4, v65
    s_add_u32 m0, s57, 3072
    s_nop 0
    buffer_load_dwordx4 v64, s[12:15], s86 offen nt lds
    v_add_u32 v64, 256, v1
    v_mul_u32_u24 v65, 4370, v64
    v_lshrrev_b32 v65, 16, v65
    v_mad_i32_i24 v66, v65, -15, v64
    v_mul_u32_u24 v66, 13108, v66
    v_lshrrev_b32 v66, 16, v66
    v_mul_u32_u24 v66, 1072, v66
    v_mad_u32_u24 v65, v65, s88, v66
    v_lshl_add_u32 v64, v64, 4, v65
    s_add_u32 m0, s57, 4096
    s_nop 0
    buffer_load_dwordx4 v64, s[12:15], s86 offen nt lds
    v_add_u32 v64, 320, v1
    v_mul_u32_u24 v65, 4370, v64
    v_lshrrev_b32 v65, 16, v65
    v_mad_i32_i24 v66, v65, -15, v64
    v_mul_u32_u24 v66, 13108, v66
    v_lshrrev_b32 v66, 16, v66
    v_mul_u32_u24 v66, 1072, v66
    v_mad_u32_u24 v65, v65, s88, v66
    v_lshl_add_u32 v64, v64, 4, v65
    s_add_u32 m0, s57, 5120
    s_nop 0
    buffer_load_dwordx4 v64, s[12:15], s86 offen nt lds
    v_add_u32 v64, 384, v1
    v_mul_u32_u24 v65, 4370, v64
    v_lshrrev_b32 v65, 16, v65
    v_mad_i32_i24 v66, v65, -15, v64
    v_mul_u32_u24 v66, 13108, v66
    v_lshrrev_b32 v66, 16, v66
    v_mul_u32_u24 v66, 1072, v66
    v_mad_u32_u24 v65, v65, s88, v66
    v_lshl_add_u32 v64, v64, 4, v65
    s_add_u32 m0, s57, 6144
    s_nop 0
    buffer_load_dwordx4 v64, s[12:15], s86 offen nt lds
    v_add_u32 v64, 448, v1
    v_mul_u32_u24 v65, 4370, v64
    v_lshrrev_b32 v65, 16, v65
    v_mad_i32_i24 v66, v65, -15, v64
    v_mul_u32_u24 v66, 13108, v66
    v_lshrrev_b32 v66, 16, v66
    v_mul_u32_u24 v66, 1072, v66
    v_mad_u32_u24 v65, v65, s88, v66
    v_lshl_add_u32 v64, v64, 4, v65
    s_add_u32 m0, s57, 7168
    s_nop 0
    buffer_load_dwordx4 v64, s[12:15], s86 offen nt lds
    s_lshl_b32 s1, s84, 5
    s_add_u32 s1, s1, s85
    s_lshl_b32 s1, s1, 3
    s_add_u32 s1, s1, 131072
    s_branch L_uend_4
L_uw_5:
    s_cmp_ge_u32 s22, 18
    s_cbranch_scc1 L_uend_4
    s_mul_i32 s67, s21, 14
    s_add_u32 s67, s67, s22
    s_sub_u32 s67, s67, 4
    s_cmp_ge_u32 s67, 108
    s_cbranch_scc1 L_uend_4
    s_mov_b32 s55, 2
    s_mul_i32 s84, s67, 3641
    s_lshr_b32 s84, s84, 16
    s_mul_i32 s85, s84, 18
    s_sub_u32 s85, s67, s85
    s_mul_i32 s86, s85, 41472
    s_sub_u32 s87, s85, 16
    s_mul_i32 s87, s87, 331776
    s_add_u32 s87, s87, 18432
    s_cmp_lt_u32 s85, 16
    s_cselect_b32 s86, s86, s87
    s_mov_b32 s88, 82944
    s_mov_b32 s89, 41472
    s_cselect_b32 s88, 4608, s88
    s_cselect_b32 s89, 23040, s89
    s_mul_i32 s87, s84, 192
    s_add_u32 s86, s86, s87
    s_mov_b32 s90, 1152
    s_mul_i32 s91, s67, 6144
    s_mov_b32 s12, s28
    s_mov_b32 s13, s29
    s_mov_b32 s14, 0xa2000
    s_mov_b32 s15, 0x20000
    v_add_u32 v64, 0, v1
    v_mul_u32_u24 v65, 5462, v64
    v_lshrrev_b32 v65, 16, v65
    v_mul_u32_u24 v66, 12, v65
    v_sub_u32 v64, v64, v66
    v_lshlrev_b32 v64, 4, v64
    v_lshrrev_b32 v66, 3, v65
    v_mul_lo_u32 v66, v66, s88
    v_bfe_u32 v67, v65, 2, 1
    v_mul_lo_u32 v67, v67, s89
    v_and_b32 v65, 3, v65
    v_mul_lo_u32 v65, v65, s90
    v_add3_u32 v64, v64, v66, v67
    v_add3_u32 v64, v64, v65, s86
    s_add_u32 m0, s57, 0
    s_nop 0
    buffer_load_dwordx4 v64, s[12:15], 0 offen nt lds
    v_add_u32 v64, 64, v1
    v_mul_u32_u24 v65, 5462, v64
    v_lshrrev_b32 v65, 16, v65
    v_mul_u32_u24 v66, 12, v65
    v_sub_u32 v64, v64, v66
    v_lshlrev_b32 v64, 4, v64
    v_lshrrev_b32 v66, 3, v65
    v_mul_lo_u32 v66, v66, s88
    v_bfe_u32 v67, v65, 2, 1
    v_mul_lo_u32 v67, v67, s89
    v_and_b32 v65, 3, v65
    v_mul_lo_u32 v65, v65, s90
    v_add3_u32 v64, v64, v66, v67
    v_add3_u32 v64, v64, v65, s86
    s_add_u32 m0, s57, 1024
    s_nop 0
    buffer_load_dwordx4 v64, s[12:15], 0 offen nt lds
    v_add_u32 v64, 128, v1
    v_mul_u32_u24 v65, 5462, v64
    v_lshrrev_b32 v65, 16, v65
    v_mul_u32_u24 v66, 12, v65
    v_sub_u32 v64, v64, v66
    v_lshlrev_b32 v64, 4, v64
    v_lshrrev_b32 v66, 3, v65
    v_mul_lo_u32 v66, v66, s88
    v_bfe_u32 v67, v65, 2, 1
    v_mul_lo_u32 v67, v67, s89
    v_and_b32 v65, 3, v65
    v_mul_lo_u32 v65, v65, s90
    v_add3_u32 v64, v64, v66, v67
    v_add3_u32 v64, v64, v65, s86
    s_add_u32 m0, s57, 2048
    s_nop 0
    buffer_load_dwordx4 v64, s[12:15], 0 offen nt lds
    v_add_u32 v64, 192, v1
    v_mul_u32_u24 v65, 5462, v64
    v_lshrrev_b32 v65, 16, v65
    v_mul_u32_u24 v66, 12, v65
    v_sub_u32 v64, v64, v66
    v_lshlrev_b32 v64, 4, v64
    v_lshrrev_b32 v66, 3, v65
    v_mul_lo_u32 v66, v66, s88
    v_bfe_u32 v67, v65, 2, 1
    v_mul_lo_u32 v67, v67, s89
    v_and_b32 v65, 3, v65
    v_mul_lo_u32 v65, v65, s90
    v_add3_u32 v64, v64, v66, v67
    v_add3_u32 v64, v64, v65, s86
    s_add_u32 m0, s57, 3072
    s_nop 0
    buffer_load_dwordx4 v64, s[12:15], 0 offen nt lds
    v_add_u32 v64, 256, v1
    v_mul_u32_u24 v65, 5462, v64
    v_lshrrev_b32 v65, 16, v65
    v_mul_u32_u24 v66, 12, v65
    v_sub_u32 v64, v64, v66
    v_lshlrev_b32 v64, 4, v64
    v_lshrrev_b32 v66, 3, v65
    v_mul_lo_u32 v66, v66, s88
    v_bfe_u32 v67, v65, 2, 1
    v_mul_lo_u32 v67, v67, s89
    v_and_b32 v65, 3, v65
    v_mul_lo_u32 v65, v65, s90
    v_add3_u32 v64, v64, v66, v67
    v_add3_u32 v64, v64, v65, s86
    s_add_u32 m0, s57, 4096
    s_nop 0
    buffer_load_dwordx4 v64, s[12:15], 0 offen nt lds
    v_add_u32 v64, 320, v1
    v_mul_u32_u24 v65, 5462, v64
    v_lshrrev_b32 v65, 16, v65
    v_mul_u32_u24 v66, 12, v65
    v_sub_u32 v64, v64, v66
    v_lshlrev_b32 v64, 4, v64
    v_lshrrev_b32 v66, 3, v65
    v_mul_lo_u32 v66, v66, s88
    v_bfe_u32 v67, v65, 2, 1
    v_mul_lo_u32 v67, v67, s89
    v_and_b32 v65, 3, v65
    v_mul_lo_u32 v65, v65, s90
    v_add3_u32 v64, v64, v66, v67
    v_add3_u32 v64, v64, v65, s86
    s_add_u32 m0, s57, 5120
    s_nop 0
    buffer_load_dwordx4 v64, s[12:15], 0 offen nt lds
    s_lshl_b32 s1, s84, 5
    s_add_u32 s1, s1, s85
    s_lshl_b32 s1, s1, 3
    s_add_u32 s1, s1, 135168
L_uend_4:
    v_add_u32 v64, 0, v1
    v_mul_u32_u24 v65, 3641, v64
    v_lshrrev_b32 v65, 16, v65
    v_mul_u32_u24 v66, 18, v65
    v_sub_u32 v64, v64, v66
    v_lshl_or_b32 v220, v64, 8, v65
    v_add_u32 v64, 64, v1
    v_mul_u32_u24 v65, 3641, v64
    v_lshrrev_b32 v65, 16, v65
    v_mul_u32_u24 v66, 18, v65
    v_sub_u32 v64, v64, v66
    v_lshl_or_b32 v221, v64, 8, v65
    v_add_u32 v64, 128, v1
    v_mul_u32_u24 v65, 3641, v64
    v_lshrrev_b32 v65, 16, v65
    v_mul_u32_u24 v66, 18, v65
    v_sub_u32 v64, v64, v66
    v_lshl_or_b32 v222, v64, 8, v65
    v_add_u32 v64, 192, v1
    v_mul_u32_u24 v65, 3641, v64
    v_lshrrev_b32 v65, 16, v65
    v_mul_u32_u24 v66, 18, v65
    v_sub_u32 v64, v64, v66
    v_lshl_or_b32 v223, v64, 8, v65
    v_add_u32 v64, 256, v1
    v_mul_u32_u24 v65, 3641, v64
    v_lshrrev_b32 v65, 16, v65
    v_mul_u32_u24 v66, 18, v65
    v_sub_u32 v64, v64, v66
    v_lshl_or_b32 v224, v64, 8, v65
    v_add_u32 v64, 320, v1
    v_mul_u32_u24 v65, 3641, v64
    v_lshrrev_b32 v65, 16, v65
    v_mul_u32_u24 v66, 18, v65
    v_sub_u32 v64, v64, v66
    v_lshl_or_b32 v225, v64, 8, v65
    v_add_u32 v64, 384, v1
    v_mul_u32_u24 v65, 3641, v64
    v_lshrrev_b32 v65, 16, v65
    v_mul_u32_u24 v66, 18, v65
    v_sub_u32 v64, v64, v66
    v_lshl_or_b32 v226, v64, 8, v65
    v_add_u32 v64, 448, v1
    v_mul_u32_u24 v65, 3641, v64
    v_lshrrev_b32 v65, 16, v65
    v_mul_u32_u24 v66, 18, v65
    v_sub_u32 v64, v64, v66
    v_lshl_or_b32 v227, v64, 8, v65
    v_add_u32 v64, 512, v1
    v_mul_u32_u24 v65, 3641, v64
    v_lshrrev_b32 v65, 16, v65
    v_mul_u32_u24 v66, 18, v65
    v_sub_u32 v64, v64, v66
    v_lshl_or_b32 v228, v64, 8, v65
    s_lshl_b32 s3, s21, 7
    s_lshl_b32 s52, s22, 2
    s_add_u32 s53, s52, s20
    s_add_u32 s3, s3, s53
    s_lshr_b32 s52, s3, 5
    s_and_b32 s3, s3, 31
    s_mul_i32 s3, s3, 36
    s_add_u32 s3, s3, s52
    s_cmp_ge_u32 s3, 1152
    s_cbranch_scc1 L_ud_6
    s_mul_i32 s64, s3, 1821
    s_lshr_b32 s64, s64, 16
    s_mul_i32 s92, s64, 36
    s_sub_u32 s92, s3, s92
    s_and_b32 s93, s92, 1
    s_lshr_b32 s94, s92, 1
    s_cmp_eq_u32 s93, 0
    s_cselect_b32 s16, s32, s34
    s_cselect_b32 s17, s33, s35
    s_mul_i32 s58, s94, 294912
    s_mul_i32 s95, s64, 288
    s_add_u32 s58, s58, s95
    s_mov_b32 s59, 73728
    s_mov_b32 s60, 36864
    s_mov_b32 s61, 9216
    s_branch L_udone_7
L_ud_6:
    s_sub_u32 s92, s3, 1152
    s_mul_i32 s64, s92, 3641
    s_lshr_b32 s64, s64, 16
    s_mul_i32 s93, s64, 18
    s_sub_u32 s92, s92, s93
    s_and_b32 s93, s64, 3
    s_and_b32 s94, s93, 1
    s_mov_b32 s16, s36
    s_mov_b32 s17, s37
    s_mov_b32 s61, 1152
    s_cmp_eq_u32 s94, 0
    s_mov_b32 s97, -165888
    s_cselect_b32 s97, 165888, s97
    s_mov_b32 s59, 9216
    s_mov_b32 s60, 4608
    s_cmp_ge_u32 s92, 4
    s_cbranch_scc1 L_ush_8
    s_mov_b32 s95, s93
    s_lshl_b32 s96, s92, 5
    s_branch L_urows_10
L_ush_8:
    s_cmp_ge_u32 s92, 6
    s_cbranch_scc1 L_urm_9
    s_sub_u32 s95, s92, 4
    s_lshl_b32 s95, s95, 1
    s_xor_b32 s95, s95, s93
    s_mov_b32 s96, 128
    s_mov_b32 s59, 4608
    s_mov_b32 s60, s97
    s_branch L_urows_10
L_urm_9:
    s_sub_u32 s95, s92, 6
    s_mul_i32 s96, s95, 21846
    s_lshr_b32 s96, s96, 16
    s_mul_i32 s97, s96, 3
    s_sub_u32 s95, s95, s97
    s_add_u32 s95, s95, 1
    s_xor_b32 s95, s95, s93
    s_lshl_b32 s96, s96, 5
L_urows_10:
    s_mul_i32 s95, s95, 144
    s_add_u32 s95, s95, s96
    s_lshr_b32 s96, s64, 2
    s_mul_i32 s96, s96, 576
    s_add_u32 s95, s95, s96
    s_mul_i32 s95, s95, 1152
    s_mul_i32 s96, s93, 288
    s_add_u32 s58, s95, s96
L_udone_7:
    s_mov_b32 s18, 0x510000
    s_mov_b32 s19, 0x20000
    v_bfe_u32 v64, v220, 3, 2
    v_mul_u32_u24 v64, s59, v64
    v_bfe_u32 v65, v220, 2, 1
    v_mul_lo_u32 v65, v65, s60
    v_and_b32 v66, 3, v220
    v_mul_u32_u24 v66, s61, v66
    v_add3_u32 v64, v64, v65, v66
    v_lshrrev_b32 v65, 8, v220
    v_lshl_add_u32 v64, v65, 4, v64
    v_add_u32 v229, s58, v64
    v_bfe_u32 v64, v221, 3, 2
    v_mul_u32_u24 v64, s59, v64
    v_bfe_u32 v65, v221, 2, 1
    v_mul_lo_u32 v65, v65, s60
    v_and_b32 v66, 3, v221
    v_mul_u32_u24 v66, s61, v66
    v_add3_u32 v64, v64, v65, v66
    v_lshrrev_b32 v65, 8, v221
    v_lshl_add_u32 v64, v65, 4, v64
    v_add_u32 v230, s58, v64
    v_bfe_u32 v64, v222, 3, 2
    v_mul_u32_u24 v64, s59, v64
    v_bfe_u32 v65, v222, 2, 1
    v_mul_lo_u32 v65, v65, s60
    v_and_b32 v66, 3, v222
    v_mul_u32_u24 v66, s61, v66
    v_add3_u32 v64, v64, v65, v66
    v_lshrrev_b32 v65, 8, v222
    v_lshl_add_u32 v64, v65, 4, v64
    v_add_u32 v231, s58, v64
    v_bfe_u32 v64, v223, 3, 2
    v_mul_u32_u24 v64, s59, v64
    v_bfe_u32 v65, v223, 2, 1
    v_mul_lo_u32 v65, v65, s60
    v_and_b32 v66, 3, v223
    v_mul_u32_u24 v66, s61, v66
    v_add3_u32 v64, v64, v65, v66
    v_lshrrev_b32 v65, 8, v223
    v_lshl_add_u32 v64, v65, 4, v64
    v_add_u32 v232, s58, v64
    v_bfe_u32 v64, v224, 3, 2
    v_mul_u32_u24 v64, s59, v64
    v_bfe_u32 v65, v224, 2, 1
    v_mul_lo_u32 v65, v65, s60
    v_and_b32 v66, 3, v224
    v_mul_u32_u24 v66, s61, v66
    v_add3_u32 v64, v64, v65, v66
    v_lshrrev_b32 v65, 8, v224
    v_lshl_add_u32 v64, v65, 4, v64
    v_add_u32 v233, s58, v64
    v_bfe_u32 v64, v225, 3, 2
    v_mul_u32_u24 v64, s59, v64
    v_bfe_u32 v65, v225, 2, 1
    v_mul_lo_u32 v65, v65, s60
    v_and_b32 v66, 3, v225
    v_mul_u32_u24 v66, s61, v66
    v_add3_u32 v64, v64, v65, v66
    v_lshrrev_b32 v65, 8, v225
    v_lshl_add_u32 v64, v65, 4, v64
    v_add_u32 v234, s58, v64
    v_bfe_u32 v64, v226, 3, 2
    v_mul_u32_u24 v64, s59, v64
    v_bfe_u32 v65, v226, 2, 1
    v_mul_lo_u32 v65, v65, s60
    v_and_b32 v66, 3, v226
    v_mul_u32_u24 v66, s61, v66
    v_add3_u32 v64, v64, v65, v66
    v_lshrrev_b32 v65, 8, v226
    v_lshl_add_u32 v64, v65, 4, v64
    v_add_u32 v235, s58, v64
    v_bfe_u32 v64, v227, 3, 2
    v_mul_u32_u24 v64, s59, v64
    v_bfe_u32 v65, v227, 2, 1
    v_mul_lo_u32 v65, v65, s60
    v_and_b32 v66, 3, v227
    v_mul_u32_u24 v66, s61, v66
    v_add3_u32 v64, v64, v65, v66
    v_lshrrev_b32 v65, 8, v227
    v_lshl_add_u32 v64, v65, 4, v64
    v_add_u32 v236, s58, v64
    v_bfe_u32 v64, v228, 3, 2
    v_mul_u32_u24 v64, s59, v64
    v_bfe_u32 v65, v228, 2, 1
    v_mul_lo_u32 v65, v65, s60
    v_and_b32 v66, 3, v228
    v_mul_u32_u24 v66, s61, v66
    v_add3_u32 v64, v64, v65, v66
    v_lshrrev_b32 v65, 8, v228
    v_lshl_add_u32 v64, v65, 4, v64
    v_add_u32 v237, s58, v64
    s_mov_b32 s30, -1
    s_mov_b32 s31, -1
    s_mul_i32 s54, s21, 72
    s_add_u32 s54, s54, 1152
    s_cmp_ge_u32 s22, 24
    s_cbranch_scc1 L_ui_11
    s_cmp_lg_u32 s20, 3
    s_cbranch_scc1 L_ue_14
    s_add_u32 s30, s54, s22
    s_add_u32 s30, s30, 48
    s_branch L_ub_13
L_ui_11:
    s_sub_u32 s53, s53, 96
    s_add_u32 s31, s54, s53
    s_add_u32 s30, s31, -16
    s_add_u32 s31, s31, 16
    s_cmp_ge_u32 s53, 16
    s_cbranch_scc1 L_ud_12
    s_lshl_b32 s30, s21, 4
    s_add_u32 s30, s30, s53
    s_add_u32 s30, s30, 1024
    s_lshr_b32 s52, s30, 5
    s_and_b32 s30, s30, 31
    s_mul_i32 s30, s30, 36
    s_add_u32 s30, s30, s52
L_ud_12:
L_ub_13:
L_ue_14:
    v_mov_b32 v238, 0
    v_mov_b32 v239, 0
    v_mov_b32 v240, 0
    v_mov_b32 v241, 0
    v_mov_b32 v242, 0
    v_mov_b32 v243, 0
    v_mov_b32 v244, 0
    v_mov_b32 v245, 0
    v_mov_b32 v246, 0
    s_mov_b32 s14, 0
    s_cmp_eq_u32 s30, -1
    s_cbranch_scc1 L_absent_15
    s_cmp_ge_u32 s30, 1152
    s_cbranch_scc1 L_ud_16
    s_mul_i32 s64, s30, 1821
    s_lshr_b32 s64, s64, 16
    s_mul_i32 s92, s64, 36
    s_sub_u32 s92, s30, s92
    s_and_b32 s93, s92, 1
    s_lshr_b32 s94, s92, 1
    s_cmp_eq_u32 s93, 0
    s_cselect_b32 s12, s32, s34
    s_cselect_b32 s13, s33, s35
    s_mul_i32 s58, s94, 294912
    s_mul_i32 s95, s64, 288
    s_add_u32 s58, s58, s95
    s_mov_b32 s59, 73728
    s_mov_b32 s60, 36864
    s_mov_b32 s61, 9216
    s_branch L_udone_17
L_ud_16:
    s_sub_u32 s92, s30, 1152
    s_mul_i32 s64, s92, 3641
    s_lshr_b32 s64, s64, 16
    s_mul_i32 s93, s64, 18
    s_sub_u32 s92, s92, s93
    s_and_b32 s93, s64, 3
    s_and_b32 s94, s93, 1
    s_mov_b32 s12, s36
    s_mov_b32 s13, s37
    s_mov_b32 s61, 1152
    s_cmp_eq_u32 s94, 0
    s_mov_b32 s97, -165888
    s_cselect_b32 s97, 165888, s97
    s_mov_b32 s59, 9216
    s_mov_b32 s60, 4608
    s_cmp_ge_u32 s92, 4
    s_cbranch_scc1 L_ush_18
    s_mov_b32 s95, s93
    s_lshl_b32 s96, s92, 5
    s_branch L_urows_20
L_ush_18:
    s_cmp_ge_u32 s92, 6
    s_cbranch_scc1 L_urm_19
    s_sub_u32 s95, s92, 4
    s_lshl_b32 s95, s95, 1
    s_xor_b32 s95, s95, s93
    s_mov_b32 s96, 128
    s_mov_b32 s59, 4608
    s_mov_b32 s60, s97
    s_branch L_urows_20
L_urm_19:
    s_sub_u32 s95, s92, 6
    s_mul_i32 s96, s95, 21846
    s_lshr_b32 s96, s96, 16
    s_mul_i32 s97, s96, 3
    s_sub_u32 s95, s95, s97
    s_add_u32 s95, s95, 1
    s_xor_b32 s95, s95, s93
    s_lshl_b32 s96, s96, 5
L_urows_20:
    s_mul_i32 s95, s95, 144
    s_add_u32 s95, s95, s96
    s_lshr_b32 s96, s64, 2
    s_mul_i32 s96, s96, 576
    s_add_u32 s95, s95, s96
    s_mul_i32 s95, s95, 1152
    s_mul_i32 s96, s93, 288
    s_add_u32 s58, s95, s96
L_udone_17:
    s_mov_b32 s14, 0x510000
    s_mov_b32 s15, 0x20000
    v_bfe_u32 v64, v220, 3, 2
    v_mul_u32_u24 v64, s59, v64
    v_bfe_u32 v65, v220, 2, 1
    v_mul_lo_u32 v65, v65, s60
    v_and_b32 v66, 3, v220
    v_mul_u32_u24 v66, s61, v66
    v_add3_u32 v64, v64, v65, v66
    v_lshrrev_b32 v65, 8, v220
    v_lshl_add_u32 v64, v65, 4, v64
    v_add_u32 v238, s58, v64
    v_bfe_u32 v64, v221, 3, 2
    v_mul_u32_u24 v64, s59, v64
    v_bfe_u32 v65, v221, 2, 1
    v_mul_lo_u32 v65, v65, s60
    v_and_b32 v66, 3, v221
    v_mul_u32_u24 v66, s61, v66
    v_add3_u32 v64, v64, v65, v66
    v_lshrrev_b32 v65, 8, v221
    v_lshl_add_u32 v64, v65, 4, v64
    v_add_u32 v239, s58, v64
    v_bfe_u32 v64, v222, 3, 2
    v_mul_u32_u24 v64, s59, v64
    v_bfe_u32 v65, v222, 2, 1
    v_mul_lo_u32 v65, v65, s60
    v_and_b32 v66, 3, v222
    v_mul_u32_u24 v66, s61, v66
    v_add3_u32 v64, v64, v65, v66
    v_lshrrev_b32 v65, 8, v222
    v_lshl_add_u32 v64, v65, 4, v64
    v_add_u32 v240, s58, v64
    v_bfe_u32 v64, v223, 3, 2
    v_mul_u32_u24 v64, s59, v64
    v_bfe_u32 v65, v223, 2, 1
    v_mul_lo_u32 v65, v65, s60
    v_and_b32 v66, 3, v223
    v_mul_u32_u24 v66, s61, v66
    v_add3_u32 v64, v64, v65, v66
    v_lshrrev_b32 v65, 8, v223
    v_lshl_add_u32 v64, v65, 4, v64
    v_add_u32 v241, s58, v64
    v_bfe_u32 v64, v224, 3, 2
    v_mul_u32_u24 v64, s59, v64
    v_bfe_u32 v65, v224, 2, 1
    v_mul_lo_u32 v65, v65, s60
    v_and_b32 v66, 3, v224
    v_mul_u32_u24 v66, s61, v66
    v_add3_u32 v64, v64, v65, v66
    v_lshrrev_b32 v65, 8, v224
    v_lshl_add_u32 v64, v65, 4, v64
    v_add_u32 v242, s58, v64
    v_bfe_u32 v64, v225, 3, 2
    v_mul_u32_u24 v64, s59, v64
    v_bfe_u32 v65, v225, 2, 1
    v_mul_lo_u32 v65, v65, s60
    v_and_b32 v66, 3, v225
    v_mul_u32_u24 v66, s61, v66
    v_add3_u32 v64, v64, v65, v66
    v_lshrrev_b32 v65, 8, v225
    v_lshl_add_u32 v64, v65, 4, v64
    v_add_u32 v243, s58, v64
    v_bfe_u32 v64, v226, 3, 2
    v_mul_u32_u24 v64, s59, v64
    v_bfe_u32 v65, v226, 2, 1
    v_mul_lo_u32 v65, v65, s60
    v_and_b32 v66, 3, v226
    v_mul_u32_u24 v66, s61, v66
    v_add3_u32 v64, v64, v65, v66
    v_lshrrev_b32 v65, 8, v226
    v_lshl_add_u32 v64, v65, 4, v64
    v_add_u32 v244, s58, v64
    v_bfe_u32 v64, v227, 3, 2
    v_mul_u32_u24 v64, s59, v64
    v_bfe_u32 v65, v227, 2, 1
    v_mul_lo_u32 v65, v65, s60
    v_and_b32 v66, 3, v227
    v_mul_u32_u24 v66, s61, v66
    v_add3_u32 v64, v64, v65, v66
    v_lshrrev_b32 v65, 8, v227
    v_lshl_add_u32 v64, v65, 4, v64
    v_add_u32 v245, s58, v64
    v_bfe_u32 v64, v228, 3, 2
    v_mul_u32_u24 v64, s59, v64
    v_bfe_u32 v65, v228, 2, 1
    v_mul_lo_u32 v65, v65, s60
    v_and_b32 v66, 3, v228
    v_mul_u32_u24 v66, s61, v66
    v_add3_u32 v64, v64, v65, v66
    v_lshrrev_b32 v65, 8, v228
    v_lshl_add_u32 v64, v65, 4, v64
    v_add_u32 v246, s58, v64
L_absent_15:
    v_mov_b32 v247, 0
    v_mov_b32 v248, 0
    v_mov_b32 v249, 0
    v_mov_b32 v250, 0
    v_mov_b32 v251, 0
    v_mov_b32 v252, 0
    v_mov_b32 v253, 0
    v_mov_b32 v254, 0
    v_mov_b32 v255, 0
    s_mov_b32 s10, 0
    s_cmp_eq_u32 s31, -1
    s_cbranch_scc1 L_absent_21
    s_cmp_ge_u32 s31, 1152
    s_cbranch_scc1 L_ud_22
    s_mul_i32 s64, s31, 1821
    s_lshr_b32 s64, s64, 16
    s_mul_i32 s92, s64, 36
    s_sub_u32 s92, s31, s92
    s_and_b32 s93, s92, 1
    s_lshr_b32 s94, s92, 1
    s_cmp_eq_u32 s93, 0
    s_cselect_b32 s8, s32, s34
    s_cselect_b32 s9, s33, s35
    s_mul_i32 s58, s94, 294912
    s_mul_i32 s95, s64, 288
    s_add_u32 s58, s58, s95
    s_mov_b32 s59, 73728
    s_mov_b32 s60, 36864
    s_mov_b32 s61, 9216
    s_branch L_udone_23
L_ud_22:
    s_sub_u32 s92, s31, 1152
    s_mul_i32 s64, s92, 3641
    s_lshr_b32 s64, s64, 16
    s_mul_i32 s93, s64, 18
    s_sub_u32 s92, s92, s93
    s_and_b32 s93, s64, 3
    s_and_b32 s94, s93, 1
    s_mov_b32 s8, s36
    s_mov_b32 s9, s37
    s_mov_b32 s61, 1152
    s_cmp_eq_u32 s94, 0
    s_mov_b32 s97, -165888
    s_cselect_b32 s97, 165888, s97
    s_mov_b32 s59, 9216
    s_mov_b32 s60, 4608
    s_cmp_ge_u32 s92, 4
    s_cbranch_scc1 L_ush_24
    s_mov_b32 s95, s93
    s_lshl_b32 s96, s92, 5
    s_branch L_urows_26
L_ush_24:
    s_cmp_ge_u32 s92, 6
    s_cbranch_scc1 L_urm_25
    s_sub_u32 s95, s92, 4
    s_lshl_b32 s95, s95, 1
    s_xor_b32 s95, s95, s93
    s_mov_b32 s96, 128
    s_mov_b32 s59, 4608
    s_mov_b32 s60, s97
    s_branch L_urows_26
L_urm_25:
    s_sub_u32 s95, s92, 6
    s_mul_i32 s96, s95, 21846
    s_lshr_b32 s96, s96, 16
    s_mul_i32 s97, s96, 3
    s_sub_u32 s95, s95, s97
    s_add_u32 s95, s95, 1
    s_xor_b32 s95, s95, s93
    s_lshl_b32 s96, s96, 5
L_urows_26:
    s_mul_i32 s95, s95, 144
    s_add_u32 s95, s95, s96
    s_lshr_b32 s96, s64, 2
    s_mul_i32 s96, s96, 576
    s_add_u32 s95, s95, s96
    s_mul_i32 s95, s95, 1152
    s_mul_i32 s96, s93, 288
    s_add_u32 s58, s95, s96
L_udone_23:
    s_mov_b32 s10, 0x510000
    s_mov_b32 s11, 0x20000
    v_bfe_u32 v64, v220, 3, 2
    v_mul_u32_u24 v64, s59, v64
    v_bfe_u32 v65, v220, 2, 1
    v_mul_lo_u32 v65, v65, s60
    v_and_b32 v66, 3, v220
    v_mul_u32_u24 v66, s61, v66
    v_add3_u32 v64, v64, v65, v66
    v_lshrrev_b32 v65, 8, v220
    v_lshl_add_u32 v64, v65, 4, v64
    v_add_u32 v247, s58, v64
    v_bfe_u32 v64, v221, 3, 2
    v_mul_u32_u24 v64, s59, v64
    v_bfe_u32 v65, v221, 2, 1
    v_mul_lo_u32 v65, v65, s60
    v_and_b32 v66, 3, v221
    v_mul_u32_u24 v66, s61, v66
    v_add3_u32 v64, v64, v65, v66
    v_lshrrev_b32 v65, 8, v221
    v_lshl_add_u32 v64, v65, 4, v64
    v_add_u32 v248, s58, v64
    v_bfe_u32 v64, v222, 3, 2
    v_mul_u32_u24 v64, s59, v64
    v_bfe_u32 v65, v222, 2, 1
    v_mul_lo_u32 v65, v65, s60
    v_and_b32 v66, 3, v222
    v_mul_u32_u24 v66, s61, v66
    v_add3_u32 v64, v64, v65, v66
    v_lshrrev_b32 v65, 8, v222
    v_lshl_add_u32 v64, v65, 4, v64
    v_add_u32 v249, s58, v64
    v_bfe_u32 v64, v223, 3, 2
    v_mul_u32_u24 v64, s59, v64
    v_bfe_u32 v65, v223, 2, 1
    v_mul_lo_u32 v65, v65, s60
    v_and_b32 v66, 3, v223
    v_mul_u32_u24 v66, s61, v66
    v_add3_u32 v64, v64, v65, v66
    v_lshrrev_b32 v65, 8, v223
    v_lshl_add_u32 v64, v65, 4, v64
    v_add_u32 v250, s58, v64
    v_bfe_u32 v64, v224, 3, 2
    v_mul_u32_u24 v64, s59, v64
    v_bfe_u32 v65, v224, 2, 1
    v_mul_lo_u32 v65, v65, s60
    v_and_b32 v66, 3, v224
    v_mul_u32_u24 v66, s61, v66
    v_add3_u32 v64, v64, v65, v66
    v_lshrrev_b32 v65, 8, v224
    v_lshl_add_u32 v64, v65, 4, v64
    v_add_u32 v251, s58, v64
    v_bfe_u32 v64, v225, 3, 2
    v_mul_u32_u24 v64, s59, v64
    v_bfe_u32 v65, v225, 2, 1
    v_mul_lo_u32 v65, v65, s60
    v_and_b32 v66, 3, v225
    v_mul_u32_u24 v66, s61, v66
    v_add3_u32 v64, v64, v65, v66
    v_lshrrev_b32 v65, 8, v225
    v_lshl_add_u32 v64, v65, 4, v64
    v_add_u32 v252, s58, v64
    v_bfe_u32 v64, v226, 3, 2
    v_mul_u32_u24 v64, s59, v64
    v_bfe_u32 v65, v226, 2, 1
    v_mul_lo_u32 v65, v65, s60
    v_and_b32 v66, 3, v226
    v_mul_u32_u24 v66, s61, v66
    v_add3_u32 v64, v64, v65, v66
    v_lshrrev_b32 v65, 8, v226
    v_lshl_add_u32 v64, v65, 4, v64
    v_add_u32 v253, s58, v64
    v_bfe_u32 v64, v227, 3, 2
    v_mul_u32_u24 v64, s59, v64
    v_bfe_u32 v65, v227, 2, 1
    v_mul_lo_u32 v65, v65, s60
    v_and_b32 v66, 3, v227
    v_mul_u32_u24 v66, s61, v66
    v_add3_u32 v64, v64, v65, v66
    v_lshrrev_b32 v65, 8, v227
    v_lshl_add_u32 v64, v65, 4, v64
    v_add_u32 v254, s58, v64
    v_bfe_u32 v64, v228, 3, 2
    v_mul_u32_u24 v64, s59, v64
    v_bfe_u32 v65, v228, 2, 1
    v_mul_lo_u32 v65, v65, s60
    v_and_b32 v66, 3, v228
    v_mul_u32_u24 v66, s61, v66
    v_add3_u32 v64, v64, v65, v66
    v_lshrrev_b32 v65, 8, v228
    v_lshl_add_u32 v64, v65, 4, v64
    v_add_u32 v255, s58, v64
L_absent_21:
    s_cmp_eq_u32 s20, 3
    s_cbranch_scc1 L_w3_30
    s_waitcnt vmcnt(0)
    v_lshlrev_b32 v20, 16, v8
    v_and_b32 v21, 0xffff0000, v8
    v_lshlrev_b32 v22, 16, v9
    v_and_b32 v23, 0xffff0000, v9
    v_lshlrev_b32 v24, 16, v10
    v_and_b32 v25, 0xffff0000, v10
    v_lshlrev_b32 v26, 16, v11
    v_and_b32 v27, 0xffff0000, v11
    v_lshlrev_b32 v28, 16, v12
    v_and_b32 v29, 0xffff0000, v12
    v_lshlrev_b32 v30, 16, v13
    v_and_b32 v31, 0xffff0000, v13
    v_lshlrev_b32 v32, 16, v14
    v_and_b32 v33, 0xffff0000, v14
    v_lshlrev_b32 v34, 16, v15
    v_and_b32 v35, 0xffff0000, v15
    v_lshlrev_b32 v36, 16, v16
    v_and_b32 v37, 0xffff0000, v16
    v_lshlrev_b32 v38, 16, v17
    v_and_b32 v39, 0xffff0000, v17
    v_lshlrev_b32 v40, 16, v18
    v_and_b32 v41, 0xffff0000, v18
    v_lshlrev_b32 v42, 16, v19
    v_and_b32 v43, 0xffff0000, v19
    v_add_f32 v44, v20, v21
    v_add_f32 v64, v22, v23
    v_add_f32 v44, v44, v24
    v_add_f32 v64, v64, v25
    v_add_f32 v44, v44, v26
    v_add_f32 v64, v64, v27
    v_add_f32 v44, v44, v28
    v_add_f32 v64, v64, v29
    v_add_f32 v44, v44, v30
    v_add_f32 v64, v64, v31
    v_add_f32 v44, v44, v32
    v_add_f32 v64, v64, v33
    v_add_f32 v44, v44, v34
    v_add_f32 v64, v64, v35
    v_add_f32 v44, v44, v36
    v_add_f32 v64, v64, v37
    v_add_f32 v44, v44, v38
    v_add_f32 v64, v64, v39
    v_add_f32 v44, v44, v40
    v_add_f32 v64, v64, v41
    v_add_f32 v44, v44, v42
    v_add_f32 v64, v64, v43
    v_add_f32 v44, v44, v64
    s_nop 1
    v_add_f32_dpp v44, v44, v44 row_ror:8 row_mask:0xf bank_mask:0xf
    v_mov_b32 v64, v44
    s_nop 1
    v_permlane16_swap_b32 v44, v64
    v_add_f32 v44, v44, v64
    v_mov_b32 v64, v44
    s_nop 1
    v_permlane32_swap_b32 v44, v64
    v_add_f32 v44, v44, v64
    v_mul_f32 v65, 0x3baaaaab, v44
    v_sub_f32 v64, v20, v65
    v_mul_f32 v45, v64, v64
    v_sub_f32 v67, v21, v65
    v_fmac_f32 v45, v67, v67
    v_sub_f32 v66, v22, v65
    v_fmac_f32 v45, v66, v66
    v_sub_f32 v67, v23, v65
    v_fmac_f32 v45, v67, v67
    v_sub_f32 v66, v24, v65
    v_fmac_f32 v45, v66, v66
    v_sub_f32 v67, v25, v65
    v_fmac_f32 v45, v67, v67
    v_sub_f32 v66, v26, v65
    v_fmac_f32 v45, v66, v66
    v_sub_f32 v67, v27, v65
    v_fmac_f32 v45, v67, v67
    v_sub_f32 v66, v28, v65
    v_fmac_f32 v45, v66, v66
    v_sub_f32 v67, v29, v65
    v_fmac_f32 v45, v67, v67
    v_sub_f32 v66, v30, v65
    v_fmac_f32 v45, v66, v66
    v_sub_f32 v67, v31, v65
    v_fmac_f32 v45, v67, v67
    v_sub_f32 v66, v32, v65
    v_fmac_f32 v45, v66, v66
    v_sub_f32 v67, v33, v65
    v_fmac_f32 v45, v67, v67
    v_sub_f32 v66, v34, v65
    v_fmac_f32 v45, v66, v66
    v_sub_f32 v67, v35, v65
    v_fmac_f32 v45, v67, v67
    v_sub_f32 v66, v36, v65
    v_fmac_f32 v45, v66, v66
    v_sub_f32 v67, v37, v65
    v_fmac_f32 v45, v67, v67
    v_sub_f32 v66, v38, v65
    v_fmac_f32 v45, v66, v66
    v_sub_f32 v67, v39, v65
    v_fmac_f32 v45, v67, v67
    v_sub_f32 v66, v40, v65
    v_fmac_f32 v45, v66, v66
    v_sub_f32 v67, v41, v65
    v_fmac_f32 v45, v67, v67
    v_sub_f32 v66, v42, v65
    v_fmac_f32 v45, v66, v66
    v_sub_f32 v67, v43, v65
    v_fmac_f32 v45, v67, v67
    s_nop 1
    v_add_f32_dpp v45, v45, v45 row_ror:8 row_mask:0xf bank_mask:0xf
    v_mov_b32 v64, v45
    s_nop 1
    v_permlane16_swap_b32 v45, v64
    v_add_f32 v45, v45, v64
    v_mov_b32 v64, v45
    s_nop 1
    v_permlane32_swap_b32 v45, v64
    v_add_f32 v45, v45, v64
    v_and_b32 v64, 7, v1
    s_mul_i32 s46, s20, 64
    s_add_u32 s46, s46, 160896
    v_lshl_add_u32 v64, v64, 3, s46
    ds_write_b64 v64, v[44:45]
    s_waitcnt lgkmcnt(0)
L_w3_30:
    s_barrier
    global_load_dwordx2 v[6:7], v5, s[40:41] sc1
    s_cmp_eq_u32 s20, 3
    s_cbranch_scc1 L_w3_31
    v_and_b32 v64, 7, v1
    v_lshlrev_b32 v64, 3, v64
    v_add_u32 v64, 160896, v64
    ds_read_b64 v[44:45], v64 offset:0
    ds_read_b64 v[46:47], v64 offset:64
    ds_read_b64 v[48:49], v64 offset:128
    s_waitcnt lgkmcnt(1)
    v_add_f32 v64, v44, v46
    s_waitcnt lgkmcnt(0)
    v_add_f32 v64, v64, v48
    v_mul_f32 v64, 0x3ae38e39, v64
    v_add_f32 v65, v45, v47
    v_add_f32 v65, v65, v49
    v_mul_f32 v66, 0x3baaaaab, v44
    v_sub_f32 v66, v66, v64
    v_mul_f32 v66, v66, v66
    v_fmac_f32 v65, 0x43400000, v66
    v_mul_f32 v66, 0x3baaaaab, v46
    v_sub_f32 v66, v66, v64
    v_mul_f32 v66, v66, v66
    v_fmac_f32 v65, 0x43400000, v66
    v_mul_f32 v66, 0x3baaaaab, v48
    v_sub_f32 v66, v66, v64
    v_mul_f32 v66, v66, v66
    v_fmac_f32 v65, 0x43400000, v66
    v_mul_f32 v65, 0x3ae38e39, v65
    v_cvt_pk_bf16_f32 v65, v65, v65
    v_lshlrev_b32 v65, 16, v65
    v_add_f32 v65, 0x3727c5ac, v65
    v_cvt_pk_bf16_f32 v65, v65, v65
    v_lshlrev_b32 v65, 16, v65
    v_sqrt_f32 v65, v65
    s_nop 0
    v_cvt_pk_bf16_f32 v65, v65, v65
    v_lshlrev_b32 v65, 16, v65
    v_rcp_f32 v65, v65
    v_cvt_pk_bf16_f32 v64, v64, v64
    v_lshlrev_b32 v64, 16, v64
    v_sub_f32 v20, v20, v64
    v_sub_f32 v21, v21, v64
    v_cvt_pk_bf16_f32 v66, v20, v21
    v_lshlrev_b32 v20, 16, v66
    v_and_b32 v21, 0xffff0000, v66
    v_mul_f32 v20, v20, v65
    v_mul_f32 v21, v21, v65
    v_cvt_pk_bf16_f32 v52, v20, v21
    v_sub_f32 v22, v22, v64
    v_sub_f32 v23, v23, v64
    v_cvt_pk_bf16_f32 v66, v22, v23
    v_lshlrev_b32 v22, 16, v66
    v_and_b32 v23, 0xffff0000, v66
    v_mul_f32 v22, v22, v65
    v_mul_f32 v23, v23, v65
    v_cvt_pk_bf16_f32 v53, v22, v23
    v_sub_f32 v24, v24, v64
    v_sub_f32 v25, v25, v64
    v_cvt_pk_bf16_f32 v66, v24, v25
    v_lshlrev_b32 v24, 16, v66
    v_and_b32 v25, 0xffff0000, v66
    v_mul_f32 v24, v24, v65
    v_mul_f32 v25, v25, v65
    v_cvt_pk_bf16_f32 v54, v24, v25
    v_sub_f32 v26, v26, v64
    v_sub_f32 v27, v27, v64
    v_cvt_pk_bf16_f32 v66, v26, v27
    v_lshlrev_b32 v26, 16, v66
    v_and_b32 v27, 0xffff0000, v66
    v_mul_f32 v26, v26, v65
    v_mul_f32 v27, v27, v65
    v_cvt_pk_bf16_f32 v55, v26, v27
    v_sub_f32 v28, v28, v64
    v_sub_f32 v29, v29, v64
    v_cvt_pk_bf16_f32 v66, v28, v29
    v_lshlrev_b32 v28, 16, v66
    v_and_b32 v29, 0xffff0000, v66
    v_mul_f32 v28, v28, v65
    v_mul_f32 v29, v29, v65
    v_cvt_pk_bf16_f32 v56, v28, v29
    v_sub_f32 v30, v30, v64
    v_sub_f32 v31, v31, v64
    v_cvt_pk_bf16_f32 v66, v30, v31
    v_lshlrev_b32 v30, 16, v66
    v_and_b32 v31, 0xffff0000, v66
    v_mul_f32 v30, v30, v65
    v_mul_f32 v31, v31, v65
    v_cvt_pk_bf16_f32 v57, v30, v31
    v_sub_f32 v32, v32, v64
    v_sub_f32 v33, v33, v64
    v_cvt_pk_bf16_f32 v66, v32, v33
    v_lshlrev_b32 v32, 16, v66
    v_and_b32 v33, 0xffff0000, v66
    v_mul_f32 v32, v32, v65
    v_mul_f32 v33, v33, v65
    v_cvt_pk_bf16_f32 v58, v32, v33
    v_sub_f32 v34, v34, v64
    v_sub_f32 v35, v35, v64
    v_cvt_pk_bf16_f32 v66, v34, v35
    v_lshlrev_b32 v34, 16, v66
    v_and_b32 v35, 0xffff0000, v66
    v_mul_f32 v34, v34, v65
    v_mul_f32 v35, v35, v65
    v_cvt_pk_bf16_f32 v59, v34, v35
    v_sub_f32 v36, v36, v64
    v_sub_f32 v37, v37, v64
    v_cvt_pk_bf16_f32 v66, v36, v37
    v_lshlrev_b32 v36, 16, v66
    v_and_b32 v37, 0xffff0000, v66
    v_mul_f32 v36, v36, v65
    v_mul_f32 v37, v37, v65
    v_cvt_pk_bf16_f32 v60, v36, v37
    v_sub_f32 v38, v38, v64
    v_sub_f32 v39, v39, v64
    v_cvt_pk_bf16_f32 v66, v38, v39
    v_lshlrev_b32 v38, 16, v66
    v_and_b32 v39, 0xffff0000, v66
    v_mul_f32 v38, v38, v65
    v_mul_f32 v39, v39, v65
    v_cvt_pk_bf16_f32 v61, v38, v39
    v_sub_f32 v40, v40, v64
    v_sub_f32 v41, v41, v64
    v_cvt_pk_bf16_f32 v66, v40, v41
    v_lshlrev_b32 v40, 16, v66
    v_and_b32 v41, 0xffff0000, v66
    v_mul_f32 v40, v40, v65
    v_mul_f32 v41, v41, v65
    v_cvt_pk_bf16_f32 v62, v40, v41
    v_sub_f32 v42, v42, v64
    v_sub_f32 v43, v43, v64
    v_cvt_pk_bf16_f32 v66, v42, v43
    v_lshlrev_b32 v42, 16, v66
    v_and_b32 v43, 0xffff0000, v66
    v_mul_f32 v42, v42, v65
    v_mul_f32 v43, v43, v65
    v_cvt_pk_bf16_f32 v63, v42, v43
    s_mov_b32 s46, 20971520
    buffer_store_dwordx4 v[52:55], v4, s[4:7], s46 offen offset:0 sc1
    buffer_store_dwordx4 v[56:59], v4, s[4:7], s46 offen offset:2048 sc1
    s_add_u32 s46, s46, 4096
    buffer_store_dwordx4 v[60:63], v4, s[4:7], s46 offen offset:0 sc1
    s_lshl_b32 s0, s47, 2
    s_add_u32 s0, s0, s20
    s_lshl_b32 s0, s0, 3
    s_add_u32 s0, s0, 0
    s_mov_b32 s55, 0
    s_branch L_ln_32
L_w3_31:
    v_lshrrev_b32 v64, 4, v1
    v_bfe_u32 v66, v1, 2, 2
    v_lshl_add_u32 v64, v64, 3, v66
    v_mul_u32_u24 v64, 240, v64
    v_add_u32 v64, s56, v64
    v_and_b32 v66, 3, v1
    v_add_u32 v64, s47, v64
    v_and_b32 v67, 1, v66
    v_mul_u32_u24 v67, 160, v67
    v_lshrrev_b32 v65, 1, v66
    v_mul_u32_u24 v65, 80, v65
    v_add3_u32 v65, v65, v67, v64
    v_cmp_eq_u32 vcc, 3, v66
    s_nop 1
    v_cndmask_b32 v65, v65, v64, vcc
    v_lshl_add_u32 v64, v66, 3, v64
    s_waitcnt vmcnt(1)
    ds_read_b64_tr_b16 v[72:73], v64 offset:0
    ds_read_b64_tr_b16 v[74:75], v64 offset:960
    ds_read_b64_tr_b16 v[76:77], v64 offset:40
    ds_read_b64_tr_b16 v[78:79], v64 offset:1000
    ds_read_b64_tr_b16 v[80:81], v64 offset:80
    ds_read_b64_tr_b16 v[82:83], v64 offset:1040
    ds_read_b64_tr_b16 v[84:85], v64 offset:120
    ds_read_b64_tr_b16 v[86:87], v64 offset:1080
    ds_read_b64_tr_b16 v[88:89], v64 offset:160
    ds_read_b64_tr_b16 v[90:91], v64 offset:1120
    ds_read_b64_tr_b16 v[92:93], v64 offset:200
    ds_read_b64_tr_b16 v[94:95], v64 offset:1160
    ds_read_b64_tr_b16 v[96:97], v65 offset:32
    ds_read_b64_tr_b16 v[98:99], v65 offset:992
    v_and_b32 v66, 15, v1
    v_cmp_gt_u32 vcc, 12, v66
    s_waitcnt lgkmcnt(1)
    s_nop 0
    v_cndmask_b32 v96, 0, v96, vcc
    v_cndmask_b32 v97, 0, v97, vcc
    s_waitcnt lgkmcnt(0)
    v_cndmask_b32 v98, 0, v98, vcc
    v_cndmask_b32 v99, 0, v99, vcc
    s_add_u32 s51, s51, 0
    buffer_store_dwordx4 v[72:75], v2, s[4:7], s51 offen offset:0 sc1
    buffer_store_dwordx4 v[76:79], v2, s[4:7], s51 offen offset:1024 sc1
    buffer_store_dwordx4 v[80:83], v2, s[4:7], s51 offen offset:2048 sc1
    buffer_store_dwordx4 v[84:87], v2, s[4:7], s51 offen offset:3072 sc1
    s_add_u32 s51, s51, 4096
    buffer_store_dwordx4 v[88:91], v2, s[4:7], s51 offen offset:0 sc1
    buffer_store_dwordx4 v[92:95], v2, s[4:7], s51 offen offset:1024 sc1
    buffer_store_dwordx4 v[96:99], v2, s[4:7], s51 offen offset:2048 sc1
    s_cmp_eq_u32 s55, 0
    s_cbranch_scc1 L_ln_32
    s_cmp_eq_u32 s55, 2
    s_cbranch_scc1 L_fw_33
    v_lshrrev_b32 v64, 4, v1
    v_bfe_u32 v66, v1, 2, 2
    v_lshl_add_u32 v64, v64, 3, v66
    v_mul_u32_u24 v64, 240, v64
    v_add_u32 v64, s57, v64
    v_and_b32 v66, 3, v1
    v_add_u32 v64, s87, v64
    v_and_b32 v67, 1, v66
    v_mul_u32_u24 v67, 160, v67
    v_lshrrev_b32 v65, 1, v66
    v_mul_u32_u24 v65, 80, v65
    v_add3_u32 v65, v65, v67, v64
    v_cmp_eq_u32 vcc, 3, v66
    s_nop 1
    v_cndmask_b32 v65, v65, v64, vcc
    v_lshl_add_u32 v64, v66, 3, v64
    s_waitcnt vmcnt(8)
    ds_read_b64_tr_b16 v[100:101], v64 offset:0
    ds_read_b64_tr_b16 v[102:103], v64 offset:960
    ds_read_b64_tr_b16 v[104:105], v64 offset:40
    ds_read_b64_tr_b16 v[106:107], v64 offset:1000
    ds_read_b64_tr_b16 v[108:109], v64 offset:80
    ds_read_b64_tr_b16 v[110:111], v64 offset:1040
    ds_read_b64_tr_b16 v[112:113], v64 offset:120
    ds_read_b64_tr_b16 v[114:115], v64 offset:1080
    ds_read_b64_tr_b16 v[116:117], v64 offset:160
    ds_read_b64_tr_b16 v[118:119], v64 offset:1120
    ds_read_b64_tr_b16 v[120:121], v64 offset:200
    ds_read_b64_tr_b16 v[122:123], v64 offset:1160
    ds_read_b64_tr_b16 v[124:125], v65 offset:32
    ds_read_b64_tr_b16 v[126:127], v65 offset:992
    v_and_b32 v66, 15, v1
    v_cmp_gt_u32 vcc, 12, v66
    s_waitcnt lgkmcnt(1)
    s_nop 0
    v_cndmask_b32 v124, 0, v124, vcc
    v_cndmask_b32 v125, 0, v125, vcc
    s_waitcnt lgkmcnt(0)
    v_cndmask_b32 v126, 0, v126, vcc
    v_cndmask_b32 v127, 0, v127, vcc
    s_add_u32 s91, s91, 0
    buffer_store_dwordx4 v[100:103], v2, s[4:7], s91 offen offset:0 sc1
    buffer_store_dwordx4 v[104:107], v2, s[4:7], s91 offen offset:1024 sc1
    buffer_store_dwordx4 v[108:111], v2, s[4:7], s91 offen offset:2048 sc1
    buffer_store_dwordx4 v[112:115], v2, s[4:7], s91 offen offset:3072 sc1
    s_add_u32 s91, s91, 4096
    buffer_store_dwordx4 v[116:119], v2, s[4:7], s91 offen offset:0 sc1
    buffer_store_dwordx4 v[120:123], v2, s[4:7], s91 offen offset:1024 sc1
    buffer_store_dwordx4 v[124:127], v2, s[4:7], s91 offen offset:2048 sc1
    s_branch L_ln_32
L_fw_33:
    v_lshrrev_b32 v64, 4, v1
    v_bfe_u32 v66, v1, 2, 2
    v_lshl_add_u32 v64, v64, 3, v66
    v_mul_u32_u24 v64, 192, v64
    v_add_u32 v64, s57, v64
    v_and_b32 v66, 3, v1
    v_lshl_add_u32 v64, v66, 4, v64
    s_waitcnt vmcnt(8)
    ds_read_b64_tr_b16 v[100:101], v64 offset:0
    ds_read_b64_tr_b16 v[102:103], v64 offset:768
    ds_read_b64_tr_b16 v[104:105], v64 offset:8
    ds_read_b64_tr_b16 v[106:107], v64 offset:776
    ds_read_b64_tr_b16 v[108:109], v64 offset:64
    ds_read_b64_tr_b16 v[110:111], v64 offset:832
    ds_read_b64_tr_b16 v[112:113], v64 offset:72
    ds_read_b64_tr_b16 v[114:115], v64 offset:840
    ds_read_b64_tr_b16 v[116:117], v64 offset:128
    ds_read_b64_tr_b16 v[118:119], v64 offset:896
    ds_read_b64_tr_b16 v[120:121], v64 offset:136
    ds_read_b64_tr_b16 v[122:123], v64 offset:904
    s_add_u32 s91, s91, 2097152
    s_waitcnt lgkmcnt(10)
    buffer_store_dwordx4 v[100:103], v2, s[4:7], s91 offen offset:0 sc1
    s_waitcnt lgkmcnt(8)
    buffer_store_dwordx4 v[104:107], v2, s[4:7], s91 offen offset:1024 sc1
    s_waitcnt lgkmcnt(6)
    buffer_store_dwordx4 v[108:111], v2, s[4:7], s91 offen offset:2048 sc1
    s_waitcnt lgkmcnt(4)
    buffer_store_dwordx4 v[112:115], v2, s[4:7], s91 offen offset:3072 sc1
    s_add_u32 s91, s91, 4096
    s_waitcnt lgkmcnt(2)
    buffer_store_dwordx4 v[116:119], v2, s[4:7], s91 offen offset:0 sc1
    s_waitcnt lgkmcnt(0)
    buffer_store_dwordx4 v[120:123], v2, s[4:7], s91 offen offset:1024 sc1
L_ln_32:
    s_waitcnt vmcnt(0)
    v_cmp_ne_u64 vcc, 0, v[6:7]
    s_nop 0
    s_cmp_eq_u64 vcc, exec
    s_cbranch_scc0 L_pn_slow_27
L_pn_back_28:
    v_readfirstlane_b32 s98, v6
    v_readfirstlane_b32 s99, v7
    s_nop 0
    v_mov_b32 v6, s98
    v_mov_b32 v7, s99
    s_lshl_b32 s0, s0, 2
    s_add_u32 s0, s0, 0x8000000
    s_mov_b64 exec, 1
    buffer_store_dwordx2 v[6:7], off, s[4:7], s0 sc1
    s_mov_b64 exec, -1
    s_cmp_eq_u32 s55, 0
    s_cbranch_scc1 L_norole_34
    s_lshl_b32 s1, s1, 2
    s_add_u32 s1, s1, 0x8000000
    s_mov_b64 exec, 1
    buffer_store_dwordx2 v[6:7], off, s[4:7], s1 sc1
    s_mov_b64 exec, -1
L_norole_34:
    buffer_load_dwordx4 a[144:147], v229, s[16:19], 0 offen nt
    buffer_load_dwordx4 a[148:151], v230, s[16:19], 0 offen nt
    buffer_load_dwordx4 a[152:155], v231, s[16:19], 0 offen nt
    buffer_load_dwordx4 a[156:159], v232, s[16:19], 0 offen nt
    buffer_load_dwordx4 a[160:163], v233, s[16:19], 0 offen nt
    buffer_load_dwordx4 a[164:167], v234, s[16:19], 0 offen nt
    buffer_load_dwordx4 a[168:171], v235, s[16:19], 0 offen nt
    buffer_load_dwordx4 a[172:175], v236, s[16:19], 0 offen nt
    buffer_load_dwordx4 a[176:179], v237, s[16:19], 0 offen nt
    s_and_b32 s52, s21, 6
    s_lshl_b32 s52, s52, 1
    s_lshr_b32 s44, s22, 3
    s_add_u32 s44, s44, s52
    s_and_b32 s52, s21, 1
    s_lshl_b32 s52, s52, 3
    s_and_b32 s45, s22, 7
    s_add_u32 s45, s45, s52
    s_mul_i32 s48, s20, 21
    s_lshr_b32 s48, s48, 1
    s_lshl_b32 s48, s48, 10
    s_mul_i32 s47, s45, 129024
    s_add_u32 s47, s47, s48
    s_add_u32 s47, s47, 0
    s_lshl_b32 s46, s44, 3
    s_max_u32 s52, s46, 1
    s_sub_u32 s52, s52, 1
    s_mul_i32 s49, s52, 18432
    s_mul_i32 s50, s20, 9
    s_lshr_b32 s50, s50, 1
    s_lshl_b32 s50, s50, 10
    s_add_u32 s49, s49, s50
    s_add_u32 s49, s49, 20971520
    s_add_u32 s50, s50, 0
    s_lshl_b32 s54, s52, 6
    s_lshl_b32 s52, s20, 1
    s_add_u32 s46, s46, s52
    s_mul_i32 s51, s46, 18432
    s_add_u32 s51, s51, 20971520
    s_lshl_b32 s55, s46, 6
    v_and_b32 v6, 3, v1
    v_min_u32 v6, 2, v6
    v_and_b32 v7, 12, v1
    v_add_lshl_u32 v8, v6, v7, 3
    v_add_u32 v8, s55, v8
    v_and_b32 v7, 4, v1
    v_add_lshl_u32 v9, v6, v7, 3
    v_add_u32 v9, s54, v9
    v_and_b32 v7, 16, v1
    v_cmp_eq_u32 vcc, 0, v7
    s_nop 1
    v_cndmask_b32 v8, v9, v8, vcc
    v_subrev_u32 v7, 32, v1
    v_min_u32 v7, 17, v7
    s_lshl_b32 s52, s45, 8
    s_add_u32 s52, s52, 131072
    v_lshl_add_u32 v7, v7, 3, s52
    v_cmp_gt_u32 vcc, 32, v1
    s_nop 1
    v_cndmask_b32 v8, v7, v8, vcc
    s_mov_b32 s52, 0
    s_min_u32 s56, s20, 2
    s_add_u32 s57, s56, 2
    s_and_b32 s56, s20, 1
    s_add_u32 s56, s56, 4
    s_cmp_ge_u32 s20, 2
    s_cselect_b32 s57, 6, s57
    s_lshl_b32 s57, s57, 10
    s_lshl_b32 s56, s56, 10
    v_add_u32 v3, 18432, v2
    v_add_u32 v4, s57, v3
    v_add_u32 v5, s56, v3
    v_add_u32 v10, 0, v2
    s_mul_i32 s57, s20, 9216
    s_add_u32 s57, s57, 110592
    v_add_u32 v64, s57, v2
    s_waitcnt vmcnt(8)
    ds_write_b128 v64, a[144:147] offset:0
    s_waitcnt vmcnt(7)
    ds_write_b128 v64, a[148:151] offset:1024
    s_waitcnt vmcnt(6)
    ds_write_b128 v64, a[152:155] offset:2048
    s_waitcnt vmcnt(5)
    ds_write_b128 v64, a[156:159] offset:3072
    s_waitcnt vmcnt(4)
    ds_write_b128 v64, a[160:163] offset:4096
    s_waitcnt vmcnt(3)
    ds_write_b128 v64, a[164:167] offset:5120
    s_waitcnt vmcnt(2)
    ds_write_b128 v64, a[168:171] offset:6144
    s_waitcnt vmcnt(1)
    ds_write_b128 v64, a[172:175] offset:7168
    s_waitcnt vmcnt(0)
    ds_write_b128 v64, a[176:179] offset:8192
    s_cmp_ge_u32 s3, 1152
    s_cbranch_scc1 L_ud_38
    s_mul_i32 s64, s3, 1821
    s_lshr_b32 s64, s64, 16
    s_mul_i32 s92, s64, 36
    s_sub_u32 s92, s3, s92
    s_and_b32 s93, s92, 1
    s_lshr_b32 s94, s92, 1
    s_mov_b32 s62, 0
    s_mov_b32 s63, 256
    s_mul_i32 s95, s64, 486
    s_add_u32 s95, s95, s92
    s_lshl_b32 s95, s95, 10
    s_add_u32 s69, s95, 4194304
    s_add_u32 s58, s69, 36864
    s_add_u32 s59, s69, 110592
    s_add_u32 s60, s69, 184320
    s_add_u32 s61, s69, 258048
    s_mov_b32 s70, 36864
    s_lshl_b32 s95, s64, 1
    s_add_u32 s95, s95, s93
    s_mul_i32 s95, s95, 18
    s_add_u32 s95, s95, s94
    s_mul_i32 s95, s95, 640
    s_add_u32 s65, s95, 2883584
    s_mov_b32 s66, s92
    s_branch L_udone_39
L_ud_38:
    s_sub_u32 s92, s3, 1152
    s_mul_i32 s64, s92, 3641
    s_lshr_b32 s64, s64, 16
    s_mul_i32 s93, s64, 18
    s_sub_u32 s92, s92, s93
    s_and_b32 s93, s64, 3
    s_and_b32 s94, s93, 1
    s_mov_b32 s65, 0
    s_lshl_b32 s62, s94, 5
    s_cmp_eq_u32 s94, 0
    s_cselect_b32 s63, 256, 0
    s_add_u32 s66, s92, 36
    s_mul_i32 s95, s64, 486
    s_add_u32 s95, s95, 324
    s_lshl_b32 s95, s95, 10
    s_add_u32 s95, s95, 4194304
    s_cmp_ge_u32 s92, 3
    s_cbranch_scc1 L_ub_40
    s_sub_u32 s96, s92, 0
    s_mov_b32 s70, 1024
    s_mov_b32 s71, 2048
    s_mul_i32 s97, s96, 5120
    s_add_u32 s97, s97, 0
    s_add_u32 s67, s97, s95
    s_mul_i32 s97, s96, 4096
    s_add_u32 s97, s97, 15360
    s_add_u32 s68, s97, s95
    s_mul_i32 s97, s96, 5120
    s_add_u32 s97, s97, 4096
    s_add_u32 s69, s97, s95
    s_branch L_ue_42
L_ub_40:
    s_cmp_ge_u32 s92, 9
    s_cbranch_scc1 L_uc_41
    s_sub_u32 s96, s92, 3
    s_mov_b32 s70, 1024
    s_mov_b32 s71, 2048
    s_mul_i32 s97, s96, 9216
    s_add_u32 s97, s97, 27648
    s_add_u32 s67, s97, s95
    s_mul_i32 s97, s96, 9216
    s_add_u32 s97, s97, 31744
    s_add_u32 s68, s97, s95
    s_mul_i32 s97, s96, 9216
    s_add_u32 s97, s97, 35840
    s_add_u32 s69, s97, s95
    s_branch L_ue_42
L_uc_41:
    s_sub_u32 s96, s92, 9
    s_mov_b32 s70, 1024
    s_mov_b32 s71, 18432
    s_mul_i32 s97, s96, 2048
    s_add_u32 s97, s97, 82944
    s_add_u32 s67, s97, s95
    s_mul_i32 s97, s96, 2048
    s_add_u32 s97, s97, 119808
    s_add_u32 s68, s97, s95
    s_mul_i32 s97, s96, 1024
    s_add_u32 s97, s97, 156672
    s_add_u32 s69, s97, s95
L_ue_42:
    s_add_u32 s96, s67, s71
    s_add_u32 s61, s68, s71
    s_lshr_b32 s97, s93, 1
    s_cmp_eq_u32 s97, s94
    s_cselect_b32 s58, s67, s68
    s_cselect_b32 s59, s96, s67
    s_cselect_b32 s60, s68, s96
L_udone_39:
    s_lshl_b32 s95, s64, 6
    s_add_u32 s95, s95, s66
    s_lshl_b32 s95, s95, 3
    s_add_u32 s66, s95, 139264
    v_lshrrev_b32 v64, 4, v1
    v_bfe_u32 v66, v1, 2, 2
    v_lshl_add_u32 v64, v64, 3, v66
    v_mul_u32_u24 v64, 288, v64
    v_add_u32 v64, s57, v64
    v_and_b32 v66, 3, v1
    v_lshl_add_u32 v65, v66, 3, v64
    v_add_u32 v65, s63, v65
    v_lshl_add_u32 v64, v66, 4, v64
    v_add_u32 v64, s62, v64
    ds_read_b64_tr_b16 v[180:181], v64 offset:0
    ds_read_b64_tr_b16 v[182:183], v64 offset:1152
    ds_read_b64_tr_b16 v[184:185], v64 offset:8
    ds_read_b64_tr_b16 v[186:187], v64 offset:1160
    ds_read_b64_tr_b16 v[188:189], v64 offset:64
    ds_read_b64_tr_b16 v[190:191], v64 offset:1216
    ds_read_b64_tr_b16 v[192:193], v64 offset:72
    ds_read_b64_tr_b16 v[194:195], v64 offset:1224
    ds_read_b64_tr_b16 v[196:197], v64 offset:128
    ds_read_b64_tr_b16 v[198:199], v64 offset:1280
    ds_read_b64_tr_b16 v[200:201], v64 offset:136
    ds_read_b64_tr_b16 v[202:203], v64 offset:1288
    ds_read_b64_tr_b16 v[204:205], v64 offset:192
    ds_read_b64_tr_b16 v[206:207], v64 offset:1344
    ds_read_b64_tr_b16 v[208:209], v64 offset:200
    ds_read_b64_tr_b16 v[210:211], v64 offset:1352
    ds_read_b64_tr_b16 v[212:213], v65 offset:0
    ds_read_b64_tr_b16 v[214:215], v65 offset:1152
    s_cmp_eq_u32 s65, 0
    s_cbranch_scc1 L_nocs_43
    v_mov_b32 v68, 0x3f803f80
    v_mov_b32 v69, 0x3f803f80
    v_mov_b32 v70, 0x3f803f80
    v_mov_b32 v71, 0x3f803f80
    s_waitcnt lgkmcnt(15)
    s_nop 0
    v_mfma_f32_16x16x32_bf16 v[72:75], v[180:183], v[68:71], 0
    s_waitcnt lgkmcnt(14)
    v_mfma_f32_16x16x32_bf16 v[76:79], v[184:187], v[68:71], 0
    s_waitcnt lgkmcnt(12)
    v_mfma_f32_16x16x32_bf16 v[80:83], v[188:191], v[68:71], 0
    s_waitcnt lgkmcnt(10)
    v_mfma_f32_16x16x32_bf16 v[84:87], v[192:195], v[68:71], 0
    s_waitcnt lgkmcnt(8)
    v_mfma_f32_16x16x32_bf16 v[88:91], v[196:199], v[68:71], 0
    s_waitcnt lgkmcnt(6)
    v_mfma_f32_16x16x32_bf16 v[92:95], v[200:203], v[68:71], 0
    s_waitcnt lgkmcnt(4)
    v_mfma_f32_16x16x32_bf16 v[96:99], v[204:207], v[68:71], 0
    s_waitcnt lgkmcnt(2)
    v_mfma_f32_16x16x32_bf16 v[100:103], v[208:211], v[68:71], 0
    s_waitcnt lgkmcnt(0)
    v_mfma_f32_16x16x32_bf16 v[104:107], v[212:215], v[68:71], 0
    v_and_b32 v66, 15, v1
    v_add_u32 v67, 1, v66
    v_cmp_gt_u32 vcc, 8, v66
    v_and_b32 v64, 48, v1
    s_nop 0
    v_cndmask_b32 v67, 0, v67, vcc
    v_cmp_eq_u32 vcc, 9, v66
    s_nop 1
    v_cndmask_b32 v67, v67, v66, vcc
    v_lshlrev_b32 v67, 6, v67
    v_add_u32 v67, v67, v64
    v_cmp_eq_u32 vcc, 1, v66
    s_nop 1
    v_cndmask_b32 v72, v72, v76, vcc
    v_cndmask_b32 v73, v73, v77, vcc
    v_cndmask_b32 v74, v74, v78, vcc
    v_cndmask_b32 v75, v75, v79, vcc
    v_cmp_eq_u32 vcc, 2, v66
    s_nop 1
    v_cndmask_b32 v72, v72, v80, vcc
    v_cndmask_b32 v73, v73, v81, vcc
    v_cndmask_b32 v74, v74, v82, vcc
    v_cndmask_b32 v75, v75, v83, vcc
    v_cmp_eq_u32 vcc, 3, v66
    s_nop 1
    v_cndmask_b32 v72, v72, v84, vcc
    v_cndmask_b32 v73, v73, v85, vcc
    v_cndmask_b32 v74, v74, v86, vcc
    v_cndmask_b32 v75, v75, v87, vcc
    v_cmp_eq_u32 vcc, 4, v66
    s_nop 1
    v_cndmask_b32 v72, v72, v88, vcc
    v_cndmask_b32 v73, v73, v89, vcc
    v_cndmask_b32 v74, v74, v90, vcc
    v_cndmask_b32 v75, v75, v91, vcc
    v_cmp_eq_u32 vcc, 5, v66
    s_nop 1
    v_cndmask_b32 v72, v72, v92, vcc
    v_cndmask_b32 v73, v73, v93, vcc
    v_cndmask_b32 v74, v74, v94, vcc
    v_cndmask_b32 v75, v75, v95, vcc
    v_cmp_eq_u32 vcc, 6, v66
    s_nop 1
    v_cndmask_b32 v72, v72, v96, vcc
    v_cndmask_b32 v73, v73, v97, vcc
    v_cndmask_b32 v74, v74, v98, vcc
    v_cndmask_b32 v75, v75, v99, vcc
    v_cmp_eq_u32 vcc, 7, v66
    s_nop 1
    v_cndmask_b32 v72, v72, v100, vcc
    v_cndmask_b32 v73, v73, v101, vcc
    v_cndmask_b32 v74, v74, v102, vcc
    v_cndmask_b32 v75, v75, v103, vcc
    v_cmp_eq_u32 vcc, 8, v66
    s_nop 1
    v_cndmask_b32 v72, v72, v104, vcc
    v_cndmask_b32 v73, v73, v105, vcc
    v_cndmask_b32 v74, v74, v106, vcc
    v_cndmask_b32 v75, v75, v107, vcc
    s_mov_b32 exec_lo, 0x03ff03ff
    s_mov_b32 exec_hi, 0x03ff03ff
    buffer_store_dwordx4 v[72:75], v67, s[4:7], s65 offen sc1
    s_mov_b64 exec, -1
L_nocs_43:
    s_mov_b32 s0, s66
    v_mov_b32 v11, v8
    s_mov_b32 s23, s52
    s_lshl_b32 s23, s23, 2
    s_add_u32 s23, s23, 0x8000000
    v_lshlrev_b32 v11, 2, v11
    buffer_load_dwordx2 v[12:13], v11, s[4:7], s23 offen sc1
    v_and_b32 v6, 15, v1
    v_lshrrev_b32 v7, 4, v1
    v_lshlrev_b32 v7, 2, v7
    v_sub_u32 v6, v6, v7
    v_mov_b32 v8, 0xf149f2ca
    s_or_b32 s52, s44, s20
    s_cmp_eq_u32 s52, 0
    s_cselect_b64 s[56:57], -1, 0
    v_subrev_u32 v7, 0, v6
    v_and_b32 v9, 0xfffffff1, v7
    v_cmp_eq_u32 vcc, 0, v9
    v_add_u32 v7, 16, v7
    v_and_b32 v9, 0xfffffff1, v7
    v_cndmask_b32_e64 v168, v8, 0, vcc
    v_cmp_eq_u32 vcc, 0, v9
    s_nop 1
    v_cndmask_b32_e64 v172, v8, 0, vcc
    v_cndmask_b32_e64 v176, v172, v8, s[56:57]
    v_subrev_u32 v7, 1, v6
    v_and_b32 v9, 0xfffffff1, v7
    v_cmp_eq_u32 vcc, 0, v9
    v_add_u32 v7, 16, v7
    v_and_b32 v9, 0xfffffff1, v7
    v_cndmask_b32_e64 v169, v8, 0, vcc
    v_cmp_eq_u32 vcc, 0, v9
    s_nop 1
    v_cndmask_b32_e64 v173, v8, 0, vcc
    v_cndmask_b32_e64 v177, v173, v8, s[56:57]
    v_subrev_u32 v7, 2, v6
    v_and_b32 v9, 0xfffffff1, v7
    v_cmp_eq_u32 vcc, 0, v9
    v_add_u32 v7, 16, v7
    v_and_b32 v9, 0xfffffff1, v7
    v_cndmask_b32_e64 v170, v8, 0, vcc
    v_cmp_eq_u32 vcc, 0, v9
    s_nop 1
    v_cndmask_b32_e64 v174, v8, 0, vcc
    v_cndmask_b32_e64 v178, v174, v8, s[56:57]
    v_subrev_u32 v7, 3, v6
    v_and_b32 v9, 0xfffffff1, v7
    v_cmp_eq_u32 vcc, 0, v9
    v_add_u32 v7, 16, v7
    v_and_b32 v9, 0xfffffff1, v7
    v_cndmask_b32_e64 v171, v8, 0, vcc
    v_cmp_eq_u32 vcc, 0, v9
    s_nop 1
    v_cndmask_b32_e64 v175, v8, 0, vcc
    v_cndmask_b32_e64 v179, v175, v8, s[56:57]
    s_mul_i32 s53, s45, 2304
    s_add_u32 s53, s53, s51
    s_waitcnt vmcnt(0)
    v_cmp_eq_u64 vcc, s[98:99], v[12:13]
    s_nop 0
    s_cmp_eq_u64 vcc, exec
    s_cbranch_scc0 L_px_slow_44
L_px_back_45:
    s_barrier
    s_add_u32 m0, s48, 18432
    s_add_u32 s53, s47, 0
    buffer_load_dwordx4 v2, s[4:7], s53 offen offset:0 lds
    buffer_load_dwordx4 v2, s[4:7], s53 offen offset:1024 lds
    buffer_load_dwordx4 v2, s[4:7], s53 offen offset:2048 lds
    buffer_load_dwordx4 v2, s[4:7], s53 offen offset:3072 lds
    s_add_u32 m0, s48, 22528
    s_add_u32 s53, s47, 4096
    buffer_load_dwordx4 v2, s[4:7], s53 offen offset:0 lds
    buffer_load_dwordx4 v2, s[4:7], s53 offen offset:1024 lds
    buffer_load_dwordx4 v2, s[4:7], s53 offen offset:2048 lds
    buffer_load_dwordx4 v2, s[4:7], s53 offen offset:3072 lds
    s_add_u32 m0, s48, 26624
    s_add_u32 s53, s47, 8192
    buffer_load_dwordx4 v2, s[4:7], s53 offen offset:0 lds
    buffer_load_dwordx4 v2, s[4:7], s53 offen offset:1024 lds
    buffer_load_dwordx4 v2, s[4:7], s53 offen offset:2048 lds
    s_add_u32 s54, s51, 0
    buffer_load_dwordx4 a[0:3], v2, s[4:7], s54 offen offset:0 sc1
    s_add_u32 s55, s51, 18432
    buffer_load_dwordx4 a[72:75], v2, s[4:7], s55 offen offset:0 sc1
    buffer_load_dwordx4 a[4:7], v2, s[4:7], s54 offen offset:1024 sc1
    buffer_load_dwordx4 a[76:79], v2, s[4:7], s55 offen offset:1024 sc1
    buffer_load_dwordx4 a[8:11], v2, s[4:7], s54 offen offset:2048 sc1
    buffer_load_dwordx4 a[80:83], v2, s[4:7], s55 offen offset:2048 sc1
    buffer_load_dwordx4 a[12:15], v2, s[4:7], s54 offen offset:3072 sc1
    buffer_load_dwordx4 a[84:87], v2, s[4:7], s55 offen offset:3072 sc1
    s_add_u32 s54, s51, 4096
    buffer_load_dwordx4 a[16:19], v2, s[4:7], s54 offen offset:0 sc1
    s_add_u32 s55, s51, 22528
    buffer_load_dwordx4 a[88:91], v2, s[4:7], s55 offen offset:0 sc1
    buffer_load_dwordx4 a[20:23], v2, s[4:7], s54 offen offset:1024 sc1
    buffer_load_dwordx4 a[92:95], v2, s[4:7], s55 offen offset:1024 sc1
    s_add_u32 m0, s48, 61440
    s_add_u32 s53, s47, 43008
    buffer_load_dwordx4 v2, s[4:7], s53 offen offset:0 lds
    buffer_load_dwordx4 v2, s[4:7], s53 offen offset:1024 lds
    buffer_load_dwordx4 v2, s[4:7], s53 offen offset:2048 lds
    buffer_load_dwordx4 v2, s[4:7], s53 offen offset:3072 lds
    s_add_u32 m0, s48, 65536
    s_add_u32 s53, s47, 47104
    buffer_load_dwordx4 v2, s[4:7], s53 offen offset:0 lds
    buffer_load_dwordx4 v2, s[4:7], s53 offen offset:1024 lds
    buffer_load_dwordx4 v2, s[4:7], s53 offen offset:2048 lds
    buffer_load_dwordx4 v2, s[4:7], s53 offen offset:3072 lds
    s_add_u32 m0, s48, 69632
    s_add_u32 s53, s47, 51200
    buffer_load_dwordx4 v2, s[4:7], s53 offen offset:0 lds
    buffer_load_dwordx4 v2, s[4:7], s53 offen offset:1024 lds
    buffer_load_dwordx4 v2, s[4:7], s53 offen offset:2048 lds
    s_waitcnt vmcnt(23)
    s_waitcnt lgkmcnt(0)
    s_barrier
    ds_read_b128 v[88:91], v3 offset:0
    ds_read_b128 v[92:95], v3 offset:1024
    ds_read_b128 v[96:99], v3 offset:2048
    ds_read_b128 v[100:103], v3 offset:3072
    ds_read_b128 v[112:115], v3 offset:6144
    ds_read_b128 v[104:107], v3 offset:4096
    ds_read_b128 v[108:111], v3 offset:5120
    s_waitcnt vmcnt(22) lgkmcnt(6)
    s_add_u32 m0, s50, 0
    s_add_u32 s53, s49, 0
    v_mfma_f32_16x16x32_bf16 v[16:19], v[88:91], a[0:3], 0
    buffer_load_dwordx4 v2, s[4:7], s53 offen offset:0 sc1 lds
    s_waitcnt vmcnt(22)
    v_mfma_f32_16x16x32_bf16 v[48:51], v[88:91], a[72:75], 0
    s_waitcnt lgkmcnt(5)
    ds_read_b128 v[116:119], v3 offset:7168
    ds_read_b128 v[120:123], v3 offset:8192
    v_mfma_f32_16x16x32_bf16 v[20:23], v[92:95], a[0:3], 0
    v_mfma_f32_16x16x32_bf16 v[52:55], v[92:95], a[72:75], 0
    s_waitcnt lgkmcnt(6)
    ds_read_b128 v[124:127], v3 offset:9216
    v_mfma_f32_16x16x32_bf16 v[24:27], v[96:99], a[0:3], 0
    buffer_load_dwordx4 v2, s[4:7], s53 offen offset:1024 sc1 lds
    v_mfma_f32_16x16x32_bf16 v[56:59], v[96:99], a[72:75], 0
    s_waitcnt lgkmcnt(6)
    ds_read_b128 v[128:131], v3 offset:10240
    v_mfma_f32_16x16x32_bf16 v[28:31], v[100:103], a[0:3], 0
    v_mfma_f32_16x16x32_bf16 v[60:63], v[100:103], a[72:75], 0
    s_waitcnt lgkmcnt(6)
    ds_read_b128 v[140:143], v3 offset:13312
    v_mfma_f32_16x16x32_bf16 v[32:35], v[112:115], a[0:3], 0
    buffer_load_dwordx4 v2, s[4:7], s53 offen offset:2048 sc1 lds
    v_mfma_f32_16x16x32_bf16 v[64:67], v[112:115], a[72:75], 0
    s_waitcnt lgkmcnt(6)
    ds_read_b128 v[132:135], v3 offset:11264
    v_mfma_f32_16x16x32_bf16 v[36:39], a[0:3], v[104:107], 0
    ds_read_b128 v[136:139], v3 offset:12288
    v_mfma_f32_16x16x32_bf16 v[68:71], a[72:75], v[104:107], 0
    s_waitcnt lgkmcnt(7)
    v_mfma_f32_16x16x32_bf16 v[40:43], a[0:3], v[108:111], 0
    buffer_load_dwordx4 v2, s[4:7], s53 offen offset:3072 sc1 lds
    v_mfma_f32_16x16x32_bf16 v[72:75], a[72:75], v[108:111], 0
    s_waitcnt vmcnt(24) lgkmcnt(6)
    s_add_u32 m0, s50, 4096
    s_add_u32 s53, s49, 4096
    v_mfma_f32_16x16x32_bf16 v[16:19], v[116:119], a[4:7], v[16:19]
    s_waitcnt vmcnt(23)
    ds_read_b128 v[88:91], v3 offset:14336
    v_mfma_f32_16x16x32_bf16 v[48:51], v[116:119], a[76:79], v[48:51]
    s_waitcnt lgkmcnt(6)
    ds_read_b128 v[92:95], v3 offset:15360
    v_mfma_f32_16x16x32_bf16 v[20:23], v[120:123], a[4:7], v[20:23]
    buffer_load_dwordx4 v2, s[4:7], s53 offen offset:0 sc1 lds
    v_mfma_f32_16x16x32_bf16 v[52:55], v[120:123], a[76:79], v[52:55]
    s_waitcnt lgkmcnt(6)
    ds_read_b128 v[96:99], v3 offset:16384
    v_mfma_f32_16x16x32_bf16 v[24:27], v[124:127], a[4:7], v[24:27]
    v_mfma_f32_16x16x32_bf16 v[56:59], v[124:127], a[76:79], v[56:59]
    s_waitcnt lgkmcnt(6)
    ds_read_b128 v[100:103], v3 offset:17408
    v_mfma_f32_16x16x32_bf16 v[28:31], v[128:131], a[4:7], v[28:31]
    buffer_load_dwordx4 a[24:27], v2, s[4:7], s54 offen offset:2048 sc1
    v_mfma_f32_16x16x32_bf16 v[60:63], v[128:131], a[76:79], v[60:63]
    s_waitcnt lgkmcnt(6)
    ds_read_b128 v[112:115], v3 offset:20480
    v_mfma_f32_16x16x32_bf16 v[32:35], v[140:143], a[4:7], v[32:35]
    ds_read_b128 v[104:107], v3 offset:18432
    v_mfma_f32_16x16x32_bf16 v[64:67], v[140:143], a[76:79], v[64:67]
    s_waitcnt lgkmcnt(7)
    v_mfma_f32_16x16x32_bf16 v[36:39], a[4:7], v[132:135], v[36:39]
    ds_read_b128 v[108:111], v3 offset:19456
    v_mfma_f32_16x16x32_bf16 v[68:71], a[76:79], v[132:135], v[68:71]
    s_waitcnt lgkmcnt(7)
    v_mfma_f32_16x16x32_bf16 v[40:43], a[4:7], v[136:139], v[40:43]
    buffer_load_dwordx4 a[96:99], v2, s[4:7], s55 offen offset:2048 sc1
    v_mfma_f32_16x16x32_bf16 v[72:75], a[76:79], v[136:139], v[72:75]
    s_waitcnt vmcnt(25) lgkmcnt(6)
    v_mfma_f32_16x16x32_bf16 v[16:19], v[88:91], a[8:11], v[16:19]
    s_waitcnt vmcnt(24)
    ds_read_b128 v[116:119], v3 offset:21504
    v_mfma_f32_16x16x32_bf16 v[48:51], v[88:91], a[80:83], v[48:51]
    s_waitcnt lgkmcnt(6)
    ds_read_b128 v[120:123], v3 offset:22528
    v_mfma_f32_16x16x32_bf16 v[20:23], v[92:95], a[8:11], v[20:23]
    buffer_load_dwordx4 a[28:31], v2, s[4:7], s54 offen offset:3072 sc1
    v_mfma_f32_16x16x32_bf16 v[52:55], v[92:95], a[80:83], v[52:55]
    s_waitcnt lgkmcnt(6)
    ds_read_b128 v[124:127], v3 offset:23552
    v_mfma_f32_16x16x32_bf16 v[24:27], v[96:99], a[8:11], v[24:27]
    v_mfma_f32_16x16x32_bf16 v[56:59], v[96:99], a[80:83], v[56:59]
    s_waitcnt lgkmcnt(6)
    ds_read_b128 v[128:131], v3 offset:24576
    v_mfma_f32_16x16x32_bf16 v[28:31], v[100:103], a[8:11], v[28:31]
    buffer_load_dwordx4 a[100:103], v2, s[4:7], s55 offen offset:3072 sc1
    v_mfma_f32_16x16x32_bf16 v[60:63], v[100:103], a[80:83], v[60:63]
    s_waitcnt lgkmcnt(6)
    s_add_u32 s54, s51, 8192
    ds_read_b128 v[140:143], v3 offset:27648
    v_mfma_f32_16x16x32_bf16 v[32:35], v[112:115], a[8:11], v[32:35]
    ds_read_b128 v[132:135], v3 offset:25600
    v_mfma_f32_16x16x32_bf16 v[64:67], v[112:115], a[80:83], v[64:67]
    s_waitcnt lgkmcnt(7)
    v_mfma_f32_16x16x32_bf16 v[36:39], a[8:11], v[104:107], v[36:39]
    ds_read_b128 v[136:139], v3 offset:26624
    v_mfma_f32_16x16x32_bf16 v[68:71], a[80:83], v[104:107], v[68:71]
    s_waitcnt lgkmcnt(7)
    v_mfma_f32_16x16x32_bf16 v[40:43], a[8:11], v[108:111], v[40:43]
    buffer_store_dwordx4 v[180:183], v2, s[4:7], s58 offen sc1
    v_mfma_f32_16x16x32_bf16 v[72:75], a[80:83], v[108:111], v[72:75]
    s_waitcnt vmcnt(26) lgkmcnt(6)
    v_mfma_f32_16x16x32_bf16 v[16:19], v[116:119], a[12:15], v[16:19]
    s_waitcnt vmcnt(25)
    ds_read_b128 v[88:91], v3 offset:28672
    v_mfma_f32_16x16x32_bf16 v[48:51], v[116:119], a[84:87], v[48:51]
    s_waitcnt lgkmcnt(6)
    ds_read_b128 v[92:95], v3 offset:29696
    v_mfma_f32_16x16x32_bf16 v[20:23], v[120:123], a[12:15], v[20:23]
    buffer_load_dwordx4 a[32:35], v2, s[4:7], s54 offen offset:0 sc1
    v_mfma_f32_16x16x32_bf16 v[52:55], v[120:123], a[84:87], v[52:55]
    s_waitcnt lgkmcnt(6)
    s_add_u32 s55, s51, 26624
    ds_read_b128 v[96:99], v3 offset:30720
    v_mfma_f32_16x16x32_bf16 v[24:27], v[124:127], a[12:15], v[24:27]
    v_mfma_f32_16x16x32_bf16 v[56:59], v[124:127], a[84:87], v[56:59]
    s_waitcnt lgkmcnt(6)
    ds_read_b128 v[100:103], v3 offset:31744
    v_mfma_f32_16x16x32_bf16 v[28:31], v[128:131], a[12:15], v[28:31]
    buffer_load_dwordx4 a[104:107], v2, s[4:7], s55 offen offset:0 sc1
    v_mfma_f32_16x16x32_bf16 v[60:63], v[128:131], a[84:87], v[60:63]
    s_waitcnt lgkmcnt(6)
    ds_read_b128 v[112:115], v3 offset:34816
    v_mfma_f32_16x16x32_bf16 v[32:35], v[140:143], a[12:15], v[32:35]
    ds_read_b128 v[104:107], v3 offset:32768
    v_mfma_f32_16x16x32_bf16 v[64:67], v[140:143], a[84:87], v[64:67]
    s_waitcnt lgkmcnt(7)
    v_mfma_f32_16x16x32_bf16 v[36:39], a[12:15], v[132:135], v[36:39]
    ds_read_b128 v[108:111], v3 offset:33792
    v_mfma_f32_16x16x32_bf16 v[68:71], a[84:87], v[132:135], v[68:71]
    s_waitcnt lgkmcnt(7)
    v_mfma_f32_16x16x32_bf16 v[40:43], a[12:15], v[136:139], v[40:43]
    buffer_load_dwordx4 a[36:39], v2, s[4:7], s54 offen offset:1024 sc1
    v_mfma_f32_16x16x32_bf16 v[72:75], a[84:87], v[136:139], v[72:75]
    s_waitcnt vmcnt(27) lgkmcnt(6)
    v_mfma_f32_16x16x32_bf16 v[16:19], v[88:91], a[16:19], v[16:19]
    s_waitcnt vmcnt(26)
    ds_read_b128 v[116:119], v3 offset:35840
    v_mfma_f32_16x16x32_bf16 v[48:51], v[88:91], a[88:91], v[48:51]
    s_waitcnt lgkmcnt(6)
    ds_read_b128 v[120:123], v3 offset:36864
    v_mfma_f32_16x16x32_bf16 v[20:23], v[92:95], a[16:19], v[20:23]
    buffer_load_dwordx4 a[108:111], v2, s[4:7], s55 offen offset:1024 sc1
    v_mfma_f32_16x16x32_bf16 v[52:55], v[92:95], a[88:91], v[52:55]
    s_waitcnt lgkmcnt(6)
    ds_read_b128 v[124:127], v3 offset:37888
    v_mfma_f32_16x16x32_bf16 v[24:27], v[96:99], a[16:19], v[24:27]
    v_mfma_f32_16x16x32_bf16 v[56:59], v[96:99], a[88:91], v[56:59]
    s_waitcnt lgkmcnt(6)
    ds_read_b128 v[128:131], v3 offset:38912
    v_mfma_f32_16x16x32_bf16 v[28:31], v[100:103], a[16:19], v[28:31]
    buffer_load_dwordx4 a[40:43], v2, s[4:7], s54 offen offset:2048 sc1
    v_mfma_f32_16x16x32_bf16 v[60:63], v[100:103], a[88:91], v[60:63]
    s_waitcnt lgkmcnt(6)
    s_add_u32 s92, s58, s70
    ds_read_b128 v[140:143], v3 offset:41984
    v_mfma_f32_16x16x32_bf16 v[32:35], v[112:115], a[16:19], v[32:35]
    ds_read_b128 v[132:135], v3 offset:39936
    v_mfma_f32_16x16x32_bf16 v[64:67], v[112:115], a[88:91], v[64:67]
    s_waitcnt lgkmcnt(7)
    v_mfma_f32_16x16x32_bf16 v[36:39], a[16:19], v[104:107], v[36:39]
    ds_read_b128 v[136:139], v3 offset:40960
    v_mfma_f32_16x16x32_bf16 v[68:71], a[88:91], v[104:107], v[68:71]
    buffer_store_dwordx4 v[184:187], v2, s[4:7], s92 offen sc1
    s_waitcnt lgkmcnt(7)
    v_mfma_f32_16x16x32_bf16 v[40:43], a[16:19], v[108:111], v[40:43]
    v_mfma_f32_16x16x32_bf16 v[72:75], a[88:91], v[108:111], v[72:75]
    s_waitcnt vmcnt(28) lgkmcnt(6)
    v_mfma_f32_16x16x32_bf16 v[16:19], v[116:119], a[20:23], v[16:19]
    s_waitcnt vmcnt(27)
    s_waitcnt vmcnt(16)
    s_waitcnt vmcnt(11)
    s_barrier
    v_mfma_f32_16x16x32_bf16 v[48:51], v[116:119], a[92:95], v[48:51]
    s_waitcnt lgkmcnt(5)
    ds_read_b128 v[88:91], v3 offset:43008
    ds_read_b128 v[92:95], v3 offset:44032
    v_mfma_f32_16x16x32_bf16 v[20:23], v[120:123], a[20:23], v[20:23]
    buffer_load_dwordx4 a[112:115], v2, s[4:7], s55 offen offset:2048 sc1
    v_mfma_f32_16x16x32_bf16 v[52:55], v[120:123], a[92:95], v[52:55]
    s_waitcnt lgkmcnt(6)
    ds_read_b128 v[96:99], v3 offset:45056
    ds_read_b128 v[144:147], v10 offset:0
    v_mfma_f32_16x16x32_bf16 v[24:27], v[124:127], a[20:23], v[24:27]
    ds_read_b128 v[148:151], v4 offset:0
    ds_read_b128 v[152:155], v5 offset:0
    v_mfma_f32_16x16x32_bf16 v[56:59], v[124:127], a[92:95], v[56:59]
    s_waitcnt lgkmcnt(9)
    ds_read_b128 v[100:103], v3 offset:46080
    ds_read_b128 v[156:159], v10 offset:1024
    v_mfma_f32_16x16x32_bf16 v[28:31], v[128:131], a[20:23], v[28:31]
    buffer_load_dwordx4 a[44:47], v2, s[4:7], s54 offen offset:3072 sc1
    v_mfma_f32_16x16x32_bf16 v[60:63], v[128:131], a[92:95], v[60:63]
    s_waitcnt lgkmcnt(10)
    ds_read_b128 v[112:115], v3 offset:49152
    ds_read_b128 v[160:163], v4 offset:7168
    v_mfma_f32_16x16x32_bf16 v[32:35], v[140:143], a[20:23], v[32:35]
    ds_read_b128 v[104:107], v3 offset:47104
    ds_read_b128 v[164:167], v5 offset:7168
    v_mfma_f32_16x16x32_bf16 v[64:67], v[140:143], a[92:95], v[64:67]
    s_waitcnt lgkmcnt(13)
    v_mfma_f32_16x16x32_bf16 v[36:39], a[20:23], v[132:135], v[36:39]
    ds_read_b128 v[108:111], v3 offset:48128
    v_mfma_f32_16x16x32_bf16 v[68:71], a[92:95], v[132:135], v[68:71]
    s_waitcnt lgkmcnt(13)
    v_mfma_f32_16x16x32_bf16 v[40:43], a[20:23], v[136:139], v[40:43]
    buffer_load_dwordx4 a[116:119], v2, s[4:7], s55 offen offset:3072 sc1
    v_mfma_f32_16x16x32_bf16 v[72:75], a[92:95], v[136:139], v[72:75]
    s_waitcnt vmcnt(13) lgkmcnt(12)
    s_add_u32 m0, s48, 104448
    s_add_u32 s53, s47, 86016
    v_mfma_f32_16x16x32_bf16 v[16:19], v[88:91], a[24:27], v[16:19]
    s_waitcnt vmcnt(12)
    ds_read_b128 v[116:119], v3 offset:50176
    v_mfma_f32_16x16x32_bf16 v[48:51], v[88:91], a[96:99], v[48:51]
    s_waitcnt lgkmcnt(12)
    ds_read_b128 v[120:123], v3 offset:51200
    v_mfma_f32_16x16x32_bf16 v[20:23], v[92:95], a[24:27], v[20:23]
    buffer_load_dwordx4 v2, s[4:7], s53 offen offset:0 lds
    v_mfma_f32_16x16x32_bf16 v[52:55], v[92:95], a[96:99], v[52:55]
    s_waitcnt lgkmcnt(12)
    ds_read_b128 v[124:127], v3 offset:52224
    v_mfma_f32_16x16x32_bf16 v[24:27], v[96:99], a[24:27], v[24:27]
    v_mfma_f32_16x16x32_bf16 v[56:59], v[96:99], a[96:99], v[56:59]
    s_waitcnt lgkmcnt(9)
    ds_read_b128 v[128:131], v3 offset:53248
    v_mfma_f32_16x16x32_bf16 v[28:31], v[100:103], a[24:27], v[28:31]
    buffer_store_dwordx4 v[188:191], v2, s[4:7], s59 offen sc1
    v_mfma_f32_16x16x32_bf16 v[60:63], v[100:103], a[96:99], v[60:63]
    s_waitcnt lgkmcnt(8)
    ds_read_b128 v[140:143], v3 offset:56320
    v_mfma_f32_16x16x32_bf16 v[32:35], v[112:115], a[24:27], v[32:35]
    ds_read_b128 v[132:135], v3 offset:54272
    v_mfma_f32_16x16x32_bf16 v[64:67], v[112:115], a[96:99], v[64:67]
    s_waitcnt lgkmcnt(8)
    v_mfma_f32_16x16x32_bf16 v[36:39], a[24:27], v[104:107], v[36:39]
    ds_read_b128 v[136:139], v3 offset:55296
    v_mfma_f32_16x16x32_bf16 v[68:71], a[96:99], v[104:107], v[68:71]
    s_waitcnt lgkmcnt(7)
    v_mfma_f32_16x16x32_bf16 v[40:43], a[24:27], v[108:111], v[40:43]
    buffer_load_dwordx4 v2, s[4:7], s53 offen offset:1024 lds
    v_mfma_f32_16x16x32_bf16 v[72:75], a[96:99], v[108:111], v[72:75]
    v_mfma_f32_16x16x32_bf16 v[80:83], v[148:151], v[144:147], 0
    v_mfma_f32_16x16x32_bf16 v[84:87], v[144:147], v[152:155], 0
    s_waitcnt vmcnt(14) lgkmcnt(6)
    ds_read_b128 v[144:147], v10 offset:2048
    ds_read_b128 v[148:151], v4 offset:14336
    v_mfma_f32_16x16x32_bf16 v[16:19], v[116:119], a[28:31], v[16:19]
    buffer_load_dwordx4 v2, s[4:7], s53 offen offset:2048 lds
    s_waitcnt vmcnt(14)
    v_mfma_f32_16x16x32_bf16 v[48:51], v[116:119], a[100:103], v[48:51]
    s_waitcnt lgkmcnt(7)
    ds_read_b128 v[88:91], v3 offset:57344
    ds_read_b128 v[92:95], v3 offset:58368
    v_mfma_f32_16x16x32_bf16 v[20:23], v[120:123], a[28:31], v[20:23]
    ds_read_b128 v[152:155], v5 offset:14336
    v_mfma_f32_16x16x32_bf16 v[52:55], v[120:123], a[100:103], v[52:55]
    s_waitcnt lgkmcnt(9)
    ds_read_b128 v[96:99], v3 offset:59392
    v_mfma_f32_16x16x32_bf16 v[24:27], v[124:127], a[28:31], v[24:27]
    buffer_load_dwordx4 v2, s[4:7], s53 offen offset:3072 lds
    v_mfma_f32_16x16x32_bf16 v[56:59], v[124:127], a[100:103], v[56:59]
    s_waitcnt lgkmcnt(9)
    s_add_u32 m0, s48, 108544
    s_add_u32 s53, s47, 90112
    v_mfma_f32_16x16x32_bf16 v[28:31], v[128:131], a[28:31], v[28:31]
    ds_read_b128 v[100:103], v3 offset:60416
    v_mfma_f32_16x16x32_bf16 v[60:63], v[128:131], a[100:103], v[60:63]
    s_waitcnt lgkmcnt(9)
    ds_read_b128 v[112:115], v3 offset:63488
    v_mfma_f32_16x16x32_bf16 v[32:35], v[140:143], a[28:31], v[32:35]
    buffer_load_dwordx4 v2, s[4:7], s53 offen offset:0 lds
    v_mfma_f32_16x16x32_bf16 v[64:67], v[140:143], a[100:103], v[64:67]
    s_waitcnt lgkmcnt(9)
    ds_read_b128 v[104:107], v3 offset:61440
    v_mfma_f32_16x16x32_bf16 v[36:39], a[28:31], v[132:135], v[36:39]
    ds_read_b128 v[108:111], v3 offset:62464
    v_mfma_f32_16x16x32_bf16 v[68:71], a[100:103], v[132:135], v[68:71]
    s_waitcnt lgkmcnt(10)
    s_add_u32 s92, s59, s70
    v_mfma_f32_16x16x32_bf16 v[40:43], a[28:31], v[136:139], v[40:43]
    buffer_store_dwordx4 v[192:195], v2, s[4:7], s92 offen sc1
    v_mfma_f32_16x16x32_bf16 v[72:75], a[100:103], v[136:139], v[72:75]
    v_mfma_f32_16x16x32_bf16 v[80:83], v[160:163], v[156:159], v[80:83]
    v_mfma_f32_16x16x32_bf16 v[84:87], v[156:159], v[164:167], v[84:87]
    s_waitcnt vmcnt(15) lgkmcnt(7)
    ds_read_b128 v[156:159], v10 offset:3072
    ds_read_b128 v[160:163], v4 offset:21504
    v_mfma_f32_16x16x32_bf16 v[16:19], v[88:91], a[32:35], v[16:19]
    buffer_load_dwordx4 v2, s[4:7], s53 offen offset:1024 lds
    s_waitcnt vmcnt(15)
    v_mfma_f32_16x16x32_bf16 v[48:51], v[88:91], a[104:107], v[48:51]
    s_waitcnt lgkmcnt(8)
    ds_read_b128 v[164:167], v5 offset:21504
    v_add_u32 v3, 64512, v3
    v_mfma_f32_16x16x32_bf16 v[20:23], v[92:95], a[32:35], v[20:23]
    ds_read_b128 v[116:119], v3 offset:0
    v_mfma_f32_16x16x32_bf16 v[52:55], v[92:95], a[104:107], v[52:55]
    s_waitcnt lgkmcnt(8)
    ds_read_b128 v[120:123], v3 offset:1024
    v_mfma_f32_16x16x32_bf16 v[24:27], v[96:99], a[32:35], v[24:27]
    buffer_load_dwordx4 v2, s[4:7], s53 offen offset:2048 lds
    v_mfma_f32_16x16x32_bf16 v[56:59], v[96:99], a[104:107], v[56:59]
    s_waitcnt lgkmcnt(8)
    ds_read_b128 v[124:127], v3 offset:2048
    v_mfma_f32_16x16x32_bf16 v[28:31], v[100:103], a[32:35], v[28:31]
    v_mfma_f32_16x16x32_bf16 v[60:63], v[100:103], a[104:107], v[60:63]
    buffer_load_dwordx4 v2, s[4:7], s53 offen offset:3072 lds
    s_add_u32 m0, s48, 112640
    s_add_u32 s53, s47, 94208
    buffer_load_dwordx4 v2, s[4:7], s53 offen offset:0 lds
    buffer_load_dwordx4 v2, s[4:7], s53 offen offset:1024 lds
    buffer_load_dwordx4 v2, s[4:7], s53 offen offset:2048 lds
    s_waitcnt lgkmcnt(8)
    v_mfma_f32_16x16x32_bf16 v[32:35], v[112:115], a[32:35], v[32:35]
    s_add_u32 s54, s51, 12288
    ds_read_b128 v[128:131], v3 offset:3072
    ds_read_b128 v[140:143], v3 offset:6144
    v_mfma_f32_16x16x32_bf16 v[64:67], v[112:115], a[104:107], v[64:67]
    s_waitcnt lgkmcnt(9)
    v_mfma_f32_16x16x32_bf16 v[36:39], a[32:35], v[104:107], v[36:39]
    ds_read_b128 v[132:135], v3 offset:4096
    v_mfma_f32_16x16x32_bf16 v[68:71], a[104:107], v[104:107], v[68:71]
    s_waitcnt lgkmcnt(9)
    v_mfma_f32_16x16x32_bf16 v[40:43], a[32:35], v[108:111], v[40:43]
    ds_read_b128 v[136:139], v3 offset:5120
    v_mfma_f32_16x16x32_bf16 v[72:75], a[104:107], v[108:111], v[72:75]
    v_mfma_f32_16x16x32_bf16 v[80:83], v[148:151], v[144:147], v[80:83]
    v_mfma_f32_16x16x32_bf16 v[84:87], v[144:147], v[152:155], v[84:87]
    s_waitcnt vmcnt(19) lgkmcnt(6)
    ds_read_b128 v[144:147], v10 offset:4096
    ds_read_b128 v[148:151], v4 offset:28672
    v_mfma_f32_16x16x32_bf16 v[16:19], v[116:119], a[36:39], v[16:19]
    buffer_load_dwordx4 a[48:51], v2, s[4:7], s54 offen offset:0 sc1
    s_waitcnt vmcnt(19)
    v_mfma_f32_16x16x32_bf16 v[48:51], v[116:119], a[108:111], v[48:51]
    s_waitcnt lgkmcnt(7)
    s_add_u32 s55, s51, 30720
    ds_read_b128 v[88:91], v3 offset:7168
    v_mfma_f32_16x16x32_bf16 v[20:23], v[120:123], a[36:39], v[20:23]
    ds_read_b128 v[92:95], v3 offset:8192
    ds_read_b128 v[152:155], v5 offset:28672
    v_mfma_f32_16x16x32_bf16 v[52:55], v[120:123], a[108:111], v[52:55]
    s_waitcnt lgkmcnt(9)
    ds_read_b128 v[96:99], v3 offset:9216
    v_mfma_f32_16x16x32_bf16 v[24:27], v[124:127], a[36:39], v[24:27]
    buffer_load_dwordx4 a[120:123], v2, s[4:7], s55 offen offset:0 sc1
    v_mfma_f32_16x16x32_bf16 v[56:59], v[124:127], a[108:111], v[56:59]
    s_waitcnt lgkmcnt(9)
    ds_read_b128 v[100:103], v3 offset:10240
    v_mfma_f32_16x16x32_bf16 v[28:31], v[128:131], a[36:39], v[28:31]
    v_mfma_f32_16x16x32_bf16 v[60:63], v[128:131], a[108:111], v[60:63]
    buffer_store_dwordx4 v[196:199], v2, s[4:7], s60 offen sc1
    s_waitcnt lgkmcnt(9)
    v_mfma_f32_16x16x32_bf16 v[32:35], v[140:143], a[36:39], v[32:35]
    ds_read_b128 v[112:115], v3 offset:13312
    ds_read_b128 v[104:107], v3 offset:11264
    v_mfma_f32_16x16x32_bf16 v[64:67], v[140:143], a[108:111], v[64:67]
    s_waitcnt lgkmcnt(10)
    v_mfma_f32_16x16x32_bf16 v[36:39], a[36:39], v[132:135], v[36:39]
    ds_read_b128 v[108:111], v3 offset:12288
    v_mfma_f32_16x16x32_bf16 v[68:71], a[108:111], v[132:135], v[68:71]
    s_waitcnt lgkmcnt(10)
    v_mfma_f32_16x16x32_bf16 v[40:43], a[36:39], v[136:139], v[40:43]
    buffer_load_dwordx4 a[52:55], v2, s[4:7], s54 offen offset:1024 sc1
    v_mfma_f32_16x16x32_bf16 v[72:75], a[108:111], v[136:139], v[72:75]
    v_mfma_f32_16x16x32_bf16 v[80:83], v[160:163], v[156:159], v[80:83]
    v_mfma_f32_16x16x32_bf16 v[84:87], v[156:159], v[164:167], v[84:87]
    s_waitcnt vmcnt(21) lgkmcnt(7)
    ds_read_b128 v[156:159], v10 offset:5120
    ds_read_b128 v[160:163], v4 offset:35840
    v_mfma_f32_16x16x32_bf16 v[16:19], v[88:91], a[40:43], v[16:19]
    buffer_load_dwordx4 a[124:127], v2, s[4:7], s55 offen offset:1024 sc1
    s_waitcnt vmcnt(20)
    v_mfma_f32_16x16x32_bf16 v[48:51], v[88:91], a[112:115], v[48:51]
    s_waitcnt lgkmcnt(8)
    ds_read_b128 v[116:119], v3 offset:14336
    ds_read_b128 v[120:123], v3 offset:15360
    v_mfma_f32_16x16x32_bf16 v[20:23], v[92:95], a[40:43], v[20:23]
    ds_read_b128 v[164:167], v5 offset:35840
    v_mfma_f32_16x16x32_bf16 v[52:55], v[92:95], a[112:115], v[52:55]
    s_waitcnt lgkmcnt(9)
    ds_read_b128 v[124:127], v3 offset:16384
    v_mfma_f32_16x16x32_bf16 v[24:27], v[96:99], a[40:43], v[24:27]
    buffer_load_dwordx4 a[56:59], v2, s[4:7], s54 offen offset:2048 sc1
    v_mfma_f32_16x16x32_bf16 v[56:59], v[96:99], a[112:115], v[56:59]
    s_waitcnt lgkmcnt(9)
    ds_read_b128 v[128:131], v3 offset:17408
    v_mfma_f32_16x16x32_bf16 v[28:31], v[100:103], a[40:43], v[28:31]
    v_mfma_f32_16x16x32_bf16 v[60:63], v[100:103], a[112:115], v[60:63]
    s_waitcnt lgkmcnt(9)
    ds_read_b128 v[140:143], v3 offset:20480
    v_mfma_f32_16x16x32_bf16 v[32:35], v[112:115], a[40:43], v[32:35]
    buffer_load_dwordx4 a[128:131], v2, s[4:7], s55 offen offset:2048 sc1
    v_mfma_f32_16x16x32_bf16 v[64:67], v[112:115], a[112:115], v[64:67]
    s_waitcnt lgkmcnt(9)
    ds_read_b128 v[132:135], v3 offset:18432
    v_mfma_f32_16x16x32_bf16 v[36:39], a[40:43], v[104:107], v[36:39]
    ds_read_b128 v[136:139], v3 offset:19456
    v_mfma_f32_16x16x32_bf16 v[68:71], a[112:115], v[104:107], v[68:71]
    s_waitcnt lgkmcnt(10)
    s_add_u32 s92, s60, s70
    v_mfma_f32_16x16x32_bf16 v[40:43], a[40:43], v[108:111], v[40:43]
    buffer_store_dwordx4 v[200:203], v2, s[4:7], s92 offen sc1
    v_mfma_f32_16x16x32_bf16 v[72:75], a[112:115], v[108:111], v[72:75]
    v_mfma_f32_16x16x32_bf16 v[80:83], v[148:151], v[144:147], v[80:83]
    v_mfma_f32_16x16x32_bf16 v[84:87], v[144:147], v[152:155], v[84:87]
    s_waitcnt vmcnt(22) lgkmcnt(7)
    ds_read_b128 v[144:147], v10 offset:6144
    ds_read_b128 v[148:151], v4 offset:43008
    v_mfma_f32_16x16x32_bf16 v[16:19], v[116:119], a[44:47], v[16:19]
    s_waitcnt vmcnt(21)
    s_waitcnt vmcnt(8)
    s_barrier
    ds_read_b128 v[88:91], v3 offset:21504
    v_mfma_f32_16x16x32_bf16 v[48:51], v[116:119], a[116:119], v[48:51]
    s_waitcnt lgkmcnt(9)
    ds_read_b128 v[92:95], v3 offset:22528
    ds_read_b128 v[152:155], v5 offset:43008
    v_mfma_f32_16x16x32_bf16 v[20:23], v[120:123], a[44:47], v[20:23]
    buffer_load_dwordx4 a[60:63], v2, s[4:7], s54 offen offset:3072 sc1
    v_mfma_f32_16x16x32_bf16 v[52:55], v[120:123], a[116:119], v[52:55]
    s_waitcnt lgkmcnt(9)
    ds_read_b128 v[96:99], v3 offset:23552
    v_mfma_f32_16x16x32_bf16 v[24:27], v[124:127], a[44:47], v[24:27]
    v_mfma_f32_16x16x32_bf16 v[56:59], v[124:127], a[116:119], v[56:59]
    s_waitcnt lgkmcnt(9)
    ds_read_b128 v[100:103], v3 offset:24576
    v_mfma_f32_16x16x32_bf16 v[28:31], v[128:131], a[44:47], v[28:31]
    buffer_load_dwordx4 a[132:135], v2, s[4:7], s55 offen offset:3072 sc1
    v_mfma_f32_16x16x32_bf16 v[60:63], v[128:131], a[116:119], v[60:63]
    s_waitcnt lgkmcnt(9)
    s_add_u32 s54, s51, 16384
    ds_read_b128 v[112:115], v3 offset:27648
    v_mfma_f32_16x16x32_bf16 v[32:35], v[140:143], a[44:47], v[32:35]
    ds_read_b128 v[104:107], v3 offset:25600
    v_mfma_f32_16x16x32_bf16 v[64:67], v[140:143], a[116:119], v[64:67]
    s_waitcnt lgkmcnt(10)
    v_mfma_f32_16x16x32_bf16 v[36:39], a[44:47], v[132:135], v[36:39]
    ds_read_b128 v[108:111], v3 offset:26624
    v_mfma_f32_16x16x32_bf16 v[68:71], a[116:119], v[132:135], v[68:71]
    s_waitcnt lgkmcnt(10)
    v_mfma_f32_16x16x32_bf16 v[40:43], a[44:47], v[136:139], v[40:43]
    buffer_load_dwordx4 a[64:67], v2, s[4:7], s54 offen offset:0 sc1
    v_mfma_f32_16x16x32_bf16 v[72:75], a[116:119], v[136:139], v[72:75]
    s_add_u32 s55, s51, 34816
    v_mfma_f32_16x16x32_bf16 v[80:83], v[160:163], v[156:159], v[80:83]
    v_mfma_f32_16x16x32_bf16 v[84:87], v[156:159], v[164:167], v[84:87]
    s_waitcnt vmcnt(10) lgkmcnt(7)
    ds_read_b128 v[156:159], v10 offset:7168
    ds_read_b128 v[160:163], v4 offset:50176
    v_mfma_f32_16x16x32_bf16 v[16:19], v[88:91], a[48:51], v[16:19]
    buffer_load_dwordx4 a[136:139], v2, s[4:7], s55 offen offset:0 sc1
    s_waitcnt vmcnt(10)
    v_mfma_f32_16x16x32_bf16 v[48:51], v[88:91], a[120:123], v[48:51]
    s_waitcnt lgkmcnt(8)
    ds_read_b128 v[164:167], v5 offset:50176
    ds_read_b128 v[116:119], v3 offset:28672
    v_mfma_f32_16x16x32_bf16 v[20:23], v[92:95], a[48:51], v[20:23]
    ds_read_b128 v[120:123], v3 offset:29696
    v_mfma_f32_16x16x32_bf16 v[52:55], v[92:95], a[120:123], v[52:55]
    s_waitcnt lgkmcnt(9)
    ds_read_b128 v[124:127], v3 offset:30720
    v_mfma_f32_16x16x32_bf16 v[24:27], v[96:99], a[48:51], v[24:27]
    buffer_store_dwordx4 v[204:207], v2, s[4:7], s61 offen sc1
    v_mfma_f32_16x16x32_bf16 v[56:59], v[96:99], a[120:123], v[56:59]
    ds_read_b128 v[128:131], v3 offset:31744
    v_mfma_f32_16x16x32_bf16 v[80:83], v[148:151], v[144:147], v[80:83]
    v_mfma_f32_16x16x32_bf16 v[84:87], v[144:147], v[152:155], v[84:87]
    s_waitcnt lgkmcnt(10)
    ds_read_b128 v[140:143], v3 offset:34816
    ds_read_b128 v[144:147], v10 offset:8192
    v_mfma_f32_16x16x32_bf16 v[28:31], v[100:103], a[48:51], v[28:31]
    buffer_load_dwordx4 a[68:71], v2, s[4:7], s54 offen offset:1024 sc1
    v_mfma_f32_16x16x32_bf16 v[60:63], v[100:103], a[120:123], v[60:63]
    s_waitcnt lgkmcnt(11)
    ds_read_b128 v[132:135], v3 offset:32768
    ds_read_b128 v[148:151], v4 offset:57344
    v_mfma_f32_16x16x32_bf16 v[32:35], v[112:115], a[48:51], v[32:35]
    ds_read_b128 v[136:139], v3 offset:33792
    ds_read_b128 v[152:155], v5 offset:57344
    v_mfma_f32_16x16x32_bf16 v[64:67], v[112:115], a[120:123], v[64:67]
    s_waitcnt lgkmcnt(14)
    v_mfma_f32_16x16x32_bf16 v[36:39], a[48:51], v[104:107], v[36:39]
    buffer_load_dwordx4 a[140:143], v2, s[4:7], s55 offen offset:1024 sc1
    v_mfma_f32_16x16x32_bf16 v[68:71], a[120:123], v[104:107], v[68:71]
    s_waitcnt lgkmcnt(13)
    v_mfma_f32_16x16x32_bf16 v[40:43], a[48:51], v[108:111], v[40:43]
    v_mfma_f32_16x16x32_bf16 v[72:75], a[120:123], v[108:111], v[72:75]
    s_waitcnt lgkmcnt(11)
    v_mfma_f32_16x16x32_bf16 v[80:83], v[160:163], v[156:159], v[80:83]
    s_waitcnt lgkmcnt(10)
    v_mfma_f32_16x16x32_bf16 v[84:87], v[156:159], v[164:167], v[84:87]
    s_waitcnt vmcnt(11) lgkmcnt(9)
    v_add_u32 v4, 64512, v4
    v_add_u32 v5, 64512, v5
    v_mfma_f32_16x16x32_bf16 v[16:19], v[116:119], a[52:55], v[16:19]
    buffer_load_dwordx4 a[180:183], v238, s[12:15], 0 offen nt
    s_waitcnt vmcnt(11)
    v_mfma_f32_16x16x32_bf16 v[48:51], v[116:119], a[124:127], v[48:51]
    s_waitcnt lgkmcnt(8)
    ds_read_b128 v[156:159], v10 offset:9216
    ds_read_b128 v[160:163], v4 offset:0
    v_mfma_f32_16x16x32_bf16 v[20:23], v[120:123], a[52:55], v[20:23]
    ds_read_b128 v[164:167], v5 offset:0
    ds_read_b128 v[88:91], v3 offset:35840
    v_mfma_f32_16x16x32_bf16 v[52:55], v[120:123], a[124:127], v[52:55]
    s_waitcnt lgkmcnt(11)
    ds_read_b128 v[92:95], v3 offset:36864
    ds_read_b128 v[96:99], v3 offset:37888
    v_mfma_f32_16x16x32_bf16 v[24:27], v[124:127], a[52:55], v[24:27]
    buffer_load_dwordx4 a[184:187], v239, s[12:15], 0 offen nt
    v_mfma_f32_16x16x32_bf16 v[56:59], v[124:127], a[124:127], v[56:59]
    s_waitcnt lgkmcnt(8)
    ds_read_b128 v[100:103], v3 offset:38912
    v_mfma_f32_16x16x32_bf16 v[80:83], v[148:151], v[144:147], v[80:83]
    s_waitcnt lgkmcnt(7)
    v_mfma_f32_16x16x32_bf16 v[84:87], v[144:147], v[152:155], v[84:87]
    ds_read_b128 v[112:115], v3 offset:41984
    ds_read_b128 v[144:147], v10 offset:10240
    v_mfma_f32_16x16x32_bf16 v[28:31], v[128:131], a[52:55], v[28:31]
    buffer_load_dwordx4 a[188:191], v240, s[12:15], 0 offen nt
    v_mfma_f32_16x16x32_bf16 v[60:63], v[128:131], a[124:127], v[60:63]
    s_add_u32 s92, s61, s70
    ds_read_b128 v[104:107], v3 offset:39936
    v_mfma_f32_16x16x32_bf16 v[32:35], v[140:143], a[52:55], v[32:35]
    ds_read_b128 v[108:111], v3 offset:40960
    ds_read_b128 v[148:151], v4 offset:7168
    v_mfma_f32_16x16x32_bf16 v[64:67], v[140:143], a[124:127], v[64:67]
    ds_read_b128 v[152:155], v5 offset:7168
    v_mfma_f32_16x16x32_bf16 v[36:39], a[52:55], v[132:135], v[36:39]
    buffer_store_dwordx4 v[208:211], v2, s[4:7], s92 offen sc1
    v_mfma_f32_16x16x32_bf16 v[68:71], a[124:127], v[132:135], v[68:71]
    v_mfma_f32_16x16x32_bf16 v[40:43], a[52:55], v[136:139], v[40:43]
    v_mfma_f32_16x16x32_bf16 v[72:75], a[124:127], v[136:139], v[72:75]
    s_waitcnt lgkmcnt(11)
    v_mfma_f32_16x16x32_bf16 v[80:83], v[160:163], v[156:159], v[80:83]
    s_waitcnt lgkmcnt(10)
    v_mfma_f32_16x16x32_bf16 v[84:87], v[156:159], v[164:167], v[84:87]
    s_waitcnt vmcnt(13) lgkmcnt(9)
    ds_read_b128 v[156:159], v10 offset:11264
    ds_read_b128 v[160:163], v4 offset:14336
    v_mfma_f32_16x16x32_bf16 v[16:19], v[88:91], a[56:59], v[16:19]
    buffer_load_dwordx4 a[192:195], v241, s[12:15], 0 offen nt
    s_waitcnt vmcnt(13)
    v_mfma_f32_16x16x32_bf16 v[48:51], v[88:91], a[128:131], v[48:51]
    s_waitcnt lgkmcnt(10)
    ds_read_b128 v[164:167], v5 offset:14336
    ds_read_b128 v[116:119], v3 offset:43008
    v_mfma_f32_16x16x32_bf16 v[20:23], v[92:95], a[56:59], v[20:23]
    ds_read_b128 v[120:123], v3 offset:44032
    v_mfma_f32_16x16x32_bf16 v[52:55], v[92:95], a[128:131], v[52:55]
    s_waitcnt lgkmcnt(12)
    ds_read_b128 v[124:127], v3 offset:45056
    v_mfma_f32_16x16x32_bf16 v[24:27], v[96:99], a[56:59], v[24:27]
    buffer_load_dwordx4 a[196:199], v242, s[12:15], 0 offen nt
    v_mfma_f32_16x16x32_bf16 v[56:59], v[96:99], a[128:131], v[56:59]
    s_waitcnt lgkmcnt(7)
    ds_read_b128 v[128:131], v3 offset:46080
    v_mfma_f32_16x16x32_bf16 v[80:83], v[148:151], v[144:147], v[80:83]
    s_waitcnt lgkmcnt(7)
    v_mfma_f32_16x16x32_bf16 v[84:87], v[144:147], v[152:155], v[84:87]
    ds_read_b128 v[140:143], v3 offset:49152
    ds_read_b128 v[144:147], v10 offset:12288
    v_mfma_f32_16x16x32_bf16 v[28:31], v[100:103], a[56:59], v[28:31]
    buffer_load_dwordx4 a[200:203], v243, s[12:15], 0 offen nt
    v_mfma_f32_16x16x32_bf16 v[60:63], v[100:103], a[128:131], v[60:63]
    ds_read_b128 v[132:135], v3 offset:47104
    ds_read_b128 v[148:151], v4 offset:21504
    v_mfma_f32_16x16x32_bf16 v[32:35], v[112:115], a[56:59], v[32:35]
    ds_read_b128 v[136:139], v3 offset:48128
    ds_read_b128 v[152:155], v5 offset:21504
    v_mfma_f32_16x16x32_bf16 v[64:67], v[112:115], a[128:131], v[64:67]
    v_mfma_f32_16x16x32_bf16 v[36:39], a[56:59], v[104:107], v[36:39]
    buffer_load_dwordx4 a[204:207], v244, s[12:15], 0 offen nt
    v_mfma_f32_16x16x32_bf16 v[68:71], a[128:131], v[104:107], v[68:71]
    v_mfma_f32_16x16x32_bf16 v[40:43], a[56:59], v[108:111], v[40:43]
    v_mfma_f32_16x16x32_bf16 v[72:75], a[128:131], v[108:111], v[72:75]
    s_waitcnt lgkmcnt(11)
    v_mfma_f32_16x16x32_bf16 v[80:83], v[160:163], v[156:159], v[80:83]
    s_waitcnt lgkmcnt(10)
    v_mfma_f32_16x16x32_bf16 v[84:87], v[156:159], v[164:167], v[84:87]
    s_waitcnt vmcnt(14) lgkmcnt(9)
    ds_read_b128 v[156:159], v10 offset:13312
    ds_read_b128 v[160:163], v4 offset:28672
    v_mfma_f32_16x16x32_bf16 v[16:19], v[116:119], a[60:63], v[16:19]
    buffer_store_dwordx4 v[212:215], v2, s[4:7], s69 offen sc1
    s_waitcnt vmcnt(14)
    v_mfma_f32_16x16x32_bf16 v[48:51], v[116:119], a[132:135], v[48:51]
    s_waitcnt lgkmcnt(10)
    ds_read_b128 v[164:167], v5 offset:28672
    ds_read_b128 v[88:91], v3 offset:50176
    v_mfma_f32_16x16x32_bf16 v[20:23], v[120:123], a[60:63], v[20:23]
    ds_read_b128 v[92:95], v3 offset:51200
    v_mfma_f32_16x16x32_bf16 v[52:55], v[120:123], a[132:135], v[52:55]
    s_waitcnt lgkmcnt(12)
    ds_read_b128 v[96:99], v3 offset:52224
    v_mfma_f32_16x16x32_bf16 v[24:27], v[124:127], a[60:63], v[24:27]
    buffer_load_dwordx4 a[208:211], v245, s[12:15], 0 offen nt
    v_mfma_f32_16x16x32_bf16 v[56:59], v[124:127], a[132:135], v[56:59]
    s_waitcnt lgkmcnt(8)
    ds_read_b128 v[100:103], v3 offset:53248
    v_mfma_f32_16x16x32_bf16 v[80:83], v[148:151], v[144:147], v[80:83]
    s_waitcnt lgkmcnt(7)
    v_mfma_f32_16x16x32_bf16 v[84:87], v[144:147], v[152:155], v[84:87]
    ds_read_b128 v[112:115], v3 offset:56320
    ds_read_b128 v[144:147], v10 offset:14336
    v_mfma_f32_16x16x32_bf16 v[28:31], v[128:131], a[60:63], v[28:31]
    buffer_load_dwordx4 a[212:215], v246, s[12:15], 0 offen nt
    v_mfma_f32_16x16x32_bf16 v[60:63], v[128:131], a[132:135], v[60:63]
    ds_read_b128 v[104:107], v3 offset:54272
    ds_read_b128 v[148:151], v4 offset:35840
    v_mfma_f32_16x16x32_bf16 v[32:35], v[140:143], a[60:63], v[32:35]
    ds_read_b128 v[108:111], v3 offset:55296
    ds_read_b128 v[152:155], v5 offset:35840
    v_mfma_f32_16x16x32_bf16 v[64:67], v[140:143], a[132:135], v[64:67]
    v_mfma_f32_16x16x32_bf16 v[36:39], a[60:63], v[132:135], v[36:39]
    buffer_load_dwordx4 a[216:219], v247, s[8:11], 0 offen nt
    v_mfma_f32_16x16x32_bf16 v[68:71], a[132:135], v[132:135], v[68:71]
    v_mfma_f32_16x16x32_bf16 v[40:43], a[60:63], v[136:139], v[40:43]
    v_mfma_f32_16x16x32_bf16 v[72:75], a[132:135], v[136:139], v[72:75]
    s_waitcnt lgkmcnt(11)
    v_mfma_f32_16x16x32_bf16 v[80:83], v[160:163], v[156:159], v[80:83]
    s_waitcnt lgkmcnt(10)
    v_mfma_f32_16x16x32_bf16 v[84:87], v[156:159], v[164:167], v[84:87]
    s_waitcnt vmcnt(16) lgkmcnt(9)
    ds_read_b128 v[156:159], v10 offset:15360
    ds_read_b128 v[160:163], v4 offset:43008
    v_mfma_f32_16x16x32_bf16 v[16:19], v[88:91], a[64:67], v[16:19]
    buffer_load_dwordx4 a[220:223], v248, s[8:11], 0 offen nt
    s_waitcnt vmcnt(16)
    v_mfma_f32_16x16x32_bf16 v[48:51], v[88:91], a[136:139], v[48:51]
    s_waitcnt lgkmcnt(10)
    ds_read_b128 v[164:167], v5 offset:43008
    ds_read_b128 v[116:119], v3 offset:57344
    v_mfma_f32_16x16x32_bf16 v[20:23], v[92:95], a[64:67], v[20:23]
    ds_read_b128 v[120:123], v3 offset:58368
    v_mfma_f32_16x16x32_bf16 v[52:55], v[92:95], a[136:139], v[52:55]
    s_waitcnt lgkmcnt(12)
    ds_read_b128 v[124:127], v3 offset:59392
    v_mfma_f32_16x16x32_bf16 v[24:27], v[96:99], a[64:67], v[24:27]
    buffer_load_dwordx4 a[224:227], v249, s[8:11], 0 offen nt
    v_mfma_f32_16x16x32_bf16 v[56:59], v[96:99], a[136:139], v[56:59]
    s_waitcnt lgkmcnt(8)
    ds_read_b128 v[128:131], v3 offset:60416
    v_mfma_f32_16x16x32_bf16 v[80:83], v[148:151], v[144:147], v[80:83]
    s_waitcnt lgkmcnt(7)
    v_mfma_f32_16x16x32_bf16 v[84:87], v[144:147], v[152:155], v[84:87]
    ds_read_b128 v[140:143], v3 offset:63488
    ds_read_b128 v[144:147], v10 offset:16384
    v_mfma_f32_16x16x32_bf16 v[28:31], v[100:103], a[64:67], v[28:31]
    buffer_load_dwordx4 a[228:231], v250, s[8:11], 0 offen nt
    v_mfma_f32_16x16x32_bf16 v[60:63], v[100:103], a[136:139], v[60:63]
    ds_read_b128 v[132:135], v3 offset:61440
    ds_read_b128 v[148:151], v4 offset:50176
    v_mfma_f32_16x16x32_bf16 v[32:35], v[112:115], a[64:67], v[32:35]
    ds_read_b128 v[136:139], v3 offset:62464
    ds_read_b128 v[152:155], v5 offset:50176
    v_mfma_f32_16x16x32_bf16 v[64:67], v[112:115], a[136:139], v[64:67]
    v_mfma_f32_16x16x32_bf16 v[36:39], a[64:67], v[104:107], v[36:39]
    buffer_load_dwordx4 a[232:235], v251, s[8:11], 0 offen nt
    v_mfma_f32_16x16x32_bf16 v[68:71], a[136:139], v[104:107], v[68:71]
    v_mfma_f32_16x16x32_bf16 v[40:43], a[64:67], v[108:111], v[40:43]
    v_mfma_f32_16x16x32_bf16 v[72:75], a[136:139], v[108:111], v[72:75]
    s_waitcnt lgkmcnt(11)
    v_mfma_f32_16x16x32_bf16 v[80:83], v[160:163], v[156:159], v[80:83]
    s_waitcnt lgkmcnt(10)
    v_mfma_f32_16x16x32_bf16 v[84:87], v[156:159], v[164:167], v[84:87]
    s_waitcnt vmcnt(17) lgkmcnt(9)
    ds_read_b128 v[156:159], v10 offset:17408
    ds_read_b128 v[160:163], v4 offset:57344
    v_mfma_f32_16x16x32_bf16 v[16:19], v[116:119], a[68:71], v[16:19]
    buffer_load_dwordx4 a[236:239], v252, s[8:11], 0 offen nt
    s_waitcnt vmcnt(17)
    v_mfma_f32_16x16x32_bf16 v[48:51], v[116:119], a[140:143], v[48:51]
    s_waitcnt lgkmcnt(10)
    ds_read_b128 v[164:167], v5 offset:57344
    v_mfma_f32_16x16x32_bf16 v[20:23], v[120:123], a[68:71], v[20:23]
    v_mfma_f32_16x16x32_bf16 v[52:55], v[120:123], a[140:143], v[52:55]
    s_waitcnt lgkmcnt(10)
    v_mfma_f32_16x16x32_bf16 v[24:27], v[124:127], a[68:71], v[24:27]
    buffer_load_dwordx4 a[240:243], v253, s[8:11], 0 offen nt
    v_mfma_f32_16x16x32_bf16 v[56:59], v[124:127], a[140:143], v[56:59]
    s_waitcnt lgkmcnt(5)
    v_mfma_f32_16x16x32_bf16 v[80:83], v[148:151], v[144:147], v[80:83]
    s_waitcnt lgkmcnt(3)
    v_mfma_f32_16x16x32_bf16 v[84:87], v[144:147], v[152:155], v[84:87]
    v_mfma_f32_16x16x32_bf16 v[28:31], v[128:131], a[68:71], v[28:31]
    buffer_load_dwordx4 a[244:247], v254, s[8:11], 0 offen nt
    v_mfma_f32_16x16x32_bf16 v[60:63], v[128:131], a[140:143], v[60:63]
    v_mfma_f32_16x16x32_bf16 v[32:35], v[140:143], a[68:71], v[32:35]
    v_mfma_f32_16x16x32_bf16 v[64:67], v[140:143], a[140:143], v[64:67]
    v_mfma_f32_16x16x32_bf16 v[36:39], a[68:71], v[132:135], v[36:39]
    buffer_load_dwordx4 a[248:251], v255, s[8:11], 0 offen nt
    v_mfma_f32_16x16x32_bf16 v[68:71], a[140:143], v[132:135], v[68:71]
    v_mfma_f32_16x16x32_bf16 v[40:43], a[68:71], v[136:139], v[40:43]
    v_mfma_f32_16x16x32_bf16 v[72:75], a[140:143], v[136:139], v[72:75]
    s_waitcnt lgkmcnt(1)
    v_mfma_f32_16x16x32_bf16 v[80:83], v[160:163], v[156:159], v[80:83]
    s_waitcnt lgkmcnt(0)
    v_mfma_f32_16x16x32_bf16 v[84:87], v[156:159], v[164:167], v[84:87]
    v_lshlrev_b32 v6, 3, v1
    v_add_u32 v6, 148608, v6
    s_mul_i32 s52, s20, 3072
    v_add_u32 v7, s52, v6
    s_lshl_b32 s52, s20, 8
    s_add_u32 s52, s52, 161024
    v_lshl_add_u32 v13, v1, 3, s52
    v_lshrrev_b32 v14, 2, v1
    v_lshl_add_u32 v14, v14, 3, s52
    v_cvt_pk_bf16_f32 v100, v56, v57
    v_cvt_pk_bf16_f32 v101, v58, v59
    v_cvt_pk_bf16_f32 v104, v60, v61
    v_cvt_pk_bf16_f32 v105, v62, v63
    v_cvt_pk_bf16_f32 v134, v64, v65
    v_cvt_pk_bf16_f32 v137, v66, v67
    v_mov_b32 v102, 0
    v_mov_b32 v103, 0
    v_cvt_pk_bf16_f32 v110, v68, v69
    v_cvt_pk_bf16_f32 v111, v70, v71
    v_cvt_pk_bf16_f32 v116, v72, v73
    v_cvt_pk_bf16_f32 v117, v74, v75
    s_mov_b32 exec_lo, 0xffff0000
    s_mov_b32 exec_hi, 0
    ds_write2_b32 v13, v134, v137 offset0:64 offset1:65
    s_mov_b64 exec, -1
    v_permlane32_swap_b32 v134, v102
    v_permlane32_swap_b32 v137, v103
    s_cmp_eq_u32 s20, 3
    s_cbranch_scc1 L_w3_47
    ds_write_b64 v7, v[100:101] offset:3072
    ds_write_b64 v7, v[102:103] offset:3584
    ds_write_b64 v7, v[104:105] offset:4096
    ds_write_b64 v7, v[110:111] offset:4608
    ds_write_b64 v7, v[116:117] offset:5120
L_w3_47:
    v_cvt_pk_bf16_f32 v140, v80, v81
    v_cvt_pk_bf16_f32 v141, v82, v83
    v_cvt_pk_bf16_f32 v142, v84, v85
    v_cvt_pk_bf16_f32 v143, v86, v87
    s_min_u32 s52, s20, 2
    s_lshl_b32 s53, s52, 1
    s_cmp_ge_u32 s20, 2
    s_cselect_b32 s53, 1, s53
    s_lshl_b32 s53, s53, 9
    s_and_b32 s52, s20, 1
    s_add_u32 s52, s52, 3
    s_lshl_b32 s52, s52, 9
    v_add_u32 v8, s53, v6
    v_add_u32 v9, s52, v6
    s_cmp_lt_u32 s20, 2
    s_cbranch_scc1 L_noswap_48
    v_lshlrev_b32 v10, 3, v1
    v_add_u32 v10, 161024, v10
    s_mov_b32 exec_lo, 0xffff0000
    s_mov_b32 exec_hi, 0
    ds_write_b64 v10, v[140:141]
    s_mov_b64 exec, -1
    v_mov_b32 v10, 0
    v_mov_b32 v11, 0
    s_nop 1
    v_permlane32_swap_b32 v140, v10
    v_permlane32_swap_b32 v141, v11
    v_mov_b32 v140, v10
    v_mov_b32 v141, v11
L_noswap_48:
    ds_write_b64 v8, v[140:141]
    ds_write_b64 v9, v[142:143]
    v_cvt_pk_bf16_f32 v132, v48, v49
    v_cvt_pk_bf16_f32 v133, v50, v51
    v_cvt_pk_bf16_f32 v138, v52, v53
    v_cvt_pk_bf16_f32 v139, v54, v55
    v_mov_b32 v135, 0
    v_mov_b32 v136, 0
    v_cvt_pk_bf16_f32 v94, v24, v25
    v_cvt_pk_bf16_f32 v95, v26, v27
    v_cvt_pk_bf16_f32 v98, v28, v29
    v_cvt_pk_bf16_f32 v99, v30, v31
    v_cvt_pk_bf16_f32 v126, v32, v33
    v_cvt_pk_bf16_f32 v129, v34, v35
    v_mov_b32 v96, 0
    v_mov_b32 v97, 0
    v_cvt_pk_bf16_f32 v108, v36, v37
    v_cvt_pk_bf16_f32 v109, v38, v39
    v_cvt_pk_bf16_f32 v114, v40, v41
    v_cvt_pk_bf16_f32 v115, v42, v43
    s_mov_b32 exec_lo, 0xffff0000
    s_mov_b32 exec_hi, 0
    ds_write2_b32 v13, v126, v129 offset0:32 offset1:33
    s_mov_b64 exec, -1
    v_permlane32_swap_b32 v126, v96
    v_permlane32_swap_b32 v129, v97
    v_cvt_pk_bf16_f32 v124, v16, v17
    v_cvt_pk_bf16_f32 v125, v18, v19
    v_cvt_pk_bf16_f32 v130, v20, v21
    v_cvt_pk_bf16_f32 v131, v22, v23
    v_mov_b32 v127, 0
    v_mov_b32 v128, 0
    v_mov_b32 v144, 0x3f803f80
    v_mov_b32 v145, 0x3f803f80
    v_mov_b32 v146, 0x3f803f80
    v_mov_b32 v147, 0x3f803f80
    v_mfma_f32_16x16x32_bf16 v[32:35], v[94:97], v[132:135], v[172:175]
    v_mfma_f32_16x16x32_bf16 v[36:39], v[100:103], v[132:135], v[168:171]
    v_mfma_f32_16x16x32_bf16 v[20:23], v[94:97], v[124:127], v[168:171]
    v_mfma_f32_16x16x32_bf16 v[40:43], v[96:99], v[136:139], v[172:175]
    v_mfma_f32_16x16x32_bf16 v[44:47], v[102:105], v[136:139], v[168:171]
    v_mfma_f32_16x16x32_bf16 v[28:31], v[96:99], v[128:131], v[168:171]
    s_waitcnt lgkmcnt(0)
    s_barrier
    ds_read_b64 v[88:89], v7 offset:0
    ds_read_b64 v[90:91], v7 offset:512
    ds_read_b64 v[92:93], v7 offset:1024
    ds_read_b64 v[106:107], v7 offset:1536
    ds_read_b64 v[112:113], v7 offset:2048
    ds_read_b64_tr_b16 v[118:119], v14 offset:128
    ds_read_b64_tr_b16 v[120:121], v14 offset:256
    ds_read_b64_tr_b16 v[122:123], v14 offset:384
    s_mov_b32 s52, 0x3eae1a93
    s_waitcnt lgkmcnt(6)
    v_mfma_f32_16x16x32_bf16 v[16:19], v[88:91], v[124:127], v[176:179]
    s_waitcnt lgkmcnt(5)
    v_mfma_f32_16x16x32_bf16 v[24:27], v[90:93], v[128:131], v[176:179]
    v_max3_f32 v48, v32, v33, v34
    v_max3_f32 v49, v40, v41, v42
    s_nop 3
    v_max3_f32 v50, v16, v17, v18
    s_nop 0
    v_max3_f32 v51, v24, v25, v26
    v_max3_f32 v48, v48, v35, v36
    v_max3_f32 v49, v49, v43, v44
    v_max3_f32 v50, v50, v19, v20
    v_max3_f32 v51, v51, v27, v28
    v_max3_f32 v48, v48, v37, v38
    v_max3_f32 v49, v49, v45, v46
    v_max3_f32 v50, v50, v21, v22
    v_max3_f32 v51, v51, v29, v30
    v_max_f32 v48, v48, v39
    v_max_f32 v49, v49, v47
    v_max_f32 v50, v50, v23
    v_max_f32 v51, v51, v31
    v_mov_b32 v52, v48
    v_mov_b32 v53, v49
    v_mov_b32 v54, v50
    v_mov_b32 v55, v51
    v_permlane16_swap_b32 v48, v52
    v_permlane16_swap_b32 v49, v53
    v_permlane16_swap_b32 v50, v54
    v_permlane16_swap_b32 v51, v55
    v_max_f32 v48, v48, v52
    v_max_f32 v49, v49, v53
    v_max_f32 v50, v50, v54
    v_max_f32 v51, v51, v55
    v_mov_b32 v52, v48
    v_mov_b32 v53, v49
    v_mov_b32 v54, v50
    v_mov_b32 v55, v51
    v_permlane32_swap_b32 v48, v52
    v_permlane32_swap_b32 v49, v53
    v_permlane32_swap_b32 v50, v54
    v_permlane32_swap_b32 v51, v55
    v_max_f32 v48, v48, v52
    v_max_f32 v49, v49, v53
    v_max_f32 v50, v50, v54
    v_max_f32 v51, v51, v55
    v_mul_f32 v48, s52, v48
    v_mul_f32 v49, s52, v49
    v_mul_f32 v50, s52, v50
    v_mul_f32 v51, s52, v51
    v_fma_f32 v32, v32, s52, -v48
    v_fma_f32 v40, v40, s52, -v49
    v_fma_f32 v16, v16, s52, -v50
    v_fma_f32 v24, v24, s52, -v51
    v_fma_f32 v33, v33, s52, -v48
    v_fma_f32 v41, v41, s52, -v49
    v_fma_f32 v17, v17, s52, -v50
    v_fma_f32 v25, v25, s52, -v51
    v_fma_f32 v34, v34, s52, -v48
    v_fma_f32 v42, v42, s52, -v49
    v_fma_f32 v18, v18, s52, -v50
    v_fma_f32 v26, v26, s52, -v51
    v_fma_f32 v35, v35, s52, -v48
    v_fma_f32 v43, v43, s52, -v49
    v_fma_f32 v19, v19, s52, -v50
    v_fma_f32 v27, v27, s52, -v51
    v_fma_f32 v36, v36, s52, -v48
    v_fma_f32 v44, v44, s52, -v49
    v_fma_f32 v20, v20, s52, -v50
    v_fma_f32 v28, v28, s52, -v51
    v_fma_f32 v37, v37, s52, -v48
    v_fma_f32 v45, v45, s52, -v49
    v_fma_f32 v21, v21, s52, -v50
    v_fma_f32 v29, v29, s52, -v51
    v_fma_f32 v38, v38, s52, -v48
    v_fma_f32 v46, v46, s52, -v49
    v_fma_f32 v22, v22, s52, -v50
    v_fma_f32 v30, v30, s52, -v51
    v_fma_f32 v39, v39, s52, -v48
    v_fma_f32 v47, v47, s52, -v49
    v_fma_f32 v23, v23, s52, -v50
    v_fma_f32 v31, v31, s52, -v51
    v_exp_f32 v32, v32
    v_exp_f32 v40, v40
    v_exp_f32 v16, v16
    v_exp_f32 v24, v24
    v_exp_f32 v33, v33
    v_exp_f32 v41, v41
    v_exp_f32 v17, v17
    v_exp_f32 v25, v25
    v_exp_f32 v34, v34
    v_exp_f32 v42, v42
    v_exp_f32 v18, v18
    v_exp_f32 v26, v26
    v_exp_f32 v35, v35
    v_exp_f32 v43, v43
    v_exp_f32 v19, v19
    v_exp_f32 v27, v27
    v_exp_f32 v36, v36
    v_exp_f32 v44, v44
    v_exp_f32 v20, v20
    v_exp_f32 v28, v28
    v_exp_f32 v37, v37
    v_exp_f32 v45, v45
    v_exp_f32 v21, v21
    v_exp_f32 v29, v29
    v_exp_f32 v38, v38
    v_exp_f32 v46, v46
    v_exp_f32 v22, v22
    v_exp_f32 v30, v30
    v_exp_f32 v39, v39
    v_exp_f32 v47, v47
    v_exp_f32 v23, v23
    v_exp_f32 v31, v31
    v_cvt_pk_bf16_f32 v56, v32, v33
    v_cvt_pk_bf16_f32 v60, v40, v41
    v_cvt_pk_bf16_f32 v64, v16, v17
    v_cvt_pk_bf16_f32 v68, v24, v25
    v_cvt_pk_bf16_f32 v57, v34, v35
    v_cvt_pk_bf16_f32 v61, v42, v43
    v_cvt_pk_bf16_f32 v65, v18, v19
    v_cvt_pk_bf16_f32 v69, v26, v27
    v_cvt_pk_bf16_f32 v58, v36, v37
    v_cvt_pk_bf16_f32 v62, v44, v45
    v_cvt_pk_bf16_f32 v66, v20, v21
    v_cvt_pk_bf16_f32 v70, v28, v29
    v_cvt_pk_bf16_f32 v59, v38, v39
    v_cvt_pk_bf16_f32 v63, v46, v47
    v_cvt_pk_bf16_f32 v67, v22, v23
    v_cvt_pk_bf16_f32 v71, v30, v31
    v_mfma_f32_16x16x32_bf16 v[188:191], v[144:147], v[56:59], 0
    v_mfma_f32_16x16x32_bf16 v[180:183], v[108:111], v[56:59], 0
    s_waitcnt lgkmcnt(0)
    v_mfma_f32_16x16x32_bf16 v[184:187], v[120:123], v[56:59], 0
    v_mfma_f32_16x16x32_bf16 v[200:203], v[144:147], v[60:63], 0
    v_mfma_f32_16x16x32_bf16 v[192:195], v[114:117], v[60:63], 0
    v_mfma_f32_16x16x32_bf16 v[196:199], v[120:123], v[60:63], 0
    v_mfma_f32_16x16x32_bf16 v[212:215], v[144:147], v[64:67], 0
    v_mfma_f32_16x16x32_bf16 v[204:207], v[106:109], v[64:67], 0
    v_mfma_f32_16x16x32_bf16 v[208:211], v[118:121], v[64:67], 0
    v_mfma_f32_16x16x32_bf16 v[224:227], v[144:147], v[68:71], 0
    v_mfma_f32_16x16x32_bf16 v[216:219], v[112:115], v[68:71], 0
    v_mfma_f32_16x16x32_bf16 v[220:223], v[118:121], v[68:71], 0
    s_lshl_b32 s53, s46, 4
    s_add_u32 s53, s53, s45
    s_lshl_b32 s54, s53, 10
    s_add_u32 s54, s54, 23330816
    s_lshl_b32 s55, s53, 7
    s_add_u32 s55, s55, 25427840
    v_lshlrev_b32 v6, 3, v1
    v_rcp_f32 v188, v188
    v_rcp_f32 v200, v200
    v_rcp_f32 v212, v212
    v_rcp_f32 v224, v224
    v_mul_f32 v180, v180, v188
    v_mul_f32 v181, v181, v188
    v_mul_f32 v182, v182, v188
    v_mul_f32 v183, v183, v188
    v_mul_f32 v184, v184, v188
    v_mul_f32 v185, v185, v188
    v_cvt_pk_bf16_f32 v76, v180, v181
    v_cvt_pk_bf16_f32 v77, v182, v183
    v_cvt_pk_bf16_f32 v82, v184, v185
    v_mul_f32 v192, v192, v200
    v_mul_f32 v193, v193, v200
    v_mul_f32 v194, v194, v200
    v_mul_f32 v195, v195, v200
    v_mul_f32 v198, v198, v200
    v_mul_f32 v199, v199, v200
    v_cvt_pk_bf16_f32 v78, v192, v193
    v_cvt_pk_bf16_f32 v79, v194, v195
    v_cvt_pk_bf16_f32 v83, v198, v199
    s_add_u32 s53, s54, 16384
    buffer_store_dwordx4 v[76:79], v2, s[4:7], s53 offen sc1
    v_mul_f32 v204, v204, v212
    v_mul_f32 v205, v205, v212
    v_mul_f32 v206, v206, v212
    v_mul_f32 v207, v207, v212
    v_mul_f32 v208, v208, v212
    v_mul_f32 v209, v209, v212
    v_cvt_pk_bf16_f32 v72, v204, v205
    v_cvt_pk_bf16_f32 v73, v206, v207
    v_cvt_pk_bf16_f32 v80, v208, v209
    v_mul_f32 v216, v216, v224
    v_mul_f32 v217, v217, v224
    v_mul_f32 v218, v218, v224
    v_mul_f32 v219, v219, v224
    v_mul_f32 v222, v222, v224
    v_mul_f32 v223, v223, v224
    v_cvt_pk_bf16_f32 v74, v216, v217
    v_cvt_pk_bf16_f32 v75, v218, v219
    v_cvt_pk_bf16_f32 v81, v222, v223
    s_add_u32 s53, s54, 0
    buffer_store_dwordx4 v[72:75], v2, s[4:7], s53 offen sc1
    s_mov_b32 exec_lo, 0xffff0000
    s_mov_b32 exec_hi, 0
    buffer_store_dwordx2 v[80:81], v6, s[4:7], s55 offen offset:0 sc1
    buffer_store_dwordx2 v[82:83], v6, s[4:7], s55 offen offset:2048 sc1
    s_mov_b64 exec, -1
    s_lshl_b32 s52, s44, 2
    s_add_u32 s52, s52, s20
    s_lshl_b32 s52, s52, 4
    s_add_u32 s52, s52, s45
    s_lshl_b32 s52, s52, 3
    s_add_u32 s52, s52, 16384
    s_mul_i32 s53, s22, 10923
    s_lshr_b32 s53, s53, 16
    s_mul_i32 s53, s53, 6
    s_sub_u32 s53, s22, s53
    s_lshl_b32 s53, s53, 8
    s_add_u32 s23, s53, 135168
    v_min_u32 v13, 17, v1
    v_lshlrev_b32 v13, 3, v13
    s_lshl_b32 s23, s23, 2
    s_add_u32 s23, s23, 0x8000000
    v_lshlrev_b32 v13, 2, v13
    buffer_load_dwordx2 v[14:15], v13, s[4:7], s23 offen sc1
    v_mov_b32 v8, s98
    v_mov_b32 v9, s99
    s_waitcnt vmcnt(1)
    s_lshl_b32 s52, s52, 2
    s_add_u32 s52, s52, 0x8000000
    s_mov_b64 exec, 1
    buffer_store_dwordx2 v[8:9], off, s[4:7], s52 sc1
    s_mov_b64 exec, -1
    s_lshl_b32 s0, s0, 2
    s_add_u32 s0, s0, 0x8000000
    s_mov_b64 exec, 1
    buffer_store_dwordx2 v[8:9], off, s[4:7], s0 sc1
    s_mov_b64 exec, -1
    s_cmp_ge_u32 s22, 24
    s_cbranch_scc1 L_idle0_49
    s_mul_i32 s44, s22, 10923
    s_lshr_b32 s44, s44, 16
    s_mul_i32 s52, s44, 6
    s_sub_u32 s45, s22, s52
    s_lshl_b32 s52, s21, 2
    s_add_u32 s44, s44, s52
    s_lshl_b32 s46, s44, 2
    s_add_u32 s46, s46, s20
    s_mul_i32 s47, s45, 110592
    s_mul_i32 s48, s20, 3072
    s_add_u32 s47, s47, s48
    s_add_u32 s47, s47, 2097152
    s_lshl_b32 s49, s46, 14
    s_add_u32 s49, s49, 23330816
    s_lshl_b32 s50, s46, 11
    s_add_u32 s50, s50, 25427968
    v_and_b32 v3, 15, v1
    v_lshrrev_b32 v4, 4, v1
    v_lshlrev_b32 v5, 3, v3
    v_lshl_add_u32 v5, v4, 8, v5
    s_lshl_b32 s52, s46, 4
    v_add_u32 v6, s52, v3
    v_lshlrev_b32 v7, 3, v6
    v_mul_u32_u24 v6, 1152, v6
    v_lshl_add_u32 v6, v4, 4, v6
    s_mul_i32 s51, s45, 192
    s_mov_b32 s8, s24
    s_mov_b32 s9, s25
    s_mov_b32 s10, 0x240000
    s_mov_b32 s11, 0x20000
    s_waitcnt vmcnt(2)
    v_cmp_eq_u64 vcc, s[98:99], v[14:15]
    s_nop 0
    s_cmp_eq_u64 vcc, exec
    s_cbranch_scc0 L_pwo_slow_35
L_pwo_back_36:
    s_mov_b32 m0, s48
    s_nop 0
    buffer_load_dwordx4 v2, s[4:7], s47 offen offset:0 lds
    buffer_load_dwordx4 v2, s[4:7], s47 offen offset:1024 lds
    buffer_load_dwordx4 v2, s[4:7], s47 offen offset:2048 lds
    s_add_u32 s48, s48, 12288
    s_add_u32 s47, s47, 12288
    s_mov_b32 m0, s48
    s_nop 0
    buffer_load_dwordx4 v2, s[4:7], s47 offen offset:0 lds
    buffer_load_dwordx4 v2, s[4:7], s47 offen offset:1024 lds
    buffer_load_dwordx4 v2, s[4:7], s47 offen offset:2048 lds
    s_add_u32 s48, s48, 12288
    s_add_u32 s47, s47, 12288
    s_mov_b32 m0, s48
    s_nop 0
    buffer_load_dwordx4 v2, s[4:7], s47 offen offset:0 lds
    buffer_load_dwordx4 v2, s[4:7], s47 offen offset:1024 lds
    buffer_load_dwordx4 v2, s[4:7], s47 offen offset:2048 lds
    s_add_u32 s48, s48, 12288
    s_add_u32 s47, s47, 12288
    s_mov_b32 m0, s48
    s_nop 0
    buffer_load_dwordx4 v2, s[4:7], s47 offen offset:0 lds
    buffer_load_dwordx4 v2, s[4:7], s47 offen offset:1024 lds
    buffer_load_dwordx4 v2, s[4:7], s47 offen offset:2048 lds
    s_add_u32 s48, s48, 12288
    s_add_u32 s47, s47, 12288
    s_mov_b32 m0, s48
    s_nop 0
    buffer_load_dwordx4 v2, s[4:7], s47 offen offset:0 lds
    buffer_load_dwordx4 v2, s[4:7], s47 offen offset:1024 lds
    buffer_load_dwordx4 v2, s[4:7], s47 offen offset:2048 lds
    s_add_u32 s48, s48, 12288
    s_add_u32 s47, s47, 12288
    s_mov_b32 m0, s48
    s_nop 0
    buffer_load_dwordx4 v2, s[4:7], s47 offen offset:0 lds
    buffer_load_dwordx4 v2, s[4:7], s47 offen offset:1024 lds
    buffer_load_dwordx4 v2, s[4:7], s47 offen offset:2048 lds
    s_add_u32 s48, s48, 12288
    s_add_u32 s47, s47, 12288
    s_mov_b32 m0, s48
    s_nop 0
    buffer_load_dwordx4 v2, s[4:7], s47 offen offset:0 lds
    buffer_load_dwordx4 v2, s[4:7], s47 offen offset:1024 lds
    buffer_load_dwordx4 v2, s[4:7], s47 offen offset:2048 lds
    s_add_u32 s48, s48, 12288
    s_add_u32 s47, s47, 12288
    s_mov_b32 m0, s48
    s_nop 0
    buffer_load_dwordx4 v2, s[4:7], s47 offen offset:0 lds
    buffer_load_dwordx4 v2, s[4:7], s47 offen offset:1024 lds
    buffer_load_dwordx4 v2, s[4:7], s47 offen offset:2048 lds
    s_add_u32 s48, s48, 12288
    s_add_u32 s47, s47, 12288
    s_mov_b32 m0, s48
    s_nop 0
    buffer_load_dwordx4 v2, s[4:7], s47 offen offset:0 lds
    buffer_load_dwordx4 v2, s[4:7], s47 offen offset:1024 lds
    buffer_load_dwordx4 v2, s[4:7], s47 offen offset:2048 lds
    s_add_u32 s48, s48, 12288
    s_add_u32 s47, s47, 12288
    s_lshr_b32 s52, s46, 1
    s_lshl_b32 s52, s52, 7
    s_add_u32 s52, s52, 16384
    v_and_b32 v10, 15, v1
    v_lshlrev_b32 v10, 3, v10
    s_mul_i32 s53, s45, 2816
    s_min_u32 s53, s53, 13568
    s_add_u32 s53, s53, s49
    buffer_load_dwordx4 v[160:163], v6, s[8:11], s51 offen offset:0
    buffer_load_dwordx4 v[164:167], v6, s[8:11], s51 offen offset:64
    buffer_load_dwordx4 v[168:171], v6, s[8:11], s51 offen offset:128
    v_mov_b32 v8, v2
    s_waitcnt vmcnt(3)
    s_barrier
    s_lshl_b32 s52, s52, 2
    s_add_u32 s52, s52, 0x8000000
    v_lshlrev_b32 v10, 2, v10
    buffer_load_dwordx2 v[12:13], v10, s[4:7], s52 offen sc1
    ds_read_b128 a[0:3], v8 offset:0
    ds_read_b128 a[4:7], v8 offset:1024
    ds_read_b128 a[8:11], v8 offset:2048
    ds_read_b128 a[12:15], v8 offset:3072
    ds_read_b128 a[16:19], v8 offset:4096
    ds_read_b128 a[20:23], v8 offset:5120
    ds_read_b128 a[24:27], v8 offset:6144
    ds_read_b128 a[28:31], v8 offset:7168
    ds_read_b128 a[32:35], v8 offset:8192
    ds_read_b128 a[36:39], v8 offset:9216
    ds_read_b128 a[40:43], v8 offset:10240
    ds_read_b128 a[44:47], v8 offset:11264
    ds_read_b128 a[48:51], v8 offset:12288
    ds_read_b128 a[52:55], v8 offset:13312
    ds_read_b128 a[56:59], v8 offset:14336
    ds_read_b128 a[60:63], v8 offset:15360
    ds_read_b128 a[64:67], v8 offset:16384
    ds_read_b128 a[68:71], v8 offset:17408
    ds_read_b128 a[72:75], v8 offset:18432
    ds_read_b128 a[76:79], v8 offset:19456
    ds_read_b128 a[80:83], v8 offset:20480
    ds_read_b128 a[84:87], v8 offset:21504
    ds_read_b128 a[88:91], v8 offset:22528
    ds_read_b128 a[92:95], v8 offset:23552
    ds_read_b128 v[112:115], v8 offset:24576
    ds_read_b128 v[116:119], v8 offset:25600
    ds_read_b128 v[120:123], v8 offset:26624
    ds_read_b128 v[124:127], v8 offset:27648
    ds_read_b128 v[128:131], v8 offset:28672
    ds_read_b128 v[132:135], v8 offset:29696
    ds_read_b128 v[136:139], v8 offset:30720
    ds_read_b128 v[140:143], v8 offset:31744
    ds_read_b128 v[144:147], v8 offset:32768
    ds_read_b128 v[148:151], v8 offset:33792
    s_waitcnt vmcnt(0)
    v_cmp_eq_u64 vcc, s[98:99], v[12:13]
    s_nop 0
    s_cmp_eq_u64 vcc, exec
    s_cbranch_scc0 L_po_slow_56
L_po_back_57:
    buffer_load_dwordx4 v[16:19], v2, s[4:7], s49 offen offset:0 sc1
    buffer_load_dwordx4 v[20:23], v2, s[4:7], s49 offen offset:1024 sc1
    buffer_load_dwordx4 v[24:27], v2, s[4:7], s49 offen offset:2048 sc1
    buffer_load_dwordx4 v[28:31], v2, s[4:7], s49 offen offset:3072 sc1
    s_add_u32 s49, s49, 4096
    buffer_load_dwordx4 v[32:35], v2, s[4:7], s49 offen offset:0 sc1
    buffer_load_dwordx4 v[36:39], v2, s[4:7], s49 offen offset:1024 sc1
    buffer_load_dwordx4 v[40:43], v2, s[4:7], s49 offen offset:2048 sc1
    buffer_load_dwordx4 v[44:47], v2, s[4:7], s49 offen offset:3072 sc1
    s_waitcnt vmcnt(7) lgkmcnt(15)
    s_add_u32 s49, s49, 4096
    v_mfma_f32_16x16x32_bf16 v[88:91], a[0:3], v[16:19], 0
    buffer_load_dwordx4 v[48:51], v2, s[4:7], s49 offen offset:0 sc1
    s_waitcnt lgkmcnt(15)
    v_mfma_f32_16x16x32_bf16 v[92:95], a[4:7], v[16:19], 0
    s_waitcnt lgkmcnt(15)
    v_mfma_f32_16x16x32_bf16 v[96:99], a[8:11], v[16:19], 0
    s_waitcnt lgkmcnt(15)
    v_mfma_f32_16x16x32_bf16 v[100:103], a[12:15], v[16:19], 0
    buffer_load_dwordx4 v[52:55], v2, s[4:7], s49 offen offset:1024 sc1
    s_waitcnt lgkmcnt(15)
    v_mfma_f32_16x16x32_bf16 v[104:107], a[16:19], v[16:19], 0
    s_waitcnt lgkmcnt(15)
    v_mfma_f32_16x16x32_bf16 v[108:111], a[20:23], v[16:19], 0
    s_waitcnt vmcnt(8) lgkmcnt(15)
    v_mfma_f32_16x16x32_bf16 v[88:91], a[24:27], v[20:23], v[88:91]
    buffer_load_dwordx4 v[56:59], v2, s[4:7], s49 offen offset:2048 sc1
    s_waitcnt lgkmcnt(15)
    v_mfma_f32_16x16x32_bf16 v[92:95], a[28:31], v[20:23], v[92:95]
    s_waitcnt lgkmcnt(15)
    v_mfma_f32_16x16x32_bf16 v[96:99], a[32:35], v[20:23], v[96:99]
    s_waitcnt lgkmcnt(15)
    v_mfma_f32_16x16x32_bf16 v[100:103], a[36:39], v[20:23], v[100:103]
    buffer_load_dwordx4 v[60:63], v2, s[4:7], s49 offen offset:3072 sc1
    s_waitcnt lgkmcnt(15)
    v_mfma_f32_16x16x32_bf16 v[104:107], a[40:43], v[20:23], v[104:107]
    s_waitcnt lgkmcnt(15)
    s_add_u32 s49, s49, 4096
    v_mfma_f32_16x16x32_bf16 v[108:111], a[44:47], v[20:23], v[108:111]
    s_waitcnt vmcnt(9) lgkmcnt(15)
    v_mfma_f32_16x16x32_bf16 v[88:91], a[48:51], v[24:27], v[88:91]
    buffer_load_dwordx4 v[64:67], v2, s[4:7], s49 offen offset:0 sc1
    s_waitcnt lgkmcnt(15)
    v_mfma_f32_16x16x32_bf16 v[92:95], a[52:55], v[24:27], v[92:95]
    s_waitcnt lgkmcnt(15)
    v_mfma_f32_16x16x32_bf16 v[96:99], a[56:59], v[24:27], v[96:99]
    s_waitcnt lgkmcnt(15)
    v_mfma_f32_16x16x32_bf16 v[100:103], a[60:63], v[24:27], v[100:103]
    buffer_load_dwordx4 v[68:71], v2, s[4:7], s49 offen offset:1024 sc1
    s_waitcnt lgkmcnt(15)
    v_mfma_f32_16x16x32_bf16 v[104:107], a[64:67], v[24:27], v[104:107]
    s_waitcnt lgkmcnt(15)
    v_mfma_f32_16x16x32_bf16 v[108:111], a[68:71], v[24:27], v[108:111]
    s_waitcnt vmcnt(10) lgkmcnt(15)
    v_mfma_f32_16x16x32_bf16 v[88:91], a[72:75], v[28:31], v[88:91]
    buffer_load_dwordx4 v[72:75], v2, s[4:7], s49 offen offset:2048 sc1
    s_waitcnt lgkmcnt(14)
    v_mfma_f32_16x16x32_bf16 v[92:95], a[76:79], v[28:31], v[92:95]
    s_waitcnt lgkmcnt(13)
    v_mfma_f32_16x16x32_bf16 v[96:99], a[80:83], v[28:31], v[96:99]
    s_waitcnt lgkmcnt(12)
    v_mfma_f32_16x16x32_bf16 v[100:103], a[84:87], v[28:31], v[100:103]
    buffer_load_dwordx4 v[76:79], v2, s[4:7], s49 offen offset:3072 sc1
    s_waitcnt lgkmcnt(11)
    v_mfma_f32_16x16x32_bf16 v[104:107], a[88:91], v[28:31], v[104:107]
    s_waitcnt lgkmcnt(10)
    v_mfma_f32_16x16x32_bf16 v[108:111], a[92:95], v[28:31], v[108:111]
    s_waitcnt vmcnt(11) lgkmcnt(9)
    v_mfma_f32_16x16x32_bf16 v[88:91], v[112:115], v[32:35], v[88:91]
    s_waitcnt lgkmcnt(8)
    ds_read_b128 v[152:155], v8 offset:34816
    v_mfma_f32_16x16x32_bf16 v[92:95], v[116:119], v[32:35], v[92:95]
    s_waitcnt lgkmcnt(8)
    ds_read_b128 v[156:159], v8 offset:35840
    v_mfma_f32_16x16x32_bf16 v[96:99], v[120:123], v[32:35], v[96:99]
    s_waitcnt lgkmcnt(8)
    ds_read_b128 v[112:115], v8 offset:36864
    v_mfma_f32_16x16x32_bf16 v[100:103], v[124:127], v[32:35], v[100:103]
    s_waitcnt lgkmcnt(8)
    ds_read_b128 v[116:119], v8 offset:37888
    v_mfma_f32_16x16x32_bf16 v[104:107], v[128:131], v[32:35], v[104:107]
    s_waitcnt lgkmcnt(8)
    ds_read_b128 v[120:123], v8 offset:38912
    v_mfma_f32_16x16x32_bf16 v[108:111], v[132:135], v[32:35], v[108:111]
    s_waitcnt vmcnt(10) lgkmcnt(8)
    ds_read_b128 v[124:127], v8 offset:39936
    v_mfma_f32_16x16x32_bf16 v[88:91], v[136:139], v[36:39], v[88:91]
    s_waitcnt lgkmcnt(8)
    ds_read_b128 v[128:131], v8 offset:40960
    v_mfma_f32_16x16x32_bf16 v[92:95], v[140:143], v[36:39], v[92:95]
    s_waitcnt lgkmcnt(8)
    ds_read_b128 v[132:135], v8 offset:41984
    v_mfma_f32_16x16x32_bf16 v[96:99], v[144:147], v[36:39], v[96:99]
    s_waitcnt lgkmcnt(8)
    ds_read_b128 v[136:139], v8 offset:43008
    v_mfma_f32_16x16x32_bf16 v[100:103], v[148:151], v[36:39], v[100:103]
    s_waitcnt lgkmcnt(8)
    ds_read_b128 v[140:143], v8 offset:44032
    v_mfma_f32_16x16x32_bf16 v[104:107], v[152:155], v[36:39], v[104:107]
    s_waitcnt lgkmcnt(8)
    ds_read_b128 v[144:147], v8 offset:45056
    v_mfma_f32_16x16x32_bf16 v[108:111], v[156:159], v[36:39], v[108:111]
    s_waitcnt vmcnt(9) lgkmcnt(8)
    ds_read_b128 v[148:151], v8 offset:46080
    v_mfma_f32_16x16x32_bf16 v[88:91], v[112:115], v[40:43], v[88:91]
    s_waitcnt lgkmcnt(8)
    ds_read_b128 v[152:155], v8 offset:47104
    v_mfma_f32_16x16x32_bf16 v[92:95], v[116:119], v[40:43], v[92:95]
    s_waitcnt lgkmcnt(8)
    ds_read_b128 v[156:159], v8 offset:48128
    v_mfma_f32_16x16x32_bf16 v[96:99], v[120:123], v[40:43], v[96:99]
    s_waitcnt lgkmcnt(8)
    ds_read_b128 v[112:115], v8 offset:49152
    v_mfma_f32_16x16x32_bf16 v[100:103], v[124:127], v[40:43], v[100:103]
    s_waitcnt lgkmcnt(8)
    ds_read_b128 v[116:119], v8 offset:50176
    v_mfma_f32_16x16x32_bf16 v[104:107], v[128:131], v[40:43], v[104:107]
    s_waitcnt lgkmcnt(8)
    ds_read_b128 v[120:123], v8 offset:51200
    v_mfma_f32_16x16x32_bf16 v[108:111], v[132:135], v[40:43], v[108:111]
    s_waitcnt vmcnt(8) lgkmcnt(8)
    ds_read_b128 v[124:127], v8 offset:52224
    v_mfma_f32_16x16x32_bf16 v[88:91], v[136:139], v[44:47], v[88:91]
    s_waitcnt lgkmcnt(8)
    ds_read_b128 v[128:131], v8 offset:53248
    v_mfma_f32_16x16x32_bf16 v[92:95], v[140:143], v[44:47], v[92:95]
    s_waitcnt lgkmcnt(8)
    ds_read_b128 v[132:135], v8 offset:54272
    v_mfma_f32_16x16x32_bf16 v[96:99], v[144:147], v[44:47], v[96:99]
    s_waitcnt lgkmcnt(8)
    ds_read_b128 v[136:139], v8 offset:55296
    v_mfma_f32_16x16x32_bf16 v[100:103], v[148:151], v[44:47], v[100:103]
    s_waitcnt lgkmcnt(8)
    ds_read_b128 v[140:143], v8 offset:56320
    v_mfma_f32_16x16x32_bf16 v[104:107], v[152:155], v[44:47], v[104:107]
    s_waitcnt lgkmcnt(8)
    ds_read_b128 v[144:147], v8 offset:57344
    v_mfma_f32_16x16x32_bf16 v[108:111], v[156:159], v[44:47], v[108:111]
    s_waitcnt vmcnt(7) lgkmcnt(8)
    ds_read_b128 v[148:151], v8 offset:58368
    v_mfma_f32_16x16x32_bf16 v[88:91], v[112:115], v[48:51], v[88:91]
    s_waitcnt lgkmcnt(8)
    ds_read_b128 v[152:155], v8 offset:59392
    v_mfma_f32_16x16x32_bf16 v[92:95], v[116:119], v[48:51], v[92:95]
    s_waitcnt lgkmcnt(8)
    ds_read_b128 v[156:159], v8 offset:60416
    v_mfma_f32_16x16x32_bf16 v[96:99], v[120:123], v[48:51], v[96:99]
    s_waitcnt lgkmcnt(8)
    v_add_u32 v8, 61440, v8
    ds_read_b128 v[112:115], v8 offset:0
    v_mfma_f32_16x16x32_bf16 v[100:103], v[124:127], v[48:51], v[100:103]
    s_waitcnt lgkmcnt(8)
    ds_read_b128 v[116:119], v8 offset:1024
    v_mfma_f32_16x16x32_bf16 v[104:107], v[128:131], v[48:51], v[104:107]
    s_waitcnt lgkmcnt(8)
    ds_read_b128 v[120:123], v8 offset:2048
    v_mfma_f32_16x16x32_bf16 v[108:111], v[132:135], v[48:51], v[108:111]
    s_waitcnt vmcnt(6) lgkmcnt(8)
    ds_read_b128 v[124:127], v8 offset:3072
    v_mfma_f32_16x16x32_bf16 v[88:91], v[136:139], v[52:55], v[88:91]
    s_waitcnt lgkmcnt(8)
    ds_read_b128 v[128:131], v8 offset:4096
    v_mfma_f32_16x16x32_bf16 v[92:95], v[140:143], v[52:55], v[92:95]
    s_waitcnt lgkmcnt(8)
    ds_read_b128 v[132:135], v8 offset:5120
    v_mfma_f32_16x16x32_bf16 v[96:99], v[144:147], v[52:55], v[96:99]
    s_waitcnt lgkmcnt(8)
    ds_read_b128 v[136:139], v8 offset:6144
    v_mfma_f32_16x16x32_bf16 v[100:103], v[148:151], v[52:55], v[100:103]
    s_waitcnt lgkmcnt(8)
    ds_read_b128 v[140:143], v8 offset:7168
    v_mfma_f32_16x16x32_bf16 v[104:107], v[152:155], v[52:55], v[104:107]
    s_waitcnt lgkmcnt(8)
    ds_read_b128 v[144:147], v8 offset:8192
    v_mfma_f32_16x16x32_bf16 v[108:111], v[156:159], v[52:55], v[108:111]
    s_waitcnt vmcnt(5) lgkmcnt(8)
    ds_read_b128 v[148:151], v8 offset:9216
    v_mfma_f32_16x16x32_bf16 v[88:91], v[112:115], v[56:59], v[88:91]
    s_waitcnt lgkmcnt(8)
    ds_read_b128 v[152:155], v8 offset:10240
    v_mfma_f32_16x16x32_bf16 v[92:95], v[116:119], v[56:59], v[92:95]
    s_waitcnt lgkmcnt(8)
    ds_read_b128 v[156:159], v8 offset:11264
    v_mfma_f32_16x16x32_bf16 v[96:99], v[120:123], v[56:59], v[96:99]
    s_waitcnt lgkmcnt(8)
    ds_read_b128 v[112:115], v8 offset:12288
    v_mfma_f32_16x16x32_bf16 v[100:103], v[124:127], v[56:59], v[100:103]
    s_waitcnt lgkmcnt(8)
    ds_read_b128 v[116:119], v8 offset:13312
    v_mfma_f32_16x16x32_bf16 v[104:107], v[128:131], v[56:59], v[104:107]
    s_waitcnt lgkmcnt(8)
    ds_read_b128 v[120:123], v8 offset:14336
    v_mfma_f32_16x16x32_bf16 v[108:111], v[132:135], v[56:59], v[108:111]
    ds_read_b128 v[124:127], v8 offset:15360
    buffer_load_dwordx2 v[80:81], v5, s[4:7], s50 offen offset:0 sc1
    buffer_load_dwordx2 v[82:83], v5, s[4:7], s50 offen offset:128 sc1
    s_waitcnt vmcnt(6) lgkmcnt(9)
    v_mfma_f32_16x16x32_bf16 v[88:91], v[136:139], v[60:63], v[88:91]
    s_waitcnt lgkmcnt(8)
    ds_read_b128 v[128:131], v8 offset:16384
    v_mfma_f32_16x16x32_bf16 v[92:95], v[140:143], v[60:63], v[92:95]
    s_waitcnt lgkmcnt(8)
    ds_read_b128 v[132:135], v8 offset:17408
    v_mfma_f32_16x16x32_bf16 v[96:99], v[144:147], v[60:63], v[96:99]
    s_waitcnt lgkmcnt(8)
    ds_read_b128 v[136:139], v8 offset:18432
    v_mfma_f32_16x16x32_bf16 v[100:103], v[148:151], v[60:63], v[100:103]
    s_waitcnt lgkmcnt(8)
    ds_read_b128 v[140:143], v8 offset:19456
    v_mfma_f32_16x16x32_bf16 v[104:107], v[152:155], v[60:63], v[104:107]
    s_waitcnt lgkmcnt(8)
    ds_read_b128 v[144:147], v8 offset:20480
    v_mfma_f32_16x16x32_bf16 v[108:111], v[156:159], v[60:63], v[108:111]
    ds_read_b128 v[148:151], v8 offset:21504
    buffer_load_dwordx2 v[84:85], v5, s[4:7], s50 offen offset:1024 sc1
    buffer_load_dwordx2 v[86:87], v5, s[4:7], s50 offen offset:1152 sc1
    s_waitcnt vmcnt(7) lgkmcnt(9)
    v_mfma_f32_16x16x32_bf16 v[88:91], v[112:115], v[64:67], v[88:91]
    s_waitcnt lgkmcnt(8)
    ds_read_b128 v[152:155], v8 offset:22528
    v_mfma_f32_16x16x32_bf16 v[92:95], v[116:119], v[64:67], v[92:95]
    s_waitcnt lgkmcnt(8)
    ds_read_b128 v[156:159], v8 offset:23552
    v_mfma_f32_16x16x32_bf16 v[96:99], v[120:123], v[64:67], v[96:99]
    s_waitcnt lgkmcnt(8)
    ds_read_b128 v[112:115], v8 offset:24576
    v_mfma_f32_16x16x32_bf16 v[100:103], v[124:127], v[64:67], v[100:103]
    s_waitcnt lgkmcnt(8)
    ds_read_b128 v[116:119], v8 offset:25600
    v_mfma_f32_16x16x32_bf16 v[104:107], v[128:131], v[64:67], v[104:107]
    s_waitcnt lgkmcnt(8)
    ds_read_b128 v[120:123], v8 offset:26624
    v_mfma_f32_16x16x32_bf16 v[108:111], v[132:135], v[64:67], v[108:111]
    s_waitcnt vmcnt(6) lgkmcnt(8)
    ds_read_b128 v[124:127], v8 offset:27648
    v_mfma_f32_16x16x32_bf16 v[88:91], v[136:139], v[68:71], v[88:91]
    s_waitcnt lgkmcnt(8)
    ds_read_b128 v[128:131], v8 offset:28672
    v_mfma_f32_16x16x32_bf16 v[92:95], v[140:143], v[68:71], v[92:95]
    s_waitcnt lgkmcnt(8)
    ds_read_b128 v[132:135], v8 offset:29696
    v_mfma_f32_16x16x32_bf16 v[96:99], v[144:147], v[68:71], v[96:99]
    s_waitcnt lgkmcnt(8)
    ds_read_b128 v[136:139], v8 offset:30720
    v_mfma_f32_16x16x32_bf16 v[100:103], v[148:151], v[68:71], v[100:103]
    s_waitcnt lgkmcnt(8)
    ds_read_b128 v[140:143], v8 offset:31744
    v_mfma_f32_16x16x32_bf16 v[104:107], v[152:155], v[68:71], v[104:107]
    s_waitcnt lgkmcnt(8)
    ds_read_b128 v[144:147], v8 offset:32768
    v_mfma_f32_16x16x32_bf16 v[108:111], v[156:159], v[68:71], v[108:111]
    s_waitcnt vmcnt(5) lgkmcnt(8)
    ds_read_b128 v[148:151], v8 offset:33792
    v_mfma_f32_16x16x32_bf16 v[88:91], v[112:115], v[72:75], v[88:91]
    s_waitcnt lgkmcnt(8)
    ds_read_b128 v[152:155], v8 offset:34816
    v_mfma_f32_16x16x32_bf16 v[92:95], v[116:119], v[72:75], v[92:95]
    s_waitcnt lgkmcnt(8)
    ds_read_b128 v[156:159], v8 offset:35840
    v_mfma_f32_16x16x32_bf16 v[96:99], v[120:123], v[72:75], v[96:99]
    s_waitcnt lgkmcnt(8)
    ds_read_b128 v[112:115], v8 offset:36864
    v_mfma_f32_16x16x32_bf16 v[100:103], v[124:127], v[72:75], v[100:103]
    s_waitcnt lgkmcnt(8)
    ds_read_b128 v[116:119], v8 offset:37888
    v_mfma_f32_16x16x32_bf16 v[104:107], v[128:131], v[72:75], v[104:107]
    s_waitcnt lgkmcnt(8)
    ds_read_b128 v[120:123], v8 offset:38912
    v_mfma_f32_16x16x32_bf16 v[108:111], v[132:135], v[72:75], v[108:111]
    s_waitcnt vmcnt(4) lgkmcnt(8)
    ds_read_b128 v[124:127], v8 offset:39936
    v_mfma_f32_16x16x32_bf16 v[88:91], v[136:139], v[76:79], v[88:91]
    s_waitcnt lgkmcnt(8)
    ds_read_b128 v[128:131], v8 offset:40960
    v_mfma_f32_16x16x32_bf16 v[92:95], v[140:143], v[76:79], v[92:95]
    s_waitcnt lgkmcnt(8)
    ds_read_b128 v[132:135], v8 offset:41984
    v_mfma_f32_16x16x32_bf16 v[96:99], v[144:147], v[76:79], v[96:99]
    s_waitcnt lgkmcnt(8)
    ds_read_b128 v[136:139], v8 offset:43008
    v_mfma_f32_16x16x32_bf16 v[100:103], v[148:151], v[76:79], v[100:103]
    s_waitcnt lgkmcnt(8)
    ds_read_b128 v[140:143], v8 offset:44032
    v_mfma_f32_16x16x32_bf16 v[104:107], v[152:155], v[76:79], v[104:107]
    s_waitcnt lgkmcnt(8)
    ds_read_b128 v[144:147], v8 offset:45056
    v_mfma_f32_16x16x32_bf16 v[108:111], v[156:159], v[76:79], v[108:111]
    s_waitcnt vmcnt(2) lgkmcnt(8)
    ds_read_b128 v[148:151], v8 offset:46080
    v_mfma_f32_16x16x32_bf16 v[88:91], v[112:115], v[80:83], v[88:91]
    s_waitcnt lgkmcnt(8)
    ds_read_b128 v[152:155], v8 offset:47104
    v_mfma_f32_16x16x32_bf16 v[92:95], v[116:119], v[80:83], v[92:95]
    s_waitcnt lgkmcnt(8)
    ds_read_b128 v[156:159], v8 offset:48128
    v_mfma_f32_16x16x32_bf16 v[96:99], v[120:123], v[80:83], v[96:99]
    s_waitcnt lgkmcnt(8)
    v_mfma_f32_16x16x32_bf16 v[100:103], v[124:127], v[80:83], v[100:103]
    s_waitcnt lgkmcnt(7)
    v_mfma_f32_16x16x32_bf16 v[104:107], v[128:131], v[80:83], v[104:107]
    s_waitcnt lgkmcnt(6)
    v_mfma_f32_16x16x32_bf16 v[108:111], v[132:135], v[80:83], v[108:111]
    s_waitcnt vmcnt(0) lgkmcnt(5)
    v_mfma_f32_16x16x32_bf16 v[88:91], v[136:139], v[84:87], v[88:91]
    s_waitcnt lgkmcnt(4)
    v_mfma_f32_16x16x32_bf16 v[92:95], v[140:143], v[84:87], v[92:95]
    s_waitcnt lgkmcnt(3)
    v_mfma_f32_16x16x32_bf16 v[96:99], v[144:147], v[84:87], v[96:99]
    s_waitcnt lgkmcnt(2)
    v_mfma_f32_16x16x32_bf16 v[100:103], v[148:151], v[84:87], v[100:103]
    s_waitcnt lgkmcnt(1)
    v_mfma_f32_16x16x32_bf16 v[104:107], v[152:155], v[84:87], v[104:107]
    s_waitcnt lgkmcnt(0)
    v_mfma_f32_16x16x32_bf16 v[108:111], v[156:159], v[84:87], v[108:111]
    v_lshlrev_b32 v16, 16, v160
    v_and_b32 v17, 0xffff0000, v160
    v_lshlrev_b32 v18, 16, v161
    v_and_b32 v19, 0xffff0000, v161
    v_lshlrev_b32 v20, 16, v162
    v_and_b32 v21, 0xffff0000, v162
    v_lshlrev_b32 v22, 16, v163
    v_and_b32 v23, 0xffff0000, v163
    v_lshlrev_b32 v24, 16, v164
    v_and_b32 v25, 0xffff0000, v164
    v_lshlrev_b32 v26, 16, v165
    v_and_b32 v27, 0xffff0000, v165
    v_lshlrev_b32 v28, 16, v166
    v_and_b32 v29, 0xffff0000, v166
    v_lshlrev_b32 v30, 16, v167
    v_and_b32 v31, 0xffff0000, v167
    v_lshlrev_b32 v32, 16, v168
    v_and_b32 v33, 0xffff0000, v168
    v_lshlrev_b32 v34, 16, v169
    v_and_b32 v35, 0xffff0000, v169
    v_lshlrev_b32 v36, 16, v170
    v_and_b32 v37, 0xffff0000, v170
    v_lshlrev_b32 v38, 16, v171
    v_and_b32 v39, 0xffff0000, v171
    v_add_f32 v16, v16, v88
    v_add_f32 v17, v17, v89
    v_add_f32 v18, v18, v90
    v_add_f32 v19, v19, v91
    v_add_f32 v20, v20, v92
    v_add_f32 v21, v21, v93
    v_add_f32 v22, v22, v94
    v_add_f32 v23, v23, v95
    v_add_f32 v24, v24, v96
    v_add_f32 v25, v25, v97
    v_add_f32 v26, v26, v98
    v_add_f32 v27, v27, v99
    v_add_f32 v28, v28, v100
    v_add_f32 v29, v29, v101
    v_add_f32 v30, v30, v102
    v_add_f32 v31, v31, v103
    v_add_f32 v32, v32, v104
    v_add_f32 v33, v33, v105
    v_add_f32 v34, v34, v106
    v_add_f32 v35, v35, v107
    v_add_f32 v36, v36, v108
    v_add_f32 v37, v37, v109
    v_add_f32 v38, v38, v110
    v_add_f32 v39, v39, v111
    s_mul_i32 s52, s46, 18
    s_mul_i32 s53, s45, 3
    s_add_u32 s52, s52, s53
    s_lshl_b32 s52, s52, 10
    s_add_u32 s52, s52, 25690112
    v_cvt_pk_bf16_f32 v40, v16, v17
    v_cvt_pk_bf16_f32 v41, v18, v19
    v_cvt_pk_bf16_f32 v42, v20, v21
    v_cvt_pk_bf16_f32 v43, v22, v23
    buffer_store_dwordx4 v[40:43], v2, s[4:7], s52 offen offset:0 sc1
    v_cvt_pk_bf16_f32 v44, v24, v25
    v_cvt_pk_bf16_f32 v45, v26, v27
    v_cvt_pk_bf16_f32 v46, v28, v29
    v_cvt_pk_bf16_f32 v47, v30, v31
    buffer_store_dwordx4 v[44:47], v2, s[4:7], s52 offen offset:1024 sc1
    v_cvt_pk_bf16_f32 v48, v32, v33
    v_cvt_pk_bf16_f32 v49, v34, v35
    v_cvt_pk_bf16_f32 v50, v36, v37
    v_cvt_pk_bf16_f32 v51, v38, v39
    buffer_store_dwordx4 v[48:51], v2, s[4:7], s52 offen offset:2048 sc1
    v_lshlrev_b32 v16, 16, v40
    v_and_b32 v17, 0xffff0000, v40
    v_lshlrev_b32 v18, 16, v41
    v_and_b32 v19, 0xffff0000, v41
    v_lshlrev_b32 v20, 16, v42
    v_and_b32 v21, 0xffff0000, v42
    v_lshlrev_b32 v22, 16, v43
    v_and_b32 v23, 0xffff0000, v43
    v_lshlrev_b32 v24, 16, v44
    v_and_b32 v25, 0xffff0000, v44
    v_lshlrev_b32 v26, 16, v45
    v_and_b32 v27, 0xffff0000, v45
    v_lshlrev_b32 v28, 16, v46
    v_and_b32 v29, 0xffff0000, v46
    v_lshlrev_b32 v30, 16, v47
    v_and_b32 v31, 0xffff0000, v47
    v_lshlrev_b32 v32, 16, v48
    v_and_b32 v33, 0xffff0000, v48
    v_lshlrev_b32 v34, 16, v49
    v_and_b32 v35, 0xffff0000, v49
    v_lshlrev_b32 v36, 16, v50
    v_and_b32 v37, 0xffff0000, v50
    v_lshlrev_b32 v38, 16, v51
    v_and_b32 v39, 0xffff0000, v51
    v_add_f32 v56, v16, v17
    v_add_f32 v58, v18, v19
    v_add_f32 v56, v56, v20
    v_add_f32 v58, v58, v21
    v_add_f32 v56, v56, v22
    v_add_f32 v58, v58, v23
    v_add_f32 v56, v56, v24
    v_add_f32 v58, v58, v25
    v_add_f32 v56, v56, v26
    v_add_f32 v58, v58, v27
    v_add_f32 v56, v56, v28
    v_add_f32 v58, v58, v29
    v_add_f32 v56, v56, v30
    v_add_f32 v58, v58, v31
    v_add_f32 v56, v56, v32
    v_add_f32 v58, v58, v33
    v_add_f32 v56, v56, v34
    v_add_f32 v58, v58, v35
    v_add_f32 v56, v56, v36
    v_add_f32 v58, v58, v37
    v_add_f32 v56, v56, v38
    v_add_f32 v58, v58, v39
    v_add_f32 v56, v56, v58
    v_mov_b32 v58, v56
    s_nop 1
    v_permlane16_swap_b32 v56, v58
    v_add_f32 v56, v56, v58
    v_mov_b32 v58, v56
    s_nop 1
    v_permlane32_swap_b32 v56, v58
    v_add_f32 v56, v56, v58
    v_mul_f32 v59, 0x3c2aaaab, v56
    v_sub_f32 v58, v16, v59
    v_mul_f32 v57, v58, v58
    v_sub_f32 v61, v17, v59
    v_fmac_f32 v57, v61, v61
    v_sub_f32 v60, v18, v59
    v_fmac_f32 v57, v60, v60
    v_sub_f32 v61, v19, v59
    v_fmac_f32 v57, v61, v61
    v_sub_f32 v60, v20, v59
    v_fmac_f32 v57, v60, v60
    v_sub_f32 v61, v21, v59
    v_fmac_f32 v57, v61, v61
    v_sub_f32 v60, v22, v59
    v_fmac_f32 v57, v60, v60
    v_sub_f32 v61, v23, v59
    v_fmac_f32 v57, v61, v61
    v_sub_f32 v60, v24, v59
    v_fmac_f32 v57, v60, v60
    v_sub_f32 v61, v25, v59
    v_fmac_f32 v57, v61, v61
    v_sub_f32 v60, v26, v59
    v_fmac_f32 v57, v60, v60
    v_sub_f32 v61, v27, v59
    v_fmac_f32 v57, v61, v61
    v_sub_f32 v60, v28, v59
    v_fmac_f32 v57, v60, v60
    v_sub_f32 v61, v29, v59
    v_fmac_f32 v57, v61, v61
    v_sub_f32 v60, v30, v59
    v_fmac_f32 v57, v60, v60
    v_sub_f32 v61, v31, v59
    v_fmac_f32 v57, v61, v61
    v_sub_f32 v60, v32, v59
    v_fmac_f32 v57, v60, v60
    v_sub_f32 v61, v33, v59
    v_fmac_f32 v57, v61, v61
    v_sub_f32 v60, v34, v59
    v_fmac_f32 v57, v60, v60
    v_sub_f32 v61, v35, v59
    v_fmac_f32 v57, v61, v61
    v_sub_f32 v60, v36, v59
    v_fmac_f32 v57, v60, v60
    v_sub_f32 v61, v37, v59
    v_fmac_f32 v57, v61, v61
    v_sub_f32 v60, v38, v59
    v_fmac_f32 v57, v60, v60
    v_sub_f32 v61, v39, v59
    v_fmac_f32 v57, v61, v61
    v_mov_b32 v58, v57
    s_nop 1
    v_permlane16_swap_b32 v57, v58
    v_add_f32 v57, v57, v58
    v_mov_b32 v58, v57
    s_nop 1
    v_permlane32_swap_b32 v57, v58
    v_add_f32 v57, v57, v58
    s_lshl_b32 s52, s45, 14
    s_add_u32 s52, s52, 28049408
    s_mov_b32 exec_lo, 0xffff
    s_mov_b32 exec_hi, 0
    buffer_store_dwordx2 v[56:57], v7, s[4:7], s52 offen sc1
    s_mov_b64 exec, -1
    s_lshl_b32 s53, s46, 3
    s_add_u32 s53, s53, s45
    s_lshl_b32 s53, s53, 3
    s_add_u32 s53, s53, 32768
    s_and_b32 s23, s21, 7
    s_lshl_b32 s23, s23, 2
    s_and_b32 s1, s22, 3
    s_add_u32 s1, s1, s23
    s_lshl_b32 s1, s1, 9
    s_add_u32 s1, s1, 139264
    v_min_u32 v14, 35, v1
    v_lshlrev_b32 v14, 3, v14
    s_lshl_b32 s1, s1, 2
    s_add_u32 s1, s1, 0x8000000
    v_lshlrev_b32 v14, 2, v14
    buffer_load_dwordx2 v[12:13], v14, s[4:7], s1 offen sc1
    v_mov_b32 v8, s98
    v_mov_b32 v9, s99
    s_waitcnt vmcnt(1)
    s_lshl_b32 s53, s53, 2
    s_add_u32 s53, s53, 0x8000000
    s_mov_b64 exec, 1
    buffer_store_dwordx2 v[8:9], off, s[4:7], s53 sc1
    s_mov_b64 exec, -1
    s_mov_b32 s0, 0
    s_mov_b32 s3, 0
    s_cmp_lg_u32 s20, 3
    s_cbranch_scc1 L_ffn_50
    s_mul_i32 s55, s20, 9216
    s_add_u32 s55, s55, 110592
    v_add_u32 v64, s55, v2
    ds_write_b128 v64, a[180:183] offset:0
    ds_write_b128 v64, a[184:187] offset:1024
    ds_write_b128 v64, a[188:191] offset:2048
    ds_write_b128 v64, a[192:195] offset:3072
    ds_write_b128 v64, a[196:199] offset:4096
    ds_write_b128 v64, a[200:203] offset:5120
    ds_write_b128 v64, a[204:207] offset:6144
    ds_write_b128 v64, a[208:211] offset:7168
    ds_write_b128 v64, a[212:215] offset:8192
    s_cmp_ge_u32 s30, 1152
    s_cbranch_scc1 L_ud_59
    s_mul_i32 s64, s30, 1821
    s_lshr_b32 s64, s64, 16
    s_mul_i32 s92, s64, 36
    s_sub_u32 s92, s30, s92
    s_and_b32 s93, s92, 1
    s_lshr_b32 s94, s92, 1
    s_mov_b32 s62, 0
    s_mov_b32 s63, 256
    s_mul_i32 s95, s64, 486
    s_add_u32 s95, s95, s92
    s_lshl_b32 s95, s95, 10
    s_add_u32 s69, s95, 4194304
    s_add_u32 s58, s69, 36864
    s_add_u32 s59, s69, 110592
    s_add_u32 s60, s69, 184320
    s_add_u32 s61, s69, 258048
    s_mov_b32 s70, 36864
    s_lshl_b32 s95, s64, 1
    s_add_u32 s95, s95, s93
    s_mul_i32 s95, s95, 18
    s_add_u32 s95, s95, s94
    s_mul_i32 s95, s95, 640
    s_add_u32 s65, s95, 2883584
    s_mov_b32 s66, s92
    s_branch L_udone_60
L_ud_59:
    s_sub_u32 s92, s30, 1152
    s_mul_i32 s64, s92, 3641
    s_lshr_b32 s64, s64, 16
    s_mul_i32 s93, s64, 18
    s_sub_u32 s92, s92, s93
    s_and_b32 s93, s64, 3
    s_and_b32 s94, s93, 1
    s_mov_b32 s65, 0
    s_lshl_b32 s62, s94, 5
    s_cmp_eq_u32 s94, 0
    s_cselect_b32 s63, 256, 0
    s_add_u32 s66, s92, 36
    s_mul_i32 s95, s64, 486
    s_add_u32 s95, s95, 324
    s_lshl_b32 s95, s95, 10
    s_add_u32 s95, s95, 4194304
    s_cmp_ge_u32 s92, 3
    s_cbranch_scc1 L_ub_61
    s_sub_u32 s96, s92, 0
    s_mov_b32 s70, 1024
    s_mov_b32 s71, 2048
    s_mul_i32 s97, s96, 5120
    s_add_u32 s97, s97, 0
    s_add_u32 s67, s97, s95
    s_mul_i32 s97, s96, 4096
    s_add_u32 s97, s97, 15360
    s_add_u32 s68, s97, s95
    s_mul_i32 s97, s96, 5120
    s_add_u32 s97, s97, 4096
    s_add_u32 s69, s97, s95
    s_branch L_ue_63
L_ub_61:
    s_cmp_ge_u32 s92, 9
    s_cbranch_scc1 L_uc_62
    s_sub_u32 s96, s92, 3
    s_mov_b32 s70, 1024
    s_mov_b32 s71, 2048
    s_mul_i32 s97, s96, 9216
    s_add_u32 s97, s97, 27648
    s_add_u32 s67, s97, s95
    s_mul_i32 s97, s96, 9216
    s_add_u32 s97, s97, 31744
    s_add_u32 s68, s97, s95
    s_mul_i32 s97, s96, 9216
    s_add_u32 s97, s97, 35840
    s_add_u32 s69, s97, s95
    s_branch L_ue_63
L_uc_62:
    s_sub_u32 s96, s92, 9
    s_mov_b32 s70, 1024
    s_mov_b32 s71, 18432
    s_mul_i32 s97, s96, 2048
    s_add_u32 s97, s97, 82944
    s_add_u32 s67, s97, s95
    s_mul_i32 s97, s96, 2048
    s_add_u32 s97, s97, 119808
    s_add_u32 s68, s97, s95
    s_mul_i32 s97, s96, 1024
    s_add_u32 s97, s97, 156672
    s_add_u32 s69, s97, s95
L_ue_63:
    s_add_u32 s96, s67, s71
    s_add_u32 s61, s68, s71
    s_lshr_b32 s97, s93, 1
    s_cmp_eq_u32 s97, s94
    s_cselect_b32 s58, s67, s68
    s_cselect_b32 s59, s96, s67
    s_cselect_b32 s60, s68, s96
L_udone_60:
    s_lshl_b32 s95, s64, 6
    s_add_u32 s95, s95, s66
    s_lshl_b32 s95, s95, 3
    s_add_u32 s66, s95, 139264
    v_lshrrev_b32 v64, 4, v1
    v_bfe_u32 v66, v1, 2, 2
    v_lshl_add_u32 v64, v64, 3, v66
    v_mul_u32_u24 v64, 288, v64
    v_add_u32 v64, s55, v64
    v_and_b32 v66, 3, v1
    v_lshl_add_u32 v65, v66, 3, v64
    v_add_u32 v65, s63, v65
    v_lshl_add_u32 v64, v66, 4, v64
    v_add_u32 v64, s62, v64
    ds_read_b64_tr_b16 v[72:73], v64 offset:0
    ds_read_b64_tr_b16 v[74:75], v64 offset:1152
    ds_read_b64_tr_b16 v[76:77], v64 offset:8
    ds_read_b64_tr_b16 v[78:79], v64 offset:1160
    ds_read_b64_tr_b16 v[80:81], v64 offset:64
    ds_read_b64_tr_b16 v[82:83], v64 offset:1216
    ds_read_b64_tr_b16 v[84:85], v64 offset:72
    ds_read_b64_tr_b16 v[86:87], v64 offset:1224
    ds_read_b64_tr_b16 v[88:89], v64 offset:128
    ds_read_b64_tr_b16 v[90:91], v64 offset:1280
    ds_read_b64_tr_b16 v[92:93], v64 offset:136
    ds_read_b64_tr_b16 v[94:95], v64 offset:1288
    ds_read_b64_tr_b16 v[96:97], v64 offset:192
    ds_read_b64_tr_b16 v[98:99], v64 offset:1344
    ds_read_b64_tr_b16 v[100:101], v64 offset:200
    ds_read_b64_tr_b16 v[102:103], v64 offset:1352
    ds_read_b64_tr_b16 v[104:105], v65 offset:0
    ds_read_b64_tr_b16 v[106:107], v65 offset:1152
    s_waitcnt lgkmcnt(15)
    buffer_store_dwordx4 v[72:75], v2, s[4:7], s58 offen sc1
    s_add_u32 s92, s58, s70
    s_waitcnt lgkmcnt(14)
    buffer_store_dwordx4 v[76:79], v2, s[4:7], s92 offen sc1
    s_waitcnt lgkmcnt(12)
    buffer_store_dwordx4 v[80:83], v2, s[4:7], s59 offen sc1
    s_add_u32 s92, s59, s70
    s_waitcnt lgkmcnt(10)
    buffer_store_dwordx4 v[84:87], v2, s[4:7], s92 offen sc1
    s_waitcnt lgkmcnt(8)
    buffer_store_dwordx4 v[88:91], v2, s[4:7], s60 offen sc1
    s_add_u32 s92, s60, s70
    s_waitcnt lgkmcnt(6)
    buffer_store_dwordx4 v[92:95], v2, s[4:7], s92 offen sc1
    s_waitcnt lgkmcnt(4)
    buffer_store_dwordx4 v[96:99], v2, s[4:7], s61 offen sc1
    s_add_u32 s92, s61, s70
    s_waitcnt lgkmcnt(2)
    buffer_store_dwordx4 v[100:103], v2, s[4:7], s92 offen sc1
    s_waitcnt lgkmcnt(0)
    buffer_store_dwordx4 v[104:107], v2, s[4:7], s69 offen sc1
    s_cmp_eq_u32 s65, 0
    s_cbranch_scc1 L_nocs_64
    v_mov_b32 v68, 0x3f803f80
    v_mov_b32 v69, 0x3f803f80
    v_mov_b32 v70, 0x3f803f80
    v_mov_b32 v71, 0x3f803f80
    s_nop 1
    v_mfma_f32_16x16x32_bf16 v[108:111], v[72:75], v[68:71], 0
    v_mfma_f32_16x16x32_bf16 v[112:115], v[76:79], v[68:71], 0
    v_mfma_f32_16x16x32_bf16 v[116:119], v[80:83], v[68:71], 0
    v_mfma_f32_16x16x32_bf16 v[120:123], v[84:87], v[68:71], 0
    v_mfma_f32_16x16x32_bf16 v[124:127], v[88:91], v[68:71], 0
    v_mfma_f32_16x16x32_bf16 v[128:131], v[92:95], v[68:71], 0
    v_mfma_f32_16x16x32_bf16 v[132:135], v[96:99], v[68:71], 0
    v_mfma_f32_16x16x32_bf16 v[136:139], v[100:103], v[68:71], 0
    v_mfma_f32_16x16x32_bf16 v[140:143], v[104:107], v[68:71], 0
    v_and_b32 v66, 15, v1
    v_add_u32 v67, 1, v66
    v_cmp_gt_u32 vcc, 8, v66
    v_and_b32 v64, 48, v1
    s_nop 0
    v_cndmask_b32 v67, 0, v67, vcc
    v_cmp_eq_u32 vcc, 9, v66
    s_nop 1
    v_cndmask_b32 v67, v67, v66, vcc
    v_lshlrev_b32 v67, 6, v67
    v_add_u32 v67, v67, v64
    v_cmp_eq_u32 vcc, 1, v66
    s_nop 1
    v_cndmask_b32 v108, v108, v112, vcc
    v_cndmask_b32 v109, v109, v113, vcc
    v_cndmask_b32 v110, v110, v114, vcc
    v_cndmask_b32 v111, v111, v115, vcc
    v_cmp_eq_u32 vcc, 2, v66
    s_nop 1
    v_cndmask_b32 v108, v108, v116, vcc
    v_cndmask_b32 v109, v109, v117, vcc
    v_cndmask_b32 v110, v110, v118, vcc
    v_cndmask_b32 v111, v111, v119, vcc
    v_cmp_eq_u32 vcc, 3, v66
    s_nop 1
    v_cndmask_b32 v108, v108, v120, vcc
    v_cndmask_b32 v109, v109, v121, vcc
    v_cndmask_b32 v110, v110, v122, vcc
    v_cndmask_b32 v111, v111, v123, vcc
    v_cmp_eq_u32 vcc, 4, v66
    s_nop 1
    v_cndmask_b32 v108, v108, v124, vcc
    v_cndmask_b32 v109, v109, v125, vcc
    v_cndmask_b32 v110, v110, v126, vcc
    v_cndmask_b32 v111, v111, v127, vcc
    v_cmp_eq_u32 vcc, 5, v66
    s_nop 1
    v_cndmask_b32 v108, v108, v128, vcc
    v_cndmask_b32 v109, v109, v129, vcc
    v_cndmask_b32 v110, v110, v130, vcc
    v_cndmask_b32 v111, v111, v131, vcc
    v_cmp_eq_u32 vcc, 6, v66
    s_nop 1
    v_cndmask_b32 v108, v108, v132, vcc
    v_cndmask_b32 v109, v109, v133, vcc
    v_cndmask_b32 v110, v110, v134, vcc
    v_cndmask_b32 v111, v111, v135, vcc
    v_cmp_eq_u32 vcc, 7, v66
    s_nop 1
    v_cndmask_b32 v108, v108, v136, vcc
    v_cndmask_b32 v109, v109, v137, vcc
    v_cndmask_b32 v110, v110, v138, vcc
    v_cndmask_b32 v111, v111, v139, vcc
    v_cmp_eq_u32 vcc, 8, v66
    s_nop 1
    v_cndmask_b32 v108, v108, v140, vcc
    v_cndmask_b32 v109, v109, v141, vcc
    v_cndmask_b32 v110, v110, v142, vcc
    v_cndmask_b32 v111, v111, v143, vcc
    s_mov_b32 exec_lo, 0x03ff03ff
    s_mov_b32 exec_hi, 0x03ff03ff
    buffer_store_dwordx4 v[108:111], v67, s[4:7], s65 offen sc1
    s_mov_b64 exec, -1
L_nocs_64:
    s_mov_b32 s3, s66
    s_branch L_ffn_50
L_idle0_49:
    s_mul_i32 s55, s20, 9216
    s_add_u32 s55, s55, 110592
    v_add_u32 v64, s55, v2
    ds_write_b128 v64, a[180:183] offset:0
    ds_write_b128 v64, a[184:187] offset:1024
    ds_write_b128 v64, a[188:191] offset:2048
    ds_write_b128 v64, a[192:195] offset:3072
    ds_write_b128 v64, a[196:199] offset:4096
    ds_write_b128 v64, a[200:203] offset:5120
    ds_write_b128 v64, a[204:207] offset:6144
    ds_write_b128 v64, a[208:211] offset:7168
    ds_write_b128 v64, a[212:215] offset:8192
    s_cmp_ge_u32 s30, 1152
    s_cbranch_scc1 L_ud_65
    s_mul_i32 s64, s30, 1821
    s_lshr_b32 s64, s64, 16
    s_mul_i32 s92, s64, 36
    s_sub_u32 s92, s30, s92
    s_and_b32 s93, s92, 1
    s_lshr_b32 s94, s92, 1
    s_mov_b32 s62, 0
    s_mov_b32 s63, 256
    s_mul_i32 s95, s64, 486
    s_add_u32 s95, s95, s92
    s_lshl_b32 s95, s95, 10
    s_add_u32 s69, s95, 4194304
    s_add_u32 s58, s69, 36864
    s_add_u32 s59, s69, 110592
    s_add_u32 s60, s69, 184320
    s_add_u32 s61, s69, 258048
    s_mov_b32 s70, 36864
    s_lshl_b32 s95, s64, 1
    s_add_u32 s95, s95, s93
    s_mul_i32 s95, s95, 18
    s_add_u32 s95, s95, s94
    s_mul_i32 s95, s95, 640
    s_add_u32 s65, s95, 2883584
    s_mov_b32 s66, s92
    s_branch L_udone_66
L_ud_65:
    s_sub_u32 s92, s30, 1152
    s_mul_i32 s64, s92, 3641
    s_lshr_b32 s64, s64, 16
    s_mul_i32 s93, s64, 18
    s_sub_u32 s92, s92, s93
    s_and_b32 s93, s64, 3
    s_and_b32 s94, s93, 1
    s_mov_b32 s65, 0
    s_lshl_b32 s62, s94, 5
    s_cmp_eq_u32 s94, 0
    s_cselect_b32 s63, 256, 0
    s_add_u32 s66, s92, 36
    s_mul_i32 s95, s64, 486
    s_add_u32 s95, s95, 324
    s_lshl_b32 s95, s95, 10
    s_add_u32 s95, s95, 4194304
    s_cmp_ge_u32 s92, 3
    s_cbranch_scc1 L_ub_67
    s_sub_u32 s96, s92, 0
    s_mov_b32 s70, 1024
    s_mov_b32 s71, 2048
    s_mul_i32 s97, s96, 5120
    s_add_u32 s97, s97, 0
    s_add_u32 s67, s97, s95
    s_mul_i32 s97, s96, 4096
    s_add_u32 s97, s97, 15360
    s_add_u32 s68, s97, s95
    s_mul_i32 s97, s96, 5120
    s_add_u32 s97, s97, 4096
    s_add_u32 s69, s97, s95
    s_branch L_ue_69
L_ub_67:
    s_cmp_ge_u32 s92, 9
    s_cbranch_scc1 L_uc_68
    s_sub_u32 s96, s92, 3
    s_mov_b32 s70, 1024
    s_mov_b32 s71, 2048
    s_mul_i32 s97, s96, 9216
    s_add_u32 s97, s97, 27648
    s_add_u32 s67, s97, s95
    s_mul_i32 s97, s96, 9216
    s_add_u32 s97, s97, 31744
    s_add_u32 s68, s97, s95
    s_mul_i32 s97, s96, 9216
    s_add_u32 s97, s97, 35840
    s_add_u32 s69, s97, s95
    s_branch L_ue_69
L_uc_68:
    s_sub_u32 s96, s92, 9
    s_mov_b32 s70, 1024
    s_mov_b32 s71, 18432
    s_mul_i32 s97, s96, 2048
    s_add_u32 s97, s97, 82944
    s_add_u32 s67, s97, s95
    s_mul_i32 s97, s96, 2048
    s_add_u32 s97, s97, 119808
    s_add_u32 s68, s97, s95
    s_mul_i32 s97, s96, 1024
    s_add_u32 s97, s97, 156672
    s_add_u32 s69, s97, s95
L_ue_69:
    s_add_u32 s96, s67, s71
    s_add_u32 s61, s68, s71
    s_lshr_b32 s97, s93, 1
    s_cmp_eq_u32 s97, s94
    s_cselect_b32 s58, s67, s68
    s_cselect_b32 s59, s96, s67
    s_cselect_b32 s60, s68, s96
L_udone_66:
    s_lshl_b32 s95, s64, 6
    s_add_u32 s95, s95, s66
    s_lshl_b32 s95, s95, 3
    s_add_u32 s66, s95, 139264
    v_lshrrev_b32 v64, 4, v1
    v_bfe_u32 v66, v1, 2, 2
    v_lshl_add_u32 v64, v64, 3, v66
    v_mul_u32_u24 v64, 288, v64
    v_add_u32 v64, s55, v64
    v_and_b32 v66, 3, v1
    v_lshl_add_u32 v65, v66, 3, v64
    v_add_u32 v65, s63, v65
    v_lshl_add_u32 v64, v66, 4, v64
    v_add_u32 v64, s62, v64
    ds_read_b64_tr_b16 v[72:73], v64 offset:0
    ds_read_b64_tr_b16 v[74:75], v64 offset:1152
    ds_read_b64_tr_b16 v[76:77], v64 offset:8
    ds_read_b64_tr_b16 v[78:79], v64 offset:1160
    ds_read_b64_tr_b16 v[80:81], v64 offset:64
    ds_read_b64_tr_b16 v[82:83], v64 offset:1216
    ds_read_b64_tr_b16 v[84:85], v64 offset:72
    ds_read_b64_tr_b16 v[86:87], v64 offset:1224
    ds_read_b64_tr_b16 v[88:89], v64 offset:128
    ds_read_b64_tr_b16 v[90:91], v64 offset:1280
    ds_read_b64_tr_b16 v[92:93], v64 offset:136
    ds_read_b64_tr_b16 v[94:95], v64 offset:1288
    ds_read_b64_tr_b16 v[96:97], v64 offset:192
    ds_read_b64_tr_b16 v[98:99], v64 offset:1344
    ds_read_b64_tr_b16 v[100:101], v64 offset:200
    ds_read_b64_tr_b16 v[102:103], v64 offset:1352
    ds_read_b64_tr_b16 v[104:105], v65 offset:0
    ds_read_b64_tr_b16 v[106:107], v65 offset:1152
    s_waitcnt lgkmcnt(15)
    buffer_store_dwordx4 v[72:75], v2, s[4:7], s58 offen sc1
    s_add_u32 s92, s58, s70
    s_waitcnt lgkmcnt(14)
    buffer_store_dwordx4 v[76:79], v2, s[4:7], s92 offen sc1
    s_waitcnt lgkmcnt(12)
    buffer_store_dwordx4 v[80:83], v2, s[4:7], s59 offen sc1
    s_add_u32 s92, s59, s70
    s_waitcnt lgkmcnt(10)
    buffer_store_dwordx4 v[84:87], v2, s[4:7], s92 offen sc1
    s_waitcnt lgkmcnt(8)
    buffer_store_dwordx4 v[88:91], v2, s[4:7], s60 offen sc1
    s_add_u32 s92, s60, s70
    s_waitcnt lgkmcnt(6)
    buffer_store_dwordx4 v[92:95], v2, s[4:7], s92 offen sc1
    s_waitcnt lgkmcnt(4)
    buffer_store_dwordx4 v[96:99], v2, s[4:7], s61 offen sc1
    s_add_u32 s92, s61, s70
    s_waitcnt lgkmcnt(2)
    buffer_store_dwordx4 v[100:103], v2, s[4:7], s92 offen sc1
    s_waitcnt lgkmcnt(0)
    buffer_store_dwordx4 v[104:107], v2, s[4:7], s69 offen sc1
    s_cmp_eq_u32 s65, 0
    s_cbranch_scc1 L_nocs_70
    v_mov_b32 v68, 0x3f803f80
    v_mov_b32 v69, 0x3f803f80
    v_mov_b32 v70, 0x3f803f80
    v_mov_b32 v71, 0x3f803f80
    s_nop 1
    v_mfma_f32_16x16x32_bf16 v[108:111], v[72:75], v[68:71], 0
    v_mfma_f32_16x16x32_bf16 v[112:115], v[76:79], v[68:71], 0
    v_mfma_f32_16x16x32_bf16 v[116:119], v[80:83], v[68:71], 0
    v_mfma_f32_16x16x32_bf16 v[120:123], v[84:87], v[68:71], 0
    v_mfma_f32_16x16x32_bf16 v[124:127], v[88:91], v[68:71], 0
    v_mfma_f32_16x16x32_bf16 v[128:131], v[92:95], v[68:71], 0
    v_mfma_f32_16x16x32_bf16 v[132:135], v[96:99], v[68:71], 0
    v_mfma_f32_16x16x32_bf16 v[136:139], v[100:103], v[68:71], 0
    v_mfma_f32_16x16x32_bf16 v[140:143], v[104:107], v[68:71], 0
    v_and_b32 v66, 15, v1
    v_add_u32 v67, 1, v66
    v_cmp_gt_u32 vcc, 8, v66
    v_and_b32 v64, 48, v1
    s_nop 0
    v_cndmask_b32 v67, 0, v67, vcc
    v_cmp_eq_u32 vcc, 9, v66
    s_nop 1
    v_cndmask_b32 v67, v67, v66, vcc
    v_lshlrev_b32 v67, 6, v67
    v_add_u32 v67, v67, v64
    v_cmp_eq_u32 vcc, 1, v66
    s_nop 1
    v_cndmask_b32 v108, v108, v112, vcc
    v_cndmask_b32 v109, v109, v113, vcc
    v_cndmask_b32 v110, v110, v114, vcc
    v_cndmask_b32 v111, v111, v115, vcc
    v_cmp_eq_u32 vcc, 2, v66
    s_nop 1
    v_cndmask_b32 v108, v108, v116, vcc
    v_cndmask_b32 v109, v109, v117, vcc
    v_cndmask_b32 v110, v110, v118, vcc
    v_cndmask_b32 v111, v111, v119, vcc
    v_cmp_eq_u32 vcc, 3, v66
    s_nop 1
    v_cndmask_b32 v108, v108, v120, vcc
    v_cndmask_b32 v109, v109, v121, vcc
    v_cndmask_b32 v110, v110, v122, vcc
    v_cndmask_b32 v111, v111, v123, vcc
    v_cmp_eq_u32 vcc, 4, v66
    s_nop 1
    v_cndmask_b32 v108, v108, v124, vcc
    v_cndmask_b32 v109, v109, v125, vcc
    v_cndmask_b32 v110, v110, v126, vcc
    v_cndmask_b32 v111, v111, v127, vcc
    v_cmp_eq_u32 vcc, 5, v66
    s_nop 1
    v_cndmask_b32 v108, v108, v128, vcc
    v_cndmask_b32 v109, v109, v129, vcc
    v_cndmask_b32 v110, v110, v130, vcc
    v_cndmask_b32 v111, v111, v131, vcc
    v_cmp_eq_u32 vcc, 6, v66
    s_nop 1
    v_cndmask_b32 v108, v108, v132, vcc
    v_cndmask_b32 v109, v109, v133, vcc
    v_cndmask_b32 v110, v110, v134, vcc
    v_cndmask_b32 v111, v111, v135, vcc
    v_cmp_eq_u32 vcc, 7, v66
    s_nop 1
    v_cndmask_b32 v108, v108, v136, vcc
    v_cndmask_b32 v109, v109, v137, vcc
    v_cndmask_b32 v110, v110, v138, vcc
    v_cndmask_b32 v111, v111, v139, vcc
    v_cmp_eq_u32 vcc, 8, v66
    s_nop 1
    v_cndmask_b32 v108, v108, v140, vcc
    v_cndmask_b32 v109, v109, v141, vcc
    v_cndmask_b32 v110, v110, v142, vcc
    v_cndmask_b32 v111, v111, v143, vcc
    s_mov_b32 exec_lo, 0x03ff03ff
    s_mov_b32 exec_hi, 0x03ff03ff
    buffer_store_dwordx4 v[108:111], v67, s[4:7], s65 offen sc1
    s_mov_b64 exec, -1
L_nocs_70:
    s_mov_b32 s44, s66
    s_mul_i32 s55, s20, 9216
    s_add_u32 s55, s55, 110592
    v_add_u32 v64, s55, v2
    ds_write_b128 v64, a[216:219] offset:0
    ds_write_b128 v64, a[220:223] offset:1024
    ds_write_b128 v64, a[224:227] offset:2048
    ds_write_b128 v64, a[228:231] offset:3072
    ds_write_b128 v64, a[232:235] offset:4096
    ds_write_b128 v64, a[236:239] offset:5120
    ds_write_b128 v64, a[240:243] offset:6144
    ds_write_b128 v64, a[244:247] offset:7168
    ds_write_b128 v64, a[248:251] offset:8192
    s_cmp_ge_u32 s31, 1152
    s_cbranch_scc1 L_ud_71
    s_mul_i32 s64, s31, 1821
    s_lshr_b32 s64, s64, 16
    s_mul_i32 s92, s64, 36
    s_sub_u32 s92, s31, s92
    s_and_b32 s93, s92, 1
    s_lshr_b32 s94, s92, 1
    s_mov_b32 s62, 0
    s_mov_b32 s63, 256
    s_mul_i32 s95, s64, 486
    s_add_u32 s95, s95, s92
    s_lshl_b32 s95, s95, 10
    s_add_u32 s69, s95, 4194304
    s_add_u32 s58, s69, 36864
    s_add_u32 s59, s69, 110592
    s_add_u32 s60, s69, 184320
    s_add_u32 s61, s69, 258048
    s_mov_b32 s70, 36864
    s_lshl_b32 s95, s64, 1
    s_add_u32 s95, s95, s93
    s_mul_i32 s95, s95, 18
    s_add_u32 s95, s95, s94
    s_mul_i32 s95, s95, 640
    s_add_u32 s65, s95, 2883584
    s_mov_b32 s66, s92
    s_branch L_udone_72
L_ud_71:
    s_sub_u32 s92, s31, 1152
    s_mul_i32 s64, s92, 3641
    s_lshr_b32 s64, s64, 16
    s_mul_i32 s93, s64, 18
    s_sub_u32 s92, s92, s93
    s_and_b32 s93, s64, 3
    s_and_b32 s94, s93, 1
    s_mov_b32 s65, 0
    s_lshl_b32 s62, s94, 5
    s_cmp_eq_u32 s94, 0
    s_cselect_b32 s63, 256, 0
    s_add_u32 s66, s92, 36
    s_mul_i32 s95, s64, 486
    s_add_u32 s95, s95, 324
    s_lshl_b32 s95, s95, 10
    s_add_u32 s95, s95, 4194304
    s_cmp_ge_u32 s92, 3
    s_cbranch_scc1 L_ub_73
    s_sub_u32 s96, s92, 0
    s_mov_b32 s70, 1024
    s_mov_b32 s71, 2048
    s_mul_i32 s97, s96, 5120
    s_add_u32 s97, s97, 0
    s_add_u32 s67, s97, s95
    s_mul_i32 s97, s96, 4096
    s_add_u32 s97, s97, 15360
    s_add_u32 s68, s97, s95
    s_mul_i32 s97, s96, 5120
    s_add_u32 s97, s97, 4096
    s_add_u32 s69, s97, s95
    s_branch L_ue_75
L_ub_73:
    s_cmp_ge_u32 s92, 9
    s_cbranch_scc1 L_uc_74
    s_sub_u32 s96, s92, 3
    s_mov_b32 s70, 1024
    s_mov_b32 s71, 2048
    s_mul_i32 s97, s96, 9216
    s_add_u32 s97, s97, 27648
    s_add_u32 s67, s97, s95
    s_mul_i32 s97, s96, 9216
    s_add_u32 s97, s97, 31744
    s_add_u32 s68, s97, s95
    s_mul_i32 s97, s96, 9216
    s_add_u32 s97, s97, 35840
    s_add_u32 s69, s97, s95
    s_branch L_ue_75
L_uc_74:
    s_sub_u32 s96, s92, 9
    s_mov_b32 s70, 1024
    s_mov_b32 s71, 18432
    s_mul_i32 s97, s96, 2048
    s_add_u32 s97, s97, 82944
    s_add_u32 s67, s97, s95
    s_mul_i32 s97, s96, 2048
    s_add_u32 s97, s97, 119808
    s_add_u32 s68, s97, s95
    s_mul_i32 s97, s96, 1024
    s_add_u32 s97, s97, 156672
    s_add_u32 s69, s97, s95
L_ue_75:
    s_add_u32 s96, s67, s71
    s_add_u32 s61, s68, s71
    s_lshr_b32 s97, s93, 1
    s_cmp_eq_u32 s97, s94
    s_cselect_b32 s58, s67, s68
    s_cselect_b32 s59, s96, s67
    s_cselect_b32 s60, s68, s96
L_udone_72:
    s_lshl_b32 s95, s64, 6
    s_add_u32 s95, s95, s66
    s_lshl_b32 s95, s95, 3
    s_add_u32 s66, s95, 139264
    v_lshrrev_b32 v64, 4, v1
    v_bfe_u32 v66, v1, 2, 2
    v_lshl_add_u32 v64, v64, 3, v66
    v_mul_u32_u24 v64, 288, v64
    v_add_u32 v64, s55, v64
    v_and_b32 v66, 3, v1
    v_lshl_add_u32 v65, v66, 3, v64
    v_add_u32 v65, s63, v65
    v_lshl_add_u32 v64, v66, 4, v64
    v_add_u32 v64, s62, v64
    ds_read_b64_tr_b16 v[180:181], v64 offset:0
    ds_read_b64_tr_b16 v[182:183], v64 offset:1152
    ds_read_b64_tr_b16 v[184:185], v64 offset:8
    ds_read_b64_tr_b16 v[186:187], v64 offset:1160
    ds_read_b64_tr_b16 v[188:189], v64 offset:64
    ds_read_b64_tr_b16 v[190:191], v64 offset:1216
    ds_read_b64_tr_b16 v[192:193], v64 offset:72
    ds_read_b64_tr_b16 v[194:195], v64 offset:1224
    ds_read_b64_tr_b16 v[196:197], v64 offset:128
    ds_read_b64_tr_b16 v[198:199], v64 offset:1280
    ds_read_b64_tr_b16 v[200:201], v64 offset:136
    ds_read_b64_tr_b16 v[202:203], v64 offset:1288
    ds_read_b64_tr_b16 v[204:205], v64 offset:192
    ds_read_b64_tr_b16 v[206:207], v64 offset:1344
    ds_read_b64_tr_b16 v[208:209], v64 offset:200
    ds_read_b64_tr_b16 v[210:211], v64 offset:1352
    ds_read_b64_tr_b16 v[212:213], v65 offset:0
    ds_read_b64_tr_b16 v[214:215], v65 offset:1152
    s_cmp_eq_u32 s65, 0
    s_cbranch_scc1 L_nocs_76
    v_mov_b32 v68, 0x3f803f80
    v_mov_b32 v69, 0x3f803f80
    v_mov_b32 v70, 0x3f803f80
    v_mov_b32 v71, 0x3f803f80
    s_waitcnt lgkmcnt(15)
    s_nop 0
    v_mfma_f32_16x16x32_bf16 v[72:75], v[180:183], v[68:71], 0
    s_waitcnt lgkmcnt(14)
    v_mfma_f32_16x16x32_bf16 v[76:79], v[184:187], v[68:71], 0
    s_waitcnt lgkmcnt(12)
    v_mfma_f32_16x16x32_bf16 v[80:83], v[188:191], v[68:71], 0
    s_waitcnt lgkmcnt(10)
    v_mfma_f32_16x16x32_bf16 v[84:87], v[192:195], v[68:71], 0
    s_waitcnt lgkmcnt(8)
    v_mfma_f32_16x16x32_bf16 v[88:91], v[196:199], v[68:71], 0
    s_waitcnt lgkmcnt(6)
    v_mfma_f32_16x16x32_bf16 v[92:95], v[200:203], v[68:71], 0
    s_waitcnt lgkmcnt(4)
    v_mfma_f32_16x16x32_bf16 v[96:99], v[204:207], v[68:71], 0
    s_waitcnt lgkmcnt(2)
    v_mfma_f32_16x16x32_bf16 v[100:103], v[208:211], v[68:71], 0
    s_waitcnt lgkmcnt(0)
    v_mfma_f32_16x16x32_bf16 v[104:107], v[212:215], v[68:71], 0
    v_and_b32 v66, 15, v1
    v_add_u32 v67, 1, v66
    v_cmp_gt_u32 vcc, 8, v66
    v_and_b32 v64, 48, v1
    s_nop 0
    v_cndmask_b32 v67, 0, v67, vcc
    v_cmp_eq_u32 vcc, 9, v66
    s_nop 1
    v_cndmask_b32 v67, v67, v66, vcc
    v_lshlrev_b32 v67, 6, v67
    v_add_u32 v67, v67, v64
    v_cmp_eq_u32 vcc, 1, v66
    s_nop 1
    v_cndmask_b32 v72, v72, v76, vcc
    v_cndmask_b32 v73, v73, v77, vcc
    v_cndmask_b32 v74, v74, v78, vcc
    v_cndmask_b32 v75, v75, v79, vcc
    v_cmp_eq_u32 vcc, 2, v66
    s_nop 1
    v_cndmask_b32 v72, v72, v80, vcc
    v_cndmask_b32 v73, v73, v81, vcc
    v_cndmask_b32 v74, v74, v82, vcc
    v_cndmask_b32 v75, v75, v83, vcc
    v_cmp_eq_u32 vcc, 3, v66
    s_nop 1
    v_cndmask_b32 v72, v72, v84, vcc
    v_cndmask_b32 v73, v73, v85, vcc
    v_cndmask_b32 v74, v74, v86, vcc
    v_cndmask_b32 v75, v75, v87, vcc
    v_cmp_eq_u32 vcc, 4, v66
    s_nop 1
    v_cndmask_b32 v72, v72, v88, vcc
    v_cndmask_b32 v73, v73, v89, vcc
    v_cndmask_b32 v74, v74, v90, vcc
    v_cndmask_b32 v75, v75, v91, vcc
    v_cmp_eq_u32 vcc, 5, v66
    s_nop 1
    v_cndmask_b32 v72, v72, v92, vcc
    v_cndmask_b32 v73, v73, v93, vcc
    v_cndmask_b32 v74, v74, v94, vcc
    v_cndmask_b32 v75, v75, v95, vcc
    v_cmp_eq_u32 vcc, 6, v66
    s_nop 1
    v_cndmask_b32 v72, v72, v96, vcc
    v_cndmask_b32 v73, v73, v97, vcc
    v_cndmask_b32 v74, v74, v98, vcc
    v_cndmask_b32 v75, v75, v99, vcc
    v_cmp_eq_u32 vcc, 7, v66
    s_nop 1
    v_cndmask_b32 v72, v72, v100, vcc
    v_cndmask_b32 v73, v73, v101, vcc
    v_cndmask_b32 v74, v74, v102, vcc
    v_cndmask_b32 v75, v75, v103, vcc
    v_cmp_eq_u32 vcc, 8, v66
    s_nop 1
    v_cndmask_b32 v72, v72, v104, vcc
    v_cndmask_b32 v73, v73, v105, vcc
    v_cndmask_b32 v74, v74, v106, vcc
    v_cndmask_b32 v75, v75, v107, vcc
    s_mov_b32 exec_lo, 0x03ff03ff
    s_mov_b32 exec_hi, 0x03ff03ff
    buffer_store_dwordx4 v[72:75], v67, s[4:7], s65 offen sc1
    s_mov_b64 exec, -1
L_nocs_76:
    v_mov_b32 v8, s98
    v_mov_b32 v9, s99
    s_waitcnt vmcnt(0)
    s_lshl_b32 s44, s44, 2
    s_add_u32 s44, s44, 0x8000000
    s_mov_b64 exec, 1
    buffer_store_dwordx2 v[8:9], off, s[4:7], s44 sc1
    s_mov_b64 exec, -1
    s_waitcnt lgkmcnt(15)
    buffer_store_dwordx4 v[180:183], v2, s[4:7], s58 offen sc1
    s_add_u32 s92, s58, s70
    s_waitcnt lgkmcnt(14)
    buffer_store_dwordx4 v[184:187], v2, s[4:7], s92 offen sc1
    s_waitcnt lgkmcnt(12)
    buffer_store_dwordx4 v[188:191], v2, s[4:7], s59 offen sc1
    s_add_u32 s92, s59, s70
    s_waitcnt lgkmcnt(10)
    buffer_store_dwordx4 v[192:195], v2, s[4:7], s92 offen sc1
    s_waitcnt lgkmcnt(8)
    buffer_store_dwordx4 v[196:199], v2, s[4:7], s60 offen sc1
    s_add_u32 s92, s60, s70
    s_waitcnt lgkmcnt(6)
    buffer_store_dwordx4 v[200:203], v2, s[4:7], s92 offen sc1
    s_waitcnt lgkmcnt(4)
    buffer_store_dwordx4 v[204:207], v2, s[4:7], s61 offen sc1
    s_add_u32 s92, s61, s70
    s_waitcnt lgkmcnt(2)
    buffer_store_dwordx4 v[208:211], v2, s[4:7], s92 offen sc1
    s_waitcnt lgkmcnt(0)
    buffer_store_dwordx4 v[212:215], v2, s[4:7], s69 offen sc1
    s_mov_b32 s3, s66
    s_mov_b32 s0, 0
    s_and_b32 s23, s21, 7
    s_lshl_b32 s23, s23, 2
    s_and_b32 s1, s22, 3
    s_add_u32 s1, s1, s23
    s_lshl_b32 s1, s1, 9
    s_add_u32 s1, s1, 139264
    v_min_u32 v14, 35, v1
    v_lshlrev_b32 v14, 3, v14
    s_lshl_b32 s1, s1, 2
    s_add_u32 s1, s1, 0x8000000
    v_lshlrev_b32 v14, 2, v14
    buffer_load_dwordx2 v[12:13], v14, s[4:7], s1 offen sc1
L_ffn_50:
    s_barrier
    s_lshr_b32 s44, s22, 2
    s_and_b32 s60, s21, 0
    s_add_u32 s44, s44, s60
    s_and_b32 s60, s21, 7
    s_lshl_b32 s60, s60, 2
    s_and_b32 s47, s22, 3
    s_add_u32 s47, s47, s60
    s_lshl_b32 s64, s47, 9
    s_add_u32 s64, s64, 139264
    s_lshr_b32 s45, s47, 2
    s_and_b32 s46, s47, 3
    s_mul_i32 s48, s47, 497664
    s_add_u32 s48, s48, 4194304
    s_mul_i32 s63, s20, 9
    s_lshr_b32 s63, s63, 1
    s_lshl_b32 s63, s63, 10
    s_add_u32 s62, s48, s63
    s_mul_i32 s49, s20, 9216
    s_add_u32 s48, s48, s49
    s_lshl_b32 s54, s44, 4
    s_lshl_b32 s60, s20, 2
    s_add_u32 s54, s54, s60
    s_mul_i32 s50, s54, 18432
    s_mul_i32 s53, s45, 2359296
    s_add_u32 s53, s53, s50
    s_add_u32 s50, s50, 4718592
    s_add_u32 s50, s50, s100
    s_lshr_b32 s60, s46, 1
    s_mul_i32 s60, s60, 9216
    s_add_u32 s53, s53, s60
    s_add_u32 s53, s53, 29360128
    s_add_u32 s53, s53, 20971520
    v_lshlrev_b32 v3, 3, v1
    v_mov_b32 v4, v2
    s_cmp_lg_u32 s101, 0
    s_cbranch_scc1 L_nopw_77
    s_waitcnt vmcnt(0)
    v_cmp_eq_u64 vcc, s[98:99], v[12:13]
    s_nop 0
    s_cmp_eq_u64 vcc, exec
    s_cbranch_scc0 L_pw_slow_53
L_pw_back_54:
L_nopw_77:
    s_add_u32 m0, s49, 0
    s_add_u32 s61, s48, 0
    buffer_load_dwordx4 v2, s[4:7], s61 offen offset:0 lds
    buffer_load_dwordx4 v2, s[4:7], s61 offen offset:1024 lds
    buffer_load_dwordx4 v2, s[4:7], s61 offen offset:2048 lds
    buffer_load_dwordx4 v2, s[4:7], s61 offen offset:3072 lds
    s_add_u32 m0, s49, 4096
    s_add_u32 s61, s48, 4096
    buffer_load_dwordx4 v2, s[4:7], s61 offen offset:0 lds
    buffer_load_dwordx4 v2, s[4:7], s61 offen offset:1024 lds
    buffer_load_dwordx4 v2, s[4:7], s61 offen offset:2048 lds
    buffer_load_dwordx4 v2, s[4:7], s61 offen offset:3072 lds
    s_add_u32 m0, s49, 8192
    s_add_u32 s61, s48, 8192
    buffer_load_dwordx4 v2, s[4:7], s61 offen offset:0 lds
    s_add_u32 m0, s49, 36864
    s_add_u32 s61, s48, 36864
    buffer_load_dwordx4 v2, s[4:7], s61 offen offset:0 lds
    buffer_load_dwordx4 v2, s[4:7], s61 offen offset:1024 lds
    buffer_load_dwordx4 v2, s[4:7], s61 offen offset:2048 lds
    buffer_load_dwordx4 v2, s[4:7], s61 offen offset:3072 lds
    s_add_u32 m0, s49, 40960
    s_add_u32 s61, s48, 40960
    buffer_load_dwordx4 v2, s[4:7], s61 offen offset:0 lds
    buffer_load_dwordx4 v2, s[4:7], s61 offen offset:1024 lds
    buffer_load_dwordx4 v2, s[4:7], s61 offen offset:2048 lds
    buffer_load_dwordx4 v2, s[4:7], s61 offen offset:3072 lds
    s_add_u32 m0, s49, 45056
    s_add_u32 s61, s48, 45056
    buffer_load_dwordx4 v2, s[4:7], s61 offen offset:0 lds
    s_add_u32 m0, s49, 73728
    s_add_u32 s61, s48, 73728
    buffer_load_dwordx4 v2, s[4:7], s61 offen offset:0 lds
    buffer_load_dwordx4 v2, s[4:7], s61 offen offset:1024 lds
    buffer_load_dwordx4 v2, s[4:7], s61 offen offset:2048 lds
    buffer_load_dwordx4 v2, s[4:7], s61 offen offset:3072 lds
    s_add_u32 m0, s49, 77824
    s_add_u32 s61, s48, 77824
    buffer_load_dwordx4 v2, s[4:7], s61 offen offset:0 lds
    buffer_load_dwordx4 v2, s[4:7], s61 offen offset:1024 lds
    buffer_load_dwordx4 v2, s[4:7], s61 offen offset:2048 lds
    buffer_load_dwordx4 v2, s[4:7], s61 offen offset:3072 lds
    s_add_u32 m0, s49, 81920
    s_add_u32 s61, s48, 81920
    buffer_load_dwordx4 v2, s[4:7], s61 offen offset:0 lds
    s_cmp_lg_u32 s101, 0
    s_cbranch_scc1 L_nocs_78
    s_cmp_ge_u32 s20, 2
    s_cbranch_scc1 L_nocs_78
    s_lshl_b32 s60, s47, 1
    s_add_u32 s60, s60, s20
    s_mul_i32 s60, s60, 11520
    s_add_u32 s60, s60, 2883584
    v_lshrrev_b32 v6, 2, v1
    v_lshlrev_b32 v6, 7, v6
    v_and_b32 v7, 3, v1
    v_lshl_add_u32 v6, v7, 4, v6
    s_lshl_b32 s61, s20, 6
    s_add_u32 s61, s61, 147456
    v_add_u32 v6, s61, v6
    s_mov_b32 exec_hi, 15
    buffer_load_dwordx4 v[64:67], v2, s[4:7], s60 offen offset:0 sc1
    buffer_load_dwordx4 v[68:71], v2, s[4:7], s60 offen offset:640 sc1
    buffer_load_dwordx4 v[72:75], v2, s[4:7], s60 offen offset:1280 sc1
    buffer_load_dwordx4 v[76:79], v2, s[4:7], s60 offen offset:1920 sc1
    buffer_load_dwordx4 v[80:83], v2, s[4:7], s60 offen offset:2560 sc1
    buffer_load_dwordx4 v[84:87], v2, s[4:7], s60 offen offset:3200 sc1
    s_add_u32 s60, s60, 3840
    buffer_load_dwordx4 v[88:91], v2, s[4:7], s60 offen offset:0 sc1
    buffer_load_dwordx4 v[92:95], v2, s[4:7], s60 offen offset:640 sc1
    buffer_load_dwordx4 v[96:99], v2, s[4:7], s60 offen offset:1280 sc1
    buffer_load_dwordx4 v[100:103], v2, s[4:7], s60 offen offset:1920 sc1
    buffer_load_dwordx4 v[104:107], v2, s[4:7], s60 offen offset:2560 sc1
    buffer_load_dwordx4 v[108:111], v2, s[4:7], s60 offen offset:3200 sc1
    s_add_u32 s60, s60, 3840
    buffer_load_dwordx4 v[112:115], v2, s[4:7], s60 offen offset:0 sc1
    buffer_load_dwordx4 v[116:119], v2, s[4:7], s60 offen offset:640 sc1
    buffer_load_dwordx4 v[120:123], v2, s[4:7], s60 offen offset:1280 sc1
    buffer_load_dwordx4 v[124:127], v2, s[4:7], s60 offen offset:1920 sc1
    buffer_load_dwordx4 v[128:131], v2, s[4:7], s60 offen offset:2560 sc1
    buffer_load_dwordx4 v[132:135], v2, s[4:7], s60 offen offset:3200 sc1
    s_waitcnt vmcnt(16)
    v_add_f32 v64, v64, v68
    v_add_f32 v65, v65, v69
    v_add_f32 v66, v66, v70
    v_add_f32 v67, v67, v71
    s_waitcnt vmcnt(15)
    v_add_f32 v64, v64, v72
    v_add_f32 v65, v65, v73
    v_add_f32 v66, v66, v74
    v_add_f32 v67, v67, v75
    s_waitcnt vmcnt(14)
    v_add_f32 v64, v64, v76
    v_add_f32 v65, v65, v77
    v_add_f32 v66, v66, v78
    v_add_f32 v67, v67, v79
    s_waitcnt vmcnt(13)
    v_add_f32 v64, v64, v80
    v_add_f32 v65, v65, v81
    v_add_f32 v66, v66, v82
    v_add_f32 v67, v67, v83
    s_waitcnt vmcnt(12)
    v_add_f32 v64, v64, v84
    v_add_f32 v65, v65, v85
    v_add_f32 v66, v66, v86
    v_add_f32 v67, v67, v87
    s_waitcnt vmcnt(11)
    v_add_f32 v64, v64, v88
    v_add_f32 v65, v65, v89
    v_add_f32 v66, v66, v90
    v_add_f32 v67, v67, v91
    s_waitcnt vmcnt(10)
    v_add_f32 v64, v64, v92
    v_add_f32 v65, v65, v93
    v_add_f32 v66, v66, v94
    v_add_f32 v67, v67, v95
    s_waitcnt vmcnt(9)
    v_add_f32 v64, v64, v96
    v_add_f32 v65, v65, v97
    v_add_f32 v66, v66, v98
    v_add_f32 v67, v67, v99
    s_waitcnt vmcnt(8)
    v_add_f32 v64, v64, v100
    v_add_f32 v65, v65, v101
    v_add_f32 v66, v66, v102
    v_add_f32 v67, v67, v103
    s_waitcnt vmcnt(7)
    v_add_f32 v64, v64, v104
    v_add_f32 v65, v65, v105
    v_add_f32 v66, v66, v106
    v_add_f32 v67, v67, v107
    s_waitcnt vmcnt(6)
    v_add_f32 v64, v64, v108
    v_add_f32 v65, v65, v109
    v_add_f32 v66, v66, v110
    v_add_f32 v67, v67, v111
    s_waitcnt vmcnt(5)
    v_add_f32 v64, v64, v112
    v_add_f32 v65, v65, v113
    v_add_f32 v66, v66, v114
    v_add_f32 v67, v67, v115
    s_waitcnt vmcnt(4)
    v_add_f32 v64, v64, v116
    v_add_f32 v65, v65, v117
    v_add_f32 v66, v66, v118
    v_add_f32 v67, v67, v119
    s_waitcnt vmcnt(3)
    v_add_f32 v64, v64, v120
    v_add_f32 v65, v65, v121
    v_add_f32 v66, v66, v122
    v_add_f32 v67, v67, v123
    s_waitcnt vmcnt(2)
    v_add_f32 v64, v64, v124
    v_add_f32 v65, v65, v125
    v_add_f32 v66, v66, v126
    v_add_f32 v67, v67, v127
    s_waitcnt vmcnt(1)
    v_add_f32 v64, v64, v128
    v_add_f32 v65, v65, v129
    v_add_f32 v66, v66, v130
    v_add_f32 v67, v67, v131
    s_waitcnt vmcnt(0)
    v_add_f32 v64, v64, v132
    v_add_f32 v65, v65, v133
    v_add_f32 v66, v66, v134
    v_add_f32 v67, v67, v135
    ds_write_b128 v6, v[64:67]
    s_mov_b64 exec, -1
    s_waitcnt lgkmcnt(0)
L_nocs_78:
    s_lshr_b32 s60, s54, 2
    s_lshl_b32 s60, s60, 8
    s_add_u32 s55, s101, 32768
    v_and_b32 v7, 7, v1
    v_min_u32 v7, 5, v7
    v_and_b32 v6, 24, v1
    v_add_lshl_u32 v0, v7, v6, 3
    v_add_u32 v0, s60, v0
    s_lshl_b32 s60, s21, 4
    s_lshr_b32 s61, s22, 1
    s_add_u32 s60, s60, s61
    s_lshl_b32 s60, s60, 6
    v_lshl_add_u32 v7, v7, 3, s60
    v_cmp_gt_u32 vcc, 32, v1
    s_nop 1
    v_cndmask_b32 v0, v7, v0, vcc
    s_lshl_b32 s55, s55, 2
    s_add_u32 s55, s55, 0x8000000
    v_lshlrev_b32 v0, 2, v0
    buffer_load_dwordx2 v[168:169], v0, s[4:7], s55 offen sc1
    s_lshl_b32 s60, s44, 5
    s_add_u32 s60, s60, s47
    s_mul_i32 s51, s60, 73728
    s_add_u32 s51, s51, 9699328
    s_add_u32 s51, s51, 20971520
    s_xor_b32 s61, s60, 1
    s_mul_i32 s56, s61, 73728
    s_add_u32 s56, s56, 9699328
    s_add_u32 s56, s56, 20971520
    s_xor_b32 s61, s60, 2
    s_mul_i32 s57, s61, 73728
    s_add_u32 s57, s57, 9699328
    s_add_u32 s57, s57, 20971520
    s_xor_b32 s61, s60, 3
    s_mul_i32 s58, s61, 73728
    s_add_u32 s58, s58, 9699328
    s_add_u32 s58, s58, 20971520
    s_lshr_b32 s52, s60, 2
    s_lshl_b32 s52, s52, 2
    s_add_u32 s52, s52, s20
    s_lshl_b32 s52, s52, 7
    s_lshl_b32 s61, s101, 2
    s_add_u32 s52, s52, s61
    s_add_u32 s52, s52, 49152
    v_lshrrev_b32 v5, 4, v1
    v_lshlrev_b32 v5, 4, v5
    v_add_u32 v5, 147456, v5
    s_lshl_b32 s60, s20, 12
    s_add_u32 s51, s51, s60
    s_add_u32 s56, s56, s60
    s_add_u32 s57, s57, s60
    s_add_u32 s58, s58, s60
    s_lshl_b32 s65, s20, 11
    s_sub_u32 s65, 65536, s65
    s_lshl_b32 s67, s46, 3
    s_add_u32 s67, s67, s52
    s_waitcnt vmcnt(1)
    s_barrier
    ds_read_b128 v[8:11], v4 offset:0
    ds_read_b128 v[12:15], v4 offset:1024
    ds_read_b128 v[16:19], v4 offset:36864
    ds_read_b128 v[20:23], v4 offset:37888
    s_and_b32 s61, s22, 3
    s_mul_i32 s61, s61, 18432
    s_add_u32 s61, s61, s50
    s_waitcnt vmcnt(0)
    v_cmp_eq_u64 vcc, s[98:99], v[168:169]
    s_nop 0
    s_cmp_eq_u64 vcc, exec
    s_cbranch_scc0 L_p1_slow_79
L_p1_back_80:
    s_cmp_eq_u32 s0, 0
    s_cbranch_scc1 L_nopend_82
    v_mov_b32 v6, s98
    v_mov_b32 v7, s99
    s_lshl_b32 s0, s0, 2
    s_add_u32 s0, s0, 0x8000000
    s_mov_b64 exec, 1
    buffer_store_dwordx2 v[6:7], off, s[4:7], s0 sc1
    s_mov_b64 exec, -1
    s_mov_b32 s0, 0
L_nopend_82:
    s_cmp_eq_u32 s3, 0
    s_cbranch_scc1 L_nopend_83
    v_mov_b32 v6, s98
    v_mov_b32 v7, s99
    s_lshl_b32 s3, s3, 2
    s_add_u32 s3, s3, 0x8000000
    s_mov_b64 exec, 1
    buffer_store_dwordx2 v[6:7], off, s[4:7], s3 sc1
    s_mov_b64 exec, -1
    s_mov_b32 s3, 0
L_nopend_83:
    s_add_u32 s59, s50, 0
    buffer_load_dwordx4 a[0:3], v2, s[4:7], s59 offen offset:0 sc1
    s_add_u32 s66, s50, 18432
    buffer_load_dwordx4 a[4:7], v2, s[4:7], s66 offen offset:0 sc1
    s_add_u32 s68, s50, 36864
    buffer_load_dwordx4 a[8:11], v2, s[4:7], s68 offen offset:0 sc1
    s_add_u32 s69, s50, 55296
    buffer_load_dwordx4 a[12:15], v2, s[4:7], s69 offen offset:0 sc1
    buffer_load_dwordx4 a[16:19], v2, s[4:7], s59 offen offset:1024 sc1
    buffer_load_dwordx4 a[20:23], v2, s[4:7], s66 offen offset:1024 sc1
    buffer_load_dwordx4 a[24:27], v2, s[4:7], s68 offen offset:1024 sc1
    buffer_load_dwordx4 a[28:31], v2, s[4:7], s69 offen offset:1024 sc1
    s_lshl_b32 s60, s54, 4
    v_add_u32 v6, s60, v1
    v_lshlrev_b32 v6, 3, v6
    s_add_u32 s55, s100, 7077888
    s_add_u32 s60, s55, 0
    buffer_load_dwordx2 v[152:153], v6, s[4:7], s60 offen sc1
    s_add_u32 s60, s55, 16384
    buffer_load_dwordx2 v[154:155], v6, s[4:7], s60 offen sc1
    s_add_u32 s60, s55, 32768
    buffer_load_dwordx2 v[156:157], v6, s[4:7], s60 offen sc1
    s_add_u32 s60, s55, 49152
    buffer_load_dwordx2 v[158:159], v6, s[4:7], s60 offen sc1
    s_add_u32 s60, s55, 65536
    buffer_load_dwordx2 v[160:161], v6, s[4:7], s60 offen sc1
    s_add_u32 s60, s55, 81920
    buffer_load_dwordx2 v[162:163], v6, s[4:7], s60 offen sc1
    v_add_u32 v7, 0x10000, v2
    buffer_load_dwordx4 a[32:35], v2, s[4:7], s59 offen offset:2048 sc1
    buffer_load_dwordx4 a[36:39], v2, s[4:7], s66 offen offset:2048 sc1
    buffer_load_dwordx4 a[40:43], v2, s[4:7], s68 offen offset:2048 sc1
    buffer_load_dwordx4 a[44:47], v2, s[4:7], s69 offen offset:2048 sc1
    s_waitcnt vmcnt(17) lgkmcnt(3)
    v_mfma_f32_16x16x32_bf16 v[208:211], v[8:11], a[0:3], 0
    s_waitcnt vmcnt(16)
    ds_read_b128 v[24:27], v7 offset:8192
    v_mfma_f32_16x16x32_bf16 v[212:215], v[8:11], a[4:7], 0
    s_waitcnt vmcnt(15)
    v_mfma_f32_16x16x32_bf16 v[216:219], v[8:11], a[8:11], 0
    s_waitcnt vmcnt(14)
    v_mfma_f32_16x16x32_bf16 v[220:223], v[8:11], a[12:15], 0
    s_waitcnt lgkmcnt(3)
    v_mfma_f32_16x16x32_bf16 v[224:227], v[12:15], a[0:3], 0
    ds_read_b128 v[28:31], v7 offset:9216
    v_mfma_f32_16x16x32_bf16 v[228:231], v[12:15], a[4:7], 0
    buffer_load_dwordx4 a[48:51], v2, s[4:7], s59 offen offset:3072 sc1
    v_mfma_f32_16x16x32_bf16 v[232:235], v[12:15], a[8:11], 0
    v_mfma_f32_16x16x32_bf16 v[236:239], v[12:15], a[12:15], 0
    s_waitcnt lgkmcnt(3)
    v_mfma_f32_16x16x32_bf16 v[64:67], v[16:19], a[0:3], 0
    ds_read_b128 v[8:11], v4 offset:2048
    v_mfma_f32_16x16x32_bf16 v[68:71], v[16:19], a[4:7], 0
    buffer_load_dwordx4 a[52:55], v2, s[4:7], s66 offen offset:3072 sc1
    v_mfma_f32_16x16x32_bf16 v[72:75], v[16:19], a[8:11], 0
    v_mfma_f32_16x16x32_bf16 v[76:79], v[16:19], a[12:15], 0
    buffer_load_dwordx4 a[56:59], v2, s[4:7], s68 offen offset:3072 sc1
    buffer_load_dwordx4 a[60:63], v2, s[4:7], s69 offen offset:3072 sc1
    s_waitcnt lgkmcnt(3)
    v_mfma_f32_16x16x32_bf16 v[80:83], v[20:23], a[0:3], 0
    s_add_u32 s59, s50, 4096
    ds_read_b128 v[12:15], v4 offset:3072
    v_mfma_f32_16x16x32_bf16 v[84:87], v[20:23], a[4:7], 0
    v_mfma_f32_16x16x32_bf16 v[88:91], v[20:23], a[8:11], 0
    v_mfma_f32_16x16x32_bf16 v[92:95], v[20:23], a[12:15], 0
    s_waitcnt lgkmcnt(3)
    v_mfma_f32_16x16x32_bf16 v[96:99], v[24:27], a[0:3], 0
    ds_read_b128 v[16:19], v4 offset:38912
    v_mfma_f32_16x16x32_bf16 v[100:103], v[24:27], a[4:7], 0
    buffer_load_dwordx4 a[64:67], v2, s[4:7], s59 offen offset:0 sc1
    v_mfma_f32_16x16x32_bf16 v[104:107], v[24:27], a[8:11], 0
    s_add_u32 s66, s50, 22528
    v_mfma_f32_16x16x32_bf16 v[108:111], v[24:27], a[12:15], 0
    s_waitcnt lgkmcnt(3)
    v_mfma_f32_16x16x32_bf16 v[112:115], v[28:31], a[0:3], 0
    ds_read_b128 v[20:23], v4 offset:39936
    v_mfma_f32_16x16x32_bf16 v[116:119], v[28:31], a[4:7], 0
    buffer_load_dwordx4 a[68:71], v2, s[4:7], s66 offen offset:0 sc1
    v_mfma_f32_16x16x32_bf16 v[120:123], v[28:31], a[8:11], 0
    s_add_u32 s68, s50, 40960
    v_mfma_f32_16x16x32_bf16 v[124:127], v[28:31], a[12:15], 0
    s_waitcnt vmcnt(19) lgkmcnt(3)
    v_mfma_f32_16x16x32_bf16 v[208:211], v[8:11], a[16:19], v[208:211]
    s_waitcnt vmcnt(18)
    ds_read_b128 v[24:27], v7 offset:10240
    v_mfma_f32_16x16x32_bf16 v[212:215], v[8:11], a[20:23], v[212:215]
    buffer_load_dwordx4 a[72:75], v2, s[4:7], s68 offen offset:0 sc1
    s_waitcnt vmcnt(18)
    v_mfma_f32_16x16x32_bf16 v[216:219], v[8:11], a[24:27], v[216:219]
    s_waitcnt vmcnt(17)
    s_add_u32 s69, s50, 59392
    v_mfma_f32_16x16x32_bf16 v[220:223], v[8:11], a[28:31], v[220:223]
    s_waitcnt lgkmcnt(3)
    v_mfma_f32_16x16x32_bf16 v[224:227], v[12:15], a[16:19], v[224:227]
    ds_read_b128 v[28:31], v7 offset:11264
    v_mfma_f32_16x16x32_bf16 v[228:231], v[12:15], a[20:23], v[228:231]
    buffer_load_dwordx4 a[76:79], v2, s[4:7], s69 offen offset:0 sc1
    v_mfma_f32_16x16x32_bf16 v[232:235], v[12:15], a[24:27], v[232:235]
    v_mfma_f32_16x16x32_bf16 v[236:239], v[12:15], a[28:31], v[236:239]
    s_waitcnt lgkmcnt(3)
    v_mfma_f32_16x16x32_bf16 v[64:67], v[16:19], a[16:19], v[64:67]
    ds_read_b128 v[8:11], v4 offset:4096
    v_mfma_f32_16x16x32_bf16 v[68:71], v[16:19], a[20:23], v[68:71]
    buffer_load_dwordx4 a[80:83], v2, s[4:7], s59 offen offset:1024 sc1
    v_mfma_f32_16x16x32_bf16 v[72:75], v[16:19], a[24:27], v[72:75]
    v_mfma_f32_16x16x32_bf16 v[76:79], v[16:19], a[28:31], v[76:79]
    s_waitcnt lgkmcnt(3)
    v_mfma_f32_16x16x32_bf16 v[80:83], v[20:23], a[16:19], v[80:83]
    ds_read_b128 v[12:15], v4 offset:5120
    v_mfma_f32_16x16x32_bf16 v[84:87], v[20:23], a[20:23], v[84:87]
    buffer_load_dwordx4 a[84:87], v2, s[4:7], s66 offen offset:1024 sc1
    v_mfma_f32_16x16x32_bf16 v[88:91], v[20:23], a[24:27], v[88:91]
    v_mfma_f32_16x16x32_bf16 v[92:95], v[20:23], a[28:31], v[92:95]
    s_waitcnt lgkmcnt(3)
    v_mfma_f32_16x16x32_bf16 v[96:99], v[24:27], a[16:19], v[96:99]
    ds_read_b128 v[16:19], v4 offset:40960
    v_mfma_f32_16x16x32_bf16 v[100:103], v[24:27], a[20:23], v[100:103]
    buffer_load_dwordx4 a[88:91], v2, s[4:7], s68 offen offset:1024 sc1
    v_mfma_f32_16x16x32_bf16 v[104:107], v[24:27], a[24:27], v[104:107]
    v_mfma_f32_16x16x32_bf16 v[108:111], v[24:27], a[28:31], v[108:111]
    s_waitcnt lgkmcnt(3)
    v_mfma_f32_16x16x32_bf16 v[112:115], v[28:31], a[16:19], v[112:115]
    ds_read_b128 v[20:23], v4 offset:41984
    v_mfma_f32_16x16x32_bf16 v[116:119], v[28:31], a[20:23], v[116:119]
    buffer_load_dwordx4 a[92:95], v2, s[4:7], s69 offen offset:1024 sc1
    v_mfma_f32_16x16x32_bf16 v[120:123], v[28:31], a[24:27], v[120:123]
    v_mfma_f32_16x16x32_bf16 v[124:127], v[28:31], a[28:31], v[124:127]
    s_waitcnt vmcnt(15) lgkmcnt(3)
    v_mfma_f32_16x16x32_bf16 v[208:211], v[8:11], a[32:35], v[208:211]
    s_waitcnt vmcnt(14)
    ds_read_b128 v[24:27], v7 offset:12288
    v_mfma_f32_16x16x32_bf16 v[212:215], v[8:11], a[36:39], v[212:215]
    buffer_load_dwordx4 a[96:99], v2, s[4:7], s59 offen offset:2048 sc1
    s_waitcnt vmcnt(14)
    v_mfma_f32_16x16x32_bf16 v[216:219], v[8:11], a[40:43], v[216:219]
    s_waitcnt vmcnt(13)
    v_mfma_f32_16x16x32_bf16 v[220:223], v[8:11], a[44:47], v[220:223]
    s_waitcnt lgkmcnt(3)
    v_mfma_f32_16x16x32_bf16 v[224:227], v[12:15], a[32:35], v[224:227]
    ds_read_b128 v[28:31], v7 offset:13312
    v_mfma_f32_16x16x32_bf16 v[228:231], v[12:15], a[36:39], v[228:231]
    buffer_load_dwordx4 a[100:103], v2, s[4:7], s66 offen offset:2048 sc1
    v_mfma_f32_16x16x32_bf16 v[232:235], v[12:15], a[40:43], v[232:235]
    v_mfma_f32_16x16x32_bf16 v[236:239], v[12:15], a[44:47], v[236:239]
    s_waitcnt lgkmcnt(3)
    v_mfma_f32_16x16x32_bf16 v[64:67], v[16:19], a[32:35], v[64:67]
    ds_read_b128 v[8:11], v4 offset:6144
    v_mfma_f32_16x16x32_bf16 v[68:71], v[16:19], a[36:39], v[68:71]
    buffer_load_dwordx4 a[104:107], v2, s[4:7], s68 offen offset:2048 sc1
    v_mfma_f32_16x16x32_bf16 v[72:75], v[16:19], a[40:43], v[72:75]
    v_mfma_f32_16x16x32_bf16 v[76:79], v[16:19], a[44:47], v[76:79]
    s_waitcnt lgkmcnt(3)
    v_mfma_f32_16x16x32_bf16 v[80:83], v[20:23], a[32:35], v[80:83]
    ds_read_b128 v[12:15], v4 offset:7168
    v_mfma_f32_16x16x32_bf16 v[84:87], v[20:23], a[36:39], v[84:87]
    buffer_load_dwordx4 a[108:111], v2, s[4:7], s69 offen offset:2048 sc1
    v_mfma_f32_16x16x32_bf16 v[88:91], v[20:23], a[40:43], v[88:91]
    v_mfma_f32_16x16x32_bf16 v[92:95], v[20:23], a[44:47], v[92:95]
    s_waitcnt lgkmcnt(3)
    v_mfma_f32_16x16x32_bf16 v[96:99], v[24:27], a[32:35], v[96:99]
    ds_read_b128 v[16:19], v4 offset:43008
    v_mfma_f32_16x16x32_bf16 v[100:103], v[24:27], a[36:39], v[100:103]
    buffer_load_dwordx4 a[112:115], v2, s[4:7], s59 offen offset:3072 sc1
    v_mfma_f32_16x16x32_bf16 v[104:107], v[24:27], a[40:43], v[104:107]
    v_mfma_f32_16x16x32_bf16 v[108:111], v[24:27], a[44:47], v[108:111]
    s_waitcnt lgkmcnt(3)
    v_mfma_f32_16x16x32_bf16 v[112:115], v[28:31], a[32:35], v[112:115]
    ds_read_b128 v[20:23], v4 offset:44032
    v_mfma_f32_16x16x32_bf16 v[116:119], v[28:31], a[36:39], v[116:119]
    buffer_load_dwordx4 a[116:119], v2, s[4:7], s66 offen offset:3072 sc1
    v_mfma_f32_16x16x32_bf16 v[120:123], v[28:31], a[40:43], v[120:123]
    v_mfma_f32_16x16x32_bf16 v[124:127], v[28:31], a[44:47], v[124:127]
    s_waitcnt vmcnt(17) lgkmcnt(3)
    v_mfma_f32_16x16x32_bf16 v[208:211], v[8:11], a[48:51], v[208:211]
    s_waitcnt vmcnt(16)
    ds_read_b128 v[24:27], v7 offset:14336
    v_mfma_f32_16x16x32_bf16 v[212:215], v[8:11], a[52:55], v[212:215]
    buffer_load_dwordx4 a[120:123], v2, s[4:7], s68 offen offset:3072 sc1
    s_waitcnt vmcnt(16)
    v_mfma_f32_16x16x32_bf16 v[216:219], v[8:11], a[56:59], v[216:219]
    s_waitcnt vmcnt(15)
    v_mfma_f32_16x16x32_bf16 v[220:223], v[8:11], a[60:63], v[220:223]
    s_waitcnt lgkmcnt(3)
    v_mfma_f32_16x16x32_bf16 v[224:227], v[12:15], a[48:51], v[224:227]
    ds_read_b128 v[28:31], v7 offset:15360
    v_mfma_f32_16x16x32_bf16 v[228:231], v[12:15], a[52:55], v[228:231]
    buffer_load_dwordx4 a[124:127], v2, s[4:7], s69 offen offset:3072 sc1
    v_mfma_f32_16x16x32_bf16 v[232:235], v[12:15], a[56:59], v[232:235]
    s_add_u32 s59, s50, 8192
    v_mfma_f32_16x16x32_bf16 v[236:239], v[12:15], a[60:63], v[236:239]
    s_waitcnt lgkmcnt(3)
    v_mfma_f32_16x16x32_bf16 v[64:67], v[16:19], a[48:51], v[64:67]
    ds_read_b128 v[8:11], v4 offset:8192
    v_mfma_f32_16x16x32_bf16 v[68:71], v[16:19], a[52:55], v[68:71]
    buffer_load_dwordx4 a[128:131], v2, s[4:7], s59 offen offset:0 sc1
    v_mfma_f32_16x16x32_bf16 v[72:75], v[16:19], a[56:59], v[72:75]
    s_add_u32 s66, s50, 26624
    v_mfma_f32_16x16x32_bf16 v[76:79], v[16:19], a[60:63], v[76:79]
    s_waitcnt lgkmcnt(3)
    v_mfma_f32_16x16x32_bf16 v[80:83], v[20:23], a[48:51], v[80:83]
    ds_read_b128 v[12:15], v4 offset:9216
    v_mfma_f32_16x16x32_bf16 v[84:87], v[20:23], a[52:55], v[84:87]
    buffer_load_dwordx4 a[132:135], v2, s[4:7], s66 offen offset:0 sc1
    v_mfma_f32_16x16x32_bf16 v[88:91], v[20:23], a[56:59], v[88:91]
    s_add_u32 s68, s50, 45056
    v_mfma_f32_16x16x32_bf16 v[92:95], v[20:23], a[60:63], v[92:95]
    s_waitcnt lgkmcnt(3)
    v_mfma_f32_16x16x32_bf16 v[96:99], v[24:27], a[48:51], v[96:99]
    ds_read_b128 v[16:19], v4 offset:45056
    v_mfma_f32_16x16x32_bf16 v[100:103], v[24:27], a[52:55], v[100:103]
    buffer_load_dwordx4 a[136:139], v2, s[4:7], s68 offen offset:0 sc1
    v_mfma_f32_16x16x32_bf16 v[104:107], v[24:27], a[56:59], v[104:107]
    s_add_u32 s69, s50, 63488
    v_mfma_f32_16x16x32_bf16 v[108:111], v[24:27], a[60:63], v[108:111]
    s_waitcnt lgkmcnt(3)
    v_mfma_f32_16x16x32_bf16 v[112:115], v[28:31], a[48:51], v[112:115]
    ds_read_b128 v[20:23], v4 offset:46080
    v_mfma_f32_16x16x32_bf16 v[116:119], v[28:31], a[52:55], v[116:119]
    buffer_load_dwordx4 a[140:143], v2, s[4:7], s69 offen offset:0 sc1
    v_mfma_f32_16x16x32_bf16 v[120:123], v[28:31], a[56:59], v[120:123]
    v_mfma_f32_16x16x32_bf16 v[124:127], v[28:31], a[60:63], v[124:127]
    s_waitcnt vmcnt(19) lgkmcnt(3)
    v_mfma_f32_16x16x32_bf16 v[208:211], v[8:11], a[64:67], v[208:211]
    s_waitcnt vmcnt(18)
    ds_read_b128 v[24:27], v7 offset:16384
    v_mfma_f32_16x16x32_bf16 v[212:215], v[8:11], a[68:71], v[212:215]
    buffer_load_dwordx4 a[144:147], v2, s[4:7], s59 offen offset:1024 sc1
    s_waitcnt vmcnt(18)
    v_mfma_f32_16x16x32_bf16 v[216:219], v[8:11], a[72:75], v[216:219]
    s_waitcnt vmcnt(17)
    v_mfma_f32_16x16x32_bf16 v[220:223], v[8:11], a[76:79], v[220:223]
    s_waitcnt lgkmcnt(3)
    v_mfma_f32_16x16x32_bf16 v[224:227], v[12:15], a[64:67], v[224:227]
    ds_read_b128 v[28:31], v7 offset:17408
    v_mfma_f32_16x16x32_bf16 v[228:231], v[12:15], a[68:71], v[228:231]
    buffer_load_dwordx4 a[148:151], v2, s[4:7], s66 offen offset:1024 sc1
    v_mfma_f32_16x16x32_bf16 v[232:235], v[12:15], a[72:75], v[232:235]
    v_mfma_f32_16x16x32_bf16 v[236:239], v[12:15], a[76:79], v[236:239]
    s_waitcnt lgkmcnt(3)
    v_mfma_f32_16x16x32_bf16 v[64:67], v[16:19], a[64:67], v[64:67]
    ds_read_b128 v[8:11], v4 offset:10240
    v_mfma_f32_16x16x32_bf16 v[68:71], v[16:19], a[68:71], v[68:71]
    buffer_load_dwordx4 a[152:155], v2, s[4:7], s68 offen offset:1024 sc1
    v_mfma_f32_16x16x32_bf16 v[72:75], v[16:19], a[72:75], v[72:75]
    v_mfma_f32_16x16x32_bf16 v[76:79], v[16:19], a[76:79], v[76:79]
    s_waitcnt lgkmcnt(3)
    v_mfma_f32_16x16x32_bf16 v[80:83], v[20:23], a[64:67], v[80:83]
    ds_read_b128 v[12:15], v4 offset:11264
    v_mfma_f32_16x16x32_bf16 v[84:87], v[20:23], a[68:71], v[84:87]
    buffer_load_dwordx4 a[156:159], v2, s[4:7], s69 offen offset:1024 sc1
    v_mfma_f32_16x16x32_bf16 v[88:91], v[20:23], a[72:75], v[88:91]
    v_mfma_f32_16x16x32_bf16 v[92:95], v[20:23], a[76:79], v[92:95]
    s_waitcnt lgkmcnt(3)
    v_mfma_f32_16x16x32_bf16 v[96:99], v[24:27], a[64:67], v[96:99]
    ds_read_b128 v[16:19], v4 offset:47104
    v_mfma_f32_16x16x32_bf16 v[100:103], v[24:27], a[68:71], v[100:103]
    buffer_load_dwordx4 a[160:163], v2, s[4:7], s59 offen offset:2048 sc1
    v_mfma_f32_16x16x32_bf16 v[104:107], v[24:27], a[72:75], v[104:107]
    v_mfma_f32_16x16x32_bf16 v[108:111], v[24:27], a[76:79], v[108:111]
    s_waitcnt lgkmcnt(3)
    v_mfma_f32_16x16x32_bf16 v[112:115], v[28:31], a[64:67], v[112:115]
    ds_read_b128 v[20:23], v4 offset:48128
    v_mfma_f32_16x16x32_bf16 v[116:119], v[28:31], a[68:71], v[116:119]
    buffer_load_dwordx4 a[164:167], v2, s[4:7], s66 offen offset:2048 sc1
    v_mfma_f32_16x16x32_bf16 v[120:123], v[28:31], a[72:75], v[120:123]
    v_mfma_f32_16x16x32_bf16 v[124:127], v[28:31], a[76:79], v[124:127]
    s_waitcnt vmcnt(21) lgkmcnt(3)
    v_mfma_f32_16x16x32_bf16 v[208:211], v[8:11], a[80:83], v[208:211]
    s_waitcnt vmcnt(20)
    ds_read_b128 v[24:27], v7 offset:18432
    v_mfma_f32_16x16x32_bf16 v[212:215], v[8:11], a[84:87], v[212:215]
    buffer_load_dwordx4 a[168:171], v2, s[4:7], s68 offen offset:2048 sc1
    s_waitcnt vmcnt(20)
    v_mfma_f32_16x16x32_bf16 v[216:219], v[8:11], a[88:91], v[216:219]
    s_waitcnt vmcnt(19)
    v_mfma_f32_16x16x32_bf16 v[220:223], v[8:11], a[92:95], v[220:223]
    s_waitcnt lgkmcnt(3)
    v_mfma_f32_16x16x32_bf16 v[224:227], v[12:15], a[80:83], v[224:227]
    ds_read_b128 v[28:31], v7 offset:19456
    v_mfma_f32_16x16x32_bf16 v[228:231], v[12:15], a[84:87], v[228:231]
    buffer_load_dwordx4 a[172:175], v2, s[4:7], s69 offen offset:2048 sc1
    v_mfma_f32_16x16x32_bf16 v[232:235], v[12:15], a[88:91], v[232:235]
    v_mfma_f32_16x16x32_bf16 v[236:239], v[12:15], a[92:95], v[236:239]
    s_waitcnt lgkmcnt(3)
    v_mfma_f32_16x16x32_bf16 v[64:67], v[16:19], a[80:83], v[64:67]
    ds_read_b128 v[8:11], v4 offset:12288
    v_mfma_f32_16x16x32_bf16 v[68:71], v[16:19], a[84:87], v[68:71]
    buffer_load_dwordx4 a[176:179], v2, s[4:7], s59 offen offset:3072 sc1
    v_mfma_f32_16x16x32_bf16 v[72:75], v[16:19], a[88:91], v[72:75]
    v_mfma_f32_16x16x32_bf16 v[76:79], v[16:19], a[92:95], v[76:79]
    s_waitcnt lgkmcnt(3)
    v_mfma_f32_16x16x32_bf16 v[80:83], v[20:23], a[80:83], v[80:83]
    ds_read_b128 v[12:15], v4 offset:13312
    v_mfma_f32_16x16x32_bf16 v[84:87], v[20:23], a[84:87], v[84:87]
    buffer_load_dwordx4 a[180:183], v2, s[4:7], s66 offen offset:3072 sc1
    v_mfma_f32_16x16x32_bf16 v[88:91], v[20:23], a[88:91], v[88:91]
    v_mfma_f32_16x16x32_bf16 v[92:95], v[20:23], a[92:95], v[92:95]
    s_waitcnt lgkmcnt(3)
    v_mfma_f32_16x16x32_bf16 v[96:99], v[24:27], a[80:83], v[96:99]
    ds_read_b128 v[16:19], v4 offset:49152
    v_mfma_f32_16x16x32_bf16 v[100:103], v[24:27], a[84:87], v[100:103]
    buffer_load_dwordx4 a[184:187], v2, s[4:7], s68 offen offset:3072 sc1
    v_mfma_f32_16x16x32_bf16 v[104:107], v[24:27], a[88:91], v[104:107]
    v_mfma_f32_16x16x32_bf16 v[108:111], v[24:27], a[92:95], v[108:111]
    s_waitcnt lgkmcnt(3)
    v_mfma_f32_16x16x32_bf16 v[112:115], v[28:31], a[80:83], v[112:115]
    ds_read_b128 v[20:23], v4 offset:50176
    v_mfma_f32_16x16x32_bf16 v[116:119], v[28:31], a[84:87], v[116:119]
    buffer_load_dwordx4 a[188:191], v2, s[4:7], s69 offen offset:3072 sc1
    v_mfma_f32_16x16x32_bf16 v[120:123], v[28:31], a[88:91], v[120:123]
    s_add_u32 s59, s50, 12288
    v_mfma_f32_16x16x32_bf16 v[124:127], v[28:31], a[92:95], v[124:127]
    s_waitcnt vmcnt(23) lgkmcnt(3)
    v_mfma_f32_16x16x32_bf16 v[208:211], v[8:11], a[96:99], v[208:211]
    s_waitcnt vmcnt(22)
    ds_read_b128 v[24:27], v7 offset:20480
    v_mfma_f32_16x16x32_bf16 v[212:215], v[8:11], a[100:103], v[212:215]
    buffer_load_dwordx4 a[192:195], v2, s[4:7], s59 offen offset:0 sc1
    s_waitcnt vmcnt(22)
    v_mfma_f32_16x16x32_bf16 v[216:219], v[8:11], a[104:107], v[216:219]
    s_waitcnt vmcnt(21)
    s_add_u32 s66, s50, 30720
    v_mfma_f32_16x16x32_bf16 v[220:223], v[8:11], a[108:111], v[220:223]
    s_waitcnt lgkmcnt(3)
    v_mfma_f32_16x16x32_bf16 v[224:227], v[12:15], a[96:99], v[224:227]
    ds_read_b128 v[28:31], v7 offset:21504
    v_mfma_f32_16x16x32_bf16 v[228:231], v[12:15], a[100:103], v[228:231]
    buffer_load_dwordx4 a[196:199], v2, s[4:7], s66 offen offset:0 sc1
    v_mfma_f32_16x16x32_bf16 v[232:235], v[12:15], a[104:107], v[232:235]
    s_add_u32 s68, s50, 49152
    v_mfma_f32_16x16x32_bf16 v[236:239], v[12:15], a[108:111], v[236:239]
    s_waitcnt lgkmcnt(3)
    v_mfma_f32_16x16x32_bf16 v[64:67], v[16:19], a[96:99], v[64:67]
    ds_read_b128 v[8:11], v4 offset:14336
    v_mfma_f32_16x16x32_bf16 v[68:71], v[16:19], a[100:103], v[68:71]
    buffer_load_dwordx4 a[200:203], v2, s[4:7], s68 offen offset:0 sc1
    v_mfma_f32_16x16x32_bf16 v[72:75], v[16:19], a[104:107], v[72:75]
    s_add_u32 s69, s50, 67584
    v_mfma_f32_16x16x32_bf16 v[76:79], v[16:19], a[108:111], v[76:79]
    s_waitcnt lgkmcnt(3)
    v_mfma_f32_16x16x32_bf16 v[80:83], v[20:23], a[96:99], v[80:83]
    ds_read_b128 v[12:15], v4 offset:15360
    v_mfma_f32_16x16x32_bf16 v[84:87], v[20:23], a[100:103], v[84:87]
    buffer_load_dwordx4 a[204:207], v2, s[4:7], s69 offen offset:0 sc1
    v_mfma_f32_16x16x32_bf16 v[88:91], v[20:23], a[104:107], v[88:91]
    v_mfma_f32_16x16x32_bf16 v[92:95], v[20:23], a[108:111], v[92:95]
    s_waitcnt lgkmcnt(3)
    v_mfma_f32_16x16x32_bf16 v[96:99], v[24:27], a[96:99], v[96:99]
    ds_read_b128 v[16:19], v4 offset:51200
    v_mfma_f32_16x16x32_bf16 v[100:103], v[24:27], a[100:103], v[100:103]
    buffer_load_dwordx4 a[208:211], v2, s[4:7], s59 offen offset:1024 sc1
    v_mfma_f32_16x16x32_bf16 v[104:107], v[24:27], a[104:107], v[104:107]
    v_mfma_f32_16x16x32_bf16 v[108:111], v[24:27], a[108:111], v[108:111]
    s_waitcnt lgkmcnt(3)
    v_mfma_f32_16x16x32_bf16 v[112:115], v[28:31], a[96:99], v[112:115]
    ds_read_b128 v[20:23], v4 offset:52224
    v_mfma_f32_16x16x32_bf16 v[116:119], v[28:31], a[100:103], v[116:119]
    buffer_load_dwordx4 a[212:215], v2, s[4:7], s66 offen offset:1024 sc1
    v_mfma_f32_16x16x32_bf16 v[120:123], v[28:31], a[104:107], v[120:123]
    v_mfma_f32_16x16x32_bf16 v[124:127], v[28:31], a[108:111], v[124:127]
    s_waitcnt vmcnt(25) lgkmcnt(3)
    v_mfma_f32_16x16x32_bf16 v[208:211], v[8:11], a[112:115], v[208:211]
    s_waitcnt vmcnt(24)
    ds_read_b128 v[24:27], v7 offset:22528
    v_mfma_f32_16x16x32_bf16 v[212:215], v[8:11], a[116:119], v[212:215]
    buffer_load_dwordx4 a[216:219], v2, s[4:7], s68 offen offset:1024 sc1
    s_waitcnt vmcnt(24)
    v_mfma_f32_16x16x32_bf16 v[216:219], v[8:11], a[120:123], v[216:219]
    s_waitcnt vmcnt(23)
    v_mfma_f32_16x16x32_bf16 v[220:223], v[8:11], a[124:127], v[220:223]
    s_waitcnt lgkmcnt(3)
    v_mfma_f32_16x16x32_bf16 v[224:227], v[12:15], a[112:115], v[224:227]
    ds_read_b128 v[28:31], v7 offset:23552
    v_mfma_f32_16x16x32_bf16 v[228:231], v[12:15], a[116:119], v[228:231]
    buffer_load_dwordx4 a[220:223], v2, s[4:7], s69 offen offset:1024 sc1
    v_mfma_f32_16x16x32_bf16 v[232:235], v[12:15], a[120:123], v[232:235]
    v_mfma_f32_16x16x32_bf16 v[236:239], v[12:15], a[124:127], v[236:239]
    s_waitcnt lgkmcnt(3)
    v_mfma_f32_16x16x32_bf16 v[64:67], v[16:19], a[112:115], v[64:67]
    ds_read_b128 v[8:11], v4 offset:16384
    v_mfma_f32_16x16x32_bf16 v[68:71], v[16:19], a[116:119], v[68:71]
    buffer_load_dwordx4 a[224:227], v2, s[4:7], s59 offen offset:2048 sc1
    v_mfma_f32_16x16x32_bf16 v[72:75], v[16:19], a[120:123], v[72:75]
    v_mfma_f32_16x16x32_bf16 v[76:79], v[16:19], a[124:127], v[76:79]
    s_waitcnt lgkmcnt(3)
    v_mfma_f32_16x16x32_bf16 v[80:83], v[20:23], a[112:115], v[80:83]
    ds_read_b128 v[12:15], v4 offset:17408
    v_mfma_f32_16x16x32_bf16 v[84:87], v[20:23], a[116:119], v[84:87]
    buffer_load_dwordx4 a[228:231], v2, s[4:7], s66 offen offset:2048 sc1
    v_mfma_f32_16x16x32_bf16 v[88:91], v[20:23], a[120:123], v[88:91]
    v_mfma_f32_16x16x32_bf16 v[92:95], v[20:23], a[124:127], v[92:95]
    s_waitcnt lgkmcnt(3)
    v_mfma_f32_16x16x32_bf16 v[96:99], v[24:27], a[112:115], v[96:99]
    ds_read_b128 v[16:19], v4 offset:53248
    v_mfma_f32_16x16x32_bf16 v[100:103], v[24:27], a[116:119], v[100:103]
    buffer_load_dwordx4 a[232:235], v2, s[4:7], s68 offen offset:2048 sc1
    v_mfma_f32_16x16x32_bf16 v[104:107], v[24:27], a[120:123], v[104:107]
    v_mfma_f32_16x16x32_bf16 v[108:111], v[24:27], a[124:127], v[108:111]
    s_waitcnt lgkmcnt(3)
    v_mfma_f32_16x16x32_bf16 v[112:115], v[28:31], a[112:115], v[112:115]
    ds_read_b128 v[20:23], v4 offset:54272
    v_mfma_f32_16x16x32_bf16 v[116:119], v[28:31], a[116:119], v[116:119]
    buffer_load_dwordx4 a[236:239], v2, s[4:7], s69 offen offset:2048 sc1
    v_mfma_f32_16x16x32_bf16 v[120:123], v[28:31], a[120:123], v[120:123]
    v_mfma_f32_16x16x32_bf16 v[124:127], v[28:31], a[124:127], v[124:127]
    s_waitcnt vmcnt(27) lgkmcnt(3)
    v_mfma_f32_16x16x32_bf16 v[208:211], v[8:11], a[128:131], v[208:211]
    s_waitcnt vmcnt(26)
    ds_read_b128 v[24:27], v7 offset:24576
    v_mfma_f32_16x16x32_bf16 v[212:215], v[8:11], a[132:135], v[212:215]
    buffer_load_dwordx4 a[240:243], v2, s[4:7], s59 offen offset:3072 sc1
    s_waitcnt vmcnt(26)
    v_mfma_f32_16x16x32_bf16 v[216:219], v[8:11], a[136:139], v[216:219]
    s_waitcnt vmcnt(25)
    v_mfma_f32_16x16x32_bf16 v[220:223], v[8:11], a[140:143], v[220:223]
    s_waitcnt lgkmcnt(3)
    v_mfma_f32_16x16x32_bf16 v[224:227], v[12:15], a[128:131], v[224:227]
    ds_read_b128 v[28:31], v7 offset:25600
    v_mfma_f32_16x16x32_bf16 v[228:231], v[12:15], a[132:135], v[228:231]
    buffer_load_dwordx4 a[244:247], v2, s[4:7], s66 offen offset:3072 sc1
    v_mfma_f32_16x16x32_bf16 v[232:235], v[12:15], a[136:139], v[232:235]
    v_mfma_f32_16x16x32_bf16 v[236:239], v[12:15], a[140:143], v[236:239]
    s_waitcnt lgkmcnt(3)
    s_add_u32 m0, s49, 110592
    s_add_u32 s61, s48, 110592
    v_mfma_f32_16x16x32_bf16 v[64:67], v[16:19], a[128:131], v[64:67]
    ds_read_b128 v[8:11], v4 offset:18432
    v_mfma_f32_16x16x32_bf16 v[68:71], v[16:19], a[132:135], v[68:71]
    buffer_load_dwordx4 a[248:251], v2, s[4:7], s68 offen offset:3072 sc1
    v_mfma_f32_16x16x32_bf16 v[72:75], v[16:19], a[136:139], v[72:75]
    v_mfma_f32_16x16x32_bf16 v[76:79], v[16:19], a[140:143], v[76:79]
    s_waitcnt lgkmcnt(3)
    v_mfma_f32_16x16x32_bf16 v[80:83], v[20:23], a[128:131], v[80:83]
    ds_read_b128 v[12:15], v4 offset:19456
    v_mfma_f32_16x16x32_bf16 v[84:87], v[20:23], a[132:135], v[84:87]
    buffer_load_dwordx4 a[252:255], v2, s[4:7], s69 offen offset:3072 sc1
    v_mfma_f32_16x16x32_bf16 v[88:91], v[20:23], a[136:139], v[88:91]
    s_add_u32 s59, s50, 16384
    v_mfma_f32_16x16x32_bf16 v[92:95], v[20:23], a[140:143], v[92:95]
    s_waitcnt lgkmcnt(3)
    v_mfma_f32_16x16x32_bf16 v[96:99], v[24:27], a[128:131], v[96:99]
    ds_read_b128 v[16:19], v4 offset:55296
    v_mfma_f32_16x16x32_bf16 v[100:103], v[24:27], a[132:135], v[100:103]
    buffer_load_dwordx4 v[32:35], v2, s[4:7], s59 offen offset:0 sc1
    v_mfma_f32_16x16x32_bf16 v[104:107], v[24:27], a[136:139], v[104:107]
    s_add_u32 s66, s50, 34816
    v_mfma_f32_16x16x32_bf16 v[108:111], v[24:27], a[140:143], v[108:111]
    s_waitcnt lgkmcnt(3)
    v_mfma_f32_16x16x32_bf16 v[112:115], v[28:31], a[128:131], v[112:115]
    ds_read_b128 v[20:23], v4 offset:56320
    v_mfma_f32_16x16x32_bf16 v[116:119], v[28:31], a[132:135], v[116:119]
    buffer_load_dwordx4 v[36:39], v2, s[4:7], s66 offen offset:0 sc1
    v_mfma_f32_16x16x32_bf16 v[120:123], v[28:31], a[136:139], v[120:123]
    s_add_u32 s68, s50, 53248
    v_mfma_f32_16x16x32_bf16 v[124:127], v[28:31], a[140:143], v[124:127]
    s_waitcnt vmcnt(29) lgkmcnt(3)
    v_mfma_f32_16x16x32_bf16 v[208:211], v[8:11], a[144:147], v[208:211]
    s_waitcnt vmcnt(28)
    ds_read_b128 v[24:27], v7 offset:26624
    v_mfma_f32_16x16x32_bf16 v[212:215], v[8:11], a[148:151], v[212:215]
    buffer_load_dwordx4 v[40:43], v2, s[4:7], s68 offen offset:0 sc1
    s_waitcnt vmcnt(28)
    v_mfma_f32_16x16x32_bf16 v[216:219], v[8:11], a[152:155], v[216:219]
    s_waitcnt vmcnt(27)
    s_add_u32 s69, s50, 71680
    v_mfma_f32_16x16x32_bf16 v[220:223], v[8:11], a[156:159], v[220:223]
    s_waitcnt lgkmcnt(3)
    v_mfma_f32_16x16x32_bf16 v[224:227], v[12:15], a[144:147], v[224:227]
    ds_read_b128 v[28:31], v7 offset:27648
    v_mfma_f32_16x16x32_bf16 v[228:231], v[12:15], a[148:151], v[228:231]
    buffer_load_dwordx4 v[44:47], v2, s[4:7], s69 offen offset:0 sc1
    v_mfma_f32_16x16x32_bf16 v[232:235], v[12:15], a[152:155], v[232:235]
    v_mfma_f32_16x16x32_bf16 v[236:239], v[12:15], a[156:159], v[236:239]
    s_waitcnt lgkmcnt(3)
    v_mfma_f32_16x16x32_bf16 v[64:67], v[16:19], a[144:147], v[64:67]
    ds_read_b128 v[8:11], v4 offset:20480
    v_mfma_f32_16x16x32_bf16 v[68:71], v[16:19], a[148:151], v[68:71]
    buffer_load_dwordx4 v2, s[4:7], s61 offen offset:0 lds
    v_mfma_f32_16x16x32_bf16 v[72:75], v[16:19], a[152:155], v[72:75]
    v_mfma_f32_16x16x32_bf16 v[76:79], v[16:19], a[156:159], v[76:79]
    s_waitcnt lgkmcnt(3)
    v_mfma_f32_16x16x32_bf16 v[80:83], v[20:23], a[144:147], v[80:83]
    ds_read_b128 v[12:15], v4 offset:21504
    v_mfma_f32_16x16x32_bf16 v[84:87], v[20:23], a[148:151], v[84:87]
    buffer_load_dwordx4 v2, s[4:7], s61 offen offset:1024 lds
    v_mfma_f32_16x16x32_bf16 v[88:91], v[20:23], a[152:155], v[88:91]
    v_mfma_f32_16x16x32_bf16 v[92:95], v[20:23], a[156:159], v[92:95]
    s_waitcnt lgkmcnt(3)
    v_mfma_f32_16x16x32_bf16 v[96:99], v[24:27], a[144:147], v[96:99]
    ds_read_b128 v[16:19], v4 offset:57344
    v_mfma_f32_16x16x32_bf16 v[100:103], v[24:27], a[148:151], v[100:103]
    buffer_load_dwordx4 v2, s[4:7], s61 offen offset:2048 lds
    v_mfma_f32_16x16x32_bf16 v[104:107], v[24:27], a[152:155], v[104:107]
    v_mfma_f32_16x16x32_bf16 v[108:111], v[24:27], a[156:159], v[108:111]
    s_waitcnt lgkmcnt(3)
    v_mfma_f32_16x16x32_bf16 v[112:115], v[28:31], a[144:147], v[112:115]
    ds_read_b128 v[20:23], v4 offset:58368
    v_mfma_f32_16x16x32_bf16 v[116:119], v[28:31], a[148:151], v[116:119]
    buffer_load_dwordx4 v2, s[4:7], s61 offen offset:3072 lds
    v_mfma_f32_16x16x32_bf16 v[120:123], v[28:31], a[152:155], v[120:123]
    s_add_u32 m0, s49, 114688
    s_add_u32 s61, s48, 114688
    v_mfma_f32_16x16x32_bf16 v[124:127], v[28:31], a[156:159], v[124:127]
    s_waitcnt vmcnt(31) lgkmcnt(3)
    v_mfma_f32_16x16x32_bf16 v[208:211], v[8:11], a[160:163], v[208:211]
    s_waitcnt vmcnt(30)
    ds_read_b128 v[24:27], v7 offset:28672
    v_mfma_f32_16x16x32_bf16 v[212:215], v[8:11], a[164:167], v[212:215]
    buffer_load_dwordx4 v2, s[4:7], s61 offen offset:0 lds
    s_waitcnt vmcnt(30)
    v_mfma_f32_16x16x32_bf16 v[216:219], v[8:11], a[168:171], v[216:219]
    s_waitcnt vmcnt(29)
    v_mfma_f32_16x16x32_bf16 v[220:223], v[8:11], a[172:175], v[220:223]
    s_waitcnt lgkmcnt(3)
    v_mfma_f32_16x16x32_bf16 v[224:227], v[12:15], a[160:163], v[224:227]
    ds_read_b128 v[28:31], v7 offset:29696
    v_mfma_f32_16x16x32_bf16 v[228:231], v[12:15], a[164:167], v[228:231]
    buffer_load_dwordx4 v2, s[4:7], s61 offen offset:1024 lds
    v_mfma_f32_16x16x32_bf16 v[232:235], v[12:15], a[168:171], v[232:235]
    v_mfma_f32_16x16x32_bf16 v[236:239], v[12:15], a[172:175], v[236:239]
    s_waitcnt lgkmcnt(3)
    v_mfma_f32_16x16x32_bf16 v[64:67], v[16:19], a[160:163], v[64:67]
    ds_read_b128 v[8:11], v4 offset:22528
    v_mfma_f32_16x16x32_bf16 v[68:71], v[16:19], a[164:167], v[68:71]
    buffer_load_dwordx4 v2, s[4:7], s61 offen offset:2048 lds
    v_mfma_f32_16x16x32_bf16 v[72:75], v[16:19], a[168:171], v[72:75]
    v_mfma_f32_16x16x32_bf16 v[76:79], v[16:19], a[172:175], v[76:79]
    s_waitcnt lgkmcnt(3)
    v_mfma_f32_16x16x32_bf16 v[80:83], v[20:23], a[160:163], v[80:83]
    ds_read_b128 v[12:15], v4 offset:23552
    v_mfma_f32_16x16x32_bf16 v[84:87], v[20:23], a[164:167], v[84:87]
    buffer_load_dwordx4 v2, s[4:7], s61 offen offset:3072 lds
    v_mfma_f32_16x16x32_bf16 v[88:91], v[20:23], a[168:171], v[88:91]
    s_add_u32 m0, s49, 118784
    s_add_u32 s61, s48, 118784
    v_mfma_f32_16x16x32_bf16 v[92:95], v[20:23], a[172:175], v[92:95]
    s_waitcnt lgkmcnt(3)
    v_mfma_f32_16x16x32_bf16 v[96:99], v[24:27], a[160:163], v[96:99]
    ds_read_b128 v[16:19], v4 offset:59392
    v_mfma_f32_16x16x32_bf16 v[100:103], v[24:27], a[164:167], v[100:103]
    buffer_load_dwordx4 v2, s[4:7], s61 offen offset:0 lds
    v_mfma_f32_16x16x32_bf16 v[104:107], v[24:27], a[168:171], v[104:107]
    v_mfma_f32_16x16x32_bf16 v[108:111], v[24:27], a[172:175], v[108:111]
    s_waitcnt lgkmcnt(3)
    v_mfma_f32_16x16x32_bf16 v[112:115], v[28:31], a[160:163], v[112:115]
    ds_read_b128 v[20:23], v4 offset:60416
    v_mfma_f32_16x16x32_bf16 v[116:119], v[28:31], a[164:167], v[116:119]
    buffer_load_dwordx4 v[48:51], v2, s[4:7], s59 offen offset:1024 sc1
    v_mfma_f32_16x16x32_bf16 v[120:123], v[28:31], a[168:171], v[120:123]
    v_mfma_f32_16x16x32_bf16 v[124:127], v[28:31], a[172:175], v[124:127]
    s_waitcnt vmcnt(33) lgkmcnt(3)
    v_mfma_f32_16x16x32_bf16 v[208:211], v[8:11], a[176:179], v[208:211]
    s_waitcnt vmcnt(32)
    ds_read_b128 v[24:27], v7 offset:30720
    v_mfma_f32_16x16x32_bf16 v[212:215], v[8:11], a[180:183], v[212:215]
    buffer_load_dwordx4 v[52:55], v2, s[4:7], s66 offen offset:1024 sc1
    s_waitcnt vmcnt(32)
    v_mfma_f32_16x16x32_bf16 v[216:219], v[8:11], a[184:187], v[216:219]
    s_waitcnt vmcnt(31)
    v_mfma_f32_16x16x32_bf16 v[220:223], v[8:11], a[188:191], v[220:223]
    s_waitcnt lgkmcnt(3)
    v_mfma_f32_16x16x32_bf16 v[224:227], v[12:15], a[176:179], v[224:227]
    ds_read_b128 v[28:31], v7 offset:31744
    v_mfma_f32_16x16x32_bf16 v[228:231], v[12:15], a[180:183], v[228:231]
    buffer_load_dwordx4 v[56:59], v2, s[4:7], s68 offen offset:1024 sc1
    v_mfma_f32_16x16x32_bf16 v[232:235], v[12:15], a[184:187], v[232:235]
    v_mfma_f32_16x16x32_bf16 v[236:239], v[12:15], a[188:191], v[236:239]
    s_waitcnt lgkmcnt(3)
    v_mfma_f32_16x16x32_bf16 v[64:67], v[16:19], a[176:179], v[64:67]
    ds_read_b128 v[8:11], v4 offset:24576
    v_mfma_f32_16x16x32_bf16 v[68:71], v[16:19], a[180:183], v[68:71]
    buffer_load_dwordx4 v[60:63], v2, s[4:7], s69 offen offset:1024 sc1
    v_mfma_f32_16x16x32_bf16 v[72:75], v[16:19], a[184:187], v[72:75]
    v_mfma_f32_16x16x32_bf16 v[76:79], v[16:19], a[188:191], v[76:79]
    s_waitcnt lgkmcnt(3)
    v_mfma_f32_16x16x32_bf16 v[80:83], v[20:23], a[176:179], v[80:83]
    ds_read_b128 v[12:15], v4 offset:25600
    v_mfma_f32_16x16x32_bf16 v[84:87], v[20:23], a[180:183], v[84:87]
    v_mfma_f32_16x16x32_bf16 v[88:91], v[20:23], a[184:187], v[88:91]
    v_mfma_f32_16x16x32_bf16 v[92:95], v[20:23], a[188:191], v[92:95]
    s_waitcnt lgkmcnt(3)
    v_mfma_f32_16x16x32_bf16 v[96:99], v[24:27], a[176:179], v[96:99]
    ds_read_b128 v[16:19], v4 offset:61440
    v_mfma_f32_16x16x32_bf16 v[100:103], v[24:27], a[180:183], v[100:103]
    v_mfma_f32_16x16x32_bf16 v[104:107], v[24:27], a[184:187], v[104:107]
    v_mfma_f32_16x16x32_bf16 v[108:111], v[24:27], a[188:191], v[108:111]
    s_waitcnt lgkmcnt(3)
    v_mfma_f32_16x16x32_bf16 v[112:115], v[28:31], a[176:179], v[112:115]
    ds_read_b128 v[20:23], v4 offset:62464
    v_mfma_f32_16x16x32_bf16 v[116:119], v[28:31], a[180:183], v[116:119]
    v_mfma_f32_16x16x32_bf16 v[120:123], v[28:31], a[184:187], v[120:123]
    v_mfma_f32_16x16x32_bf16 v[124:127], v[28:31], a[188:191], v[124:127]
    s_waitcnt vmcnt(32) lgkmcnt(3)
    v_mfma_f32_16x16x32_bf16 v[208:211], v[8:11], a[192:195], v[208:211]
    s_waitcnt vmcnt(31)
    ds_read_b128 v[24:27], v7 offset:32768
    v_mfma_f32_16x16x32_bf16 v[212:215], v[8:11], a[196:199], v[212:215]
    s_waitcnt vmcnt(30)
    v_mfma_f32_16x16x32_bf16 v[216:219], v[8:11], a[200:203], v[216:219]
    s_waitcnt vmcnt(29)
    v_mfma_f32_16x16x32_bf16 v[220:223], v[8:11], a[204:207], v[220:223]
    s_waitcnt lgkmcnt(3)
    v_mfma_f32_16x16x32_bf16 v[224:227], v[12:15], a[192:195], v[224:227]
    ds_read_b128 v[28:31], v7 offset:33792
    v_mfma_f32_16x16x32_bf16 v[228:231], v[12:15], a[196:199], v[228:231]
    v_mfma_f32_16x16x32_bf16 v[232:235], v[12:15], a[200:203], v[232:235]
    v_mfma_f32_16x16x32_bf16 v[236:239], v[12:15], a[204:207], v[236:239]
    s_waitcnt lgkmcnt(3)
    v_mfma_f32_16x16x32_bf16 v[64:67], v[16:19], a[192:195], v[64:67]
    ds_read_b128 v[8:11], v4 offset:26624
    v_mfma_f32_16x16x32_bf16 v[68:71], v[16:19], a[196:199], v[68:71]
    v_mfma_f32_16x16x32_bf16 v[72:75], v[16:19], a[200:203], v[72:75]
    v_mfma_f32_16x16x32_bf16 v[76:79], v[16:19], a[204:207], v[76:79]
    s_waitcnt lgkmcnt(3)
    v_mfma_f32_16x16x32_bf16 v[80:83], v[20:23], a[192:195], v[80:83]
    ds_read_b128 v[12:15], v4 offset:27648
    v_mfma_f32_16x16x32_bf16 v[84:87], v[20:23], a[196:199], v[84:87]
    v_mfma_f32_16x16x32_bf16 v[88:91], v[20:23], a[200:203], v[88:91]
    v_mfma_f32_16x16x32_bf16 v[92:95], v[20:23], a[204:207], v[92:95]
    s_waitcnt lgkmcnt(3)
    v_mfma_f32_16x16x32_bf16 v[96:99], v[24:27], a[192:195], v[96:99]
    ds_read_b128 v[16:19], v4 offset:63488
    v_mfma_f32_16x16x32_bf16 v[100:103], v[24:27], a[196:199], v[100:103]
    v_mfma_f32_16x16x32_bf16 v[104:107], v[24:27], a[200:203], v[104:107]
    v_mfma_f32_16x16x32_bf16 v[108:111], v[24:27], a[204:207], v[108:111]
    s_waitcnt lgkmcnt(3)
    v_mfma_f32_16x16x32_bf16 v[112:115], v[28:31], a[192:195], v[112:115]
    ds_read_b128 v[20:23], v4 offset:64512
    v_mfma_f32_16x16x32_bf16 v[116:119], v[28:31], a[196:199], v[116:119]
    v_mfma_f32_16x16x32_bf16 v[120:123], v[28:31], a[200:203], v[120:123]
    v_mfma_f32_16x16x32_bf16 v[124:127], v[28:31], a[204:207], v[124:127]
    s_waitcnt vmcnt(28) lgkmcnt(3)
    v_mfma_f32_16x16x32_bf16 v[208:211], v[8:11], a[208:211], v[208:211]
    s_waitcnt vmcnt(27)
    ds_read_b128 v[24:27], v7 offset:34816
    v_mfma_f32_16x16x32_bf16 v[212:215], v[8:11], a[212:215], v[212:215]
    s_waitcnt vmcnt(26)
    v_mfma_f32_16x16x32_bf16 v[216:219], v[8:11], a[216:219], v[216:219]
    s_waitcnt vmcnt(25)
    v_mfma_f32_16x16x32_bf16 v[220:223], v[8:11], a[220:223], v[220:223]
    s_waitcnt lgkmcnt(3)
    v_mfma_f32_16x16x32_bf16 v[224:227], v[12:15], a[208:211], v[224:227]
    ds_read_b128 v[28:31], v7 offset:35840
    v_mfma_f32_16x16x32_bf16 v[228:231], v[12:15], a[212:215], v[228:231]
    v_mfma_f32_16x16x32_bf16 v[232:235], v[12:15], a[216:219], v[232:235]
    v_mfma_f32_16x16x32_bf16 v[236:239], v[12:15], a[220:223], v[236:239]
    s_waitcnt lgkmcnt(3)
    v_mfma_f32_16x16x32_bf16 v[64:67], v[16:19], a[208:211], v[64:67]
    ds_read_b128 v[8:11], v4 offset:28672
    v_mfma_f32_16x16x32_bf16 v[68:71], v[16:19], a[212:215], v[68:71]
    v_mfma_f32_16x16x32_bf16 v[72:75], v[16:19], a[216:219], v[72:75]
    v_mfma_f32_16x16x32_bf16 v[76:79], v[16:19], a[220:223], v[76:79]
    s_waitcnt lgkmcnt(3)
    v_mfma_f32_16x16x32_bf16 v[80:83], v[20:23], a[208:211], v[80:83]
    ds_read_b128 v[12:15], v4 offset:29696
    v_mfma_f32_16x16x32_bf16 v[84:87], v[20:23], a[212:215], v[84:87]
    v_mfma_f32_16x16x32_bf16 v[88:91], v[20:23], a[216:219], v[88:91]
    v_mfma_f32_16x16x32_bf16 v[92:95], v[20:23], a[220:223], v[92:95]
    s_waitcnt lgkmcnt(3)
    v_mfma_f32_16x16x32_bf16 v[96:99], v[24:27], a[208:211], v[96:99]
    ds_read_b128 v[16:19], v7 offset:0
    v_mfma_f32_16x16x32_bf16 v[100:103], v[24:27], a[212:215], v[100:103]
    v_mfma_f32_16x16x32_bf16 v[104:107], v[24:27], a[216:219], v[104:107]
    v_mfma_f32_16x16x32_bf16 v[108:111], v[24:27], a[220:223], v[108:111]
    s_waitcnt lgkmcnt(3)
    v_mfma_f32_16x16x32_bf16 v[112:115], v[28:31], a[208:211], v[112:115]
    ds_read_b128 v[20:23], v7 offset:1024
    v_mfma_f32_16x16x32_bf16 v[116:119], v[28:31], a[212:215], v[116:119]
    v_mfma_f32_16x16x32_bf16 v[120:123], v[28:31], a[216:219], v[120:123]
    v_mfma_f32_16x16x32_bf16 v[124:127], v[28:31], a[220:223], v[124:127]
    s_waitcnt vmcnt(24) lgkmcnt(3)
    v_mfma_f32_16x16x32_bf16 v[208:211], v[8:11], a[224:227], v[208:211]
    s_waitcnt vmcnt(23)
    ds_read_b128 v[24:27], v7 offset:36864
    v_mfma_f32_16x16x32_bf16 v[212:215], v[8:11], a[228:231], v[212:215]
    s_waitcnt vmcnt(22)
    v_mfma_f32_16x16x32_bf16 v[216:219], v[8:11], a[232:235], v[216:219]
    s_waitcnt vmcnt(21)
    v_mfma_f32_16x16x32_bf16 v[220:223], v[8:11], a[236:239], v[220:223]
    s_waitcnt lgkmcnt(3)
    v_mfma_f32_16x16x32_bf16 v[224:227], v[12:15], a[224:227], v[224:227]
    ds_read_b128 v[28:31], v7 offset:37888
    v_mfma_f32_16x16x32_bf16 v[228:231], v[12:15], a[228:231], v[228:231]
    v_mfma_f32_16x16x32_bf16 v[232:235], v[12:15], a[232:235], v[232:235]
    v_mfma_f32_16x16x32_bf16 v[236:239], v[12:15], a[236:239], v[236:239]
    s_waitcnt lgkmcnt(3)
    v_mfma_f32_16x16x32_bf16 v[64:67], v[16:19], a[224:227], v[64:67]
    ds_read_b128 v[8:11], v4 offset:30720
    v_mfma_f32_16x16x32_bf16 v[68:71], v[16:19], a[228:231], v[68:71]
    v_mfma_f32_16x16x32_bf16 v[72:75], v[16:19], a[232:235], v[72:75]
    v_mfma_f32_16x16x32_bf16 v[76:79], v[16:19], a[236:239], v[76:79]
    s_waitcnt lgkmcnt(3)
    v_mfma_f32_16x16x32_bf16 v[80:83], v[20:23], a[224:227], v[80:83]
    ds_read_b128 v[12:15], v4 offset:31744
    v_mfma_f32_16x16x32_bf16 v[84:87], v[20:23], a[228:231], v[84:87]
    v_mfma_f32_16x16x32_bf16 v[88:91], v[20:23], a[232:235], v[88:91]
    v_mfma_f32_16x16x32_bf16 v[92:95], v[20:23], a[236:239], v[92:95]
    s_waitcnt lgkmcnt(3)
    v_mfma_f32_16x16x32_bf16 v[96:99], v[24:27], a[224:227], v[96:99]
    ds_read_b128 v[16:19], v7 offset:2048
    v_mfma_f32_16x16x32_bf16 v[100:103], v[24:27], a[228:231], v[100:103]
    v_mfma_f32_16x16x32_bf16 v[104:107], v[24:27], a[232:235], v[104:107]
    v_mfma_f32_16x16x32_bf16 v[108:111], v[24:27], a[236:239], v[108:111]
    s_waitcnt lgkmcnt(3)
    v_mfma_f32_16x16x32_bf16 v[112:115], v[28:31], a[224:227], v[112:115]
    ds_read_b128 v[20:23], v7 offset:3072
    v_mfma_f32_16x16x32_bf16 v[116:119], v[28:31], a[228:231], v[116:119]
    v_mfma_f32_16x16x32_bf16 v[120:123], v[28:31], a[232:235], v[120:123]
    v_mfma_f32_16x16x32_bf16 v[124:127], v[28:31], a[236:239], v[124:127]
    s_waitcnt vmcnt(20) lgkmcnt(3)
    v_mfma_f32_16x16x32_bf16 v[208:211], v[8:11], a[240:243], v[208:211]
    s_waitcnt vmcnt(19)
    ds_read_b128 v[24:27], v7 offset:38912
    v_mfma_f32_16x16x32_bf16 v[212:215], v[8:11], a[244:247], v[212:215]
    s_waitcnt vmcnt(18)
    v_mfma_f32_16x16x32_bf16 v[216:219], v[8:11], a[248:251], v[216:219]
    s_waitcnt vmcnt(17)
    v_mfma_f32_16x16x32_bf16 v[220:223], v[8:11], a[252:255], v[220:223]
    s_waitcnt lgkmcnt(3)
    v_mfma_f32_16x16x32_bf16 v[224:227], v[12:15], a[240:243], v[224:227]
    ds_read_b128 v[28:31], v7 offset:39936
    v_mfma_f32_16x16x32_bf16 v[228:231], v[12:15], a[244:247], v[228:231]
    v_mfma_f32_16x16x32_bf16 v[232:235], v[12:15], a[248:251], v[232:235]
    v_mfma_f32_16x16x32_bf16 v[236:239], v[12:15], a[252:255], v[236:239]
    s_waitcnt lgkmcnt(3)
    v_mfma_f32_16x16x32_bf16 v[64:67], v[16:19], a[240:243], v[64:67]
    ds_read_b128 v[8:11], v4 offset:32768
    v_mfma_f32_16x16x32_bf16 v[68:71], v[16:19], a[244:247], v[68:71]
    v_mfma_f32_16x16x32_bf16 v[72:75], v[16:19], a[248:251], v[72:75]
    v_mfma_f32_16x16x32_bf16 v[76:79], v[16:19], a[252:255], v[76:79]
    s_waitcnt lgkmcnt(3)
    v_mfma_f32_16x16x32_bf16 v[80:83], v[20:23], a[240:243], v[80:83]
    ds_read_b128 v[12:15], v4 offset:33792
    v_mfma_f32_16x16x32_bf16 v[84:87], v[20:23], a[244:247], v[84:87]
    v_mfma_f32_16x16x32_bf16 v[88:91], v[20:23], a[248:251], v[88:91]
    v_mfma_f32_16x16x32_bf16 v[92:95], v[20:23], a[252:255], v[92:95]
    s_waitcnt lgkmcnt(3)
    v_mfma_f32_16x16x32_bf16 v[96:99], v[24:27], a[240:243], v[96:99]
    ds_read_b128 v[16:19], v7 offset:4096
    v_mfma_f32_16x16x32_bf16 v[100:103], v[24:27], a[244:247], v[100:103]
    v_mfma_f32_16x16x32_bf16 v[104:107], v[24:27], a[248:251], v[104:107]
    v_mfma_f32_16x16x32_bf16 v[108:111], v[24:27], a[252:255], v[108:111]
    s_waitcnt lgkmcnt(3)
    v_mfma_f32_16x16x32_bf16 v[112:115], v[28:31], a[240:243], v[112:115]
    ds_read_b128 v[20:23], v7 offset:5120
    v_mfma_f32_16x16x32_bf16 v[116:119], v[28:31], a[244:247], v[116:119]
    v_add_f32 v166, v152, v154
    v_add_f32 v167, v153, v155
    v_mfma_f32_16x16x32_bf16 v[120:123], v[28:31], a[248:251], v[120:123]
    v_add_f32 v166, v166, v156
    v_add_f32 v167, v167, v157
    v_mfma_f32_16x16x32_bf16 v[124:127], v[28:31], a[252:255], v[124:127]
    s_waitcnt vmcnt(16) lgkmcnt(3)
    v_add_f32 v166, v166, v158
    v_add_f32 v167, v167, v159
    v_mfma_f32_16x16x32_bf16 v[208:211], v[8:11], v[32:35], v[208:211]
    s_waitcnt vmcnt(15)
    ds_read_b128 v[24:27], v7 offset:40960
    v_add_f32 v166, v166, v160
    v_mfma_f32_16x16x32_bf16 v[212:215], v[8:11], v[36:39], v[212:215]
    s_waitcnt vmcnt(14)
    v_add_f32 v167, v167, v161
    v_add_f32 v166, v166, v162
    v_mfma_f32_16x16x32_bf16 v[216:219], v[8:11], v[40:43], v[216:219]
    s_waitcnt vmcnt(13)
    v_add_f32 v167, v167, v163
    v_mul_f32 v166, 0xbae38e39, v166
    v_mfma_f32_16x16x32_bf16 v[220:223], v[8:11], v[44:47], v[220:223]
    s_waitcnt lgkmcnt(3)
    v_fmamk_f32 v165, v152, 0x3c2aaaab, v166
    v_mul_f32 v164, v165, v165
    v_mfma_f32_16x16x32_bf16 v[224:227], v[12:15], v[32:35], v[224:227]
    ds_read_b128 v[28:31], v7 offset:41984
    v_fmamk_f32 v165, v154, 0x3c2aaaab, v166
    v_mfma_f32_16x16x32_bf16 v[228:231], v[12:15], v[36:39], v[228:231]
    v_fmac_f32 v164, v165, v165
    v_fmamk_f32 v165, v156, 0x3c2aaaab, v166
    v_mfma_f32_16x16x32_bf16 v[232:235], v[12:15], v[40:43], v[232:235]
    v_fmac_f32 v164, v165, v165
    v_fmamk_f32 v165, v158, 0x3c2aaaab, v166
    v_mfma_f32_16x16x32_bf16 v[236:239], v[12:15], v[44:47], v[236:239]
    s_waitcnt lgkmcnt(3)
    v_fmac_f32 v164, v165, v165
    v_fmamk_f32 v165, v160, 0x3c2aaaab, v166
    v_mfma_f32_16x16x32_bf16 v[64:67], v[16:19], v[32:35], v[64:67]
    ds_read_b128 v[8:11], v4 offset:34816
    v_fmac_f32 v164, v165, v165
    v_mfma_f32_16x16x32_bf16 v[68:71], v[16:19], v[36:39], v[68:71]
    v_fmamk_f32 v165, v162, 0x3c2aaaab, v166
    v_fmac_f32 v164, v165, v165
    v_mfma_f32_16x16x32_bf16 v[72:75], v[16:19], v[40:43], v[72:75]
    v_fmac_f32 v167, 0x42c00000, v164
    v_mov_b32 v165, 0x3727c5ac
    v_mfma_f32_16x16x32_bf16 v[76:79], v[16:19], v[44:47], v[76:79]
    s_waitcnt lgkmcnt(3)
    v_fmac_f32 v165, 0x3ae38e39, v167
    v_rcp_f32 v167, v165
    v_mfma_f32_16x16x32_bf16 v[80:83], v[20:23], v[32:35], v[80:83]
    ds_read_b128 v[12:15], v4 offset:35840
    v_and_b32 v164, 15, v1
    v_mfma_f32_16x16x32_bf16 v[84:87], v[20:23], v[36:39], v[84:87]
    v_lshlrev_b32 v164, 2, v164
    v_mfma_f32_16x16x32_bf16 v[88:91], v[20:23], v[40:43], v[88:91]
    ds_bpermute_b32 v128, v164, v166 offset:0
    ds_bpermute_b32 v132, v164, v167 offset:0
    v_mfma_f32_16x16x32_bf16 v[92:95], v[20:23], v[44:47], v[92:95]
    s_waitcnt lgkmcnt(5)
    ds_bpermute_b32 v129, v164, v166 offset:64
    ds_bpermute_b32 v133, v164, v167 offset:64
    v_mfma_f32_16x16x32_bf16 v[96:99], v[24:27], v[32:35], v[96:99]
    ds_read_b128 v[16:19], v7 offset:6144
    ds_bpermute_b32 v130, v164, v166 offset:128
    v_mfma_f32_16x16x32_bf16 v[100:103], v[24:27], v[36:39], v[100:103]
    ds_bpermute_b32 v134, v164, v167 offset:128
    ds_bpermute_b32 v131, v164, v166 offset:192
    v_mfma_f32_16x16x32_bf16 v[104:107], v[24:27], v[40:43], v[104:107]
    ds_bpermute_b32 v135, v164, v167 offset:192
    v_mfma_f32_16x16x32_bf16 v[108:111], v[24:27], v[44:47], v[108:111]
    s_waitcnt lgkmcnt(11)
    v_mfma_f32_16x16x32_bf16 v[112:115], v[28:31], v[32:35], v[112:115]
    ds_read_b128 v[20:23], v7 offset:7168
    v_mfma_f32_16x16x32_bf16 v[116:119], v[28:31], v[36:39], v[116:119]
    v_mfma_f32_16x16x32_bf16 v[120:123], v[28:31], v[40:43], v[120:123]
    v_mfma_f32_16x16x32_bf16 v[124:127], v[28:31], v[44:47], v[124:127]
    s_waitcnt vmcnt(3) lgkmcnt(11)
    v_mfma_f32_16x16x32_bf16 v[208:211], v[8:11], v[48:51], v[208:211]
    s_waitcnt vmcnt(2)
    ds_read_b128 v[24:27], v7 offset:43008
    v_mfma_f32_16x16x32_bf16 v[212:215], v[8:11], v[52:55], v[212:215]
    s_waitcnt vmcnt(1)
    v_mfma_f32_16x16x32_bf16 v[216:219], v[8:11], v[56:59], v[216:219]
    s_waitcnt vmcnt(0)
    v_mfma_f32_16x16x32_bf16 v[220:223], v[8:11], v[60:63], v[220:223]
    s_waitcnt lgkmcnt(11)
    ds_read_b128 v[136:139], v5 offset:128
    ds_read_b128 v[140:143], v5 offset:192
    v_mfma_f32_16x16x32_bf16 v[224:227], v[12:15], v[48:51], v[224:227]
    ds_read_b128 v[28:31], v7 offset:44032
    ds_read_b128 v[144:147], v5 offset:256
    v_mfma_f32_16x16x32_bf16 v[228:231], v[12:15], v[52:55], v[228:231]
    ds_read_b128 v[148:151], v5 offset:320
    v_mfma_f32_16x16x32_bf16 v[232:235], v[12:15], v[56:59], v[232:235]
    v_mfma_f32_16x16x32_bf16 v[236:239], v[12:15], v[60:63], v[236:239]
    s_waitcnt lgkmcnt(11)
    v_mfma_f32_16x16x32_bf16 v[64:67], v[16:19], v[48:51], v[64:67]
    s_waitcnt lgkmcnt(0)
    s_barrier
    v_mfma_f32_16x16x32_bf16 v[68:71], v[16:19], v[52:55], v[68:71]
    s_add_u32 m0, s49, 0
    v_add_u32 v4, 0x1b000, v4
    ds_read_b128 v[8:11], v4 offset:0
    v_mfma_f32_16x16x32_bf16 v[72:75], v[16:19], v[56:59], v[72:75]
    s_add_u32 s61, s48, 147456
    v_mfma_f32_16x16x32_bf16 v[76:79], v[16:19], v[60:63], v[76:79]
    v_mfma_f32_16x16x32_bf16 v[80:83], v[20:23], v[48:51], v[80:83]
    ds_read_b128 v[12:15], v4 offset:1024
    v_mfma_f32_16x16x32_bf16 v[84:87], v[20:23], v[52:55], v[84:87]
    buffer_load_dwordx4 v2, s[4:7], s61 offen offset:0 lds
    v_mfma_f32_16x16x32_bf16 v[88:91], v[20:23], v[56:59], v[88:91]
    v_mfma_f32_16x16x32_bf16 v[92:95], v[20:23], v[60:63], v[92:95]
    v_mfma_f32_16x16x32_bf16 v[96:99], v[24:27], v[48:51], v[96:99]
    ds_read_b128 v[16:19], v4 offset:2048
    v_mfma_f32_16x16x32_bf16 v[100:103], v[24:27], v[52:55], v[100:103]
    buffer_load_dwordx4 v2, s[4:7], s61 offen offset:1024 lds
    v_mfma_f32_16x16x32_bf16 v[104:107], v[24:27], v[56:59], v[104:107]
    v_mfma_f32_16x16x32_bf16 v[108:111], v[24:27], v[60:63], v[108:111]
    v_mfma_f32_16x16x32_bf16 v[112:115], v[28:31], v[48:51], v[112:115]
    ds_read_b128 v[20:23], v4 offset:3072
    v_mfma_f32_16x16x32_bf16 v[116:119], v[28:31], v[52:55], v[116:119]
    buffer_load_dwordx4 v2, s[4:7], s61 offen offset:2048 lds
    v_mfma_f32_16x16x32_bf16 v[120:123], v[28:31], v[56:59], v[120:123]
    v_mfma_f32_16x16x32_bf16 v[124:127], v[28:31], v[60:63], v[124:127]
    s_waitcnt lgkmcnt(3)
    v_mfma_f32_16x16x32_bf16 v[192:195], v[8:11], a[0:3], 0
    ds_read_b128 v[24:27], v4 offset:4096
    v_mfma_f32_16x16x32_bf16 v[196:199], v[8:11], a[4:7], 0
    buffer_load_dwordx4 v2, s[4:7], s61 offen offset:3072 lds
    v_mfma_f32_16x16x32_bf16 v[200:203], v[8:11], a[8:11], 0
    s_add_u32 m0, s49, 4096
    s_add_u32 s61, s48, 151552
    v_mfma_f32_16x16x32_bf16 v[204:207], v[8:11], a[12:15], 0
    s_waitcnt lgkmcnt(3)
    v_mfma_f32_16x16x32_bf16 v[152:155], v[12:15], a[0:3], 0
    ds_read_b128 v[28:31], v4 offset:5120
    v_mfma_f32_16x16x32_bf16 v[156:159], v[12:15], a[4:7], 0
    buffer_load_dwordx4 v2, s[4:7], s61 offen offset:0 lds
    v_mfma_f32_16x16x32_bf16 v[160:163], v[12:15], a[8:11], 0
    v_fmac_f32 v64, v136, v128
    v_fmac_f32 v65, v137, v128
    v_mfma_f32_16x16x32_bf16 v[164:167], v[12:15], a[12:15], 0
    s_waitcnt lgkmcnt(3)
    v_fmac_f32 v66, v138, v128
    v_fmac_f32 v67, v139, v128
    v_mfma_f32_16x16x32_bf16 v[192:195], v[16:19], a[16:19], v[192:195]
    ds_read_b128 v[8:11], v4 offset:6144
    v_fmac_f32 v80, v140, v128
    v_mfma_f32_16x16x32_bf16 v[196:199], v[16:19], a[20:23], v[196:199]
    buffer_load_dwordx4 v2, s[4:7], s61 offen offset:1024 lds
    v_mfma_f32_16x16x32_bf16 v[200:203], v[16:19], a[24:27], v[200:203]
    v_fmac_f32 v81, v141, v128
    v_fmac_f32 v82, v142, v128
    v_mfma_f32_16x16x32_bf16 v[204:207], v[16:19], a[28:31], v[204:207]
    s_waitcnt lgkmcnt(3)
    v_fmac_f32 v83, v143, v128
    v_mul_f32 v64, v64, v132
    v_mfma_f32_16x16x32_bf16 v[152:155], v[20:23], a[16:19], v[152:155]
    ds_read_b128 v[12:15], v4 offset:7168
    v_mul_f32 v65, v65, v132
    v_mfma_f32_16x16x32_bf16 v[156:159], v[20:23], a[20:23], v[156:159]
    buffer_load_dwordx4 v2, s[4:7], s61 offen offset:2048 lds
    v_mfma_f32_16x16x32_bf16 v[160:163], v[20:23], a[24:27], v[160:163]
    v_mul_f32 v66, v66, v132
    v_mul_f32 v67, v67, v132
    v_mfma_f32_16x16x32_bf16 v[164:167], v[20:23], a[28:31], v[164:167]
    s_waitcnt lgkmcnt(3)
    v_mul_f32 v64, v64, v80
    v_mul_f32 v65, v65, v81
    v_mfma_f32_16x16x32_bf16 v[192:195], v[24:27], a[32:35], v[192:195]
    ds_read_b128 v[16:19], v4 offset:8192
    v_mul_f32 v66, v66, v82
    v_mfma_f32_16x16x32_bf16 v[196:199], v[24:27], a[36:39], v[196:199]
    buffer_load_dwordx4 v2, s[4:7], s61 offen offset:3072 lds
    v_mfma_f32_16x16x32_bf16 v[200:203], v[24:27], a[40:43], v[200:203]
    s_add_u32 m0, s49, 8192
    s_add_u32 s61, s48, 155648
    v_mul_f32 v67, v67, v83
    v_mfma_f32_16x16x32_bf16 v[204:207], v[24:27], a[44:47], v[204:207]
    s_waitcnt lgkmcnt(3)
    v_cvt_pk_bf16_f32 v176, v64, v65
    v_cvt_pk_bf16_f32 v177, v66, v67
    v_mfma_f32_16x16x32_bf16 v[152:155], v[28:31], a[32:35], v[152:155]
    ds_read_b128 v[20:23], v4 offset:9216
    v_fmac_f32 v68, v136, v129
    v_mfma_f32_16x16x32_bf16 v[156:159], v[28:31], a[36:39], v[156:159]
    buffer_load_dwordx4 v2, s[4:7], s61 offen offset:0 lds
    v_mfma_f32_16x16x32_bf16 v[160:163], v[28:31], a[40:43], v[160:163]
    s_add_u32 m0, s49, 36864
    s_add_u32 s61, s48, 184320
    v_fmac_f32 v69, v137, v129
    v_mfma_f32_16x16x32_bf16 v[164:167], v[28:31], a[44:47], v[164:167]
    s_waitcnt lgkmcnt(3)
    v_fmac_f32 v70, v138, v129
    v_fmac_f32 v71, v139, v129
    v_mfma_f32_16x16x32_bf16 v[192:195], v[8:11], a[48:51], v[192:195]
    ds_read_b128 v[24:27], v4 offset:10240
    v_fmac_f32 v84, v140, v129
    v_mfma_f32_16x16x32_bf16 v[196:199], v[8:11], a[52:55], v[196:199]
    buffer_load_dwordx4 v2, s[4:7], s61 offen offset:0 lds
    v_mfma_f32_16x16x32_bf16 v[200:203], v[8:11], a[56:59], v[200:203]
    v_fmac_f32 v85, v141, v129
    v_fmac_f32 v86, v142, v129
    v_mfma_f32_16x16x32_bf16 v[204:207], v[8:11], a[60:63], v[204:207]
    s_waitcnt lgkmcnt(3)
    v_fmac_f32 v87, v143, v129
    v_mul_f32 v68, v68, v133
    v_mfma_f32_16x16x32_bf16 v[152:155], v[12:15], a[48:51], v[152:155]
    ds_read_b128 v[28:31], v4 offset:11264
    v_mul_f32 v69, v69, v133
    v_mfma_f32_16x16x32_bf16 v[156:159], v[12:15], a[52:55], v[156:159]
    buffer_load_dwordx4 v2, s[4:7], s61 offen offset:1024 lds
    v_mfma_f32_16x16x32_bf16 v[160:163], v[12:15], a[56:59], v[160:163]
    v_mul_f32 v70, v70, v133
    v_mul_f32 v71, v71, v133
    v_mfma_f32_16x16x32_bf16 v[164:167], v[12:15], a[60:63], v[164:167]
    s_waitcnt lgkmcnt(3)
    v_mul_f32 v68, v68, v84
    v_mul_f32 v69, v69, v85
    v_mfma_f32_16x16x32_bf16 v[192:195], v[16:19], a[64:67], v[192:195]
    ds_read_b128 v[8:11], v4 offset:12288
    v_mul_f32 v70, v70, v86
    v_mfma_f32_16x16x32_bf16 v[196:199], v[16:19], a[68:71], v[196:199]
    buffer_load_dwordx4 v2, s[4:7], s61 offen offset:2048 lds
    v_mfma_f32_16x16x32_bf16 v[200:203], v[16:19], a[72:75], v[200:203]
    v_mul_f32 v71, v71, v87
    v_cvt_pk_bf16_f32 v180, v68, v69
    v_mfma_f32_16x16x32_bf16 v[204:207], v[16:19], a[76:79], v[204:207]
    s_waitcnt lgkmcnt(3)
    v_cvt_pk_bf16_f32 v181, v70, v71
    v_fmac_f32 v72, v136, v130
    v_mfma_f32_16x16x32_bf16 v[152:155], v[20:23], a[64:67], v[152:155]
    ds_read_b128 v[12:15], v4 offset:13312
    v_fmac_f32 v73, v137, v130
    v_mfma_f32_16x16x32_bf16 v[156:159], v[20:23], a[68:71], v[156:159]
    buffer_load_dwordx4 v2, s[4:7], s61 offen offset:3072 lds
    v_mfma_f32_16x16x32_bf16 v[160:163], v[20:23], a[72:75], v[160:163]
    s_add_u32 m0, s49, 40960
    s_add_u32 s61, s48, 188416
    v_fmac_f32 v74, v138, v130
    v_mfma_f32_16x16x32_bf16 v[164:167], v[20:23], a[76:79], v[164:167]
    s_waitcnt lgkmcnt(3)
    v_fmac_f32 v75, v139, v130
    v_fmac_f32 v88, v140, v130
    v_mfma_f32_16x16x32_bf16 v[192:195], v[24:27], a[80:83], v[192:195]
    ds_read_b128 v[16:19], v4 offset:14336
    v_fmac_f32 v89, v141, v130
    v_mfma_f32_16x16x32_bf16 v[196:199], v[24:27], a[84:87], v[196:199]
    buffer_load_dwordx4 v2, s[4:7], s61 offen offset:0 lds
    v_mfma_f32_16x16x32_bf16 v[200:203], v[24:27], a[88:91], v[200:203]
    v_fmac_f32 v90, v142, v130
    v_fmac_f32 v91, v143, v130
    v_mfma_f32_16x16x32_bf16 v[204:207], v[24:27], a[92:95], v[204:207]
    s_waitcnt lgkmcnt(3)
    v_mul_f32 v72, v72, v134
    v_mul_f32 v73, v73, v134
    v_mfma_f32_16x16x32_bf16 v[152:155], v[28:31], a[80:83], v[152:155]
    ds_read_b128 v[20:23], v4 offset:15360
    v_mul_f32 v74, v74, v134
    v_mfma_f32_16x16x32_bf16 v[156:159], v[28:31], a[84:87], v[156:159]
    buffer_load_dwordx4 v2, s[4:7], s61 offen offset:1024 lds
    v_mfma_f32_16x16x32_bf16 v[160:163], v[28:31], a[88:91], v[160:163]
    v_mul_f32 v75, v75, v134
    v_mul_f32 v72, v72, v88
    v_mfma_f32_16x16x32_bf16 v[164:167], v[28:31], a[92:95], v[164:167]
    s_waitcnt lgkmcnt(3)
    v_mul_f32 v73, v73, v89
    v_mul_f32 v74, v74, v90
    v_mfma_f32_16x16x32_bf16 v[192:195], v[8:11], a[96:99], v[192:195]
    ds_read_b128 v[24:27], v4 offset:16384
    v_mul_f32 v75, v75, v91
    v_mfma_f32_16x16x32_bf16 v[196:199], v[8:11], a[100:103], v[196:199]
    buffer_load_dwordx4 v2, s[4:7], s61 offen offset:2048 lds
    v_mfma_f32_16x16x32_bf16 v[200:203], v[8:11], a[104:107], v[200:203]
    v_cvt_pk_bf16_f32 v184, v72, v73
    v_cvt_pk_bf16_f32 v185, v74, v75
    v_mfma_f32_16x16x32_bf16 v[204:207], v[8:11], a[108:111], v[204:207]
    s_waitcnt lgkmcnt(3)
    v_fmac_f32 v76, v136, v131
    v_fmac_f32 v77, v137, v131
    v_mfma_f32_16x16x32_bf16 v[152:155], v[12:15], a[96:99], v[152:155]
    ds_read_b128 v[28:31], v4 offset:17408
    v_fmac_f32 v78, v138, v131
    v_mfma_f32_16x16x32_bf16 v[156:159], v[12:15], a[100:103], v[156:159]
    buffer_load_dwordx4 v2, s[4:7], s61 offen offset:3072 lds
    v_mfma_f32_16x16x32_bf16 v[160:163], v[12:15], a[104:107], v[160:163]
    s_add_u32 m0, s49, 45056
    s_add_u32 s61, s48, 192512
    v_fmac_f32 v79, v139, v131
    v_mfma_f32_16x16x32_bf16 v[164:167], v[12:15], a[108:111], v[164:167]
    s_waitcnt lgkmcnt(3)
    v_fmac_f32 v92, v140, v131
    v_fmac_f32 v93, v141, v131
    v_mfma_f32_16x16x32_bf16 v[192:195], v[16:19], a[112:115], v[192:195]
    ds_read_b128 v[8:11], v4 offset:18432
    v_fmac_f32 v94, v142, v131
    v_mfma_f32_16x16x32_bf16 v[196:199], v[16:19], a[116:119], v[196:199]
    buffer_load_dwordx4 v2, s[4:7], s61 offen offset:0 lds
    v_mfma_f32_16x16x32_bf16 v[200:203], v[16:19], a[120:123], v[200:203]
    s_add_u32 m0, s49, 73728
    s_add_u32 s61, s48, 221184
    v_fmac_f32 v95, v143, v131
    v_mfma_f32_16x16x32_bf16 v[204:207], v[16:19], a[124:127], v[204:207]
    s_waitcnt lgkmcnt(3)
    v_mul_f32 v76, v76, v135
    v_mul_f32 v77, v77, v135
    v_mfma_f32_16x16x32_bf16 v[152:155], v[20:23], a[112:115], v[152:155]
    ds_read_b128 v[12:15], v4 offset:19456
    v_mul_f32 v78, v78, v135
    v_mfma_f32_16x16x32_bf16 v[156:159], v[20:23], a[116:119], v[156:159]
    buffer_load_dwordx4 v2, s[4:7], s61 offen offset:0 lds
    v_mfma_f32_16x16x32_bf16 v[160:163], v[20:23], a[120:123], v[160:163]
    v_mul_f32 v79, v79, v135
    v_mul_f32 v76, v76, v92
    v_mfma_f32_16x16x32_bf16 v[164:167], v[20:23], a[124:127], v[164:167]
    s_waitcnt lgkmcnt(3)
    v_mul_f32 v77, v77, v93
    v_mul_f32 v78, v78, v94
    v_mfma_f32_16x16x32_bf16 v[192:195], v[24:27], a[128:131], v[192:195]
    ds_read_b128 v[16:19], v4 offset:20480
    v_mul_f32 v79, v79, v95
    v_mfma_f32_16x16x32_bf16 v[196:199], v[24:27], a[132:135], v[196:199]
    buffer_load_dwordx4 v2, s[4:7], s61 offen offset:1024 lds
    v_mfma_f32_16x16x32_bf16 v[200:203], v[24:27], a[136:139], v[200:203]
    v_cvt_pk_bf16_f32 v188, v76, v77
    v_cvt_pk_bf16_f32 v189, v78, v79
    v_mfma_f32_16x16x32_bf16 v[204:207], v[24:27], a[140:143], v[204:207]
    s_waitcnt lgkmcnt(3)
    ds_read_b128 v[136:139], v5 offset:0
    ds_read_b128 v[140:143], v5 offset:64
    v_mfma_f32_16x16x32_bf16 v[152:155], v[28:31], a[128:131], v[152:155]
    ds_read_b128 v[20:23], v4 offset:21504
    v_fmac_f32 v96, v144, v128
    v_mfma_f32_16x16x32_bf16 v[156:159], v[28:31], a[132:135], v[156:159]
    buffer_load_dwordx4 v2, s[4:7], s61 offen offset:2048 lds
    v_mfma_f32_16x16x32_bf16 v[160:163], v[28:31], a[136:139], v[160:163]
    v_fmac_f32 v97, v145, v128
    v_fmac_f32 v98, v146, v128
    v_mfma_f32_16x16x32_bf16 v[164:167], v[28:31], a[140:143], v[164:167]
    s_waitcnt lgkmcnt(5)
    v_fmac_f32 v99, v147, v128
    v_fmac_f32 v112, v148, v128
    v_mfma_f32_16x16x32_bf16 v[192:195], v[8:11], a[144:147], v[192:195]
    ds_read_b128 v[24:27], v4 offset:22528
    v_fmac_f32 v113, v149, v128
    v_mfma_f32_16x16x32_bf16 v[196:199], v[8:11], a[148:151], v[196:199]
    buffer_load_dwordx4 v2, s[4:7], s61 offen offset:3072 lds
    v_mfma_f32_16x16x32_bf16 v[200:203], v[8:11], a[152:155], v[200:203]
    s_add_u32 m0, s49, 77824
    s_add_u32 s61, s48, 225280
    v_fmac_f32 v114, v150, v128
    v_mfma_f32_16x16x32_bf16 v[204:207], v[8:11], a[156:159], v[204:207]
    s_waitcnt lgkmcnt(5)
    v_fmac_f32 v115, v151, v128
    v_mul_f32 v96, v96, v132
    v_mfma_f32_16x16x32_bf16 v[152:155], v[12:15], a[144:147], v[152:155]
    ds_read_b128 v[28:31], v4 offset:23552
    v_mul_f32 v97, v97, v132
    v_mfma_f32_16x16x32_bf16 v[156:159], v[12:15], a[148:151], v[156:159]
    buffer_load_dwordx4 v2, s[4:7], s61 offen offset:0 lds
    v_mfma_f32_16x16x32_bf16 v[160:163], v[12:15], a[152:155], v[160:163]
    v_mul_f32 v98, v98, v132
    v_mul_f32 v99, v99, v132
    v_mfma_f32_16x16x32_bf16 v[164:167], v[12:15], a[156:159], v[164:167]
    s_waitcnt lgkmcnt(5)
    v_mul_f32 v96, v96, v112
    v_mul_f32 v97, v97, v113
    v_mfma_f32_16x16x32_bf16 v[192:195], v[16:19], a[160:163], v[192:195]
    ds_read_b128 v[8:11], v4 offset:24576
    v_mul_f32 v98, v98, v114
    v_mfma_f32_16x16x32_bf16 v[196:199], v[16:19], a[164:167], v[196:199]
    buffer_load_dwordx4 v2, s[4:7], s61 offen offset:1024 lds
    v_mfma_f32_16x16x32_bf16 v[200:203], v[16:19], a[168:171], v[200:203]
    v_mul_f32 v99, v99, v115
    v_cvt_pk_bf16_f32 v178, v96, v97
    v_mfma_f32_16x16x32_bf16 v[204:207], v[16:19], a[172:175], v[204:207]
    s_waitcnt lgkmcnt(3)
    v_cvt_pk_bf16_f32 v179, v98, v99
    v_mfma_f32_16x16x32_bf16 v[152:155], v[20:23], a[160:163], v[152:155]
    s_add_u32 s66, s51, 0
    ds_read_b128 v[12:15], v4 offset:25600
    v_mfma_f32_16x16x32_bf16 v[156:159], v[20:23], a[164:167], v[156:159]
    buffer_store_dwordx4 v[176:179], v2, s[4:7], s66 offen offset:0 sc1
    v_mfma_f32_16x16x32_bf16 v[160:163], v[20:23], a[168:171], v[160:163]
    v_fmac_f32 v100, v144, v129
    v_fmac_f32 v101, v145, v129
    v_mfma_f32_16x16x32_bf16 v[164:167], v[20:23], a[172:175], v[164:167]
    s_waitcnt lgkmcnt(3)
    v_fmac_f32 v102, v146, v129
    v_fmac_f32 v103, v147, v129
    v_mfma_f32_16x16x32_bf16 v[192:195], v[24:27], a[176:179], v[192:195]
    ds_read_b128 v[16:19], v4 offset:26624
    v_fmac_f32 v116, v148, v129
    v_mfma_f32_16x16x32_bf16 v[196:199], v[24:27], a[180:183], v[196:199]
    buffer_load_dwordx4 v2, s[4:7], s61 offen offset:2048 lds
    v_mfma_f32_16x16x32_bf16 v[200:203], v[24:27], a[184:187], v[200:203]
    v_fmac_f32 v117, v149, v129
    v_fmac_f32 v118, v150, v129
    v_mfma_f32_16x16x32_bf16 v[204:207], v[24:27], a[188:191], v[204:207]
    s_waitcnt lgkmcnt(3)
    v_fmac_f32 v119, v151, v129
    v_mul_f32 v100, v100, v133
    v_mfma_f32_16x16x32_bf16 v[152:155], v[28:31], a[176:179], v[152:155]
    ds_read_b128 v[20:23], v4 offset:27648
    v_mul_f32 v101, v101, v133
    v_mfma_f32_16x16x32_bf16 v[156:159], v[28:31], a[180:183], v[156:159]
    buffer_load_dwordx4 v2, s[4:7], s61 offen offset:3072 lds
    v_mfma_f32_16x16x32_bf16 v[160:163], v[28:31], a[184:187], v[160:163]
    s_add_u32 m0, s49, 81920
    s_add_u32 s61, s48, 229376
    v_mul_f32 v102, v102, v133
    v_mfma_f32_16x16x32_bf16 v[164:167], v[28:31], a[188:191], v[164:167]
    s_waitcnt lgkmcnt(3)
    v_mul_f32 v103, v103, v133
    v_mul_f32 v100, v100, v116
    v_mfma_f32_16x16x32_bf16 v[192:195], v[8:11], a[192:195], v[192:195]
    ds_read_b128 v[24:27], v4 offset:28672
    v_mul_f32 v101, v101, v117
    v_mfma_f32_16x16x32_bf16 v[196:199], v[8:11], a[196:199], v[196:199]
    buffer_load_dwordx4 v2, s[4:7], s61 offen offset:0 lds
    v_mfma_f32_16x16x32_bf16 v[200:203], v[8:11], a[200:203], v[200:203]
    v_mul_f32 v102, v102, v118
    v_mul_f32 v103, v103, v119
    v_mfma_f32_16x16x32_bf16 v[204:207], v[8:11], a[204:207], v[204:207]
    s_waitcnt lgkmcnt(3)
    v_cvt_pk_bf16_f32 v182, v100, v101
    v_cvt_pk_bf16_f32 v183, v102, v103
    v_mfma_f32_16x16x32_bf16 v[152:155], v[12:15], a[192:195], v[152:155]
    ds_read_b128 v[28:31], v4 offset:29696
    v_mfma_f32_16x16x32_bf16 v[156:159], v[12:15], a[196:199], v[156:159]
    buffer_store_dwordx4 v[180:183], v2, s[4:7], s66 offen offset:1024 sc1
    v_mfma_f32_16x16x32_bf16 v[160:163], v[12:15], a[200:203], v[160:163]
    v_fmac_f32 v104, v144, v130
    v_fmac_f32 v105, v145, v130
    v_mfma_f32_16x16x32_bf16 v[164:167], v[12:15], a[204:207], v[164:167]
    s_waitcnt lgkmcnt(3)
    v_fmac_f32 v106, v146, v130
    v_fmac_f32 v107, v147, v130
    v_mfma_f32_16x16x32_bf16 v[192:195], v[16:19], a[208:211], v[192:195]
    ds_read_b128 v[8:11], v4 offset:30720
    v_fmac_f32 v120, v148, v130
    v_mfma_f32_16x16x32_bf16 v[196:199], v[16:19], a[212:215], v[196:199]
    v_fmac_f32 v121, v149, v130
    v_fmac_f32 v122, v150, v130
    v_mfma_f32_16x16x32_bf16 v[200:203], v[16:19], a[216:219], v[200:203]
    v_fmac_f32 v123, v151, v130
    v_mul_f32 v104, v104, v134
    v_mfma_f32_16x16x32_bf16 v[204:207], v[16:19], a[220:223], v[204:207]
    s_waitcnt lgkmcnt(3)
    v_mul_f32 v105, v105, v134
    v_mul_f32 v106, v106, v134
    v_mfma_f32_16x16x32_bf16 v[152:155], v[20:23], a[208:211], v[152:155]
    ds_read_b128 v[12:15], v4 offset:31744
    v_mul_f32 v107, v107, v134
    v_mfma_f32_16x16x32_bf16 v[156:159], v[20:23], a[212:215], v[156:159]
    v_mul_f32 v104, v104, v120
    v_mul_f32 v105, v105, v121
    v_mfma_f32_16x16x32_bf16 v[160:163], v[20:23], a[216:219], v[160:163]
    v_mul_f32 v106, v106, v122
    v_mul_f32 v107, v107, v123
    v_mfma_f32_16x16x32_bf16 v[164:167], v[20:23], a[220:223], v[164:167]
    s_waitcnt lgkmcnt(3)
    v_cvt_pk_bf16_f32 v186, v104, v105
    v_cvt_pk_bf16_f32 v187, v106, v107
    v_mfma_f32_16x16x32_bf16 v[192:195], v[24:27], a[224:227], v[192:195]
    ds_read_b128 v[16:19], v4 offset:32768
    v_mfma_f32_16x16x32_bf16 v[196:199], v[24:27], a[228:231], v[196:199]
    buffer_store_dwordx4 v[184:187], v2, s[4:7], s66 offen offset:2048 sc1
    v_mfma_f32_16x16x32_bf16 v[200:203], v[24:27], a[232:235], v[200:203]
    v_fmac_f32 v108, v144, v131
    v_fmac_f32 v109, v145, v131
    v_mfma_f32_16x16x32_bf16 v[204:207], v[24:27], a[236:239], v[204:207]
    s_waitcnt lgkmcnt(3)
    v_fmac_f32 v110, v146, v131
    v_fmac_f32 v111, v147, v131
    v_mfma_f32_16x16x32_bf16 v[152:155], v[28:31], a[224:227], v[152:155]
    ds_read_b128 v[20:23], v4 offset:33792
    v_fmac_f32 v124, v148, v131
    v_mfma_f32_16x16x32_bf16 v[156:159], v[28:31], a[228:231], v[156:159]
    v_fmac_f32 v125, v149, v131
    v_fmac_f32 v126, v150, v131
    v_mfma_f32_16x16x32_bf16 v[160:163], v[28:31], a[232:235], v[160:163]
    v_fmac_f32 v127, v151, v131
    v_mul_f32 v108, v108, v135
    v_mfma_f32_16x16x32_bf16 v[164:167], v[28:31], a[236:239], v[164:167]
    s_waitcnt lgkmcnt(3)
    v_mul_f32 v109, v109, v135
    v_mul_f32 v110, v110, v135
    v_mfma_f32_16x16x32_bf16 v[192:195], v[8:11], a[240:243], v[192:195]
    ds_read_b128 v[24:27], v4 offset:34816
    v_mul_f32 v111, v111, v135
    v_mfma_f32_16x16x32_bf16 v[196:199], v[8:11], a[244:247], v[196:199]
    v_mul_f32 v108, v108, v124
    v_mul_f32 v109, v109, v125
    v_mfma_f32_16x16x32_bf16 v[200:203], v[8:11], a[248:251], v[200:203]
    v_mul_f32 v110, v110, v126
    v_mul_f32 v111, v111, v127
    v_mfma_f32_16x16x32_bf16 v[204:207], v[8:11], a[252:255], v[204:207]
    s_waitcnt lgkmcnt(3)
    v_cvt_pk_bf16_f32 v190, v108, v109
    v_cvt_pk_bf16_f32 v191, v110, v111
    v_mfma_f32_16x16x32_bf16 v[152:155], v[12:15], a[240:243], v[152:155]
    ds_read_b128 v[28:31], v4 offset:35840
    v_mfma_f32_16x16x32_bf16 v[156:159], v[12:15], a[244:247], v[156:159]
    buffer_store_dwordx4 v[188:191], v2, s[4:7], s66 offen offset:3072 sc1
    v_mfma_f32_16x16x32_bf16 v[160:163], v[12:15], a[248:251], v[160:163]
    ds_read_b128 v[144:147], v5 offset:384
    ds_read_b128 v[148:151], v5 offset:448
    v_mfma_f32_16x16x32_bf16 v[164:167], v[12:15], a[252:255], v[164:167]
    s_waitcnt lgkmcnt(5)
    v_fmac_f32 v208, v136, v128
    v_fmac_f32 v209, v137, v128
    v_mfma_f32_16x16x32_bf16 v[192:195], v[16:19], v[32:35], v[192:195]
    s_waitcnt vmcnt(22)
    s_barrier
    v_add_u32 v4, 0xfffe5000, v4
    v_mfma_f32_16x16x32_bf16 v[196:199], v[16:19], v[36:39], v[196:199]
    ds_read_b128 v[8:11], v4 offset:0
    v_fmac_f32 v210, v138, v128
    v_mfma_f32_16x16x32_bf16 v[200:203], v[16:19], v[40:43], v[200:203]
    v_fmac_f32 v211, v139, v128
    v_fmac_f32 v224, v140, v128
    v_mfma_f32_16x16x32_bf16 v[204:207], v[16:19], v[44:47], v[204:207]
    s_waitcnt lgkmcnt(5)
    v_fmac_f32 v225, v141, v128
    v_fmac_f32 v226, v142, v128
    v_mfma_f32_16x16x32_bf16 v[152:155], v[20:23], v[32:35], v[152:155]
    ds_read_b128 v[12:15], v4 offset:1024
    v_fmac_f32 v227, v143, v128
    v_mfma_f32_16x16x32_bf16 v[156:159], v[20:23], v[36:39], v[156:159]
    v_mul_f32 v208, v208, v132
    v_mul_f32 v209, v209, v132
    v_mfma_f32_16x16x32_bf16 v[160:163], v[20:23], v[40:43], v[160:163]
    v_mul_f32 v210, v210, v132
    v_mul_f32 v211, v211, v132
    v_mfma_f32_16x16x32_bf16 v[164:167], v[20:23], v[44:47], v[164:167]
    s_waitcnt lgkmcnt(5)
    v_mul_f32 v208, v208, v224
    v_mul_f32 v209, v209, v225
    v_mfma_f32_16x16x32_bf16 v[192:195], v[24:27], v[48:51], v[192:195]
    ds_read_b128 v[16:19], v4 offset:2048
    v_mul_f32 v210, v210, v226
    v_mfma_f32_16x16x32_bf16 v[196:199], v[24:27], v[52:55], v[196:199]
    v_mul_f32 v211, v211, v227
    v_cvt_pk_bf16_f32 v240, v208, v209
    v_mfma_f32_16x16x32_bf16 v[200:203], v[24:27], v[56:59], v[200:203]
    v_cvt_pk_bf16_f32 v241, v210, v211
    v_mfma_f32_16x16x32_bf16 v[204:207], v[24:27], v[60:63], v[204:207]
    s_waitcnt lgkmcnt(5)
    s_add_u32 s66, s51, s65
    v_mfma_f32_16x16x32_bf16 v[152:155], v[28:31], v[48:51], v[152:155]
    ds_read_b128 v[20:23], v4 offset:3072
    v_mfma_f32_16x16x32_bf16 v[156:159], v[28:31], v[52:55], v[156:159]
    buffer_store_dwordx2 v[240:241], v3, s[4:7], s66 offen offset:0 sc1
    v_mfma_f32_16x16x32_bf16 v[160:163], v[28:31], v[56:59], v[160:163]
    v_fmac_f32 v212, v136, v129
    v_fmac_f32 v213, v137, v129
    v_mfma_f32_16x16x32_bf16 v[164:167], v[28:31], v[60:63], v[164:167]
    s_waitcnt lgkmcnt(3)
    v_fmac_f32 v214, v138, v129
    v_fmac_f32 v215, v139, v129
    v_mfma_f32_16x16x32_bf16 v[96:99], v[8:11], a[0:3], 0
    ds_read_b128 v[24:27], v4 offset:4096
    v_fmac_f32 v228, v140, v129
    v_mfma_f32_16x16x32_bf16 v[100:103], v[8:11], a[4:7], 0
    v_fmac_f32 v229, v141, v129
    v_fmac_f32 v230, v142, v129
    v_mfma_f32_16x16x32_bf16 v[104:107], v[8:11], a[8:11], 0
    v_fmac_f32 v231, v143, v129
    v_mul_f32 v212, v212, v133
    v_mfma_f32_16x16x32_bf16 v[108:111], v[8:11], a[12:15], 0
    s_waitcnt lgkmcnt(3)
    v_mul_f32 v213, v213, v133
    v_mul_f32 v214, v214, v133
    v_mfma_f32_16x16x32_bf16 v[112:115], v[12:15], a[0:3], 0
    ds_read_b128 v[28:31], v4 offset:5120
    v_mul_f32 v215, v215, v133
    v_mfma_f32_16x16x32_bf16 v[116:119], v[12:15], a[4:7], 0
    v_mul_f32 v212, v212, v228
    v_mul_f32 v213, v213, v229
    v_mfma_f32_16x16x32_bf16 v[120:123], v[12:15], a[8:11], 0
    v_mul_f32 v214, v214, v230
    v_mul_f32 v215, v215, v231
    v_mfma_f32_16x16x32_bf16 v[124:127], v[12:15], a[12:15], 0
    s_waitcnt lgkmcnt(3)
    v_cvt_pk_bf16_f32 v244, v212, v213
    v_cvt_pk_bf16_f32 v245, v214, v215
    v_mfma_f32_16x16x32_bf16 v[96:99], v[16:19], a[16:19], v[96:99]
    ds_read_b128 v[8:11], v4 offset:6144
    v_mfma_f32_16x16x32_bf16 v[100:103], v[16:19], a[20:23], v[100:103]
    buffer_store_dwordx2 v[244:245], v3, s[4:7], s66 offen offset:512 sc1
    v_mfma_f32_16x16x32_bf16 v[104:107], v[16:19], a[24:27], v[104:107]
    v_fmac_f32 v216, v136, v130
    v_fmac_f32 v217, v137, v130
    v_mfma_f32_16x16x32_bf16 v[108:111], v[16:19], a[28:31], v[108:111]
    s_waitcnt lgkmcnt(3)
    v_fmac_f32 v218, v138, v130
    v_fmac_f32 v219, v139, v130
    v_mfma_f32_16x16x32_bf16 v[112:115], v[20:23], a[16:19], v[112:115]
    ds_read_b128 v[12:15], v4 offset:7168
    v_fmac_f32 v232, v140, v130
    v_mfma_f32_16x16x32_bf16 v[116:119], v[20:23], a[20:23], v[116:119]
    v_fmac_f32 v233, v141, v130
    v_fmac_f32 v234, v142, v130
    v_mfma_f32_16x16x32_bf16 v[120:123], v[20:23], a[24:27], v[120:123]
    v_fmac_f32 v235, v143, v130
    v_mul_f32 v216, v216, v134
    v_mfma_f32_16x16x32_bf16 v[124:127], v[20:23], a[28:31], v[124:127]
    s_waitcnt lgkmcnt(3)
    v_mul_f32 v217, v217, v134
    v_mul_f32 v218, v218, v134
    v_mfma_f32_16x16x32_bf16 v[96:99], v[24:27], a[32:35], v[96:99]
    ds_read_b128 v[16:19], v4 offset:8192
    v_mul_f32 v219, v219, v134
    v_mfma_f32_16x16x32_bf16 v[100:103], v[24:27], a[36:39], v[100:103]
    v_mul_f32 v216, v216, v232
    v_mul_f32 v217, v217, v233
    v_mfma_f32_16x16x32_bf16 v[104:107], v[24:27], a[40:43], v[104:107]
    v_mul_f32 v218, v218, v234
    v_mul_f32 v219, v219, v235
    v_mfma_f32_16x16x32_bf16 v[108:111], v[24:27], a[44:47], v[108:111]
    s_waitcnt lgkmcnt(3)
    v_cvt_pk_bf16_f32 v248, v216, v217
    v_cvt_pk_bf16_f32 v249, v218, v219
    v_mfma_f32_16x16x32_bf16 v[112:115], v[28:31], a[32:35], v[112:115]
    ds_read_b128 v[20:23], v4 offset:9216
    v_mfma_f32_16x16x32_bf16 v[116:119], v[28:31], a[36:39], v[116:119]
    buffer_store_dwordx2 v[248:249], v3, s[4:7], s66 offen offset:1024 sc1
    v_mfma_f32_16x16x32_bf16 v[120:123], v[28:31], a[40:43], v[120:123]
    v_fmac_f32 v220, v136, v131
    v_fmac_f32 v221, v137, v131
    v_mfma_f32_16x16x32_bf16 v[124:127], v[28:31], a[44:47], v[124:127]
    s_waitcnt lgkmcnt(3)
    v_fmac_f32 v222, v138, v131
    v_fmac_f32 v223, v139, v131
    v_mfma_f32_16x16x32_bf16 v[96:99], v[8:11], a[48:51], v[96:99]
    ds_read_b128 v[24:27], v4 offset:10240
    v_fmac_f32 v236, v140, v131
    v_mfma_f32_16x16x32_bf16 v[100:103], v[8:11], a[52:55], v[100:103]
    v_fmac_f32 v237, v141, v131
    v_fmac_f32 v238, v142, v131
    v_mfma_f32_16x16x32_bf16 v[104:107], v[8:11], a[56:59], v[104:107]
    v_fmac_f32 v239, v143, v131
    v_mul_f32 v220, v220, v135
    v_mfma_f32_16x16x32_bf16 v[108:111], v[8:11], a[60:63], v[108:111]
    s_waitcnt lgkmcnt(3)
    v_mul_f32 v221, v221, v135
    v_mul_f32 v222, v222, v135
    v_mfma_f32_16x16x32_bf16 v[112:115], v[12:15], a[48:51], v[112:115]
    ds_read_b128 v[28:31], v4 offset:11264
    v_mul_f32 v223, v223, v135
    v_mfma_f32_16x16x32_bf16 v[116:119], v[12:15], a[52:55], v[116:119]
    v_mul_f32 v220, v220, v236
    v_mul_f32 v221, v221, v237
    v_mfma_f32_16x16x32_bf16 v[120:123], v[12:15], a[56:59], v[120:123]
    v_mul_f32 v222, v222, v238
    v_mul_f32 v223, v223, v239
    v_mfma_f32_16x16x32_bf16 v[124:127], v[12:15], a[60:63], v[124:127]
    s_waitcnt lgkmcnt(3)
    v_cvt_pk_bf16_f32 v252, v220, v221
    v_cvt_pk_bf16_f32 v253, v222, v223
    v_mfma_f32_16x16x32_bf16 v[96:99], v[16:19], a[64:67], v[96:99]
    ds_read_b128 v[8:11], v4 offset:12288
    v_mfma_f32_16x16x32_bf16 v[100:103], v[16:19], a[68:71], v[100:103]
    buffer_store_dwordx2 v[252:253], v3, s[4:7], s66 offen offset:1536 sc1
    v_mfma_f32_16x16x32_bf16 v[104:107], v[16:19], a[72:75], v[104:107]
    ds_read_b128 v[136:139], v5 offset:512
    ds_read_b128 v[140:143], v5 offset:576
    v_mfma_f32_16x16x32_bf16 v[108:111], v[16:19], a[76:79], v[108:111]
    s_waitcnt lgkmcnt(5)
    v_fmac_f32 v192, v144, v128
    v_fmac_f32 v193, v145, v128
    v_mfma_f32_16x16x32_bf16 v[112:115], v[20:23], a[64:67], v[112:115]
    ds_read_b128 v[12:15], v4 offset:13312
    v_fmac_f32 v194, v146, v128
    v_mfma_f32_16x16x32_bf16 v[116:119], v[20:23], a[68:71], v[116:119]
    v_fmac_f32 v195, v147, v128
    v_fmac_f32 v152, v148, v128
    v_mfma_f32_16x16x32_bf16 v[120:123], v[20:23], a[72:75], v[120:123]
    v_fmac_f32 v153, v149, v128
    v_fmac_f32 v154, v150, v128
    v_mfma_f32_16x16x32_bf16 v[124:127], v[20:23], a[76:79], v[124:127]
    s_waitcnt lgkmcnt(5)
    v_fmac_f32 v155, v151, v128
    v_mul_f32 v192, v192, v132
    v_mfma_f32_16x16x32_bf16 v[96:99], v[24:27], a[80:83], v[96:99]
    ds_read_b128 v[16:19], v4 offset:14336
    v_mul_f32 v193, v193, v132
    v_mfma_f32_16x16x32_bf16 v[100:103], v[24:27], a[84:87], v[100:103]
    v_mul_f32 v194, v194, v132
    v_mul_f32 v195, v195, v132
    v_mfma_f32_16x16x32_bf16 v[104:107], v[24:27], a[88:91], v[104:107]
    v_mul_f32 v192, v192, v152
    v_mul_f32 v193, v193, v153
    v_mfma_f32_16x16x32_bf16 v[108:111], v[24:27], a[92:95], v[108:111]
    s_waitcnt lgkmcnt(5)
    v_mul_f32 v194, v194, v154
    v_mul_f32 v195, v195, v155
    v_mfma_f32_16x16x32_bf16 v[112:115], v[28:31], a[80:83], v[112:115]
    ds_read_b128 v[20:23], v4 offset:15360
    v_cvt_pk_bf16_f32 v192, v192, v193
    v_mfma_f32_16x16x32_bf16 v[116:119], v[28:31], a[84:87], v[116:119]
    v_cvt_pk_bf16_f32 v193, v194, v195
    v_fmac_f32 v196, v144, v129
    v_mfma_f32_16x16x32_bf16 v[120:123], v[28:31], a[88:91], v[120:123]
    v_fmac_f32 v197, v145, v129
    v_fmac_f32 v198, v146, v129
    v_mfma_f32_16x16x32_bf16 v[124:127], v[28:31], a[92:95], v[124:127]
    s_waitcnt lgkmcnt(5)
    v_fmac_f32 v199, v147, v129
    v_fmac_f32 v156, v148, v129
    v_mfma_f32_16x16x32_bf16 v[96:99], v[8:11], a[96:99], v[96:99]
    ds_read_b128 v[24:27], v4 offset:16384
    v_fmac_f32 v157, v149, v129
    v_mfma_f32_16x16x32_bf16 v[100:103], v[8:11], a[100:103], v[100:103]
    v_fmac_f32 v158, v150, v129
    v_fmac_f32 v159, v151, v129
    v_mfma_f32_16x16x32_bf16 v[104:107], v[8:11], a[104:107], v[104:107]
    v_mul_f32 v196, v196, v133
    v_mul_f32 v197, v197, v133
    v_mfma_f32_16x16x32_bf16 v[108:111], v[8:11], a[108:111], v[108:111]
    s_waitcnt lgkmcnt(3)
    v_mul_f32 v198, v198, v133
    v_mul_f32 v199, v199, v133
    v_mfma_f32_16x16x32_bf16 v[112:115], v[12:15], a[96:99], v[112:115]
    ds_read_b128 v[28:31], v4 offset:17408
    v_mul_f32 v196, v196, v156
    v_mfma_f32_16x16x32_bf16 v[116:119], v[12:15], a[100:103], v[116:119]
    v_mul_f32 v197, v197, v157
    v_mul_f32 v198, v198, v158
    v_mfma_f32_16x16x32_bf16 v[120:123], v[12:15], a[104:107], v[120:123]
    v_mul_f32 v199, v199, v159
    v_cvt_pk_bf16_f32 v196, v196, v197
    v_mfma_f32_16x16x32_bf16 v[124:127], v[12:15], a[108:111], v[124:127]
    s_waitcnt lgkmcnt(3)
    v_cvt_pk_bf16_f32 v197, v198, v199
    v_fmac_f32 v200, v144, v130
    v_mfma_f32_16x16x32_bf16 v[96:99], v[16:19], a[112:115], v[96:99]
    ds_read_b128 v[8:11], v4 offset:18432
    v_fmac_f32 v201, v145, v130
    v_mfma_f32_16x16x32_bf16 v[100:103], v[16:19], a[116:119], v[100:103]
    v_fmac_f32 v202, v146, v130
    v_fmac_f32 v203, v147, v130
    v_mfma_f32_16x16x32_bf16 v[104:107], v[16:19], a[120:123], v[104:107]
    v_fmac_f32 v160, v148, v130
    v_fmac_f32 v161, v149, v130
    v_mfma_f32_16x16x32_bf16 v[108:111], v[16:19], a[124:127], v[108:111]
    s_waitcnt lgkmcnt(3)
    v_fmac_f32 v162, v150, v130
    v_fmac_f32 v163, v151, v130
    v_mfma_f32_16x16x32_bf16 v[112:115], v[20:23], a[112:115], v[112:115]
    ds_read_b128 v[12:15], v4 offset:19456
    v_mul_f32 v200, v200, v134
    v_mfma_f32_16x16x32_bf16 v[116:119], v[20:23], a[116:119], v[116:119]
    v_mul_f32 v201, v201, v134
    v_mul_f32 v202, v202, v134
    v_mfma_f32_16x16x32_bf16 v[120:123], v[20:23], a[120:123], v[120:123]
    v_mul_f32 v203, v203, v134
    v_mul_f32 v200, v200, v160
    v_mfma_f32_16x16x32_bf16 v[124:127], v[20:23], a[124:127], v[124:127]
    s_waitcnt lgkmcnt(3)
    v_mul_f32 v201, v201, v161
    v_mul_f32 v202, v202, v162
    v_mfma_f32_16x16x32_bf16 v[96:99], v[24:27], a[128:131], v[96:99]
    ds_read_b128 v[16:19], v4 offset:20480
    v_mul_f32 v203, v203, v163
    v_mfma_f32_16x16x32_bf16 v[100:103], v[24:27], a[132:135], v[100:103]
    v_min_u32 v0, 17, v1
    v_lshlrev_b32 v0, 3, v0
    v_mfma_f32_16x16x32_bf16 v[104:107], v[24:27], a[136:139], v[104:107]
    s_add_u32 s55, s64, 288
    s_lshl_b32 s55, s55, 2
    s_add_u32 s55, s55, 0x8000000
    v_mfma_f32_16x16x32_bf16 v[108:111], v[24:27], a[140:143], v[108:111]
    s_waitcnt lgkmcnt(3)
    v_lshlrev_b32 v0, 2, v0
    v_cvt_pk_bf16_f32 v200, v200, v201
    v_mfma_f32_16x16x32_bf16 v[112:115], v[28:31], a[128:131], v[112:115]
    ds_read_b128 v[20:23], v4 offset:21504
    v_cvt_pk_bf16_f32 v201, v202, v203
    v_mfma_f32_16x16x32_bf16 v[116:119], v[28:31], a[132:135], v[116:119]
    buffer_load_dwordx2 v[6:7], v0, s[4:7], s55 offen sc1
    v_mfma_f32_16x16x32_bf16 v[120:123], v[28:31], a[136:139], v[120:123]
    v_fmac_f32 v204, v144, v131
    v_fmac_f32 v205, v145, v131
    v_mfma_f32_16x16x32_bf16 v[124:127], v[28:31], a[140:143], v[124:127]
    s_waitcnt lgkmcnt(3)
    v_fmac_f32 v206, v146, v131
    v_fmac_f32 v207, v147, v131
    v_mfma_f32_16x16x32_bf16 v[96:99], v[8:11], a[144:147], v[96:99]
    ds_read_b128 v[24:27], v4 offset:22528
    v_fmac_f32 v164, v148, v131
    v_mfma_f32_16x16x32_bf16 v[100:103], v[8:11], a[148:151], v[100:103]
    v_fmac_f32 v165, v149, v131
    v_fmac_f32 v166, v150, v131
    v_mfma_f32_16x16x32_bf16 v[104:107], v[8:11], a[152:155], v[104:107]
    v_fmac_f32 v167, v151, v131
    v_mul_f32 v204, v204, v135
    v_mfma_f32_16x16x32_bf16 v[108:111], v[8:11], a[156:159], v[108:111]
    s_waitcnt lgkmcnt(3)
    v_mul_f32 v205, v205, v135
    v_mul_f32 v206, v206, v135
    v_mfma_f32_16x16x32_bf16 v[112:115], v[12:15], a[144:147], v[112:115]
    ds_read_b128 v[28:31], v4 offset:23552
    v_mul_f32 v207, v207, v135
    v_mfma_f32_16x16x32_bf16 v[116:119], v[12:15], a[148:151], v[116:119]
    v_mul_f32 v204, v204, v164
    v_mul_f32 v205, v205, v165
    v_mfma_f32_16x16x32_bf16 v[120:123], v[12:15], a[152:155], v[120:123]
    v_mul_f32 v206, v206, v166
    v_mul_f32 v207, v207, v167
    v_mfma_f32_16x16x32_bf16 v[124:127], v[12:15], a[156:159], v[124:127]
    s_waitcnt lgkmcnt(3)
    v_cvt_pk_bf16_f32 v204, v204, v205
    v_cvt_pk_bf16_f32 v205, v206, v207
    v_mfma_f32_16x16x32_bf16 v[96:99], v[16:19], a[160:163], v[96:99]
    ds_read_b128 v[8:11], v4 offset:24576
    ds_read_b128 v[144:147], v5 offset:640
    v_mfma_f32_16x16x32_bf16 v[100:103], v[16:19], a[164:167], v[100:103]
    ds_read_b128 v[148:151], v5 offset:704
    v_mfma_f32_16x16x32_bf16 v[104:107], v[16:19], a[168:171], v[104:107]
    v_mfma_f32_16x16x32_bf16 v[108:111], v[16:19], a[172:175], v[108:111]
    s_waitcnt lgkmcnt(5)
    v_mfma_f32_16x16x32_bf16 v[112:115], v[20:23], a[160:163], v[112:115]
    ds_read_b128 v[12:15], v4 offset:25600
    v_mfma_f32_16x16x32_bf16 v[116:119], v[20:23], a[164:167], v[116:119]
    v_mfma_f32_16x16x32_bf16 v[120:123], v[20:23], a[168:171], v[120:123]
    v_mfma_f32_16x16x32_bf16 v[124:127], v[20:23], a[172:175], v[124:127]
    s_waitcnt lgkmcnt(5)
    v_mfma_f32_16x16x32_bf16 v[96:99], v[24:27], a[176:179], v[96:99]
    ds_read_b128 v[16:19], v4 offset:26624
    v_mfma_f32_16x16x32_bf16 v[100:103], v[24:27], a[180:183], v[100:103]
    v_mfma_f32_16x16x32_bf16 v[104:107], v[24:27], a[184:187], v[104:107]
    v_mfma_f32_16x16x32_bf16 v[108:111], v[24:27], a[188:191], v[108:111]
    s_waitcnt lgkmcnt(5)
    v_mfma_f32_16x16x32_bf16 v[112:115], v[28:31], a[176:179], v[112:115]
    ds_read_b128 v[20:23], v4 offset:27648
    v_mfma_f32_16x16x32_bf16 v[116:119], v[28:31], a[180:183], v[116:119]
    v_mfma_f32_16x16x32_bf16 v[120:123], v[28:31], a[184:187], v[120:123]
    v_mfma_f32_16x16x32_bf16 v[124:127], v[28:31], a[188:191], v[124:127]
    s_waitcnt lgkmcnt(5)
    v_mfma_f32_16x16x32_bf16 v[96:99], v[8:11], a[192:195], v[96:99]
    ds_read_b128 v[24:27], v4 offset:28672
    v_mfma_f32_16x16x32_bf16 v[100:103], v[8:11], a[196:199], v[100:103]
    v_mfma_f32_16x16x32_bf16 v[104:107], v[8:11], a[200:203], v[104:107]
    v_mfma_f32_16x16x32_bf16 v[108:111], v[8:11], a[204:207], v[108:111]
    s_waitcnt lgkmcnt(3)
    v_mfma_f32_16x16x32_bf16 v[112:115], v[12:15], a[192:195], v[112:115]
    ds_read_b128 v[28:31], v4 offset:29696
    v_mfma_f32_16x16x32_bf16 v[116:119], v[12:15], a[196:199], v[116:119]
    v_mfma_f32_16x16x32_bf16 v[120:123], v[12:15], a[200:203], v[120:123]
    v_mfma_f32_16x16x32_bf16 v[124:127], v[12:15], a[204:207], v[124:127]
    s_waitcnt lgkmcnt(3)
    v_mfma_f32_16x16x32_bf16 v[96:99], v[16:19], a[208:211], v[96:99]
    ds_read_b128 v[8:11], v4 offset:30720
    v_mfma_f32_16x16x32_bf16 v[100:103], v[16:19], a[212:215], v[100:103]
    v_mfma_f32_16x16x32_bf16 v[104:107], v[16:19], a[216:219], v[104:107]
    v_mfma_f32_16x16x32_bf16 v[108:111], v[16:19], a[220:223], v[108:111]
    s_waitcnt lgkmcnt(3)
    v_mfma_f32_16x16x32_bf16 v[112:115], v[20:23], a[208:211], v[112:115]
    ds_read_b128 v[12:15], v4 offset:31744
    v_mfma_f32_16x16x32_bf16 v[116:119], v[20:23], a[212:215], v[116:119]
    v_mfma_f32_16x16x32_bf16 v[120:123], v[20:23], a[216:219], v[120:123]
    v_mfma_f32_16x16x32_bf16 v[124:127], v[20:23], a[220:223], v[124:127]
    s_waitcnt lgkmcnt(3)
    v_mfma_f32_16x16x32_bf16 v[96:99], v[24:27], a[224:227], v[96:99]
    ds_read_b128 v[16:19], v4 offset:32768
    v_mfma_f32_16x16x32_bf16 v[100:103], v[24:27], a[228:231], v[100:103]
    v_mfma_f32_16x16x32_bf16 v[104:107], v[24:27], a[232:235], v[104:107]
    v_mfma_f32_16x16x32_bf16 v[108:111], v[24:27], a[236:239], v[108:111]
    s_waitcnt lgkmcnt(3)
    v_mfma_f32_16x16x32_bf16 v[112:115], v[28:31], a[224:227], v[112:115]
    ds_read_b128 v[20:23], v4 offset:33792
    v_mfma_f32_16x16x32_bf16 v[116:119], v[28:31], a[228:231], v[116:119]
    v_mfma_f32_16x16x32_bf16 v[120:123], v[28:31], a[232:235], v[120:123]
    v_mfma_f32_16x16x32_bf16 v[124:127], v[28:31], a[236:239], v[124:127]
    s_waitcnt lgkmcnt(3)
    v_mfma_f32_16x16x32_bf16 v[96:99], v[8:11], a[240:243], v[96:99]
    ds_read_b128 v[24:27], v4 offset:34816
    v_mfma_f32_16x16x32_bf16 v[100:103], v[8:11], a[244:247], v[100:103]
    v_mfma_f32_16x16x32_bf16 v[104:107], v[8:11], a[248:251], v[104:107]
    v_mfma_f32_16x16x32_bf16 v[108:111], v[8:11], a[252:255], v[108:111]
    s_waitcnt lgkmcnt(3)
    v_mfma_f32_16x16x32_bf16 v[112:115], v[12:15], a[240:243], v[112:115]
    ds_read_b128 v[28:31], v4 offset:35840
    v_mfma_f32_16x16x32_bf16 v[116:119], v[12:15], a[244:247], v[116:119]
    s_waitcnt vmcnt(0)
    v_cmp_eq_u64 vcc, s[98:99], v[6:7]
    s_nop 0
    s_cmp_eq_u64 vcc, exec
    s_cbranch_scc0 L_pd_slow_84
L_pd_back_85:
    v_mfma_f32_16x16x32_bf16 v[120:123], v[12:15], a[248:251], v[120:123]
    v_mfma_f32_16x16x32_bf16 v[124:127], v[12:15], a[252:255], v[124:127]
    s_waitcnt lgkmcnt(3)
    s_lshr_b32 s55, s22, 2
    s_lshl_b32 s55, s55, 2
    v_mfma_f32_16x16x32_bf16 v[96:99], v[16:19], v[32:35], v[96:99]
    s_barrier
    v_add_u32 v4, 0x9000, v4
    v_mfma_f32_16x16x32_bf16 v[100:103], v[16:19], v[36:39], v[100:103]
    s_add_u32 m0, s49, 110592
    s_add_u32 s61, s48, 258048
    ds_read_b128 v[8:11], v4 offset:0
    v_mfma_f32_16x16x32_bf16 v[104:107], v[16:19], v[40:43], v[104:107]
    buffer_load_dwordx4 v2, s[4:7], s61 offen offset:0 lds
    v_mfma_f32_16x16x32_bf16 v[108:111], v[16:19], v[44:47], v[108:111]
    s_waitcnt lgkmcnt(3)
    s_add_u32 s55, s55, s20
    s_mul_i32 s55, s55, 5248
    v_mfma_f32_16x16x32_bf16 v[112:115], v[20:23], v[32:35], v[112:115]
    s_mul_i32 s60, s47, 497664
    s_add_u32 s55, s55, s60
    ds_read_b128 v[12:15], v4 offset:1024
    v_mfma_f32_16x16x32_bf16 v[116:119], v[20:23], v[36:39], v[116:119]
    s_add_u32 s55, s55, 4526080
    v_min_u32 v0, 40, v1
    v_lshlrev_b32 v0, 7, v0
    v_mfma_f32_16x16x32_bf16 v[120:123], v[20:23], v[40:43], v[120:123]
    buffer_load_dwordx4 v2, s[4:7], s61 offen offset:1024 lds
    v_mfma_f32_16x16x32_bf16 v[124:127], v[20:23], v[44:47], v[124:127]
    s_waitcnt lgkmcnt(3)
    v_mfma_f32_16x16x32_bf16 v[96:99], v[24:27], v[48:51], v[96:99]
    ds_read_b128 v[16:19], v4 offset:2048
    v_mfma_f32_16x16x32_bf16 v[100:103], v[24:27], v[52:55], v[100:103]
    v_mfma_f32_16x16x32_bf16 v[104:107], v[24:27], v[56:59], v[104:107]
    buffer_load_dwordx4 v2, s[4:7], s61 offen offset:2048 lds
    v_mfma_f32_16x16x32_bf16 v[108:111], v[24:27], v[60:63], v[108:111]
    s_waitcnt lgkmcnt(3)
    v_mfma_f32_16x16x32_bf16 v[112:115], v[28:31], v[48:51], v[112:115]
    ds_read_b128 v[20:23], v4 offset:3072
    v_mfma_f32_16x16x32_bf16 v[116:119], v[28:31], v[52:55], v[116:119]
    v_mfma_f32_16x16x32_bf16 v[120:123], v[28:31], v[56:59], v[120:123]
    buffer_load_dwordx4 v2, s[4:7], s61 offen offset:3072 lds
    v_mfma_f32_16x16x32_bf16 v[124:127], v[28:31], v[60:63], v[124:127]
    s_waitcnt lgkmcnt(3)
    s_add_u32 m0, s49, 114688
    s_add_u32 s61, s48, 262144
    v_mfma_f32_16x16x32_bf16 v[64:67], v[8:11], a[0:3], 0
    ds_read_b128 v[24:27], v4 offset:4096
    v_mfma_f32_16x16x32_bf16 v[68:71], v[8:11], a[4:7], 0
    v_mfma_f32_16x16x32_bf16 v[72:75], v[8:11], a[8:11], 0
    buffer_load_dwordx4 v2, s[4:7], s61 offen offset:0 lds
    v_mfma_f32_16x16x32_bf16 v[76:79], v[8:11], a[12:15], 0
    s_waitcnt lgkmcnt(3)
    v_mfma_f32_16x16x32_bf16 v[80:83], v[12:15], a[0:3], 0
    ds_read_b128 v[28:31], v4 offset:5120
    v_mfma_f32_16x16x32_bf16 v[84:87], v[12:15], a[4:7], 0
    v_fmac_f32 v96, v136, v128
    v_fmac_f32 v97, v137, v128
    v_mfma_f32_16x16x32_bf16 v[88:91], v[12:15], a[8:11], 0
    buffer_load_dwordx4 v2, s[4:7], s61 offen offset:1024 lds
    v_mfma_f32_16x16x32_bf16 v[92:95], v[12:15], a[12:15], 0
    s_waitcnt lgkmcnt(3)
    v_fmac_f32 v98, v138, v128
    v_fmac_f32 v99, v139, v128
    v_mfma_f32_16x16x32_bf16 v[64:67], v[16:19], a[16:19], v[64:67]
    ds_read_b128 v[8:11], v4 offset:6144
    v_fmac_f32 v112, v140, v128
    v_mfma_f32_16x16x32_bf16 v[68:71], v[16:19], a[20:23], v[68:71]
    v_fmac_f32 v113, v141, v128
    v_fmac_f32 v114, v142, v128
    v_mfma_f32_16x16x32_bf16 v[72:75], v[16:19], a[24:27], v[72:75]
    buffer_load_dwordx4 v2, s[4:7], s61 offen offset:2048 lds
    v_mfma_f32_16x16x32_bf16 v[76:79], v[16:19], a[28:31], v[76:79]
    s_waitcnt lgkmcnt(3)
    v_fmac_f32 v115, v143, v128
    v_mul_f32 v96, v96, v132
    v_mfma_f32_16x16x32_bf16 v[80:83], v[20:23], a[16:19], v[80:83]
    ds_read_b128 v[12:15], v4 offset:7168
    v_mul_f32 v97, v97, v132
    v_mfma_f32_16x16x32_bf16 v[84:87], v[20:23], a[20:23], v[84:87]
    v_mul_f32 v98, v98, v132
    v_mul_f32 v99, v99, v132
    v_mfma_f32_16x16x32_bf16 v[88:91], v[20:23], a[24:27], v[88:91]
    buffer_load_dwordx4 v2, s[4:7], s61 offen offset:3072 lds
    v_mfma_f32_16x16x32_bf16 v[92:95], v[20:23], a[28:31], v[92:95]
    s_waitcnt lgkmcnt(3)
    s_add_u32 m0, s49, 118784
    s_add_u32 s61, s48, 266240
    v_mfma_f32_16x16x32_bf16 v[64:67], v[24:27], a[32:35], v[64:67]
    ds_read_b128 v[16:19], v4 offset:8192
    v_mul_f32 v96, v96, v112
    v_mfma_f32_16x16x32_bf16 v[68:71], v[24:27], a[36:39], v[68:71]
    v_mul_f32 v97, v97, v113
    v_mul_f32 v98, v98, v114
    v_mfma_f32_16x16x32_bf16 v[72:75], v[24:27], a[40:43], v[72:75]
    buffer_load_dwordx4 v2, s[4:7], s61 offen offset:0 lds
    v_mfma_f32_16x16x32_bf16 v[76:79], v[24:27], a[44:47], v[76:79]
    s_waitcnt lgkmcnt(3)
    v_mul_f32 v99, v99, v115
    v_cvt_pk_bf16_f32 v194, v96, v97
    v_mfma_f32_16x16x32_bf16 v[80:83], v[28:31], a[32:35], v[80:83]
    ds_read_b128 v[20:23], v4 offset:9216
    v_cvt_pk_bf16_f32 v195, v98, v99
    v_mfma_f32_16x16x32_bf16 v[84:87], v[28:31], a[36:39], v[84:87]
    s_add_u32 s66, s51, 16384
    v_mfma_f32_16x16x32_bf16 v[88:91], v[28:31], a[40:43], v[88:91]
    buffer_store_dwordx4 v[192:195], v2, s[4:7], s66 offen offset:0 sc1
    v_mfma_f32_16x16x32_bf16 v[92:95], v[28:31], a[44:47], v[92:95]
    s_waitcnt lgkmcnt(3)
    v_fmac_f32 v100, v136, v129
    v_fmac_f32 v101, v137, v129
    v_mfma_f32_16x16x32_bf16 v[64:67], v[8:11], a[48:51], v[64:67]
    ds_read_b128 v[24:27], v4 offset:10240
    v_fmac_f32 v102, v138, v129
    v_mfma_f32_16x16x32_bf16 v[68:71], v[8:11], a[52:55], v[68:71]
    v_fmac_f32 v103, v139, v129
    v_fmac_f32 v116, v140, v129
    v_mfma_f32_16x16x32_bf16 v[72:75], v[8:11], a[56:59], v[72:75]
    buffer_load_dword v6, v0, s[4:7], s55 offen
    v_mfma_f32_16x16x32_bf16 v[76:79], v[8:11], a[60:63], v[76:79]
    s_waitcnt lgkmcnt(3)
    v_fmac_f32 v117, v141, v129
    v_fmac_f32 v118, v142, v129
    v_mfma_f32_16x16x32_bf16 v[80:83], v[12:15], a[48:51], v[80:83]
    ds_read_b128 v[28:31], v4 offset:11264
    v_fmac_f32 v119, v143, v129
    v_mfma_f32_16x16x32_bf16 v[84:87], v[12:15], a[52:55], v[84:87]
    v_mul_f32 v100, v100, v133
    v_mul_f32 v101, v101, v133
    v_mfma_f32_16x16x32_bf16 v[88:91], v[12:15], a[56:59], v[88:91]
    v_mul_f32 v102, v102, v133
    v_mul_f32 v103, v103, v133
    v_mfma_f32_16x16x32_bf16 v[92:95], v[12:15], a[60:63], v[92:95]
    s_waitcnt lgkmcnt(3)
    v_mul_f32 v100, v100, v116
    v_mul_f32 v101, v101, v117
    v_mfma_f32_16x16x32_bf16 v[64:67], v[16:19], a[64:67], v[64:67]
    ds_read_b128 v[8:11], v4 offset:12288
    v_mul_f32 v102, v102, v118
    v_mfma_f32_16x16x32_bf16 v[68:71], v[16:19], a[68:71], v[68:71]
    v_mul_f32 v103, v103, v119
    v_cvt_pk_bf16_f32 v198, v100, v101
    v_mfma_f32_16x16x32_bf16 v[72:75], v[16:19], a[72:75], v[72:75]
    v_cvt_pk_bf16_f32 v199, v102, v103
    v_mfma_f32_16x16x32_bf16 v[76:79], v[16:19], a[76:79], v[76:79]
    s_waitcnt lgkmcnt(3)
    v_mfma_f32_16x16x32_bf16 v[80:83], v[20:23], a[64:67], v[80:83]
    ds_read_b128 v[12:15], v4 offset:13312
    v_mfma_f32_16x16x32_bf16 v[84:87], v[20:23], a[68:71], v[84:87]
    buffer_store_dwordx4 v[196:199], v2, s[4:7], s66 offen offset:1024 sc1
    v_mfma_f32_16x16x32_bf16 v[88:91], v[20:23], a[72:75], v[88:91]
    v_fmac_f32 v104, v136, v130
    v_fmac_f32 v105, v137, v130
    v_mfma_f32_16x16x32_bf16 v[92:95], v[20:23], a[76:79], v[92:95]
    s_waitcnt lgkmcnt(3)
    v_fmac_f32 v106, v138, v130
    v_fmac_f32 v107, v139, v130
    v_mfma_f32_16x16x32_bf16 v[64:67], v[24:27], a[80:83], v[64:67]
    ds_read_b128 v[16:19], v4 offset:14336
    v_fmac_f32 v120, v140, v130
    v_mfma_f32_16x16x32_bf16 v[68:71], v[24:27], a[84:87], v[68:71]
    v_fmac_f32 v121, v141, v130
    v_fmac_f32 v122, v142, v130
    v_mfma_f32_16x16x32_bf16 v[72:75], v[24:27], a[88:91], v[72:75]
    v_fmac_f32 v123, v143, v130
    v_mul_f32 v104, v104, v134
    v_mfma_f32_16x16x32_bf16 v[76:79], v[24:27], a[92:95], v[76:79]
    s_waitcnt lgkmcnt(3)
    v_mul_f32 v105, v105, v134
    v_mul_f32 v106, v106, v134
    v_mfma_f32_16x16x32_bf16 v[80:83], v[28:31], a[80:83], v[80:83]
    ds_read_b128 v[20:23], v4 offset:15360
    v_mul_f32 v107, v107, v134
    v_mfma_f32_16x16x32_bf16 v[84:87], v[28:31], a[84:87], v[84:87]
    v_mul_f32 v104, v104, v120
    v_mul_f32 v105, v105, v121
    v_mfma_f32_16x16x32_bf16 v[88:91], v[28:31], a[88:91], v[88:91]
    v_mul_f32 v106, v106, v122
    v_mul_f32 v107, v107, v123
    v_mfma_f32_16x16x32_bf16 v[92:95], v[28:31], a[92:95], v[92:95]
    s_waitcnt lgkmcnt(3)
    v_cvt_pk_bf16_f32 v202, v104, v105
    v_cvt_pk_bf16_f32 v203, v106, v107
    v_mfma_f32_16x16x32_bf16 v[64:67], v[8:11], a[96:99], v[64:67]
    ds_read_b128 v[24:27], v4 offset:16384
    v_mfma_f32_16x16x32_bf16 v[68:71], v[8:11], a[100:103], v[68:71]
    buffer_store_dwordx4 v[200:203], v2, s[4:7], s66 offen offset:2048 sc1
    v_mfma_f32_16x16x32_bf16 v[72:75], v[8:11], a[104:107], v[72:75]
    v_fmac_f32 v108, v136, v131
    v_fmac_f32 v109, v137, v131
    v_mfma_f32_16x16x32_bf16 v[76:79], v[8:11], a[108:111], v[76:79]
    s_waitcnt lgkmcnt(3)
    v_fmac_f32 v110, v138, v131
    v_fmac_f32 v111, v139, v131
    v_mfma_f32_16x16x32_bf16 v[80:83], v[12:15], a[96:99], v[80:83]
    ds_read_b128 v[28:31], v4 offset:17408
    v_fmac_f32 v124, v140, v131
    v_mfma_f32_16x16x32_bf16 v[84:87], v[12:15], a[100:103], v[84:87]
    v_fmac_f32 v125, v141, v131
    v_fmac_f32 v126, v142, v131
    v_mfma_f32_16x16x32_bf16 v[88:91], v[12:15], a[104:107], v[88:91]
    v_fmac_f32 v127, v143, v131
    v_mul_f32 v108, v108, v135
    v_mfma_f32_16x16x32_bf16 v[92:95], v[12:15], a[108:111], v[92:95]
    s_waitcnt lgkmcnt(3)
    v_mul_f32 v109, v109, v135
    v_mul_f32 v110, v110, v135
    v_mfma_f32_16x16x32_bf16 v[64:67], v[16:19], a[112:115], v[64:67]
    ds_read_b128 v[8:11], v4 offset:18432
    v_mul_f32 v111, v111, v135
    v_mfma_f32_16x16x32_bf16 v[68:71], v[16:19], a[116:119], v[68:71]
    v_mul_f32 v108, v108, v124
    v_mul_f32 v109, v109, v125
    v_mfma_f32_16x16x32_bf16 v[72:75], v[16:19], a[120:123], v[72:75]
    v_mul_f32 v110, v110, v126
    v_mul_f32 v111, v111, v127
    v_mfma_f32_16x16x32_bf16 v[76:79], v[16:19], a[124:127], v[76:79]
    s_waitcnt lgkmcnt(3)
    v_cvt_pk_bf16_f32 v206, v108, v109
    v_cvt_pk_bf16_f32 v207, v110, v111
    v_mfma_f32_16x16x32_bf16 v[80:83], v[20:23], a[112:115], v[80:83]
    ds_read_b128 v[12:15], v4 offset:19456
    v_mfma_f32_16x16x32_bf16 v[84:87], v[20:23], a[116:119], v[84:87]
    buffer_store_dwordx4 v[204:207], v2, s[4:7], s66 offen offset:3072 sc1
    v_mfma_f32_16x16x32_bf16 v[88:91], v[20:23], a[120:123], v[88:91]
    ds_read_b128 v[136:139], v5 offset:768
    ds_read_b128 v[140:143], v5 offset:832
    v_mfma_f32_16x16x32_bf16 v[92:95], v[20:23], a[124:127], v[92:95]
    s_waitcnt lgkmcnt(5)
    v_mfma_f32_16x16x32_bf16 v[64:67], v[24:27], a[128:131], v[64:67]
    ds_read_b128 v[16:19], v4 offset:20480
    v_mfma_f32_16x16x32_bf16 v[68:71], v[24:27], a[132:135], v[68:71]
    v_mfma_f32_16x16x32_bf16 v[72:75], v[24:27], a[136:139], v[72:75]
    v_mfma_f32_16x16x32_bf16 v[76:79], v[24:27], a[140:143], v[76:79]
    s_waitcnt lgkmcnt(5)
    v_mfma_f32_16x16x32_bf16 v[80:83], v[28:31], a[128:131], v[80:83]
    ds_read_b128 v[20:23], v4 offset:21504
    v_mfma_f32_16x16x32_bf16 v[84:87], v[28:31], a[132:135], v[84:87]
    v_mfma_f32_16x16x32_bf16 v[88:91], v[28:31], a[136:139], v[88:91]
    v_mfma_f32_16x16x32_bf16 v[92:95], v[28:31], a[140:143], v[92:95]
    s_waitcnt lgkmcnt(5)
    v_mfma_f32_16x16x32_bf16 v[64:67], v[8:11], a[144:147], v[64:67]
    ds_read_b128 v[24:27], v4 offset:22528
    v_mfma_f32_16x16x32_bf16 v[68:71], v[8:11], a[148:151], v[68:71]
    v_mfma_f32_16x16x32_bf16 v[72:75], v[8:11], a[152:155], v[72:75]
    v_mfma_f32_16x16x32_bf16 v[76:79], v[8:11], a[156:159], v[76:79]
    s_waitcnt lgkmcnt(5)
    v_mfma_f32_16x16x32_bf16 v[80:83], v[12:15], a[144:147], v[80:83]
    ds_read_b128 v[28:31], v4 offset:23552
    v_mfma_f32_16x16x32_bf16 v[84:87], v[12:15], a[148:151], v[84:87]
    v_mfma_f32_16x16x32_bf16 v[88:91], v[12:15], a[152:155], v[88:91]
    v_mfma_f32_16x16x32_bf16 v[92:95], v[12:15], a[156:159], v[92:95]
    s_waitcnt lgkmcnt(3)
    v_mfma_f32_16x16x32_bf16 v[64:67], v[16:19], a[160:163], v[64:67]
    ds_read_b128 v[8:11], v4 offset:24576
    v_mfma_f32_16x16x32_bf16 v[68:71], v[16:19], a[164:167], v[68:71]
    v_mfma_f32_16x16x32_bf16 v[72:75], v[16:19], a[168:171], v[72:75]
    v_mfma_f32_16x16x32_bf16 v[76:79], v[16:19], a[172:175], v[76:79]
    s_waitcnt lgkmcnt(3)
    v_mfma_f32_16x16x32_bf16 v[80:83], v[20:23], a[160:163], v[80:83]
    ds_read_b128 v[12:15], v4 offset:25600
    v_mfma_f32_16x16x32_bf16 v[84:87], v[20:23], a[164:167], v[84:87]
    v_mfma_f32_16x16x32_bf16 v[88:91], v[20:23], a[168:171], v[88:91]
    v_mfma_f32_16x16x32_bf16 v[92:95], v[20:23], a[172:175], v[92:95]
    s_waitcnt lgkmcnt(3)
    v_mfma_f32_16x16x32_bf16 v[64:67], v[24:27], a[176:179], v[64:67]
    ds_read_b128 v[16:19], v4 offset:26624
    v_mfma_f32_16x16x32_bf16 v[68:71], v[24:27], a[180:183], v[68:71]
    v_mfma_f32_16x16x32_bf16 v[72:75], v[24:27], a[184:187], v[72:75]
    v_mfma_f32_16x16x32_bf16 v[76:79], v[24:27], a[188:191], v[76:79]
    s_waitcnt lgkmcnt(3)
    v_mfma_f32_16x16x32_bf16 v[80:83], v[28:31], a[176:179], v[80:83]
    ds_read_b128 v[20:23], v4 offset:27648
    v_mfma_f32_16x16x32_bf16 v[84:87], v[28:31], a[180:183], v[84:87]
    v_mfma_f32_16x16x32_bf16 v[88:91], v[28:31], a[184:187], v[88:91]
    v_mfma_f32_16x16x32_bf16 v[92:95], v[28:31], a[188:191], v[92:95]
    s_waitcnt lgkmcnt(3)
    v_mfma_f32_16x16x32_bf16 v[64:67], v[8:11], a[192:195], v[64:67]
    ds_read_b128 v[24:27], v4 offset:28672
    v_mfma_f32_16x16x32_bf16 v[68:71], v[8:11], a[196:199], v[68:71]
    v_mfma_f32_16x16x32_bf16 v[72:75], v[8:11], a[200:203], v[72:75]
    v_mfma_f32_16x16x32_bf16 v[76:79], v[8:11], a[204:207], v[76:79]
    s_waitcnt lgkmcnt(3)
    v_mfma_f32_16x16x32_bf16 v[80:83], v[12:15], a[192:195], v[80:83]
    ds_read_b128 v[28:31], v4 offset:29696
    v_mfma_f32_16x16x32_bf16 v[84:87], v[12:15], a[196:199], v[84:87]
    v_mfma_f32_16x16x32_bf16 v[88:91], v[12:15], a[200:203], v[88:91]
    v_mfma_f32_16x16x32_bf16 v[92:95], v[12:15], a[204:207], v[92:95]
    s_waitcnt lgkmcnt(3)
    v_mfma_f32_16x16x32_bf16 v[64:67], v[16:19], a[208:211], v[64:67]
    ds_read_b128 v[8:11], v4 offset:30720
    v_mfma_f32_16x16x32_bf16 v[68:71], v[16:19], a[212:215], v[68:71]
    v_mfma_f32_16x16x32_bf16 v[72:75], v[16:19], a[216:219], v[72:75]
    v_mfma_f32_16x16x32_bf16 v[76:79], v[16:19], a[220:223], v[76:79]
    s_waitcnt lgkmcnt(3)
    v_mfma_f32_16x16x32_bf16 v[80:83], v[20:23], a[208:211], v[80:83]
    ds_read_b128 v[12:15], v4 offset:31744
    v_mfma_f32_16x16x32_bf16 v[84:87], v[20:23], a[212:215], v[84:87]
    v_mfma_f32_16x16x32_bf16 v[88:91], v[20:23], a[216:219], v[88:91]
    v_mfma_f32_16x16x32_bf16 v[92:95], v[20:23], a[220:223], v[92:95]
    s_waitcnt lgkmcnt(3)
    v_mfma_f32_16x16x32_bf16 v[64:67], v[24:27], a[224:227], v[64:67]
    ds_read_b128 v[16:19], v4 offset:32768
    v_mfma_f32_16x16x32_bf16 v[68:71], v[24:27], a[228:231], v[68:71]
    v_mfma_f32_16x16x32_bf16 v[72:75], v[24:27], a[232:235], v[72:75]
    v_mfma_f32_16x16x32_bf16 v[76:79], v[24:27], a[236:239], v[76:79]
    s_waitcnt lgkmcnt(3)
    v_mfma_f32_16x16x32_bf16 v[80:83], v[28:31], a[224:227], v[80:83]
    ds_read_b128 v[20:23], v4 offset:33792
    v_mfma_f32_16x16x32_bf16 v[84:87], v[28:31], a[228:231], v[84:87]
    v_mfma_f32_16x16x32_bf16 v[88:91], v[28:31], a[232:235], v[88:91]
    v_mfma_f32_16x16x32_bf16 v[92:95], v[28:31], a[236:239], v[92:95]
    s_waitcnt lgkmcnt(3)
    v_mfma_f32_16x16x32_bf16 v[64:67], v[8:11], a[240:243], v[64:67]
    ds_read_b128 v[24:27], v4 offset:34816
    v_mfma_f32_16x16x32_bf16 v[68:71], v[8:11], a[244:247], v[68:71]
    v_mfma_f32_16x16x32_bf16 v[72:75], v[8:11], a[248:251], v[72:75]
    v_mfma_f32_16x16x32_bf16 v[76:79], v[8:11], a[252:255], v[76:79]
    s_waitcnt lgkmcnt(3)
    v_mfma_f32_16x16x32_bf16 v[80:83], v[12:15], a[240:243], v[80:83]
    ds_read_b128 v[28:31], v4 offset:35840
    v_mfma_f32_16x16x32_bf16 v[84:87], v[12:15], a[244:247], v[84:87]
    v_mfma_f32_16x16x32_bf16 v[88:91], v[12:15], a[248:251], v[88:91]
    v_mfma_f32_16x16x32_bf16 v[92:95], v[12:15], a[252:255], v[92:95]
    s_waitcnt lgkmcnt(3)
    v_mfma_f32_16x16x32_bf16 v[64:67], v[16:19], v[32:35], v[64:67]
    s_barrier
    v_add_u32 v4, 0x9000, v4
    v_mfma_f32_16x16x32_bf16 v[68:71], v[16:19], v[36:39], v[68:71]
    s_add_u32 m0, s49, 0
    s_add_u32 s61, s48, 294912
    ds_read_b128 v[8:11], v4 offset:0
    v_mfma_f32_16x16x32_bf16 v[72:75], v[16:19], v[40:43], v[72:75]
    buffer_load_dwordx4 v2, s[4:7], s61 offen offset:0 lds
    v_mfma_f32_16x16x32_bf16 v[76:79], v[16:19], v[44:47], v[76:79]
    s_waitcnt lgkmcnt(3)
    v_mfma_f32_16x16x32_bf16 v[80:83], v[20:23], v[32:35], v[80:83]
    ds_read_b128 v[12:15], v4 offset:1024
    v_mfma_f32_16x16x32_bf16 v[84:87], v[20:23], v[36:39], v[84:87]
    v_mfma_f32_16x16x32_bf16 v[88:91], v[20:23], v[40:43], v[88:91]
    buffer_load_dwordx4 v2, s[4:7], s61 offen offset:1024 lds
    v_mfma_f32_16x16x32_bf16 v[92:95], v[20:23], v[44:47], v[92:95]
    s_waitcnt lgkmcnt(3)
    s_add_u32 s71, s67, 0
    s_waitcnt vmcnt(5)
    v_mov_b32 v6, s98
    v_mfma_f32_16x16x32_bf16 v[64:67], v[24:27], v[48:51], v[64:67]
    ds_read_b128 v[16:19], v4 offset:2048
    v_mov_b32 v7, s99
    v_mfma_f32_16x16x32_bf16 v[68:71], v[24:27], v[52:55], v[68:71]
    s_waitcnt vmcnt(2)
    v_mfma_f32_16x16x32_bf16 v[72:75], v[24:27], v[56:59], v[72:75]
    s_lshl_b32 s71, s71, 2
    s_add_u32 s71, s71, 0x8000000
    s_mov_b64 exec, 1
    buffer_store_dwordx2 v[6:7], off, s[4:7], s71 sc1
    s_mov_b64 exec, -1
    v_mfma_f32_16x16x32_bf16 v[76:79], v[24:27], v[60:63], v[76:79]
    s_waitcnt lgkmcnt(3)
    v_mfma_f32_16x16x32_bf16 v[80:83], v[28:31], v[48:51], v[80:83]
    ds_read_b128 v[20:23], v4 offset:3072
    v_mfma_f32_16x16x32_bf16 v[84:87], v[28:31], v[52:55], v[84:87]
    v_mfma_f32_16x16x32_bf16 v[88:91], v[28:31], v[56:59], v[88:91]
    buffer_load_dwordx4 v2, s[4:7], s61 offen offset:2048 lds
    v_mfma_f32_16x16x32_bf16 v[92:95], v[28:31], v[60:63], v[92:95]
    s_waitcnt lgkmcnt(3)
    v_mfma_f32_16x16x32_bf16 v[96:99], v[8:11], a[0:3], 0
    ds_read_b128 v[24:27], v4 offset:4096
    v_mfma_f32_16x16x32_bf16 v[100:103], v[8:11], a[4:7], 0
    v_mfma_f32_16x16x32_bf16 v[104:107], v[8:11], a[8:11], 0
    buffer_load_dwordx4 v2, s[4:7], s61 offen offset:3072 lds
    v_mfma_f32_16x16x32_bf16 v[108:111], v[8:11], a[12:15], 0
    s_waitcnt lgkmcnt(3)
    s_add_u32 m0, s49, 4096
    s_add_u32 s61, s48, 299008
    v_mfma_f32_16x16x32_bf16 v[112:115], v[12:15], a[0:3], 0
    ds_read_b128 v[28:31], v4 offset:5120
    v_mfma_f32_16x16x32_bf16 v[116:119], v[12:15], a[4:7], 0
    v_fmac_f32 v64, v144, v128
    v_fmac_f32 v65, v145, v128
    v_mfma_f32_16x16x32_bf16 v[120:123], v[12:15], a[8:11], 0
    buffer_load_dwordx4 v2, s[4:7], s61 offen offset:0 lds
    v_mfma_f32_16x16x32_bf16 v[124:127], v[12:15], a[12:15], 0
    s_waitcnt lgkmcnt(3)
    v_fmac_f32 v66, v146, v128
    v_fmac_f32 v67, v147, v128
    v_mfma_f32_16x16x32_bf16 v[96:99], v[16:19], a[16:19], v[96:99]
    ds_read_b128 v[8:11], v4 offset:6144
    v_fmac_f32 v80, v148, v128
    v_mfma_f32_16x16x32_bf16 v[100:103], v[16:19], a[20:23], v[100:103]
    v_fmac_f32 v81, v149, v128
    v_fmac_f32 v82, v150, v128
    v_mfma_f32_16x16x32_bf16 v[104:107], v[16:19], a[24:27], v[104:107]
    buffer_load_dwordx4 v2, s[4:7], s61 offen offset:1024 lds
    v_mfma_f32_16x16x32_bf16 v[108:111], v[16:19], a[28:31], v[108:111]
    s_waitcnt lgkmcnt(3)
    v_fmac_f32 v83, v151, v128
    v_mul_f32 v64, v64, v132
    v_mfma_f32_16x16x32_bf16 v[112:115], v[20:23], a[16:19], v[112:115]
    ds_read_b128 v[12:15], v4 offset:7168
    v_mul_f32 v65, v65, v132
    v_mfma_f32_16x16x32_bf16 v[116:119], v[20:23], a[20:23], v[116:119]
    v_mul_f32 v66, v66, v132
    v_mul_f32 v67, v67, v132
    v_mfma_f32_16x16x32_bf16 v[120:123], v[20:23], a[24:27], v[120:123]
    buffer_load_dwordx4 v2, s[4:7], s61 offen offset:2048 lds
    v_mfma_f32_16x16x32_bf16 v[124:127], v[20:23], a[28:31], v[124:127]
    s_waitcnt lgkmcnt(3)
    v_mul_f32 v64, v64, v80
    v_mul_f32 v65, v65, v81
    v_mfma_f32_16x16x32_bf16 v[96:99], v[24:27], a[32:35], v[96:99]
    ds_read_b128 v[16:19], v4 offset:8192
    v_mul_f32 v66, v66, v82
    v_mfma_f32_16x16x32_bf16 v[100:103], v[24:27], a[36:39], v[100:103]
    v_mul_f32 v67, v67, v83
    v_cvt_pk_bf16_f32 v208, v64, v65
    v_mfma_f32_16x16x32_bf16 v[104:107], v[24:27], a[40:43], v[104:107]
    buffer_load_dwordx4 v2, s[4:7], s61 offen offset:3072 lds
    v_mfma_f32_16x16x32_bf16 v[108:111], v[24:27], a[44:47], v[108:111]
    s_waitcnt lgkmcnt(3)
    s_add_u32 m0, s49, 8192
    s_add_u32 s61, s48, 303104
    v_mfma_f32_16x16x32_bf16 v[112:115], v[28:31], a[32:35], v[112:115]
    ds_read_b128 v[20:23], v4 offset:9216
    v_cvt_pk_bf16_f32 v209, v66, v67
    v_mfma_f32_16x16x32_bf16 v[116:119], v[28:31], a[36:39], v[116:119]
    v_fmac_f32 v68, v144, v129
    v_fmac_f32 v69, v145, v129
    v_mfma_f32_16x16x32_bf16 v[120:123], v[28:31], a[40:43], v[120:123]
    buffer_load_dwordx4 v2, s[4:7], s61 offen offset:0 lds
    v_mfma_f32_16x16x32_bf16 v[124:127], v[28:31], a[44:47], v[124:127]
    s_waitcnt lgkmcnt(3)
    v_fmac_f32 v70, v146, v129
    v_fmac_f32 v71, v147, v129
    v_mfma_f32_16x16x32_bf16 v[96:99], v[8:11], a[48:51], v[96:99]
    ds_read_b128 v[24:27], v4 offset:10240
    v_fmac_f32 v84, v148, v129
    v_mfma_f32_16x16x32_bf16 v[100:103], v[8:11], a[52:55], v[100:103]
    v_fmac_f32 v85, v149, v129
    v_fmac_f32 v86, v150, v129
    v_mfma_f32_16x16x32_bf16 v[104:107], v[8:11], a[56:59], v[104:107]
    v_fmac_f32 v87, v151, v129
    v_mul_f32 v68, v68, v133
    v_mfma_f32_16x16x32_bf16 v[108:111], v[8:11], a[60:63], v[108:111]
    s_waitcnt lgkmcnt(3)
    v_mul_f32 v69, v69, v133
    v_mul_f32 v70, v70, v133
    v_mfma_f32_16x16x32_bf16 v[112:115], v[12:15], a[48:51], v[112:115]
    ds_read_b128 v[28:31], v4 offset:11264
    v_mul_f32 v71, v71, v133
    v_mfma_f32_16x16x32_bf16 v[116:119], v[12:15], a[52:55], v[116:119]
    v_mul_f32 v68, v68, v84
    v_mul_f32 v69, v69, v85
    v_mfma_f32_16x16x32_bf16 v[120:123], v[12:15], a[56:59], v[120:123]
    v_mul_f32 v70, v70, v86
    v_mul_f32 v71, v71, v87
    v_mfma_f32_16x16x32_bf16 v[124:127], v[12:15], a[60:63], v[124:127]
    s_waitcnt lgkmcnt(3)
    v_cvt_pk_bf16_f32 v212, v68, v69
    v_cvt_pk_bf16_f32 v213, v70, v71
    v_mfma_f32_16x16x32_bf16 v[96:99], v[16:19], a[64:67], v[96:99]
    ds_read_b128 v[8:11], v4 offset:12288
    v_fmac_f32 v72, v144, v130
    v_mfma_f32_16x16x32_bf16 v[100:103], v[16:19], a[68:71], v[100:103]
    v_fmac_f32 v73, v145, v130
    v_fmac_f32 v74, v146, v130
    v_mfma_f32_16x16x32_bf16 v[104:107], v[16:19], a[72:75], v[104:107]
    v_fmac_f32 v75, v147, v130
    v_fmac_f32 v88, v148, v130
    v_mfma_f32_16x16x32_bf16 v[108:111], v[16:19], a[76:79], v[108:111]
    s_waitcnt lgkmcnt(3)
    v_fmac_f32 v89, v149, v130
    v_fmac_f32 v90, v150, v130
    v_mfma_f32_16x16x32_bf16 v[112:115], v[20:23], a[64:67], v[112:115]
    ds_read_b128 v[12:15], v4 offset:13312
    v_fmac_f32 v91, v151, v130
    v_mfma_f32_16x16x32_bf16 v[116:119], v[20:23], a[68:71], v[116:119]
    v_mul_f32 v72, v72, v134
    v_mul_f32 v73, v73, v134
    v_mfma_f32_16x16x32_bf16 v[120:123], v[20:23], a[72:75], v[120:123]
    v_mul_f32 v74, v74, v134
    v_mul_f32 v75, v75, v134
    v_mfma_f32_16x16x32_bf16 v[124:127], v[20:23], a[76:79], v[124:127]
    s_waitcnt lgkmcnt(3)
    v_mul_f32 v72, v72, v88
    v_mul_f32 v73, v73, v89
    v_mfma_f32_16x16x32_bf16 v[96:99], v[24:27], a[80:83], v[96:99]
    ds_read_b128 v[16:19], v4 offset:14336
    v_mul_f32 v74, v74, v90
    v_mfma_f32_16x16x32_bf16 v[100:103], v[24:27], a[84:87], v[100:103]
    v_mul_f32 v75, v75, v91
    v_cvt_pk_bf16_f32 v216, v72, v73
    v_mfma_f32_16x16x32_bf16 v[104:107], v[24:27], a[88:91], v[104:107]
    v_cvt_pk_bf16_f32 v217, v74, v75
    v_fmac_f32 v76, v144, v131
    v_mfma_f32_16x16x32_bf16 v[108:111], v[24:27], a[92:95], v[108:111]
    s_waitcnt lgkmcnt(3)
    v_fmac_f32 v77, v145, v131
    v_fmac_f32 v78, v146, v131
    v_mfma_f32_16x16x32_bf16 v[112:115], v[28:31], a[80:83], v[112:115]
    ds_read_b128 v[20:23], v4 offset:15360
    v_fmac_f32 v79, v147, v131
    v_mfma_f32_16x16x32_bf16 v[116:119], v[28:31], a[84:87], v[116:119]
    v_fmac_f32 v92, v148, v131
    v_fmac_f32 v93, v149, v131
    v_mfma_f32_16x16x32_bf16 v[120:123], v[28:31], a[88:91], v[120:123]
    v_fmac_f32 v94, v150, v131
    v_fmac_f32 v95, v151, v131
    v_mfma_f32_16x16x32_bf16 v[124:127], v[28:31], a[92:95], v[124:127]
    s_waitcnt lgkmcnt(3)
    v_mul_f32 v76, v76, v135
    v_mul_f32 v77, v77, v135
    v_mfma_f32_16x16x32_bf16 v[96:99], v[8:11], a[96:99], v[96:99]
    ds_read_b128 v[24:27], v4 offset:16384
    v_mul_f32 v78, v78, v135
    v_mfma_f32_16x16x32_bf16 v[100:103], v[8:11], a[100:103], v[100:103]
    v_mul_f32 v79, v79, v135
    v_mul_f32 v76, v76, v92
    v_mfma_f32_16x16x32_bf16 v[104:107], v[8:11], a[104:107], v[104:107]
    v_mul_f32 v77, v77, v93
    v_mul_f32 v78, v78, v94
    v_mfma_f32_16x16x32_bf16 v[108:111], v[8:11], a[108:111], v[108:111]
    s_waitcnt lgkmcnt(3)
    v_mul_f32 v79, v79, v95
    v_cvt_pk_bf16_f32 v220, v76, v77
    v_mfma_f32_16x16x32_bf16 v[112:115], v[12:15], a[96:99], v[112:115]
    ds_read_b128 v[28:31], v4 offset:17408
    v_cvt_pk_bf16_f32 v221, v78, v79
    v_mfma_f32_16x16x32_bf16 v[116:119], v[12:15], a[100:103], v[116:119]
    ds_read_b128 v[144:147], v5 offset:896
    ds_read_b128 v[148:151], v5 offset:960
    v_mfma_f32_16x16x32_bf16 v[120:123], v[12:15], a[104:107], v[120:123]
    v_mfma_f32_16x16x32_bf16 v[124:127], v[12:15], a[108:111], v[124:127]
    s_waitcnt lgkmcnt(5)
    v_mfma_f32_16x16x32_bf16 v[96:99], v[16:19], a[112:115], v[96:99]
    ds_read_b128 v[8:11], v4 offset:18432
    v_mfma_f32_16x16x32_bf16 v[100:103], v[16:19], a[116:119], v[100:103]
    v_mfma_f32_16x16x32_bf16 v[104:107], v[16:19], a[120:123], v[104:107]
    v_mfma_f32_16x16x32_bf16 v[108:111], v[16:19], a[124:127], v[108:111]
    s_waitcnt lgkmcnt(5)
    v_mfma_f32_16x16x32_bf16 v[112:115], v[20:23], a[112:115], v[112:115]
    ds_read_b128 v[12:15], v4 offset:19456
    v_mfma_f32_16x16x32_bf16 v[116:119], v[20:23], a[116:119], v[116:119]
    v_mfma_f32_16x16x32_bf16 v[120:123], v[20:23], a[120:123], v[120:123]
    v_mfma_f32_16x16x32_bf16 v[124:127], v[20:23], a[124:127], v[124:127]
    s_waitcnt lgkmcnt(5)
    v_mfma_f32_16x16x32_bf16 v[96:99], v[24:27], a[128:131], v[96:99]
    ds_read_b128 v[16:19], v4 offset:20480
    v_mfma_f32_16x16x32_bf16 v[100:103], v[24:27], a[132:135], v[100:103]
    v_mfma_f32_16x16x32_bf16 v[104:107], v[24:27], a[136:139], v[104:107]
    v_mfma_f32_16x16x32_bf16 v[108:111], v[24:27], a[140:143], v[108:111]
    s_waitcnt lgkmcnt(5)
    v_mfma_f32_16x16x32_bf16 v[112:115], v[28:31], a[128:131], v[112:115]
    ds_read_b128 v[20:23], v4 offset:21504
    v_mfma_f32_16x16x32_bf16 v[116:119], v[28:31], a[132:135], v[116:119]
    v_mfma_f32_16x16x32_bf16 v[120:123], v[28:31], a[136:139], v[120:123]
    v_mfma_f32_16x16x32_bf16 v[124:127], v[28:31], a[140:143], v[124:127]
    s_waitcnt lgkmcnt(3)
    v_mfma_f32_16x16x32_bf16 v[96:99], v[8:11], a[144:147], v[96:99]
    ds_read_b128 v[24:27], v4 offset:22528
    v_mfma_f32_16x16x32_bf16 v[100:103], v[8:11], a[148:151], v[100:103]
    v_mfma_f32_16x16x32_bf16 v[104:107], v[8:11], a[152:155], v[104:107]
    v_mfma_f32_16x16x32_bf16 v[108:111], v[8:11], a[156:159], v[108:111]
    s_waitcnt lgkmcnt(3)
    v_mfma_f32_16x16x32_bf16 v[112:115], v[12:15], a[144:147], v[112:115]
    ds_read_b128 v[28:31], v4 offset:23552
    v_mfma_f32_16x16x32_bf16 v[116:119], v[12:15], a[148:151], v[116:119]
    v_mfma_f32_16x16x32_bf16 v[120:123], v[12:15], a[152:155], v[120:123]
    v_mfma_f32_16x16x32_bf16 v[124:127], v[12:15], a[156:159], v[124:127]
    s_waitcnt lgkmcnt(3)
    v_mfma_f32_16x16x32_bf16 v[96:99], v[16:19], a[160:163], v[96:99]
    ds_read_b128 v[8:11], v4 offset:24576
    v_mfma_f32_16x16x32_bf16 v[100:103], v[16:19], a[164:167], v[100:103]
    v_mfma_f32_16x16x32_bf16 v[104:107], v[16:19], a[168:171], v[104:107]
    v_mfma_f32_16x16x32_bf16 v[108:111], v[16:19], a[172:175], v[108:111]
    s_waitcnt lgkmcnt(3)
    v_mfma_f32_16x16x32_bf16 v[112:115], v[20:23], a[160:163], v[112:115]
    ds_read_b128 v[12:15], v4 offset:25600
    v_mfma_f32_16x16x32_bf16 v[116:119], v[20:23], a[164:167], v[116:119]
    v_mfma_f32_16x16x32_bf16 v[120:123], v[20:23], a[168:171], v[120:123]
    v_mfma_f32_16x16x32_bf16 v[124:127], v[20:23], a[172:175], v[124:127]
    s_waitcnt lgkmcnt(3)
    v_mfma_f32_16x16x32_bf16 v[96:99], v[24:27], a[176:179], v[96:99]
    ds_read_b128 v[16:19], v4 offset:26624
    v_mfma_f32_16x16x32_bf16 v[100:103], v[24:27], a[180:183], v[100:103]
    v_mfma_f32_16x16x32_bf16 v[104:107], v[24:27], a[184:187], v[104:107]
    v_mfma_f32_16x16x32_bf16 v[108:111], v[24:27], a[188:191], v[108:111]
    s_waitcnt lgkmcnt(3)
    v_mfma_f32_16x16x32_bf16 v[112:115], v[28:31], a[176:179], v[112:115]
    ds_read_b128 v[20:23], v4 offset:27648
    v_mfma_f32_16x16x32_bf16 v[116:119], v[28:31], a[180:183], v[116:119]
    v_mfma_f32_16x16x32_bf16 v[120:123], v[28:31], a[184:187], v[120:123]
    v_mfma_f32_16x16x32_bf16 v[124:127], v[28:31], a[188:191], v[124:127]
    s_waitcnt lgkmcnt(3)
    v_mfma_f32_16x16x32_bf16 v[96:99], v[8:11], a[192:195], v[96:99]
    ds_read_b128 v[24:27], v4 offset:28672
    v_mfma_f32_16x16x32_bf16 v[100:103], v[8:11], a[196:199], v[100:103]
    v_mfma_f32_16x16x32_bf16 v[104:107], v[8:11], a[200:203], v[104:107]
    v_mfma_f32_16x16x32_bf16 v[108:111], v[8:11], a[204:207], v[108:111]
    s_waitcnt lgkmcnt(3)
    v_mfma_f32_16x16x32_bf16 v[112:115], v[12:15], a[192:195], v[112:115]
    ds_read_b128 v[28:31], v4 offset:29696
    v_mfma_f32_16x16x32_bf16 v[116:119], v[12:15], a[196:199], v[116:119]
    v_mfma_f32_16x16x32_bf16 v[120:123], v[12:15], a[200:203], v[120:123]
    v_mfma_f32_16x16x32_bf16 v[124:127], v[12:15], a[204:207], v[124:127]
    s_waitcnt lgkmcnt(3)
    v_mfma_f32_16x16x32_bf16 v[96:99], v[16:19], a[208:211], v[96:99]
    ds_read_b128 v[8:11], v4 offset:30720
    v_mfma_f32_16x16x32_bf16 v[100:103], v[16:19], a[212:215], v[100:103]
    v_mfma_f32_16x16x32_bf16 v[104:107], v[16:19], a[216:219], v[104:107]
    v_mfma_f32_16x16x32_bf16 v[108:111], v[16:19], a[220:223], v[108:111]
    s_waitcnt lgkmcnt(3)
    v_mfma_f32_16x16x32_bf16 v[112:115], v[20:23], a[208:211], v[112:115]
    ds_read_b128 v[12:15], v4 offset:31744
    v_mfma_f32_16x16x32_bf16 v[116:119], v[20:23], a[212:215], v[116:119]
    v_mfma_f32_16x16x32_bf16 v[120:123], v[20:23], a[216:219], v[120:123]
    v_mfma_f32_16x16x32_bf16 v[124:127], v[20:23], a[220:223], v[124:127]
    s_waitcnt lgkmcnt(3)
    v_mfma_f32_16x16x32_bf16 v[96:99], v[24:27], a[224:227], v[96:99]
    ds_read_b128 v[16:19], v4 offset:32768
    v_mfma_f32_16x16x32_bf16 v[100:103], v[24:27], a[228:231], v[100:103]
    v_mfma_f32_16x16x32_bf16 v[104:107], v[24:27], a[232:235], v[104:107]
    v_mfma_f32_16x16x32_bf16 v[108:111], v[24:27], a[236:239], v[108:111]
    s_waitcnt lgkmcnt(3)
    v_mfma_f32_16x16x32_bf16 v[112:115], v[28:31], a[224:227], v[112:115]
    ds_read_b128 v[20:23], v4 offset:33792
    v_mfma_f32_16x16x32_bf16 v[116:119], v[28:31], a[228:231], v[116:119]
    v_mfma_f32_16x16x32_bf16 v[120:123], v[28:31], a[232:235], v[120:123]
    v_mfma_f32_16x16x32_bf16 v[124:127], v[28:31], a[236:239], v[124:127]
    s_waitcnt lgkmcnt(3)
    v_mfma_f32_16x16x32_bf16 v[96:99], v[8:11], a[240:243], v[96:99]
    ds_read_b128 v[24:27], v4 offset:34816
    v_mfma_f32_16x16x32_bf16 v[100:103], v[8:11], a[244:247], v[100:103]
    v_mfma_f32_16x16x32_bf16 v[104:107], v[8:11], a[248:251], v[104:107]
    v_mfma_f32_16x16x32_bf16 v[108:111], v[8:11], a[252:255], v[108:111]
    s_waitcnt lgkmcnt(3)
    v_mfma_f32_16x16x32_bf16 v[112:115], v[12:15], a[240:243], v[112:115]
    ds_read_b128 v[28:31], v4 offset:35840
    v_mfma_f32_16x16x32_bf16 v[116:119], v[12:15], a[244:247], v[116:119]
    v_mfma_f32_16x16x32_bf16 v[120:123], v[12:15], a[248:251], v[120:123]
    v_mfma_f32_16x16x32_bf16 v[124:127], v[12:15], a[252:255], v[124:127]
    s_waitcnt lgkmcnt(3)
    v_mfma_f32_16x16x32_bf16 v[96:99], v[16:19], v[32:35], v[96:99]
    s_barrier
    v_add_u32 v4, 0x9000, v4
    v_mfma_f32_16x16x32_bf16 v[100:103], v[16:19], v[36:39], v[100:103]
    s_add_u32 m0, s49, 36864
    s_add_u32 s61, s48, 331776
    ds_read_b128 v[8:11], v4 offset:0
    v_mfma_f32_16x16x32_bf16 v[104:107], v[16:19], v[40:43], v[104:107]
    buffer_load_dwordx4 v2, s[4:7], s61 offen offset:0 lds
    v_mfma_f32_16x16x32_bf16 v[108:111], v[16:19], v[44:47], v[108:111]
    s_waitcnt lgkmcnt(3)
    v_mfma_f32_16x16x32_bf16 v[112:115], v[20:23], v[32:35], v[112:115]
    ds_read_b128 v[12:15], v4 offset:1024
    v_mfma_f32_16x16x32_bf16 v[116:119], v[20:23], v[36:39], v[116:119]
    v_mfma_f32_16x16x32_bf16 v[120:123], v[20:23], v[40:43], v[120:123]
    buffer_load_dwordx4 v2, s[4:7], s61 offen offset:1024 lds
    v_mfma_f32_16x16x32_bf16 v[124:127], v[20:23], v[44:47], v[124:127]
    s_waitcnt lgkmcnt(3)
    v_mfma_f32_16x16x32_bf16 v[96:99], v[24:27], v[48:51], v[96:99]
    ds_read_b128 v[16:19], v4 offset:2048
    v_mfma_f32_16x16x32_bf16 v[100:103], v[24:27], v[52:55], v[100:103]
    v_mfma_f32_16x16x32_bf16 v[104:107], v[24:27], v[56:59], v[104:107]
    buffer_load_dwordx4 v2, s[4:7], s61 offen offset:2048 lds
    v_mfma_f32_16x16x32_bf16 v[108:111], v[24:27], v[60:63], v[108:111]
    s_waitcnt lgkmcnt(3)
    v_mfma_f32_16x16x32_bf16 v[112:115], v[28:31], v[48:51], v[112:115]
    ds_read_b128 v[20:23], v4 offset:3072
    v_mfma_f32_16x16x32_bf16 v[116:119], v[28:31], v[52:55], v[116:119]
    v_mfma_f32_16x16x32_bf16 v[120:123], v[28:31], v[56:59], v[120:123]
    buffer_load_dwordx4 v2, s[4:7], s61 offen offset:3072 lds
    v_mfma_f32_16x16x32_bf16 v[124:127], v[28:31], v[60:63], v[124:127]
    s_waitcnt lgkmcnt(3)
    s_add_u32 m0, s49, 40960
    s_add_u32 s61, s48, 335872
    v_mfma_f32_16x16x32_bf16 v[64:67], v[8:11], a[0:3], 0
    ds_read_b128 v[24:27], v4 offset:4096
    v_mfma_f32_16x16x32_bf16 v[68:71], v[8:11], a[4:7], 0
    v_mfma_f32_16x16x32_bf16 v[72:75], v[8:11], a[8:11], 0
    buffer_load_dwordx4 v2, s[4:7], s61 offen offset:0 lds
    v_mfma_f32_16x16x32_bf16 v[76:79], v[8:11], a[12:15], 0
    s_waitcnt lgkmcnt(3)
    v_mfma_f32_16x16x32_bf16 v[80:83], v[12:15], a[0:3], 0
    ds_read_b128 v[28:31], v4 offset:5120
    v_mfma_f32_16x16x32_bf16 v[84:87], v[12:15], a[4:7], 0
    v_fmac_f32 v96, v136, v128
    v_fmac_f32 v97, v137, v128
    v_mfma_f32_16x16x32_bf16 v[88:91], v[12:15], a[8:11], 0
    buffer_load_dwordx4 v2, s[4:7], s61 offen offset:1024 lds
    v_mfma_f32_16x16x32_bf16 v[92:95], v[12:15], a[12:15], 0
    s_waitcnt lgkmcnt(3)
    v_fmac_f32 v98, v138, v128
    v_fmac_f32 v99, v139, v128
    v_mfma_f32_16x16x32_bf16 v[64:67], v[16:19], a[16:19], v[64:67]
    ds_read_b128 v[8:11], v4 offset:6144
    v_fmac_f32 v112, v140, v128
    v_mfma_f32_16x16x32_bf16 v[68:71], v[16:19], a[20:23], v[68:71]
    v_fmac_f32 v113, v141, v128
    v_fmac_f32 v114, v142, v128
    v_mfma_f32_16x16x32_bf16 v[72:75], v[16:19], a[24:27], v[72:75]
    buffer_load_dwordx4 v2, s[4:7], s61 offen offset:2048 lds
    v_mfma_f32_16x16x32_bf16 v[76:79], v[16:19], a[28:31], v[76:79]
    s_waitcnt lgkmcnt(3)
    v_fmac_f32 v115, v143, v128
    v_mul_f32 v96, v96, v132
    v_mfma_f32_16x16x32_bf16 v[80:83], v[20:23], a[16:19], v[80:83]
    ds_read_b128 v[12:15], v4 offset:7168
    v_mul_f32 v97, v97, v132
    v_mfma_f32_16x16x32_bf16 v[84:87], v[20:23], a[20:23], v[84:87]
    v_mul_f32 v98, v98, v132
    v_mul_f32 v99, v99, v132
    v_mfma_f32_16x16x32_bf16 v[88:91], v[20:23], a[24:27], v[88:91]
    buffer_load_dwordx4 v2, s[4:7], s61 offen offset:3072 lds
    v_mfma_f32_16x16x32_bf16 v[92:95], v[20:23], a[28:31], v[92:95]
    s_waitcnt lgkmcnt(3)
    s_add_u32 m0, s49, 45056
    s_add_u32 s61, s48, 339968
    v_mfma_f32_16x16x32_bf16 v[64:67], v[24:27], a[32:35], v[64:67]
    ds_read_b128 v[16:19], v4 offset:8192
    v_mul_f32 v96, v96, v112
    v_mfma_f32_16x16x32_bf16 v[68:71], v[24:27], a[36:39], v[68:71]
    v_mul_f32 v97, v97, v113
    v_mul_f32 v98, v98, v114
    v_mfma_f32_16x16x32_bf16 v[72:75], v[24:27], a[40:43], v[72:75]
    buffer_load_dwordx4 v2, s[4:7], s61 offen offset:0 lds
    v_mfma_f32_16x16x32_bf16 v[76:79], v[24:27], a[44:47], v[76:79]
    s_waitcnt lgkmcnt(3)
    v_mul_f32 v99, v99, v115
    v_cvt_pk_bf16_f32 v210, v96, v97
    v_mfma_f32_16x16x32_bf16 v[80:83], v[28:31], a[32:35], v[80:83]
    ds_read_b128 v[20:23], v4 offset:9216
    v_cvt_pk_bf16_f32 v211, v98, v99
    v_mfma_f32_16x16x32_bf16 v[84:87], v[28:31], a[36:39], v[84:87]
    s_add_u32 s66, s51, 32768
    v_mfma_f32_16x16x32_bf16 v[88:91], v[28:31], a[40:43], v[88:91]
    buffer_store_dwordx4 v[208:211], v2, s[4:7], s66 offen offset:0 sc1
    v_mfma_f32_16x16x32_bf16 v[92:95], v[28:31], a[44:47], v[92:95]
    s_waitcnt lgkmcnt(3)
    v_fmac_f32 v100, v136, v129
    v_fmac_f32 v101, v137, v129
    v_mfma_f32_16x16x32_bf16 v[64:67], v[8:11], a[48:51], v[64:67]
    ds_read_b128 v[24:27], v4 offset:10240
    v_fmac_f32 v102, v138, v129
    v_mfma_f32_16x16x32_bf16 v[68:71], v[8:11], a[52:55], v[68:71]
    v_fmac_f32 v103, v139, v129
    v_fmac_f32 v116, v140, v129
    v_mfma_f32_16x16x32_bf16 v[72:75], v[8:11], a[56:59], v[72:75]
    v_fmac_f32 v117, v141, v129
    v_fmac_f32 v118, v142, v129
    v_mfma_f32_16x16x32_bf16 v[76:79], v[8:11], a[60:63], v[76:79]
    s_waitcnt lgkmcnt(3)
    v_fmac_f32 v119, v143, v129
    v_mul_f32 v100, v100, v133
    v_mfma_f32_16x16x32_bf16 v[80:83], v[12:15], a[48:51], v[80:83]
    ds_read_b128 v[28:31], v4 offset:11264
    v_mul_f32 v101, v101, v133
    v_mfma_f32_16x16x32_bf16 v[84:87], v[12:15], a[52:55], v[84:87]
    v_mul_f32 v102, v102, v133
    v_mul_f32 v103, v103, v133
    v_mfma_f32_16x16x32_bf16 v[88:91], v[12:15], a[56:59], v[88:91]
    v_mul_f32 v100, v100, v116
    v_mul_f32 v101, v101, v117
    v_mfma_f32_16x16x32_bf16 v[92:95], v[12:15], a[60:63], v[92:95]
    s_waitcnt lgkmcnt(3)
    v_mul_f32 v102, v102, v118
    v_mul_f32 v103, v103, v119
    v_mfma_f32_16x16x32_bf16 v[64:67], v[16:19], a[64:67], v[64:67]
    ds_read_b128 v[8:11], v4 offset:12288
    v_cvt_pk_bf16_f32 v214, v100, v101
    v_mfma_f32_16x16x32_bf16 v[68:71], v[16:19], a[68:71], v[68:71]
    v_cvt_pk_bf16_f32 v215, v102, v103
    v_mfma_f32_16x16x32_bf16 v[72:75], v[16:19], a[72:75], v[72:75]
    buffer_store_dwordx4 v[212:215], v2, s[4:7], s66 offen offset:1024 sc1
    v_mfma_f32_16x16x32_bf16 v[76:79], v[16:19], a[76:79], v[76:79]
    s_waitcnt lgkmcnt(3)
    v_fmac_f32 v104, v136, v130
    v_fmac_f32 v105, v137, v130
    v_mfma_f32_16x16x32_bf16 v[80:83], v[20:23], a[64:67], v[80:83]
    ds_read_b128 v[12:15], v4 offset:13312
    v_fmac_f32 v106, v138, v130
    v_mfma_f32_16x16x32_bf16 v[84:87], v[20:23], a[68:71], v[84:87]
    v_fmac_f32 v107, v139, v130
    v_fmac_f32 v120, v140, v130
    v_mfma_f32_16x16x32_bf16 v[88:91], v[20:23], a[72:75], v[88:91]
    v_fmac_f32 v121, v141, v130
    v_fmac_f32 v122, v142, v130
    v_mfma_f32_16x16x32_bf16 v[92:95], v[20:23], a[76:79], v[92:95]
    s_waitcnt lgkmcnt(3)
    v_fmac_f32 v123, v143, v130
    v_mul_f32 v104, v104, v134
    v_mfma_f32_16x16x32_bf16 v[64:67], v[24:27], a[80:83], v[64:67]
    ds_read_b128 v[16:19], v4 offset:14336
    v_mul_f32 v105, v105, v134
    v_mfma_f32_16x16x32_bf16 v[68:71], v[24:27], a[84:87], v[68:71]
    v_mul_f32 v106, v106, v134
    v_mul_f32 v107, v107, v134
    v_mfma_f32_16x16x32_bf16 v[72:75], v[24:27], a[88:91], v[72:75]
    v_mul_f32 v104, v104, v120
    v_mul_f32 v105, v105, v121
    v_mfma_f32_16x16x32_bf16 v[76:79], v[24:27], a[92:95], v[76:79]
    s_waitcnt lgkmcnt(3)
    v_mul_f32 v106, v106, v122
    v_mul_f32 v107, v107, v123
    v_mfma_f32_16x16x32_bf16 v[80:83], v[28:31], a[80:83], v[80:83]
    ds_read_b128 v[20:23], v4 offset:15360
    v_cvt_pk_bf16_f32 v218, v104, v105
    v_mfma_f32_16x16x32_bf16 v[84:87], v[28:31], a[84:87], v[84:87]
    v_cvt_pk_bf16_f32 v219, v106, v107
    v_mfma_f32_16x16x32_bf16 v[88:91], v[28:31], a[88:91], v[88:91]
    buffer_store_dwordx4 v[216:219], v2, s[4:7], s66 offen offset:2048 sc1
    v_mfma_f32_16x16x32_bf16 v[92:95], v[28:31], a[92:95], v[92:95]
    s_waitcnt lgkmcnt(3)
    v_and_b32 v0, 3, v1
    v_lshlrev_b32 v0, 3, v0
    v_mfma_f32_16x16x32_bf16 v[64:67], v[8:11], a[96:99], v[64:67]
    s_mov_b32 s55, s52
    ds_read_b128 v[24:27], v4 offset:16384
    v_fmac_f32 v108, v136, v131
    v_mfma_f32_16x16x32_bf16 v[68:71], v[8:11], a[100:103], v[68:71]
    v_fmac_f32 v109, v137, v131
    v_fmac_f32 v110, v138, v131
    v_mfma_f32_16x16x32_bf16 v[72:75], v[8:11], a[104:107], v[72:75]
    v_fmac_f32 v111, v139, v131
    v_fmac_f32 v124, v140, v131
    v_mfma_f32_16x16x32_bf16 v[76:79], v[8:11], a[108:111], v[76:79]
    s_waitcnt lgkmcnt(3)
    v_fmac_f32 v125, v141, v131
    v_fmac_f32 v126, v142, v131
    v_mfma_f32_16x16x32_bf16 v[80:83], v[12:15], a[96:99], v[80:83]
    ds_read_b128 v[28:31], v4 offset:17408
    v_fmac_f32 v127, v143, v131
    v_mfma_f32_16x16x32_bf16 v[84:87], v[12:15], a[100:103], v[84:87]
    v_mul_f32 v108, v108, v135
    v_mul_f32 v109, v109, v135
    v_mfma_f32_16x16x32_bf16 v[88:91], v[12:15], a[104:107], v[88:91]
    v_mul_f32 v110, v110, v135
    v_mul_f32 v111, v111, v135
    v_mfma_f32_16x16x32_bf16 v[92:95], v[12:15], a[108:111], v[92:95]
    s_waitcnt lgkmcnt(3)
    v_mul_f32 v108, v108, v124
    v_mul_f32 v109, v109, v125
    v_mfma_f32_16x16x32_bf16 v[64:67], v[16:19], a[112:115], v[64:67]
    ds_read_b128 v[8:11], v4 offset:18432
    v_mul_f32 v110, v110, v126
    v_mfma_f32_16x16x32_bf16 v[68:71], v[16:19], a[116:119], v[68:71]
    v_mul_f32 v111, v111, v127
    v_cvt_pk_bf16_f32 v222, v108, v109
    v_mfma_f32_16x16x32_bf16 v[72:75], v[16:19], a[120:123], v[72:75]
    v_cvt_pk_bf16_f32 v223, v110, v111
    v_mfma_f32_16x16x32_bf16 v[76:79], v[16:19], a[124:127], v[76:79]
    s_waitcnt lgkmcnt(3)
    v_mfma_f32_16x16x32_bf16 v[80:83], v[20:23], a[112:115], v[80:83]
    ds_read_b128 v[12:15], v4 offset:19456
    v_mfma_f32_16x16x32_bf16 v[84:87], v[20:23], a[116:119], v[84:87]
    buffer_store_dwordx4 v[220:223], v2, s[4:7], s66 offen offset:3072 sc1
    v_mfma_f32_16x16x32_bf16 v[88:91], v[20:23], a[120:123], v[88:91]
    ds_read_b128 v[136:139], v5 offset:1024
    ds_read_b128 v[140:143], v5 offset:1088
    v_mfma_f32_16x16x32_bf16 v[92:95], v[20:23], a[124:127], v[92:95]
    s_waitcnt lgkmcnt(5)
    s_lshl_b32 s55, s55, 2
    s_add_u32 s55, s55, 0x8000000
    v_mfma_f32_16x16x32_bf16 v[64:67], v[24:27], a[128:131], v[64:67]
    ds_read_b128 v[16:19], v4 offset:20480
    v_lshlrev_b32 v0, 2, v0
    v_mfma_f32_16x16x32_bf16 v[68:71], v[24:27], a[132:135], v[68:71]
    v_mfma_f32_16x16x32_bf16 v[72:75], v[24:27], a[136:139], v[72:75]
    v_mfma_f32_16x16x32_bf16 v[76:79], v[24:27], a[140:143], v[76:79]
    s_waitcnt lgkmcnt(5)
    v_mfma_f32_16x16x32_bf16 v[80:83], v[28:31], a[128:131], v[80:83]
    ds_read_b128 v[20:23], v4 offset:21504
    v_mfma_f32_16x16x32_bf16 v[84:87], v[28:31], a[132:135], v[84:87]
    buffer_load_dwordx2 v[6:7], v0, s[4:7], s55 offen sc1
    v_mfma_f32_16x16x32_bf16 v[88:91], v[28:31], a[136:139], v[88:91]
    v_mfma_f32_16x16x32_bf16 v[92:95], v[28:31], a[140:143], v[92:95]
    s_waitcnt lgkmcnt(5)
    v_mfma_f32_16x16x32_bf16 v[64:67], v[8:11], a[144:147], v[64:67]
    ds_read_b128 v[24:27], v4 offset:22528
    v_mfma_f32_16x16x32_bf16 v[68:71], v[8:11], a[148:151], v[68:71]
    v_mfma_f32_16x16x32_bf16 v[72:75], v[8:11], a[152:155], v[72:75]
    v_mfma_f32_16x16x32_bf16 v[76:79], v[8:11], a[156:159], v[76:79]
    s_waitcnt lgkmcnt(5)
    v_mfma_f32_16x16x32_bf16 v[80:83], v[12:15], a[144:147], v[80:83]
    ds_read_b128 v[28:31], v4 offset:23552
    v_mfma_f32_16x16x32_bf16 v[84:87], v[12:15], a[148:151], v[84:87]
    v_mfma_f32_16x16x32_bf16 v[88:91], v[12:15], a[152:155], v[88:91]
    v_mfma_f32_16x16x32_bf16 v[92:95], v[12:15], a[156:159], v[92:95]
    s_waitcnt lgkmcnt(3)
    v_mfma_f32_16x16x32_bf16 v[64:67], v[16:19], a[160:163], v[64:67]
    ds_read_b128 v[8:11], v4 offset:24576
    v_mfma_f32_16x16x32_bf16 v[68:71], v[16:19], a[164:167], v[68:71]
    v_mfma_f32_16x16x32_bf16 v[72:75], v[16:19], a[168:171], v[72:75]
    v_mfma_f32_16x16x32_bf16 v[76:79], v[16:19], a[172:175], v[76:79]
    s_waitcnt lgkmcnt(3)
    v_mfma_f32_16x16x32_bf16 v[80:83], v[20:23], a[160:163], v[80:83]
    ds_read_b128 v[12:15], v4 offset:25600
    v_mfma_f32_16x16x32_bf16 v[84:87], v[20:23], a[164:167], v[84:87]
    v_mfma_f32_16x16x32_bf16 v[88:91], v[20:23], a[168:171], v[88:91]
    v_mfma_f32_16x16x32_bf16 v[92:95], v[20:23], a[172:175], v[92:95]
    s_waitcnt lgkmcnt(3)
    v_mfma_f32_16x16x32_bf16 v[64:67], v[24:27], a[176:179], v[64:67]
    ds_read_b128 v[16:19], v4 offset:26624
    v_mfma_f32_16x16x32_bf16 v[68:71], v[24:27], a[180:183], v[68:71]
    v_mfma_f32_16x16x32_bf16 v[72:75], v[24:27], a[184:187], v[72:75]
    v_mfma_f32_16x16x32_bf16 v[76:79], v[24:27], a[188:191], v[76:79]
    s_waitcnt lgkmcnt(3)
    v_mfma_f32_16x16x32_bf16 v[80:83], v[28:31], a[176:179], v[80:83]
    ds_read_b128 v[20:23], v4 offset:27648
    v_mfma_f32_16x16x32_bf16 v[84:87], v[28:31], a[180:183], v[84:87]
    v_mfma_f32_16x16x32_bf16 v[88:91], v[28:31], a[184:187], v[88:91]
    v_mfma_f32_16x16x32_bf16 v[92:95], v[28:31], a[188:191], v[92:95]
    s_waitcnt lgkmcnt(3)
    v_mfma_f32_16x16x32_bf16 v[64:67], v[8:11], a[192:195], v[64:67]
    ds_read_b128 v[24:27], v4 offset:28672
    v_mfma_f32_16x16x32_bf16 v[68:71], v[8:11], a[196:199], v[68:71]
    v_mfma_f32_16x16x32_bf16 v[72:75], v[8:11], a[200:203], v[72:75]
    v_mfma_f32_16x16x32_bf16 v[76:79], v[8:11], a[204:207], v[76:79]
    s_waitcnt lgkmcnt(3)
    v_mfma_f32_16x16x32_bf16 v[80:83], v[12:15], a[192:195], v[80:83]
    ds_read_b128 v[28:31], v4 offset:29696
    v_mfma_f32_16x16x32_bf16 v[84:87], v[12:15], a[196:199], v[84:87]
    v_mfma_f32_16x16x32_bf16 v[88:91], v[12:15], a[200:203], v[88:91]
    v_mfma_f32_16x16x32_bf16 v[92:95], v[12:15], a[204:207], v[92:95]
    s_waitcnt lgkmcnt(3)
    v_mfma_f32_16x16x32_bf16 v[64:67], v[16:19], a[208:211], v[64:67]
    ds_read_b128 v[8:11], v4 offset:30720
    v_mfma_f32_16x16x32_bf16 v[68:71], v[16:19], a[212:215], v[68:71]
    v_mfma_f32_16x16x32_bf16 v[72:75], v[16:19], a[216:219], v[72:75]
    v_mfma_f32_16x16x32_bf16 v[76:79], v[16:19], a[220:223], v[76:79]
    s_waitcnt lgkmcnt(3)
    v_mfma_f32_16x16x32_bf16 v[80:83], v[20:23], a[208:211], v[80:83]
    ds_read_b128 v[12:15], v4 offset:31744
    v_mfma_f32_16x16x32_bf16 v[84:87], v[20:23], a[212:215], v[84:87]
    v_mfma_f32_16x16x32_bf16 v[88:91], v[20:23], a[216:219], v[88:91]
    v_mfma_f32_16x16x32_bf16 v[92:95], v[20:23], a[220:223], v[92:95]
    s_waitcnt lgkmcnt(3)
    v_mfma_f32_16x16x32_bf16 v[64:67], v[24:27], a[224:227], v[64:67]
    ds_read_b128 v[16:19], v4 offset:32768
    v_mfma_f32_16x16x32_bf16 v[68:71], v[24:27], a[228:231], v[68:71]
    v_mfma_f32_16x16x32_bf16 v[72:75], v[24:27], a[232:235], v[72:75]
    v_mfma_f32_16x16x32_bf16 v[76:79], v[24:27], a[236:239], v[76:79]
    s_waitcnt lgkmcnt(3)
    v_mfma_f32_16x16x32_bf16 v[80:83], v[28:31], a[224:227], v[80:83]
    ds_read_b128 v[20:23], v4 offset:33792
    v_mfma_f32_16x16x32_bf16 v[84:87], v[28:31], a[228:231], v[84:87]
    v_mfma_f32_16x16x32_bf16 v[88:91], v[28:31], a[232:235], v[88:91]
    v_mfma_f32_16x16x32_bf16 v[92:95], v[28:31], a[236:239], v[92:95]
    s_waitcnt lgkmcnt(3)
    v_mfma_f32_16x16x32_bf16 v[64:67], v[8:11], a[240:243], v[64:67]
    ds_read_b128 v[24:27], v4 offset:34816
    v_mfma_f32_16x16x32_bf16 v[68:71], v[8:11], a[244:247], v[68:71]
    v_mfma_f32_16x16x32_bf16 v[72:75], v[8:11], a[248:251], v[72:75]
    v_mfma_f32_16x16x32_bf16 v[76:79], v[8:11], a[252:255], v[76:79]
    s_waitcnt lgkmcnt(3)
    v_mfma_f32_16x16x32_bf16 v[80:83], v[12:15], a[240:243], v[80:83]
    s_waitcnt vmcnt(0)
    v_cmp_eq_u64 vcc, s[98:99], v[6:7]
    s_nop 0
    s_cmp_eq_u64 vcc, exec
    s_cbranch_scc0 L_p0_slow_87
L_p0_back_88:
    v_mfma_f32_16x16x32_bf16 v[84:87], v[12:15], a[244:247], v[84:87]
    s_add_u32 s60, s56, s65
    ds_read_b128 v[28:31], v4 offset:35840
    v_mfma_f32_16x16x32_bf16 v[88:91], v[12:15], a[248:251], v[88:91]
    buffer_load_dwordx2 v[242:243], v3, s[4:7], s60 offen offset:0 sc1
    v_mfma_f32_16x16x32_bf16 v[92:95], v[12:15], a[252:255], v[92:95]
    s_waitcnt lgkmcnt(3)
    v_mfma_f32_16x16x32_bf16 v[64:67], v[16:19], v[32:35], v[64:67]
    s_barrier
    v_add_u32 v4, 0xfffe5000, v4
    v_mfma_f32_16x16x32_bf16 v[68:71], v[16:19], v[36:39], v[68:71]
    s_add_u32 m0, s49, 73728
    s_add_u32 s61, s48, 368640
    ds_read_b128 v[8:11], v4 offset:0
    v_mfma_f32_16x16x32_bf16 v[72:75], v[16:19], v[40:43], v[72:75]
    buffer_load_dwordx4 v2, s[4:7], s61 offen offset:0 lds
    v_mfma_f32_16x16x32_bf16 v[76:79], v[16:19], v[44:47], v[76:79]
    s_waitcnt lgkmcnt(3)
    v_mfma_f32_16x16x32_bf16 v[80:83], v[20:23], v[32:35], v[80:83]
    ds_read_b128 v[12:15], v4 offset:1024
    v_mfma_f32_16x16x32_bf16 v[84:87], v[20:23], v[36:39], v[84:87]
    v_mfma_f32_16x16x32_bf16 v[88:91], v[20:23], v[40:43], v[88:91]
    buffer_load_dwordx4 v2, s[4:7], s61 offen offset:1024 lds
    v_mfma_f32_16x16x32_bf16 v[92:95], v[20:23], v[44:47], v[92:95]
    s_waitcnt lgkmcnt(3)
    v_mfma_f32_16x16x32_bf16 v[64:67], v[24:27], v[48:51], v[64:67]
    ds_read_b128 v[16:19], v4 offset:2048
    v_mfma_f32_16x16x32_bf16 v[68:71], v[24:27], v[52:55], v[68:71]
    s_add_u32 s71, s67, 32
    v_mov_b32 v6, s98
    v_mov_b32 v7, s99
    v_mfma_f32_16x16x32_bf16 v[72:75], v[24:27], v[56:59], v[72:75]
    buffer_load_dwordx4 v2, s[4:7], s61 offen offset:2048 lds
    v_mfma_f32_16x16x32_bf16 v[76:79], v[24:27], v[60:63], v[76:79]
    s_waitcnt lgkmcnt(3)
    v_mfma_f32_16x16x32_bf16 v[80:83], v[28:31], v[48:51], v[80:83]
    ds_read_b128 v[20:23], v4 offset:3072
    v_mfma_f32_16x16x32_bf16 v[84:87], v[28:31], v[52:55], v[84:87]
    v_mfma_f32_16x16x32_bf16 v[88:91], v[28:31], v[56:59], v[88:91]
    s_lshl_b32 s71, s71, 2
    s_add_u32 s71, s71, 0x8000000
    s_mov_b64 exec, 1
    buffer_store_dwordx2 v[6:7], off, s[4:7], s71 sc1
    s_mov_b64 exec, -1
    v_mfma_f32_16x16x32_bf16 v[92:95], v[28:31], v[60:63], v[92:95]
    s_waitcnt lgkmcnt(3)
    v_mfma_f32_16x16x32_bf16 v[96:99], v[8:11], a[0:3], 0
    ds_read_b128 v[24:27], v4 offset:4096
    v_mfma_f32_16x16x32_bf16 v[100:103], v[8:11], a[4:7], 0
    v_mfma_f32_16x16x32_bf16 v[104:107], v[8:11], a[8:11], 0
    buffer_load_dwordx4 v2, s[4:7], s61 offen offset:3072 lds
    v_mfma_f32_16x16x32_bf16 v[108:111], v[8:11], a[12:15], 0
    s_waitcnt lgkmcnt(3)
    s_add_u32 m0, s49, 77824
    s_add_u32 s61, s48, 372736
    v_mfma_f32_16x16x32_bf16 v[112:115], v[12:15], a[0:3], 0
    ds_read_b128 v[28:31], v4 offset:5120
    v_mfma_f32_16x16x32_bf16 v[116:119], v[12:15], a[4:7], 0
    v_fmac_f32 v64, v144, v128
    v_fmac_f32 v65, v145, v128
    v_mfma_f32_16x16x32_bf16 v[120:123], v[12:15], a[8:11], 0
    buffer_load_dwordx4 v2, s[4:7], s61 offen offset:0 lds
    v_mfma_f32_16x16x32_bf16 v[124:127], v[12:15], a[12:15], 0
    s_waitcnt lgkmcnt(3)
    v_fmac_f32 v66, v146, v128
    v_fmac_f32 v67, v147, v128
    v_mfma_f32_16x16x32_bf16 v[96:99], v[16:19], a[16:19], v[96:99]
    ds_read_b128 v[8:11], v4 offset:6144
    v_fmac_f32 v80, v148, v128
    v_mfma_f32_16x16x32_bf16 v[100:103], v[16:19], a[20:23], v[100:103]
    v_fmac_f32 v81, v149, v128
    v_fmac_f32 v82, v150, v128
    v_mfma_f32_16x16x32_bf16 v[104:107], v[16:19], a[24:27], v[104:107]
    buffer_load_dwordx4 v2, s[4:7], s61 offen offset:1024 lds
    v_mfma_f32_16x16x32_bf16 v[108:111], v[16:19], a[28:31], v[108:111]
    s_waitcnt lgkmcnt(3)
    v_fmac_f32 v83, v151, v128
    v_mul_f32 v64, v64, v132
    v_mfma_f32_16x16x32_bf16 v[112:115], v[20:23], a[16:19], v[112:115]
    ds_read_b128 v[12:15], v4 offset:7168
    v_mul_f32 v65, v65, v132
    v_mfma_f32_16x16x32_bf16 v[116:119], v[20:23], a[20:23], v[116:119]
    v_mul_f32 v66, v66, v132
    v_mul_f32 v67, v67, v132
    v_mfma_f32_16x16x32_bf16 v[120:123], v[20:23], a[24:27], v[120:123]
    buffer_load_dwordx4 v2, s[4:7], s61 offen offset:2048 lds
    v_mfma_f32_16x16x32_bf16 v[124:127], v[20:23], a[28:31], v[124:127]
    s_waitcnt lgkmcnt(3)
    v_mul_f32 v64, v64, v80
    v_mul_f32 v65, v65, v81
    v_mfma_f32_16x16x32_bf16 v[96:99], v[24:27], a[32:35], v[96:99]
    ds_read_b128 v[16:19], v4 offset:8192
    v_mul_f32 v66, v66, v82
    v_mfma_f32_16x16x32_bf16 v[100:103], v[24:27], a[36:39], v[100:103]
    v_mul_f32 v67, v67, v83
    v_cvt_pk_bf16_f32 v224, v64, v65
    v_mfma_f32_16x16x32_bf16 v[104:107], v[24:27], a[40:43], v[104:107]
    buffer_load_dwordx4 v2, s[4:7], s61 offen offset:3072 lds
    v_mfma_f32_16x16x32_bf16 v[108:111], v[24:27], a[44:47], v[108:111]
    s_waitcnt lgkmcnt(3)
    s_add_u32 m0, s49, 81920
    s_add_u32 s61, s48, 376832
    v_mfma_f32_16x16x32_bf16 v[112:115], v[28:31], a[32:35], v[112:115]
    ds_read_b128 v[20:23], v4 offset:9216
    v_cvt_pk_bf16_f32 v225, v66, v67
    v_mfma_f32_16x16x32_bf16 v[116:119], v[28:31], a[36:39], v[116:119]
    v_fmac_f32 v68, v144, v129
    v_fmac_f32 v69, v145, v129
    v_mfma_f32_16x16x32_bf16 v[120:123], v[28:31], a[40:43], v[120:123]
    buffer_load_dwordx4 v2, s[4:7], s61 offen offset:0 lds
    v_mfma_f32_16x16x32_bf16 v[124:127], v[28:31], a[44:47], v[124:127]
    s_waitcnt lgkmcnt(3)
    v_fmac_f32 v70, v146, v129
    v_fmac_f32 v71, v147, v129
    v_mfma_f32_16x16x32_bf16 v[96:99], v[8:11], a[48:51], v[96:99]
    ds_read_b128 v[24:27], v4 offset:10240
    v_fmac_f32 v84, v148, v129
    v_mfma_f32_16x16x32_bf16 v[100:103], v[8:11], a[52:55], v[100:103]
    v_fmac_f32 v85, v149, v129
    v_fmac_f32 v86, v150, v129
    v_mfma_f32_16x16x32_bf16 v[104:107], v[8:11], a[56:59], v[104:107]
    buffer_load_dwordx2 v[246:247], v3, s[4:7], s60 offen offset:512 sc1
    v_mfma_f32_16x16x32_bf16 v[108:111], v[8:11], a[60:63], v[108:111]
    s_waitcnt lgkmcnt(3)
    v_fmac_f32 v87, v151, v129
    v_mul_f32 v68, v68, v133
    v_mfma_f32_16x16x32_bf16 v[112:115], v[12:15], a[48:51], v[112:115]
    ds_read_b128 v[28:31], v4 offset:11264
    v_mul_f32 v69, v69, v133
    v_mfma_f32_16x16x32_bf16 v[116:119], v[12:15], a[52:55], v[116:119]
    v_mul_f32 v70, v70, v133
    v_mul_f32 v71, v71, v133
    v_mfma_f32_16x16x32_bf16 v[120:123], v[12:15], a[56:59], v[120:123]
    buffer_load_dwordx2 v[250:251], v3, s[4:7], s60 offen offset:1024 sc1
    v_mfma_f32_16x16x32_bf16 v[124:127], v[12:15], a[60:63], v[124:127]
    s_waitcnt lgkmcnt(3)
    v_mul_f32 v68, v68, v84
    v_mul_f32 v69, v69, v85
    v_mfma_f32_16x16x32_bf16 v[96:99], v[16:19], a[64:67], v[96:99]
    ds_read_b128 v[8:11], v4 offset:12288
    v_mul_f32 v70, v70, v86
    v_mfma_f32_16x16x32_bf16 v[100:103], v[16:19], a[68:71], v[100:103]
    v_mul_f32 v71, v71, v87
    v_cvt_pk_bf16_f32 v228, v68, v69
    v_mfma_f32_16x16x32_bf16 v[104:107], v[16:19], a[72:75], v[104:107]
    buffer_load_dwordx2 v[254:255], v3, s[4:7], s60 offen offset:1536 sc1
    v_mfma_f32_16x16x32_bf16 v[108:111], v[16:19], a[76:79], v[108:111]
    s_waitcnt lgkmcnt(3)
    s_add_u32 s60, s57, s65
    v_cvt_pk_bf16_f32 v229, v70, v71
    v_mfma_f32_16x16x32_bf16 v[112:115], v[20:23], a[64:67], v[112:115]
    ds_read_b128 v[12:15], v4 offset:13312
    v_fmac_f32 v72, v144, v130
    v_mfma_f32_16x16x32_bf16 v[116:119], v[20:23], a[68:71], v[116:119]
    v_fmac_f32 v73, v145, v130
    v_fmac_f32 v74, v146, v130
    v_mfma_f32_16x16x32_bf16 v[120:123], v[20:23], a[72:75], v[120:123]
    buffer_load_dwordx2 a[0:1], v3, s[4:7], s60 offen offset:0 sc1
    v_mfma_f32_16x16x32_bf16 v[124:127], v[20:23], a[76:79], v[124:127]
    s_waitcnt lgkmcnt(3)
    v_fmac_f32 v75, v147, v130
    v_fmac_f32 v88, v148, v130
    v_mfma_f32_16x16x32_bf16 v[96:99], v[24:27], a[80:83], v[96:99]
    ds_read_b128 v[16:19], v4 offset:14336
    v_fmac_f32 v89, v149, v130
    v_mfma_f32_16x16x32_bf16 v[100:103], v[24:27], a[84:87], v[100:103]
    v_fmac_f32 v90, v150, v130
    v_fmac_f32 v91, v151, v130
    v_mfma_f32_16x16x32_bf16 v[104:107], v[24:27], a[88:91], v[104:107]
    buffer_load_dwordx2 a[4:5], v3, s[4:7], s60 offen offset:512 sc1
    v_mfma_f32_16x16x32_bf16 v[108:111], v[24:27], a[92:95], v[108:111]
    s_waitcnt lgkmcnt(3)
    v_mul_f32 v72, v72, v134
    v_mul_f32 v73, v73, v134
    v_mfma_f32_16x16x32_bf16 v[112:115], v[28:31], a[80:83], v[112:115]
    ds_read_b128 v[20:23], v4 offset:15360
    v_mul_f32 v74, v74, v134
    v_mfma_f32_16x16x32_bf16 v[116:119], v[28:31], a[84:87], v[116:119]
    v_mul_f32 v75, v75, v134
    v_mul_f32 v72, v72, v88
    v_mfma_f32_16x16x32_bf16 v[120:123], v[28:31], a[88:91], v[120:123]
    buffer_load_dwordx2 a[8:9], v3, s[4:7], s60 offen offset:1024 sc1
    v_mfma_f32_16x16x32_bf16 v[124:127], v[28:31], a[92:95], v[124:127]
    s_waitcnt lgkmcnt(3)
    v_mul_f32 v73, v73, v89
    v_mul_f32 v74, v74, v90
    v_mfma_f32_16x16x32_bf16 v[96:99], v[8:11], a[96:99], v[96:99]
    ds_read_b128 v[24:27], v4 offset:16384
    v_mul_f32 v75, v75, v91
    v_mfma_f32_16x16x32_bf16 v[100:103], v[8:11], a[100:103], v[100:103]
    v_cvt_pk_bf16_f32 v232, v72, v73
    v_cvt_pk_bf16_f32 v233, v74, v75
    v_mfma_f32_16x16x32_bf16 v[104:107], v[8:11], a[104:107], v[104:107]
    buffer_load_dwordx2 a[12:13], v3, s[4:7], s60 offen offset:1536 sc1
    v_mfma_f32_16x16x32_bf16 v[108:111], v[8:11], a[108:111], v[108:111]
    s_waitcnt lgkmcnt(3)
    s_add_u32 s60, s58, s65
    v_fmac_f32 v76, v144, v131
    v_mfma_f32_16x16x32_bf16 v[112:115], v[12:15], a[96:99], v[112:115]
    ds_read_b128 v[28:31], v4 offset:17408
    v_fmac_f32 v77, v145, v131
    v_mfma_f32_16x16x32_bf16 v[116:119], v[12:15], a[100:103], v[116:119]
    v_fmac_f32 v78, v146, v131
    v_fmac_f32 v79, v147, v131
    v_mfma_f32_16x16x32_bf16 v[120:123], v[12:15], a[104:107], v[120:123]
    buffer_load_dwordx2 a[2:3], v3, s[4:7], s60 offen offset:0 sc1
    v_mfma_f32_16x16x32_bf16 v[124:127], v[12:15], a[108:111], v[124:127]
    s_waitcnt lgkmcnt(3)
    v_fmac_f32 v92, v148, v131
    v_fmac_f32 v93, v149, v131
    v_mfma_f32_16x16x32_bf16 v[96:99], v[16:19], a[112:115], v[96:99]
    ds_read_b128 v[8:11], v4 offset:18432
    v_fmac_f32 v94, v150, v131
    v_mfma_f32_16x16x32_bf16 v[100:103], v[16:19], a[116:119], v[100:103]
    v_fmac_f32 v95, v151, v131
    v_mul_f32 v76, v76, v135
    v_mfma_f32_16x16x32_bf16 v[104:107], v[16:19], a[120:123], v[104:107]
    buffer_load_dwordx2 a[6:7], v3, s[4:7], s60 offen offset:512 sc1
    v_mfma_f32_16x16x32_bf16 v[108:111], v[16:19], a[124:127], v[108:111]
    s_waitcnt lgkmcnt(3)
    v_mul_f32 v77, v77, v135
    v_mul_f32 v78, v78, v135
    v_mfma_f32_16x16x32_bf16 v[112:115], v[20:23], a[112:115], v[112:115]
    ds_read_b128 v[12:15], v4 offset:19456
    v_mul_f32 v79, v79, v135
    v_mfma_f32_16x16x32_bf16 v[116:119], v[20:23], a[116:119], v[116:119]
    v_mul_f32 v76, v76, v92
    v_mul_f32 v77, v77, v93
    v_mfma_f32_16x16x32_bf16 v[120:123], v[20:23], a[120:123], v[120:123]
    buffer_load_dwordx2 a[10:11], v3, s[4:7], s60 offen offset:1024 sc1
    v_mfma_f32_16x16x32_bf16 v[124:127], v[20:23], a[124:127], v[124:127]
    s_waitcnt lgkmcnt(3)
    v_mul_f32 v78, v78, v94
    v_mul_f32 v79, v79, v95
    v_mfma_f32_16x16x32_bf16 v[96:99], v[24:27], a[128:131], v[96:99]
    ds_read_b128 v[16:19], v4 offset:20480
    v_cvt_pk_bf16_f32 v236, v76, v77
    v_mfma_f32_16x16x32_bf16 v[100:103], v[24:27], a[132:135], v[100:103]
    v_cvt_pk_bf16_f32 v237, v78, v79
    v_mfma_f32_16x16x32_bf16 v[104:107], v[24:27], a[136:139], v[104:107]
    buffer_load_dwordx2 a[14:15], v3, s[4:7], s60 offen offset:1536 sc1
    v_mfma_f32_16x16x32_bf16 v[108:111], v[24:27], a[140:143], v[108:111]
    s_waitcnt lgkmcnt(3)
    s_add_u32 s60, s56, 0
    v_mfma_f32_16x16x32_bf16 v[112:115], v[28:31], a[128:131], v[112:115]
    ds_read_b128 v[20:23], v4 offset:21504
    v_mfma_f32_16x16x32_bf16 v[116:119], v[28:31], a[132:135], v[116:119]
    v_mfma_f32_16x16x32_bf16 v[120:123], v[28:31], a[136:139], v[120:123]
    buffer_load_dwordx4 a[16:19], v2, s[4:7], s60 offen offset:0 sc1
    v_mfma_f32_16x16x32_bf16 v[124:127], v[28:31], a[140:143], v[124:127]
    s_waitcnt lgkmcnt(3)
    v_mfma_f32_16x16x32_bf16 v[96:99], v[8:11], a[144:147], v[96:99]
    ds_read_b128 v[24:27], v4 offset:22528
    v_mfma_f32_16x16x32_bf16 v[100:103], v[8:11], a[148:151], v[100:103]
    v_mfma_f32_16x16x32_bf16 v[104:107], v[8:11], a[152:155], v[104:107]
    buffer_load_dwordx4 a[20:23], v2, s[4:7], s60 offen offset:1024 sc1
    v_mfma_f32_16x16x32_bf16 v[108:111], v[8:11], a[156:159], v[108:111]
    s_waitcnt lgkmcnt(3)
    v_mfma_f32_16x16x32_bf16 v[112:115], v[12:15], a[144:147], v[112:115]
    ds_read_b128 v[28:31], v4 offset:23552
    v_mfma_f32_16x16x32_bf16 v[116:119], v[12:15], a[148:151], v[116:119]
    v_mfma_f32_16x16x32_bf16 v[120:123], v[12:15], a[152:155], v[120:123]
    buffer_load_dwordx4 a[24:27], v2, s[4:7], s60 offen offset:2048 sc1
    v_mfma_f32_16x16x32_bf16 v[124:127], v[12:15], a[156:159], v[124:127]
    s_waitcnt lgkmcnt(3)
    v_mfma_f32_16x16x32_bf16 v[96:99], v[16:19], a[160:163], v[96:99]
    ds_read_b128 v[8:11], v4 offset:24576
    v_mfma_f32_16x16x32_bf16 v[100:103], v[16:19], a[164:167], v[100:103]
    v_mfma_f32_16x16x32_bf16 v[104:107], v[16:19], a[168:171], v[104:107]
    buffer_load_dwordx4 a[28:31], v2, s[4:7], s60 offen offset:3072 sc1
    v_mfma_f32_16x16x32_bf16 v[108:111], v[16:19], a[172:175], v[108:111]
    s_waitcnt lgkmcnt(3)
    s_add_u32 s60, s57, 0
    v_mfma_f32_16x16x32_bf16 v[112:115], v[20:23], a[160:163], v[112:115]
    ds_read_b128 v[12:15], v4 offset:25600
    v_mfma_f32_16x16x32_bf16 v[116:119], v[20:23], a[164:167], v[116:119]
    v_mfma_f32_16x16x32_bf16 v[120:123], v[20:23], a[168:171], v[120:123]
    buffer_load_dwordx4 a[32:35], v2, s[4:7], s60 offen offset:0 sc1
    v_mfma_f32_16x16x32_bf16 v[124:127], v[20:23], a[172:175], v[124:127]
    s_waitcnt lgkmcnt(3)
    v_mfma_f32_16x16x32_bf16 v[96:99], v[24:27], a[176:179], v[96:99]
    ds_read_b128 v[16:19], v4 offset:26624
    v_mfma_f32_16x16x32_bf16 v[100:103], v[24:27], a[180:183], v[100:103]
    v_mfma_f32_16x16x32_bf16 v[104:107], v[24:27], a[184:187], v[104:107]
    buffer_load_dwordx4 a[36:39], v2, s[4:7], s60 offen offset:1024 sc1
    v_mfma_f32_16x16x32_bf16 v[108:111], v[24:27], a[188:191], v[108:111]
    s_waitcnt lgkmcnt(3)
    v_mfma_f32_16x16x32_bf16 v[112:115], v[28:31], a[176:179], v[112:115]
    ds_read_b128 v[20:23], v4 offset:27648
    v_mfma_f32_16x16x32_bf16 v[116:119], v[28:31], a[180:183], v[116:119]
    v_mfma_f32_16x16x32_bf16 v[120:123], v[28:31], a[184:187], v[120:123]
    buffer_load_dwordx4 a[40:43], v2, s[4:7], s60 offen offset:2048 sc1
    v_mfma_f32_16x16x32_bf16 v[124:127], v[28:31], a[188:191], v[124:127]
    s_waitcnt lgkmcnt(3)
    v_mfma_f32_16x16x32_bf16 v[96:99], v[8:11], a[192:195], v[96:99]
    ds_read_b128 v[24:27], v4 offset:28672
    v_mfma_f32_16x16x32_bf16 v[100:103], v[8:11], a[196:199], v[100:103]
    v_mfma_f32_16x16x32_bf16 v[104:107], v[8:11], a[200:203], v[104:107]
    buffer_load_dwordx4 a[44:47], v2, s[4:7], s60 offen offset:3072 sc1
    v_mfma_f32_16x16x32_bf16 v[108:111], v[8:11], a[204:207], v[108:111]
    s_waitcnt lgkmcnt(3)
    s_add_u32 s60, s58, 0
    v_mfma_f32_16x16x32_bf16 v[112:115], v[12:15], a[192:195], v[112:115]
    ds_read_b128 v[28:31], v4 offset:29696
    v_mfma_f32_16x16x32_bf16 v[116:119], v[12:15], a[196:199], v[116:119]
    v_mfma_f32_16x16x32_bf16 v[120:123], v[12:15], a[200:203], v[120:123]
    buffer_load_dwordx4 a[48:51], v2, s[4:7], s60 offen offset:0 sc1
    v_mfma_f32_16x16x32_bf16 v[124:127], v[12:15], a[204:207], v[124:127]
    s_waitcnt lgkmcnt(3)
    v_mfma_f32_16x16x32_bf16 v[96:99], v[16:19], a[208:211], v[96:99]
    ds_read_b128 v[8:11], v4 offset:30720
    v_mfma_f32_16x16x32_bf16 v[100:103], v[16:19], a[212:215], v[100:103]
    v_mfma_f32_16x16x32_bf16 v[104:107], v[16:19], a[216:219], v[104:107]
    buffer_load_dwordx4 a[52:55], v2, s[4:7], s60 offen offset:1024 sc1
    v_mfma_f32_16x16x32_bf16 v[108:111], v[16:19], a[220:223], v[108:111]
    s_waitcnt lgkmcnt(3)
    v_mfma_f32_16x16x32_bf16 v[112:115], v[20:23], a[208:211], v[112:115]
    ds_read_b128 v[12:15], v4 offset:31744
    v_mfma_f32_16x16x32_bf16 v[116:119], v[20:23], a[212:215], v[116:119]
    v_mfma_f32_16x16x32_bf16 v[120:123], v[20:23], a[216:219], v[120:123]
    buffer_load_dwordx4 a[56:59], v2, s[4:7], s60 offen offset:2048 sc1
    v_mfma_f32_16x16x32_bf16 v[124:127], v[20:23], a[220:223], v[124:127]
    s_waitcnt lgkmcnt(3)
    v_mfma_f32_16x16x32_bf16 v[96:99], v[24:27], a[224:227], v[96:99]
    ds_read_b128 v[16:19], v4 offset:32768
    v_mfma_f32_16x16x32_bf16 v[100:103], v[24:27], a[228:231], v[100:103]
    v_mfma_f32_16x16x32_bf16 v[104:107], v[24:27], a[232:235], v[104:107]
    buffer_load_dwordx4 a[60:63], v2, s[4:7], s60 offen offset:3072 sc1
    v_mfma_f32_16x16x32_bf16 v[108:111], v[24:27], a[236:239], v[108:111]
    s_waitcnt lgkmcnt(3)
    s_add_u32 s60, s56, 16384
    v_mfma_f32_16x16x32_bf16 v[112:115], v[28:31], a[224:227], v[112:115]
    ds_read_b128 v[20:23], v4 offset:33792
    v_mfma_f32_16x16x32_bf16 v[116:119], v[28:31], a[228:231], v[116:119]
    v_mfma_f32_16x16x32_bf16 v[120:123], v[28:31], a[232:235], v[120:123]
    buffer_load_dwordx4 a[64:67], v2, s[4:7], s60 offen offset:0 sc1
    v_mfma_f32_16x16x32_bf16 v[124:127], v[28:31], a[236:239], v[124:127]
    s_waitcnt lgkmcnt(3)
    v_mfma_f32_16x16x32_bf16 v[96:99], v[8:11], a[240:243], v[96:99]
    ds_read_b128 v[24:27], v4 offset:34816
    v_mfma_f32_16x16x32_bf16 v[100:103], v[8:11], a[244:247], v[100:103]
    v_mfma_f32_16x16x32_bf16 v[104:107], v[8:11], a[248:251], v[104:107]
    buffer_load_dwordx4 a[68:71], v2, s[4:7], s60 offen offset:1024 sc1
    v_mfma_f32_16x16x32_bf16 v[108:111], v[8:11], a[252:255], v[108:111]
    s_waitcnt lgkmcnt(3)
    v_mfma_f32_16x16x32_bf16 v[112:115], v[12:15], a[240:243], v[112:115]
    ds_read_b128 v[28:31], v4 offset:35840
    v_mfma_f32_16x16x32_bf16 v[116:119], v[12:15], a[244:247], v[116:119]
    v_mfma_f32_16x16x32_bf16 v[120:123], v[12:15], a[248:251], v[120:123]
    buffer_load_dwordx4 a[72:75], v2, s[4:7], s60 offen offset:2048 sc1
    v_mfma_f32_16x16x32_bf16 v[124:127], v[12:15], a[252:255], v[124:127]
    s_waitcnt lgkmcnt(3)
    v_mfma_f32_16x16x32_bf16 v[96:99], v[16:19], v[32:35], v[96:99]
    s_barrier
    v_add_u32 v4, 0x9000, v4
    v_mfma_f32_16x16x32_bf16 v[100:103], v[16:19], v[36:39], v[100:103]
    s_add_u32 m0, s49, 110592
    s_add_u32 s61, s48, 405504
    ds_read_b128 v[8:11], v4 offset:0
    v_mfma_f32_16x16x32_bf16 v[104:107], v[16:19], v[40:43], v[104:107]
    buffer_load_dwordx4 a[76:79], v2, s[4:7], s60 offen offset:3072 sc1
    v_mfma_f32_16x16x32_bf16 v[108:111], v[16:19], v[44:47], v[108:111]
    s_waitcnt lgkmcnt(3)
    s_add_u32 s60, s57, 16384
    v_mfma_f32_16x16x32_bf16 v[112:115], v[20:23], v[32:35], v[112:115]
    ds_read_b128 v[12:15], v4 offset:1024
    v_mfma_f32_16x16x32_bf16 v[116:119], v[20:23], v[36:39], v[116:119]
    v_mfma_f32_16x16x32_bf16 v[120:123], v[20:23], v[40:43], v[120:123]
    buffer_load_dwordx4 a[80:83], v2, s[4:7], s60 offen offset:0 sc1
    v_mfma_f32_16x16x32_bf16 v[124:127], v[20:23], v[44:47], v[124:127]
    s_waitcnt lgkmcnt(3)
    v_mfma_f32_16x16x32_bf16 v[96:99], v[24:27], v[48:51], v[96:99]
    ds_read_b128 v[16:19], v4 offset:2048
    v_mfma_f32_16x16x32_bf16 v[100:103], v[24:27], v[52:55], v[100:103]
    v_mfma_f32_16x16x32_bf16 v[104:107], v[24:27], v[56:59], v[104:107]
    buffer_load_dwordx4 a[84:87], v2, s[4:7], s60 offen offset:1024 sc1
    v_mfma_f32_16x16x32_bf16 v[108:111], v[24:27], v[60:63], v[108:111]
    s_waitcnt lgkmcnt(3)
    v_mfma_f32_16x16x32_bf16 v[112:115], v[28:31], v[48:51], v[112:115]
    ds_read_b128 v[20:23], v4 offset:3072
    v_mfma_f32_16x16x32_bf16 v[116:119], v[28:31], v[52:55], v[116:119]
    v_mfma_f32_16x16x32_bf16 v[120:123], v[28:31], v[56:59], v[120:123]
    buffer_load_dwordx4 a[88:91], v2, s[4:7], s60 offen offset:2048 sc1
    v_mfma_f32_16x16x32_bf16 v[124:127], v[28:31], v[60:63], v[124:127]
    s_waitcnt lgkmcnt(3)
    v_mfma_f32_16x16x32_bf16 v[32:35], v[8:11], v[176:179], 0
    ds_read_b128 v[24:27], v4 offset:4096
    v_mfma_f32_16x16x32_bf16 v[40:43], v[8:11], v[180:183], 0
    v_mfma_f32_16x16x32_bf16 v[48:51], v[8:11], v[184:187], 0
    buffer_load_dwordx4 a[92:95], v2, s[4:7], s60 offen offset:3072 sc1
    v_mfma_f32_16x16x32_bf16 v[56:59], v[8:11], v[188:191], 0
    s_waitcnt lgkmcnt(3)
    s_add_u32 s60, s58, 16384
    v_mfma_f32_16x16x32_bf16 v[36:39], v[12:15], v[176:179], 0
    ds_read_b128 v[28:31], v4 offset:5120
    v_mfma_f32_16x16x32_bf16 v[44:47], v[12:15], v[180:183], 0
    v_fmac_f32 v96, v136, v128
    v_fmac_f32 v97, v137, v128
    v_mfma_f32_16x16x32_bf16 v[52:55], v[12:15], v[184:187], 0
    v_fmac_f32 v98, v138, v128
    v_fmac_f32 v99, v139, v128
    v_mfma_f32_16x16x32_bf16 v[60:63], v[12:15], v[188:191], 0
    s_waitcnt lgkmcnt(3)
    v_fmac_f32 v112, v140, v128
    v_fmac_f32 v113, v141, v128
    v_mfma_f32_16x16x32_bf16 v[64:67], v[16:19], v[176:179], 0
    ds_read_b128 v[8:11], v4 offset:6144
    v_fmac_f32 v114, v142, v128
    v_mfma_f32_16x16x32_bf16 v[72:75], v[16:19], v[180:183], 0
    v_fmac_f32 v115, v143, v128
    v_mul_f32 v96, v96, v132
    v_mfma_f32_16x16x32_bf16 v[80:83], v[16:19], v[184:187], 0
    v_mul_f32 v97, v97, v132
    v_mul_f32 v98, v98, v132
    v_mfma_f32_16x16x32_bf16 v[88:91], v[16:19], v[188:191], 0
    s_waitcnt lgkmcnt(3)
    v_mul_f32 v99, v99, v132
    v_mul_f32 v96, v96, v112
    v_mfma_f32_16x16x32_bf16 v[68:71], v[20:23], v[176:179], 0
    ds_read_b128 v[12:15], v4 offset:7168
    v_mul_f32 v97, v97, v113
    v_mfma_f32_16x16x32_bf16 v[76:79], v[20:23], v[180:183], 0
    v_mul_f32 v98, v98, v114
    v_mul_f32 v99, v99, v115
    v_mfma_f32_16x16x32_bf16 v[84:87], v[20:23], v[184:187], 0
    v_cvt_pk_bf16_f32 v226, v96, v97
    v_cvt_pk_bf16_f32 v227, v98, v99
    v_mfma_f32_16x16x32_bf16 v[92:95], v[20:23], v[188:191], 0
    s_waitcnt lgkmcnt(3)
    s_add_u32 s66, s51, 49152
    v_mfma_f32_16x16x32_bf16 v[160:163], v[24:27], v[176:179], 0
    ds_read_b128 v[16:19], v4 offset:8192
    v_mfma_f32_16x16x32_bf16 v[164:167], v[24:27], v[180:183], 0
    buffer_store_dwordx4 v[224:227], v2, s[4:7], s66 offen offset:0 sc1
    v_mfma_f32_16x16x32_bf16 v[168:171], v[24:27], v[184:187], 0
    v_fmac_f32 v100, v136, v129
    v_fmac_f32 v101, v137, v129
    v_mfma_f32_16x16x32_bf16 v[172:175], v[24:27], v[188:191], 0
    s_waitcnt lgkmcnt(3)
    v_fmac_f32 v102, v138, v129
    v_fmac_f32 v103, v139, v129
    v_mfma_f32_16x16x32_bf16 v[32:35], v[28:31], v[192:195], v[32:35]
    ds_read_b128 v[20:23], v4 offset:9216
    v_fmac_f32 v116, v140, v129
    v_mfma_f32_16x16x32_bf16 v[40:43], v[28:31], v[196:199], v[40:43]
    v_fmac_f32 v117, v141, v129
    v_fmac_f32 v118, v142, v129
    v_mfma_f32_16x16x32_bf16 v[48:51], v[28:31], v[200:203], v[48:51]
    v_fmac_f32 v119, v143, v129
    v_mul_f32 v100, v100, v133
    v_mfma_f32_16x16x32_bf16 v[56:59], v[28:31], v[204:207], v[56:59]
    s_waitcnt lgkmcnt(3)
    v_mul_f32 v101, v101, v133
    v_mul_f32 v102, v102, v133
    v_mfma_f32_16x16x32_bf16 v[36:39], v[8:11], v[192:195], v[36:39]
    ds_read_b128 v[24:27], v4 offset:10240
    v_mul_f32 v103, v103, v133
    v_mfma_f32_16x16x32_bf16 v[44:47], v[8:11], v[196:199], v[44:47]
    v_mul_f32 v100, v100, v116
    v_mul_f32 v101, v101, v117
    v_mfma_f32_16x16x32_bf16 v[52:55], v[8:11], v[200:203], v[52:55]
    v_mul_f32 v102, v102, v118
    v_mul_f32 v103, v103, v119
    v_mfma_f32_16x16x32_bf16 v[60:63], v[8:11], v[204:207], v[60:63]
    s_waitcnt lgkmcnt(3)
    v_cvt_pk_bf16_f32 v230, v100, v101
    v_cvt_pk_bf16_f32 v231, v102, v103
    v_mfma_f32_16x16x32_bf16 v[64:67], v[12:15], v[192:195], v[64:67]
    ds_read_b128 v[28:31], v4 offset:11264
    v_mfma_f32_16x16x32_bf16 v[72:75], v[12:15], v[196:199], v[72:75]
    buffer_store_dwordx4 v[228:231], v2, s[4:7], s66 offen offset:1024 sc1
    v_mfma_f32_16x16x32_bf16 v[80:83], v[12:15], v[200:203], v[80:83]
    v_fmac_f32 v104, v136, v130
    v_fmac_f32 v105, v137, v130
    v_mfma_f32_16x16x32_bf16 v[88:91], v[12:15], v[204:207], v[88:91]
    s_waitcnt lgkmcnt(3)
    v_fmac_f32 v106, v138, v130
    v_fmac_f32 v107, v139, v130
    v_mfma_f32_16x16x32_bf16 v[68:71], v[16:19], v[192:195], v[68:71]
    ds_read_b128 v[8:11], v4 offset:12288
    v_fmac_f32 v120, v140, v130
    v_mfma_f32_16x16x32_bf16 v[76:79], v[16:19], v[196:199], v[76:79]
    v_fmac_f32 v121, v141, v130
    v_fmac_f32 v122, v142, v130
    v_mfma_f32_16x16x32_bf16 v[84:87], v[16:19], v[200:203], v[84:87]
    v_fmac_f32 v123, v143, v130
    v_mul_f32 v104, v104, v134
    v_mfma_f32_16x16x32_bf16 v[92:95], v[16:19], v[204:207], v[92:95]
    s_waitcnt lgkmcnt(3)
    v_mul_f32 v105, v105, v134
    v_mul_f32 v106, v106, v134
    v_mfma_f32_16x16x32_bf16 v[160:163], v[20:23], v[192:195], v[160:163]
    ds_read_b128 v[12:15], v4 offset:13312
    v_mul_f32 v107, v107, v134
    v_mfma_f32_16x16x32_bf16 v[164:167], v[20:23], v[196:199], v[164:167]
    v_mul_f32 v104, v104, v120
    v_mul_f32 v105, v105, v121
    v_mfma_f32_16x16x32_bf16 v[168:171], v[20:23], v[200:203], v[168:171]
    v_mul_f32 v106, v106, v122
    v_mul_f32 v107, v107, v123
    v_mfma_f32_16x16x32_bf16 v[172:175], v[20:23], v[204:207], v[172:175]
    s_waitcnt lgkmcnt(3)
    v_cvt_pk_bf16_f32 v234, v104, v105
    v_cvt_pk_bf16_f32 v235, v106, v107
    v_mfma_f32_16x16x32_bf16 v[32:35], v[24:27], v[208:211], v[32:35]
    ds_read_b128 v[16:19], v4 offset:14336
    v_mfma_f32_16x16x32_bf16 v[40:43], v[24:27], v[212:215], v[40:43]
    buffer_store_dwordx4 v[232:235], v2, s[4:7], s66 offen offset:2048 sc1
    v_mfma_f32_16x16x32_bf16 v[48:51], v[24:27], v[216:219], v[48:51]
    v_fmac_f32 v108, v136, v131
    v_fmac_f32 v109, v137, v131
    v_mfma_f32_16x16x32_bf16 v[56:59], v[24:27], v[220:223], v[56:59]
    s_waitcnt lgkmcnt(3)
    v_fmac_f32 v110, v138, v131
    v_fmac_f32 v111, v139, v131
    v_mfma_f32_16x16x32_bf16 v[36:39], v[28:31], v[208:211], v[36:39]
    ds_read_b128 v[20:23], v4 offset:15360
    v_fmac_f32 v124, v140, v131
    v_mfma_f32_16x16x32_bf16 v[44:47], v[28:31], v[212:215], v[44:47]
    v_fmac_f32 v125, v141, v131
    v_fmac_f32 v126, v142, v131
    v_mfma_f32_16x16x32_bf16 v[52:55], v[28:31], v[216:219], v[52:55]
    buffer_load_dwordx4 a[96:99], v2, s[4:7], s60 offen offset:0 sc1
    buffer_load_dwordx4 a[100:103], v2, s[4:7], s60 offen offset:1024 sc1
    buffer_load_dwordx4 a[104:107], v2, s[4:7], s60 offen offset:2048 sc1
    buffer_load_dwordx4 a[108:111], v2, s[4:7], s60 offen offset:3072 sc1
    s_add_u32 s55, s52, 32
    s_lshl_b32 s55, s55, 2
    s_add_u32 s55, s55, 0x8000000
    buffer_load_dwordx2 v[6:7], v0, s[4:7], s55 offen sc1
    v_mfma_f32_16x16x32_bf16 v[60:63], v[28:31], v[220:223], v[60:63]
    s_waitcnt lgkmcnt(3)
    v_fmac_f32 v127, v143, v131
    v_mul_f32 v108, v108, v135
    v_mfma_f32_16x16x32_bf16 v[64:67], v[8:11], v[208:211], v[64:67]
    ds_read_b128 v[24:27], v4 offset:16384
    v_mul_f32 v109, v109, v135
    v_mfma_f32_16x16x32_bf16 v[72:75], v[8:11], v[212:215], v[72:75]
    v_mul_f32 v110, v110, v135
    v_mul_f32 v111, v111, v135
    v_mfma_f32_16x16x32_bf16 v[80:83], v[8:11], v[216:219], v[80:83]
    v_mul_f32 v108, v108, v124
    v_mul_f32 v109, v109, v125
    v_mfma_f32_16x16x32_bf16 v[88:91], v[8:11], v[220:223], v[88:91]
    s_waitcnt lgkmcnt(3)
    v_mul_f32 v110, v110, v126
    v_mul_f32 v111, v111, v127
    v_mfma_f32_16x16x32_bf16 v[68:71], v[12:15], v[208:211], v[68:71]
    ds_read_b128 v[28:31], v4 offset:17408
    v_cvt_pk_bf16_f32 v238, v108, v109
    v_mfma_f32_16x16x32_bf16 v[76:79], v[12:15], v[212:215], v[76:79]
    buffer_load_dwordx4 v2, s[4:7], s61 offen offset:0 lds
    v_mfma_f32_16x16x32_bf16 v[84:87], v[12:15], v[216:219], v[84:87]
    v_cvt_pk_bf16_f32 v239, v110, v111
    v_mfma_f32_16x16x32_bf16 v[92:95], v[12:15], v[220:223], v[92:95]
    s_waitcnt lgkmcnt(3)
    v_mfma_f32_16x16x32_bf16 v[160:163], v[16:19], v[208:211], v[160:163]
    ds_read_b128 v[8:11], v4 offset:18432
    v_mfma_f32_16x16x32_bf16 v[164:167], v[16:19], v[212:215], v[164:167]
    buffer_store_dwordx4 v[236:239], v2, s[4:7], s66 offen offset:3072 sc1
    v_mfma_f32_16x16x32_bf16 v[168:171], v[16:19], v[216:219], v[168:171]
    v_mfma_f32_16x16x32_bf16 v[172:175], v[16:19], v[220:223], v[172:175]
    s_waitcnt lgkmcnt(3)
    v_mfma_f32_16x16x32_bf16 v[96:99], v[20:23], v[176:179], 0
    ds_read_b128 v[12:15], v4 offset:19456
    v_mfma_f32_16x16x32_bf16 v[104:107], v[20:23], v[180:183], 0
    buffer_load_dwordx4 v2, s[4:7], s61 offen offset:1024 lds
    v_mfma_f32_16x16x32_bf16 v[112:115], v[20:23], v[184:187], 0
    v_mfma_f32_16x16x32_bf16 v[120:123], v[20:23], v[188:191], 0
    s_waitcnt lgkmcnt(3)
    v_mfma_f32_16x16x32_bf16 v[100:103], v[24:27], v[176:179], 0
    ds_read_b128 v[16:19], v4 offset:20480
    v_mfma_f32_16x16x32_bf16 v[108:111], v[24:27], v[180:183], 0
    buffer_load_dwordx4 v2, s[4:7], s61 offen offset:2048 lds
    v_mfma_f32_16x16x32_bf16 v[116:119], v[24:27], v[184:187], 0
    v_mfma_f32_16x16x32_bf16 v[124:127], v[24:27], v[188:191], 0
    s_waitcnt lgkmcnt(3)
    v_mfma_f32_16x16x32_bf16 v[128:131], v[28:31], v[176:179], 0
    ds_read_b128 v[20:23], v4 offset:21504
    v_mfma_f32_16x16x32_bf16 v[136:139], v[28:31], v[180:183], 0
    buffer_load_dwordx4 v2, s[4:7], s61 offen offset:3072 lds
    v_mfma_f32_16x16x32_bf16 v[144:147], v[28:31], v[184:187], 0
    s_add_u32 m0, s49, 114688
    s_add_u32 s61, s48, 409600
    v_mfma_f32_16x16x32_bf16 v[152:155], v[28:31], v[188:191], 0
    s_waitcnt lgkmcnt(3)
    v_mfma_f32_16x16x32_bf16 v[132:135], v[8:11], v[176:179], 0
    ds_read_b128 v[24:27], v4 offset:22528
    v_mfma_f32_16x16x32_bf16 v[140:143], v[8:11], v[180:183], 0
    buffer_load_dwordx4 v2, s[4:7], s61 offen offset:0 lds
    v_mfma_f32_16x16x32_bf16 v[148:151], v[8:11], v[184:187], 0
    v_mfma_f32_16x16x32_bf16 v[156:159], v[8:11], v[188:191], 0
    s_waitcnt lgkmcnt(3)
    v_mfma_f32_16x16x32_bf16 v[96:99], v[12:15], v[192:195], v[96:99]
    ds_read_b128 v[28:31], v4 offset:23552
    v_mfma_f32_16x16x32_bf16 v[104:107], v[12:15], v[196:199], v[104:107]
    buffer_load_dwordx4 v2, s[4:7], s61 offen offset:1024 lds
    v_mfma_f32_16x16x32_bf16 v[112:115], v[12:15], v[200:203], v[112:115]
    v_mfma_f32_16x16x32_bf16 v[120:123], v[12:15], v[204:207], v[120:123]
    s_waitcnt lgkmcnt(3)
    v_mfma_f32_16x16x32_bf16 v[100:103], v[16:19], v[192:195], v[100:103]
    ds_read_b128 v[8:11], v4 offset:24576
    v_mfma_f32_16x16x32_bf16 v[108:111], v[16:19], v[196:199], v[108:111]
    buffer_load_dwordx4 v2, s[4:7], s61 offen offset:2048 lds
    v_mfma_f32_16x16x32_bf16 v[116:119], v[16:19], v[200:203], v[116:119]
    v_mfma_f32_16x16x32_bf16 v[124:127], v[16:19], v[204:207], v[124:127]
    s_waitcnt lgkmcnt(3)
    v_mfma_f32_16x16x32_bf16 v[128:131], v[20:23], v[192:195], v[128:131]
    ds_read_b128 v[12:15], v4 offset:25600
    v_mfma_f32_16x16x32_bf16 v[136:139], v[20:23], v[196:199], v[136:139]
    buffer_load_dwordx4 v2, s[4:7], s61 offen offset:3072 lds
    v_mfma_f32_16x16x32_bf16 v[144:147], v[20:23], v[200:203], v[144:147]
    s_add_u32 m0, s49, 118784
    s_add_u32 s61, s48, 413696
    v_mfma_f32_16x16x32_bf16 v[152:155], v[20:23], v[204:207], v[152:155]
    s_waitcnt lgkmcnt(3)
    v_mfma_f32_16x16x32_bf16 v[132:135], v[24:27], v[192:195], v[132:135]
    ds_read_b128 v[16:19], v4 offset:26624
    v_mfma_f32_16x16x32_bf16 v[140:143], v[24:27], v[196:199], v[140:143]
    buffer_load_dwordx4 v2, s[4:7], s61 offen offset:0 lds
    v_mfma_f32_16x16x32_bf16 v[148:151], v[24:27], v[200:203], v[148:151]
    v_mfma_f32_16x16x32_bf16 v[156:159], v[24:27], v[204:207], v[156:159]
    s_waitcnt lgkmcnt(3)
    v_mfma_f32_16x16x32_bf16 v[96:99], v[28:31], v[208:211], v[96:99]
    ds_read_b128 v[20:23], v4 offset:27648
    v_mfma_f32_16x16x32_bf16 v[104:107], v[28:31], v[212:215], v[104:107]
    v_mfma_f32_16x16x32_bf16 v[112:115], v[28:31], v[216:219], v[112:115]
    v_mfma_f32_16x16x32_bf16 v[120:123], v[28:31], v[220:223], v[120:123]
    s_waitcnt lgkmcnt(3)
    v_mfma_f32_16x16x32_bf16 v[100:103], v[8:11], v[208:211], v[100:103]
    ds_read_b128 v[24:27], v4 offset:28672
    v_mfma_f32_16x16x32_bf16 v[108:111], v[8:11], v[212:215], v[108:111]
    v_mfma_f32_16x16x32_bf16 v[116:119], v[8:11], v[216:219], v[116:119]
    v_mfma_f32_16x16x32_bf16 v[124:127], v[8:11], v[220:223], v[124:127]
    s_waitcnt lgkmcnt(3)
    v_mfma_f32_16x16x32_bf16 v[128:131], v[12:15], v[208:211], v[128:131]
    s_waitcnt vmcnt(10)
    v_cmp_eq_u64 vcc, s[98:99], v[6:7]
    s_nop 0
    s_cmp_eq_u64 vcc, exec
    s_cbranch_scc0 L_p1_slow_90
L_p1_back_91:
    v_mfma_f32_16x16x32_bf16 v[136:139], v[12:15], v[212:215], v[136:139]
    s_add_u32 s60, s56, 32768
    ds_read_b128 v[28:31], v4 offset:29696
    v_mfma_f32_16x16x32_bf16 v[144:147], v[12:15], v[216:219], v[144:147]
    buffer_load_dwordx4 a[112:115], v2, s[4:7], s60 offen offset:0 sc1
    v_mfma_f32_16x16x32_bf16 v[152:155], v[12:15], v[220:223], v[152:155]
    s_waitcnt lgkmcnt(3)
    v_mfma_f32_16x16x32_bf16 v[132:135], v[16:19], v[208:211], v[132:135]
    ds_read_b128 v[8:11], v4 offset:30720
    v_mfma_f32_16x16x32_bf16 v[140:143], v[16:19], v[212:215], v[140:143]
    v_mfma_f32_16x16x32_bf16 v[148:151], v[16:19], v[216:219], v[148:151]
    buffer_load_dwordx4 a[116:119], v2, s[4:7], s60 offen offset:1024 sc1
    v_mfma_f32_16x16x32_bf16 v[156:159], v[16:19], v[220:223], v[156:159]
    s_waitcnt lgkmcnt(3)
    v_mfma_f32_16x16x32_bf16 v[32:35], v[20:23], v[224:227], v[32:35]
    ds_read_b128 v[12:15], v4 offset:31744
    v_mfma_f32_16x16x32_bf16 v[40:43], v[20:23], v[228:231], v[40:43]
    v_mfma_f32_16x16x32_bf16 v[48:51], v[20:23], v[232:235], v[48:51]
    buffer_load_dwordx4 a[120:123], v2, s[4:7], s60 offen offset:2048 sc1
    v_mfma_f32_16x16x32_bf16 v[56:59], v[20:23], v[236:239], v[56:59]
    s_waitcnt lgkmcnt(3)
    v_mfma_f32_16x16x32_bf16 v[36:39], v[24:27], v[224:227], v[36:39]
    ds_read_b128 v[16:19], v4 offset:32768
    v_mfma_f32_16x16x32_bf16 v[44:47], v[24:27], v[228:231], v[44:47]
    s_add_u32 s71, s67, 64
    v_mov_b32 v6, s98
    v_mov_b32 v7, s99
    v_mfma_f32_16x16x32_bf16 v[52:55], v[24:27], v[232:235], v[52:55]
    buffer_load_dwordx4 a[124:127], v2, s[4:7], s60 offen offset:3072 sc1
    v_mfma_f32_16x16x32_bf16 v[60:63], v[24:27], v[236:239], v[60:63]
    s_waitcnt lgkmcnt(3)
    s_waitcnt vmcnt(12)
    s_add_u32 s60, s57, 32768
    v_mfma_f32_16x16x32_bf16 v[64:67], v[28:31], v[224:227], v[64:67]
    ds_read_b128 v[20:23], v4 offset:33792
    v_mfma_f32_16x16x32_bf16 v[72:75], v[28:31], v[228:231], v[72:75]
    v_mfma_f32_16x16x32_bf16 v[80:83], v[28:31], v[232:235], v[80:83]
    s_lshl_b32 s71, s71, 2
    s_add_u32 s71, s71, 0x8000000
    s_mov_b64 exec, 1
    buffer_store_dwordx2 v[6:7], off, s[4:7], s71 sc1
    s_mov_b64 exec, -1
    v_mfma_f32_16x16x32_bf16 v[88:91], v[28:31], v[236:239], v[88:91]
    s_waitcnt lgkmcnt(3)
    v_mfma_f32_16x16x32_bf16 v[68:71], v[8:11], v[224:227], v[68:71]
    ds_read_b128 v[24:27], v4 offset:34816
    v_mfma_f32_16x16x32_bf16 v[76:79], v[8:11], v[228:231], v[76:79]
    v_mfma_f32_16x16x32_bf16 v[84:87], v[8:11], v[232:235], v[84:87]
    buffer_load_dwordx4 a[128:131], v2, s[4:7], s60 offen offset:0 sc1
    v_mfma_f32_16x16x32_bf16 v[92:95], v[8:11], v[236:239], v[92:95]
    s_waitcnt lgkmcnt(3)
    v_mfma_f32_16x16x32_bf16 v[96:99], v[12:15], v[224:227], v[96:99]
    ds_read_b128 v[28:31], v4 offset:35840
    v_mfma_f32_16x16x32_bf16 v[104:107], v[12:15], v[228:231], v[104:107]
    v_mfma_f32_16x16x32_bf16 v[112:115], v[12:15], v[232:235], v[112:115]
    buffer_load_dwordx4 a[132:135], v2, s[4:7], s60 offen offset:1024 sc1
    v_mfma_f32_16x16x32_bf16 v[120:123], v[12:15], v[236:239], v[120:123]
    s_waitcnt lgkmcnt(3)
    v_mfma_f32_16x16x32_bf16 v[100:103], v[16:19], v[224:227], v[100:103]
    s_barrier
    v_add_u32 v4, 0x9000, v4
    v_mfma_f32_16x16x32_bf16 v[108:111], v[16:19], v[228:231], v[108:111]
    s_add_u32 m0, s49, 0
    s_add_u32 s61, s48, 442368
    ds_read_b128 v[8:11], v4 offset:0
    v_mfma_f32_16x16x32_bf16 v[116:119], v[16:19], v[232:235], v[116:119]
    buffer_load_dwordx4 a[136:139], v2, s[4:7], s60 offen offset:2048 sc1
    v_mfma_f32_16x16x32_bf16 v[124:127], v[16:19], v[236:239], v[124:127]
    s_waitcnt lgkmcnt(3)
    v_mfma_f32_16x16x32_bf16 v[128:131], v[20:23], v[224:227], v[128:131]
    ds_read_b128 v[12:15], v4 offset:1024
    v_mfma_f32_16x16x32_bf16 v[136:139], v[20:23], v[228:231], v[136:139]
    v_mfma_f32_16x16x32_bf16 v[144:147], v[20:23], v[232:235], v[144:147]
    buffer_load_dwordx4 a[140:143], v2, s[4:7], s60 offen offset:3072 sc1
    v_mfma_f32_16x16x32_bf16 v[152:155], v[20:23], v[236:239], v[152:155]
    s_waitcnt lgkmcnt(3)
    s_add_u32 s60, s58, 32768
    v_mfma_f32_16x16x32_bf16 v[132:135], v[24:27], v[224:227], v[132:135]
    ds_read_b128 v[16:19], v4 offset:2048
    v_mfma_f32_16x16x32_bf16 v[140:143], v[24:27], v[228:231], v[140:143]
    v_mfma_f32_16x16x32_bf16 v[148:151], v[24:27], v[232:235], v[148:151]
    buffer_load_dwordx4 a[144:147], v2, s[4:7], s60 offen offset:0 sc1
    v_mfma_f32_16x16x32_bf16 v[156:159], v[24:27], v[236:239], v[156:159]
    s_waitcnt lgkmcnt(3)
    v_mfma_f32_16x16x32_bf16 v[160:163], v[28:31], v[224:227], v[160:163]
    ds_read_b128 v[20:23], v4 offset:3072
    v_mfma_f32_16x16x32_bf16 v[164:167], v[28:31], v[228:231], v[164:167]
    v_mfma_f32_16x16x32_bf16 v[168:171], v[28:31], v[232:235], v[168:171]
    buffer_load_dwordx4 a[148:151], v2, s[4:7], s60 offen offset:1024 sc1
    v_mfma_f32_16x16x32_bf16 v[172:175], v[28:31], v[236:239], v[172:175]
    s_waitcnt lgkmcnt(3)
    v_mfma_f32_16x16x32_bf16 v[32:35], v[8:11], v[240:243], v[32:35]
    ds_read_b128 v[24:27], v4 offset:4096
    v_mfma_f32_16x16x32_bf16 v[40:43], v[8:11], v[244:247], v[40:43]
    v_mfma_f32_16x16x32_bf16 v[48:51], v[8:11], v[248:251], v[48:51]
    buffer_load_dwordx4 a[152:155], v2, s[4:7], s60 offen offset:2048 sc1
    v_mfma_f32_16x16x32_bf16 v[56:59], v[8:11], v[252:255], v[56:59]
    s_waitcnt lgkmcnt(3)
    v_mfma_f32_16x16x32_bf16 v[36:39], v[12:15], v[240:243], v[36:39]
    ds_read_b128 v[28:31], v4 offset:5120
    v_mfma_f32_16x16x32_bf16 v[44:47], v[12:15], v[244:247], v[44:47]
    v_mfma_f32_16x16x32_bf16 v[52:55], v[12:15], v[248:251], v[52:55]
    buffer_load_dwordx4 a[156:159], v2, s[4:7], s60 offen offset:3072 sc1
    v_mfma_f32_16x16x32_bf16 v[60:63], v[12:15], v[252:255], v[60:63]
    s_waitcnt lgkmcnt(3)
    v_mfma_f32_16x16x32_bf16 v[64:67], v[16:19], v[240:243], v[64:67]
    ds_read_b128 v[8:11], v4 offset:6144
    v_mfma_f32_16x16x32_bf16 v[72:75], v[16:19], v[244:247], v[72:75]
    v_mfma_f32_16x16x32_bf16 v[80:83], v[16:19], v[248:251], v[80:83]
    buffer_load_dwordx4 v2, s[4:7], s61 offen offset:0 lds
    v_mfma_f32_16x16x32_bf16 v[88:91], v[16:19], v[252:255], v[88:91]
    s_waitcnt lgkmcnt(3)
    v_mfma_f32_16x16x32_bf16 v[68:71], v[20:23], v[240:243], v[68:71]
    ds_read_b128 v[12:15], v4 offset:7168
    v_mfma_f32_16x16x32_bf16 v[76:79], v[20:23], v[244:247], v[76:79]
    v_mfma_f32_16x16x32_bf16 v[84:87], v[20:23], v[248:251], v[84:87]
    buffer_load_dwordx4 v2, s[4:7], s61 offen offset:1024 lds
    v_mfma_f32_16x16x32_bf16 v[92:95], v[20:23], v[252:255], v[92:95]
    s_waitcnt lgkmcnt(3)
    v_mfma_f32_16x16x32_bf16 v[96:99], v[24:27], v[240:243], v[96:99]
    ds_read_b128 v[16:19], v4 offset:8192
    v_mfma_f32_16x16x32_bf16 v[104:107], v[24:27], v[244:247], v[104:107]
    v_mfma_f32_16x16x32_bf16 v[112:115], v[24:27], v[248:251], v[112:115]
    buffer_load_dwordx4 v2, s[4:7], s61 offen offset:2048 lds
    v_mfma_f32_16x16x32_bf16 v[120:123], v[24:27], v[252:255], v[120:123]
    s_waitcnt lgkmcnt(3)
    v_mfma_f32_16x16x32_bf16 v[100:103], v[28:31], v[240:243], v[100:103]
    ds_read_b128 v[20:23], v4 offset:9216
    v_mfma_f32_16x16x32_bf16 v[108:111], v[28:31], v[244:247], v[108:111]
    v_mfma_f32_16x16x32_bf16 v[116:119], v[28:31], v[248:251], v[116:119]
    buffer_load_dwordx4 v2, s[4:7], s61 offen offset:3072 lds
    v_mfma_f32_16x16x32_bf16 v[124:127], v[28:31], v[252:255], v[124:127]
    s_waitcnt lgkmcnt(3)
    s_add_u32 m0, s49, 4096
    s_add_u32 s61, s48, 446464
    v_mfma_f32_16x16x32_bf16 v[128:131], v[8:11], v[240:243], v[128:131]
    ds_read_b128 v[24:27], v4 offset:10240
    v_mfma_f32_16x16x32_bf16 v[136:139], v[8:11], v[244:247], v[136:139]
    v_mfma_f32_16x16x32_bf16 v[144:147], v[8:11], v[248:251], v[144:147]
    buffer_load_dwordx4 v2, s[4:7], s61 offen offset:0 lds
    v_mfma_f32_16x16x32_bf16 v[152:155], v[8:11], v[252:255], v[152:155]
    s_waitcnt lgkmcnt(3)
    v_mfma_f32_16x16x32_bf16 v[132:135], v[12:15], v[240:243], v[132:135]
    ds_read_b128 v[28:31], v4 offset:11264
    v_mfma_f32_16x16x32_bf16 v[140:143], v[12:15], v[244:247], v[140:143]
    v_mfma_f32_16x16x32_bf16 v[148:151], v[12:15], v[248:251], v[148:151]
    buffer_load_dwordx4 v2, s[4:7], s61 offen offset:1024 lds
    v_mfma_f32_16x16x32_bf16 v[156:159], v[12:15], v[252:255], v[156:159]
    s_waitcnt lgkmcnt(3)
    v_mfma_f32_16x16x32_bf16 v[160:163], v[16:19], v[240:243], v[160:163]
    ds_read_b128 v[8:11], v4 offset:12288
    v_mfma_f32_16x16x32_bf16 v[164:167], v[16:19], v[244:247], v[164:167]
    v_mfma_f32_16x16x32_bf16 v[168:171], v[16:19], v[248:251], v[168:171]
    buffer_load_dwordx4 v2, s[4:7], s61 offen offset:2048 lds
    v_mfma_f32_16x16x32_bf16 v[172:175], v[16:19], v[252:255], v[172:175]
    s_waitcnt lgkmcnt(3)
    v_mfma_f32_16x16x32_bf16 v[32:35], v[20:23], a[0:3], v[32:35]
    ds_read_b128 v[12:15], v4 offset:13312
    v_mfma_f32_16x16x32_bf16 v[40:43], v[20:23], a[4:7], v[40:43]
    v_mfma_f32_16x16x32_bf16 v[48:51], v[20:23], a[8:11], v[48:51]
    buffer_load_dwordx4 v2, s[4:7], s61 offen offset:3072 lds
    v_mfma_f32_16x16x32_bf16 v[56:59], v[20:23], a[12:15], v[56:59]
    s_waitcnt lgkmcnt(3)
    s_add_u32 m0, s49, 8192
    s_add_u32 s61, s48, 450560
    v_mfma_f32_16x16x32_bf16 v[36:39], v[24:27], a[0:3], v[36:39]
    ds_read_b128 v[16:19], v4 offset:14336
    v_mfma_f32_16x16x32_bf16 v[44:47], v[24:27], a[4:7], v[44:47]
    v_mfma_f32_16x16x32_bf16 v[52:55], v[24:27], a[8:11], v[52:55]
    buffer_load_dwordx4 v2, s[4:7], s61 offen offset:0 lds
    v_mfma_f32_16x16x32_bf16 v[60:63], v[24:27], a[12:15], v[60:63]
    s_waitcnt lgkmcnt(3)
    v_mfma_f32_16x16x32_bf16 v[64:67], v[28:31], a[0:3], v[64:67]
    ds_read_b128 v[20:23], v4 offset:15360
    v_mfma_f32_16x16x32_bf16 v[72:75], v[28:31], a[4:7], v[72:75]
    v_mfma_f32_16x16x32_bf16 v[80:83], v[28:31], a[8:11], v[80:83]
    v_mfma_f32_16x16x32_bf16 v[88:91], v[28:31], a[12:15], v[88:91]
    s_waitcnt lgkmcnt(3)
    v_mfma_f32_16x16x32_bf16 v[68:71], v[8:11], a[0:3], v[68:71]
    ds_read_b128 v[24:27], v4 offset:16384
    v_mfma_f32_16x16x32_bf16 v[76:79], v[8:11], a[4:7], v[76:79]
    v_mfma_f32_16x16x32_bf16 v[84:87], v[8:11], a[8:11], v[84:87]
    v_mfma_f32_16x16x32_bf16 v[92:95], v[8:11], a[12:15], v[92:95]
    s_waitcnt lgkmcnt(3)
    v_mfma_f32_16x16x32_bf16 v[96:99], v[12:15], a[0:3], v[96:99]
    ds_read_b128 v[28:31], v4 offset:17408
    v_mfma_f32_16x16x32_bf16 v[104:107], v[12:15], a[4:7], v[104:107]
    s_add_u32 s55, s52, 64
    v_mfma_f32_16x16x32_bf16 v[112:115], v[12:15], a[8:11], v[112:115]
    v_mfma_f32_16x16x32_bf16 v[120:123], v[12:15], a[12:15], v[120:123]
    s_waitcnt lgkmcnt(3)
    v_mfma_f32_16x16x32_bf16 v[100:103], v[16:19], a[0:3], v[100:103]
    ds_read_b128 v[8:11], v4 offset:18432
    v_mfma_f32_16x16x32_bf16 v[108:111], v[16:19], a[4:7], v[108:111]
    v_mfma_f32_16x16x32_bf16 v[116:119], v[16:19], a[8:11], v[116:119]
    v_mfma_f32_16x16x32_bf16 v[124:127], v[16:19], a[12:15], v[124:127]
    s_waitcnt lgkmcnt(3)
    s_lshl_b32 s55, s55, 2
    s_add_u32 s55, s55, 0x8000000
    v_mfma_f32_16x16x32_bf16 v[128:131], v[20:23], a[0:3], v[128:131]
    ds_read_b128 v[12:15], v4 offset:19456
    v_mfma_f32_16x16x32_bf16 v[136:139], v[20:23], a[4:7], v[136:139]
    v_mfma_f32_16x16x32_bf16 v[144:147], v[20:23], a[8:11], v[144:147]
    v_mfma_f32_16x16x32_bf16 v[152:155], v[20:23], a[12:15], v[152:155]
    s_waitcnt lgkmcnt(3)
    v_mfma_f32_16x16x32_bf16 v[132:135], v[24:27], a[0:3], v[132:135]
    ds_read_b128 v[16:19], v4 offset:20480
    v_mfma_f32_16x16x32_bf16 v[140:143], v[24:27], a[4:7], v[140:143]
    buffer_load_dwordx2 v[6:7], v0, s[4:7], s55 offen sc1
    v_mfma_f32_16x16x32_bf16 v[148:151], v[24:27], a[8:11], v[148:151]
    v_mfma_f32_16x16x32_bf16 v[156:159], v[24:27], a[12:15], v[156:159]
    s_waitcnt lgkmcnt(3)
    v_mfma_f32_16x16x32_bf16 v[160:163], v[28:31], a[0:3], v[160:163]
    ds_read_b128 v[20:23], v4 offset:21504
    v_mfma_f32_16x16x32_bf16 v[164:167], v[28:31], a[4:7], v[164:167]
    v_mfma_f32_16x16x32_bf16 v[168:171], v[28:31], a[8:11], v[168:171]
    v_mfma_f32_16x16x32_bf16 v[172:175], v[28:31], a[12:15], v[172:175]
    s_waitcnt lgkmcnt(3)
    v_mfma_f32_16x16x32_bf16 v[32:35], v[8:11], a[16:19], v[32:35]
    ds_read_b128 v[24:27], v4 offset:22528
    v_mfma_f32_16x16x32_bf16 v[40:43], v[8:11], a[20:23], v[40:43]
    v_mfma_f32_16x16x32_bf16 v[48:51], v[8:11], a[24:27], v[48:51]
    v_mfma_f32_16x16x32_bf16 v[56:59], v[8:11], a[28:31], v[56:59]
    s_waitcnt lgkmcnt(3)
    v_mfma_f32_16x16x32_bf16 v[36:39], v[12:15], a[16:19], v[36:39]
    ds_read_b128 v[28:31], v4 offset:23552
    v_mfma_f32_16x16x32_bf16 v[44:47], v[12:15], a[20:23], v[44:47]
    v_mfma_f32_16x16x32_bf16 v[52:55], v[12:15], a[24:27], v[52:55]
    v_mfma_f32_16x16x32_bf16 v[60:63], v[12:15], a[28:31], v[60:63]
    s_waitcnt lgkmcnt(3)
    v_mfma_f32_16x16x32_bf16 v[64:67], v[16:19], a[16:19], v[64:67]
    ds_read_b128 v[8:11], v4 offset:24576
    v_mfma_f32_16x16x32_bf16 v[72:75], v[16:19], a[20:23], v[72:75]
    v_mfma_f32_16x16x32_bf16 v[80:83], v[16:19], a[24:27], v[80:83]
    v_mfma_f32_16x16x32_bf16 v[88:91], v[16:19], a[28:31], v[88:91]
    s_waitcnt lgkmcnt(3)
    v_mfma_f32_16x16x32_bf16 v[68:71], v[20:23], a[16:19], v[68:71]
    ds_read_b128 v[12:15], v4 offset:25600
    v_mfma_f32_16x16x32_bf16 v[76:79], v[20:23], a[20:23], v[76:79]
    v_mfma_f32_16x16x32_bf16 v[84:87], v[20:23], a[24:27], v[84:87]
    v_mfma_f32_16x16x32_bf16 v[92:95], v[20:23], a[28:31], v[92:95]
    s_waitcnt lgkmcnt(3)
    v_mfma_f32_16x16x32_bf16 v[96:99], v[24:27], a[16:19], v[96:99]
    ds_read_b128 v[16:19], v4 offset:26624
    v_mfma_f32_16x16x32_bf16 v[104:107], v[24:27], a[20:23], v[104:107]
    v_mfma_f32_16x16x32_bf16 v[112:115], v[24:27], a[24:27], v[112:115]
    v_mfma_f32_16x16x32_bf16 v[120:123], v[24:27], a[28:31], v[120:123]
    s_waitcnt lgkmcnt(3)
    v_mfma_f32_16x16x32_bf16 v[100:103], v[28:31], a[16:19], v[100:103]
    ds_read_b128 v[20:23], v4 offset:27648
    v_mfma_f32_16x16x32_bf16 v[108:111], v[28:31], a[20:23], v[108:111]
    v_mfma_f32_16x16x32_bf16 v[116:119], v[28:31], a[24:27], v[116:119]
    v_mfma_f32_16x16x32_bf16 v[124:127], v[28:31], a[28:31], v[124:127]
    s_waitcnt lgkmcnt(3)
    v_mfma_f32_16x16x32_bf16 v[128:131], v[8:11], a[16:19], v[128:131]
    ds_read_b128 v[24:27], v4 offset:28672
    v_mfma_f32_16x16x32_bf16 v[136:139], v[8:11], a[20:23], v[136:139]
    v_mfma_f32_16x16x32_bf16 v[144:147], v[8:11], a[24:27], v[144:147]
    v_mfma_f32_16x16x32_bf16 v[152:155], v[8:11], a[28:31], v[152:155]
    s_waitcnt lgkmcnt(3)
    v_mfma_f32_16x16x32_bf16 v[132:135], v[12:15], a[16:19], v[132:135]
    ds_read_b128 v[28:31], v4 offset:29696
    v_mfma_f32_16x16x32_bf16 v[140:143], v[12:15], a[20:23], v[140:143]
    v_mfma_f32_16x16x32_bf16 v[148:151], v[12:15], a[24:27], v[148:151]
    v_mfma_f32_16x16x32_bf16 v[156:159], v[12:15], a[28:31], v[156:159]
    s_waitcnt lgkmcnt(3)
    v_mfma_f32_16x16x32_bf16 v[160:163], v[16:19], a[16:19], v[160:163]
    ds_read_b128 v[8:11], v4 offset:30720
    v_mfma_f32_16x16x32_bf16 v[164:167], v[16:19], a[20:23], v[164:167]
    v_mfma_f32_16x16x32_bf16 v[168:171], v[16:19], a[24:27], v[168:171]
    v_mfma_f32_16x16x32_bf16 v[172:175], v[16:19], a[28:31], v[172:175]
    s_waitcnt lgkmcnt(3)
    v_mfma_f32_16x16x32_bf16 v[32:35], v[20:23], a[32:35], v[32:35]
    ds_read_b128 v[12:15], v4 offset:31744
    v_mfma_f32_16x16x32_bf16 v[40:43], v[20:23], a[36:39], v[40:43]
    v_mfma_f32_16x16x32_bf16 v[48:51], v[20:23], a[40:43], v[48:51]
    v_mfma_f32_16x16x32_bf16 v[56:59], v[20:23], a[44:47], v[56:59]
    s_waitcnt lgkmcnt(3)
    v_mfma_f32_16x16x32_bf16 v[36:39], v[24:27], a[32:35], v[36:39]
    ds_read_b128 v[16:19], v4 offset:32768
    v_mfma_f32_16x16x32_bf16 v[44:47], v[24:27], a[36:39], v[44:47]
    v_mfma_f32_16x16x32_bf16 v[52:55], v[24:27], a[40:43], v[52:55]
    v_mfma_f32_16x16x32_bf16 v[60:63], v[24:27], a[44:47], v[60:63]
    s_waitcnt lgkmcnt(3)
    v_mfma_f32_16x16x32_bf16 v[64:67], v[28:31], a[32:35], v[64:67]
    ds_read_b128 v[20:23], v4 offset:33792
    v_mfma_f32_16x16x32_bf16 v[72:75], v[28:31], a[36:39], v[72:75]
    v_mfma_f32_16x16x32_bf16 v[80:83], v[28:31], a[40:43], v[80:83]
    v_mfma_f32_16x16x32_bf16 v[88:91], v[28:31], a[44:47], v[88:91]
    s_waitcnt lgkmcnt(3)
    v_mfma_f32_16x16x32_bf16 v[68:71], v[8:11], a[32:35], v[68:71]
    s_waitcnt vmcnt(0)
    v_cmp_eq_u64 vcc, s[98:99], v[6:7]
    s_nop 0
    s_cmp_eq_u64 vcc, exec
    s_cbranch_scc0 L_p2_slow_93
L_p2_back_94:
    v_mfma_f32_16x16x32_bf16 v[76:79], v[8:11], a[36:39], v[76:79]
    s_add_u32 s60, s56, 49152
    ds_read_b128 v[24:27], v4 offset:34816
    v_mfma_f32_16x16x32_bf16 v[84:87], v[8:11], a[40:43], v[84:87]
    buffer_load_dwordx4 a[160:163], v2, s[4:7], s60 offen offset:0 sc1
    v_mfma_f32_16x16x32_bf16 v[92:95], v[8:11], a[44:47], v[92:95]
    s_waitcnt lgkmcnt(3)
    s_and_b32 s68, s46, 1
    s_mul_i32 s69, s68, 5120
    v_mfma_f32_16x16x32_bf16 v[96:99], v[12:15], a[32:35], v[96:99]
    s_add_u32 s69, s69, s53
    s_lshr_b32 s59, s46, 1
    ds_read_b128 v[28:31], v4 offset:35840
    v_mfma_f32_16x16x32_bf16 v[104:107], v[12:15], a[36:39], v[104:107]
    s_xor_b32 s59, s59, s68
    s_lshl_b32 s59, s59, 10
    s_lshl_b32 s68, s68, 9
    v_mfma_f32_16x16x32_bf16 v[112:115], v[12:15], a[40:43], v[112:115]
    buffer_load_dwordx4 a[164:167], v2, s[4:7], s60 offen offset:1024 sc1
    v_mfma_f32_16x16x32_bf16 v[120:123], v[12:15], a[44:47], v[120:123]
    s_waitcnt lgkmcnt(3)
    s_add_u32 s68, s68, s53
    v_and_b32 v0, 15, v1
    v_mfma_f32_16x16x32_bf16 v[100:103], v[16:19], a[32:35], v[100:103]
    s_barrier
    v_add_u32 v4, 0x9000, v4
    v_mfma_f32_16x16x32_bf16 v[108:111], v[16:19], a[36:39], v[108:111]
    s_add_u32 m0, s63, 36864
    s_add_u32 s61, s62, 479232
    ds_read_b128 v[8:11], v4 offset:0
    v_mfma_f32_16x16x32_bf16 v[116:119], v[16:19], a[40:43], v[116:119]
    buffer_load_dwordx4 a[168:171], v2, s[4:7], s60 offen offset:2048 sc1
    v_mfma_f32_16x16x32_bf16 v[124:127], v[16:19], a[44:47], v[124:127]
    s_waitcnt lgkmcnt(3)
    v_lshlrev_b32 v0, 5, v0
    v_lshrrev_b32 v5, 4, v1
    v_mfma_f32_16x16x32_bf16 v[128:131], v[20:23], a[32:35], v[128:131]
    ds_read_b128 v[12:15], v4 offset:1024
    v_lshl_add_u32 v0, v5, 3, v0
    v_mfma_f32_16x16x32_bf16 v[136:139], v[20:23], a[36:39], v[136:139]
    v_mfma_f32_16x16x32_bf16 v[144:147], v[20:23], a[40:43], v[144:147]
    buffer_load_dwordx4 a[172:175], v2, s[4:7], s60 offen offset:3072 sc1
    v_mfma_f32_16x16x32_bf16 v[152:155], v[20:23], a[44:47], v[152:155]
    s_waitcnt lgkmcnt(3)
    s_add_u32 s60, s57, 49152
    v_mfma_f32_16x16x32_bf16 v[132:135], v[24:27], a[32:35], v[132:135]
    ds_read_b128 v[16:19], v4 offset:2048
    v_mfma_f32_16x16x32_bf16 v[140:143], v[24:27], a[36:39], v[140:143]
    v_mfma_f32_16x16x32_bf16 v[148:151], v[24:27], a[40:43], v[148:151]
    buffer_load_dwordx4 a[176:179], v2, s[4:7], s60 offen offset:0 sc1
    v_mfma_f32_16x16x32_bf16 v[156:159], v[24:27], a[44:47], v[156:159]
    s_waitcnt lgkmcnt(3)
    v_mfma_f32_16x16x32_bf16 v[160:163], v[28:31], a[32:35], v[160:163]
    ds_read_b128 v[20:23], v4 offset:3072
    v_mfma_f32_16x16x32_bf16 v[164:167], v[28:31], a[36:39], v[164:167]
    v_mfma_f32_16x16x32_bf16 v[168:171], v[28:31], a[40:43], v[168:171]
    buffer_load_dwordx4 a[180:183], v2, s[4:7], s60 offen offset:1024 sc1
    v_mfma_f32_16x16x32_bf16 v[172:175], v[28:31], a[44:47], v[172:175]
    s_waitcnt lgkmcnt(3)
    v_mfma_f32_16x16x32_bf16 v[32:35], v[8:11], a[48:51], v[32:35]
    ds_read_b128 v[24:27], v4 offset:4096
    v_mfma_f32_16x16x32_bf16 v[40:43], v[8:11], a[52:55], v[40:43]
    v_mfma_f32_16x16x32_bf16 v[48:51], v[8:11], a[56:59], v[48:51]
    buffer_load_dwordx4 a[184:187], v2, s[4:7], s60 offen offset:2048 sc1
    v_mfma_f32_16x16x32_bf16 v[56:59], v[8:11], a[60:63], v[56:59]
    s_waitcnt lgkmcnt(3)
    v_mfma_f32_16x16x32_bf16 v[36:39], v[12:15], a[48:51], v[36:39]
    ds_read_b128 v[28:31], v4 offset:5120
    v_mfma_f32_16x16x32_bf16 v[44:47], v[12:15], a[52:55], v[44:47]
    v_mfma_f32_16x16x32_bf16 v[52:55], v[12:15], a[56:59], v[52:55]
    buffer_load_dwordx4 a[188:191], v2, s[4:7], s60 offen offset:3072 sc1
    v_mfma_f32_16x16x32_bf16 v[60:63], v[12:15], a[60:63], v[60:63]
    s_waitcnt lgkmcnt(3)
    s_add_u32 s60, s58, 49152
    v_mfma_f32_16x16x32_bf16 v[64:67], v[16:19], a[48:51], v[64:67]
    ds_read_b128 v[8:11], v4 offset:6144
    v_mfma_f32_16x16x32_bf16 v[72:75], v[16:19], a[52:55], v[72:75]
    v_mfma_f32_16x16x32_bf16 v[80:83], v[16:19], a[56:59], v[80:83]
    buffer_load_dwordx4 a[192:195], v2, s[4:7], s60 offen offset:0 sc1
    v_mfma_f32_16x16x32_bf16 v[88:91], v[16:19], a[60:63], v[88:91]
    s_waitcnt lgkmcnt(3)
    v_mfma_f32_16x16x32_bf16 v[68:71], v[20:23], a[48:51], v[68:71]
    ds_read_b128 v[12:15], v4 offset:7168
    v_mfma_f32_16x16x32_bf16 v[76:79], v[20:23], a[52:55], v[76:79]
    v_mfma_f32_16x16x32_bf16 v[84:87], v[20:23], a[56:59], v[84:87]
    buffer_load_dwordx4 a[196:199], v2, s[4:7], s60 offen offset:1024 sc1
    v_mfma_f32_16x16x32_bf16 v[92:95], v[20:23], a[60:63], v[92:95]
    s_waitcnt lgkmcnt(3)
    v_mfma_f32_16x16x32_bf16 v[96:99], v[24:27], a[48:51], v[96:99]
    ds_read_b128 v[16:19], v4 offset:8192
    v_mfma_f32_16x16x32_bf16 v[104:107], v[24:27], a[52:55], v[104:107]
    v_mfma_f32_16x16x32_bf16 v[112:115], v[24:27], a[56:59], v[112:115]
    buffer_load_dwordx4 a[200:203], v2, s[4:7], s60 offen offset:2048 sc1
    v_mfma_f32_16x16x32_bf16 v[120:123], v[24:27], a[60:63], v[120:123]
    s_waitcnt lgkmcnt(3)
    v_mfma_f32_16x16x32_bf16 v[100:103], v[28:31], a[48:51], v[100:103]
    ds_read_b128 v[20:23], v4 offset:9216
    v_mfma_f32_16x16x32_bf16 v[108:111], v[28:31], a[52:55], v[108:111]
    v_mfma_f32_16x16x32_bf16 v[116:119], v[28:31], a[56:59], v[116:119]
    buffer_load_dwordx4 a[204:207], v2, s[4:7], s60 offen offset:3072 sc1
    v_mfma_f32_16x16x32_bf16 v[124:127], v[28:31], a[60:63], v[124:127]
    s_waitcnt lgkmcnt(3)
    v_mfma_f32_16x16x32_bf16 v[128:131], v[8:11], a[48:51], v[128:131]
    ds_read_b128 v[24:27], v4 offset:10240
    v_mfma_f32_16x16x32_bf16 v[136:139], v[8:11], a[52:55], v[136:139]
    v_mfma_f32_16x16x32_bf16 v[144:147], v[8:11], a[56:59], v[144:147]
    buffer_load_dwordx4 v2, s[4:7], s61 offen offset:0 lds
    v_mfma_f32_16x16x32_bf16 v[152:155], v[8:11], a[60:63], v[152:155]
    s_waitcnt lgkmcnt(3)
    v_mfma_f32_16x16x32_bf16 v[132:135], v[12:15], a[48:51], v[132:135]
    ds_read_b128 v[28:31], v4 offset:11264
    v_mfma_f32_16x16x32_bf16 v[140:143], v[12:15], a[52:55], v[140:143]
    v_mfma_f32_16x16x32_bf16 v[148:151], v[12:15], a[56:59], v[148:151]
    buffer_load_dwordx4 v2, s[4:7], s61 offen offset:1024 lds
    v_mfma_f32_16x16x32_bf16 v[156:159], v[12:15], a[60:63], v[156:159]
    s_waitcnt lgkmcnt(3)
    v_mfma_f32_16x16x32_bf16 v[160:163], v[16:19], a[48:51], v[160:163]
    ds_read_b128 v[8:11], v4 offset:12288
    v_mfma_f32_16x16x32_bf16 v[164:167], v[16:19], a[52:55], v[164:167]
    v_mfma_f32_16x16x32_bf16 v[168:171], v[16:19], a[56:59], v[168:171]
    buffer_load_dwordx4 v2, s[4:7], s61 offen offset:2048 lds
    v_mfma_f32_16x16x32_bf16 v[172:175], v[16:19], a[60:63], v[172:175]
    s_waitcnt lgkmcnt(3)
    v_mfma_f32_16x16x32_bf16 v[32:35], v[20:23], a[64:67], v[32:35]
    ds_read_b128 v[12:15], v4 offset:13312
    v_mfma_f32_16x16x32_bf16 v[40:43], v[20:23], a[68:71], v[40:43]
    v_mfma_f32_16x16x32_bf16 v[48:51], v[20:23], a[72:75], v[48:51]
    buffer_load_dwordx4 v2, s[4:7], s61 offen offset:3072 lds
    v_mfma_f32_16x16x32_bf16 v[56:59], v[20:23], a[76:79], v[56:59]
    s_waitcnt lgkmcnt(3)
    s_add_u32 m0, s63, 40960
    s_add_u32 s61, s62, 483328
    v_mfma_f32_16x16x32_bf16 v[36:39], v[24:27], a[64:67], v[36:39]
    ds_read_b128 v[16:19], v4 offset:14336
    v_mfma_f32_16x16x32_bf16 v[44:47], v[24:27], a[68:71], v[44:47]
    v_mfma_f32_16x16x32_bf16 v[52:55], v[24:27], a[72:75], v[52:55]
    buffer_load_dwordx4 v2, s[4:7], s61 offen offset:0 lds
    v_mfma_f32_16x16x32_bf16 v[60:63], v[24:27], a[76:79], v[60:63]
    s_waitcnt lgkmcnt(3)
    v_mfma_f32_16x16x32_bf16 v[32:35], v[28:31], a[80:83], v[32:35]
    s_and_b32 s61, s21, 1
    s_lshl_b32 s61, s61, 3
    ds_read_b128 v[20:23], v4 offset:15360
    v_mfma_f32_16x16x32_bf16 v[40:43], v[28:31], a[84:87], v[40:43]
    s_and_b32 s62, s22, 7
    s_add_u32 s62, s62, s61
    s_mul_i32 s62, s62, 129024
    v_mfma_f32_16x16x32_bf16 v[48:51], v[28:31], a[88:91], v[48:51]
    s_add_u32 s62, s62, 0
    s_cmp_lg_u32 s101, 0
    s_cselect_b32 s62, 0x10000000, s62
    v_mfma_f32_16x16x32_bf16 v[56:59], v[28:31], a[92:95], v[56:59]
    s_waitcnt lgkmcnt(3)
    s_add_u32 s61, s63, 36864
    s_add_u32 m0, s61, 18432
    v_mfma_f32_16x16x32_bf16 v[36:39], v[8:11], a[80:83], v[36:39]
    s_add_u32 s61, s61, s62
    ds_read_b128 v[24:27], v4 offset:16384
    v_mfma_f32_16x16x32_bf16 v[44:47], v[8:11], a[84:87], v[44:47]
    buffer_load_dwordx4 v2, s[4:7], s61 offen offset:0 lds
    v_mfma_f32_16x16x32_bf16 v[52:55], v[8:11], a[88:91], v[52:55]
    v_mfma_f32_16x16x32_bf16 v[60:63], v[8:11], a[92:95], v[60:63]
    s_waitcnt lgkmcnt(3)
    v_mfma_f32_16x16x32_bf16 v[32:35], v[12:15], a[96:99], v[32:35]
    ds_read_b128 v[28:31], v4 offset:17408
    v_mfma_f32_16x16x32_bf16 v[40:43], v[12:15], a[100:103], v[40:43]
    buffer_load_dwordx4 v2, s[4:7], s61 offen offset:1024 lds
    v_mfma_f32_16x16x32_bf16 v[48:51], v[12:15], a[104:107], v[48:51]
    v_mfma_f32_16x16x32_bf16 v[56:59], v[12:15], a[108:111], v[56:59]
    s_waitcnt lgkmcnt(3)
    v_mfma_f32_16x16x32_bf16 v[36:39], v[16:19], a[96:99], v[36:39]
    ds_read_b128 v[8:11], v4 offset:18432
    v_mfma_f32_16x16x32_bf16 v[44:47], v[16:19], a[100:103], v[44:47]
    buffer_load_dwordx4 v2, s[4:7], s61 offen offset:2048 lds
    v_mfma_f32_16x16x32_bf16 v[52:55], v[16:19], a[104:107], v[52:55]
    v_mfma_f32_16x16x32_bf16 v[60:63], v[16:19], a[108:111], v[60:63]
    s_waitcnt lgkmcnt(3)
    v_mfma_f32_16x16x32_bf16 v[32:35], v[20:23], a[112:115], v[32:35]
    ds_read_b128 v[12:15], v4 offset:19456
    v_mfma_f32_16x16x32_bf16 v[40:43], v[20:23], a[116:119], v[40:43]
    buffer_load_dwordx4 v2, s[4:7], s61 offen offset:3072 lds
    v_mfma_f32_16x16x32_bf16 v[48:51], v[20:23], a[120:123], v[48:51]
    s_add_u32 s61, s63, 40960
    s_add_u32 m0, s61, 18432
    s_add_u32 s61, s61, s62
    v_mfma_f32_16x16x32_bf16 v[56:59], v[20:23], a[124:127], v[56:59]
    s_waitcnt lgkmcnt(3)
    v_mfma_f32_16x16x32_bf16 v[36:39], v[24:27], a[112:115], v[36:39]
    ds_read_b128 v[16:19], v4 offset:20480
    v_mfma_f32_16x16x32_bf16 v[44:47], v[24:27], a[116:119], v[44:47]
    buffer_load_dwordx4 v2, s[4:7], s61 offen offset:0 lds
    v_mfma_f32_16x16x32_bf16 v[52:55], v[24:27], a[120:123], v[52:55]
    v_mfma_f32_16x16x32_bf16 v[60:63], v[24:27], a[124:127], v[60:63]
    s_waitcnt lgkmcnt(3)
    v_mfma_f32_16x16x32_bf16 v[32:35], v[28:31], a[128:131], v[32:35]
    ds_read_b128 v[20:23], v4 offset:21504
    v_mfma_f32_16x16x32_bf16 v[40:43], v[28:31], a[132:135], v[40:43]
    v_mfma_f32_16x16x32_bf16 v[48:51], v[28:31], a[136:139], v[48:51]
    v_mfma_f32_16x16x32_bf16 v[56:59], v[28:31], a[140:143], v[56:59]
    s_waitcnt lgkmcnt(3)
    v_mfma_f32_16x16x32_bf16 v[36:39], v[8:11], a[128:131], v[36:39]
    ds_read_b128 v[24:27], v4 offset:22528
    v_mfma_f32_16x16x32_bf16 v[44:47], v[8:11], a[132:135], v[44:47]
    v_mfma_f32_16x16x32_bf16 v[52:55], v[8:11], a[136:139], v[52:55]
    v_mfma_f32_16x16x32_bf16 v[60:63], v[8:11], a[140:143], v[60:63]
    s_waitcnt lgkmcnt(3)
    v_mfma_f32_16x16x32_bf16 v[32:35], v[12:15], a[144:147], v[32:35]
    ds_read_b128 v[28:31], v4 offset:23552
    v_mfma_f32_16x16x32_bf16 v[40:43], v[12:15], a[148:151], v[40:43]
    v_mfma_f32_16x16x32_bf16 v[48:51], v[12:15], a[152:155], v[48:51]
    v_mfma_f32_16x16x32_bf16 v[56:59], v[12:15], a[156:159], v[56:59]
    s_waitcnt lgkmcnt(3)
    v_mfma_f32_16x16x32_bf16 v[36:39], v[16:19], a[144:147], v[36:39]
    ds_read_b128 v[8:11], v4 offset:24576
    v_mfma_f32_16x16x32_bf16 v[44:47], v[16:19], a[148:151], v[44:47]
    v_mfma_f32_16x16x32_bf16 v[52:55], v[16:19], a[152:155], v[52:55]
    v_mfma_f32_16x16x32_bf16 v[60:63], v[16:19], a[156:159], v[60:63]
    s_waitcnt vmcnt(21) lgkmcnt(3)
    v_mfma_f32_16x16x32_bf16 v[32:35], v[20:23], a[160:163], v[32:35]
    s_waitcnt vmcnt(20)
    ds_read_b128 v[12:15], v4 offset:25600
    v_mfma_f32_16x16x32_bf16 v[40:43], v[20:23], a[164:167], v[40:43]
    s_waitcnt vmcnt(19)
    v_mfma_f32_16x16x32_bf16 v[48:51], v[20:23], a[168:171], v[48:51]
    s_waitcnt vmcnt(18)
    v_mfma_f32_16x16x32_bf16 v[56:59], v[20:23], a[172:175], v[56:59]
    s_waitcnt lgkmcnt(3)
    v_mfma_f32_16x16x32_bf16 v[36:39], v[24:27], a[160:163], v[36:39]
    ds_read_b128 v[16:19], v4 offset:26624
    v_mfma_f32_16x16x32_bf16 v[44:47], v[24:27], a[164:167], v[44:47]
    v_mfma_f32_16x16x32_bf16 v[52:55], v[24:27], a[168:171], v[52:55]
    v_mfma_f32_16x16x32_bf16 v[60:63], v[24:27], a[172:175], v[60:63]
    s_waitcnt vmcnt(17) lgkmcnt(3)
    v_mfma_f32_16x16x32_bf16 v[32:35], v[28:31], a[176:179], v[32:35]
    s_waitcnt vmcnt(16)
    ds_read_b128 v[20:23], v4 offset:27648
    v_mfma_f32_16x16x32_bf16 v[40:43], v[28:31], a[180:183], v[40:43]
    s_waitcnt vmcnt(15)
    v_mfma_f32_16x16x32_bf16 v[48:51], v[28:31], a[184:187], v[48:51]
    s_waitcnt vmcnt(14)
    v_mfma_f32_16x16x32_bf16 v[56:59], v[28:31], a[188:191], v[56:59]
    s_waitcnt lgkmcnt(3)
    v_mfma_f32_16x16x32_bf16 v[36:39], v[8:11], a[176:179], v[36:39]
    ds_read_b128 v[24:27], v4 offset:28672
    v_mfma_f32_16x16x32_bf16 v[44:47], v[8:11], a[180:183], v[44:47]
    v_mfma_f32_16x16x32_bf16 v[52:55], v[8:11], a[184:187], v[52:55]
    v_mfma_f32_16x16x32_bf16 v[60:63], v[8:11], a[188:191], v[60:63]
    s_waitcnt vmcnt(13) lgkmcnt(3)
    v_mfma_f32_16x16x32_bf16 v[32:35], v[12:15], a[192:195], v[32:35]
    s_waitcnt vmcnt(12)
    ds_read_b128 v[28:31], v4 offset:29696
    v_mfma_f32_16x16x32_bf16 v[40:43], v[12:15], a[196:199], v[40:43]
    s_waitcnt vmcnt(11)
    v_mfma_f32_16x16x32_bf16 v[48:51], v[12:15], a[200:203], v[48:51]
    s_waitcnt vmcnt(10)
    v_mfma_f32_16x16x32_bf16 v[56:59], v[12:15], a[204:207], v[56:59]
    s_waitcnt lgkmcnt(3)
    s_add_u32 s69, s69, s59
    v_mfma_f32_16x16x32_bf16 v[36:39], v[16:19], a[192:195], v[36:39]
    ds_read_b128 v[8:11], v4 offset:30720
    v_mfma_f32_16x16x32_bf16 v[44:47], v[16:19], a[196:199], v[44:47]
    v_mfma_f32_16x16x32_bf16 v[52:55], v[16:19], a[200:203], v[52:55]
    v_mfma_f32_16x16x32_bf16 v[60:63], v[16:19], a[204:207], v[60:63]
    s_waitcnt lgkmcnt(3)
    v_mfma_f32_16x16x32_bf16 v[64:67], v[20:23], a[64:67], v[64:67]
    ds_read_b128 v[12:15], v4 offset:31744
    v_mfma_f32_16x16x32_bf16 v[72:75], v[20:23], a[68:71], v[72:75]
    v_mfma_f32_16x16x32_bf16 v[80:83], v[20:23], a[72:75], v[80:83]
    v_mfma_f32_16x16x32_bf16 v[88:91], v[20:23], a[76:79], v[88:91]
    s_waitcnt lgkmcnt(3)
    v_cvt_pk_bf16_f32 v32, v32, v33
    v_cvt_pk_bf16_f32 v33, v34, v35
    v_mfma_f32_16x16x32_bf16 v[68:71], v[24:27], a[64:67], v[68:71]
    ds_read_b128 v[16:19], v4 offset:32768
    v_cvt_pk_bf16_f32 v34, v36, v37
    v_mfma_f32_16x16x32_bf16 v[76:79], v[24:27], a[68:71], v[76:79]
    v_cvt_pk_bf16_f32 v35, v38, v39
    v_mfma_f32_16x16x32_bf16 v[84:87], v[24:27], a[72:75], v[84:87]
    s_add_u32 s70, s69, 0
    v_mfma_f32_16x16x32_bf16 v[92:95], v[24:27], a[76:79], v[92:95]
    s_waitcnt lgkmcnt(3)
    v_mfma_f32_16x16x32_bf16 v[64:67], v[28:31], a[80:83], v[64:67]
    ds_read_b128 v[20:23], v4 offset:33792
    v_mfma_f32_16x16x32_bf16 v[72:75], v[28:31], a[84:87], v[72:75]
    buffer_store_dwordx4 v[32:35], v2, s[4:7], s70 offen sc1
    v_mfma_f32_16x16x32_bf16 v[80:83], v[28:31], a[88:91], v[80:83]
    v_cvt_pk_bf16_f32 v40, v40, v41
    v_cvt_pk_bf16_f32 v41, v42, v43
    v_mfma_f32_16x16x32_bf16 v[88:91], v[28:31], a[92:95], v[88:91]
    s_waitcnt lgkmcnt(3)
    v_cvt_pk_bf16_f32 v42, v44, v45
    v_cvt_pk_bf16_f32 v43, v46, v47
    v_mfma_f32_16x16x32_bf16 v[68:71], v[8:11], a[80:83], v[68:71]
    s_add_u32 s70, s69, 18432
    ds_read_b128 v[24:27], v4 offset:34816
    v_mfma_f32_16x16x32_bf16 v[76:79], v[8:11], a[84:87], v[76:79]
    buffer_store_dwordx4 v[40:43], v2, s[4:7], s70 offen sc1
    v_mfma_f32_16x16x32_bf16 v[84:87], v[8:11], a[88:91], v[84:87]
    v_cvt_pk_bf16_f32 v48, v48, v49
    v_cvt_pk_bf16_f32 v49, v50, v51
    v_mfma_f32_16x16x32_bf16 v[92:95], v[8:11], a[92:95], v[92:95]
    s_waitcnt lgkmcnt(3)
    v_cvt_pk_bf16_f32 v50, v52, v53
    v_cvt_pk_bf16_f32 v51, v54, v55
    v_mfma_f32_16x16x32_bf16 v[64:67], v[12:15], a[96:99], v[64:67]
    s_add_u32 s70, s69, 36864
    ds_read_b128 v[28:31], v4 offset:35840
    v_mfma_f32_16x16x32_bf16 v[72:75], v[12:15], a[100:103], v[72:75]
    buffer_store_dwordx4 v[48:51], v2, s[4:7], s70 offen sc1
    v_mfma_f32_16x16x32_bf16 v[80:83], v[12:15], a[104:107], v[80:83]
    v_cvt_pk_bf16_f32 v56, v56, v57
    v_cvt_pk_bf16_f32 v57, v58, v59
    v_mfma_f32_16x16x32_bf16 v[88:91], v[12:15], a[108:111], v[88:91]
    s_waitcnt lgkmcnt(3)
    v_cvt_pk_bf16_f32 v58, v60, v61
    v_cvt_pk_bf16_f32 v59, v62, v63
    v_mfma_f32_16x16x32_bf16 v[68:71], v[16:19], a[96:99], v[68:71]
    s_barrier
    v_add_u32 v4, 0xfffe5000, v4
    v_mfma_f32_16x16x32_bf16 v[76:79], v[16:19], a[100:103], v[76:79]
    s_add_u32 s70, s69, 55296
    s_add_u32 s61, s49, 55296
    ds_read_b128 v[8:11], v4 offset:0
    v_mfma_f32_16x16x32_bf16 v[84:87], v[16:19], a[104:107], v[84:87]
    buffer_store_dwordx4 v[56:59], v2, s[4:7], s70 offen sc1
    v_mfma_f32_16x16x32_bf16 v[92:95], v[16:19], a[108:111], v[92:95]
    s_waitcnt lgkmcnt(3)
    s_add_u32 m0, s61, 18432
    s_add_u32 s61, s61, s62
    v_mfma_f32_16x16x32_bf16 v[64:67], v[20:23], a[112:115], v[64:67]
    ds_read_b128 v[12:15], v4 offset:1024
    v_mfma_f32_16x16x32_bf16 v[72:75], v[20:23], a[116:119], v[72:75]
    v_mfma_f32_16x16x32_bf16 v[80:83], v[20:23], a[120:123], v[80:83]
    buffer_load_dwordx4 v2, s[4:7], s61 offen offset:0 lds
    v_mfma_f32_16x16x32_bf16 v[88:91], v[20:23], a[124:127], v[88:91]
    s_waitcnt lgkmcnt(3)
    v_mfma_f32_16x16x32_bf16 v[68:71], v[24:27], a[112:115], v[68:71]
    ds_read_b128 v[16:19], v4 offset:2048
    v_mfma_f32_16x16x32_bf16 v[76:79], v[24:27], a[116:119], v[76:79]
    v_mfma_f32_16x16x32_bf16 v[84:87], v[24:27], a[120:123], v[84:87]
    buffer_load_dwordx4 v2, s[4:7], s61 offen offset:1024 lds
    v_mfma_f32_16x16x32_bf16 v[92:95], v[24:27], a[124:127], v[92:95]
    s_waitcnt lgkmcnt(3)
    v_mfma_f32_16x16x32_bf16 v[64:67], v[28:31], a[128:131], v[64:67]
    ds_read_b128 v[20:23], v4 offset:3072
    v_mfma_f32_16x16x32_bf16 v[72:75], v[28:31], a[132:135], v[72:75]
    v_mfma_f32_16x16x32_bf16 v[80:83], v[28:31], a[136:139], v[80:83]
    buffer_load_dwordx4 v2, s[4:7], s61 offen offset:2048 lds
    v_mfma_f32_16x16x32_bf16 v[88:91], v[28:31], a[140:143], v[88:91]
    s_waitcnt lgkmcnt(3)
    v_mfma_f32_16x16x32_bf16 v[68:71], v[8:11], a[128:131], v[68:71]
    ds_read_b128 v[24:27], v4 offset:4096
    v_mfma_f32_16x16x32_bf16 v[76:79], v[8:11], a[132:135], v[76:79]
    v_mfma_f32_16x16x32_bf16 v[84:87], v[8:11], a[136:139], v[84:87]
    buffer_load_dwordx4 v2, s[4:7], s61 offen offset:3072 lds
    v_mfma_f32_16x16x32_bf16 v[92:95], v[8:11], a[140:143], v[92:95]
    s_waitcnt lgkmcnt(3)
    s_add_u32 s61, s49, 59392
    s_add_u32 m0, s61, 18432
    v_mfma_f32_16x16x32_bf16 v[64:67], v[12:15], a[144:147], v[64:67]
    s_add_u32 s61, s61, s62
    ds_read_b128 v[28:31], v4 offset:5120
    v_mfma_f32_16x16x32_bf16 v[72:75], v[12:15], a[148:151], v[72:75]
    v_mfma_f32_16x16x32_bf16 v[80:83], v[12:15], a[152:155], v[80:83]
    buffer_load_dwordx4 v2, s[4:7], s61 offen offset:0 lds
    v_mfma_f32_16x16x32_bf16 v[88:91], v[12:15], a[156:159], v[88:91]
    s_waitcnt lgkmcnt(3)
    v_mfma_f32_16x16x32_bf16 v[68:71], v[16:19], a[144:147], v[68:71]
    ds_read_b128 v[8:11], v4 offset:6144
    v_mfma_f32_16x16x32_bf16 v[76:79], v[16:19], a[148:151], v[76:79]
    v_mfma_f32_16x16x32_bf16 v[84:87], v[16:19], a[152:155], v[84:87]
    buffer_load_dwordx4 v2, s[4:7], s61 offen offset:1024 lds
    v_mfma_f32_16x16x32_bf16 v[92:95], v[16:19], a[156:159], v[92:95]
    s_waitcnt lgkmcnt(3)
    v_mfma_f32_16x16x32_bf16 v[64:67], v[20:23], a[160:163], v[64:67]
    ds_read_b128 v[12:15], v4 offset:7168
    v_mfma_f32_16x16x32_bf16 v[72:75], v[20:23], a[164:167], v[72:75]
    v_mfma_f32_16x16x32_bf16 v[80:83], v[20:23], a[168:171], v[80:83]
    buffer_load_dwordx4 v2, s[4:7], s61 offen offset:2048 lds
    v_mfma_f32_16x16x32_bf16 v[88:91], v[20:23], a[172:175], v[88:91]
    s_waitcnt lgkmcnt(3)
    v_mfma_f32_16x16x32_bf16 v[68:71], v[24:27], a[160:163], v[68:71]
    ds_read_b128 v[16:19], v4 offset:8192
    v_mfma_f32_16x16x32_bf16 v[76:79], v[24:27], a[164:167], v[76:79]
    v_mfma_f32_16x16x32_bf16 v[84:87], v[24:27], a[168:171], v[84:87]
    buffer_load_dwordx4 v2, s[4:7], s61 offen offset:3072 lds
    v_mfma_f32_16x16x32_bf16 v[92:95], v[24:27], a[172:175], v[92:95]
    s_waitcnt lgkmcnt(3)
    s_add_u32 s61, s49, 63488
    s_add_u32 m0, s61, 18432
    v_mfma_f32_16x16x32_bf16 v[64:67], v[28:31], a[176:179], v[64:67]
    s_add_u32 s61, s61, s62
    ds_read_b128 v[20:23], v4 offset:9216
    v_mfma_f32_16x16x32_bf16 v[72:75], v[28:31], a[180:183], v[72:75]
    v_mfma_f32_16x16x32_bf16 v[80:83], v[28:31], a[184:187], v[80:83]
    buffer_load_dwordx4 v2, s[4:7], s61 offen offset:0 lds
    v_mfma_f32_16x16x32_bf16 v[88:91], v[28:31], a[188:191], v[88:91]
    s_waitcnt lgkmcnt(3)
    v_mfma_f32_16x16x32_bf16 v[68:71], v[8:11], a[176:179], v[68:71]
    ds_read_b128 v[24:27], v4 offset:10240
    v_mfma_f32_16x16x32_bf16 v[76:79], v[8:11], a[180:183], v[76:79]
    v_mfma_f32_16x16x32_bf16 v[84:87], v[8:11], a[184:187], v[84:87]
    v_mfma_f32_16x16x32_bf16 v[92:95], v[8:11], a[188:191], v[92:95]
    s_waitcnt lgkmcnt(3)
    v_mfma_f32_16x16x32_bf16 v[64:67], v[12:15], a[192:195], v[64:67]
    ds_read_b128 v[28:31], v4 offset:11264
    v_mfma_f32_16x16x32_bf16 v[72:75], v[12:15], a[196:199], v[72:75]
    v_mfma_f32_16x16x32_bf16 v[80:83], v[12:15], a[200:203], v[80:83]
    v_mfma_f32_16x16x32_bf16 v[88:91], v[12:15], a[204:207], v[88:91]
    s_waitcnt lgkmcnt(3)
    v_mfma_f32_16x16x32_bf16 v[68:71], v[16:19], a[192:195], v[68:71]
    ds_read_b128 v[8:11], v4 offset:12288
    v_mfma_f32_16x16x32_bf16 v[76:79], v[16:19], a[196:199], v[76:79]
    v_mfma_f32_16x16x32_bf16 v[84:87], v[16:19], a[200:203], v[84:87]
    v_mfma_f32_16x16x32_bf16 v[92:95], v[16:19], a[204:207], v[92:95]
    s_waitcnt lgkmcnt(3)
    v_mfma_f32_16x16x32_bf16 v[96:99], v[20:23], a[64:67], v[96:99]
    ds_read_b128 v[12:15], v4 offset:13312
    v_mfma_f32_16x16x32_bf16 v[104:107], v[20:23], a[68:71], v[104:107]
    v_mfma_f32_16x16x32_bf16 v[112:115], v[20:23], a[72:75], v[112:115]
    v_mfma_f32_16x16x32_bf16 v[120:123], v[20:23], a[76:79], v[120:123]
    s_waitcnt lgkmcnt(3)
    v_cvt_pk_bf16_f32 v64, v64, v65
    v_cvt_pk_bf16_f32 v65, v66, v67
    v_mfma_f32_16x16x32_bf16 v[100:103], v[24:27], a[64:67], v[100:103]
    ds_read_b128 v[16:19], v4 offset:14336
    v_cvt_pk_bf16_f32 v66, v68, v69
    v_mfma_f32_16x16x32_bf16 v[108:111], v[24:27], a[68:71], v[108:111]
    v_cvt_pk_bf16_f32 v67, v70, v71
    v_mfma_f32_16x16x32_bf16 v[116:119], v[24:27], a[72:75], v[116:119]
    s_add_u32 s70, s69, 1024
    v_mfma_f32_16x16x32_bf16 v[124:127], v[24:27], a[76:79], v[124:127]
    s_waitcnt lgkmcnt(3)
    v_mfma_f32_16x16x32_bf16 v[96:99], v[28:31], a[80:83], v[96:99]
    ds_read_b128 v[20:23], v4 offset:15360
    v_mfma_f32_16x16x32_bf16 v[104:107], v[28:31], a[84:87], v[104:107]
    buffer_store_dwordx4 v[64:67], v2, s[4:7], s70 offen sc1
    v_mfma_f32_16x16x32_bf16 v[112:115], v[28:31], a[88:91], v[112:115]
    v_cvt_pk_bf16_f32 v72, v72, v73
    v_cvt_pk_bf16_f32 v73, v74, v75
    v_mfma_f32_16x16x32_bf16 v[120:123], v[28:31], a[92:95], v[120:123]
    s_waitcnt lgkmcnt(3)
    v_cvt_pk_bf16_f32 v74, v76, v77
    v_cvt_pk_bf16_f32 v75, v78, v79
    v_mfma_f32_16x16x32_bf16 v[100:103], v[8:11], a[80:83], v[100:103]
    s_add_u32 s70, s69, 19456
    ds_read_b128 v[24:27], v4 offset:16384
    v_mfma_f32_16x16x32_bf16 v[108:111], v[8:11], a[84:87], v[108:111]
    buffer_store_dwordx4 v[72:75], v2, s[4:7], s70 offen sc1
    v_mfma_f32_16x16x32_bf16 v[116:119], v[8:11], a[88:91], v[116:119]
    v_cvt_pk_bf16_f32 v80, v80, v81
    v_cvt_pk_bf16_f32 v81, v82, v83
    v_mfma_f32_16x16x32_bf16 v[124:127], v[8:11], a[92:95], v[124:127]
    s_waitcnt lgkmcnt(3)
    v_cvt_pk_bf16_f32 v82, v84, v85
    v_cvt_pk_bf16_f32 v83, v86, v87
    v_mfma_f32_16x16x32_bf16 v[96:99], v[12:15], a[96:99], v[96:99]
    s_add_u32 s70, s69, 37888
    ds_read_b128 v[28:31], v4 offset:17408
    v_mfma_f32_16x16x32_bf16 v[104:107], v[12:15], a[100:103], v[104:107]
    buffer_store_dwordx4 v[80:83], v2, s[4:7], s70 offen sc1
    v_mfma_f32_16x16x32_bf16 v[112:115], v[12:15], a[104:107], v[112:115]
    v_cvt_pk_bf16_f32 v88, v88, v89
    v_cvt_pk_bf16_f32 v89, v90, v91
    v_mfma_f32_16x16x32_bf16 v[120:123], v[12:15], a[108:111], v[120:123]
    s_waitcnt lgkmcnt(3)
    v_cvt_pk_bf16_f32 v90, v92, v93
    v_cvt_pk_bf16_f32 v91, v94, v95
    v_mfma_f32_16x16x32_bf16 v[100:103], v[16:19], a[96:99], v[100:103]
    s_add_u32 s70, s69, 56320
    ds_read_b128 v[8:11], v4 offset:18432
    v_mfma_f32_16x16x32_bf16 v[108:111], v[16:19], a[100:103], v[108:111]
    buffer_store_dwordx4 v[88:91], v2, s[4:7], s70 offen sc1
    v_mfma_f32_16x16x32_bf16 v[116:119], v[16:19], a[104:107], v[116:119]
    v_mfma_f32_16x16x32_bf16 v[124:127], v[16:19], a[108:111], v[124:127]
    s_waitcnt lgkmcnt(3)
    v_mfma_f32_16x16x32_bf16 v[96:99], v[20:23], a[112:115], v[96:99]
    ds_read_b128 v[12:15], v4 offset:19456
    v_mfma_f32_16x16x32_bf16 v[104:107], v[20:23], a[116:119], v[104:107]
    v_mfma_f32_16x16x32_bf16 v[112:115], v[20:23], a[120:123], v[112:115]
    v_mfma_f32_16x16x32_bf16 v[120:123], v[20:23], a[124:127], v[120:123]
    s_waitcnt lgkmcnt(3)
    v_mfma_f32_16x16x32_bf16 v[100:103], v[24:27], a[112:115], v[100:103]
    ds_read_b128 v[16:19], v4 offset:20480
    v_mfma_f32_16x16x32_bf16 v[108:111], v[24:27], a[116:119], v[108:111]
    v_mfma_f32_16x16x32_bf16 v[116:119], v[24:27], a[120:123], v[116:119]
    v_mfma_f32_16x16x32_bf16 v[124:127], v[24:27], a[124:127], v[124:127]
    s_waitcnt lgkmcnt(3)
    v_mfma_f32_16x16x32_bf16 v[96:99], v[28:31], a[128:131], v[96:99]
    ds_read_b128 v[20:23], v4 offset:21504
    v_mfma_f32_16x16x32_bf16 v[104:107], v[28:31], a[132:135], v[104:107]
    v_mfma_f32_16x16x32_bf16 v[112:115], v[28:31], a[136:139], v[112:115]
    v_mfma_f32_16x16x32_bf16 v[120:123], v[28:31], a[140:143], v[120:123]
    s_waitcnt lgkmcnt(3)
    v_mfma_f32_16x16x32_bf16 v[100:103], v[8:11], a[128:131], v[100:103]
    ds_read_b128 v[24:27], v4 offset:22528
    v_mfma_f32_16x16x32_bf16 v[108:111], v[8:11], a[132:135], v[108:111]
    v_mfma_f32_16x16x32_bf16 v[116:119], v[8:11], a[136:139], v[116:119]
    v_mfma_f32_16x16x32_bf16 v[124:127], v[8:11], a[140:143], v[124:127]
    s_waitcnt lgkmcnt(3)
    v_mfma_f32_16x16x32_bf16 v[96:99], v[12:15], a[144:147], v[96:99]
    ds_read_b128 v[28:31], v4 offset:23552
    v_mfma_f32_16x16x32_bf16 v[104:107], v[12:15], a[148:151], v[104:107]
    v_mfma_f32_16x16x32_bf16 v[112:115], v[12:15], a[152:155], v[112:115]
    v_mfma_f32_16x16x32_bf16 v[120:123], v[12:15], a[156:159], v[120:123]
    s_waitcnt lgkmcnt(3)
    v_mfma_f32_16x16x32_bf16 v[100:103], v[16:19], a[144:147], v[100:103]
    ds_read_b128 v[8:11], v4 offset:24576
    v_mfma_f32_16x16x32_bf16 v[108:111], v[16:19], a[148:151], v[108:111]
    v_mfma_f32_16x16x32_bf16 v[116:119], v[16:19], a[152:155], v[116:119]
    v_mfma_f32_16x16x32_bf16 v[124:127], v[16:19], a[156:159], v[124:127]
    s_waitcnt lgkmcnt(3)
    s_lshl_b32 s71, s44, 2
    s_add_u32 s71, s71, s20
    v_mfma_f32_16x16x32_bf16 v[96:99], v[20:23], a[160:163], v[96:99]
    s_lshl_b32 s71, s71, 5
    s_add_u32 s71, s71, s47
    ds_read_b128 v[12:15], v4 offset:25600
    v_mfma_f32_16x16x32_bf16 v[104:107], v[20:23], a[164:167], v[104:107]
    s_lshl_b32 s71, s71, 3
    s_add_u32 s71, s71, s101
    s_add_u32 s71, s71, 155648
    v_mfma_f32_16x16x32_bf16 v[112:115], v[20:23], a[168:171], v[112:115]
    v_mfma_f32_16x16x32_bf16 v[120:123], v[20:23], a[172:175], v[120:123]
    s_waitcnt lgkmcnt(3)
    v_mfma_f32_16x16x32_bf16 v[100:103], v[24:27], a[160:163], v[100:103]
    ds_read_b128 v[16:19], v4 offset:26624
    v_mfma_f32_16x16x32_bf16 v[108:111], v[24:27], a[164:167], v[108:111]
    v_mfma_f32_16x16x32_bf16 v[116:119], v[24:27], a[168:171], v[116:119]
    v_mfma_f32_16x16x32_bf16 v[124:127], v[24:27], a[172:175], v[124:127]
    s_waitcnt lgkmcnt(3)
    v_mfma_f32_16x16x32_bf16 v[96:99], v[28:31], a[176:179], v[96:99]
    ds_read_b128 v[20:23], v4 offset:27648
    v_mfma_f32_16x16x32_bf16 v[104:107], v[28:31], a[180:183], v[104:107]
    v_mov_b32 v6, s98
    v_mov_b32 v7, s99
    v_mfma_f32_16x16x32_bf16 v[112:115], v[28:31], a[184:187], v[112:115]
    v_mfma_f32_16x16x32_bf16 v[120:123], v[28:31], a[188:191], v[120:123]
    s_waitcnt lgkmcnt(3)
    s_waitcnt vmcnt(0)
    v_mfma_f32_16x16x32_bf16 v[100:103], v[8:11], a[176:179], v[100:103]
    ds_read_b128 v[24:27], v4 offset:28672
    v_mfma_f32_16x16x32_bf16 v[108:111], v[8:11], a[180:183], v[108:111]
    s_lshl_b32 s71, s71, 2
    s_add_u32 s71, s71, 0x8000000
    s_mov_b64 exec, 1
    buffer_store_dwordx2 v[6:7], off, s[4:7], s71 sc1
    s_mov_b64 exec, -1
    v_mfma_f32_16x16x32_bf16 v[116:119], v[8:11], a[184:187], v[116:119]
    v_mfma_f32_16x16x32_bf16 v[124:127], v[8:11], a[188:191], v[124:127]
    s_waitcnt lgkmcnt(3)
    v_mfma_f32_16x16x32_bf16 v[96:99], v[12:15], a[192:195], v[96:99]
    ds_read_b128 v[28:31], v4 offset:29696
    v_mfma_f32_16x16x32_bf16 v[104:107], v[12:15], a[196:199], v[104:107]
    v_mfma_f32_16x16x32_bf16 v[112:115], v[12:15], a[200:203], v[112:115]
    v_mfma_f32_16x16x32_bf16 v[120:123], v[12:15], a[204:207], v[120:123]
    s_waitcnt lgkmcnt(3)
    s_mul_i32 s66, s59, 3
    s_sub_u32 s69, s69, s66
    v_mfma_f32_16x16x32_bf16 v[100:103], v[16:19], a[192:195], v[100:103]
    ds_read_b128 v[8:11], v4 offset:30720
    v_mfma_f32_16x16x32_bf16 v[108:111], v[16:19], a[196:199], v[108:111]
    v_mfma_f32_16x16x32_bf16 v[116:119], v[16:19], a[200:203], v[116:119]
    v_mfma_f32_16x16x32_bf16 v[124:127], v[16:19], a[204:207], v[124:127]
    s_waitcnt lgkmcnt(3)
    v_mfma_f32_16x16x32_bf16 v[128:131], v[20:23], a[64:67], v[128:131]
    ds_read_b128 v[12:15], v4 offset:31744
    v_mfma_f32_16x16x32_bf16 v[136:139], v[20:23], a[68:71], v[136:139]
    v_mfma_f32_16x16x32_bf16 v[144:147], v[20:23], a[72:75], v[144:147]
    v_mfma_f32_16x16x32_bf16 v[152:155], v[20:23], a[76:79], v[152:155]
    s_waitcnt lgkmcnt(3)
    v_cvt_pk_bf16_f32 v96, v96, v97
    v_cvt_pk_bf16_f32 v97, v98, v99
    v_mfma_f32_16x16x32_bf16 v[132:135], v[24:27], a[64:67], v[132:135]
    ds_read_b128 v[16:19], v4 offset:32768
    v_cvt_pk_bf16_f32 v98, v100, v101
    v_mfma_f32_16x16x32_bf16 v[140:143], v[24:27], a[68:71], v[140:143]
    v_cvt_pk_bf16_f32 v99, v102, v103
    v_mfma_f32_16x16x32_bf16 v[148:151], v[24:27], a[72:75], v[148:151]
    s_add_u32 s70, s69, 2048
    v_mfma_f32_16x16x32_bf16 v[156:159], v[24:27], a[76:79], v[156:159]
    s_waitcnt lgkmcnt(3)
    v_mfma_f32_16x16x32_bf16 v[128:131], v[28:31], a[80:83], v[128:131]
    ds_read_b128 v[20:23], v4 offset:33792
    v_mfma_f32_16x16x32_bf16 v[136:139], v[28:31], a[84:87], v[136:139]
    buffer_store_dwordx4 v[96:99], v2, s[4:7], s70 offen sc1
    v_mfma_f32_16x16x32_bf16 v[144:147], v[28:31], a[88:91], v[144:147]
    v_cvt_pk_bf16_f32 v104, v104, v105
    v_cvt_pk_bf16_f32 v105, v106, v107
    v_mfma_f32_16x16x32_bf16 v[152:155], v[28:31], a[92:95], v[152:155]
    s_waitcnt lgkmcnt(3)
    v_cvt_pk_bf16_f32 v106, v108, v109
    v_cvt_pk_bf16_f32 v107, v110, v111
    v_mfma_f32_16x16x32_bf16 v[132:135], v[8:11], a[80:83], v[132:135]
    s_add_u32 s70, s69, 20480
    ds_read_b128 v[24:27], v4 offset:34816
    v_mfma_f32_16x16x32_bf16 v[140:143], v[8:11], a[84:87], v[140:143]
    buffer_store_dwordx4 v[104:107], v2, s[4:7], s70 offen sc1
    v_mfma_f32_16x16x32_bf16 v[148:151], v[8:11], a[88:91], v[148:151]
    v_cvt_pk_bf16_f32 v112, v112, v113
    v_cvt_pk_bf16_f32 v113, v114, v115
    v_mfma_f32_16x16x32_bf16 v[156:159], v[8:11], a[92:95], v[156:159]
    s_waitcnt lgkmcnt(3)
    v_cvt_pk_bf16_f32 v114, v116, v117
    v_cvt_pk_bf16_f32 v115, v118, v119
    v_mfma_f32_16x16x32_bf16 v[128:131], v[12:15], a[96:99], v[128:131]
    s_add_u32 s70, s69, 38912
    ds_read_b128 v[28:31], v4 offset:35840
    v_mfma_f32_16x16x32_bf16 v[136:139], v[12:15], a[100:103], v[136:139]
    buffer_store_dwordx4 v[112:115], v2, s[4:7], s70 offen sc1
    v_mfma_f32_16x16x32_bf16 v[144:147], v[12:15], a[104:107], v[144:147]
    v_cvt_pk_bf16_f32 v120, v120, v121
    v_cvt_pk_bf16_f32 v121, v122, v123
    v_mfma_f32_16x16x32_bf16 v[152:155], v[12:15], a[108:111], v[152:155]
    s_waitcnt lgkmcnt(3)
    v_cvt_pk_bf16_f32 v122, v124, v125
    v_cvt_pk_bf16_f32 v123, v126, v127
    v_mfma_f32_16x16x32_bf16 v[132:135], v[16:19], a[96:99], v[132:135]
    s_barrier
    v_add_u32 v4, 0x9000, v4
    v_mfma_f32_16x16x32_bf16 v[140:143], v[16:19], a[100:103], v[140:143]
    s_add_u32 s70, s69, 57344
    s_add_u32 s61, s49, 92160
    ds_read_b128 v[8:11], v4 offset:0
    v_mfma_f32_16x16x32_bf16 v[148:151], v[16:19], a[104:107], v[148:151]
    buffer_store_dwordx4 v[120:123], v2, s[4:7], s70 offen sc1
    v_mfma_f32_16x16x32_bf16 v[156:159], v[16:19], a[108:111], v[156:159]
    s_waitcnt lgkmcnt(3)
    s_add_u32 m0, s61, 18432
    s_add_u32 s61, s61, s62
    v_mfma_f32_16x16x32_bf16 v[128:131], v[20:23], a[112:115], v[128:131]
    ds_read_b128 v[12:15], v4 offset:1024
    v_mfma_f32_16x16x32_bf16 v[136:139], v[20:23], a[116:119], v[136:139]
    v_mfma_f32_16x16x32_bf16 v[144:147], v[20:23], a[120:123], v[144:147]
    buffer_load_dwordx4 v2, s[4:7], s61 offen offset:0 lds
    v_mfma_f32_16x16x32_bf16 v[152:155], v[20:23], a[124:127], v[152:155]
    s_waitcnt lgkmcnt(3)
    v_mfma_f32_16x16x32_bf16 v[132:135], v[24:27], a[112:115], v[132:135]
    ds_read_b128 v[16:19], v4 offset:2048
    v_mfma_f32_16x16x32_bf16 v[140:143], v[24:27], a[116:119], v[140:143]
    v_mfma_f32_16x16x32_bf16 v[148:151], v[24:27], a[120:123], v[148:151]
    buffer_load_dwordx4 v2, s[4:7], s61 offen offset:1024 lds
    v_mfma_f32_16x16x32_bf16 v[156:159], v[24:27], a[124:127], v[156:159]
    s_waitcnt lgkmcnt(3)
    v_mfma_f32_16x16x32_bf16 v[128:131], v[28:31], a[128:131], v[128:131]
    ds_read_b128 v[20:23], v4 offset:3072
    v_mfma_f32_16x16x32_bf16 v[136:139], v[28:31], a[132:135], v[136:139]
    v_mfma_f32_16x16x32_bf16 v[144:147], v[28:31], a[136:139], v[144:147]
    buffer_load_dwordx4 v2, s[4:7], s61 offen offset:2048 lds
    v_mfma_f32_16x16x32_bf16 v[152:155], v[28:31], a[140:143], v[152:155]
    s_waitcnt lgkmcnt(3)
    v_mfma_f32_16x16x32_bf16 v[132:135], v[8:11], a[128:131], v[132:135]
    ds_read_b128 v[24:27], v4 offset:4096
    v_mfma_f32_16x16x32_bf16 v[140:143], v[8:11], a[132:135], v[140:143]
    v_mfma_f32_16x16x32_bf16 v[148:151], v[8:11], a[136:139], v[148:151]
    buffer_load_dwordx4 v2, s[4:7], s61 offen offset:3072 lds
    v_mfma_f32_16x16x32_bf16 v[156:159], v[8:11], a[140:143], v[156:159]
    s_waitcnt lgkmcnt(3)
    s_add_u32 s61, s49, 96256
    s_add_u32 m0, s61, 18432
    v_mfma_f32_16x16x32_bf16 v[128:131], v[12:15], a[144:147], v[128:131]
    s_add_u32 s61, s61, s62
    ds_read_b128 v[28:31], v4 offset:5120
    v_mfma_f32_16x16x32_bf16 v[136:139], v[12:15], a[148:151], v[136:139]
    v_mfma_f32_16x16x32_bf16 v[144:147], v[12:15], a[152:155], v[144:147]
    buffer_load_dwordx4 v2, s[4:7], s61 offen offset:0 lds
    v_mfma_f32_16x16x32_bf16 v[152:155], v[12:15], a[156:159], v[152:155]
    s_waitcnt lgkmcnt(3)
    v_mfma_f32_16x16x32_bf16 v[132:135], v[16:19], a[144:147], v[132:135]
    ds_read_b128 v[8:11], v4 offset:6144
    v_mfma_f32_16x16x32_bf16 v[140:143], v[16:19], a[148:151], v[140:143]
    v_mfma_f32_16x16x32_bf16 v[148:151], v[16:19], a[152:155], v[148:151]
    buffer_load_dwordx4 v2, s[4:7], s61 offen offset:1024 lds
    v_mfma_f32_16x16x32_bf16 v[156:159], v[16:19], a[156:159], v[156:159]
    s_waitcnt lgkmcnt(3)
    v_mfma_f32_16x16x32_bf16 v[128:131], v[20:23], a[160:163], v[128:131]
    ds_read_b128 v[12:15], v4 offset:7168
    v_mfma_f32_16x16x32_bf16 v[136:139], v[20:23], a[164:167], v[136:139]
    v_mfma_f32_16x16x32_bf16 v[144:147], v[20:23], a[168:171], v[144:147]
    buffer_load_dwordx4 v2, s[4:7], s61 offen offset:2048 lds
    v_mfma_f32_16x16x32_bf16 v[152:155], v[20:23], a[172:175], v[152:155]
    s_waitcnt lgkmcnt(3)
    v_mfma_f32_16x16x32_bf16 v[132:135], v[24:27], a[160:163], v[132:135]
    ds_read_b128 v[16:19], v4 offset:8192
    v_mfma_f32_16x16x32_bf16 v[140:143], v[24:27], a[164:167], v[140:143]
    v_mfma_f32_16x16x32_bf16 v[148:151], v[24:27], a[168:171], v[148:151]
    buffer_load_dwordx4 v2, s[4:7], s61 offen offset:3072 lds
    v_mfma_f32_16x16x32_bf16 v[156:159], v[24:27], a[172:175], v[156:159]
    s_waitcnt lgkmcnt(3)
    s_add_u32 s61, s49, 100352
    s_add_u32 m0, s61, 18432
    v_mfma_f32_16x16x32_bf16 v[128:131], v[28:31], a[176:179], v[128:131]
    s_add_u32 s61, s61, s62
    ds_read_b128 v[20:23], v4 offset:9216
    v_mfma_f32_16x16x32_bf16 v[136:139], v[28:31], a[180:183], v[136:139]
    v_mfma_f32_16x16x32_bf16 v[144:147], v[28:31], a[184:187], v[144:147]
    buffer_load_dwordx4 v2, s[4:7], s61 offen offset:0 lds
    v_mfma_f32_16x16x32_bf16 v[152:155], v[28:31], a[188:191], v[152:155]
    s_waitcnt lgkmcnt(3)
    v_mfma_f32_16x16x32_bf16 v[132:135], v[8:11], a[176:179], v[132:135]
    ds_read_b128 v[24:27], v4 offset:10240
    v_mfma_f32_16x16x32_bf16 v[140:143], v[8:11], a[180:183], v[140:143]
    v_mfma_f32_16x16x32_bf16 v[148:151], v[8:11], a[184:187], v[148:151]
    v_mfma_f32_16x16x32_bf16 v[156:159], v[8:11], a[188:191], v[156:159]
    s_waitcnt lgkmcnt(3)
    v_mfma_f32_16x16x32_bf16 v[128:131], v[12:15], a[192:195], v[128:131]
    ds_read_b128 v[28:31], v4 offset:11264
    v_mfma_f32_16x16x32_bf16 v[136:139], v[12:15], a[196:199], v[136:139]
    v_mfma_f32_16x16x32_bf16 v[144:147], v[12:15], a[200:203], v[144:147]
    v_mfma_f32_16x16x32_bf16 v[152:155], v[12:15], a[204:207], v[152:155]
    s_waitcnt lgkmcnt(3)
    s_lshl_b32 s66, s59, 1
    s_add_u32 s69, s69, s66
    v_mfma_f32_16x16x32_bf16 v[132:135], v[16:19], a[192:195], v[132:135]
    ds_read_b128 v[8:11], v4 offset:12288
    v_mfma_f32_16x16x32_bf16 v[140:143], v[16:19], a[196:199], v[140:143]
    v_mfma_f32_16x16x32_bf16 v[148:151], v[16:19], a[200:203], v[148:151]
    v_mfma_f32_16x16x32_bf16 v[156:159], v[16:19], a[204:207], v[156:159]
    s_waitcnt lgkmcnt(3)
    v_mfma_f32_16x16x32_bf16 v[160:163], v[20:23], a[64:67], v[160:163]
    ds_read_b128 v[12:15], v4 offset:13312
    v_mfma_f32_16x16x32_bf16 v[164:167], v[20:23], a[68:71], v[164:167]
    v_mfma_f32_16x16x32_bf16 v[168:171], v[20:23], a[72:75], v[168:171]
    v_mfma_f32_16x16x32_bf16 v[172:175], v[20:23], a[76:79], v[172:175]
    s_waitcnt lgkmcnt(3)
    v_cvt_pk_bf16_f32 v128, v128, v129
    v_cvt_pk_bf16_f32 v129, v130, v131
    v_mfma_f32_16x16x32_bf16 v[160:163], v[24:27], a[80:83], v[160:163]
    ds_read_b128 v[16:19], v4 offset:14336
    v_cvt_pk_bf16_f32 v130, v132, v133
    v_mfma_f32_16x16x32_bf16 v[164:167], v[24:27], a[84:87], v[164:167]
    v_cvt_pk_bf16_f32 v131, v134, v135
    v_mfma_f32_16x16x32_bf16 v[168:171], v[24:27], a[88:91], v[168:171]
    s_add_u32 s70, s69, 3072
    v_mfma_f32_16x16x32_bf16 v[172:175], v[24:27], a[92:95], v[172:175]
    s_waitcnt lgkmcnt(3)
    v_mfma_f32_16x16x32_bf16 v[160:163], v[28:31], a[96:99], v[160:163]
    ds_read_b128 v[20:23], v4 offset:15360
    v_mfma_f32_16x16x32_bf16 v[164:167], v[28:31], a[100:103], v[164:167]
    buffer_store_dwordx4 v[128:131], v2, s[4:7], s70 offen sc1
    v_mfma_f32_16x16x32_bf16 v[168:171], v[28:31], a[104:107], v[168:171]
    v_cvt_pk_bf16_f32 v136, v136, v137
    v_cvt_pk_bf16_f32 v137, v138, v139
    v_mfma_f32_16x16x32_bf16 v[172:175], v[28:31], a[108:111], v[172:175]
    s_waitcnt lgkmcnt(3)
    v_cvt_pk_bf16_f32 v138, v140, v141
    v_cvt_pk_bf16_f32 v139, v142, v143
    v_mfma_f32_16x16x32_bf16 v[160:163], v[8:11], a[112:115], v[160:163]
    s_add_u32 s70, s69, 21504
    ds_read_b128 v[24:27], v4 offset:16384
    v_mfma_f32_16x16x32_bf16 v[164:167], v[8:11], a[116:119], v[164:167]
    buffer_store_dwordx4 v[136:139], v2, s[4:7], s70 offen sc1
    v_mfma_f32_16x16x32_bf16 v[168:171], v[8:11], a[120:123], v[168:171]
    v_cvt_pk_bf16_f32 v144, v144, v145
    v_cvt_pk_bf16_f32 v145, v146, v147
    v_mfma_f32_16x16x32_bf16 v[172:175], v[8:11], a[124:127], v[172:175]
    s_waitcnt lgkmcnt(3)
    v_cvt_pk_bf16_f32 v146, v148, v149
    v_cvt_pk_bf16_f32 v147, v150, v151
    v_mfma_f32_16x16x32_bf16 v[160:163], v[12:15], a[128:131], v[160:163]
    s_add_u32 s70, s69, 39936
    ds_read_b128 v[28:31], v4 offset:17408
    v_mfma_f32_16x16x32_bf16 v[164:167], v[12:15], a[132:135], v[164:167]
    buffer_store_dwordx4 v[144:147], v2, s[4:7], s70 offen sc1
    v_mfma_f32_16x16x32_bf16 v[168:171], v[12:15], a[136:139], v[168:171]
    v_cvt_pk_bf16_f32 v152, v152, v153
    v_cvt_pk_bf16_f32 v153, v154, v155
    v_mfma_f32_16x16x32_bf16 v[172:175], v[12:15], a[140:143], v[172:175]
    s_waitcnt lgkmcnt(3)
    v_cvt_pk_bf16_f32 v154, v156, v157
    v_cvt_pk_bf16_f32 v155, v158, v159
    v_mfma_f32_16x16x32_bf16 v[160:163], v[16:19], a[144:147], v[160:163]
    s_add_u32 s70, s69, 58368
    v_mfma_f32_16x16x32_bf16 v[164:167], v[16:19], a[148:151], v[164:167]
    buffer_store_dwordx4 v[152:155], v2, s[4:7], s70 offen sc1
    v_mfma_f32_16x16x32_bf16 v[168:171], v[16:19], a[152:155], v[168:171]
    v_mfma_f32_16x16x32_bf16 v[172:175], v[16:19], a[156:159], v[172:175]
    s_waitcnt lgkmcnt(2)
    v_mfma_f32_16x16x32_bf16 v[160:163], v[20:23], a[160:163], v[160:163]
    v_mfma_f32_16x16x32_bf16 v[164:167], v[20:23], a[164:167], v[164:167]
    v_mfma_f32_16x16x32_bf16 v[168:171], v[20:23], a[168:171], v[168:171]
    v_mfma_f32_16x16x32_bf16 v[172:175], v[20:23], a[172:175], v[172:175]
    s_waitcnt lgkmcnt(1)
    v_mfma_f32_16x16x32_bf16 v[160:163], v[24:27], a[176:179], v[160:163]
    v_mfma_f32_16x16x32_bf16 v[164:167], v[24:27], a[180:183], v[164:167]
    v_mfma_f32_16x16x32_bf16 v[168:171], v[24:27], a[184:187], v[168:171]
    v_mfma_f32_16x16x32_bf16 v[172:175], v[24:27], a[188:191], v[172:175]
    s_waitcnt lgkmcnt(0)
    v_mfma_f32_16x16x32_bf16 v[160:163], v[28:31], a[192:195], v[160:163]
    v_mfma_f32_16x16x32_bf16 v[164:167], v[28:31], a[196:199], v[164:167]
    v_mfma_f32_16x16x32_bf16 v[168:171], v[28:31], a[200:203], v[168:171]
    v_mfma_f32_16x16x32_bf16 v[172:175], v[28:31], a[204:207], v[172:175]
    s_nop 4
    v_cvt_pk_bf16_f32 v160, v160, v161
    v_cvt_pk_bf16_f32 v161, v162, v163
    s_add_u32 s70, s68, 4096
    buffer_store_dwordx2 v[160:161], v0, s[4:7], s70 offen sc1
    v_cvt_pk_bf16_f32 v164, v164, v165
    v_cvt_pk_bf16_f32 v165, v166, v167
    s_add_u32 s70, s68, 22528
    buffer_store_dwordx2 v[164:165], v0, s[4:7], s70 offen sc1
    v_cvt_pk_bf16_f32 v168, v168, v169
    v_cvt_pk_bf16_f32 v169, v170, v171
    s_add_u32 s70, s68, 40960
    buffer_store_dwordx2 v[168:169], v0, s[4:7], s70 offen sc1
    v_cvt_pk_bf16_f32 v172, v172, v173
    v_cvt_pk_bf16_f32 v173, v174, v175
    s_add_u32 s70, s68, 59392
    buffer_store_dwordx2 v[172:173], v0, s[4:7], s70 offen sc1
    s_lshl_b32 s60, s44, 2
    s_add_u32 s60, s60, s20
    s_lshl_b32 s60, s60, 5
    s_add_u32 s60, s60, s47
    s_lshl_b32 s60, s60, 3
    s_add_u32 s60, s60, s101
    s_add_u32 s60, s60, 114688
    v_mov_b32 v6, s98
    v_mov_b32 v7, s99
    s_waitcnt vmcnt(0)
    s_lshl_b32 s60, s60, 2
    s_add_u32 s60, s60, 0x8000000
    s_mov_b64 exec, 1
    buffer_store_dwordx2 v[6:7], off, s[4:7], s60 sc1
    s_mov_b64 exec, -1
    s_cmp_lg_u32 s101, 0
    s_cbranch_scc1 L_red1_51
    s_barrier
    s_lshl_b32 s47, s21, 5
    s_add_u32 s47, s47, s22
    v_and_b32 v8, 7, v1
    v_lshrrev_b32 v9, 3, v1
    s_lshl_b32 s48, s47, 3
    v_add_u32 v3, s48, v8
    v_mul_u32_u24 v3, 1152, v3
    s_mul_i32 s48, s20, 0
    v_lshl_add_u32 v3, v9, 4, v3
    v_add_u32 v3, s48, v3
    s_lshr_b32 s48, s47, 1
    s_mul_i32 s48, s48, 18432
    s_and_b32 s49, s47, 1
    s_lshl_b32 s49, s49, 7
    s_add_u32 s48, s48, s49
    s_mul_i32 s49, s20, 0
    s_add_u32 s48, s48, s49
    v_lshlrev_b32 v8, 4, v8
    v_lshl_add_u32 v8, v9, 8, v8
    v_add_u32 v4, s48, v8
    s_lshl_b32 s48, s20, 2
    s_lshr_b32 s50, 0x530, s48
    s_and_b32 s50, s50, 15
    s_lshl_b32 s53, s50, 11
    s_lshr_b32 s51, 0x217, s48
    s_and_b32 s51, s51, 15
    s_lshl_b32 s54, s51, 11
    s_lshr_b32 s52, 0x864, s48
    s_and_b32 s52, s52, 15
    s_lshl_b32 s55, s52, 11
    v_lshrrev_b32 v8, 3, v1
    v_and_b32 v9, 7, v1
    s_and_b32 s48, s47, 1
    s_lshl_b32 s48, s48, 3
    v_add_u32 v9, s48, v9
    v_lshlrev_b32 v9, 4, v9
    v_bfe_u32 v10, v8, 1, 1
    v_and_b32 v11, 1, v8
    v_lshl_add_u32 v9, v11, 4, v9
    v_lshl_add_u32 v9, v10, 9, v9
    v_and_b32 v10, 3, v8
    v_lshlrev_b32 v10, 8, v10
    v_sub_u32 v9, v9, v10
    v_lshrrev_b32 v8, 2, v8
    s_lshl_b32 s48, s50, 1
    v_add_u32 v10, s48, v8
    v_cmp_eq_u32 vcc, 4, v10
    v_cmp_eq_u32 s[56:57], 13, v10
    s_nop 0
    s_or_b64 vcc, vcc, s[56:57]
    v_cndmask_b32 v10, 0, v9, vcc
    v_add3_u32 v5, v4, v10, s53
    s_lshl_b32 s50, s50, 7
    s_lshl_b32 s48, s51, 1
    v_add_u32 v10, s48, v8
    v_cmp_eq_u32 vcc, 4, v10
    v_cmp_eq_u32 s[56:57], 13, v10
    s_nop 0
    s_or_b64 vcc, vcc, s[56:57]
    v_cndmask_b32 v10, 0, v9, vcc
    v_add3_u32 v6, v4, v10, s54
    s_lshl_b32 s51, s51, 7
    s_lshl_b32 s48, s52, 1
    v_add_u32 v10, s48, v8
    v_cmp_eq_u32 vcc, 4, v10
    v_cmp_eq_u32 s[56:57], 13, v10
    s_nop 0
    s_or_b64 vcc, vcc, s[56:57]
    v_cndmask_b32 v10, 0, v9, vcc
    v_add3_u32 v7, v4, v10, s55
    s_lshl_b32 s52, s52, 7
    s_cmp_eq_u32 s20, 3
    s_cbranch_scc1 L_w3a_96
    s_add_u32 s48, s53, 25690112
    buffer_load_dwordx4 v[16:19], v4, s[4:7], s48 offen sc1
    s_add_u32 s48, s54, 25690112
    buffer_load_dwordx4 v[52:55], v4, s[4:7], s48 offen sc1
    s_add_u32 s48, s55, 25690112
    buffer_load_dwordx4 v[88:91], v4, s[4:7], s48 offen sc1
    s_lshr_b32 s49, s47, 3
    s_lshl_b32 s49, s49, 8
    s_add_u32 s58, s49, 155648
    s_add_u32 s49, s49, 114688
    v_and_b32 v10, 31, v1
    v_lshlrev_b32 v10, 3, v10
    s_lshl_b32 s58, s58, 2
    s_add_u32 s58, s58, 0x8000000
    v_lshlrev_b32 v10, 2, v10
    buffer_load_dwordx2 v[176:177], v10, s[4:7], s58 offen sc1
    s_waitcnt vmcnt(0)
    v_cmp_eq_u64 vcc, s[98:99], v[176:177]
    s_nop 0
    s_cmp_eq_u64 vcc, exec
    s_cbranch_scc0 L_pa_slow_97
L_pa_back_98:
    s_mov_b32 s48, 50331648
    buffer_load_dwordx4 v[20:23], v5, s[4:7], s48 offen sc1
    s_mov_b32 s48, 52690944
    buffer_load_dwordx4 v[24:27], v5, s[4:7], s48 offen sc1
    s_mov_b32 s48, 55050240
    buffer_load_dwordx4 v[28:31], v5, s[4:7], s48 offen sc1
    s_mov_b32 s48, 57409536
    buffer_load_dwordx4 v[32:35], v5, s[4:7], s48 offen sc1
    s_mov_b32 s48, 59768832
    buffer_load_dwordx4 v[36:39], v5, s[4:7], s48 offen sc1
    s_mov_b32 s48, 62128128
    buffer_load_dwordx4 v[40:43], v5, s[4:7], s48 offen sc1
    s_mov_b32 s48, 64487424
    buffer_load_dwordx4 v[44:47], v5, s[4:7], s48 offen sc1
    s_mov_b32 s48, 66846720
    buffer_load_dwordx4 v[48:51], v5, s[4:7], s48 offen sc1
    s_lshl_b32 s49, s49, 2
    s_add_u32 s49, s49, 0x8000000
    buffer_load_dwordx2 v[176:177], v10, s[4:7], s49 offen sc1
    s_waitcnt vmcnt(0)
    v_cmp_eq_u64 vcc, s[98:99], v[176:177]
    s_nop 0
    s_cmp_eq_u64 vcc, exec
    s_cbranch_scc0 L_pp_slow_100
L_pp_back_101:
    s_mov_b32 s48, 50331648
    buffer_load_dwordx4 v[56:59], v6, s[4:7], s48 offen sc1
    buffer_load_dwordx4 v[92:95], v7, s[4:7], s48 offen sc1
    s_mov_b32 s48, 52690944
    buffer_load_dwordx4 v[60:63], v6, s[4:7], s48 offen sc1
    buffer_load_dwordx4 v[96:99], v7, s[4:7], s48 offen sc1
    s_mov_b32 s48, 55050240
    buffer_load_dwordx4 v[64:67], v6, s[4:7], s48 offen sc1
    buffer_load_dwordx4 v[100:103], v7, s[4:7], s48 offen sc1
    s_mov_b32 s48, 57409536
    buffer_load_dwordx4 v[68:71], v6, s[4:7], s48 offen sc1
    buffer_load_dwordx4 v[104:107], v7, s[4:7], s48 offen sc1
    s_mov_b32 s48, 59768832
    buffer_load_dwordx4 v[72:75], v6, s[4:7], s48 offen sc1
    buffer_load_dwordx4 v[108:111], v7, s[4:7], s48 offen sc1
    s_mov_b32 s48, 62128128
    buffer_load_dwordx4 v[76:79], v6, s[4:7], s48 offen sc1
    buffer_load_dwordx4 v[112:115], v7, s[4:7], s48 offen sc1
    s_mov_b32 s48, 64487424
    buffer_load_dwordx4 v[80:83], v6, s[4:7], s48 offen sc1
    buffer_load_dwordx4 v[116:119], v7, s[4:7], s48 offen sc1
    s_mov_b32 s48, 66846720
    buffer_load_dwordx4 v[84:87], v6, s[4:7], s48 offen sc1
    buffer_load_dwordx4 v[120:123], v7, s[4:7], s48 offen sc1
    v_lshlrev_b32 v128, 16, v16
    v_and_b32 v129, 0xffff0000, v16
    v_lshlrev_b32 v130, 16, v17
    v_and_b32 v131, 0xffff0000, v17
    v_lshlrev_b32 v132, 16, v18
    v_and_b32 v133, 0xffff0000, v18
    v_lshlrev_b32 v134, 16, v19
    v_and_b32 v135, 0xffff0000, v19
    v_lshlrev_b32 v136, 16, v52
    v_and_b32 v137, 0xffff0000, v52
    v_lshlrev_b32 v138, 16, v53
    v_and_b32 v139, 0xffff0000, v53
    v_lshlrev_b32 v140, 16, v54
    v_and_b32 v141, 0xffff0000, v54
    v_lshlrev_b32 v142, 16, v55
    v_and_b32 v143, 0xffff0000, v55
    v_lshlrev_b32 v144, 16, v88
    v_and_b32 v145, 0xffff0000, v88
    v_lshlrev_b32 v146, 16, v89
    v_and_b32 v147, 0xffff0000, v89
    v_lshlrev_b32 v148, 16, v90
    v_and_b32 v149, 0xffff0000, v90
    v_lshlrev_b32 v150, 16, v91
    v_and_b32 v151, 0xffff0000, v91
    v_mov_b32 v12, 0x3f80
    v_mov_b32 v13, 0x3f800000
    v_dot2c_f32_bf16 v128, v20, v12
    v_dot2c_f32_bf16 v129, v20, v13
    v_dot2c_f32_bf16 v130, v21, v12
    v_dot2c_f32_bf16 v131, v21, v13
    v_dot2c_f32_bf16 v132, v22, v12
    v_dot2c_f32_bf16 v133, v22, v13
    v_dot2c_f32_bf16 v134, v23, v12
    v_dot2c_f32_bf16 v135, v23, v13
    v_dot2c_f32_bf16 v128, v24, v12
    v_dot2c_f32_bf16 v129, v24, v13
    v_dot2c_f32_bf16 v130, v25, v12
    v_dot2c_f32_bf16 v131, v25, v13
    v_dot2c_f32_bf16 v132, v26, v12
    v_dot2c_f32_bf16 v133, v26, v13
    v_dot2c_f32_bf16 v134, v27, v12
    v_dot2c_f32_bf16 v135, v27, v13
    v_dot2c_f32_bf16 v128, v28, v12
    v_dot2c_f32_bf16 v129, v28, v13
    v_dot2c_f32_bf16 v130, v29, v12
    v_dot2c_f32_bf16 v131, v29, v13
    v_dot2c_f32_bf16 v132, v30, v12
    v_dot2c_f32_bf16 v133, v30, v13
    v_dot2c_f32_bf16 v134, v31, v12
    v_dot2c_f32_bf16 v135, v31, v13
    v_dot2c_f32_bf16 v128, v32, v12
    v_dot2c_f32_bf16 v129, v32, v13
    v_dot2c_f32_bf16 v130, v33, v12
    v_dot2c_f32_bf16 v131, v33, v13
    v_dot2c_f32_bf16 v132, v34, v12
    v_dot2c_f32_bf16 v133, v34, v13
    v_dot2c_f32_bf16 v134, v35, v12
    v_dot2c_f32_bf16 v135, v35, v13
    v_dot2c_f32_bf16 v128, v36, v12
    v_dot2c_f32_bf16 v129, v36, v13
    v_dot2c_f32_bf16 v130, v37, v12
    v_dot2c_f32_bf16 v131, v37, v13
    v_dot2c_f32_bf16 v132, v38, v12
    v_dot2c_f32_bf16 v133, v38, v13
    v_dot2c_f32_bf16 v134, v39, v12
    v_dot2c_f32_bf16 v135, v39, v13
    v_dot2c_f32_bf16 v128, v40, v12
    v_dot2c_f32_bf16 v129, v40, v13
    v_dot2c_f32_bf16 v130, v41, v12
    v_dot2c_f32_bf16 v131, v41, v13
    v_dot2c_f32_bf16 v132, v42, v12
    v_dot2c_f32_bf16 v133, v42, v13
    v_dot2c_f32_bf16 v134, v43, v12
    v_dot2c_f32_bf16 v135, v43, v13
    v_dot2c_f32_bf16 v128, v44, v12
    v_dot2c_f32_bf16 v129, v44, v13
    v_dot2c_f32_bf16 v130, v45, v12
    v_dot2c_f32_bf16 v131, v45, v13
    v_dot2c_f32_bf16 v132, v46, v12
    v_dot2c_f32_bf16 v133, v46, v13
    v_dot2c_f32_bf16 v134, v47, v12
    v_dot2c_f32_bf16 v135, v47, v13
    v_dot2c_f32_bf16 v128, v48, v12
    v_dot2c_f32_bf16 v129, v48, v13
    v_dot2c_f32_bf16 v130, v49, v12
    v_dot2c_f32_bf16 v131, v49, v13
    v_dot2c_f32_bf16 v132, v50, v12
    v_dot2c_f32_bf16 v133, v50, v13
    v_dot2c_f32_bf16 v134, v51, v12
    v_dot2c_f32_bf16 v135, v51, v13
    s_waitcnt vmcnt(15)
    v_dot2c_f32_bf16 v136, v56, v12
    v_dot2c_f32_bf16 v137, v56, v13
    v_dot2c_f32_bf16 v138, v57, v12
    v_dot2c_f32_bf16 v139, v57, v13
    v_dot2c_f32_bf16 v140, v58, v12
    v_dot2c_f32_bf16 v141, v58, v13
    v_dot2c_f32_bf16 v142, v59, v12
    v_dot2c_f32_bf16 v143, v59, v13
    s_waitcnt vmcnt(14)
    v_dot2c_f32_bf16 v144, v92, v12
    v_dot2c_f32_bf16 v145, v92, v13
    v_dot2c_f32_bf16 v146, v93, v12
    v_dot2c_f32_bf16 v147, v93, v13
    v_dot2c_f32_bf16 v148, v94, v12
    v_dot2c_f32_bf16 v149, v94, v13
    v_dot2c_f32_bf16 v150, v95, v12
    v_dot2c_f32_bf16 v151, v95, v13
    s_waitcnt vmcnt(13)
    v_dot2c_f32_bf16 v136, v60, v12
    v_dot2c_f32_bf16 v137, v60, v13
    v_dot2c_f32_bf16 v138, v61, v12
    v_dot2c_f32_bf16 v139, v61, v13
    v_dot2c_f32_bf16 v140, v62, v12
    v_dot2c_f32_bf16 v141, v62, v13
    v_dot2c_f32_bf16 v142, v63, v12
    v_dot2c_f32_bf16 v143, v63, v13
    s_waitcnt vmcnt(12)
    v_dot2c_f32_bf16 v144, v96, v12
    v_dot2c_f32_bf16 v145, v96, v13
    v_dot2c_f32_bf16 v146, v97, v12
    v_dot2c_f32_bf16 v147, v97, v13
    v_dot2c_f32_bf16 v148, v98, v12
    v_dot2c_f32_bf16 v149, v98, v13
    v_dot2c_f32_bf16 v150, v99, v12
    v_dot2c_f32_bf16 v151, v99, v13
    s_waitcnt vmcnt(11)
    v_dot2c_f32_bf16 v136, v64, v12
    v_dot2c_f32_bf16 v137, v64, v13
    v_dot2c_f32_bf16 v138, v65, v12
    v_dot2c_f32_bf16 v139, v65, v13
    v_dot2c_f32_bf16 v140, v66, v12
    v_dot2c_f32_bf16 v141, v66, v13
    v_dot2c_f32_bf16 v142, v67, v12
    v_dot2c_f32_bf16 v143, v67, v13
    s_waitcnt vmcnt(10)
    v_dot2c_f32_bf16 v144, v100, v12
    v_dot2c_f32_bf16 v145, v100, v13
    v_dot2c_f32_bf16 v146, v101, v12
    v_dot2c_f32_bf16 v147, v101, v13
    v_dot2c_f32_bf16 v148, v102, v12
    v_dot2c_f32_bf16 v149, v102, v13
    v_dot2c_f32_bf16 v150, v103, v12
    v_dot2c_f32_bf16 v151, v103, v13
    s_waitcnt vmcnt(9)
    v_dot2c_f32_bf16 v136, v68, v12
    v_dot2c_f32_bf16 v137, v68, v13
    v_dot2c_f32_bf16 v138, v69, v12
    v_dot2c_f32_bf16 v139, v69, v13
    v_dot2c_f32_bf16 v140, v70, v12
    v_dot2c_f32_bf16 v141, v70, v13
    v_dot2c_f32_bf16 v142, v71, v12
    v_dot2c_f32_bf16 v143, v71, v13
    s_waitcnt vmcnt(8)
    v_dot2c_f32_bf16 v144, v104, v12
    v_dot2c_f32_bf16 v145, v104, v13
    v_dot2c_f32_bf16 v146, v105, v12
    v_dot2c_f32_bf16 v147, v105, v13
    v_dot2c_f32_bf16 v148, v106, v12
    v_dot2c_f32_bf16 v149, v106, v13
    v_dot2c_f32_bf16 v150, v107, v12
    v_dot2c_f32_bf16 v151, v107, v13
    s_waitcnt vmcnt(7)
    v_dot2c_f32_bf16 v136, v72, v12
    v_dot2c_f32_bf16 v137, v72, v13
    v_dot2c_f32_bf16 v138, v73, v12
    v_dot2c_f32_bf16 v139, v73, v13
    v_dot2c_f32_bf16 v140, v74, v12
    v_dot2c_f32_bf16 v141, v74, v13
    v_dot2c_f32_bf16 v142, v75, v12
    v_dot2c_f32_bf16 v143, v75, v13
    s_waitcnt vmcnt(6)
    v_dot2c_f32_bf16 v144, v108, v12
    v_dot2c_f32_bf16 v145, v108, v13
    v_dot2c_f32_bf16 v146, v109, v12
    v_dot2c_f32_bf16 v147, v109, v13
    v_dot2c_f32_bf16 v148, v110, v12
    v_dot2c_f32_bf16 v149, v110, v13
    v_dot2c_f32_bf16 v150, v111, v12
    v_dot2c_f32_bf16 v151, v111, v13
    s_waitcnt vmcnt(5)
    v_dot2c_f32_bf16 v136, v76, v12
    v_dot2c_f32_bf16 v137, v76, v13
    v_dot2c_f32_bf16 v138, v77, v12
    v_dot2c_f32_bf16 v139, v77, v13
    v_dot2c_f32_bf16 v140, v78, v12
    v_dot2c_f32_bf16 v141, v78, v13
    v_dot2c_f32_bf16 v142, v79, v12
    v_dot2c_f32_bf16 v143, v79, v13
    s_waitcnt vmcnt(4)
    v_dot2c_f32_bf16 v144, v112, v12
    v_dot2c_f32_bf16 v145, v112, v13
    v_dot2c_f32_bf16 v146, v113, v12
    v_dot2c_f32_bf16 v147, v113, v13
    v_dot2c_f32_bf16 v148, v114, v12
    v_dot2c_f32_bf16 v149, v114, v13
    v_dot2c_f32_bf16 v150, v115, v12
    v_dot2c_f32_bf16 v151, v115, v13
    s_waitcnt vmcnt(3)
    v_dot2c_f32_bf16 v136, v80, v12
    v_dot2c_f32_bf16 v137, v80, v13
    v_dot2c_f32_bf16 v138, v81, v12
    v_dot2c_f32_bf16 v139, v81, v13
    v_dot2c_f32_bf16 v140, v82, v12
    v_dot2c_f32_bf16 v141, v82, v13
    v_dot2c_f32_bf16 v142, v83, v12
    v_dot2c_f32_bf16 v143, v83, v13
    s_waitcnt vmcnt(2)
    v_dot2c_f32_bf16 v144, v116, v12
    v_dot2c_f32_bf16 v145, v116, v13
    v_dot2c_f32_bf16 v146, v117, v12
    v_dot2c_f32_bf16 v147, v117, v13
    v_dot2c_f32_bf16 v148, v118, v12
    v_dot2c_f32_bf16 v149, v118, v13
    v_dot2c_f32_bf16 v150, v119, v12
    v_dot2c_f32_bf16 v151, v119, v13
    s_waitcnt vmcnt(1)
    v_dot2c_f32_bf16 v136, v84, v12
    v_dot2c_f32_bf16 v137, v84, v13
    v_dot2c_f32_bf16 v138, v85, v12
    v_dot2c_f32_bf16 v139, v85, v13
    v_dot2c_f32_bf16 v140, v86, v12
    v_dot2c_f32_bf16 v141, v86, v13
    v_dot2c_f32_bf16 v142, v87, v12
    v_dot2c_f32_bf16 v143, v87, v13
    s_waitcnt vmcnt(0)
    v_dot2c_f32_bf16 v144, v120, v12
    v_dot2c_f32_bf16 v145, v120, v13
    v_dot2c_f32_bf16 v146, v121, v12
    v_dot2c_f32_bf16 v147, v121, v13
    v_dot2c_f32_bf16 v148, v122, v12
    v_dot2c_f32_bf16 v149, v122, v13
    v_dot2c_f32_bf16 v150, v123, v12
    v_dot2c_f32_bf16 v151, v123, v13
    s_add_u32 s16, s42, 28311552
    s_addc_u32 s17, s43, 0
    s_mov_b32 s18, 0x240000
    s_mov_b32 s19, 0x20000
    v_cvt_pk_bf16_f32 v160, v128, v129
    v_cvt_pk_bf16_f32 v161, v130, v131
    v_cvt_pk_bf16_f32 v162, v132, v133
    v_cvt_pk_bf16_f32 v163, v134, v135
    buffer_store_dwordx4 v[160:163], v3, s[16:19], s50 offen sc1
    v_cvt_pk_bf16_f32 v164, v136, v137
    v_cvt_pk_bf16_f32 v165, v138, v139
    v_cvt_pk_bf16_f32 v166, v140, v141
    v_cvt_pk_bf16_f32 v167, v142, v143
    buffer_store_dwordx4 v[164:167], v3, s[16:19], s51 offen sc1
    v_cvt_pk_bf16_f32 v168, v144, v145
    v_cvt_pk_bf16_f32 v169, v146, v147
    v_cvt_pk_bf16_f32 v170, v148, v149
    v_cvt_pk_bf16_f32 v171, v150, v151
    buffer_store_dwordx4 v[168:171], v3, s[16:19], s52 offen sc1
    v_lshlrev_b32 v128, 16, v160
    v_and_b32 v129, 0xffff0000, v160
    v_lshlrev_b32 v130, 16, v161
    v_and_b32 v131, 0xffff0000, v161
    v_lshlrev_b32 v132, 16, v162
    v_and_b32 v133, 0xffff0000, v162
    v_lshlrev_b32 v134, 16, v163
    v_and_b32 v135, 0xffff0000, v163
    v_lshlrev_b32 v136, 16, v164
    v_and_b32 v137, 0xffff0000, v164
    v_lshlrev_b32 v138, 16, v165
    v_and_b32 v139, 0xffff0000, v165
    v_lshlrev_b32 v140, 16, v166
    v_and_b32 v141, 0xffff0000, v166
    v_lshlrev_b32 v142, 16, v167
    v_and_b32 v143, 0xffff0000, v167
    v_lshlrev_b32 v144, 16, v168
    v_and_b32 v145, 0xffff0000, v168
    v_lshlrev_b32 v146, 16, v169
    v_and_b32 v147, 0xffff0000, v169
    v_lshlrev_b32 v148, 16, v170
    v_and_b32 v149, 0xffff0000, v170
    v_lshlrev_b32 v150, 16, v171
    v_and_b32 v151, 0xffff0000, v171
    v_add_f32 v152, v128, v129
    v_add_f32 v8, v130, v131
    v_add_f32 v152, v152, v132
    v_add_f32 v8, v8, v133
    v_add_f32 v152, v152, v134
    v_add_f32 v8, v8, v135
    v_add_f32 v152, v152, v136
    v_add_f32 v8, v8, v137
    v_add_f32 v152, v152, v138
    v_add_f32 v8, v8, v139
    v_add_f32 v152, v152, v140
    v_add_f32 v8, v8, v141
    v_add_f32 v152, v152, v142
    v_add_f32 v8, v8, v143
    v_add_f32 v152, v152, v144
    v_add_f32 v8, v8, v145
    v_add_f32 v152, v152, v146
    v_add_f32 v8, v8, v147
    v_add_f32 v152, v152, v148
    v_add_f32 v8, v8, v149
    v_add_f32 v152, v152, v150
    v_add_f32 v8, v8, v151
    v_add_f32 v152, v152, v8
    s_nop 1
    v_add_f32_dpp v152, v152, v152 row_ror:8 row_mask:0xf bank_mask:0xf
    v_mov_b32 v8, v152
    s_nop 1
    v_permlane16_swap_b32 v152, v8
    v_add_f32 v152, v152, v8
    v_mov_b32 v8, v152
    s_nop 1
    v_permlane32_swap_b32 v152, v8
    v_add_f32 v152, v152, v8
    v_mul_f32 v9, 0x3baaaaab, v152
    v_sub_f32 v8, v128, v9
    v_mul_f32 v153, v8, v8
    v_sub_f32 v11, v129, v9
    v_fmac_f32 v153, v11, v11
    v_sub_f32 v10, v130, v9
    v_fmac_f32 v153, v10, v10
    v_sub_f32 v11, v131, v9
    v_fmac_f32 v153, v11, v11
    v_sub_f32 v10, v132, v9
    v_fmac_f32 v153, v10, v10
    v_sub_f32 v11, v133, v9
    v_fmac_f32 v153, v11, v11
    v_sub_f32 v10, v134, v9
    v_fmac_f32 v153, v10, v10
    v_sub_f32 v11, v135, v9
    v_fmac_f32 v153, v11, v11
    v_sub_f32 v10, v136, v9
    v_fmac_f32 v153, v10, v10
    v_sub_f32 v11, v137, v9
    v_fmac_f32 v153, v11, v11
    v_sub_f32 v10, v138, v9
    v_fmac_f32 v153, v10, v10
    v_sub_f32 v11, v139, v9
    v_fmac_f32 v153, v11, v11
    v_sub_f32 v10, v140, v9
    v_fmac_f32 v153, v10, v10
    v_sub_f32 v11, v141, v9
    v_fmac_f32 v153, v11, v11
    v_sub_f32 v10, v142, v9
    v_fmac_f32 v153, v10, v10
    v_sub_f32 v11, v143, v9
    v_fmac_f32 v153, v11, v11
    v_sub_f32 v10, v144, v9
    v_fmac_f32 v153, v10, v10
    v_sub_f32 v11, v145, v9
    v_fmac_f32 v153, v11, v11
    v_sub_f32 v10, v146, v9
    v_fmac_f32 v153, v10, v10
    v_sub_f32 v11, v147, v9
    v_fmac_f32 v153, v11, v11
    v_sub_f32 v10, v148, v9
    v_fmac_f32 v153, v10, v10
    v_sub_f32 v11, v149, v9
    v_fmac_f32 v153, v11, v11
    v_sub_f32 v10, v150, v9
    v_fmac_f32 v153, v10, v10
    v_sub_f32 v11, v151, v9
    v_fmac_f32 v153, v11, v11
    s_nop 1
    v_add_f32_dpp v153, v153, v153 row_ror:8 row_mask:0xf bank_mask:0xf
    v_mov_b32 v8, v153
    s_nop 1
    v_permlane16_swap_b32 v153, v8
    v_add_f32 v153, v153, v8
    v_mov_b32 v8, v153
    s_nop 1
    v_permlane32_swap_b32 v153, v8
    v_add_f32 v153, v153, v8
    v_and_b32 v8, 7, v1
    s_mul_i32 s46, s20, 64
    s_add_u32 s46, s46, 160896
    v_lshl_add_u32 v8, v8, 3, s46
    ds_write_b64 v8, v[152:153]
    s_waitcnt lgkmcnt(0)
    s_branch L_join_103
L_w3a_96:
    s_and_b32 s45, s21, 1
    s_lshl_b32 s45, s45, 3
    s_and_b32 s44, s22, 7
    s_add_u32 s44, s44, s45
    s_mul_i32 s44, s44, 129024
    s_add_u32 s44, s44, 0
    s_mov_b32 m0, 18432
    s_add_u32 s45, s44, 0
    buffer_load_dwordx4 v2, s[4:7], s45 offen offset:0 lds
    buffer_load_dwordx4 v2, s[4:7], s45 offen offset:1024 lds
    buffer_load_dwordx4 v2, s[4:7], s45 offen offset:2048 lds
    buffer_load_dwordx4 v2, s[4:7], s45 offen offset:3072 lds
    s_mov_b32 m0, 22528
    s_add_u32 s45, s44, 4096
    buffer_load_dwordx4 v2, s[4:7], s45 offen offset:0 lds
    buffer_load_dwordx4 v2, s[4:7], s45 offen offset:1024 lds
    buffer_load_dwordx4 v2, s[4:7], s45 offen offset:2048 lds
    buffer_load_dwordx4 v2, s[4:7], s45 offen offset:3072 lds
    s_mov_b32 m0, 26624
    s_add_u32 s45, s44, 8192
    buffer_load_dwordx4 v2, s[4:7], s45 offen offset:0 lds
    buffer_load_dwordx4 v2, s[4:7], s45 offen offset:1024 lds
    buffer_load_dwordx4 v2, s[4:7], s45 offen offset:2048 lds
    buffer_load_dwordx4 v2, s[4:7], s45 offen offset:3072 lds
    s_mov_b32 m0, 30720
    s_add_u32 s45, s44, 12288
    buffer_load_dwordx4 v2, s[4:7], s45 offen offset:0 lds
    buffer_load_dwordx4 v2, s[4:7], s45 offen offset:1024 lds
    buffer_load_dwordx4 v2, s[4:7], s45 offen offset:2048 lds
    buffer_load_dwordx4 v2, s[4:7], s45 offen offset:3072 lds
    s_mov_b32 m0, 34816
    s_add_u32 s45, s44, 16384
    buffer_load_dwordx4 v2, s[4:7], s45 offen offset:0 lds
    buffer_load_dwordx4 v2, s[4:7], s45 offen offset:1024 lds
    buffer_load_dwordx4 v2, s[4:7], s45 offen offset:2048 lds
    buffer_load_dwordx4 v2, s[4:7], s45 offen offset:3072 lds
    s_mov_b32 m0, 38912
    s_add_u32 s45, s44, 20480
    buffer_load_dwordx4 v2, s[4:7], s45 offen offset:0 lds
    buffer_load_dwordx4 v2, s[4:7], s45 offen offset:1024 lds
    buffer_load_dwordx4 v2, s[4:7], s45 offen offset:2048 lds
    buffer_load_dwordx4 v2, s[4:7], s45 offen offset:3072 lds
    s_mov_b32 m0, 43008
    s_add_u32 s45, s44, 24576
    buffer_load_dwordx4 v2, s[4:7], s45 offen offset:0 lds
    buffer_load_dwordx4 v2, s[4:7], s45 offen offset:1024 lds
    buffer_load_dwordx4 v2, s[4:7], s45 offen offset:2048 lds
    buffer_load_dwordx4 v2, s[4:7], s45 offen offset:3072 lds
    s_mov_b32 m0, 47104
    s_add_u32 s45, s44, 28672
    buffer_load_dwordx4 v2, s[4:7], s45 offen offset:0 lds
    buffer_load_dwordx4 v2, s[4:7], s45 offen offset:1024 lds
    buffer_load_dwordx4 v2, s[4:7], s45 offen offset:2048 lds
    buffer_load_dwordx4 v2, s[4:7], s45 offen offset:3072 lds
    s_mov_b32 m0, 51200
    s_add_u32 s45, s44, 32768
    buffer_load_dwordx4 v2, s[4:7], s45 offen offset:0 lds
    buffer_load_dwordx4 v2, s[4:7], s45 offen offset:1024 lds
    buffer_load_dwordx4 v2, s[4:7], s45 offen offset:2048 lds
    buffer_load_dwordx4 v2, s[4:7], s45 offen offset:3072 lds
L_join_103:
    s_barrier
    s_cmp_eq_u32 s20, 3
    s_cbranch_scc1 L_w3b_104
    v_and_b32 v8, 7, v1
    v_lshlrev_b32 v8, 3, v8
    v_add_u32 v8, 160896, v8
    ds_read_b64 v[152:153], v8 offset:0
    ds_read_b64 v[154:155], v8 offset:64
    ds_read_b64 v[156:157], v8 offset:128
    s_waitcnt lgkmcnt(1)
    v_add_f32 v8, v152, v154
    s_waitcnt lgkmcnt(0)
    v_add_f32 v8, v8, v156
    v_mul_f32 v8, 0x3ae38e39, v8
    v_add_f32 v9, v153, v155
    v_add_f32 v9, v9, v157
    v_mul_f32 v10, 0x3baaaaab, v152
    v_sub_f32 v10, v10, v8
    v_mul_f32 v10, v10, v10
    v_fmac_f32 v9, 0x43400000, v10
    v_mul_f32 v10, 0x3baaaaab, v154
    v_sub_f32 v10, v10, v8
    v_mul_f32 v10, v10, v10
    v_fmac_f32 v9, 0x43400000, v10
    v_mul_f32 v10, 0x3baaaaab, v156
    v_sub_f32 v10, v10, v8
    v_mul_f32 v10, v10, v10
    v_fmac_f32 v9, 0x43400000, v10
    v_mul_f32 v9, 0x3ae38e39, v9
    v_cvt_pk_bf16_f32 v9, v9, v9
    v_lshlrev_b32 v9, 16, v9
    v_add_f32 v9, 0x3727c5ac, v9
    v_cvt_pk_bf16_f32 v9, v9, v9
    v_lshlrev_b32 v9, 16, v9
    v_sqrt_f32 v9, v9
    s_nop 0
    v_cvt_pk_bf16_f32 v9, v9, v9
    v_lshlrev_b32 v9, 16, v9
    v_rcp_f32 v9, v9
    v_cvt_pk_bf16_f32 v8, v8, v8
    v_lshlrev_b32 v8, 16, v8
    v_sub_f32 v128, v128, v8
    v_sub_f32 v129, v129, v8
    v_cvt_pk_bf16_f32 v10, v128, v129
    v_lshlrev_b32 v128, 16, v10
    v_and_b32 v129, 0xffff0000, v10
    v_mul_f32 v128, v128, v9
    v_mul_f32 v129, v129, v9
    v_cvt_pk_bf16_f32 v16, v128, v129
    v_sub_f32 v130, v130, v8
    v_sub_f32 v131, v131, v8
    v_cvt_pk_bf16_f32 v10, v130, v131
    v_lshlrev_b32 v130, 16, v10
    v_and_b32 v131, 0xffff0000, v10
    v_mul_f32 v130, v130, v9
    v_mul_f32 v131, v131, v9
    v_cvt_pk_bf16_f32 v17, v130, v131
    v_sub_f32 v132, v132, v8
    v_sub_f32 v133, v133, v8
    v_cvt_pk_bf16_f32 v10, v132, v133
    v_lshlrev_b32 v132, 16, v10
    v_and_b32 v133, 0xffff0000, v10
    v_mul_f32 v132, v132, v9
    v_mul_f32 v133, v133, v9
    v_cvt_pk_bf16_f32 v18, v132, v133
    v_sub_f32 v134, v134, v8
    v_sub_f32 v135, v135, v8
    v_cvt_pk_bf16_f32 v10, v134, v135
    v_lshlrev_b32 v134, 16, v10
    v_and_b32 v135, 0xffff0000, v10
    v_mul_f32 v134, v134, v9
    v_mul_f32 v135, v135, v9
    v_cvt_pk_bf16_f32 v19, v134, v135
    v_sub_f32 v136, v136, v8
    v_sub_f32 v137, v137, v8
    v_cvt_pk_bf16_f32 v10, v136, v137
    v_lshlrev_b32 v136, 16, v10
    v_and_b32 v137, 0xffff0000, v10
    v_mul_f32 v136, v136, v9
    v_mul_f32 v137, v137, v9
    v_cvt_pk_bf16_f32 v20, v136, v137
    v_sub_f32 v138, v138, v8
    v_sub_f32 v139, v139, v8
    v_cvt_pk_bf16_f32 v10, v138, v139
    v_lshlrev_b32 v138, 16, v10
    v_and_b32 v139, 0xffff0000, v10
    v_mul_f32 v138, v138, v9
    v_mul_f32 v139, v139, v9
    v_cvt_pk_bf16_f32 v21, v138, v139
    v_sub_f32 v140, v140, v8
    v_sub_f32 v141, v141, v8
    v_cvt_pk_bf16_f32 v10, v140, v141
    v_lshlrev_b32 v140, 16, v10
    v_and_b32 v141, 0xffff0000, v10
    v_mul_f32 v140, v140, v9
    v_mul_f32 v141, v141, v9
    v_cvt_pk_bf16_f32 v22, v140, v141
    v_sub_f32 v142, v142, v8
    v_sub_f32 v143, v143, v8
    v_cvt_pk_bf16_f32 v10, v142, v143
    v_lshlrev_b32 v142, 16, v10
    v_and_b32 v143, 0xffff0000, v10
    v_mul_f32 v142, v142, v9
    v_mul_f32 v143, v143, v9
    v_cvt_pk_bf16_f32 v23, v142, v143
    v_sub_f32 v144, v144, v8
    v_sub_f32 v145, v145, v8
    v_cvt_pk_bf16_f32 v10, v144, v145
    v_lshlrev_b32 v144, 16, v10
    v_and_b32 v145, 0xffff0000, v10
    v_mul_f32 v144, v144, v9
    v_mul_f32 v145, v145, v9
    v_cvt_pk_bf16_f32 v24, v144, v145
    v_sub_f32 v146, v146, v8
    v_sub_f32 v147, v147, v8
    v_cvt_pk_bf16_f32 v10, v146, v147
    v_lshlrev_b32 v146, 16, v10
    v_and_b32 v147, 0xffff0000, v10
    v_mul_f32 v146, v146, v9
    v_mul_f32 v147, v147, v9
    v_cvt_pk_bf16_f32 v25, v146, v147
    v_sub_f32 v148, v148, v8
    v_sub_f32 v149, v149, v8
    v_cvt_pk_bf16_f32 v10, v148, v149
    v_lshlrev_b32 v148, 16, v10
    v_and_b32 v149, 0xffff0000, v10
    v_mul_f32 v148, v148, v9
    v_mul_f32 v149, v149, v9
    v_cvt_pk_bf16_f32 v26, v148, v149
    v_sub_f32 v150, v150, v8
    v_sub_f32 v151, v151, v8
    v_cvt_pk_bf16_f32 v10, v150, v151
    v_lshlrev_b32 v150, 16, v10
    v_and_b32 v151, 0xffff0000, v10
    v_mul_f32 v150, v150, v9
    v_mul_f32 v151, v151, v9
    v_cvt_pk_bf16_f32 v27, v150, v151
    s_add_u32 s46, s53, 20971520
    buffer_store_dwordx4 v[16:19], v4, s[4:7], s46 offen sc1
    s_add_u32 s46, s54, 20971520
    buffer_store_dwordx4 v[20:23], v4, s[4:7], s46 offen sc1
    s_add_u32 s46, s55, 20971520
    buffer_store_dwordx4 v[24:27], v4, s[4:7], s46 offen sc1
    s_lshl_b32 s46, s47, 2
    s_add_u32 s46, s46, s20
    s_lshl_b32 s46, s46, 3
    s_add_u32 s46, s46, 8192
    v_mov_b32 v8, s98
    v_mov_b32 v9, s99
    s_waitcnt vmcnt(0)
    s_lshl_b32 s46, s46, 2
    s_add_u32 s46, s46, 0x8000000
    s_mov_b64 exec, 1
    buffer_store_dwordx2 v[8:9], off, s[4:7], s46 sc1
    s_mov_b64 exec, -1
L_w3b_104:
    s_and_b32 s52, s21, 6
    s_lshl_b32 s52, s52, 1
    s_lshr_b32 s44, s22, 3
    s_add_u32 s44, s44, s52
    s_and_b32 s52, s21, 1
    s_lshl_b32 s52, s52, 3
    s_and_b32 s45, s22, 7
    s_add_u32 s45, s45, s52
    s_mul_i32 s48, s20, 21
    s_lshr_b32 s48, s48, 1
    s_lshl_b32 s48, s48, 10
    s_mul_i32 s47, s45, 129024
    s_add_u32 s47, s47, s48
    s_add_u32 s47, s47, 0
    s_lshl_b32 s46, s44, 3
    s_max_u32 s52, s46, 1
    s_sub_u32 s52, s52, 1
    s_mul_i32 s49, s52, 18432
    s_mul_i32 s50, s20, 9
    s_lshr_b32 s50, s50, 1
    s_lshl_b32 s50, s50, 10
    s_add_u32 s49, s49, s50
    s_add_u32 s49, s49, 20971520
    s_add_u32 s50, s50, 0
    s_lshl_b32 s54, s52, 6
    s_lshl_b32 s52, s20, 1
    s_add_u32 s46, s46, s52
    s_mul_i32 s51, s46, 18432
    s_add_u32 s51, s51, 20971520
    s_lshl_b32 s55, s46, 6
    v_and_b32 v6, 3, v1
    v_min_u32 v6, 2, v6
    v_and_b32 v7, 12, v1
    v_add_lshl_u32 v8, v6, v7, 3
    v_add_u32 v8, s55, v8
    v_and_b32 v7, 4, v1
    v_add_lshl_u32 v9, v6, v7, 3
    v_add_u32 v9, s54, v9
    v_and_b32 v7, 16, v1
    v_cmp_eq_u32 vcc, 0, v7
    s_nop 1
    v_cndmask_b32 v8, v9, v8, vcc
    s_min_u32 s52, s22, 23
    s_mul_i32 s52, s52, 10923
    s_lshr_b32 s52, s52, 16
    s_lshl_b32 s53, s21, 2
    s_add_u32 s52, s52, s53
    s_lshl_b32 s52, s52, 2
    s_add_u32 s52, s52, s20
    s_lshl_b32 s52, s52, 6
    v_and_b32 v7, 4, v1
    v_add_lshl_u32 v7, v6, v7, 3
    v_add_u32 v7, s52, v7
    v_cmp_gt_u32 vcc, 32, v1
    s_nop 1
    v_cndmask_b32 v8, v7, v8, vcc
    s_mov_b32 s52, 8192
    s_min_u32 s56, s20, 2
    s_add_u32 s57, s56, 2
    s_and_b32 s56, s20, 1
    s_add_u32 s56, s56, 4
    s_cmp_ge_u32 s20, 2
    s_cselect_b32 s57, 6, s57
    s_lshl_b32 s57, s57, 10
    s_lshl_b32 s56, s56, 10
    v_add_u32 v3, 18432, v2
    v_add_u32 v4, s57, v3
    v_add_u32 v5, s56, v3
    v_add_u32 v10, 0, v2
    s_waitcnt vmcnt(0)
    s_waitcnt vmcnt(0)
    s_barrier
    ds_read_b128 v[88:91], v3 offset:0
    ds_read_b128 v[92:95], v3 offset:1024
    ds_read_b128 v[96:99], v3 offset:2048
    ds_read_b128 v[100:103], v3 offset:3072
    ds_read_b128 v[112:115], v3 offset:6144
    ds_read_b128 v[104:107], v3 offset:4096
    ds_read_b128 v[108:111], v3 offset:5120
    v_mov_b32 v11, v8
    s_mov_b32 s23, s52
    s_lshl_b32 s23, s23, 2
    s_add_u32 s23, s23, 0x8000000
    v_lshlrev_b32 v11, 2, v11
    buffer_load_dwordx2 v[12:13], v11, s[4:7], s23 offen sc1
    v_and_b32 v6, 15, v1
    v_lshrrev_b32 v7, 4, v1
    v_lshlrev_b32 v7, 2, v7
    v_sub_u32 v6, v6, v7
    v_mov_b32 v8, 0xf149f2ca
    s_or_b32 s52, s44, s20
    s_cmp_eq_u32 s52, 0
    s_cselect_b64 s[56:57], -1, 0
    v_subrev_u32 v7, 0, v6
    v_and_b32 v9, 0xfffffff1, v7
    v_cmp_eq_u32 vcc, 0, v9
    v_add_u32 v7, 16, v7
    v_and_b32 v9, 0xfffffff1, v7
    v_cndmask_b32_e64 v168, v8, 0, vcc
    v_cmp_eq_u32 vcc, 0, v9
    s_nop 1
    v_cndmask_b32_e64 v172, v8, 0, vcc
    v_cndmask_b32_e64 v176, v172, v8, s[56:57]
    v_subrev_u32 v7, 1, v6
    v_and_b32 v9, 0xfffffff1, v7
    v_cmp_eq_u32 vcc, 0, v9
    v_add_u32 v7, 16, v7
    v_and_b32 v9, 0xfffffff1, v7
    v_cndmask_b32_e64 v169, v8, 0, vcc
    v_cmp_eq_u32 vcc, 0, v9
    s_nop 1
    v_cndmask_b32_e64 v173, v8, 0, vcc
    v_cndmask_b32_e64 v177, v173, v8, s[56:57]
    v_subrev_u32 v7, 2, v6
    v_and_b32 v9, 0xfffffff1, v7
    v_cmp_eq_u32 vcc, 0, v9
    v_add_u32 v7, 16, v7
    v_and_b32 v9, 0xfffffff1, v7
    v_cndmask_b32_e64 v170, v8, 0, vcc
    v_cmp_eq_u32 vcc, 0, v9
    s_nop 1
    v_cndmask_b32_e64 v174, v8, 0, vcc
    v_cndmask_b32_e64 v178, v174, v8, s[56:57]
    v_subrev_u32 v7, 3, v6
    v_and_b32 v9, 0xfffffff1, v7
    v_cmp_eq_u32 vcc, 0, v9
    v_add_u32 v7, 16, v7
    v_and_b32 v9, 0xfffffff1, v7
    v_cndmask_b32_e64 v171, v8, 0, vcc
    v_cmp_eq_u32 vcc, 0, v9
    s_nop 1
    v_cndmask_b32_e64 v175, v8, 0, vcc
    v_cndmask_b32_e64 v179, v175, v8, s[56:57]
    s_mul_i32 s53, s45, 2304
    s_add_u32 s53, s53, s51
    s_waitcnt vmcnt(0)
    v_cmp_eq_u64 vcc, s[98:99], v[12:13]
    s_nop 0
    s_cmp_eq_u64 vcc, exec
    s_cbranch_scc0 L_px_slow_105
L_px_back_106:
    s_add_u32 s54, s51, 0
    buffer_load_dwordx4 a[0:3], v2, s[4:7], s54 offen offset:0 sc1
    s_add_u32 s55, s51, 18432
    buffer_load_dwordx4 a[72:75], v2, s[4:7], s55 offen offset:0 sc1
    buffer_load_dwordx4 a[4:7], v2, s[4:7], s54 offen offset:1024 sc1
    buffer_load_dwordx4 a[76:79], v2, s[4:7], s55 offen offset:1024 sc1
    buffer_load_dwordx4 a[8:11], v2, s[4:7], s54 offen offset:2048 sc1
    buffer_load_dwordx4 a[80:83], v2, s[4:7], s55 offen offset:2048 sc1
    s_waitcnt vmcnt(5) lgkmcnt(6)
    s_add_u32 m0, s50, 0
    s_add_u32 s53, s49, 0
    v_mfma_f32_16x16x32_bf16 v[16:19], v[88:91], a[0:3], 0
    buffer_load_dwordx4 v2, s[4:7], s53 offen offset:0 sc1 lds
    s_waitcnt vmcnt(5)
    v_mfma_f32_16x16x32_bf16 v[48:51], v[88:91], a[72:75], 0
    buffer_load_dwordx4 v2, s[4:7], s53 offen offset:1024 sc1 lds
    buffer_load_dwordx4 v2, s[4:7], s53 offen offset:2048 sc1 lds
    buffer_load_dwordx4 v2, s[4:7], s53 offen offset:3072 sc1 lds
    s_add_u32 m0, s50, 4096
    s_add_u32 s53, s49, 4096
    buffer_load_dwordx4 v2, s[4:7], s53 offen offset:0 sc1 lds
    buffer_load_dwordx4 a[12:15], v2, s[4:7], s54 offen offset:3072 sc1
    buffer_load_dwordx4 a[84:87], v2, s[4:7], s55 offen offset:3072 sc1
    s_waitcnt lgkmcnt(5)
    v_mfma_f32_16x16x32_bf16 v[20:23], v[92:95], a[0:3], 0
    s_add_u32 s54, s51, 4096
    ds_read_b128 v[116:119], v3 offset:7168
    ds_read_b128 v[120:123], v3 offset:8192
    v_mfma_f32_16x16x32_bf16 v[52:55], v[92:95], a[72:75], 0
    s_waitcnt lgkmcnt(6)
    ds_read_b128 v[124:127], v3 offset:9216
    v_mfma_f32_16x16x32_bf16 v[24:27], v[96:99], a[0:3], 0
    v_mfma_f32_16x16x32_bf16 v[56:59], v[96:99], a[72:75], 0
    s_waitcnt lgkmcnt(6)
    ds_read_b128 v[128:131], v3 offset:10240
    v_mfma_f32_16x16x32_bf16 v[28:31], v[100:103], a[0:3], 0
    buffer_load_dwordx4 a[16:19], v2, s[4:7], s54 offen offset:0 sc1
    v_mfma_f32_16x16x32_bf16 v[60:63], v[100:103], a[72:75], 0
    s_waitcnt lgkmcnt(6)
    s_add_u32 s55, s51, 22528
    ds_read_b128 v[140:143], v3 offset:13312
    v_mfma_f32_16x16x32_bf16 v[32:35], v[112:115], a[0:3], 0
    ds_read_b128 v[132:135], v3 offset:11264
    v_mfma_f32_16x16x32_bf16 v[64:67], v[112:115], a[72:75], 0
    s_waitcnt lgkmcnt(7)
    v_mfma_f32_16x16x32_bf16 v[36:39], a[0:3], v[104:107], 0
    ds_read_b128 v[136:139], v3 offset:12288
    v_mfma_f32_16x16x32_bf16 v[68:71], a[72:75], v[104:107], 0
    s_waitcnt lgkmcnt(7)
    v_mfma_f32_16x16x32_bf16 v[40:43], a[0:3], v[108:111], 0
    buffer_load_dwordx4 a[88:91], v2, s[4:7], s55 offen offset:0 sc1
    v_mfma_f32_16x16x32_bf16 v[72:75], a[72:75], v[108:111], 0
    s_waitcnt vmcnt(12) lgkmcnt(6)
    v_mfma_f32_16x16x32_bf16 v[16:19], v[116:119], a[4:7], v[16:19]
    s_waitcnt vmcnt(11)
    ds_read_b128 v[88:91], v3 offset:14336
    v_mfma_f32_16x16x32_bf16 v[48:51], v[116:119], a[76:79], v[48:51]
    s_waitcnt lgkmcnt(6)
    ds_read_b128 v[92:95], v3 offset:15360
    v_mfma_f32_16x16x32_bf16 v[20:23], v[120:123], a[4:7], v[20:23]
    buffer_load_dwordx4 a[20:23], v2, s[4:7], s54 offen offset:1024 sc1
    v_mfma_f32_16x16x32_bf16 v[52:55], v[120:123], a[76:79], v[52:55]
    s_waitcnt lgkmcnt(6)
    ds_read_b128 v[96:99], v3 offset:16384
    v_mfma_f32_16x16x32_bf16 v[24:27], v[124:127], a[4:7], v[24:27]
    v_mfma_f32_16x16x32_bf16 v[56:59], v[124:127], a[76:79], v[56:59]
    s_waitcnt lgkmcnt(6)
    ds_read_b128 v[100:103], v3 offset:17408
    v_mfma_f32_16x16x32_bf16 v[28:31], v[128:131], a[4:7], v[28:31]
    buffer_load_dwordx4 a[92:95], v2, s[4:7], s55 offen offset:1024 sc1
    v_mfma_f32_16x16x32_bf16 v[60:63], v[128:131], a[76:79], v[60:63]
    s_waitcnt lgkmcnt(6)
    ds_read_b128 v[112:115], v3 offset:20480
    v_mfma_f32_16x16x32_bf16 v[32:35], v[140:143], a[4:7], v[32:35]
    ds_read_b128 v[104:107], v3 offset:18432
    v_mfma_f32_16x16x32_bf16 v[64:67], v[140:143], a[76:79], v[64:67]
    s_waitcnt lgkmcnt(7)
    v_mfma_f32_16x16x32_bf16 v[36:39], a[4:7], v[132:135], v[36:39]
    ds_read_b128 v[108:111], v3 offset:19456
    v_mfma_f32_16x16x32_bf16 v[68:71], a[76:79], v[132:135], v[68:71]
    s_waitcnt lgkmcnt(7)
    v_mfma_f32_16x16x32_bf16 v[40:43], a[4:7], v[136:139], v[40:43]
    buffer_load_dwordx4 a[24:27], v2, s[4:7], s54 offen offset:2048 sc1
    v_mfma_f32_16x16x32_bf16 v[72:75], a[76:79], v[136:139], v[72:75]
    s_waitcnt vmcnt(13) lgkmcnt(6)
    v_mfma_f32_16x16x32_bf16 v[16:19], v[88:91], a[8:11], v[16:19]
    s_waitcnt vmcnt(12)
    ds_read_b128 v[116:119], v3 offset:21504
    v_mfma_f32_16x16x32_bf16 v[48:51], v[88:91], a[80:83], v[48:51]
    s_waitcnt lgkmcnt(6)
    ds_read_b128 v[120:123], v3 offset:22528
    v_mfma_f32_16x16x32_bf16 v[20:23], v[92:95], a[8:11], v[20:23]
    buffer_load_dwordx4 a[96:99], v2, s[4:7], s55 offen offset:2048 sc1
    v_mfma_f32_16x16x32_bf16 v[52:55], v[92:95], a[80:83], v[52:55]
    s_waitcnt lgkmcnt(6)
    ds_read_b128 v[124:127], v3 offset:23552
    v_mfma_f32_16x16x32_bf16 v[24:27], v[96:99], a[8:11], v[24:27]
    v_mfma_f32_16x16x32_bf16 v[56:59], v[96:99], a[80:83], v[56:59]
    s_waitcnt lgkmcnt(6)
    ds_read_b128 v[128:131], v3 offset:24576
    v_mfma_f32_16x16x32_bf16 v[28:31], v[100:103], a[8:11], v[28:31]
    buffer_load_dwordx4 a[28:31], v2, s[4:7], s54 offen offset:3072 sc1
    v_mfma_f32_16x16x32_bf16 v[60:63], v[100:103], a[80:83], v[60:63]
    s_waitcnt lgkmcnt(6)
    ds_read_b128 v[140:143], v3 offset:27648
    v_mfma_f32_16x16x32_bf16 v[32:35], v[112:115], a[8:11], v[32:35]
    ds_read_b128 v[132:135], v3 offset:25600
    v_mfma_f32_16x16x32_bf16 v[64:67], v[112:115], a[80:83], v[64:67]
    s_waitcnt lgkmcnt(7)
    v_mfma_f32_16x16x32_bf16 v[36:39], a[8:11], v[104:107], v[36:39]
    ds_read_b128 v[136:139], v3 offset:26624
    v_mfma_f32_16x16x32_bf16 v[68:71], a[80:83], v[104:107], v[68:71]
    s_waitcnt lgkmcnt(7)
    v_mfma_f32_16x16x32_bf16 v[40:43], a[8:11], v[108:111], v[40:43]
    buffer_load_dwordx4 a[100:103], v2, s[4:7], s55 offen offset:3072 sc1
    v_mfma_f32_16x16x32_bf16 v[72:75], a[80:83], v[108:111], v[72:75]
    s_waitcnt vmcnt(9) lgkmcnt(6)
    s_add_u32 s54, s51, 8192
    v_mfma_f32_16x16x32_bf16 v[16:19], v[116:119], a[12:15], v[16:19]
    s_waitcnt vmcnt(8)
    ds_read_b128 v[88:91], v3 offset:28672
    v_mfma_f32_16x16x32_bf16 v[48:51], v[116:119], a[84:87], v[48:51]
    s_waitcnt lgkmcnt(6)
    ds_read_b128 v[92:95], v3 offset:29696
    v_mfma_f32_16x16x32_bf16 v[20:23], v[120:123], a[12:15], v[20:23]
    buffer_load_dwordx4 a[32:35], v2, s[4:7], s54 offen offset:0 sc1
    v_mfma_f32_16x16x32_bf16 v[52:55], v[120:123], a[84:87], v[52:55]
    s_waitcnt lgkmcnt(6)
    s_add_u32 s55, s51, 26624
    ds_read_b128 v[96:99], v3 offset:30720
    v_mfma_f32_16x16x32_bf16 v[24:27], v[124:127], a[12:15], v[24:27]
    v_mfma_f32_16x16x32_bf16 v[56:59], v[124:127], a[84:87], v[56:59]
    s_waitcnt lgkmcnt(6)
    ds_read_b128 v[100:103], v3 offset:31744
    v_mfma_f32_16x16x32_bf16 v[28:31], v[128:131], a[12:15], v[28:31]
    buffer_load_dwordx4 a[104:107], v2, s[4:7], s55 offen offset:0 sc1
    v_mfma_f32_16x16x32_bf16 v[60:63], v[128:131], a[84:87], v[60:63]
    s_waitcnt lgkmcnt(6)
    ds_read_b128 v[112:115], v3 offset:34816
    v_mfma_f32_16x16x32_bf16 v[32:35], v[140:143], a[12:15], v[32:35]
    ds_read_b128 v[104:107], v3 offset:32768
    v_mfma_f32_16x16x32_bf16 v[64:67], v[140:143], a[84:87], v[64:67]
    s_waitcnt lgkmcnt(7)
    v_mfma_f32_16x16x32_bf16 v[36:39], a[12:15], v[132:135], v[36:39]
    ds_read_b128 v[108:111], v3 offset:33792
    v_mfma_f32_16x16x32_bf16 v[68:71], a[84:87], v[132:135], v[68:71]
    s_waitcnt lgkmcnt(7)
    v_mfma_f32_16x16x32_bf16 v[40:43], a[12:15], v[136:139], v[40:43]
    buffer_load_dwordx4 a[36:39], v2, s[4:7], s54 offen offset:1024 sc1
    v_mfma_f32_16x16x32_bf16 v[72:75], a[84:87], v[136:139], v[72:75]
    s_waitcnt vmcnt(10) lgkmcnt(6)
    v_mfma_f32_16x16x32_bf16 v[16:19], v[88:91], a[16:19], v[16:19]
    s_waitcnt vmcnt(9)
    ds_read_b128 v[116:119], v3 offset:35840
    v_mfma_f32_16x16x32_bf16 v[48:51], v[88:91], a[88:91], v[48:51]
    s_waitcnt lgkmcnt(6)
    ds_read_b128 v[120:123], v3 offset:36864
    v_mfma_f32_16x16x32_bf16 v[20:23], v[92:95], a[16:19], v[20:23]
    buffer_load_dwordx4 a[108:111], v2, s[4:7], s55 offen offset:1024 sc1
    v_mfma_f32_16x16x32_bf16 v[52:55], v[92:95], a[88:91], v[52:55]
    s_waitcnt lgkmcnt(6)
    ds_read_b128 v[124:127], v3 offset:37888
    v_mfma_f32_16x16x32_bf16 v[24:27], v[96:99], a[16:19], v[24:27]
    v_mfma_f32_16x16x32_bf16 v[56:59], v[96:99], a[88:91], v[56:59]
    s_waitcnt lgkmcnt(6)
    ds_read_b128 v[128:131], v3 offset:38912
    v_mfma_f32_16x16x32_bf16 v[28:31], v[100:103], a[16:19], v[28:31]
    buffer_load_dwordx4 a[40:43], v2, s[4:7], s54 offen offset:2048 sc1
    v_mfma_f32_16x16x32_bf16 v[60:63], v[100:103], a[88:91], v[60:63]
    s_waitcnt lgkmcnt(6)
    ds_read_b128 v[140:143], v3 offset:41984
    v_mfma_f32_16x16x32_bf16 v[32:35], v[112:115], a[16:19], v[32:35]
    ds_read_b128 v[132:135], v3 offset:39936
    v_mfma_f32_16x16x32_bf16 v[64:67], v[112:115], a[88:91], v[64:67]
    s_waitcnt lgkmcnt(7)
    v_mfma_f32_16x16x32_bf16 v[36:39], a[16:19], v[104:107], v[36:39]
    ds_read_b128 v[136:139], v3 offset:40960
    v_mfma_f32_16x16x32_bf16 v[68:71], a[88:91], v[104:107], v[68:71]
    s_waitcnt lgkmcnt(7)
    v_mfma_f32_16x16x32_bf16 v[40:43], a[16:19], v[108:111], v[40:43]
    buffer_load_dwordx4 a[112:115], v2, s[4:7], s55 offen offset:2048 sc1
    v_mfma_f32_16x16x32_bf16 v[72:75], a[88:91], v[108:111], v[72:75]
    s_waitcnt vmcnt(11) lgkmcnt(6)
    v_mfma_f32_16x16x32_bf16 v[16:19], v[116:119], a[20:23], v[16:19]
    s_waitcnt vmcnt(10)
    s_barrier
    ds_read_b128 v[88:91], v3 offset:43008
    v_mfma_f32_16x16x32_bf16 v[48:51], v[116:119], a[92:95], v[48:51]
    s_waitcnt lgkmcnt(6)
    ds_read_b128 v[92:95], v3 offset:44032
    ds_read_b128 v[144:147], v10 offset:0
    v_mfma_f32_16x16x32_bf16 v[20:23], v[120:123], a[20:23], v[20:23]
    buffer_load_dwordx4 a[44:47], v2, s[4:7], s54 offen offset:3072 sc1
    v_mfma_f32_16x16x32_bf16 v[52:55], v[120:123], a[92:95], v[52:55]
    s_waitcnt lgkmcnt(7)
    ds_read_b128 v[96:99], v3 offset:45056
    ds_read_b128 v[148:151], v4 offset:0
    v_mfma_f32_16x16x32_bf16 v[24:27], v[124:127], a[20:23], v[24:27]
    ds_read_b128 v[152:155], v5 offset:0
    ds_read_b128 v[156:159], v10 offset:1024
    v_mfma_f32_16x16x32_bf16 v[56:59], v[124:127], a[92:95], v[56:59]
    s_waitcnt lgkmcnt(10)
    ds_read_b128 v[100:103], v3 offset:46080
    ds_read_b128 v[160:163], v4 offset:7168
    v_mfma_f32_16x16x32_bf16 v[28:31], v[128:131], a[20:23], v[28:31]
    buffer_load_dwordx4 a[116:119], v2, s[4:7], s55 offen offset:3072 sc1
    v_mfma_f32_16x16x32_bf16 v[60:63], v[128:131], a[92:95], v[60:63]
    s_waitcnt lgkmcnt(11)
    s_add_u32 s54, s51, 12288
    ds_read_b128 v[112:115], v3 offset:49152
    v_mfma_f32_16x16x32_bf16 v[32:35], v[140:143], a[20:23], v[32:35]
    ds_read_b128 v[104:107], v3 offset:47104
    ds_read_b128 v[164:167], v5 offset:7168
    v_mfma_f32_16x16x32_bf16 v[64:67], v[140:143], a[92:95], v[64:67]
    s_waitcnt lgkmcnt(13)
    v_mfma_f32_16x16x32_bf16 v[36:39], a[20:23], v[132:135], v[36:39]
    ds_read_b128 v[108:111], v3 offset:48128
    v_mfma_f32_16x16x32_bf16 v[68:71], a[92:95], v[132:135], v[68:71]
    s_waitcnt lgkmcnt(13)
    v_mfma_f32_16x16x32_bf16 v[40:43], a[20:23], v[136:139], v[40:43]
    buffer_load_dwordx4 a[48:51], v2, s[4:7], s54 offen offset:0 sc1
    v_mfma_f32_16x16x32_bf16 v[72:75], a[92:95], v[136:139], v[72:75]
    s_waitcnt vmcnt(12) lgkmcnt(12)
    s_add_u32 s55, s51, 30720
    v_mfma_f32_16x16x32_bf16 v[16:19], v[88:91], a[24:27], v[16:19]
    s_waitcnt vmcnt(11)
    ds_read_b128 v[116:119], v3 offset:50176
    v_mfma_f32_16x16x32_bf16 v[48:51], v[88:91], a[96:99], v[48:51]
    s_waitcnt lgkmcnt(12)
    ds_read_b128 v[120:123], v3 offset:51200
    v_mfma_f32_16x16x32_bf16 v[20:23], v[92:95], a[24:27], v[20:23]
    buffer_load_dwordx4 a[120:123], v2, s[4:7], s55 offen offset:0 sc1
    v_mfma_f32_16x16x32_bf16 v[52:55], v[92:95], a[96:99], v[52:55]
    s_waitcnt lgkmcnt(11)
    ds_read_b128 v[124:127], v3 offset:52224
    v_mfma_f32_16x16x32_bf16 v[24:27], v[96:99], a[24:27], v[24:27]
    v_mfma_f32_16x16x32_bf16 v[56:59], v[96:99], a[96:99], v[56:59]
    s_waitcnt lgkmcnt(8)
    ds_read_b128 v[128:131], v3 offset:53248
    v_mfma_f32_16x16x32_bf16 v[28:31], v[100:103], a[24:27], v[28:31]
    buffer_load_dwordx4 a[52:55], v2, s[4:7], s54 offen offset:1024 sc1
    v_mfma_f32_16x16x32_bf16 v[60:63], v[100:103], a[96:99], v[60:63]
    s_waitcnt lgkmcnt(7)
    ds_read_b128 v[140:143], v3 offset:56320
    v_mfma_f32_16x16x32_bf16 v[32:35], v[112:115], a[24:27], v[32:35]
    ds_read_b128 v[132:135], v3 offset:54272
    v_mfma_f32_16x16x32_bf16 v[64:67], v[112:115], a[96:99], v[64:67]
    s_waitcnt lgkmcnt(8)
    v_mfma_f32_16x16x32_bf16 v[36:39], a[24:27], v[104:107], v[36:39]
    ds_read_b128 v[136:139], v3 offset:55296
    v_mfma_f32_16x16x32_bf16 v[68:71], a[96:99], v[104:107], v[68:71]
    s_waitcnt lgkmcnt(7)
    v_mfma_f32_16x16x32_bf16 v[40:43], a[24:27], v[108:111], v[40:43]
    buffer_load_dwordx4 a[124:127], v2, s[4:7], s55 offen offset:1024 sc1
    v_mfma_f32_16x16x32_bf16 v[72:75], a[96:99], v[108:111], v[72:75]
    v_mfma_f32_16x16x32_bf16 v[80:83], v[148:151], v[144:147], 0
    v_mfma_f32_16x16x32_bf16 v[84:87], v[144:147], v[152:155], 0
    s_waitcnt vmcnt(13) lgkmcnt(6)
    ds_read_b128 v[144:147], v10 offset:2048
    ds_read_b128 v[148:151], v4 offset:14336
    v_mfma_f32_16x16x32_bf16 v[16:19], v[116:119], a[28:31], v[16:19]
    buffer_load_dwordx4 a[56:59], v2, s[4:7], s54 offen offset:2048 sc1
    s_waitcnt vmcnt(13)
    v_mfma_f32_16x16x32_bf16 v[48:51], v[116:119], a[100:103], v[48:51]
    s_waitcnt lgkmcnt(7)
    ds_read_b128 v[88:91], v3 offset:57344
    ds_read_b128 v[92:95], v3 offset:58368
    v_mfma_f32_16x16x32_bf16 v[20:23], v[120:123], a[28:31], v[20:23]
    ds_read_b128 v[152:155], v5 offset:14336
    v_mfma_f32_16x16x32_bf16 v[52:55], v[120:123], a[100:103], v[52:55]
    s_waitcnt lgkmcnt(9)
    ds_read_b128 v[96:99], v3 offset:59392
    v_mfma_f32_16x16x32_bf16 v[24:27], v[124:127], a[28:31], v[24:27]
    buffer_load_dwordx4 a[128:131], v2, s[4:7], s55 offen offset:2048 sc1
    v_mfma_f32_16x16x32_bf16 v[56:59], v[124:127], a[100:103], v[56:59]
    s_waitcnt lgkmcnt(9)
    ds_read_b128 v[100:103], v3 offset:60416
    v_mfma_f32_16x16x32_bf16 v[28:31], v[128:131], a[28:31], v[28:31]
    v_mfma_f32_16x16x32_bf16 v[60:63], v[128:131], a[100:103], v[60:63]
    s_waitcnt lgkmcnt(9)
    ds_read_b128 v[112:115], v3 offset:63488
    v_mfma_f32_16x16x32_bf16 v[32:35], v[140:143], a[28:31], v[32:35]
    buffer_load_dwordx4 a[60:63], v2, s[4:7], s54 offen offset:3072 sc1
    v_mfma_f32_16x16x32_bf16 v[64:67], v[140:143], a[100:103], v[64:67]
    s_waitcnt lgkmcnt(9)
    ds_read_b128 v[104:107], v3 offset:61440
    v_mfma_f32_16x16x32_bf16 v[36:39], a[28:31], v[132:135], v[36:39]
    ds_read_b128 v[108:111], v3 offset:62464
    v_mfma_f32_16x16x32_bf16 v[68:71], a[100:103], v[132:135], v[68:71]
    s_waitcnt lgkmcnt(10)
    v_mfma_f32_16x16x32_bf16 v[40:43], a[28:31], v[136:139], v[40:43]
    buffer_load_dwordx4 a[132:135], v2, s[4:7], s55 offen offset:3072 sc1
    v_mfma_f32_16x16x32_bf16 v[72:75], a[100:103], v[136:139], v[72:75]
    s_add_u32 s54, s51, 16384
    v_mfma_f32_16x16x32_bf16 v[80:83], v[160:163], v[156:159], v[80:83]
    v_mfma_f32_16x16x32_bf16 v[84:87], v[156:159], v[164:167], v[84:87]
    s_waitcnt vmcnt(15) lgkmcnt(7)
    ds_read_b128 v[156:159], v10 offset:3072
    ds_read_b128 v[160:163], v4 offset:21504
    v_mfma_f32_16x16x32_bf16 v[16:19], v[88:91], a[32:35], v[16:19]
    buffer_load_dwordx4 a[64:67], v2, s[4:7], s54 offen offset:0 sc1
    s_waitcnt vmcnt(15)
    v_mfma_f32_16x16x32_bf16 v[48:51], v[88:91], a[104:107], v[48:51]
    s_waitcnt lgkmcnt(8)
    s_add_u32 s55, s51, 34816
    v_add_u32 v3, 64512, v3
    v_mfma_f32_16x16x32_bf16 v[20:23], v[92:95], a[32:35], v[20:23]
    ds_read_b128 v[116:119], v3 offset:0
    ds_read_b128 v[164:167], v5 offset:21504
    v_mfma_f32_16x16x32_bf16 v[52:55], v[92:95], a[104:107], v[52:55]
    s_waitcnt lgkmcnt(8)
    ds_read_b128 v[120:123], v3 offset:1024
    v_mfma_f32_16x16x32_bf16 v[24:27], v[96:99], a[32:35], v[24:27]
    buffer_load_dwordx4 a[136:139], v2, s[4:7], s55 offen offset:0 sc1
    v_mfma_f32_16x16x32_bf16 v[56:59], v[96:99], a[104:107], v[56:59]
    s_waitcnt lgkmcnt(8)
    ds_read_b128 v[124:127], v3 offset:2048
    v_mfma_f32_16x16x32_bf16 v[28:31], v[100:103], a[32:35], v[28:31]
    v_mfma_f32_16x16x32_bf16 v[60:63], v[100:103], a[104:107], v[60:63]
    s_waitcnt lgkmcnt(8)
    ds_read_b128 v[128:131], v3 offset:3072
    v_mfma_f32_16x16x32_bf16 v[32:35], v[112:115], a[32:35], v[32:35]
    buffer_load_dwordx4 a[68:71], v2, s[4:7], s54 offen offset:1024 sc1
    v_mfma_f32_16x16x32_bf16 v[64:67], v[112:115], a[104:107], v[64:67]
    s_waitcnt lgkmcnt(8)
    ds_read_b128 v[140:143], v3 offset:6144
    v_mfma_f32_16x16x32_bf16 v[36:39], a[32:35], v[104:107], v[36:39]
    ds_read_b128 v[132:135], v3 offset:4096
    v_mfma_f32_16x16x32_bf16 v[68:71], a[104:107], v[104:107], v[68:71]
    s_waitcnt lgkmcnt(9)
    v_mfma_f32_16x16x32_bf16 v[40:43], a[32:35], v[108:111], v[40:43]
    ds_read_b128 v[136:139], v3 offset:5120
    v_mfma_f32_16x16x32_bf16 v[72:75], a[104:107], v[108:111], v[72:75]
    v_mfma_f32_16x16x32_bf16 v[80:83], v[148:151], v[144:147], v[80:83]
    v_mfma_f32_16x16x32_bf16 v[84:87], v[144:147], v[152:155], v[84:87]
    s_waitcnt vmcnt(16) lgkmcnt(7)
    ds_read_b128 v[144:147], v10 offset:4096
    ds_read_b128 v[148:151], v4 offset:28672
    v_mfma_f32_16x16x32_bf16 v[16:19], v[116:119], a[36:39], v[16:19]
    buffer_load_dwordx4 a[140:143], v2, s[4:7], s55 offen offset:1024 sc1
    s_waitcnt vmcnt(16)
    v_mfma_f32_16x16x32_bf16 v[48:51], v[116:119], a[108:111], v[48:51]
    s_waitcnt lgkmcnt(7)
    s_lshl_b32 s53, s22, 2
    s_add_u32 s53, s53, s20
    v_mfma_f32_16x16x32_bf16 v[20:23], v[120:123], a[36:39], v[20:23]
    s_mul_i32 s53, s53, 5248
    s_add_u32 s53, s53, 2097152
    ds_read_b128 v[88:91], v3 offset:7168
    v_mfma_f32_16x16x32_bf16 v[52:55], v[120:123], a[108:111], v[52:55]
    s_waitcnt lgkmcnt(7)
    ds_read_b128 v[92:95], v3 offset:8192
    ds_read_b128 v[96:99], v3 offset:9216
    v_mfma_f32_16x16x32_bf16 v[24:27], v[124:127], a[36:39], v[24:27]
    ds_read_b128 v[152:155], v5 offset:28672
    v_min_u32 v11, 40, v1
    v_mfma_f32_16x16x32_bf16 v[56:59], v[124:127], a[108:111], v[56:59]
    s_waitcnt lgkmcnt(9)
    ds_read_b128 v[100:103], v3 offset:10240
    v_lshlrev_b32 v11, 7, v11
    v_mfma_f32_16x16x32_bf16 v[28:31], v[128:131], a[36:39], v[28:31]
    buffer_load_dword v218, v11, s[4:7], s53 offen
    v_mfma_f32_16x16x32_bf16 v[60:63], v[128:131], a[108:111], v[60:63]
    s_waitcnt lgkmcnt(9)
    s_and_b32 s53, s21, 7
    s_lshl_b32 s53, s53, 2
    v_mfma_f32_16x16x32_bf16 v[32:35], v[140:143], a[36:39], v[32:35]
    s_and_b32 s54, s22, 3
    s_add_u32 s53, s53, s54
    s_mul_i32 s53, s53, 497664
    v_mfma_f32_16x16x32_bf16 v[64:67], v[140:143], a[108:111], v[64:67]
    s_waitcnt lgkmcnt(8)
    s_lshr_b32 s54, s22, 2
    s_lshl_b32 s54, s54, 2
    v_mfma_f32_16x16x32_bf16 v[36:39], a[36:39], v[132:135], v[36:39]
    s_add_u32 s54, s54, s20
    ds_read_b128 v[112:115], v3 offset:13312
    ds_read_b128 v[104:107], v3 offset:11264
    v_mfma_f32_16x16x32_bf16 v[68:71], a[108:111], v[132:135], v[68:71]
    s_waitcnt lgkmcnt(9)
    s_mul_i32 s54, s54, 4608
    ds_read_b128 v[108:111], v3 offset:12288
    v_mfma_f32_16x16x32_bf16 v[40:43], a[36:39], v[136:139], v[40:43]
    s_add_u32 s53, s53, s54
    s_add_u32 s53, s53, 4194304
    v_min_u32 v11, 35, v1
    v_mfma_f32_16x16x32_bf16 v[72:75], a[108:111], v[136:139], v[72:75]
    v_lshlrev_b32 v11, 7, v11
    v_mfma_f32_16x16x32_bf16 v[80:83], v[160:163], v[156:159], v[80:83]
    v_mfma_f32_16x16x32_bf16 v[84:87], v[156:159], v[164:167], v[84:87]
    s_waitcnt vmcnt(16) lgkmcnt(7)
    ds_read_b128 v[156:159], v10 offset:5120
    ds_read_b128 v[160:163], v4 offset:35840
    v_mfma_f32_16x16x32_bf16 v[16:19], v[88:91], a[40:43], v[16:19]
    buffer_load_dword v216, v11, s[4:7], s53 offen
    s_waitcnt vmcnt(16)
    v_mfma_f32_16x16x32_bf16 v[48:51], v[88:91], a[112:115], v[48:51]
    s_waitcnt lgkmcnt(8)
    ds_read_b128 v[116:119], v3 offset:14336
    ds_read_b128 v[120:123], v3 offset:15360
    v_mfma_f32_16x16x32_bf16 v[20:23], v[92:95], a[40:43], v[20:23]
    ds_read_b128 v[164:167], v5 offset:35840
    v_mfma_f32_16x16x32_bf16 v[52:55], v[92:95], a[112:115], v[52:55]
    s_waitcnt lgkmcnt(10)
    ds_read_b128 v[124:127], v3 offset:16384
    v_mfma_f32_16x16x32_bf16 v[24:27], v[96:99], a[40:43], v[24:27]
    v_mfma_f32_16x16x32_bf16 v[56:59], v[96:99], a[112:115], v[56:59]
    s_waitcnt lgkmcnt(9)
    ds_read_b128 v[128:131], v3 offset:17408
    v_mfma_f32_16x16x32_bf16 v[28:31], v[100:103], a[40:43], v[28:31]
    v_mfma_f32_16x16x32_bf16 v[60:63], v[100:103], a[112:115], v[60:63]
    s_waitcnt lgkmcnt(9)
    ds_read_b128 v[140:143], v3 offset:20480
    v_mfma_f32_16x16x32_bf16 v[32:35], v[112:115], a[40:43], v[32:35]
    ds_read_b128 v[132:135], v3 offset:18432
    v_mfma_f32_16x16x32_bf16 v[64:67], v[112:115], a[112:115], v[64:67]
    s_waitcnt lgkmcnt(10)
    v_mfma_f32_16x16x32_bf16 v[36:39], a[40:43], v[104:107], v[36:39]
    ds_read_b128 v[136:139], v3 offset:19456
    v_mfma_f32_16x16x32_bf16 v[68:71], a[112:115], v[104:107], v[68:71]
    s_waitcnt lgkmcnt(10)
    v_mfma_f32_16x16x32_bf16 v[40:43], a[40:43], v[108:111], v[40:43]
    v_mfma_f32_16x16x32_bf16 v[72:75], a[112:115], v[108:111], v[72:75]
    v_mfma_f32_16x16x32_bf16 v[80:83], v[148:151], v[144:147], v[80:83]
    v_mfma_f32_16x16x32_bf16 v[84:87], v[144:147], v[152:155], v[84:87]
    s_waitcnt vmcnt(15) lgkmcnt(7)
    ds_read_b128 v[144:147], v10 offset:6144
    ds_read_b128 v[148:151], v4 offset:43008
    v_mfma_f32_16x16x32_bf16 v[16:19], v[116:119], a[44:47], v[16:19]
    s_waitcnt vmcnt(14)
    ds_read_b128 v[88:91], v3 offset:21504
    ds_read_b128 v[152:155], v5 offset:43008
    v_mfma_f32_16x16x32_bf16 v[48:51], v[116:119], a[116:119], v[48:51]
    s_waitcnt lgkmcnt(10)
    ds_read_b128 v[92:95], v3 offset:22528
    v_mfma_f32_16x16x32_bf16 v[20:23], v[120:123], a[44:47], v[20:23]
    v_mfma_f32_16x16x32_bf16 v[52:55], v[120:123], a[116:119], v[52:55]
    s_waitcnt lgkmcnt(9)
    ds_read_b128 v[96:99], v3 offset:23552
    v_mfma_f32_16x16x32_bf16 v[24:27], v[124:127], a[44:47], v[24:27]
    v_mfma_f32_16x16x32_bf16 v[56:59], v[124:127], a[116:119], v[56:59]
    s_waitcnt lgkmcnt(9)
    ds_read_b128 v[100:103], v3 offset:24576
    v_mfma_f32_16x16x32_bf16 v[28:31], v[128:131], a[44:47], v[28:31]
    v_mfma_f32_16x16x32_bf16 v[60:63], v[128:131], a[116:119], v[60:63]
    s_waitcnt lgkmcnt(9)
    ds_read_b128 v[112:115], v3 offset:27648
    v_mfma_f32_16x16x32_bf16 v[32:35], v[140:143], a[44:47], v[32:35]
    ds_read_b128 v[104:107], v3 offset:25600
    v_mfma_f32_16x16x32_bf16 v[64:67], v[140:143], a[116:119], v[64:67]
    s_waitcnt lgkmcnt(10)
    v_mfma_f32_16x16x32_bf16 v[36:39], a[44:47], v[132:135], v[36:39]
    ds_read_b128 v[108:111], v3 offset:26624
    v_mfma_f32_16x16x32_bf16 v[68:71], a[116:119], v[132:135], v[68:71]
    s_waitcnt lgkmcnt(10)
    v_mfma_f32_16x16x32_bf16 v[40:43], a[44:47], v[136:139], v[40:43]
    v_mfma_f32_16x16x32_bf16 v[72:75], a[116:119], v[136:139], v[72:75]
    v_mfma_f32_16x16x32_bf16 v[80:83], v[160:163], v[156:159], v[80:83]
    v_mfma_f32_16x16x32_bf16 v[84:87], v[156:159], v[164:167], v[84:87]
    s_waitcnt vmcnt(13) lgkmcnt(7)
    ds_read_b128 v[156:159], v10 offset:7168
    ds_read_b128 v[160:163], v4 offset:50176
    v_mfma_f32_16x16x32_bf16 v[16:19], v[88:91], a[48:51], v[16:19]
    s_waitcnt vmcnt(12)
    ds_read_b128 v[164:167], v5 offset:50176
    ds_read_b128 v[116:119], v3 offset:28672
    v_mfma_f32_16x16x32_bf16 v[48:51], v[88:91], a[120:123], v[48:51]
    s_waitcnt lgkmcnt(9)
    ds_read_b128 v[120:123], v3 offset:29696
    v_mfma_f32_16x16x32_bf16 v[20:23], v[92:95], a[48:51], v[20:23]
    v_mfma_f32_16x16x32_bf16 v[52:55], v[92:95], a[120:123], v[52:55]
    s_waitcnt lgkmcnt(9)
    ds_read_b128 v[124:127], v3 offset:30720
    v_mfma_f32_16x16x32_bf16 v[24:27], v[96:99], a[48:51], v[24:27]
    v_mfma_f32_16x16x32_bf16 v[56:59], v[96:99], a[120:123], v[56:59]
    ds_read_b128 v[128:131], v3 offset:31744
    v_mfma_f32_16x16x32_bf16 v[80:83], v[148:151], v[144:147], v[80:83]
    v_mfma_f32_16x16x32_bf16 v[84:87], v[144:147], v[152:155], v[84:87]
    s_waitcnt lgkmcnt(10)
    ds_read_b128 v[140:143], v3 offset:34816
    ds_read_b128 v[144:147], v10 offset:8192
    v_mfma_f32_16x16x32_bf16 v[28:31], v[100:103], a[48:51], v[28:31]
    ds_read_b128 v[132:135], v3 offset:32768
    ds_read_b128 v[148:151], v4 offset:57344
    v_mfma_f32_16x16x32_bf16 v[60:63], v[100:103], a[120:123], v[60:63]
    s_waitcnt lgkmcnt(13)
    ds_read_b128 v[152:155], v5 offset:57344
    v_mfma_f32_16x16x32_bf16 v[32:35], v[112:115], a[48:51], v[32:35]
    ds_read_b128 v[136:139], v3 offset:33792
    v_mfma_f32_16x16x32_bf16 v[64:67], v[112:115], a[120:123], v[64:67]
    s_waitcnt lgkmcnt(14)
    v_mfma_f32_16x16x32_bf16 v[36:39], a[48:51], v[104:107], v[36:39]
    v_mfma_f32_16x16x32_bf16 v[68:71], a[120:123], v[104:107], v[68:71]
    s_waitcnt lgkmcnt(13)
    v_mfma_f32_16x16x32_bf16 v[40:43], a[48:51], v[108:111], v[40:43]
    v_mfma_f32_16x16x32_bf16 v[72:75], a[120:123], v[108:111], v[72:75]
    s_waitcnt lgkmcnt(11)
    v_mfma_f32_16x16x32_bf16 v[80:83], v[160:163], v[156:159], v[80:83]
    s_waitcnt lgkmcnt(10)
    v_mfma_f32_16x16x32_bf16 v[84:87], v[156:159], v[164:167], v[84:87]
    s_waitcnt vmcnt(11) lgkmcnt(9)
    v_add_u32 v4, 64512, v4
    v_add_u32 v5, 64512, v5
    v_mfma_f32_16x16x32_bf16 v[16:19], v[116:119], a[52:55], v[16:19]
    s_waitcnt vmcnt(10)
    ds_read_b128 v[156:159], v10 offset:9216
    ds_read_b128 v[160:163], v4 offset:0
    v_mfma_f32_16x16x32_bf16 v[48:51], v[116:119], a[124:127], v[48:51]
    s_waitcnt lgkmcnt(10)
    ds_read_b128 v[164:167], v5 offset:0
    ds_read_b128 v[88:91], v3 offset:35840
    v_mfma_f32_16x16x32_bf16 v[20:23], v[120:123], a[52:55], v[20:23]
    ds_read_b128 v[92:95], v3 offset:36864
    v_mfma_f32_16x16x32_bf16 v[52:55], v[120:123], a[124:127], v[52:55]
    s_waitcnt lgkmcnt(12)
    ds_read_b128 v[96:99], v3 offset:37888
    v_mfma_f32_16x16x32_bf16 v[24:27], v[124:127], a[52:55], v[24:27]
    v_mfma_f32_16x16x32_bf16 v[56:59], v[124:127], a[124:127], v[56:59]
    s_waitcnt lgkmcnt(8)
    ds_read_b128 v[100:103], v3 offset:38912
    v_mfma_f32_16x16x32_bf16 v[80:83], v[148:151], v[144:147], v[80:83]
    s_waitcnt lgkmcnt(8)
    v_mfma_f32_16x16x32_bf16 v[84:87], v[144:147], v[152:155], v[84:87]
    ds_read_b128 v[112:115], v3 offset:41984
    ds_read_b128 v[144:147], v10 offset:10240
    v_mfma_f32_16x16x32_bf16 v[28:31], v[128:131], a[52:55], v[28:31]
    ds_read_b128 v[104:107], v3 offset:39936
    ds_read_b128 v[148:151], v4 offset:7168
    v_mfma_f32_16x16x32_bf16 v[60:63], v[128:131], a[124:127], v[60:63]
    ds_read_b128 v[152:155], v5 offset:7168
    v_mfma_f32_16x16x32_bf16 v[32:35], v[140:143], a[52:55], v[32:35]
    ds_read_b128 v[108:111], v3 offset:40960
    v_mfma_f32_16x16x32_bf16 v[64:67], v[140:143], a[124:127], v[64:67]
    v_mfma_f32_16x16x32_bf16 v[36:39], a[52:55], v[132:135], v[36:39]
    v_mfma_f32_16x16x32_bf16 v[68:71], a[124:127], v[132:135], v[68:71]
    s_waitcnt lgkmcnt(13)
    v_mfma_f32_16x16x32_bf16 v[40:43], a[52:55], v[136:139], v[40:43]
    v_mfma_f32_16x16x32_bf16 v[72:75], a[124:127], v[136:139], v[72:75]
    s_waitcnt lgkmcnt(11)
    v_mfma_f32_16x16x32_bf16 v[80:83], v[160:163], v[156:159], v[80:83]
    s_waitcnt lgkmcnt(10)
    v_mfma_f32_16x16x32_bf16 v[84:87], v[156:159], v[164:167], v[84:87]
    s_waitcnt vmcnt(9) lgkmcnt(9)
    ds_read_b128 v[156:159], v10 offset:11264
    ds_read_b128 v[160:163], v4 offset:14336
    v_mfma_f32_16x16x32_bf16 v[16:19], v[88:91], a[56:59], v[16:19]
    s_waitcnt vmcnt(8)
    ds_read_b128 v[164:167], v5 offset:14336
    ds_read_b128 v[116:119], v3 offset:43008
    v_mfma_f32_16x16x32_bf16 v[48:51], v[88:91], a[128:131], v[48:51]
    s_waitcnt lgkmcnt(12)
    ds_read_b128 v[120:123], v3 offset:44032
    v_mfma_f32_16x16x32_bf16 v[20:23], v[92:95], a[56:59], v[20:23]
    v_mfma_f32_16x16x32_bf16 v[52:55], v[92:95], a[128:131], v[52:55]
    s_waitcnt lgkmcnt(12)
    ds_read_b128 v[124:127], v3 offset:45056
    v_mfma_f32_16x16x32_bf16 v[24:27], v[96:99], a[56:59], v[24:27]
    v_mfma_f32_16x16x32_bf16 v[56:59], v[96:99], a[128:131], v[56:59]
    s_waitcnt lgkmcnt(8)
    ds_read_b128 v[128:131], v3 offset:46080
    v_mfma_f32_16x16x32_bf16 v[80:83], v[148:151], v[144:147], v[80:83]
    s_waitcnt lgkmcnt(8)
    v_mfma_f32_16x16x32_bf16 v[84:87], v[144:147], v[152:155], v[84:87]
    ds_read_b128 v[140:143], v3 offset:49152
    ds_read_b128 v[144:147], v10 offset:12288
    v_mfma_f32_16x16x32_bf16 v[28:31], v[100:103], a[56:59], v[28:31]
    ds_read_b128 v[132:135], v3 offset:47104
    ds_read_b128 v[148:151], v4 offset:21504
    v_mfma_f32_16x16x32_bf16 v[60:63], v[100:103], a[128:131], v[60:63]
    ds_read_b128 v[152:155], v5 offset:21504
    v_mfma_f32_16x16x32_bf16 v[32:35], v[112:115], a[56:59], v[32:35]
    ds_read_b128 v[136:139], v3 offset:48128
    v_mfma_f32_16x16x32_bf16 v[64:67], v[112:115], a[128:131], v[64:67]
    v_mfma_f32_16x16x32_bf16 v[36:39], a[56:59], v[104:107], v[36:39]
    v_mfma_f32_16x16x32_bf16 v[68:71], a[128:131], v[104:107], v[68:71]
    s_waitcnt lgkmcnt(13)
    v_mfma_f32_16x16x32_bf16 v[40:43], a[56:59], v[108:111], v[40:43]
    v_mfma_f32_16x16x32_bf16 v[72:75], a[128:131], v[108:111], v[72:75]
    s_waitcnt lgkmcnt(11)
    v_mfma_f32_16x16x32_bf16 v[80:83], v[160:163], v[156:159], v[80:83]
    s_waitcnt lgkmcnt(10)
    v_mfma_f32_16x16x32_bf16 v[84:87], v[156:159], v[164:167], v[84:87]
    s_waitcnt vmcnt(7) lgkmcnt(9)
    ds_read_b128 v[156:159], v10 offset:13312
    ds_read_b128 v[160:163], v4 offset:28672
    v_mfma_f32_16x16x32_bf16 v[16:19], v[116:119], a[60:63], v[16:19]
    s_waitcnt vmcnt(6)
    ds_read_b128 v[164:167], v5 offset:28672
    ds_read_b128 v[88:91], v3 offset:50176
    v_mfma_f32_16x16x32_bf16 v[48:51], v[116:119], a[132:135], v[48:51]
    s_waitcnt lgkmcnt(12)
    ds_read_b128 v[92:95], v3 offset:51200
    v_mfma_f32_16x16x32_bf16 v[20:23], v[120:123], a[60:63], v[20:23]
    v_mfma_f32_16x16x32_bf16 v[52:55], v[120:123], a[132:135], v[52:55]
    s_waitcnt lgkmcnt(12)
    ds_read_b128 v[96:99], v3 offset:52224
    v_mfma_f32_16x16x32_bf16 v[24:27], v[124:127], a[60:63], v[24:27]
    v_mfma_f32_16x16x32_bf16 v[56:59], v[124:127], a[132:135], v[56:59]
    s_waitcnt lgkmcnt(8)
    ds_read_b128 v[100:103], v3 offset:53248
    v_mfma_f32_16x16x32_bf16 v[80:83], v[148:151], v[144:147], v[80:83]
    s_waitcnt lgkmcnt(8)
    v_mfma_f32_16x16x32_bf16 v[84:87], v[144:147], v[152:155], v[84:87]
    ds_read_b128 v[112:115], v3 offset:56320
    ds_read_b128 v[144:147], v10 offset:14336
    v_mfma_f32_16x16x32_bf16 v[28:31], v[128:131], a[60:63], v[28:31]
    ds_read_b128 v[104:107], v3 offset:54272
    ds_read_b128 v[148:151], v4 offset:35840
    v_mfma_f32_16x16x32_bf16 v[60:63], v[128:131], a[132:135], v[60:63]
    ds_read_b128 v[152:155], v5 offset:35840
    v_mfma_f32_16x16x32_bf16 v[32:35], v[140:143], a[60:63], v[32:35]
    ds_read_b128 v[108:111], v3 offset:55296
    v_mfma_f32_16x16x32_bf16 v[64:67], v[140:143], a[132:135], v[64:67]
    v_mfma_f32_16x16x32_bf16 v[36:39], a[60:63], v[132:135], v[36:39]
    v_mfma_f32_16x16x32_bf16 v[68:71], a[132:135], v[132:135], v[68:71]
    s_waitcnt lgkmcnt(13)
    v_mfma_f32_16x16x32_bf16 v[40:43], a[60:63], v[136:139], v[40:43]
    v_mfma_f32_16x16x32_bf16 v[72:75], a[132:135], v[136:139], v[72:75]
    s_waitcnt lgkmcnt(11)
    v_mfma_f32_16x16x32_bf16 v[80:83], v[160:163], v[156:159], v[80:83]
    s_waitcnt lgkmcnt(10)
    v_mfma_f32_16x16x32_bf16 v[84:87], v[156:159], v[164:167], v[84:87]
    s_waitcnt vmcnt(5) lgkmcnt(9)
    ds_read_b128 v[156:159], v10 offset:15360
    ds_read_b128 v[160:163], v4 offset:43008
    v_mfma_f32_16x16x32_bf16 v[16:19], v[88:91], a[64:67], v[16:19]
    s_waitcnt vmcnt(4)
    ds_read_b128 v[164:167], v5 offset:43008
    ds_read_b128 v[116:119], v3 offset:57344
    v_mfma_f32_16x16x32_bf16 v[48:51], v[88:91], a[136:139], v[48:51]
    s_waitcnt lgkmcnt(12)
    ds_read_b128 v[120:123], v3 offset:58368
    v_mfma_f32_16x16x32_bf16 v[20:23], v[92:95], a[64:67], v[20:23]
    v_mfma_f32_16x16x32_bf16 v[52:55], v[92:95], a[136:139], v[52:55]
    s_waitcnt lgkmcnt(12)
    ds_read_b128 v[124:127], v3 offset:59392
    v_mfma_f32_16x16x32_bf16 v[24:27], v[96:99], a[64:67], v[24:27]
    v_mfma_f32_16x16x32_bf16 v[56:59], v[96:99], a[136:139], v[56:59]
    s_waitcnt lgkmcnt(8)
    ds_read_b128 v[128:131], v3 offset:60416
    v_mfma_f32_16x16x32_bf16 v[80:83], v[148:151], v[144:147], v[80:83]
    s_waitcnt lgkmcnt(8)
    v_mfma_f32_16x16x32_bf16 v[84:87], v[144:147], v[152:155], v[84:87]
    ds_read_b128 v[140:143], v3 offset:63488
    ds_read_b128 v[144:147], v10 offset:16384
    v_mfma_f32_16x16x32_bf16 v[28:31], v[100:103], a[64:67], v[28:31]
    ds_read_b128 v[132:135], v3 offset:61440
    ds_read_b128 v[148:151], v4 offset:50176
    v_mfma_f32_16x16x32_bf16 v[60:63], v[100:103], a[136:139], v[60:63]
    ds_read_b128 v[152:155], v5 offset:50176
    v_mfma_f32_16x16x32_bf16 v[32:35], v[112:115], a[64:67], v[32:35]
    ds_read_b128 v[136:139], v3 offset:62464
    v_mfma_f32_16x16x32_bf16 v[64:67], v[112:115], a[136:139], v[64:67]
    v_mfma_f32_16x16x32_bf16 v[36:39], a[64:67], v[104:107], v[36:39]
    v_mfma_f32_16x16x32_bf16 v[68:71], a[136:139], v[104:107], v[68:71]
    s_waitcnt lgkmcnt(13)
    v_mfma_f32_16x16x32_bf16 v[40:43], a[64:67], v[108:111], v[40:43]
    v_mfma_f32_16x16x32_bf16 v[72:75], a[136:139], v[108:111], v[72:75]
    s_waitcnt lgkmcnt(11)
    v_mfma_f32_16x16x32_bf16 v[80:83], v[160:163], v[156:159], v[80:83]
    s_waitcnt lgkmcnt(10)
    v_mfma_f32_16x16x32_bf16 v[84:87], v[156:159], v[164:167], v[84:87]
    s_waitcnt vmcnt(3) lgkmcnt(9)
    ds_read_b128 v[156:159], v10 offset:17408
    ds_read_b128 v[160:163], v4 offset:57344
    v_mfma_f32_16x16x32_bf16 v[16:19], v[116:119], a[68:71], v[16:19]
    s_waitcnt vmcnt(2)
    ds_read_b128 v[164:167], v5 offset:57344
    v_mfma_f32_16x16x32_bf16 v[48:51], v[116:119], a[140:143], v[48:51]
    s_waitcnt lgkmcnt(11)
    v_mfma_f32_16x16x32_bf16 v[20:23], v[120:123], a[68:71], v[20:23]
    v_mfma_f32_16x16x32_bf16 v[52:55], v[120:123], a[140:143], v[52:55]
    s_waitcnt lgkmcnt(10)
    v_mfma_f32_16x16x32_bf16 v[24:27], v[124:127], a[68:71], v[24:27]
    v_mfma_f32_16x16x32_bf16 v[56:59], v[124:127], a[140:143], v[56:59]
    s_waitcnt lgkmcnt(5)
    v_mfma_f32_16x16x32_bf16 v[80:83], v[148:151], v[144:147], v[80:83]
    s_waitcnt lgkmcnt(4)
    v_mfma_f32_16x16x32_bf16 v[84:87], v[144:147], v[152:155], v[84:87]
    v_mfma_f32_16x16x32_bf16 v[28:31], v[128:131], a[68:71], v[28:31]
    v_mfma_f32_16x16x32_bf16 v[60:63], v[128:131], a[140:143], v[60:63]
    v_mfma_f32_16x16x32_bf16 v[32:35], v[140:143], a[68:71], v[32:35]
    v_mfma_f32_16x16x32_bf16 v[64:67], v[140:143], a[140:143], v[64:67]
    v_mfma_f32_16x16x32_bf16 v[36:39], a[68:71], v[132:135], v[36:39]
    v_mfma_f32_16x16x32_bf16 v[68:71], a[140:143], v[132:135], v[68:71]
    s_waitcnt lgkmcnt(3)
    v_mfma_f32_16x16x32_bf16 v[40:43], a[68:71], v[136:139], v[40:43]
    v_mfma_f32_16x16x32_bf16 v[72:75], a[140:143], v[136:139], v[72:75]
    s_waitcnt lgkmcnt(1)
    v_mfma_f32_16x16x32_bf16 v[80:83], v[160:163], v[156:159], v[80:83]
    s_waitcnt lgkmcnt(0)
    v_mfma_f32_16x16x32_bf16 v[84:87], v[156:159], v[164:167], v[84:87]
    v_lshlrev_b32 v6, 3, v1
    v_add_u32 v6, 148608, v6
    s_mul_i32 s52, s20, 3072
    v_add_u32 v7, s52, v6
    s_lshl_b32 s52, s20, 8
    s_add_u32 s52, s52, 161024
    v_lshl_add_u32 v13, v1, 3, s52
    v_lshrrev_b32 v14, 2, v1
    v_lshl_add_u32 v14, v14, 3, s52
    v_cvt_pk_bf16_f32 v100, v56, v57
    v_cvt_pk_bf16_f32 v101, v58, v59
    v_cvt_pk_bf16_f32 v104, v60, v61
    v_cvt_pk_bf16_f32 v105, v62, v63
    v_cvt_pk_bf16_f32 v134, v64, v65
    v_cvt_pk_bf16_f32 v137, v66, v67
    v_mov_b32 v102, 0
    v_mov_b32 v103, 0
    v_cvt_pk_bf16_f32 v110, v68, v69
    v_cvt_pk_bf16_f32 v111, v70, v71
    v_cvt_pk_bf16_f32 v116, v72, v73
    v_cvt_pk_bf16_f32 v117, v74, v75
    s_mov_b32 exec_lo, 0xffff0000
    s_mov_b32 exec_hi, 0
    ds_write2_b32 v13, v134, v137 offset0:64 offset1:65
    s_mov_b64 exec, -1
    v_permlane32_swap_b32 v134, v102
    v_permlane32_swap_b32 v137, v103
    s_cmp_eq_u32 s20, 3
    s_cbranch_scc1 L_w3_108
    ds_write_b64 v7, v[100:101] offset:3072
    ds_write_b64 v7, v[102:103] offset:3584
    ds_write_b64 v7, v[104:105] offset:4096
    ds_write_b64 v7, v[110:111] offset:4608
    ds_write_b64 v7, v[116:117] offset:5120
L_w3_108:
    v_cvt_pk_bf16_f32 v140, v80, v81
    v_cvt_pk_bf16_f32 v141, v82, v83
    v_cvt_pk_bf16_f32 v142, v84, v85
    v_cvt_pk_bf16_f32 v143, v86, v87
    s_min_u32 s52, s20, 2
    s_lshl_b32 s53, s52, 1
    s_cmp_ge_u32 s20, 2
    s_cselect_b32 s53, 1, s53
    s_lshl_b32 s53, s53, 9
    s_and_b32 s52, s20, 1
    s_add_u32 s52, s52, 3
    s_lshl_b32 s52, s52, 9
    v_add_u32 v8, s53, v6
    v_add_u32 v9, s52, v6
    s_cmp_lt_u32 s20, 2
    s_cbranch_scc1 L_noswap_109
    v_lshlrev_b32 v10, 3, v1
    v_add_u32 v10, 161024, v10
    s_mov_b32 exec_lo, 0xffff0000
    s_mov_b32 exec_hi, 0
    ds_write_b64 v10, v[140:141]
    s_mov_b64 exec, -1
    v_mov_b32 v10, 0
    v_mov_b32 v11, 0
    s_nop 1
    v_permlane32_swap_b32 v140, v10
    v_permlane32_swap_b32 v141, v11
    v_mov_b32 v140, v10
    v_mov_b32 v141, v11
L_noswap_109:
    ds_write_b64 v8, v[140:141]
    ds_write_b64 v9, v[142:143]
    v_cvt_pk_bf16_f32 v132, v48, v49
    v_cvt_pk_bf16_f32 v133, v50, v51
    v_cvt_pk_bf16_f32 v138, v52, v53
    v_cvt_pk_bf16_f32 v139, v54, v55
    v_mov_b32 v135, 0
    v_mov_b32 v136, 0
    v_cvt_pk_bf16_f32 v94, v24, v25
    v_cvt_pk_bf16_f32 v95, v26, v27
    v_cvt_pk_bf16_f32 v98, v28, v29
    v_cvt_pk_bf16_f32 v99, v30, v31
    v_cvt_pk_bf16_f32 v126, v32, v33
    v_cvt_pk_bf16_f32 v129, v34, v35
    v_mov_b32 v96, 0
    v_mov_b32 v97, 0
    v_cvt_pk_bf16_f32 v108, v36, v37
    v_cvt_pk_bf16_f32 v109, v38, v39
    v_cvt_pk_bf16_f32 v114, v40, v41
    v_cvt_pk_bf16_f32 v115, v42, v43
    s_mov_b32 exec_lo, 0xffff0000
    s_mov_b32 exec_hi, 0
    ds_write2_b32 v13, v126, v129 offset0:32 offset1:33
    s_mov_b64 exec, -1
    v_permlane32_swap_b32 v126, v96
    v_permlane32_swap_b32 v129, v97
    v_cvt_pk_bf16_f32 v124, v16, v17
    v_cvt_pk_bf16_f32 v125, v18, v19
    v_cvt_pk_bf16_f32 v130, v20, v21
    v_cvt_pk_bf16_f32 v131, v22, v23
    v_mov_b32 v127, 0
    v_mov_b32 v128, 0
    v_mov_b32 v144, 0x3f803f80
    v_mov_b32 v145, 0x3f803f80
    v_mov_b32 v146, 0x3f803f80
    v_mov_b32 v147, 0x3f803f80
    v_mfma_f32_16x16x32_bf16 v[32:35], v[94:97], v[132:135], v[172:175]
    v_mfma_f32_16x16x32_bf16 v[36:39], v[100:103], v[132:135], v[168:171]
    v_mfma_f32_16x16x32_bf16 v[20:23], v[94:97], v[124:127], v[168:171]
    v_mfma_f32_16x16x32_bf16 v[40:43], v[96:99], v[136:139], v[172:175]
    v_mfma_f32_16x16x32_bf16 v[44:47], v[102:105], v[136:139], v[168:171]
    v_mfma_f32_16x16x32_bf16 v[28:31], v[96:99], v[128:131], v[168:171]
    s_waitcnt lgkmcnt(0)
    s_barrier
    ds_read_b64 v[88:89], v7 offset:0
    ds_read_b64 v[90:91], v7 offset:512
    ds_read_b64 v[92:93], v7 offset:1024
    ds_read_b64 v[106:107], v7 offset:1536
    ds_read_b64 v[112:113], v7 offset:2048
    ds_read_b64_tr_b16 v[118:119], v14 offset:128
    ds_read_b64_tr_b16 v[120:121], v14 offset:256
    ds_read_b64_tr_b16 v[122:123], v14 offset:384
    s_mov_b32 s52, 0x3eae1a93
    s_waitcnt lgkmcnt(6)
    v_mfma_f32_16x16x32_bf16 v[16:19], v[88:91], v[124:127], v[176:179]
    s_waitcnt lgkmcnt(5)
    v_mfma_f32_16x16x32_bf16 v[24:27], v[90:93], v[128:131], v[176:179]
    v_max3_f32 v48, v32, v33, v34
    v_max3_f32 v49, v40, v41, v42
    s_nop 3
    v_max3_f32 v50, v16, v17, v18
    s_nop 0
    v_max3_f32 v51, v24, v25, v26
    v_max3_f32 v48, v48, v35, v36
    v_max3_f32 v49, v49, v43, v44
    v_max3_f32 v50, v50, v19, v20
    v_max3_f32 v51, v51, v27, v28
    v_max3_f32 v48, v48, v37, v38
    v_max3_f32 v49, v49, v45, v46
    v_max3_f32 v50, v50, v21, v22
    v_max3_f32 v51, v51, v29, v30
    v_max_f32 v48, v48, v39
    v_max_f32 v49, v49, v47
    v_max_f32 v50, v50, v23
    v_max_f32 v51, v51, v31
    v_mov_b32 v52, v48
    v_mov_b32 v53, v49
    v_mov_b32 v54, v50
    v_mov_b32 v55, v51
    v_permlane16_swap_b32 v48, v52
    v_permlane16_swap_b32 v49, v53
    v_permlane16_swap_b32 v50, v54
    v_permlane16_swap_b32 v51, v55
    v_max_f32 v48, v48, v52
    v_max_f32 v49, v49, v53
    v_max_f32 v50, v50, v54
    v_max_f32 v51, v51, v55
    v_mov_b32 v52, v48
    v_mov_b32 v53, v49
    v_mov_b32 v54, v50
    v_mov_b32 v55, v51
    v_permlane32_swap_b32 v48, v52
    v_permlane32_swap_b32 v49, v53
    v_permlane32_swap_b32 v50, v54
    v_permlane32_swap_b32 v51, v55
    v_max_f32 v48, v48, v52
    v_max_f32 v49, v49, v53
    v_max_f32 v50, v50, v54
    v_max_f32 v51, v51, v55
    v_mul_f32 v48, s52, v48
    v_mul_f32 v49, s52, v49
    v_mul_f32 v50, s52, v50
    v_mul_f32 v51, s52, v51
    v_fma_f32 v32, v32, s52, -v48
    v_fma_f32 v40, v40, s52, -v49
    v_fma_f32 v16, v16, s52, -v50
    v_fma_f32 v24, v24, s52, -v51
    v_fma_f32 v33, v33, s52, -v48
    v_fma_f32 v41, v41, s52, -v49
    v_fma_f32 v17, v17, s52, -v50
    v_fma_f32 v25, v25, s52, -v51
    v_fma_f32 v34, v34, s52, -v48
    v_fma_f32 v42, v42, s52, -v49
    v_fma_f32 v18, v18, s52, -v50
    v_fma_f32 v26, v26, s52, -v51
    v_fma_f32 v35, v35, s52, -v48
    v_fma_f32 v43, v43, s52, -v49
    v_fma_f32 v19, v19, s52, -v50
    v_fma_f32 v27, v27, s52, -v51
    v_fma_f32 v36, v36, s52, -v48
    v_fma_f32 v44, v44, s52, -v49
    v_fma_f32 v20, v20, s52, -v50
    v_fma_f32 v28, v28, s52, -v51
    v_fma_f32 v37, v37, s52, -v48
    v_fma_f32 v45, v45, s52, -v49
    v_fma_f32 v21, v21, s52, -v50
    v_fma_f32 v29, v29, s52, -v51
    v_fma_f32 v38, v38, s52, -v48
    v_fma_f32 v46, v46, s52, -v49
    v_fma_f32 v22, v22, s52, -v50
    v_fma_f32 v30, v30, s52, -v51
    v_fma_f32 v39, v39, s52, -v48
    v_fma_f32 v47, v47, s52, -v49
    v_fma_f32 v23, v23, s52, -v50
    v_fma_f32 v31, v31, s52, -v51
    v_exp_f32 v32, v32
    v_exp_f32 v40, v40
    v_exp_f32 v16, v16
    v_exp_f32 v24, v24
    v_exp_f32 v33, v33
    v_exp_f32 v41, v41
    v_exp_f32 v17, v17
    v_exp_f32 v25, v25
    v_exp_f32 v34, v34
    v_exp_f32 v42, v42
    v_exp_f32 v18, v18
    v_exp_f32 v26, v26
    v_exp_f32 v35, v35
    v_exp_f32 v43, v43
    v_exp_f32 v19, v19
    v_exp_f32 v27, v27
    v_exp_f32 v36, v36
    v_exp_f32 v44, v44
    v_exp_f32 v20, v20
    v_exp_f32 v28, v28
    v_exp_f32 v37, v37
    v_exp_f32 v45, v45
    v_exp_f32 v21, v21
    v_exp_f32 v29, v29
    v_exp_f32 v38, v38
    v_exp_f32 v46, v46
    v_exp_f32 v22, v22
    v_exp_f32 v30, v30
    v_exp_f32 v39, v39
    v_exp_f32 v47, v47
    v_exp_f32 v23, v23
    v_exp_f32 v31, v31
    v_cvt_pk_bf16_f32 v56, v32, v33
    v_cvt_pk_bf16_f32 v60, v40, v41
    v_cvt_pk_bf16_f32 v64, v16, v17
    v_cvt_pk_bf16_f32 v68, v24, v25
    v_cvt_pk_bf16_f32 v57, v34, v35
    v_cvt_pk_bf16_f32 v61, v42, v43
    v_cvt_pk_bf16_f32 v65, v18, v19
    v_cvt_pk_bf16_f32 v69, v26, v27
    v_cvt_pk_bf16_f32 v58, v36, v37
    v_cvt_pk_bf16_f32 v62, v44, v45
    v_cvt_pk_bf16_f32 v66, v20, v21
    v_cvt_pk_bf16_f32 v70, v28, v29
    v_cvt_pk_bf16_f32 v59, v38, v39
    v_cvt_pk_bf16_f32 v63, v46, v47
    v_cvt_pk_bf16_f32 v67, v22, v23
    v_cvt_pk_bf16_f32 v71, v30, v31
    v_mfma_f32_16x16x32_bf16 v[188:191], v[144:147], v[56:59], 0
    v_mfma_f32_16x16x32_bf16 v[180:183], v[108:111], v[56:59], 0
    s_waitcnt lgkmcnt(0)
    v_mfma_f32_16x16x32_bf16 v[184:187], v[120:123], v[56:59], 0
    v_mfma_f32_16x16x32_bf16 v[200:203], v[144:147], v[60:63], 0
    v_mfma_f32_16x16x32_bf16 v[192:195], v[114:117], v[60:63], 0
    v_mfma_f32_16x16x32_bf16 v[196:199], v[120:123], v[60:63], 0
    v_mfma_f32_16x16x32_bf16 v[212:215], v[144:147], v[64:67], 0
    v_mfma_f32_16x16x32_bf16 v[204:207], v[106:109], v[64:67], 0
    v_mfma_f32_16x16x32_bf16 v[208:211], v[118:121], v[64:67], 0
    v_mfma_f32_16x16x32_bf16 v[224:227], v[144:147], v[68:71], 0
    s_waitcnt vmcnt(0)
    v_mfma_f32_16x16x32_bf16 v[216:219], v[112:115], v[68:71], 0
    v_mfma_f32_16x16x32_bf16 v[220:223], v[118:121], v[68:71], 0
    s_lshl_b32 s53, s46, 4
    s_add_u32 s53, s53, s45
    s_lshl_b32 s54, s53, 10
    s_add_u32 s54, s54, 23330816
    s_lshl_b32 s55, s53, 7
    s_add_u32 s55, s55, 25427840
    v_lshlrev_b32 v6, 3, v1
    v_rcp_f32 v188, v188
    v_rcp_f32 v200, v200
    v_rcp_f32 v212, v212
    v_rcp_f32 v224, v224
    v_mul_f32 v180, v180, v188
    v_mul_f32 v181, v181, v188
    v_mul_f32 v182, v182, v188
    v_mul_f32 v183, v183, v188
    v_mul_f32 v184, v184, v188
    v_mul_f32 v185, v185, v188
    v_cvt_pk_bf16_f32 v76, v180, v181
    v_cvt_pk_bf16_f32 v77, v182, v183
    v_cvt_pk_bf16_f32 v82, v184, v185
    v_mul_f32 v192, v192, v200
    v_mul_f32 v193, v193, v200
    v_mul_f32 v194, v194, v200
    v_mul_f32 v195, v195, v200
    v_mul_f32 v198, v198, v200
    v_mul_f32 v199, v199, v200
    v_cvt_pk_bf16_f32 v78, v192, v193
    v_cvt_pk_bf16_f32 v79, v194, v195
    v_cvt_pk_bf16_f32 v83, v198, v199
    s_add_u32 s53, s54, 16384
    buffer_store_dwordx4 v[76:79], v2, s[4:7], s53 offen sc1
    v_mul_f32 v204, v204, v212
    v_mul_f32 v205, v205, v212
    v_mul_f32 v206, v206, v212
    v_mul_f32 v207, v207, v212
    v_mul_f32 v208, v208, v212
    v_mul_f32 v209, v209, v212
    v_cvt_pk_bf16_f32 v72, v204, v205
    v_cvt_pk_bf16_f32 v73, v206, v207
    v_cvt_pk_bf16_f32 v80, v208, v209
    v_mul_f32 v216, v216, v224
    v_mul_f32 v217, v217, v224
    v_mul_f32 v218, v218, v224
    v_mul_f32 v219, v219, v224
    v_mul_f32 v222, v222, v224
    v_mul_f32 v223, v223, v224
    v_cvt_pk_bf16_f32 v74, v216, v217
    v_cvt_pk_bf16_f32 v75, v218, v219
    v_cvt_pk_bf16_f32 v81, v222, v223
    s_add_u32 s53, s54, 0
    buffer_store_dwordx4 v[72:75], v2, s[4:7], s53 offen sc1
    s_mov_b32 exec_lo, 0xffff0000
    s_mov_b32 exec_hi, 0
    buffer_store_dwordx2 v[80:81], v6, s[4:7], s55 offen offset:0 sc1
    buffer_store_dwordx2 v[82:83], v6, s[4:7], s55 offen offset:2048 sc1
    s_mov_b64 exec, -1
    s_lshl_b32 s52, s44, 2
    s_add_u32 s52, s52, s20
    s_lshl_b32 s52, s52, 4
    s_add_u32 s52, s52, s45
    s_lshl_b32 s52, s52, 3
    s_add_u32 s52, s52, 24576
    v_mov_b32 v8, s98
    v_mov_b32 v9, s99
    s_waitcnt vmcnt(0)
    s_lshl_b32 s52, s52, 2
    s_add_u32 s52, s52, 0x8000000
    s_mov_b64 exec, 1
    buffer_store_dwordx2 v[8:9], off, s[4:7], s52 sc1
    s_mov_b64 exec, -1
    s_cmp_ge_u32 s22, 24
    s_cbranch_scc1 L_next_52
    s_mul_i32 s44, s22, 10923
    s_lshr_b32 s44, s44, 16
    s_mul_i32 s52, s44, 6
    s_sub_u32 s45, s22, s52
    s_lshl_b32 s52, s21, 2
    s_add_u32 s44, s44, s52
    s_lshl_b32 s46, s44, 2
    s_add_u32 s46, s46, s20
    s_mul_i32 s47, s45, 110592
    s_mul_i32 s48, s20, 3072
    s_add_u32 s47, s47, s48
    s_add_u32 s47, s47, 2097152
    s_lshl_b32 s49, s46, 14
    s_add_u32 s49, s49, 23330816
    s_lshl_b32 s50, s46, 11
    s_add_u32 s50, s50, 25427968
    v_and_b32 v3, 15, v1
    v_lshrrev_b32 v4, 4, v1
    v_lshlrev_b32 v5, 3, v3
    v_lshl_add_u32 v5, v4, 8, v5
    s_lshl_b32 s52, s46, 4
    v_add_u32 v6, s52, v3
    v_lshlrev_b32 v7, 3, v6
    v_mul_u32_u24 v6, 1152, v6
    v_lshl_add_u32 v6, v4, 4, v6
    s_mul_i32 s51, s45, 192
    s_add_u32 s8, s42, 28311552
    s_addc_u32 s9, s43, 0
    s_mov_b32 s10, 0x240000
    s_mov_b32 s11, 0x20000
    s_mov_b32 m0, s48
    s_nop 0
    buffer_load_dwordx4 v2, s[4:7], s47 offen offset:0 lds
    buffer_load_dwordx4 v2, s[4:7], s47 offen offset:1024 lds
    buffer_load_dwordx4 v2, s[4:7], s47 offen offset:2048 lds
    s_add_u32 s48, s48, 12288
    s_add_u32 s47, s47, 12288
    s_mov_b32 m0, s48
    s_nop 0
    buffer_load_dwordx4 v2, s[4:7], s47 offen offset:0 lds
    buffer_load_dwordx4 v2, s[4:7], s47 offen offset:1024 lds
    buffer_load_dwordx4 v2, s[4:7], s47 offen offset:2048 lds
    s_add_u32 s48, s48, 12288
    s_add_u32 s47, s47, 12288
    s_mov_b32 m0, s48
    s_nop 0
    buffer_load_dwordx4 v2, s[4:7], s47 offen offset:0 lds
    buffer_load_dwordx4 v2, s[4:7], s47 offen offset:1024 lds
    buffer_load_dwordx4 v2, s[4:7], s47 offen offset:2048 lds
    s_add_u32 s48, s48, 12288
    s_add_u32 s47, s47, 12288
    s_mov_b32 m0, s48
    s_nop 0
    buffer_load_dwordx4 v2, s[4:7], s47 offen offset:0 lds
    buffer_load_dwordx4 v2, s[4:7], s47 offen offset:1024 lds
    buffer_load_dwordx4 v2, s[4:7], s47 offen offset:2048 lds
    s_add_u32 s48, s48, 12288
    s_add_u32 s47, s47, 12288
    s_mov_b32 m0, s48
    s_nop 0
    buffer_load_dwordx4 v2, s[4:7], s47 offen offset:0 lds
    buffer_load_dwordx4 v2, s[4:7], s47 offen offset:1024 lds
    buffer_load_dwordx4 v2, s[4:7], s47 offen offset:2048 lds
    s_add_u32 s48, s48, 12288
    s_add_u32 s47, s47, 12288
    s_mov_b32 m0, s48
    s_nop 0
    buffer_load_dwordx4 v2, s[4:7], s47 offen offset:0 lds
    buffer_load_dwordx4 v2, s[4:7], s47 offen offset:1024 lds
    buffer_load_dwordx4 v2, s[4:7], s47 offen offset:2048 lds
    s_add_u32 s48, s48, 12288
    s_add_u32 s47, s47, 12288
    s_mov_b32 m0, s48
    s_nop 0
    buffer_load_dwordx4 v2, s[4:7], s47 offen offset:0 lds
    buffer_load_dwordx4 v2, s[4:7], s47 offen offset:1024 lds
    buffer_load_dwordx4 v2, s[4:7], s47 offen offset:2048 lds
    s_add_u32 s48, s48, 12288
    s_add_u32 s47, s47, 12288
    s_mov_b32 m0, s48
    s_nop 0
    buffer_load_dwordx4 v2, s[4:7], s47 offen offset:0 lds
    buffer_load_dwordx4 v2, s[4:7], s47 offen offset:1024 lds
    buffer_load_dwordx4 v2, s[4:7], s47 offen offset:2048 lds
    s_add_u32 s48, s48, 12288
    s_add_u32 s47, s47, 12288
    s_mov_b32 m0, s48
    s_nop 0
    buffer_load_dwordx4 v2, s[4:7], s47 offen offset:0 lds
    buffer_load_dwordx4 v2, s[4:7], s47 offen offset:1024 lds
    buffer_load_dwordx4 v2, s[4:7], s47 offen offset:2048 lds
    s_add_u32 s48, s48, 12288
    s_add_u32 s47, s47, 12288
    s_lshr_b32 s52, s46, 1
    s_lshl_b32 s52, s52, 7
    s_add_u32 s52, s52, 24576
    v_and_b32 v10, 15, v1
    v_lshlrev_b32 v10, 3, v10
    s_mul_i32 s53, s45, 2816
    s_min_u32 s53, s53, 13568
    s_add_u32 s53, s53, s49
    buffer_load_dwordx4 v[160:163], v6, s[8:11], s51 offen offset:0 sc1
    buffer_load_dwordx4 v[164:167], v6, s[8:11], s51 offen offset:64 sc1
    buffer_load_dwordx4 v[168:171], v6, s[8:11], s51 offen offset:128 sc1
    v_mov_b32 v8, v2
    s_waitcnt vmcnt(3)
    s_barrier
    s_lshl_b32 s52, s52, 2
    s_add_u32 s52, s52, 0x8000000
    v_lshlrev_b32 v10, 2, v10
    buffer_load_dwordx2 v[12:13], v10, s[4:7], s52 offen sc1
    ds_read_b128 a[0:3], v8 offset:0
    ds_read_b128 a[4:7], v8 offset:1024
    ds_read_b128 a[8:11], v8 offset:2048
    ds_read_b128 a[12:15], v8 offset:3072
    ds_read_b128 a[16:19], v8 offset:4096
    ds_read_b128 a[20:23], v8 offset:5120
    ds_read_b128 a[24:27], v8 offset:6144
    ds_read_b128 a[28:31], v8 offset:7168
    ds_read_b128 a[32:35], v8 offset:8192
    ds_read_b128 a[36:39], v8 offset:9216
    ds_read_b128 a[40:43], v8 offset:10240
    ds_read_b128 a[44:47], v8 offset:11264
    ds_read_b128 a[48:51], v8 offset:12288
    ds_read_b128 a[52:55], v8 offset:13312
    ds_read_b128 a[56:59], v8 offset:14336
    ds_read_b128 a[60:63], v8 offset:15360
    ds_read_b128 a[64:67], v8 offset:16384
    ds_read_b128 a[68:71], v8 offset:17408
    ds_read_b128 a[72:75], v8 offset:18432
    ds_read_b128 a[76:79], v8 offset:19456
    ds_read_b128 a[80:83], v8 offset:20480
    ds_read_b128 a[84:87], v8 offset:21504
    ds_read_b128 a[88:91], v8 offset:22528
    ds_read_b128 a[92:95], v8 offset:23552
    ds_read_b128 v[112:115], v8 offset:24576
    ds_read_b128 v[116:119], v8 offset:25600
    ds_read_b128 v[120:123], v8 offset:26624
    ds_read_b128 v[124:127], v8 offset:27648
    ds_read_b128 v[128:131], v8 offset:28672
    ds_read_b128 v[132:135], v8 offset:29696
    ds_read_b128 v[136:139], v8 offset:30720
    ds_read_b128 v[140:143], v8 offset:31744
    ds_read_b128 v[144:147], v8 offset:32768
    ds_read_b128 v[148:151], v8 offset:33792
    s_waitcnt vmcnt(0)
    v_cmp_eq_u64 vcc, s[98:99], v[12:13]
    s_nop 0
    s_cmp_eq_u64 vcc, exec
    s_cbranch_scc0 L_po_slow_110
L_po_back_111:
    buffer_load_dwordx4 v[16:19], v2, s[4:7], s49 offen offset:0 sc1
    buffer_load_dwordx4 v[20:23], v2, s[4:7], s49 offen offset:1024 sc1
    buffer_load_dwordx4 v[24:27], v2, s[4:7], s49 offen offset:2048 sc1
    buffer_load_dwordx4 v[28:31], v2, s[4:7], s49 offen offset:3072 sc1
    s_add_u32 s49, s49, 4096
    buffer_load_dwordx4 v[32:35], v2, s[4:7], s49 offen offset:0 sc1
    buffer_load_dwordx4 v[36:39], v2, s[4:7], s49 offen offset:1024 sc1
    buffer_load_dwordx4 v[40:43], v2, s[4:7], s49 offen offset:2048 sc1
    buffer_load_dwordx4 v[44:47], v2, s[4:7], s49 offen offset:3072 sc1
    s_waitcnt vmcnt(7) lgkmcnt(15)
    s_add_u32 s49, s49, 4096
    v_mfma_f32_16x16x32_bf16 v[88:91], a[0:3], v[16:19], 0
    buffer_load_dwordx4 v[48:51], v2, s[4:7], s49 offen offset:0 sc1
    s_waitcnt lgkmcnt(15)
    v_mfma_f32_16x16x32_bf16 v[92:95], a[4:7], v[16:19], 0
    s_waitcnt lgkmcnt(15)
    v_mfma_f32_16x16x32_bf16 v[96:99], a[8:11], v[16:19], 0
    s_waitcnt lgkmcnt(15)
    v_mfma_f32_16x16x32_bf16 v[100:103], a[12:15], v[16:19], 0
    buffer_load_dwordx4 v[52:55], v2, s[4:7], s49 offen offset:1024 sc1
    s_waitcnt lgkmcnt(15)
    v_mfma_f32_16x16x32_bf16 v[104:107], a[16:19], v[16:19], 0
    s_waitcnt lgkmcnt(15)
    v_mfma_f32_16x16x32_bf16 v[108:111], a[20:23], v[16:19], 0
    s_waitcnt vmcnt(8) lgkmcnt(15)
    v_mfma_f32_16x16x32_bf16 v[88:91], a[24:27], v[20:23], v[88:91]
    buffer_load_dwordx4 v[56:59], v2, s[4:7], s49 offen offset:2048 sc1
    s_waitcnt lgkmcnt(15)
    v_mfma_f32_16x16x32_bf16 v[92:95], a[28:31], v[20:23], v[92:95]
    s_waitcnt lgkmcnt(15)
    v_mfma_f32_16x16x32_bf16 v[96:99], a[32:35], v[20:23], v[96:99]
    s_waitcnt lgkmcnt(15)
    v_mfma_f32_16x16x32_bf16 v[100:103], a[36:39], v[20:23], v[100:103]
    buffer_load_dwordx4 v[60:63], v2, s[4:7], s49 offen offset:3072 sc1
    s_waitcnt lgkmcnt(15)
    v_mfma_f32_16x16x32_bf16 v[104:107], a[40:43], v[20:23], v[104:107]
    s_waitcnt lgkmcnt(15)
    s_add_u32 s49, s49, 4096
    v_mfma_f32_16x16x32_bf16 v[108:111], a[44:47], v[20:23], v[108:111]
    s_waitcnt vmcnt(9) lgkmcnt(15)
    v_mfma_f32_16x16x32_bf16 v[88:91], a[48:51], v[24:27], v[88:91]
    buffer_load_dwordx4 v[64:67], v2, s[4:7], s49 offen offset:0 sc1
    s_waitcnt lgkmcnt(15)
    v_mfma_f32_16x16x32_bf16 v[92:95], a[52:55], v[24:27], v[92:95]
    s_waitcnt lgkmcnt(15)
    v_mfma_f32_16x16x32_bf16 v[96:99], a[56:59], v[24:27], v[96:99]
    s_waitcnt lgkmcnt(15)
    v_mfma_f32_16x16x32_bf16 v[100:103], a[60:63], v[24:27], v[100:103]
    buffer_load_dwordx4 v[68:71], v2, s[4:7], s49 offen offset:1024 sc1
    s_waitcnt lgkmcnt(15)
    v_mfma_f32_16x16x32_bf16 v[104:107], a[64:67], v[24:27], v[104:107]
    s_waitcnt lgkmcnt(15)
    v_mfma_f32_16x16x32_bf16 v[108:111], a[68:71], v[24:27], v[108:111]
    s_waitcnt vmcnt(10) lgkmcnt(15)
    v_mfma_f32_16x16x32_bf16 v[88:91], a[72:75], v[28:31], v[88:91]
    buffer_load_dwordx4 v[72:75], v2, s[4:7], s49 offen offset:2048 sc1
    s_waitcnt lgkmcnt(14)
    v_mfma_f32_16x16x32_bf16 v[92:95], a[76:79], v[28:31], v[92:95]
    s_waitcnt lgkmcnt(13)
    v_mfma_f32_16x16x32_bf16 v[96:99], a[80:83], v[28:31], v[96:99]
    s_waitcnt lgkmcnt(12)
    v_mfma_f32_16x16x32_bf16 v[100:103], a[84:87], v[28:31], v[100:103]
    buffer_load_dwordx4 v[76:79], v2, s[4:7], s49 offen offset:3072 sc1
    s_waitcnt lgkmcnt(11)
    v_mfma_f32_16x16x32_bf16 v[104:107], a[88:91], v[28:31], v[104:107]
    s_waitcnt lgkmcnt(10)
    v_mfma_f32_16x16x32_bf16 v[108:111], a[92:95], v[28:31], v[108:111]
    s_waitcnt vmcnt(11) lgkmcnt(9)
    v_mfma_f32_16x16x32_bf16 v[88:91], v[112:115], v[32:35], v[88:91]
    s_waitcnt lgkmcnt(8)
    ds_read_b128 v[152:155], v8 offset:34816
    v_mfma_f32_16x16x32_bf16 v[92:95], v[116:119], v[32:35], v[92:95]
    s_waitcnt lgkmcnt(8)
    ds_read_b128 v[156:159], v8 offset:35840
    v_mfma_f32_16x16x32_bf16 v[96:99], v[120:123], v[32:35], v[96:99]
    s_waitcnt lgkmcnt(8)
    ds_read_b128 v[112:115], v8 offset:36864
    v_mfma_f32_16x16x32_bf16 v[100:103], v[124:127], v[32:35], v[100:103]
    s_waitcnt lgkmcnt(8)
    ds_read_b128 v[116:119], v8 offset:37888
    v_mfma_f32_16x16x32_bf16 v[104:107], v[128:131], v[32:35], v[104:107]
    s_waitcnt lgkmcnt(8)
    ds_read_b128 v[120:123], v8 offset:38912
    v_mfma_f32_16x16x32_bf16 v[108:111], v[132:135], v[32:35], v[108:111]
    s_waitcnt vmcnt(10) lgkmcnt(8)
    ds_read_b128 v[124:127], v8 offset:39936
    v_mfma_f32_16x16x32_bf16 v[88:91], v[136:139], v[36:39], v[88:91]
    s_waitcnt lgkmcnt(8)
    ds_read_b128 v[128:131], v8 offset:40960
    v_mfma_f32_16x16x32_bf16 v[92:95], v[140:143], v[36:39], v[92:95]
    s_waitcnt lgkmcnt(8)
    ds_read_b128 v[132:135], v8 offset:41984
    v_mfma_f32_16x16x32_bf16 v[96:99], v[144:147], v[36:39], v[96:99]
    s_waitcnt lgkmcnt(8)
    ds_read_b128 v[136:139], v8 offset:43008
    v_mfma_f32_16x16x32_bf16 v[100:103], v[148:151], v[36:39], v[100:103]
    s_waitcnt lgkmcnt(8)
    ds_read_b128 v[140:143], v8 offset:44032
    v_mfma_f32_16x16x32_bf16 v[104:107], v[152:155], v[36:39], v[104:107]
    s_waitcnt lgkmcnt(8)
    ds_read_b128 v[144:147], v8 offset:45056
    v_mfma_f32_16x16x32_bf16 v[108:111], v[156:159], v[36:39], v[108:111]
    s_waitcnt vmcnt(9) lgkmcnt(8)
    ds_read_b128 v[148:151], v8 offset:46080
    v_mfma_f32_16x16x32_bf16 v[88:91], v[112:115], v[40:43], v[88:91]
    s_waitcnt lgkmcnt(8)
    ds_read_b128 v[152:155], v8 offset:47104
    v_mfma_f32_16x16x32_bf16 v[92:95], v[116:119], v[40:43], v[92:95]
    s_waitcnt lgkmcnt(8)
    ds_read_b128 v[156:159], v8 offset:48128
    v_mfma_f32_16x16x32_bf16 v[96:99], v[120:123], v[40:43], v[96:99]
    s_waitcnt lgkmcnt(8)
    ds_read_b128 v[112:115], v8 offset:49152
    v_mfma_f32_16x16x32_bf16 v[100:103], v[124:127], v[40:43], v[100:103]
    s_waitcnt lgkmcnt(8)
    ds_read_b128 v[116:119], v8 offset:50176
    v_mfma_f32_16x16x32_bf16 v[104:107], v[128:131], v[40:43], v[104:107]
    s_waitcnt lgkmcnt(8)
    ds_read_b128 v[120:123], v8 offset:51200
    v_mfma_f32_16x16x32_bf16 v[108:111], v[132:135], v[40:43], v[108:111]
    s_waitcnt vmcnt(8) lgkmcnt(8)
    ds_read_b128 v[124:127], v8 offset:52224
    v_mfma_f32_16x16x32_bf16 v[88:91], v[136:139], v[44:47], v[88:91]
    s_waitcnt lgkmcnt(8)
    ds_read_b128 v[128:131], v8 offset:53248
    v_mfma_f32_16x16x32_bf16 v[92:95], v[140:143], v[44:47], v[92:95]
    s_waitcnt lgkmcnt(8)
    ds_read_b128 v[132:135], v8 offset:54272
    v_mfma_f32_16x16x32_bf16 v[96:99], v[144:147], v[44:47], v[96:99]
    s_waitcnt lgkmcnt(8)
    ds_read_b128 v[136:139], v8 offset:55296
    v_mfma_f32_16x16x32_bf16 v[100:103], v[148:151], v[44:47], v[100:103]
    s_waitcnt lgkmcnt(8)
    ds_read_b128 v[140:143], v8 offset:56320
    v_mfma_f32_16x16x32_bf16 v[104:107], v[152:155], v[44:47], v[104:107]
    s_waitcnt lgkmcnt(8)
    ds_read_b128 v[144:147], v8 offset:57344
    v_mfma_f32_16x16x32_bf16 v[108:111], v[156:159], v[44:47], v[108:111]
    s_waitcnt vmcnt(7) lgkmcnt(8)
    ds_read_b128 v[148:151], v8 offset:58368
    v_mfma_f32_16x16x32_bf16 v[88:91], v[112:115], v[48:51], v[88:91]
    s_waitcnt lgkmcnt(8)
    ds_read_b128 v[152:155], v8 offset:59392
    v_mfma_f32_16x16x32_bf16 v[92:95], v[116:119], v[48:51], v[92:95]
    s_waitcnt lgkmcnt(8)
    ds_read_b128 v[156:159], v8 offset:60416
    v_mfma_f32_16x16x32_bf16 v[96:99], v[120:123], v[48:51], v[96:99]
    s_waitcnt lgkmcnt(8)
    v_add_u32 v8, 61440, v8
    ds_read_b128 v[112:115], v8 offset:0
    v_mfma_f32_16x16x32_bf16 v[100:103], v[124:127], v[48:51], v[100:103]
    s_waitcnt lgkmcnt(8)
    ds_read_b128 v[116:119], v8 offset:1024
    v_mfma_f32_16x16x32_bf16 v[104:107], v[128:131], v[48:51], v[104:107]
    s_waitcnt lgkmcnt(8)
    ds_read_b128 v[120:123], v8 offset:2048
    v_mfma_f32_16x16x32_bf16 v[108:111], v[132:135], v[48:51], v[108:111]
    s_waitcnt vmcnt(6) lgkmcnt(8)
    ds_read_b128 v[124:127], v8 offset:3072
    v_mfma_f32_16x16x32_bf16 v[88:91], v[136:139], v[52:55], v[88:91]
    s_waitcnt lgkmcnt(8)
    ds_read_b128 v[128:131], v8 offset:4096
    v_mfma_f32_16x16x32_bf16 v[92:95], v[140:143], v[52:55], v[92:95]
    s_waitcnt lgkmcnt(8)
    ds_read_b128 v[132:135], v8 offset:5120
    v_mfma_f32_16x16x32_bf16 v[96:99], v[144:147], v[52:55], v[96:99]
    s_waitcnt lgkmcnt(8)
    ds_read_b128 v[136:139], v8 offset:6144
    v_mfma_f32_16x16x32_bf16 v[100:103], v[148:151], v[52:55], v[100:103]
    s_waitcnt lgkmcnt(8)
    ds_read_b128 v[140:143], v8 offset:7168
    v_mfma_f32_16x16x32_bf16 v[104:107], v[152:155], v[52:55], v[104:107]
    s_waitcnt lgkmcnt(8)
    ds_read_b128 v[144:147], v8 offset:8192
    v_mfma_f32_16x16x32_bf16 v[108:111], v[156:159], v[52:55], v[108:111]
    s_waitcnt vmcnt(5) lgkmcnt(8)
    ds_read_b128 v[148:151], v8 offset:9216
    v_mfma_f32_16x16x32_bf16 v[88:91], v[112:115], v[56:59], v[88:91]
    s_waitcnt lgkmcnt(8)
    ds_read_b128 v[152:155], v8 offset:10240
    v_mfma_f32_16x16x32_bf16 v[92:95], v[116:119], v[56:59], v[92:95]
    s_waitcnt lgkmcnt(8)
    ds_read_b128 v[156:159], v8 offset:11264
    v_mfma_f32_16x16x32_bf16 v[96:99], v[120:123], v[56:59], v[96:99]
    s_waitcnt lgkmcnt(8)
    ds_read_b128 v[112:115], v8 offset:12288
    v_mfma_f32_16x16x32_bf16 v[100:103], v[124:127], v[56:59], v[100:103]
    s_waitcnt lgkmcnt(8)
    ds_read_b128 v[116:119], v8 offset:13312
    v_mfma_f32_16x16x32_bf16 v[104:107], v[128:131], v[56:59], v[104:107]
    s_waitcnt lgkmcnt(8)
    ds_read_b128 v[120:123], v8 offset:14336
    v_mfma_f32_16x16x32_bf16 v[108:111], v[132:135], v[56:59], v[108:111]
    ds_read_b128 v[124:127], v8 offset:15360
    buffer_load_dwordx2 v[80:81], v5, s[4:7], s50 offen offset:0 sc1
    buffer_load_dwordx2 v[82:83], v5, s[4:7], s50 offen offset:128 sc1
    s_waitcnt vmcnt(6) lgkmcnt(9)
    v_mfma_f32_16x16x32_bf16 v[88:91], v[136:139], v[60:63], v[88:91]
    s_waitcnt lgkmcnt(8)
    ds_read_b128 v[128:131], v8 offset:16384
    v_mfma_f32_16x16x32_bf16 v[92:95], v[140:143], v[60:63], v[92:95]
    s_waitcnt lgkmcnt(8)
    ds_read_b128 v[132:135], v8 offset:17408
    v_mfma_f32_16x16x32_bf16 v[96:99], v[144:147], v[60:63], v[96:99]
    s_waitcnt lgkmcnt(8)
    ds_read_b128 v[136:139], v8 offset:18432
    v_mfma_f32_16x16x32_bf16 v[100:103], v[148:151], v[60:63], v[100:103]
    s_waitcnt lgkmcnt(8)
    ds_read_b128 v[140:143], v8 offset:19456
    v_mfma_f32_16x16x32_bf16 v[104:107], v[152:155], v[60:63], v[104:107]
    s_waitcnt lgkmcnt(8)
    ds_read_b128 v[144:147], v8 offset:20480
    v_mfma_f32_16x16x32_bf16 v[108:111], v[156:159], v[60:63], v[108:111]
    ds_read_b128 v[148:151], v8 offset:21504
    buffer_load_dwordx2 v[84:85], v5, s[4:7], s50 offen offset:1024 sc1
    buffer_load_dwordx2 v[86:87], v5, s[4:7], s50 offen offset:1152 sc1
    s_waitcnt vmcnt(7) lgkmcnt(9)
    v_mfma_f32_16x16x32_bf16 v[88:91], v[112:115], v[64:67], v[88:91]
    s_waitcnt lgkmcnt(8)
    ds_read_b128 v[152:155], v8 offset:22528
    v_mfma_f32_16x16x32_bf16 v[92:95], v[116:119], v[64:67], v[92:95]
    s_waitcnt lgkmcnt(8)
    ds_read_b128 v[156:159], v8 offset:23552
    v_mfma_f32_16x16x32_bf16 v[96:99], v[120:123], v[64:67], v[96:99]
    s_waitcnt lgkmcnt(8)
    ds_read_b128 v[112:115], v8 offset:24576
    v_mfma_f32_16x16x32_bf16 v[100:103], v[124:127], v[64:67], v[100:103]
    s_waitcnt lgkmcnt(8)
    ds_read_b128 v[116:119], v8 offset:25600
    v_mfma_f32_16x16x32_bf16 v[104:107], v[128:131], v[64:67], v[104:107]
    s_waitcnt lgkmcnt(8)
    ds_read_b128 v[120:123], v8 offset:26624
    v_mfma_f32_16x16x32_bf16 v[108:111], v[132:135], v[64:67], v[108:111]
    s_waitcnt vmcnt(6) lgkmcnt(8)
    ds_read_b128 v[124:127], v8 offset:27648
    v_mfma_f32_16x16x32_bf16 v[88:91], v[136:139], v[68:71], v[88:91]
    s_waitcnt lgkmcnt(8)
    ds_read_b128 v[128:131], v8 offset:28672
    v_mfma_f32_16x16x32_bf16 v[92:95], v[140:143], v[68:71], v[92:95]
    s_waitcnt lgkmcnt(8)
    ds_read_b128 v[132:135], v8 offset:29696
    v_mfma_f32_16x16x32_bf16 v[96:99], v[144:147], v[68:71], v[96:99]
    s_waitcnt lgkmcnt(8)
    ds_read_b128 v[136:139], v8 offset:30720
    v_mfma_f32_16x16x32_bf16 v[100:103], v[148:151], v[68:71], v[100:103]
    s_waitcnt lgkmcnt(8)
    ds_read_b128 v[140:143], v8 offset:31744
    v_mfma_f32_16x16x32_bf16 v[104:107], v[152:155], v[68:71], v[104:107]
    s_waitcnt lgkmcnt(8)
    ds_read_b128 v[144:147], v8 offset:32768
    v_mfma_f32_16x16x32_bf16 v[108:111], v[156:159], v[68:71], v[108:111]
    s_waitcnt vmcnt(5) lgkmcnt(8)
    ds_read_b128 v[148:151], v8 offset:33792
    v_mfma_f32_16x16x32_bf16 v[88:91], v[112:115], v[72:75], v[88:91]
    s_waitcnt lgkmcnt(8)
    ds_read_b128 v[152:155], v8 offset:34816
    v_mfma_f32_16x16x32_bf16 v[92:95], v[116:119], v[72:75], v[92:95]
    s_waitcnt lgkmcnt(8)
    ds_read_b128 v[156:159], v8 offset:35840
    v_mfma_f32_16x16x32_bf16 v[96:99], v[120:123], v[72:75], v[96:99]
    s_waitcnt lgkmcnt(8)
    ds_read_b128 v[112:115], v8 offset:36864
    v_mfma_f32_16x16x32_bf16 v[100:103], v[124:127], v[72:75], v[100:103]
    s_waitcnt lgkmcnt(8)
    ds_read_b128 v[116:119], v8 offset:37888
    v_mfma_f32_16x16x32_bf16 v[104:107], v[128:131], v[72:75], v[104:107]
    s_waitcnt lgkmcnt(8)
    ds_read_b128 v[120:123], v8 offset:38912
    v_mfma_f32_16x16x32_bf16 v[108:111], v[132:135], v[72:75], v[108:111]
    s_waitcnt vmcnt(4) lgkmcnt(8)
    ds_read_b128 v[124:127], v8 offset:39936
    v_mfma_f32_16x16x32_bf16 v[88:91], v[136:139], v[76:79], v[88:91]
    s_waitcnt lgkmcnt(8)
    ds_read_b128 v[128:131], v8 offset:40960
    v_mfma_f32_16x16x32_bf16 v[92:95], v[140:143], v[76:79], v[92:95]
    s_waitcnt lgkmcnt(8)
    ds_read_b128 v[132:135], v8 offset:41984
    v_mfma_f32_16x16x32_bf16 v[96:99], v[144:147], v[76:79], v[96:99]
    s_waitcnt lgkmcnt(8)
    ds_read_b128 v[136:139], v8 offset:43008
    v_mfma_f32_16x16x32_bf16 v[100:103], v[148:151], v[76:79], v[100:103]
    s_waitcnt lgkmcnt(8)
    ds_read_b128 v[140:143], v8 offset:44032
    v_mfma_f32_16x16x32_bf16 v[104:107], v[152:155], v[76:79], v[104:107]
    s_waitcnt lgkmcnt(8)
    ds_read_b128 v[144:147], v8 offset:45056
    v_mfma_f32_16x16x32_bf16 v[108:111], v[156:159], v[76:79], v[108:111]
    s_waitcnt vmcnt(2) lgkmcnt(8)
    ds_read_b128 v[148:151], v8 offset:46080
    v_mfma_f32_16x16x32_bf16 v[88:91], v[112:115], v[80:83], v[88:91]
    s_waitcnt lgkmcnt(8)
    ds_read_b128 v[152:155], v8 offset:47104
    v_mfma_f32_16x16x32_bf16 v[92:95], v[116:119], v[80:83], v[92:95]
    s_waitcnt lgkmcnt(8)
    ds_read_b128 v[156:159], v8 offset:48128
    v_mfma_f32_16x16x32_bf16 v[96:99], v[120:123], v[80:83], v[96:99]
    s_waitcnt lgkmcnt(8)
    v_mfma_f32_16x16x32_bf16 v[100:103], v[124:127], v[80:83], v[100:103]
    s_waitcnt lgkmcnt(7)
    v_mfma_f32_16x16x32_bf16 v[104:107], v[128:131], v[80:83], v[104:107]
    s_waitcnt lgkmcnt(6)
    v_mfma_f32_16x16x32_bf16 v[108:111], v[132:135], v[80:83], v[108:111]
    s_waitcnt vmcnt(0) lgkmcnt(5)
    v_mfma_f32_16x16x32_bf16 v[88:91], v[136:139], v[84:87], v[88:91]
    s_waitcnt lgkmcnt(4)
    v_mfma_f32_16x16x32_bf16 v[92:95], v[140:143], v[84:87], v[92:95]
    s_waitcnt lgkmcnt(3)
    v_mfma_f32_16x16x32_bf16 v[96:99], v[144:147], v[84:87], v[96:99]
    s_waitcnt lgkmcnt(2)
    v_mfma_f32_16x16x32_bf16 v[100:103], v[148:151], v[84:87], v[100:103]
    s_waitcnt lgkmcnt(1)
    v_mfma_f32_16x16x32_bf16 v[104:107], v[152:155], v[84:87], v[104:107]
    s_waitcnt lgkmcnt(0)
    v_mfma_f32_16x16x32_bf16 v[108:111], v[156:159], v[84:87], v[108:111]
    v_lshlrev_b32 v16, 16, v160
    v_and_b32 v17, 0xffff0000, v160
    v_lshlrev_b32 v18, 16, v161
    v_and_b32 v19, 0xffff0000, v161
    v_lshlrev_b32 v20, 16, v162
    v_and_b32 v21, 0xffff0000, v162
    v_lshlrev_b32 v22, 16, v163
    v_and_b32 v23, 0xffff0000, v163
    v_lshlrev_b32 v24, 16, v164
    v_and_b32 v25, 0xffff0000, v164
    v_lshlrev_b32 v26, 16, v165
    v_and_b32 v27, 0xffff0000, v165
    v_lshlrev_b32 v28, 16, v166
    v_and_b32 v29, 0xffff0000, v166
    v_lshlrev_b32 v30, 16, v167
    v_and_b32 v31, 0xffff0000, v167
    v_lshlrev_b32 v32, 16, v168
    v_and_b32 v33, 0xffff0000, v168
    v_lshlrev_b32 v34, 16, v169
    v_and_b32 v35, 0xffff0000, v169
    v_lshlrev_b32 v36, 16, v170
    v_and_b32 v37, 0xffff0000, v170
    v_lshlrev_b32 v38, 16, v171
    v_and_b32 v39, 0xffff0000, v171
    v_add_f32 v16, v16, v88
    v_add_f32 v17, v17, v89
    v_add_f32 v18, v18, v90
    v_add_f32 v19, v19, v91
    v_add_f32 v20, v20, v92
    v_add_f32 v21, v21, v93
    v_add_f32 v22, v22, v94
    v_add_f32 v23, v23, v95
    v_add_f32 v24, v24, v96
    v_add_f32 v25, v25, v97
    v_add_f32 v26, v26, v98
    v_add_f32 v27, v27, v99
    v_add_f32 v28, v28, v100
    v_add_f32 v29, v29, v101
    v_add_f32 v30, v30, v102
    v_add_f32 v31, v31, v103
    v_add_f32 v32, v32, v104
    v_add_f32 v33, v33, v105
    v_add_f32 v34, v34, v106
    v_add_f32 v35, v35, v107
    v_add_f32 v36, v36, v108
    v_add_f32 v37, v37, v109
    v_add_f32 v38, v38, v110
    v_add_f32 v39, v39, v111
    s_mul_i32 s52, s46, 18
    s_mul_i32 s53, s45, 3
    s_add_u32 s52, s52, s53
    s_lshl_b32 s52, s52, 10
    s_add_u32 s52, s52, 25690112
    v_cvt_pk_bf16_f32 v40, v16, v17
    v_cvt_pk_bf16_f32 v41, v18, v19
    v_cvt_pk_bf16_f32 v42, v20, v21
    v_cvt_pk_bf16_f32 v43, v22, v23
    buffer_store_dwordx4 v[40:43], v2, s[4:7], s52 offen offset:0 sc1
    v_cvt_pk_bf16_f32 v44, v24, v25
    v_cvt_pk_bf16_f32 v45, v26, v27
    v_cvt_pk_bf16_f32 v46, v28, v29
    v_cvt_pk_bf16_f32 v47, v30, v31
    buffer_store_dwordx4 v[44:47], v2, s[4:7], s52 offen offset:1024 sc1
    v_cvt_pk_bf16_f32 v48, v32, v33
    v_cvt_pk_bf16_f32 v49, v34, v35
    v_cvt_pk_bf16_f32 v50, v36, v37
    v_cvt_pk_bf16_f32 v51, v38, v39
    buffer_store_dwordx4 v[48:51], v2, s[4:7], s52 offen offset:2048 sc1
    v_lshlrev_b32 v16, 16, v40
    v_and_b32 v17, 0xffff0000, v40
    v_lshlrev_b32 v18, 16, v41
    v_and_b32 v19, 0xffff0000, v41
    v_lshlrev_b32 v20, 16, v42
    v_and_b32 v21, 0xffff0000, v42
    v_lshlrev_b32 v22, 16, v43
    v_and_b32 v23, 0xffff0000, v43
    v_lshlrev_b32 v24, 16, v44
    v_and_b32 v25, 0xffff0000, v44
    v_lshlrev_b32 v26, 16, v45
    v_and_b32 v27, 0xffff0000, v45
    v_lshlrev_b32 v28, 16, v46
    v_and_b32 v29, 0xffff0000, v46
    v_lshlrev_b32 v30, 16, v47
    v_and_b32 v31, 0xffff0000, v47
    v_lshlrev_b32 v32, 16, v48
    v_and_b32 v33, 0xffff0000, v48
    v_lshlrev_b32 v34, 16, v49
    v_and_b32 v35, 0xffff0000, v49
    v_lshlrev_b32 v36, 16, v50
    v_and_b32 v37, 0xffff0000, v50
    v_lshlrev_b32 v38, 16, v51
    v_and_b32 v39, 0xffff0000, v51
    v_add_f32 v56, v16, v17
    v_add_f32 v58, v18, v19
    v_add_f32 v56, v56, v20
    v_add_f32 v58, v58, v21
    v_add_f32 v56, v56, v22
    v_add_f32 v58, v58, v23
    v_add_f32 v56, v56, v24
    v_add_f32 v58, v58, v25
    v_add_f32 v56, v56, v26
    v_add_f32 v58, v58, v27
    v_add_f32 v56, v56, v28
    v_add_f32 v58, v58, v29
    v_add_f32 v56, v56, v30
    v_add_f32 v58, v58, v31
    v_add_f32 v56, v56, v32
    v_add_f32 v58, v58, v33
    v_add_f32 v56, v56, v34
    v_add_f32 v58, v58, v35
    v_add_f32 v56, v56, v36
    v_add_f32 v58, v58, v37
    v_add_f32 v56, v56, v38
    v_add_f32 v58, v58, v39
    v_add_f32 v56, v56, v58
    v_mov_b32 v58, v56
    s_nop 1
    v_permlane16_swap_b32 v56, v58
    v_add_f32 v56, v56, v58
    v_mov_b32 v58, v56
    s_nop 1
    v_permlane32_swap_b32 v56, v58
    v_add_f32 v56, v56, v58
    v_mul_f32 v59, 0x3c2aaaab, v56
    v_sub_f32 v58, v16, v59
    v_mul_f32 v57, v58, v58
    v_sub_f32 v61, v17, v59
    v_fmac_f32 v57, v61, v61
    v_sub_f32 v60, v18, v59
    v_fmac_f32 v57, v60, v60
    v_sub_f32 v61, v19, v59
    v_fmac_f32 v57, v61, v61
    v_sub_f32 v60, v20, v59
    v_fmac_f32 v57, v60, v60
    v_sub_f32 v61, v21, v59
    v_fmac_f32 v57, v61, v61
    v_sub_f32 v60, v22, v59
    v_fmac_f32 v57, v60, v60
    v_sub_f32 v61, v23, v59
    v_fmac_f32 v57, v61, v61
    v_sub_f32 v60, v24, v59
    v_fmac_f32 v57, v60, v60
    v_sub_f32 v61, v25, v59
    v_fmac_f32 v57, v61, v61
    v_sub_f32 v60, v26, v59
    v_fmac_f32 v57, v60, v60
    v_sub_f32 v61, v27, v59
    v_fmac_f32 v57, v61, v61
    v_sub_f32 v60, v28, v59
    v_fmac_f32 v57, v60, v60
    v_sub_f32 v61, v29, v59
    v_fmac_f32 v57, v61, v61
    v_sub_f32 v60, v30, v59
    v_fmac_f32 v57, v60, v60
    v_sub_f32 v61, v31, v59
    v_fmac_f32 v57, v61, v61
    v_sub_f32 v60, v32, v59
    v_fmac_f32 v57, v60, v60
    v_sub_f32 v61, v33, v59
    v_fmac_f32 v57, v61, v61
    v_sub_f32 v60, v34, v59
    v_fmac_f32 v57, v60, v60
    v_sub_f32 v61, v35, v59
    v_fmac_f32 v57, v61, v61
    v_sub_f32 v60, v36, v59
    v_fmac_f32 v57, v60, v60
    v_sub_f32 v61, v37, v59
    v_fmac_f32 v57, v61, v61
    v_sub_f32 v60, v38, v59
    v_fmac_f32 v57, v60, v60
    v_sub_f32 v61, v39, v59
    v_fmac_f32 v57, v61, v61
    v_mov_b32 v58, v57
    s_nop 1
    v_permlane16_swap_b32 v57, v58
    v_add_f32 v57, v57, v58
    v_mov_b32 v58, v57
    s_nop 1
    v_permlane32_swap_b32 v57, v58
    v_add_f32 v57, v57, v58
    s_lshl_b32 s52, s45, 14
    s_add_u32 s52, s52, 28049408
    s_mov_b32 exec_lo, 0xffff
    s_mov_b32 exec_hi, 0
    buffer_store_dwordx2 v[56:57], v7, s[4:7], s52 offen sc1
    s_mov_b64 exec, -1
    s_lshl_b32 s53, s46, 3
    s_add_u32 s53, s53, s45
    s_lshl_b32 s53, s53, 3
    s_add_u32 s53, s53, 40960
    v_mov_b32 v8, s98
    v_mov_b32 v9, s99
    s_waitcnt vmcnt(0)
    s_lshl_b32 s53, s53, 2
    s_add_u32 s53, s53, 0x8000000
    s_mov_b64 exec, 1
    buffer_store_dwordx2 v[8:9], off, s[4:7], s53 sc1
    s_mov_b64 exec, -1
L_next_52:
    s_mov_b32 s100, 20971520
    s_mov_b32 s101, 0x2000
    s_branch L_ffn_50
L_red1_51:
    s_lshl_b32 s47, s21, 5
    s_add_u32 s47, s47, s22
    v_and_b32 v8, 7, v1
    v_lshrrev_b32 v9, 3, v1
    s_lshl_b32 s48, s47, 3
    v_add_u32 v3, s48, v8
    v_mul_u32_u24 v3, 1152, v3
    s_mul_i32 s48, s20, 0
    v_lshl_add_u32 v3, v9, 4, v3
    v_add_u32 v3, s48, v3
    s_lshr_b32 s48, s47, 1
    s_mul_i32 s48, s48, 18432
    s_and_b32 s49, s47, 1
    s_lshl_b32 s49, s49, 7
    s_add_u32 s48, s48, s49
    s_mul_i32 s49, s20, 0
    s_add_u32 s48, s48, s49
    v_lshlrev_b32 v8, 4, v8
    v_lshl_add_u32 v8, v9, 8, v8
    v_add_u32 v4, s48, v8
    s_lshl_b32 s48, s20, 2
    s_lshr_b32 s50, 0x530, s48
    s_and_b32 s50, s50, 15
    s_lshl_b32 s53, s50, 11
    s_lshr_b32 s51, 0x217, s48
    s_and_b32 s51, s51, 15
    s_lshl_b32 s54, s51, 11
    s_lshr_b32 s52, 0x864, s48
    s_and_b32 s52, s52, 15
    s_lshl_b32 s55, s52, 11
    v_lshrrev_b32 v8, 3, v1
    v_and_b32 v9, 7, v1
    s_and_b32 s48, s47, 1
    s_lshl_b32 s48, s48, 3
    v_add_u32 v9, s48, v9
    v_lshlrev_b32 v9, 4, v9
    v_bfe_u32 v10, v8, 1, 1
    v_and_b32 v11, 1, v8
    v_lshl_add_u32 v9, v11, 4, v9
    v_lshl_add_u32 v9, v10, 9, v9
    v_and_b32 v10, 3, v8
    v_lshlrev_b32 v10, 8, v10
    v_sub_u32 v9, v9, v10
    v_lshrrev_b32 v8, 2, v8
    s_lshl_b32 s48, s50, 1
    v_add_u32 v10, s48, v8
    v_cmp_eq_u32 vcc, 4, v10
    v_cmp_eq_u32 s[56:57], 13, v10
    s_nop 0
    s_or_b64 vcc, vcc, s[56:57]
    v_cndmask_b32 v10, 0, v9, vcc
    v_add3_u32 v5, v4, v10, s53
    s_lshl_b32 s50, s50, 7
    s_lshl_b32 s48, s51, 1
    v_add_u32 v10, s48, v8
    v_cmp_eq_u32 vcc, 4, v10
    v_cmp_eq_u32 s[56:57], 13, v10
    s_nop 0
    s_or_b64 vcc, vcc, s[56:57]
    v_cndmask_b32 v10, 0, v9, vcc
    v_add3_u32 v6, v4, v10, s54
    s_lshl_b32 s51, s51, 7
    s_lshl_b32 s48, s52, 1
    v_add_u32 v10, s48, v8
    v_cmp_eq_u32 vcc, 4, v10
    v_cmp_eq_u32 s[56:57], 13, v10
    s_nop 0
    s_or_b64 vcc, vcc, s[56:57]
    v_cndmask_b32 v10, 0, v9, vcc
    v_add3_u32 v7, v4, v10, s55
    s_lshl_b32 s52, s52, 7
    s_cmp_eq_u32 s20, 3
    s_cbranch_scc1 L_w3a_113
    s_add_u32 s48, s53, 25690112
    buffer_load_dwordx4 v[16:19], v4, s[4:7], s48 offen sc1
    s_add_u32 s48, s54, 25690112
    buffer_load_dwordx4 v[52:55], v4, s[4:7], s48 offen sc1
    s_add_u32 s48, s55, 25690112
    buffer_load_dwordx4 v[88:91], v4, s[4:7], s48 offen sc1
    s_lshr_b32 s49, s47, 3
    s_lshl_b32 s49, s49, 8
    s_add_u32 s58, s49, 163840
    s_add_u32 s49, s49, 122880
    v_and_b32 v10, 31, v1
    v_lshlrev_b32 v10, 3, v10
    s_lshl_b32 s58, s58, 2
    s_add_u32 s58, s58, 0x8000000
    v_lshlrev_b32 v10, 2, v10
    buffer_load_dwordx2 v[176:177], v10, s[4:7], s58 offen sc1
    s_waitcnt vmcnt(0)
    v_cmp_eq_u64 vcc, s[98:99], v[176:177]
    s_nop 0
    s_cmp_eq_u64 vcc, exec
    s_cbranch_scc0 L_pa_slow_114
L_pa_back_115:
    s_mov_b32 s48, 50331648
    buffer_load_dwordx4 v[20:23], v5, s[4:7], s48 offen sc1
    s_mov_b32 s48, 52690944
    buffer_load_dwordx4 v[24:27], v5, s[4:7], s48 offen sc1
    s_mov_b32 s48, 55050240
    buffer_load_dwordx4 v[28:31], v5, s[4:7], s48 offen sc1
    s_mov_b32 s48, 57409536
    buffer_load_dwordx4 v[32:35], v5, s[4:7], s48 offen sc1
    s_mov_b32 s48, 59768832
    buffer_load_dwordx4 v[36:39], v5, s[4:7], s48 offen sc1
    s_mov_b32 s48, 62128128
    buffer_load_dwordx4 v[40:43], v5, s[4:7], s48 offen sc1
    s_mov_b32 s48, 64487424
    buffer_load_dwordx4 v[44:47], v5, s[4:7], s48 offen sc1
    s_mov_b32 s48, 66846720
    buffer_load_dwordx4 v[48:51], v5, s[4:7], s48 offen sc1
    s_lshl_b32 s49, s49, 2
    s_add_u32 s49, s49, 0x8000000
    buffer_load_dwordx2 v[176:177], v10, s[4:7], s49 offen sc1
    s_waitcnt vmcnt(0)
    v_cmp_eq_u64 vcc, s[98:99], v[176:177]
    s_nop 0
    s_cmp_eq_u64 vcc, exec
    s_cbranch_scc0 L_pp_slow_117
L_pp_back_118:
    s_mov_b32 s48, 50331648
    buffer_load_dwordx4 v[56:59], v6, s[4:7], s48 offen sc1
    buffer_load_dwordx4 v[92:95], v7, s[4:7], s48 offen sc1
    s_mov_b32 s48, 52690944
    buffer_load_dwordx4 v[60:63], v6, s[4:7], s48 offen sc1
    buffer_load_dwordx4 v[96:99], v7, s[4:7], s48 offen sc1
    s_mov_b32 s48, 55050240
    buffer_load_dwordx4 v[64:67], v6, s[4:7], s48 offen sc1
    buffer_load_dwordx4 v[100:103], v7, s[4:7], s48 offen sc1
    s_mov_b32 s48, 57409536
    buffer_load_dwordx4 v[68:71], v6, s[4:7], s48 offen sc1
    buffer_load_dwordx4 v[104:107], v7, s[4:7], s48 offen sc1
    s_mov_b32 s48, 59768832
    buffer_load_dwordx4 v[72:75], v6, s[4:7], s48 offen sc1
    buffer_load_dwordx4 v[108:111], v7, s[4:7], s48 offen sc1
    s_mov_b32 s48, 62128128
    buffer_load_dwordx4 v[76:79], v6, s[4:7], s48 offen sc1
    buffer_load_dwordx4 v[112:115], v7, s[4:7], s48 offen sc1
    s_mov_b32 s48, 64487424
    buffer_load_dwordx4 v[80:83], v6, s[4:7], s48 offen sc1
    buffer_load_dwordx4 v[116:119], v7, s[4:7], s48 offen sc1
    s_mov_b32 s48, 66846720
    buffer_load_dwordx4 v[84:87], v6, s[4:7], s48 offen sc1
    buffer_load_dwordx4 v[120:123], v7, s[4:7], s48 offen sc1
    v_lshlrev_b32 v128, 16, v16
    v_and_b32 v129, 0xffff0000, v16
    v_lshlrev_b32 v130, 16, v17
    v_and_b32 v131, 0xffff0000, v17
    v_lshlrev_b32 v132, 16, v18
    v_and_b32 v133, 0xffff0000, v18
    v_lshlrev_b32 v134, 16, v19
    v_and_b32 v135, 0xffff0000, v19
    v_lshlrev_b32 v136, 16, v52
    v_and_b32 v137, 0xffff0000, v52
    v_lshlrev_b32 v138, 16, v53
    v_and_b32 v139, 0xffff0000, v53
    v_lshlrev_b32 v140, 16, v54
    v_and_b32 v141, 0xffff0000, v54
    v_lshlrev_b32 v142, 16, v55
    v_and_b32 v143, 0xffff0000, v55
    v_lshlrev_b32 v144, 16, v88
    v_and_b32 v145, 0xffff0000, v88
    v_lshlrev_b32 v146, 16, v89
    v_and_b32 v147, 0xffff0000, v89
    v_lshlrev_b32 v148, 16, v90
    v_and_b32 v149, 0xffff0000, v90
    v_lshlrev_b32 v150, 16, v91
    v_and_b32 v151, 0xffff0000, v91
    v_mov_b32 v12, 0x3f80
    v_mov_b32 v13, 0x3f800000
    v_dot2c_f32_bf16 v128, v20, v12
    v_dot2c_f32_bf16 v129, v20, v13
    v_dot2c_f32_bf16 v130, v21, v12
    v_dot2c_f32_bf16 v131, v21, v13
    v_dot2c_f32_bf16 v132, v22, v12
    v_dot2c_f32_bf16 v133, v22, v13
    v_dot2c_f32_bf16 v134, v23, v12
    v_dot2c_f32_bf16 v135, v23, v13
    v_dot2c_f32_bf16 v128, v24, v12
    v_dot2c_f32_bf16 v129, v24, v13
    v_dot2c_f32_bf16 v130, v25, v12
    v_dot2c_f32_bf16 v131, v25, v13
    v_dot2c_f32_bf16 v132, v26, v12
    v_dot2c_f32_bf16 v133, v26, v13
    v_dot2c_f32_bf16 v134, v27, v12
    v_dot2c_f32_bf16 v135, v27, v13
    v_dot2c_f32_bf16 v128, v28, v12
    v_dot2c_f32_bf16 v129, v28, v13
    v_dot2c_f32_bf16 v130, v29, v12
    v_dot2c_f32_bf16 v131, v29, v13
    v_dot2c_f32_bf16 v132, v30, v12
    v_dot2c_f32_bf16 v133, v30, v13
    v_dot2c_f32_bf16 v134, v31, v12
    v_dot2c_f32_bf16 v135, v31, v13
    v_dot2c_f32_bf16 v128, v32, v12
    v_dot2c_f32_bf16 v129, v32, v13
    v_dot2c_f32_bf16 v130, v33, v12
    v_dot2c_f32_bf16 v131, v33, v13
    v_dot2c_f32_bf16 v132, v34, v12
    v_dot2c_f32_bf16 v133, v34, v13
    v_dot2c_f32_bf16 v134, v35, v12
    v_dot2c_f32_bf16 v135, v35, v13
    v_dot2c_f32_bf16 v128, v36, v12
    v_dot2c_f32_bf16 v129, v36, v13
    v_dot2c_f32_bf16 v130, v37, v12
    v_dot2c_f32_bf16 v131, v37, v13
    v_dot2c_f32_bf16 v132, v38, v12
    v_dot2c_f32_bf16 v133, v38, v13
    v_dot2c_f32_bf16 v134, v39, v12
    v_dot2c_f32_bf16 v135, v39, v13
    v_dot2c_f32_bf16 v128, v40, v12
    v_dot2c_f32_bf16 v129, v40, v13
    v_dot2c_f32_bf16 v130, v41, v12
    v_dot2c_f32_bf16 v131, v41, v13
    v_dot2c_f32_bf16 v132, v42, v12
    v_dot2c_f32_bf16 v133, v42, v13
    v_dot2c_f32_bf16 v134, v43, v12
    v_dot2c_f32_bf16 v135, v43, v13
    v_dot2c_f32_bf16 v128, v44, v12
    v_dot2c_f32_bf16 v129, v44, v13
    v_dot2c_f32_bf16 v130, v45, v12
    v_dot2c_f32_bf16 v131, v45, v13
    v_dot2c_f32_bf16 v132, v46, v12
    v_dot2c_f32_bf16 v133, v46, v13
    v_dot2c_f32_bf16 v134, v47, v12
    v_dot2c_f32_bf16 v135, v47, v13
    v_dot2c_f32_bf16 v128, v48, v12
    v_dot2c_f32_bf16 v129, v48, v13
    v_dot2c_f32_bf16 v130, v49, v12
    v_dot2c_f32_bf16 v131, v49, v13
    v_dot2c_f32_bf16 v132, v50, v12
    v_dot2c_f32_bf16 v133, v50, v13
    v_dot2c_f32_bf16 v134, v51, v12
    v_dot2c_f32_bf16 v135, v51, v13
    s_waitcnt vmcnt(15)
    v_dot2c_f32_bf16 v136, v56, v12
    v_dot2c_f32_bf16 v137, v56, v13
    v_dot2c_f32_bf16 v138, v57, v12
    v_dot2c_f32_bf16 v139, v57, v13
    v_dot2c_f32_bf16 v140, v58, v12
    v_dot2c_f32_bf16 v141, v58, v13
    v_dot2c_f32_bf16 v142, v59, v12
    v_dot2c_f32_bf16 v143, v59, v13
    s_waitcnt vmcnt(14)
    v_dot2c_f32_bf16 v144, v92, v12
    v_dot2c_f32_bf16 v145, v92, v13
    v_dot2c_f32_bf16 v146, v93, v12
    v_dot2c_f32_bf16 v147, v93, v13
    v_dot2c_f32_bf16 v148, v94, v12
    v_dot2c_f32_bf16 v149, v94, v13
    v_dot2c_f32_bf16 v150, v95, v12
    v_dot2c_f32_bf16 v151, v95, v13
    s_waitcnt vmcnt(13)
    v_dot2c_f32_bf16 v136, v60, v12
    v_dot2c_f32_bf16 v137, v60, v13
    v_dot2c_f32_bf16 v138, v61, v12
    v_dot2c_f32_bf16 v139, v61, v13
    v_dot2c_f32_bf16 v140, v62, v12
    v_dot2c_f32_bf16 v141, v62, v13
    v_dot2c_f32_bf16 v142, v63, v12
    v_dot2c_f32_bf16 v143, v63, v13
    s_waitcnt vmcnt(12)
    v_dot2c_f32_bf16 v144, v96, v12
    v_dot2c_f32_bf16 v145, v96, v13
    v_dot2c_f32_bf16 v146, v97, v12
    v_dot2c_f32_bf16 v147, v97, v13
    v_dot2c_f32_bf16 v148, v98, v12
    v_dot2c_f32_bf16 v149, v98, v13
    v_dot2c_f32_bf16 v150, v99, v12
    v_dot2c_f32_bf16 v151, v99, v13
    s_waitcnt vmcnt(11)
    v_dot2c_f32_bf16 v136, v64, v12
    v_dot2c_f32_bf16 v137, v64, v13
    v_dot2c_f32_bf16 v138, v65, v12
    v_dot2c_f32_bf16 v139, v65, v13
    v_dot2c_f32_bf16 v140, v66, v12
    v_dot2c_f32_bf16 v141, v66, v13
    v_dot2c_f32_bf16 v142, v67, v12
    v_dot2c_f32_bf16 v143, v67, v13
    s_waitcnt vmcnt(10)
    v_dot2c_f32_bf16 v144, v100, v12
    v_dot2c_f32_bf16 v145, v100, v13
    v_dot2c_f32_bf16 v146, v101, v12
    v_dot2c_f32_bf16 v147, v101, v13
    v_dot2c_f32_bf16 v148, v102, v12
    v_dot2c_f32_bf16 v149, v102, v13
    v_dot2c_f32_bf16 v150, v103, v12
    v_dot2c_f32_bf16 v151, v103, v13
    s_waitcnt vmcnt(9)
    v_dot2c_f32_bf16 v136, v68, v12
    v_dot2c_f32_bf16 v137, v68, v13
    v_dot2c_f32_bf16 v138, v69, v12
    v_dot2c_f32_bf16 v139, v69, v13
    v_dot2c_f32_bf16 v140, v70, v12
    v_dot2c_f32_bf16 v141, v70, v13
    v_dot2c_f32_bf16 v142, v71, v12
    v_dot2c_f32_bf16 v143, v71, v13
    s_waitcnt vmcnt(8)
    v_dot2c_f32_bf16 v144, v104, v12
    v_dot2c_f32_bf16 v145, v104, v13
    v_dot2c_f32_bf16 v146, v105, v12
    v_dot2c_f32_bf16 v147, v105, v13
    v_dot2c_f32_bf16 v148, v106, v12
    v_dot2c_f32_bf16 v149, v106, v13
    v_dot2c_f32_bf16 v150, v107, v12
    v_dot2c_f32_bf16 v151, v107, v13
    s_waitcnt vmcnt(7)
    v_dot2c_f32_bf16 v136, v72, v12
    v_dot2c_f32_bf16 v137, v72, v13
    v_dot2c_f32_bf16 v138, v73, v12
    v_dot2c_f32_bf16 v139, v73, v13
    v_dot2c_f32_bf16 v140, v74, v12
    v_dot2c_f32_bf16 v141, v74, v13
    v_dot2c_f32_bf16 v142, v75, v12
    v_dot2c_f32_bf16 v143, v75, v13
    s_waitcnt vmcnt(6)
    v_dot2c_f32_bf16 v144, v108, v12
    v_dot2c_f32_bf16 v145, v108, v13
    v_dot2c_f32_bf16 v146, v109, v12
    v_dot2c_f32_bf16 v147, v109, v13
    v_dot2c_f32_bf16 v148, v110, v12
    v_dot2c_f32_bf16 v149, v110, v13
    v_dot2c_f32_bf16 v150, v111, v12
    v_dot2c_f32_bf16 v151, v111, v13
    s_waitcnt vmcnt(5)
    v_dot2c_f32_bf16 v136, v76, v12
    v_dot2c_f32_bf16 v137, v76, v13
    v_dot2c_f32_bf16 v138, v77, v12
    v_dot2c_f32_bf16 v139, v77, v13
    v_dot2c_f32_bf16 v140, v78, v12
    v_dot2c_f32_bf16 v141, v78, v13
    v_dot2c_f32_bf16 v142, v79, v12
    v_dot2c_f32_bf16 v143, v79, v13
    s_waitcnt vmcnt(4)
    v_dot2c_f32_bf16 v144, v112, v12
    v_dot2c_f32_bf16 v145, v112, v13
    v_dot2c_f32_bf16 v146, v113, v12
    v_dot2c_f32_bf16 v147, v113, v13
    v_dot2c_f32_bf16 v148, v114, v12
    v_dot2c_f32_bf16 v149, v114, v13
    v_dot2c_f32_bf16 v150, v115, v12
    v_dot2c_f32_bf16 v151, v115, v13
    s_waitcnt vmcnt(3)
    v_dot2c_f32_bf16 v136, v80, v12
    v_dot2c_f32_bf16 v137, v80, v13
    v_dot2c_f32_bf16 v138, v81, v12
    v_dot2c_f32_bf16 v139, v81, v13
    v_dot2c_f32_bf16 v140, v82, v12
    v_dot2c_f32_bf16 v141, v82, v13
    v_dot2c_f32_bf16 v142, v83, v12
    v_dot2c_f32_bf16 v143, v83, v13
    s_waitcnt vmcnt(2)
    v_dot2c_f32_bf16 v144, v116, v12
    v_dot2c_f32_bf16 v145, v116, v13
    v_dot2c_f32_bf16 v146, v117, v12
    v_dot2c_f32_bf16 v147, v117, v13
    v_dot2c_f32_bf16 v148, v118, v12
    v_dot2c_f32_bf16 v149, v118, v13
    v_dot2c_f32_bf16 v150, v119, v12
    v_dot2c_f32_bf16 v151, v119, v13
    s_waitcnt vmcnt(1)
    v_dot2c_f32_bf16 v136, v84, v12
    v_dot2c_f32_bf16 v137, v84, v13
    v_dot2c_f32_bf16 v138, v85, v12
    v_dot2c_f32_bf16 v139, v85, v13
    v_dot2c_f32_bf16 v140, v86, v12
    v_dot2c_f32_bf16 v141, v86, v13
    v_dot2c_f32_bf16 v142, v87, v12
    v_dot2c_f32_bf16 v143, v87, v13
    s_waitcnt vmcnt(0)
    v_dot2c_f32_bf16 v144, v120, v12
    v_dot2c_f32_bf16 v145, v120, v13
    v_dot2c_f32_bf16 v146, v121, v12
    v_dot2c_f32_bf16 v147, v121, v13
    v_dot2c_f32_bf16 v148, v122, v12
    v_dot2c_f32_bf16 v149, v122, v13
    v_dot2c_f32_bf16 v150, v123, v12
    v_dot2c_f32_bf16 v151, v123, v13
    s_mov_b32 s16, s38
    s_mov_b32 s17, s39
    s_mov_b32 s18, 0x240000
    s_mov_b32 s19, 0x20000
    v_cvt_pk_bf16_f32 v160, v128, v129
    v_cvt_pk_bf16_f32 v161, v130, v131
    v_cvt_pk_bf16_f32 v162, v132, v133
    v_cvt_pk_bf16_f32 v163, v134, v135
    buffer_store_dwordx4 v[160:163], v3, s[16:19], s50 offen sc1
    v_cvt_pk_bf16_f32 v164, v136, v137
    v_cvt_pk_bf16_f32 v165, v138, v139
    v_cvt_pk_bf16_f32 v166, v140, v141
    v_cvt_pk_bf16_f32 v167, v142, v143
    buffer_store_dwordx4 v[164:167], v3, s[16:19], s51 offen sc1
    v_cvt_pk_bf16_f32 v168, v144, v145
    v_cvt_pk_bf16_f32 v169, v146, v147
    v_cvt_pk_bf16_f32 v170, v148, v149
    v_cvt_pk_bf16_f32 v171, v150, v151
    buffer_store_dwordx4 v[168:171], v3, s[16:19], s52 offen sc1
L_w3a_113:
    s_waitcnt vmcnt(0) lgkmcnt(0)
interleave_layers__sliding_local_dilated__glu_gated_bilinear__prompt_kernel_end:
    s_endpgm
L_pn_slow_27:
    s_mov_b32 s97, 0x40000
L_pn_spin_29:
    s_sleep 4
    global_load_dwordx2 v[6:7], v5, s[40:41] sc1
    s_waitcnt vmcnt(0)
    v_cmp_ne_u64 vcc, 0, v[6:7]
    s_sub_u32 s97, s97, 1
    s_cbranch_scc1 L_pn_back_28
    s_cmp_eq_u64 vcc, exec
    s_cbranch_scc1 L_pn_back_28
    s_branch L_pn_spin_29
L_pwo_slow_35:
    s_mov_b32 s97, 0x40000
L_pwo_spin_37:
    s_sleep 4
    buffer_load_dwordx2 v[14:15], v13, s[4:7], s23 offen sc1
    s_waitcnt vmcnt(0)
    v_cmp_eq_u64 vcc, s[98:99], v[14:15]
    s_sub_u32 s97, s97, 1
    s_cbranch_scc1 L_pwo_back_36
    s_cmp_eq_u64 vcc, exec
    s_cbranch_scc1 L_pwo_back_36
    s_branch L_pwo_spin_37
L_px_slow_44:
    s_mov_b32 s97, 0x40000
L_px_spin_46:
    s_sleep 4
    buffer_load_dwordx2 v[12:13], v11, s[4:7], s23 offen sc1
    s_waitcnt vmcnt(0)
    v_cmp_eq_u64 vcc, s[98:99], v[12:13]
    s_sub_u32 s97, s97, 1
    s_cbranch_scc1 L_px_back_45
    s_cmp_eq_u64 vcc, exec
    s_cbranch_scc1 L_px_back_45
    s_branch L_px_spin_46
L_pw_slow_53:
    s_mov_b32 s97, 0x40000
L_pw_spin_55:
    s_sleep 4
    buffer_load_dwordx2 v[12:13], v14, s[4:7], s1 offen sc1
    s_waitcnt vmcnt(0)
    v_cmp_eq_u64 vcc, s[98:99], v[12:13]
    s_sub_u32 s97, s97, 1
    s_cbranch_scc1 L_pw_back_54
    s_cmp_eq_u64 vcc, exec
    s_cbranch_scc1 L_pw_back_54
    s_branch L_pw_spin_55
L_po_slow_56:
    s_mov_b32 s97, 0x40000
L_po_spin_58:
    s_sleep 4
    buffer_load_dwordx2 v[12:13], v10, s[4:7], s52 offen sc1
    s_waitcnt vmcnt(0)
    v_cmp_eq_u64 vcc, s[98:99], v[12:13]
    s_sub_u32 s97, s97, 1
    s_cbranch_scc1 L_po_back_57
    s_cmp_eq_u64 vcc, exec
    s_cbranch_scc1 L_po_back_57
    s_branch L_po_spin_58
L_p1_slow_79:
    s_mov_b32 s97, 0x40000
L_p1_spin_81:
    s_sleep 4
    buffer_load_dwordx2 v[168:169], v0, s[4:7], s55 offen sc1
    s_waitcnt vmcnt(0)
    v_cmp_eq_u64 vcc, s[98:99], v[168:169]
    s_sub_u32 s97, s97, 1
    s_cbranch_scc1 L_p1_back_80
    s_cmp_eq_u64 vcc, exec
    s_cbranch_scc1 L_p1_back_80
    s_branch L_p1_spin_81
L_pd_slow_84:
    s_mov_b32 s97, 0x40000
L_pd_spin_86:
    s_sleep 4
    buffer_load_dwordx2 v[6:7], v0, s[4:7], s55 offen sc1
    s_waitcnt vmcnt(0)
    v_cmp_eq_u64 vcc, s[98:99], v[6:7]
    s_sub_u32 s97, s97, 1
    s_cbranch_scc1 L_pd_back_85
    s_cmp_eq_u64 vcc, exec
    s_cbranch_scc1 L_pd_back_85
    s_branch L_pd_spin_86
L_p0_slow_87:
    s_mov_b32 s97, 0x40000
L_p0_spin_89:
    s_sleep 4
    buffer_load_dwordx2 v[6:7], v0, s[4:7], s55 offen sc1
    s_waitcnt vmcnt(0)
    v_cmp_eq_u64 vcc, s[98:99], v[6:7]
    s_sub_u32 s97, s97, 1
    s_cbranch_scc1 L_p0_back_88
    s_cmp_eq_u64 vcc, exec
    s_cbranch_scc1 L_p0_back_88
    s_branch L_p0_spin_89
L_p1_slow_90:
    s_mov_b32 s97, 0x40000
L_p1_spin_92:
    s_sleep 4
    buffer_load_dwordx2 v[6:7], v0, s[4:7], s55 offen sc1
    s_waitcnt vmcnt(0)
    v_cmp_eq_u64 vcc, s[98:99], v[6:7]
    s_sub_u32 s97, s97, 1
    s_cbranch_scc1 L_p1_back_91
    s_cmp_eq_u64 vcc, exec
    s_cbranch_scc1 L_p1_back_91
    s_branch L_p1_spin_92
L_p2_slow_93:
    s_mov_b32 s97, 0x40000
L_p2_spin_95:
    s_sleep 4
    buffer_load_dwordx2 v[6:7], v0, s[4:7], s55 offen sc1
    s_waitcnt vmcnt(0)
    v_cmp_eq_u64 vcc, s[98:99], v[6:7]
    s_sub_u32 s97, s97, 1
    s_cbranch_scc1 L_p2_back_94
    s_cmp_eq_u64 vcc, exec
    s_cbranch_scc1 L_p2_back_94
    s_branch L_p2_spin_95
L_pa_slow_97:
    s_mov_b32 s97, 0x40000
L_pa_spin_99:
    s_sleep 4
    buffer_load_dwordx2 v[176:177], v10, s[4:7], s58 offen sc1
    s_waitcnt vmcnt(0)
    v_cmp_eq_u64 vcc, s[98:99], v[176:177]
    s_sub_u32 s97, s97, 1
    s_cbranch_scc1 L_pa_back_98
    s_cmp_eq_u64 vcc, exec
    s_cbranch_scc1 L_pa_back_98
    s_branch L_pa_spin_99
L_pp_slow_100:
    s_mov_b32 s97, 0x40000
L_pp_spin_102:
    s_sleep 4
    buffer_load_dwordx2 v[176:177], v10, s[4:7], s49 offen sc1
    s_waitcnt vmcnt(0)
    v_cmp_eq_u64 vcc, s[98:99], v[176:177]
    s_sub_u32 s97, s97, 1
    s_cbranch_scc1 L_pp_back_101
    s_cmp_eq_u64 vcc, exec
    s_cbranch_scc1 L_pp_back_101
    s_branch L_pp_spin_102
L_px_slow_105:
    s_mov_b32 s97, 0x40000
L_px_spin_107:
    s_sleep 4
    buffer_load_dwordx2 v[12:13], v11, s[4:7], s23 offen sc1
    s_waitcnt vmcnt(0)
    v_cmp_eq_u64 vcc, s[98:99], v[12:13]
    s_sub_u32 s97, s97, 1
    s_cbranch_scc1 L_px_back_106
    s_cmp_eq_u64 vcc, exec
    s_cbranch_scc1 L_px_back_106
    s_branch L_px_spin_107
L_po_slow_110:
    s_mov_b32 s97, 0x40000
L_po_spin_112:
    s_sleep 4
    buffer_load_dwordx2 v[12:13], v10, s[4:7], s52 offen sc1
    s_waitcnt vmcnt(0)
    v_cmp_eq_u64 vcc, s[98:99], v[12:13]
    s_sub_u32 s97, s97, 1
    s_cbranch_scc1 L_po_back_111
    s_cmp_eq_u64 vcc, exec
    s_cbranch_scc1 L_po_back_111
    s_branch L_po_spin_112
L_pa_slow_114:
    s_mov_b32 s97, 0x40000
L_pa_spin_116:
    s_sleep 4
    buffer_load_dwordx2 v[176:177], v10, s[4:7], s58 offen sc1
    s_waitcnt vmcnt(0)
    v_cmp_eq_u64 vcc, s[98:99], v[176:177]
    s_sub_u32 s97, s97, 1
    s_cbranch_scc1 L_pa_back_115
    s_cmp_eq_u64 vcc, exec
    s_cbranch_scc1 L_pa_back_115
    s_branch L_pa_spin_116
L_pp_slow_117:
    s_mov_b32 s97, 0x40000
L_pp_spin_119:
    s_sleep 4
    buffer_load_dwordx2 v[176:177], v10, s[4:7], s49 offen sc1
    s_waitcnt vmcnt(0)
    v_cmp_eq_u64 vcc, s[98:99], v[176:177]
    s_sub_u32 s97, s97, 1
    s_cbranch_scc1 L_pp_back_118
    s_cmp_eq_u64 vcc, exec
    s_cbranch_scc1 L_pp_back_118
    s_branch L_pp_spin_119
interleave_layers__sliding_local_dilated__glu_gated_bilinear__prompt_kernel_last:
    s_endpgm
.section .rodata,"a"
.p2align 6
.amdhsa_kernel interleave_layers__sliding_local_dilated__glu_gated_bilinear__prompt_kernel
  .amdhsa_next_free_vgpr 512
  .amdhsa_next_free_sgpr 102
  .amdhsa_accum_offset 256
  .amdhsa_group_segment_fixed_size 0
  .amdhsa_kernarg_size 80
  .amdhsa_user_sgpr_count 2
  .amdhsa_user_sgpr_kernarg_segment_ptr 1
  .amdhsa_system_sgpr_workgroup_id_x 1
  .amdhsa_float_denorm_mode_32 3
.end_amdhsa_kernel
```
